```python
import torch

def _softmax(x, axis=-1):
    return torch.softmax(x, dim=axis)
def _gelu(x):
    return torch.nn.functional.gelu(x, approximate="tanh")
def _silu(x):
    return torch.nn.functional.silu(x)
def _sigmoid(x):
    return torch.sigmoid(x)
def _layernorm(x, axis=-1, eps=1e-5):
    m = x.mean(dim=axis, keepdim=True)
    v = x.var(dim=axis, keepdim=True, unbiased=False)
    return (x - m) / torch.sqrt(v + eps)
def _scatter_add(tgt, idx, src, axis=0):
    return tgt.clone().index_add_(axis, idx, src)
def _segment_sum(src, seg, n):
    out = torch.zeros((n,) + src.shape[1:], dtype=src.dtype)
    return out.index_add_(0, seg, src)
def _pad(x, pw):
    flat = tuple(v for pair in reversed(pw) for v in pair)
    return torch.nn.functional.pad(x, flat)

kernel_name = 'standalone__kv_cache_quant_int4_int2_kv_with_per_channel_or_per_token_scales__sampling'

def setup_inputs():

    _w = (lambda a: (lambda t: t.to(torch.bfloat16) if t.is_floating_point() else t)(torch.as_tensor(a)))
    B = 8
    Sq = 4
    Skv = 4096
    Hq = 32
    Hkv = 32
    Dh = 192
    bits = 2
    G = 64
    if G <= 0 or G >= Skv:
        G = max(1, Skv // 2)
    Skv = (Skv // G) * G
    ngk = Skv // G
    qmax = (1 << bits) - 1
    return {
        "q": _w((lambda *s: torch.randn(*s, dtype=torch.bfloat16) * 3.2)(B, Hq, Sq, Dh)),
        "qk": _w(torch.randint(0, qmax + 1, (B, Hkv, Skv, Dh)).to(torch.int32)),
        "qv": _w(torch.randint(0, qmax + 1, (B, Hkv, Skv, Dh)).to(torch.int32)),
        "k_scales": _w(torch.abs((lambda *s: torch.randn(*s, dtype=torch.bfloat16) * 3.2)(B, Hkv, ngk, Dh)) * 0.05 + 0.02),
        "k_zeros": _w((lambda *s: torch.randn(*s, dtype=torch.bfloat16) * 3.2)(B, Hkv, ngk, Dh) + float(qmax) / 2.0),
        "v_scales": _w(torch.abs((lambda *s: torch.randn(*s, dtype=torch.bfloat16) * 0.05)(B, Hkv, Skv, 1)) * 0.05 + 0.02),
        "v_zeros": _w((lambda *s: torch.randn(*s, dtype=torch.bfloat16) * 0.05)(B, Hkv, Skv, 1) + float(qmax) / 2.0),
    }

def reference(q, qk, qv, k_scales, k_zeros, v_scales, v_zeros):
    B, Hq, Sq, Dh = q.shape
    Hkv, Skv = qk.shape[1], qk.shape[2]
    ngk = k_scales.shape[2]
    G = Skv // ngk
    ks = (lambda x, n, axis: torch.repeat_interleave(x, n, dim=axis))(k_scales, G, axis=2)
    kz = (lambda x, n, axis: torch.repeat_interleave(x, n, dim=axis))(k_zeros, G, axis=2)
    k = ((lambda x, dt: x.to(dt))(qk, q.dtype) - kz) * ks
    v = ((lambda x, dt: x.to(dt))(qv, q.dtype) - v_zeros) * v_scales
    rep = Hq // Hkv
    if rep > 1:
        k = (lambda x, n, axis: torch.repeat_interleave(x, n, dim=axis))(k, rep, axis=1)
        v = (lambda x, n, axis: torch.repeat_interleave(x, n, dim=axis))(v, rep, axis=1)
    scale = float(Dh) ** -0.5
    logits = torch.einsum("bhqd,bhkd->bhqk", q, k) * scale
    p = _softmax(logits, axis=-1)
    o = torch.einsum("bhqk,bhkd->bhqd", p, v)
    return o
```

```asm
; @launch grid=(256,1,1) block=(256,1,1) lds=148480
.amdgcn_target "amdgcn-amd-amdhsa--gfx950"
.text
.globl standalone__kv_cache_quant_int4_int2_kv_with_per_channel_or_per_token_scales__sampling_kernel
.p2align 8
.type standalone__kv_cache_quant_int4_int2_kv_with_per_channel_or_per_token_scales__sampling_kernel,@function
standalone__kv_cache_quant_int4_int2_kv_with_per_channel_or_per_token_scales__sampling_kernel:
    s_cmp_ge_u32 s2, 256
    s_cbranch_scc1 L_end
    s_load_dwordx16 s[4:19], s[0:1], 0
    s_load_dwordx4 s[20:23], s[0:1], 64
    v_lshrrev_b32 v2, 6, v0
    v_and_b32 v1, 63, v0
    v_readfirstlane_b32 s56, v2
    s_mov_b32 s60, 768
    s_mul_i32 s57, s2, 3145728
    v_bfe_u32 v3, v1, 2, 2
    v_lshl_add_u32 v3, v2, 2, v3
    v_lshrrev_b32 v4, 4, v1
    v_and_b32 v20, 3, v1
    v_lshl_add_u32 v4, v4, 2, v20
    v_lshlrev_b32 v4, 4, v4
    v_mad_u32_u24 v6, v3, s60, v4
    v_cmp_le_u32 vcc, 11, v3
    v_add_u32 v5, 33024, v6
    s_nop 0
    v_cndmask_b32 v7, v6, v5, vcc
    v_cmp_le_u32 vcc, 6, v3
    s_nop 1
    v_cndmask_b32 v8, v6, v5, vcc
    v_add_u32 v5, 32256, v6
    v_cndmask_b32 v9, v6, v5, vcc
    v_lshlrev_b32 v21, 4, v1
    s_waitcnt lgkmcnt(0)
    s_mov_b32 s36, s12
    s_and_b32 s37, s13, 0xffff
    s_mov_b32 s38, 6291456
    s_mov_b32 s39, 0x20000
    s_mov_b32 s32, s10
    s_and_b32 s33, s11, 0xffff
    s_mov_b32 s34, 6291456
    s_mov_b32 s35, 0x20000
    s_mul_i32 s61, s2, 24576
    s_mul_i32 s62, s56, 6144
    s_add_u32 s61, s61, s62
    s_add_u32 s62, s61, 3072
    buffer_load_dwordx4 v[92:95], v21, s[36:39], s61 offen offset:0 nt
    buffer_load_dwordx4 v[96:99], v21, s[36:39], s61 offen offset:1024 nt
    buffer_load_dwordx4 v[100:103], v21, s[36:39], s61 offen offset:2048 nt
    buffer_load_dwordx4 v[104:107], v21, s[36:39], s62 offen offset:0 nt
    buffer_load_dwordx4 v[108:111], v21, s[36:39], s62 offen offset:1024 nt
    buffer_load_dwordx4 v[112:115], v21, s[36:39], s62 offen offset:2048 nt
    buffer_load_dwordx4 v[116:119], v21, s[32:35], s61 offen offset:0 nt
    buffer_load_dwordx4 v[120:123], v21, s[32:35], s61 offen offset:1024 nt
    buffer_load_dwordx4 v[124:127], v21, s[32:35], s61 offen offset:2048 nt
    buffer_load_dwordx4 v[128:131], v21, s[32:35], s62 offen offset:0 nt
    buffer_load_dwordx4 v[132:135], v21, s[32:35], s62 offen offset:1024 nt
    buffer_load_dwordx4 v[136:139], v21, s[32:35], s62 offen offset:2048 nt
    s_mov_b32 s24, s6
    s_and_b32 s25, s7, 0xffff
    s_mov_b32 s26, 805306368
    s_mov_b32 s27, 0x20000
    s_mov_b32 s48, s4
    s_and_b32 s49, s5, 0xffff
    s_mov_b32 s50, 393216
    s_mov_b32 s51, 0x20000
    v_lshrrev_b32 v22, 2, v1
    v_lshlrev_b32 v22, 3, v22
    v_mul_u32_u24 v20, 384, v20
    v_add_u32 v22, v22, v20
    s_lshr_b32 s61, s2, 0
    s_mul_i32 s61, s61, 1536
    buffer_load_dwordx2 v[160:161], v22, s[48:51], s61 offen offset:0
    buffer_load_dwordx2 v[162:163], v22, s[48:51], s61 offen offset:128
    buffer_load_dwordx2 v[164:165], v22, s[48:51], s61 offen offset:256
    s_mov_b32 s40, s14
    s_and_b32 s41, s15, 0xffff
    s_mov_b32 s42, 2097152
    s_mov_b32 s43, 0x20000
    s_mov_b32 s44, s16
    s_and_b32 s45, s17, 0xffff
    s_mov_b32 s46, 2097152
    s_mov_b32 s47, 0x20000
    s_mul_i32 s61, s2, 8192
    s_mul_i32 s62, s56, 2048
    s_add_u32 s61, s61, s62
    s_add_u32 s62, s61, 1024
    buffer_load_dwordx4 v[168:171], v21, s[40:43], s61 offen nt
    buffer_load_dwordx4 v[172:175], v21, s[40:43], s62 offen nt
    buffer_load_dwordx4 v[176:179], v21, s[44:47], s61 offen nt
    buffer_load_dwordx4 v[180:183], v21, s[44:47], s62 offen nt
    s_add_u32 s60, s57, 0
    buffer_load_dwordx4 v[44:47], v6, s[24:27], s60 offen offset:0 nt
    buffer_load_dwordx4 v[48:51], v6, s[24:27], s60 offen offset:256 nt
    buffer_load_dwordx4 v[52:55], v6, s[24:27], s60 offen offset:512 nt
    s_add_u32 s61, s57, 33024
    buffer_load_dwordx4 v[56:59], v6, s[24:27], s61 offen offset:0 nt
    buffer_load_dwordx4 v[60:63], v6, s[24:27], s61 offen offset:256 nt
    buffer_load_dwordx4 v[64:67], v6, s[24:27], s61 offen offset:512 nt
    s_mov_b32 s28, s8
    s_and_b32 s29, s9, 0xffff
    s_mov_b32 s30, 805306368
    s_mov_b32 s31, 0x20000
    s_mov_b32 s66, 0x3fb8aa3b
    s_mov_b32 s67, 0x3d93cd3a
    s_mov_b32 s68, 0xffff0000
    s_mov_b32 s69, 0x05040100
    s_mov_b32 s70, 0x07060302
    s_mov_b32 s60, 768
    v_add_u32 v23, 0, v3
    v_lshrrev_b32 v23, 6, v23
    v_mad_u32_u24 v23, v23, s60, v4
    v_add_u32 v24, 43, v3
    v_lshrrev_b32 v24, 6, v24
    v_mad_u32_u24 v24, v24, s60, v4
    v_add_u32 v25, 16, v3
    v_lshrrev_b32 v25, 6, v25
    v_mad_u32_u24 v25, v25, s60, v4
    v_add_u32 v26, 59, v3
    v_lshrrev_b32 v26, 6, v26
    v_mad_u32_u24 v26, v26, s60, v4
    v_add_u32 v27, 32, v3
    v_cmp_le_u32 vcc, 11, v3
    v_add_u32 v5, 43, v27
    s_nop 0
    v_cndmask_b32 v27, v27, v5, vcc
    v_lshrrev_b32 v27, 6, v27
    v_mad_u32_u24 v27, v27, s60, v4
    v_add_u32 v28, 75, v3
    v_cmp_le_u32 vcc, 11, v3
    v_add_u32 v5, 43, v28
    s_nop 0
    v_cndmask_b32 v28, v28, v5, vcc
    v_lshrrev_b32 v28, 6, v28
    v_mad_u32_u24 v28, v28, s60, v4
    v_add_u32 v29, 91, v3
    v_lshrrev_b32 v29, 6, v29
    v_mad_u32_u24 v29, v29, s60, v4
    v_add_u32 v30, 134, v3
    v_lshrrev_b32 v30, 6, v30
    v_mad_u32_u24 v30, v30, s60, v4
    v_add_u32 v31, 107, v3
    v_lshrrev_b32 v31, 6, v31
    v_mad_u32_u24 v31, v31, s60, v4
    v_add_u32 v32, 150, v3
    v_lshrrev_b32 v32, 6, v32
    v_mad_u32_u24 v32, v32, s60, v4
    v_add_u32 v33, 123, v3
    v_cmp_le_u32 vcc, 6, v3
    v_add_u32 v5, 43, v33
    s_nop 0
    v_cndmask_b32 v33, v33, v5, vcc
    v_lshrrev_b32 v33, 6, v33
    v_mad_u32_u24 v33, v33, s60, v4
    v_add_u32 v34, 166, v3
    v_cmp_le_u32 vcc, 6, v3
    v_add_u32 v5, 42, v34
    s_nop 0
    v_cndmask_b32 v34, v34, v5, vcc
    v_lshrrev_b32 v34, 6, v34
    v_mad_u32_u24 v34, v34, s60, v4
    v_add_u32 v35, 182, v3
    v_lshrrev_b32 v35, 6, v35
    v_mad_u32_u24 v35, v35, s60, v4
    v_add_u32 v36, 224, v3
    v_lshrrev_b32 v36, 6, v36
    v_mad_u32_u24 v36, v36, s60, v4
    v_add_u32 v37, 198, v3
    v_lshrrev_b32 v37, 6, v37
    v_mad_u32_u24 v37, v37, s60, v4
    v_add_u32 v38, 240, v3
    v_lshrrev_b32 v38, 6, v38
    v_mad_u32_u24 v38, v38, s60, v4
    v_lshrrev_b32 v3, 4, v1
    v_lshl_add_u32 v3, v2, 2, v3
    v_and_b32 v4, 15, v1
    v_lshlrev_b32 v4, 4, v4
    v_mad_u32_u24 v10, v3, s60, v4
    v_cmp_le_u32 vcc, 11, v3
    v_add_u32 v5, 33024, v10
    s_nop 0
    v_cndmask_b32 v11, v10, v5, vcc
    v_cmp_le_u32 vcc, 6, v3
    s_nop 1
    v_cndmask_b32 v12, v10, v5, vcc
    v_add_u32 v5, 32256, v10
    v_cndmask_b32 v13, v10, v5, vcc
    v_bfe_u32 v4, v1, 2, 2
    v_lshl_add_u32 v3, v4, 4, v3
    v_cmp_le_u32 vcc, 43, v3
    v_add_u32 v5, 43, v3
    s_nop 0
    v_cndmask_b32 v14, v3, v5, vcc
    v_add_u32 v15, 43, v14
    v_cmp_le_u32 vcc, 22, v3
    s_nop 1
    v_cndmask_b32 v16, v3, v5, vcc
    v_add_u32 v16, 107, v16
    v_add_u32 v5, 42, v3
    v_cndmask_b32 v17, v3, v5, vcc
    v_add_u32 v17, 150, v17
    s_mov_b32 s61, 131072
    v_lshl_add_u32 v14, v14, 2, s61
    v_lshl_add_u32 v15, v15, 2, s61
    v_lshl_add_u32 v16, v16, 2, s61
    v_lshl_add_u32 v17, v17, 2, s61
    v_lshlrev_b32 v18, 2, v1
    v_lshl_add_u32 v19, v2, 8, v18
    v_add_u32 v19, 147456, v19
    v_lshl_add_u32 v18, v2, 13, v18
    v_add_u32 v18, 98304, v18
    v_mul_u32_u24 v3, 12288, v2
    v_lshl_add_u32 v3, v1, 5, v3
    s_waitcnt vmcnt(24)
    v_lshlrev_b32 v68, 16, v92
    v_and_b32 v69, s68, v92
    v_lshlrev_b32 v70, 16, v93
    v_and_b32 v71, s68, v93
    v_lshlrev_b32 v72, 16, v94
    v_and_b32 v73, s68, v94
    v_lshlrev_b32 v74, 16, v95
    v_and_b32 v75, s68, v95
    ds_write_b128 v3, v[68:71] offset:0
    ds_write_b128 v3, v[72:75] offset:16
    s_waitcnt vmcnt(23)
    v_lshlrev_b32 v76, 16, v96
    v_and_b32 v77, s68, v96
    v_lshlrev_b32 v78, 16, v97
    v_and_b32 v79, s68, v97
    v_lshlrev_b32 v80, 16, v98
    v_and_b32 v81, s68, v98
    v_lshlrev_b32 v82, 16, v99
    v_and_b32 v83, s68, v99
    ds_write_b128 v3, v[76:79] offset:2048
    ds_write_b128 v3, v[80:83] offset:2064
    s_waitcnt vmcnt(22)
    v_lshlrev_b32 v84, 16, v100
    v_and_b32 v85, s68, v100
    v_lshlrev_b32 v86, 16, v101
    v_and_b32 v87, s68, v101
    v_lshlrev_b32 v88, 16, v102
    v_and_b32 v89, s68, v102
    v_lshlrev_b32 v90, 16, v103
    v_and_b32 v91, s68, v103
    ds_write_b128 v3, v[84:87] offset:4096
    ds_write_b128 v3, v[88:91] offset:4112
    s_waitcnt vmcnt(21)
    v_lshlrev_b32 v68, 16, v104
    v_and_b32 v69, s68, v104
    v_lshlrev_b32 v70, 16, v105
    v_and_b32 v71, s68, v105
    v_lshlrev_b32 v72, 16, v106
    v_and_b32 v73, s68, v106
    v_lshlrev_b32 v74, 16, v107
    v_and_b32 v75, s68, v107
    ds_write_b128 v3, v[68:71] offset:6144
    ds_write_b128 v3, v[72:75] offset:6160
    s_waitcnt vmcnt(20)
    v_lshlrev_b32 v76, 16, v108
    v_and_b32 v77, s68, v108
    v_lshlrev_b32 v78, 16, v109
    v_and_b32 v79, s68, v109
    v_lshlrev_b32 v80, 16, v110
    v_and_b32 v81, s68, v110
    v_lshlrev_b32 v82, 16, v111
    v_and_b32 v83, s68, v111
    ds_write_b128 v3, v[76:79] offset:8192
    ds_write_b128 v3, v[80:83] offset:8208
    s_waitcnt vmcnt(19)
    v_lshlrev_b32 v84, 16, v112
    v_and_b32 v85, s68, v112
    v_lshlrev_b32 v86, 16, v113
    v_and_b32 v87, s68, v113
    v_lshlrev_b32 v88, 16, v114
    v_and_b32 v89, s68, v114
    v_lshlrev_b32 v90, 16, v115
    v_and_b32 v91, s68, v115
    ds_write_b128 v3, v[84:87] offset:10240
    ds_write_b128 v3, v[88:91] offset:10256
    s_waitcnt vmcnt(18)
    v_lshlrev_b32 v68, 16, v116
    v_and_b32 v69, s68, v116
    v_lshlrev_b32 v70, 16, v117
    v_and_b32 v71, s68, v117
    v_lshlrev_b32 v72, 16, v118
    v_and_b32 v73, s68, v118
    v_lshlrev_b32 v74, 16, v119
    v_and_b32 v75, s68, v119
    ds_write_b128 v3, v[68:71] offset:49152
    ds_write_b128 v3, v[72:75] offset:49168
    s_waitcnt vmcnt(17)
    v_lshlrev_b32 v76, 16, v120
    v_and_b32 v77, s68, v120
    v_lshlrev_b32 v78, 16, v121
    v_and_b32 v79, s68, v121
    v_lshlrev_b32 v80, 16, v122
    v_and_b32 v81, s68, v122
    v_lshlrev_b32 v82, 16, v123
    v_and_b32 v83, s68, v123
    ds_write_b128 v3, v[76:79] offset:51200
    ds_write_b128 v3, v[80:83] offset:51216
    s_waitcnt vmcnt(16)
    v_lshlrev_b32 v84, 16, v124
    v_and_b32 v85, s68, v124
    v_lshlrev_b32 v86, 16, v125
    v_and_b32 v87, s68, v125
    v_lshlrev_b32 v88, 16, v126
    v_and_b32 v89, s68, v126
    v_lshlrev_b32 v90, 16, v127
    v_and_b32 v91, s68, v127
    ds_write_b128 v3, v[84:87] offset:53248
    ds_write_b128 v3, v[88:91] offset:53264
    s_waitcnt vmcnt(15)
    v_lshlrev_b32 v68, 16, v128
    v_and_b32 v69, s68, v128
    v_lshlrev_b32 v70, 16, v129
    v_and_b32 v71, s68, v129
    v_lshlrev_b32 v72, 16, v130
    v_and_b32 v73, s68, v130
    v_lshlrev_b32 v74, 16, v131
    v_and_b32 v75, s68, v131
    ds_write_b128 v3, v[68:71] offset:55296
    ds_write_b128 v3, v[72:75] offset:55312
    s_waitcnt vmcnt(14)
    v_lshlrev_b32 v76, 16, v132
    v_and_b32 v77, s68, v132
    v_lshlrev_b32 v78, 16, v133
    v_and_b32 v79, s68, v133
    v_lshlrev_b32 v80, 16, v134
    v_and_b32 v81, s68, v134
    v_lshlrev_b32 v82, 16, v135
    v_and_b32 v83, s68, v135
    ds_write_b128 v3, v[76:79] offset:57344
    ds_write_b128 v3, v[80:83] offset:57360
    s_waitcnt vmcnt(13)
    v_lshlrev_b32 v84, 16, v136
    v_and_b32 v85, s68, v136
    v_lshlrev_b32 v86, 16, v137
    v_and_b32 v87, s68, v137
    v_lshlrev_b32 v88, 16, v138
    v_and_b32 v89, s68, v138
    v_lshlrev_b32 v90, 16, v139
    v_and_b32 v91, s68, v139
    ds_write_b128 v3, v[84:87] offset:59392
    ds_write_b128 v3, v[88:91] offset:59408
    v_lshlrev_b32 v3, 12, v2
    v_lshl_add_u32 v3, v1, 5, v3
    v_add_u32 v3, 131072, v3
    s_waitcnt vmcnt(6)
    v_perm_b32 v92, v168, v176, s69
    v_perm_b32 v93, v168, v176, s70
    v_perm_b32 v94, v169, v177, s69
    v_perm_b32 v95, v169, v177, s70
    v_perm_b32 v96, v170, v178, s69
    v_perm_b32 v97, v170, v178, s70
    v_perm_b32 v98, v171, v179, s69
    v_perm_b32 v99, v171, v179, s70
    ds_write_b128 v3, v[92:95] offset:0
    ds_write_b128 v3, v[96:99] offset:16
    v_perm_b32 v100, v172, v180, s69
    v_perm_b32 v101, v172, v180, s70
    v_perm_b32 v102, v173, v181, s69
    v_perm_b32 v103, v173, v181, s70
    v_perm_b32 v104, v174, v182, s69
    v_perm_b32 v105, v174, v182, s70
    v_perm_b32 v106, v175, v183, s69
    v_perm_b32 v107, v175, v183, s70
    ds_write_b128 v3, v[100:103] offset:2048
    ds_write_b128 v3, v[104:107] offset:2064
    v_mov_b32 v20, 0xff800000
    s_mov_b32 s58, s57
    s_mov_b32 s63, 0
    s_mov_b32 s71, 0
    s_waitcnt lgkmcnt(0)
    s_barrier
    v_add_u32 v39, s71, v23
    v_add_u32 v40, s71, v24
    ds_read_b128 v[92:95], v39 offset:0
    ds_read_b128 v[116:119], v39 offset:49152
    ds_read_b128 v[96:99], v39 offset:256
    ds_read_b128 v[120:123], v39 offset:49408
    ds_read_b128 v[100:103], v39 offset:512
    ds_read_b128 v[124:127], v39 offset:49664
    ds_read_b128 v[104:107], v40 offset:0
    ds_read_b128 v[128:131], v40 offset:49152
    ds_read_b128 v[108:111], v40 offset:256
    ds_read_b128 v[132:135], v40 offset:49408
    ds_read_b128 v[112:115], v40 offset:512
    ds_read_b128 v[136:139], v40 offset:49664
L_kblk:
    s_add_u32 s62, s63, 1
    s_and_b32 s62, s62, 15
    s_cselect_b32 s62, 0, 802160640
    s_add_u32 s59, s58, s62
    s_add_u32 s59, s59, 196608
    s_waitcnt vmcnt(0)
    v_cvt_f32_i32 v68, v44
    v_cvt_f32_i32 v69, v45
    v_cvt_f32_i32 v70, v46
    v_cvt_f32_i32 v71, v47
    v_cvt_f32_i32 v72, v48
    v_cvt_f32_i32 v73, v49
    v_cvt_f32_i32 v74, v50
    v_cvt_f32_i32 v75, v51
    v_cvt_f32_i32 v76, v52
    v_cvt_f32_i32 v77, v53
    v_cvt_f32_i32 v78, v54
    v_cvt_f32_i32 v79, v55
    v_cvt_f32_i32 v80, v56
    v_cvt_f32_i32 v81, v57
    v_cvt_f32_i32 v82, v58
    v_cvt_f32_i32 v83, v59
    v_cvt_f32_i32 v84, v60
    v_cvt_f32_i32 v85, v61
    v_cvt_f32_i32 v86, v62
    v_cvt_f32_i32 v87, v63
    v_cvt_f32_i32 v88, v64
    v_cvt_f32_i32 v89, v65
    v_cvt_f32_i32 v90, v66
    v_cvt_f32_i32 v91, v67
    s_waitcnt lgkmcnt(0)
    v_sub_f32 v68, v68, v92
    v_sub_f32 v69, v69, v93
    v_sub_f32 v70, v70, v94
    v_sub_f32 v71, v71, v95
    v_sub_f32 v72, v72, v96
    v_sub_f32 v73, v73, v97
    v_sub_f32 v74, v74, v98
    v_sub_f32 v75, v75, v99
    v_sub_f32 v76, v76, v100
    v_sub_f32 v77, v77, v101
    v_sub_f32 v78, v78, v102
    v_sub_f32 v79, v79, v103
    v_cvt_pk_bf16_f32 v68, 0, v68
    v_cvt_pk_bf16_f32 v69, 0, v69
    v_cvt_pk_bf16_f32 v70, 0, v70
    v_cvt_pk_bf16_f32 v71, 0, v71
    v_cvt_pk_bf16_f32 v72, 0, v72
    v_cvt_pk_bf16_f32 v73, 0, v73
    v_cvt_pk_bf16_f32 v74, 0, v74
    v_cvt_pk_bf16_f32 v75, 0, v75
    v_cvt_pk_bf16_f32 v76, 0, v76
    v_cvt_pk_bf16_f32 v77, 0, v77
    v_cvt_pk_bf16_f32 v78, 0, v78
    v_cvt_pk_bf16_f32 v79, 0, v79
    v_mul_f32 v68, v68, v116
    v_mul_f32 v69, v69, v117
    v_mul_f32 v70, v70, v118
    v_mul_f32 v71, v71, v119
    v_mul_f32 v72, v72, v120
    v_mul_f32 v73, v73, v121
    v_mul_f32 v74, v74, v122
    v_mul_f32 v75, v75, v123
    v_mul_f32 v76, v76, v124
    v_mul_f32 v77, v77, v125
    v_mul_f32 v78, v78, v126
    s_add_u32 s60, s58, 12288
    buffer_load_dwordx4 v[44:47], v6, s[24:27], s60 offen offset:0 nt
    buffer_load_dwordx4 v[48:51], v6, s[24:27], s60 offen offset:256 nt
    buffer_load_dwordx4 v[52:55], v6, s[24:27], s60 offen offset:512 nt
    s_add_u32 s61, s58, 45312
    buffer_load_dwordx4 v[56:59], v6, s[24:27], s61 offen offset:0 nt
    buffer_load_dwordx4 v[60:63], v6, s[24:27], s61 offen offset:256 nt
    buffer_load_dwordx4 v[64:67], v6, s[24:27], s61 offen offset:512 nt
    v_mul_f32 v79, v79, v127
    v_cvt_pk_bf16_f32 v140, v68, v69
    v_cvt_pk_bf16_f32 v141, v70, v71
    v_cvt_pk_bf16_f32 v142, v72, v73
    v_cvt_pk_bf16_f32 v143, v74, v75
    v_cvt_pk_bf16_f32 v144, v76, v77
    v_cvt_pk_bf16_f32 v145, v78, v79
    v_mfma_f32_16x16x16_bf16 v[152:155], v[140:141], v[160:161], 0
    v_mfma_f32_16x16x16_bf16 v[152:155], v[142:143], v[162:163], v[152:155]
    v_mfma_f32_16x16x16_bf16 v[152:155], v[144:145], v[164:165], v[152:155]
    v_sub_f32 v80, v80, v104
    v_sub_f32 v81, v81, v105
    v_sub_f32 v82, v82, v106
    v_sub_f32 v83, v83, v107
    v_sub_f32 v84, v84, v108
    v_sub_f32 v85, v85, v109
    v_sub_f32 v86, v86, v110
    v_sub_f32 v87, v87, v111
    v_sub_f32 v88, v88, v112
    v_sub_f32 v89, v89, v113
    v_sub_f32 v90, v90, v114
    v_sub_f32 v91, v91, v115
    v_cvt_pk_bf16_f32 v80, 0, v80
    v_cvt_pk_bf16_f32 v81, 0, v81
    v_cvt_pk_bf16_f32 v82, 0, v82
    v_cvt_pk_bf16_f32 v83, 0, v83
    v_cvt_pk_bf16_f32 v84, 0, v84
    v_cvt_pk_bf16_f32 v85, 0, v85
    v_cvt_pk_bf16_f32 v86, 0, v86
    v_cvt_pk_bf16_f32 v87, 0, v87
    v_cvt_pk_bf16_f32 v88, 0, v88
    v_cvt_pk_bf16_f32 v89, 0, v89
    v_cvt_pk_bf16_f32 v90, 0, v90
    v_cvt_pk_bf16_f32 v91, 0, v91
    v_mul_f32 v80, v80, v128
    v_mul_f32 v81, v81, v129
    v_mul_f32 v82, v82, v130
    v_mul_f32 v83, v83, v131
    v_mul_f32 v84, v84, v132
    v_mul_f32 v85, v85, v133
    v_mul_f32 v86, v86, v134
    v_mul_f32 v87, v87, v135
    v_mul_f32 v88, v88, v136
    v_mul_f32 v89, v89, v137
    v_mul_f32 v90, v90, v138
    v_mul_f32 v91, v91, v139
    v_cvt_pk_bf16_f32 v146, v80, v81
    v_cvt_pk_bf16_f32 v147, v82, v83
    v_add_f32_dpp v3, v153, v152 row_ror:12 row_mask:0xf bank_mask:0xf
    v_cvt_pk_bf16_f32 v148, v84, v85
    v_cvt_pk_bf16_f32 v149, v86, v87
    v_add_f32_dpp v3, v154, v3 row_ror:8 row_mask:0xf bank_mask:0xf
    v_cvt_pk_bf16_f32 v150, v88, v89
    v_cvt_pk_bf16_f32 v151, v90, v91
    v_add_f32_dpp v21, v155, v3 row_ror:4 row_mask:0xf bank_mask:0x1
    v_mfma_f32_16x16x16_bf16 v[156:159], v[146:147], v[160:161], 0
    v_mfma_f32_16x16x16_bf16 v[156:159], v[148:149], v[162:163], v[156:159]
    v_mfma_f32_16x16x16_bf16 v[156:159], v[150:151], v[164:165], v[156:159]
    v_add_u32 v39, s71, v25
    v_add_u32 v40, s71, v26
    ds_read_b128 v[92:95], v39 offset:0
    ds_read_b128 v[116:119], v39 offset:49152
    ds_read_b128 v[96:99], v39 offset:256
    ds_read_b128 v[120:123], v39 offset:49408
    ds_read_b128 v[100:103], v39 offset:512
    ds_read_b128 v[124:127], v39 offset:49664
    ds_read_b128 v[104:107], v40 offset:0
    v_add_f32_dpp v4, v157, v156 row_ror:12 row_mask:0xf bank_mask:0xf
    ds_read_b128 v[128:131], v40 offset:49152
    ds_read_b128 v[108:111], v40 offset:256
    v_add_f32_dpp v4, v158, v4 row_ror:8 row_mask:0xf bank_mask:0xf
    ds_read_b128 v[132:135], v40 offset:49408
    ds_read_b128 v[112:115], v40 offset:512
    ds_read_b128 v[136:139], v40 offset:49664
    v_add_f32_dpp v22, v159, v4 row_ror:4 row_mask:0xf bank_mask:0x1
    s_waitcnt vmcnt(0)
    v_cvt_f32_i32 v68, v44
    v_cvt_f32_i32 v69, v45
    v_cvt_f32_i32 v70, v46
    v_cvt_f32_i32 v71, v47
    v_cvt_f32_i32 v72, v48
    v_cvt_f32_i32 v73, v49
    v_cvt_f32_i32 v74, v50
    v_cvt_f32_i32 v75, v51
    v_cvt_f32_i32 v76, v52
    v_cvt_f32_i32 v77, v53
    v_cvt_f32_i32 v78, v54
    v_cvt_f32_i32 v79, v55
    v_cvt_f32_i32 v80, v56
    v_cvt_f32_i32 v81, v57
    v_cvt_f32_i32 v82, v58
    v_cvt_f32_i32 v83, v59
    v_cvt_f32_i32 v84, v60
    v_cvt_f32_i32 v85, v61
    v_cvt_f32_i32 v86, v62
    v_cvt_f32_i32 v87, v63
    v_cvt_f32_i32 v88, v64
    v_cvt_f32_i32 v89, v65
    v_cvt_f32_i32 v90, v66
    v_cvt_f32_i32 v91, v67
    s_waitcnt lgkmcnt(0)
    v_sub_f32 v68, v68, v92
    v_sub_f32 v69, v69, v93
    v_sub_f32 v70, v70, v94
    v_sub_f32 v71, v71, v95
    v_sub_f32 v72, v72, v96
    v_sub_f32 v73, v73, v97
    v_sub_f32 v74, v74, v98
    v_sub_f32 v75, v75, v99
    v_sub_f32 v76, v76, v100
    v_sub_f32 v77, v77, v101
    v_sub_f32 v78, v78, v102
    v_sub_f32 v79, v79, v103
    v_cvt_pk_bf16_f32 v68, 0, v68
    v_cvt_pk_bf16_f32 v69, 0, v69
    v_cvt_pk_bf16_f32 v70, 0, v70
    v_cvt_pk_bf16_f32 v71, 0, v71
    v_cvt_pk_bf16_f32 v72, 0, v72
    v_cvt_pk_bf16_f32 v73, 0, v73
    v_cvt_pk_bf16_f32 v74, 0, v74
    v_cvt_pk_bf16_f32 v75, 0, v75
    v_cvt_pk_bf16_f32 v76, 0, v76
    v_cvt_pk_bf16_f32 v77, 0, v77
    v_cvt_pk_bf16_f32 v78, 0, v78
    v_cvt_pk_bf16_f32 v79, 0, v79
    v_mul_f32 v68, v68, v116
    v_mul_f32 v69, v69, v117
    v_mul_f32 v70, v70, v118
    v_mul_f32 v71, v71, v119
    v_mul_f32 v72, v72, v120
    v_mul_f32 v73, v73, v121
    v_mul_f32 v74, v74, v122
    v_mul_f32 v75, v75, v123
    v_mul_f32 v76, v76, v124
    v_mul_f32 v77, v77, v125
    v_mul_f32 v78, v78, v126
    s_add_u32 s60, s58, 24576
    buffer_load_dwordx4 v[44:47], v7, s[24:27], s60 offen offset:0 nt
    buffer_load_dwordx4 v[48:51], v7, s[24:27], s60 offen offset:256 nt
    buffer_load_dwordx4 v[52:55], v7, s[24:27], s60 offen offset:512 nt
    s_add_u32 s61, s58, 57600
    buffer_load_dwordx4 v[56:59], v7, s[24:27], s61 offen offset:0 nt
    buffer_load_dwordx4 v[60:63], v7, s[24:27], s61 offen offset:256 nt
    buffer_load_dwordx4 v[64:67], v7, s[24:27], s61 offen offset:512 nt
    v_mul_f32 v79, v79, v127
    v_cvt_pk_bf16_f32 v140, v68, v69
    v_cvt_pk_bf16_f32 v141, v70, v71
    v_cvt_pk_bf16_f32 v142, v72, v73
    v_cvt_pk_bf16_f32 v143, v74, v75
    v_cvt_pk_bf16_f32 v144, v76, v77
    v_cvt_pk_bf16_f32 v145, v78, v79
    v_mfma_f32_16x16x16_bf16 v[152:155], v[140:141], v[160:161], 0
    v_mfma_f32_16x16x16_bf16 v[152:155], v[142:143], v[162:163], v[152:155]
    v_mfma_f32_16x16x16_bf16 v[152:155], v[144:145], v[164:165], v[152:155]
    v_sub_f32 v80, v80, v104
    v_sub_f32 v81, v81, v105
    v_sub_f32 v82, v82, v106
    v_sub_f32 v83, v83, v107
    v_sub_f32 v84, v84, v108
    v_sub_f32 v85, v85, v109
    v_sub_f32 v86, v86, v110
    v_sub_f32 v87, v87, v111
    v_sub_f32 v88, v88, v112
    v_sub_f32 v89, v89, v113
    v_sub_f32 v90, v90, v114
    v_sub_f32 v91, v91, v115
    v_cvt_pk_bf16_f32 v80, 0, v80
    v_cvt_pk_bf16_f32 v81, 0, v81
    v_cvt_pk_bf16_f32 v82, 0, v82
    v_cvt_pk_bf16_f32 v83, 0, v83
    v_cvt_pk_bf16_f32 v84, 0, v84
    v_cvt_pk_bf16_f32 v85, 0, v85
    v_cvt_pk_bf16_f32 v86, 0, v86
    v_cvt_pk_bf16_f32 v87, 0, v87
    v_cvt_pk_bf16_f32 v88, 0, v88
    v_cvt_pk_bf16_f32 v89, 0, v89
    v_cvt_pk_bf16_f32 v90, 0, v90
    v_cvt_pk_bf16_f32 v91, 0, v91
    v_mul_f32 v80, v80, v128
    v_mul_f32 v81, v81, v129
    v_mul_f32 v82, v82, v130
    v_mul_f32 v83, v83, v131
    v_mul_f32 v84, v84, v132
    v_mul_f32 v85, v85, v133
    v_mul_f32 v86, v86, v134
    v_mul_f32 v87, v87, v135
    v_mul_f32 v88, v88, v136
    v_mul_f32 v89, v89, v137
    v_mul_f32 v90, v90, v138
    v_mul_f32 v91, v91, v139
    v_cvt_pk_bf16_f32 v146, v80, v81
    v_cvt_pk_bf16_f32 v147, v82, v83
    v_add_f32_dpp v3, v154, v153 row_ror:12 row_mask:0xf bank_mask:0xf
    v_cvt_pk_bf16_f32 v148, v84, v85
    v_cvt_pk_bf16_f32 v149, v86, v87
    v_add_f32_dpp v3, v155, v3 row_ror:8 row_mask:0xf bank_mask:0xf
    v_cvt_pk_bf16_f32 v150, v88, v89
    v_cvt_pk_bf16_f32 v151, v90, v91
    v_add_f32_dpp v21, v152, v3 row_ror:4 row_mask:0xf bank_mask:0x2
    v_mfma_f32_16x16x16_bf16 v[156:159], v[146:147], v[160:161], 0
    v_mfma_f32_16x16x16_bf16 v[156:159], v[148:149], v[162:163], v[156:159]
    v_mfma_f32_16x16x16_bf16 v[156:159], v[150:151], v[164:165], v[156:159]
    v_add_u32 v39, s71, v27
    v_add_u32 v40, s71, v28
    ds_read_b128 v[92:95], v39 offset:0
    ds_read_b128 v[116:119], v39 offset:49152
    ds_read_b128 v[96:99], v39 offset:256
    ds_read_b128 v[120:123], v39 offset:49408
    ds_read_b128 v[100:103], v39 offset:512
    ds_read_b128 v[124:127], v39 offset:49664
    ds_read_b128 v[104:107], v40 offset:0
    v_add_f32_dpp v4, v158, v157 row_ror:12 row_mask:0xf bank_mask:0xf
    ds_read_b128 v[128:131], v40 offset:49152
    ds_read_b128 v[108:111], v40 offset:256
    v_add_f32_dpp v4, v159, v4 row_ror:8 row_mask:0xf bank_mask:0xf
    ds_read_b128 v[132:135], v40 offset:49408
    ds_read_b128 v[112:115], v40 offset:512
    ds_read_b128 v[136:139], v40 offset:49664
    v_add_f32_dpp v22, v156, v4 row_ror:4 row_mask:0xf bank_mask:0x2
    s_waitcnt vmcnt(0)
    v_cvt_f32_i32 v68, v44
    v_cvt_f32_i32 v69, v45
    v_cvt_f32_i32 v70, v46
    v_cvt_f32_i32 v71, v47
    v_cvt_f32_i32 v72, v48
    v_cvt_f32_i32 v73, v49
    v_cvt_f32_i32 v74, v50
    v_cvt_f32_i32 v75, v51
    v_cvt_f32_i32 v76, v52
    v_cvt_f32_i32 v77, v53
    v_cvt_f32_i32 v78, v54
    v_cvt_f32_i32 v79, v55
    v_cvt_f32_i32 v80, v56
    v_cvt_f32_i32 v81, v57
    v_cvt_f32_i32 v82, v58
    v_cvt_f32_i32 v83, v59
    v_cvt_f32_i32 v84, v60
    v_cvt_f32_i32 v85, v61
    v_cvt_f32_i32 v86, v62
    v_cvt_f32_i32 v87, v63
    v_cvt_f32_i32 v88, v64
    v_cvt_f32_i32 v89, v65
    v_cvt_f32_i32 v90, v66
    v_cvt_f32_i32 v91, v67
    s_waitcnt lgkmcnt(0)
    v_sub_f32 v68, v68, v92
    v_sub_f32 v69, v69, v93
    v_sub_f32 v70, v70, v94
    v_sub_f32 v71, v71, v95
    v_sub_f32 v72, v72, v96
    v_sub_f32 v73, v73, v97
    v_sub_f32 v74, v74, v98
    v_sub_f32 v75, v75, v99
    v_sub_f32 v76, v76, v100
    v_sub_f32 v77, v77, v101
    v_sub_f32 v78, v78, v102
    v_sub_f32 v79, v79, v103
    v_cvt_pk_bf16_f32 v68, 0, v68
    v_cvt_pk_bf16_f32 v69, 0, v69
    v_cvt_pk_bf16_f32 v70, 0, v70
    v_cvt_pk_bf16_f32 v71, 0, v71
    v_cvt_pk_bf16_f32 v72, 0, v72
    v_cvt_pk_bf16_f32 v73, 0, v73
    v_cvt_pk_bf16_f32 v74, 0, v74
    v_cvt_pk_bf16_f32 v75, 0, v75
    v_cvt_pk_bf16_f32 v76, 0, v76
    v_cvt_pk_bf16_f32 v77, 0, v77
    v_cvt_pk_bf16_f32 v78, 0, v78
    v_cvt_pk_bf16_f32 v79, 0, v79
    v_mul_f32 v68, v68, v116
    v_mul_f32 v69, v69, v117
    v_mul_f32 v70, v70, v118
    v_mul_f32 v71, v71, v119
    v_mul_f32 v72, v72, v120
    v_mul_f32 v73, v73, v121
    v_mul_f32 v74, v74, v122
    v_mul_f32 v75, v75, v123
    v_mul_f32 v76, v76, v124
    v_mul_f32 v77, v77, v125
    v_mul_f32 v78, v78, v126
    s_add_u32 s60, s58, 69888
    buffer_load_dwordx4 v[44:47], v6, s[24:27], s60 offen offset:0 nt
    buffer_load_dwordx4 v[48:51], v6, s[24:27], s60 offen offset:256 nt
    buffer_load_dwordx4 v[52:55], v6, s[24:27], s60 offen offset:512 nt
    s_add_u32 s61, s58, 102912
    buffer_load_dwordx4 v[56:59], v6, s[24:27], s61 offen offset:0 nt
    buffer_load_dwordx4 v[60:63], v6, s[24:27], s61 offen offset:256 nt
    buffer_load_dwordx4 v[64:67], v6, s[24:27], s61 offen offset:512 nt
    v_mul_f32 v79, v79, v127
    v_cvt_pk_bf16_f32 v140, v68, v69
    v_cvt_pk_bf16_f32 v141, v70, v71
    v_cvt_pk_bf16_f32 v142, v72, v73
    v_cvt_pk_bf16_f32 v143, v74, v75
    v_cvt_pk_bf16_f32 v144, v76, v77
    v_cvt_pk_bf16_f32 v145, v78, v79
    v_mfma_f32_16x16x16_bf16 v[152:155], v[140:141], v[160:161], 0
    v_mfma_f32_16x16x16_bf16 v[152:155], v[142:143], v[162:163], v[152:155]
    v_mfma_f32_16x16x16_bf16 v[152:155], v[144:145], v[164:165], v[152:155]
    v_sub_f32 v80, v80, v104
    v_sub_f32 v81, v81, v105
    v_sub_f32 v82, v82, v106
    v_sub_f32 v83, v83, v107
    v_sub_f32 v84, v84, v108
    v_sub_f32 v85, v85, v109
    v_sub_f32 v86, v86, v110
    v_sub_f32 v87, v87, v111
    v_sub_f32 v88, v88, v112
    v_sub_f32 v89, v89, v113
    v_sub_f32 v90, v90, v114
    v_sub_f32 v91, v91, v115
    v_cvt_pk_bf16_f32 v80, 0, v80
    v_cvt_pk_bf16_f32 v81, 0, v81
    v_cvt_pk_bf16_f32 v82, 0, v82
    v_cvt_pk_bf16_f32 v83, 0, v83
    v_cvt_pk_bf16_f32 v84, 0, v84
    v_cvt_pk_bf16_f32 v85, 0, v85
    v_cvt_pk_bf16_f32 v86, 0, v86
    v_cvt_pk_bf16_f32 v87, 0, v87
    v_cvt_pk_bf16_f32 v88, 0, v88
    v_cvt_pk_bf16_f32 v89, 0, v89
    v_cvt_pk_bf16_f32 v90, 0, v90
    v_cvt_pk_bf16_f32 v91, 0, v91
    v_mul_f32 v80, v80, v128
    v_mul_f32 v81, v81, v129
    v_mul_f32 v82, v82, v130
    v_mul_f32 v83, v83, v131
    v_mul_f32 v84, v84, v132
    v_mul_f32 v85, v85, v133
    v_mul_f32 v86, v86, v134
    v_mul_f32 v87, v87, v135
    v_mul_f32 v88, v88, v136
    v_mul_f32 v89, v89, v137
    v_mul_f32 v90, v90, v138
    v_mul_f32 v91, v91, v139
    v_cvt_pk_bf16_f32 v146, v80, v81
    v_cvt_pk_bf16_f32 v147, v82, v83
    v_add_f32_dpp v3, v155, v154 row_ror:12 row_mask:0xf bank_mask:0xf
    v_cvt_pk_bf16_f32 v148, v84, v85
    v_cvt_pk_bf16_f32 v149, v86, v87
    v_add_f32_dpp v3, v152, v3 row_ror:8 row_mask:0xf bank_mask:0xf
    v_cvt_pk_bf16_f32 v150, v88, v89
    v_cvt_pk_bf16_f32 v151, v90, v91
    v_add_f32_dpp v21, v153, v3 row_ror:4 row_mask:0xf bank_mask:0x4
    v_mfma_f32_16x16x16_bf16 v[156:159], v[146:147], v[160:161], 0
    v_mfma_f32_16x16x16_bf16 v[156:159], v[148:149], v[162:163], v[156:159]
    v_mfma_f32_16x16x16_bf16 v[156:159], v[150:151], v[164:165], v[156:159]
    v_add_u32 v39, s71, v29
    v_add_u32 v40, s71, v30
    ds_read_b128 v[92:95], v39 offset:0
    ds_read_b128 v[116:119], v39 offset:49152
    ds_read_b128 v[96:99], v39 offset:256
    ds_read_b128 v[120:123], v39 offset:49408
    ds_read_b128 v[100:103], v39 offset:512
    ds_read_b128 v[124:127], v39 offset:49664
    ds_read_b128 v[104:107], v40 offset:0
    v_add_f32_dpp v4, v159, v158 row_ror:12 row_mask:0xf bank_mask:0xf
    ds_read_b128 v[128:131], v40 offset:49152
    ds_read_b128 v[108:111], v40 offset:256
    v_add_f32_dpp v4, v156, v4 row_ror:8 row_mask:0xf bank_mask:0xf
    ds_read_b128 v[132:135], v40 offset:49408
    ds_read_b128 v[112:115], v40 offset:512
    ds_read_b128 v[136:139], v40 offset:49664
    v_add_f32_dpp v22, v157, v4 row_ror:4 row_mask:0xf bank_mask:0x4
    s_waitcnt vmcnt(0)
    v_cvt_f32_i32 v68, v44
    v_cvt_f32_i32 v69, v45
    v_cvt_f32_i32 v70, v46
    v_cvt_f32_i32 v71, v47
    v_cvt_f32_i32 v72, v48
    v_cvt_f32_i32 v73, v49
    v_cvt_f32_i32 v74, v50
    v_cvt_f32_i32 v75, v51
    v_cvt_f32_i32 v76, v52
    v_cvt_f32_i32 v77, v53
    v_cvt_f32_i32 v78, v54
    v_cvt_f32_i32 v79, v55
    v_cvt_f32_i32 v80, v56
    v_cvt_f32_i32 v81, v57
    v_cvt_f32_i32 v82, v58
    v_cvt_f32_i32 v83, v59
    v_cvt_f32_i32 v84, v60
    v_cvt_f32_i32 v85, v61
    v_cvt_f32_i32 v86, v62
    v_cvt_f32_i32 v87, v63
    v_cvt_f32_i32 v88, v64
    v_cvt_f32_i32 v89, v65
    v_cvt_f32_i32 v90, v66
    v_cvt_f32_i32 v91, v67
    s_waitcnt lgkmcnt(0)
    v_sub_f32 v68, v68, v92
    v_sub_f32 v69, v69, v93
    v_sub_f32 v70, v70, v94
    v_sub_f32 v71, v71, v95
    v_sub_f32 v72, v72, v96
    v_sub_f32 v73, v73, v97
    v_sub_f32 v74, v74, v98
    v_sub_f32 v75, v75, v99
    v_sub_f32 v76, v76, v100
    v_sub_f32 v77, v77, v101
    v_sub_f32 v78, v78, v102
    v_sub_f32 v79, v79, v103
    v_cvt_pk_bf16_f32 v68, 0, v68
    v_cvt_pk_bf16_f32 v69, 0, v69
    v_cvt_pk_bf16_f32 v70, 0, v70
    v_cvt_pk_bf16_f32 v71, 0, v71
    v_cvt_pk_bf16_f32 v72, 0, v72
    v_cvt_pk_bf16_f32 v73, 0, v73
    v_cvt_pk_bf16_f32 v74, 0, v74
    v_cvt_pk_bf16_f32 v75, 0, v75
    v_cvt_pk_bf16_f32 v76, 0, v76
    v_cvt_pk_bf16_f32 v77, 0, v77
    v_cvt_pk_bf16_f32 v78, 0, v78
    v_cvt_pk_bf16_f32 v79, 0, v79
    v_mul_f32 v68, v68, v116
    v_mul_f32 v69, v69, v117
    v_mul_f32 v70, v70, v118
    v_mul_f32 v71, v71, v119
    v_mul_f32 v72, v72, v120
    v_mul_f32 v73, v73, v121
    v_mul_f32 v74, v74, v122
    v_mul_f32 v75, v75, v123
    v_mul_f32 v76, v76, v124
    v_mul_f32 v77, v77, v125
    v_mul_f32 v78, v78, v126
    s_add_u32 s60, s58, 82176
    buffer_load_dwordx4 v[44:47], v6, s[24:27], s60 offen offset:0 nt
    buffer_load_dwordx4 v[48:51], v6, s[24:27], s60 offen offset:256 nt
    buffer_load_dwordx4 v[52:55], v6, s[24:27], s60 offen offset:512 nt
    s_add_u32 s61, s58, 115200
    buffer_load_dwordx4 v[56:59], v6, s[24:27], s61 offen offset:0 nt
    buffer_load_dwordx4 v[60:63], v6, s[24:27], s61 offen offset:256 nt
    buffer_load_dwordx4 v[64:67], v6, s[24:27], s61 offen offset:512 nt
    v_mul_f32 v79, v79, v127
    v_cvt_pk_bf16_f32 v140, v68, v69
    v_cvt_pk_bf16_f32 v141, v70, v71
    v_cvt_pk_bf16_f32 v142, v72, v73
    v_cvt_pk_bf16_f32 v143, v74, v75
    v_cvt_pk_bf16_f32 v144, v76, v77
    v_cvt_pk_bf16_f32 v145, v78, v79
    v_mfma_f32_16x16x16_bf16 v[152:155], v[140:141], v[160:161], 0
    v_mfma_f32_16x16x16_bf16 v[152:155], v[142:143], v[162:163], v[152:155]
    v_mfma_f32_16x16x16_bf16 v[152:155], v[144:145], v[164:165], v[152:155]
    v_sub_f32 v80, v80, v104
    v_sub_f32 v81, v81, v105
    v_sub_f32 v82, v82, v106
    v_sub_f32 v83, v83, v107
    v_sub_f32 v84, v84, v108
    v_sub_f32 v85, v85, v109
    v_sub_f32 v86, v86, v110
    v_sub_f32 v87, v87, v111
    v_sub_f32 v88, v88, v112
    v_sub_f32 v89, v89, v113
    v_sub_f32 v90, v90, v114
    v_sub_f32 v91, v91, v115
    v_cvt_pk_bf16_f32 v80, 0, v80
    v_cvt_pk_bf16_f32 v81, 0, v81
    v_cvt_pk_bf16_f32 v82, 0, v82
    v_cvt_pk_bf16_f32 v83, 0, v83
    v_cvt_pk_bf16_f32 v84, 0, v84
    v_cvt_pk_bf16_f32 v85, 0, v85
    v_cvt_pk_bf16_f32 v86, 0, v86
    v_cvt_pk_bf16_f32 v87, 0, v87
    v_cvt_pk_bf16_f32 v88, 0, v88
    v_cvt_pk_bf16_f32 v89, 0, v89
    v_cvt_pk_bf16_f32 v90, 0, v90
    v_cvt_pk_bf16_f32 v91, 0, v91
    v_mul_f32 v80, v80, v128
    v_mul_f32 v81, v81, v129
    v_mul_f32 v82, v82, v130
    v_mul_f32 v83, v83, v131
    v_mul_f32 v84, v84, v132
    v_mul_f32 v85, v85, v133
    v_mul_f32 v86, v86, v134
    v_mul_f32 v87, v87, v135
    v_mul_f32 v88, v88, v136
    v_mul_f32 v89, v89, v137
    v_mul_f32 v90, v90, v138
    v_mul_f32 v91, v91, v139
    v_cvt_pk_bf16_f32 v146, v80, v81
    v_cvt_pk_bf16_f32 v147, v82, v83
    v_add_f32_dpp v3, v152, v155 row_ror:12 row_mask:0xf bank_mask:0xf
    v_cvt_pk_bf16_f32 v148, v84, v85
    v_cvt_pk_bf16_f32 v149, v86, v87
    v_add_f32_dpp v3, v153, v3 row_ror:8 row_mask:0xf bank_mask:0xf
    v_cvt_pk_bf16_f32 v150, v88, v89
    v_cvt_pk_bf16_f32 v151, v90, v91
    v_add_f32_dpp v21, v154, v3 row_ror:4 row_mask:0xf bank_mask:0x8
    v_mfma_f32_16x16x16_bf16 v[156:159], v[146:147], v[160:161], 0
    v_mfma_f32_16x16x16_bf16 v[156:159], v[148:149], v[162:163], v[156:159]
    v_mfma_f32_16x16x16_bf16 v[156:159], v[150:151], v[164:165], v[156:159]
    v_add_u32 v39, s71, v31
    v_add_u32 v40, s71, v32
    ds_read_b128 v[92:95], v39 offset:0
    ds_read_b128 v[116:119], v39 offset:49152
    ds_read_b128 v[96:99], v39 offset:256
    ds_read_b128 v[120:123], v39 offset:49408
    ds_read_b128 v[100:103], v39 offset:512
    ds_read_b128 v[124:127], v39 offset:49664
    ds_read_b128 v[104:107], v40 offset:0
    v_add_f32_dpp v4, v156, v159 row_ror:12 row_mask:0xf bank_mask:0xf
    ds_read_b128 v[128:131], v40 offset:49152
    ds_read_b128 v[108:111], v40 offset:256
    v_add_f32_dpp v4, v157, v4 row_ror:8 row_mask:0xf bank_mask:0xf
    ds_read_b128 v[132:135], v40 offset:49408
    ds_read_b128 v[112:115], v40 offset:512
    ds_read_b128 v[136:139], v40 offset:49664
    v_add_f32_dpp v22, v158, v4 row_ror:4 row_mask:0xf bank_mask:0x8
    v_cvt_pk_bf16_f32 v3, 0, v21
    v_cvt_pk_bf16_f32 v4, 0, v22
    v_mul_f32 v3, s67, v3
    v_mul_f32 v4, s67, v4
    v_cvt_pk_bf16_f32 v5, v3, v4
    v_max3_f32 v20, v20, v3, v4
    ds_write_b32 v18, v5 offset:0
    s_waitcnt vmcnt(0)
    v_cvt_f32_i32 v68, v44
    v_cvt_f32_i32 v69, v45
    v_cvt_f32_i32 v70, v46
    v_cvt_f32_i32 v71, v47
    v_cvt_f32_i32 v72, v48
    v_cvt_f32_i32 v73, v49
    v_cvt_f32_i32 v74, v50
    v_cvt_f32_i32 v75, v51
    v_cvt_f32_i32 v76, v52
    v_cvt_f32_i32 v77, v53
    v_cvt_f32_i32 v78, v54
    v_cvt_f32_i32 v79, v55
    v_cvt_f32_i32 v80, v56
    v_cvt_f32_i32 v81, v57
    v_cvt_f32_i32 v82, v58
    v_cvt_f32_i32 v83, v59
    v_cvt_f32_i32 v84, v60
    v_cvt_f32_i32 v85, v61
    v_cvt_f32_i32 v86, v62
    v_cvt_f32_i32 v87, v63
    v_cvt_f32_i32 v88, v64
    v_cvt_f32_i32 v89, v65
    v_cvt_f32_i32 v90, v66
    v_cvt_f32_i32 v91, v67
    s_waitcnt lgkmcnt(0)
    v_sub_f32 v68, v68, v92
    v_sub_f32 v69, v69, v93
    v_sub_f32 v70, v70, v94
    v_sub_f32 v71, v71, v95
    v_sub_f32 v72, v72, v96
    v_sub_f32 v73, v73, v97
    v_sub_f32 v74, v74, v98
    v_sub_f32 v75, v75, v99
    v_sub_f32 v76, v76, v100
    v_sub_f32 v77, v77, v101
    v_sub_f32 v78, v78, v102
    v_sub_f32 v79, v79, v103
    v_cvt_pk_bf16_f32 v68, 0, v68
    v_cvt_pk_bf16_f32 v69, 0, v69
    v_cvt_pk_bf16_f32 v70, 0, v70
    v_cvt_pk_bf16_f32 v71, 0, v71
    v_cvt_pk_bf16_f32 v72, 0, v72
    v_cvt_pk_bf16_f32 v73, 0, v73
    v_cvt_pk_bf16_f32 v74, 0, v74
    v_cvt_pk_bf16_f32 v75, 0, v75
    v_cvt_pk_bf16_f32 v76, 0, v76
    v_cvt_pk_bf16_f32 v77, 0, v77
    v_cvt_pk_bf16_f32 v78, 0, v78
    v_cvt_pk_bf16_f32 v79, 0, v79
    v_mul_f32 v68, v68, v116
    v_mul_f32 v69, v69, v117
    v_mul_f32 v70, v70, v118
    v_mul_f32 v71, v71, v119
    v_mul_f32 v72, v72, v120
    v_mul_f32 v73, v73, v121
    v_mul_f32 v74, v74, v122
    v_mul_f32 v75, v75, v123
    v_mul_f32 v76, v76, v124
    v_mul_f32 v77, v77, v125
    v_mul_f32 v78, v78, v126
    s_add_u32 s60, s58, 94464
    buffer_load_dwordx4 v[44:47], v8, s[24:27], s60 offen offset:0 nt
    buffer_load_dwordx4 v[48:51], v8, s[24:27], s60 offen offset:256 nt
    buffer_load_dwordx4 v[52:55], v8, s[24:27], s60 offen offset:512 nt
    s_add_u32 s61, s58, 127488
    buffer_load_dwordx4 v[56:59], v9, s[24:27], s61 offen offset:0 nt
    buffer_load_dwordx4 v[60:63], v9, s[24:27], s61 offen offset:256 nt
    buffer_load_dwordx4 v[64:67], v9, s[24:27], s61 offen offset:512 nt
    v_mul_f32 v79, v79, v127
    v_cvt_pk_bf16_f32 v140, v68, v69
    v_cvt_pk_bf16_f32 v141, v70, v71
    v_cvt_pk_bf16_f32 v142, v72, v73
    v_cvt_pk_bf16_f32 v143, v74, v75
    v_cvt_pk_bf16_f32 v144, v76, v77
    v_cvt_pk_bf16_f32 v145, v78, v79
    v_mfma_f32_16x16x16_bf16 v[152:155], v[140:141], v[160:161], 0
    v_mfma_f32_16x16x16_bf16 v[152:155], v[142:143], v[162:163], v[152:155]
    v_mfma_f32_16x16x16_bf16 v[152:155], v[144:145], v[164:165], v[152:155]
    v_sub_f32 v80, v80, v104
    v_sub_f32 v81, v81, v105
    v_sub_f32 v82, v82, v106
    v_sub_f32 v83, v83, v107
    v_sub_f32 v84, v84, v108
    v_sub_f32 v85, v85, v109
    v_sub_f32 v86, v86, v110
    v_sub_f32 v87, v87, v111
    v_sub_f32 v88, v88, v112
    v_sub_f32 v89, v89, v113
    v_sub_f32 v90, v90, v114
    v_sub_f32 v91, v91, v115
    v_cvt_pk_bf16_f32 v80, 0, v80
    v_cvt_pk_bf16_f32 v81, 0, v81
    v_cvt_pk_bf16_f32 v82, 0, v82
    v_cvt_pk_bf16_f32 v83, 0, v83
    v_cvt_pk_bf16_f32 v84, 0, v84
    v_cvt_pk_bf16_f32 v85, 0, v85
    v_cvt_pk_bf16_f32 v86, 0, v86
    v_cvt_pk_bf16_f32 v87, 0, v87
    v_cvt_pk_bf16_f32 v88, 0, v88
    v_cvt_pk_bf16_f32 v89, 0, v89
    v_cvt_pk_bf16_f32 v90, 0, v90
    v_cvt_pk_bf16_f32 v91, 0, v91
    v_mul_f32 v80, v80, v128
    v_mul_f32 v81, v81, v129
    v_mul_f32 v82, v82, v130
    v_mul_f32 v83, v83, v131
    v_mul_f32 v84, v84, v132
    v_mul_f32 v85, v85, v133
    v_mul_f32 v86, v86, v134
    v_mul_f32 v87, v87, v135
    v_mul_f32 v88, v88, v136
    v_mul_f32 v89, v89, v137
    v_mul_f32 v90, v90, v138
    v_mul_f32 v91, v91, v139
    v_cvt_pk_bf16_f32 v146, v80, v81
    v_cvt_pk_bf16_f32 v147, v82, v83
    v_add_f32_dpp v3, v153, v152 row_ror:12 row_mask:0xf bank_mask:0xf
    v_cvt_pk_bf16_f32 v148, v84, v85
    v_cvt_pk_bf16_f32 v149, v86, v87
    v_add_f32_dpp v3, v154, v3 row_ror:8 row_mask:0xf bank_mask:0xf
    v_cvt_pk_bf16_f32 v150, v88, v89
    v_cvt_pk_bf16_f32 v151, v90, v91
    v_add_f32_dpp v21, v155, v3 row_ror:4 row_mask:0xf bank_mask:0x1
    v_mfma_f32_16x16x16_bf16 v[156:159], v[146:147], v[160:161], 0
    v_mfma_f32_16x16x16_bf16 v[156:159], v[148:149], v[162:163], v[156:159]
    v_mfma_f32_16x16x16_bf16 v[156:159], v[150:151], v[164:165], v[156:159]
    v_add_u32 v39, s71, v33
    v_add_u32 v40, s71, v34
    ds_read_b128 v[92:95], v39 offset:0
    ds_read_b128 v[116:119], v39 offset:49152
    ds_read_b128 v[96:99], v39 offset:256
    ds_read_b128 v[120:123], v39 offset:49408
    ds_read_b128 v[100:103], v39 offset:512
    ds_read_b128 v[124:127], v39 offset:49664
    ds_read_b128 v[104:107], v40 offset:0
    v_add_f32_dpp v4, v157, v156 row_ror:12 row_mask:0xf bank_mask:0xf
    ds_read_b128 v[128:131], v40 offset:49152
    ds_read_b128 v[108:111], v40 offset:256
    v_add_f32_dpp v4, v158, v4 row_ror:8 row_mask:0xf bank_mask:0xf
    ds_read_b128 v[132:135], v40 offset:49408
    ds_read_b128 v[112:115], v40 offset:512
    ds_read_b128 v[136:139], v40 offset:49664
    v_add_f32_dpp v22, v159, v4 row_ror:4 row_mask:0xf bank_mask:0x1
    s_waitcnt vmcnt(0)
    v_cvt_f32_i32 v68, v44
    v_cvt_f32_i32 v69, v45
    v_cvt_f32_i32 v70, v46
    v_cvt_f32_i32 v71, v47
    v_cvt_f32_i32 v72, v48
    v_cvt_f32_i32 v73, v49
    v_cvt_f32_i32 v74, v50
    v_cvt_f32_i32 v75, v51
    v_cvt_f32_i32 v76, v52
    v_cvt_f32_i32 v77, v53
    v_cvt_f32_i32 v78, v54
    v_cvt_f32_i32 v79, v55
    v_cvt_f32_i32 v80, v56
    v_cvt_f32_i32 v81, v57
    v_cvt_f32_i32 v82, v58
    v_cvt_f32_i32 v83, v59
    v_cvt_f32_i32 v84, v60
    v_cvt_f32_i32 v85, v61
    v_cvt_f32_i32 v86, v62
    v_cvt_f32_i32 v87, v63
    v_cvt_f32_i32 v88, v64
    v_cvt_f32_i32 v89, v65
    v_cvt_f32_i32 v90, v66
    v_cvt_f32_i32 v91, v67
    s_waitcnt lgkmcnt(0)
    v_sub_f32 v68, v68, v92
    v_sub_f32 v69, v69, v93
    v_sub_f32 v70, v70, v94
    v_sub_f32 v71, v71, v95
    v_sub_f32 v72, v72, v96
    v_sub_f32 v73, v73, v97
    v_sub_f32 v74, v74, v98
    v_sub_f32 v75, v75, v99
    v_sub_f32 v76, v76, v100
    v_sub_f32 v77, v77, v101
    v_sub_f32 v78, v78, v102
    v_sub_f32 v79, v79, v103
    v_cvt_pk_bf16_f32 v68, 0, v68
    v_cvt_pk_bf16_f32 v69, 0, v69
    v_cvt_pk_bf16_f32 v70, 0, v70
    v_cvt_pk_bf16_f32 v71, 0, v71
    v_cvt_pk_bf16_f32 v72, 0, v72
    v_cvt_pk_bf16_f32 v73, 0, v73
    v_cvt_pk_bf16_f32 v74, 0, v74
    v_cvt_pk_bf16_f32 v75, 0, v75
    v_cvt_pk_bf16_f32 v76, 0, v76
    v_cvt_pk_bf16_f32 v77, 0, v77
    v_cvt_pk_bf16_f32 v78, 0, v78
    v_cvt_pk_bf16_f32 v79, 0, v79
    v_mul_f32 v68, v68, v116
    v_mul_f32 v69, v69, v117
    v_mul_f32 v70, v70, v118
    v_mul_f32 v71, v71, v119
    v_mul_f32 v72, v72, v120
    v_mul_f32 v73, v73, v121
    v_mul_f32 v74, v74, v122
    v_mul_f32 v75, v75, v123
    v_mul_f32 v76, v76, v124
    v_mul_f32 v77, v77, v125
    v_mul_f32 v78, v78, v126
    s_add_u32 s60, s58, 139776
    buffer_load_dwordx4 v[44:47], v6, s[24:27], s60 offen offset:0 nt
    buffer_load_dwordx4 v[48:51], v6, s[24:27], s60 offen offset:256 nt
    buffer_load_dwordx4 v[52:55], v6, s[24:27], s60 offen offset:512 nt
    s_add_u32 s61, s58, 172032
    buffer_load_dwordx4 v[56:59], v6, s[24:27], s61 offen offset:0 nt
    buffer_load_dwordx4 v[60:63], v6, s[24:27], s61 offen offset:256 nt
    buffer_load_dwordx4 v[64:67], v6, s[24:27], s61 offen offset:512 nt
    v_mul_f32 v79, v79, v127
    v_cvt_pk_bf16_f32 v140, v68, v69
    v_cvt_pk_bf16_f32 v141, v70, v71
    v_cvt_pk_bf16_f32 v142, v72, v73
    v_cvt_pk_bf16_f32 v143, v74, v75
    v_cvt_pk_bf16_f32 v144, v76, v77
    v_cvt_pk_bf16_f32 v145, v78, v79
    v_mfma_f32_16x16x16_bf16 v[152:155], v[140:141], v[160:161], 0
    v_mfma_f32_16x16x16_bf16 v[152:155], v[142:143], v[162:163], v[152:155]
    v_mfma_f32_16x16x16_bf16 v[152:155], v[144:145], v[164:165], v[152:155]
    v_sub_f32 v80, v80, v104
    v_sub_f32 v81, v81, v105
    v_sub_f32 v82, v82, v106
    v_sub_f32 v83, v83, v107
    v_sub_f32 v84, v84, v108
    v_sub_f32 v85, v85, v109
    v_sub_f32 v86, v86, v110
    v_sub_f32 v87, v87, v111
    v_sub_f32 v88, v88, v112
    v_sub_f32 v89, v89, v113
    v_sub_f32 v90, v90, v114
    v_sub_f32 v91, v91, v115
    v_cvt_pk_bf16_f32 v80, 0, v80
    v_cvt_pk_bf16_f32 v81, 0, v81
    v_cvt_pk_bf16_f32 v82, 0, v82
    v_cvt_pk_bf16_f32 v83, 0, v83
    v_cvt_pk_bf16_f32 v84, 0, v84
    v_cvt_pk_bf16_f32 v85, 0, v85
    v_cvt_pk_bf16_f32 v86, 0, v86
    v_cvt_pk_bf16_f32 v87, 0, v87
    v_cvt_pk_bf16_f32 v88, 0, v88
    v_cvt_pk_bf16_f32 v89, 0, v89
    v_cvt_pk_bf16_f32 v90, 0, v90
    v_cvt_pk_bf16_f32 v91, 0, v91
    v_mul_f32 v80, v80, v128
    v_mul_f32 v81, v81, v129
    v_mul_f32 v82, v82, v130
    v_mul_f32 v83, v83, v131
    v_mul_f32 v84, v84, v132
    v_mul_f32 v85, v85, v133
    v_mul_f32 v86, v86, v134
    v_mul_f32 v87, v87, v135
    v_mul_f32 v88, v88, v136
    v_mul_f32 v89, v89, v137
    v_mul_f32 v90, v90, v138
    v_mul_f32 v91, v91, v139
    v_cvt_pk_bf16_f32 v146, v80, v81
    v_cvt_pk_bf16_f32 v147, v82, v83
    v_add_f32_dpp v3, v154, v153 row_ror:12 row_mask:0xf bank_mask:0xf
    v_cvt_pk_bf16_f32 v148, v84, v85
    v_cvt_pk_bf16_f32 v149, v86, v87
    v_add_f32_dpp v3, v155, v3 row_ror:8 row_mask:0xf bank_mask:0xf
    v_cvt_pk_bf16_f32 v150, v88, v89
    v_cvt_pk_bf16_f32 v151, v90, v91
    v_add_f32_dpp v21, v152, v3 row_ror:4 row_mask:0xf bank_mask:0x2
    v_mfma_f32_16x16x16_bf16 v[156:159], v[146:147], v[160:161], 0
    v_mfma_f32_16x16x16_bf16 v[156:159], v[148:149], v[162:163], v[156:159]
    v_mfma_f32_16x16x16_bf16 v[156:159], v[150:151], v[164:165], v[156:159]
    v_add_u32 v39, s71, v35
    v_add_u32 v40, s71, v36
    ds_read_b128 v[92:95], v39 offset:0
    ds_read_b128 v[116:119], v39 offset:49152
    ds_read_b128 v[96:99], v39 offset:256
    ds_read_b128 v[120:123], v39 offset:49408
    ds_read_b128 v[100:103], v39 offset:512
    ds_read_b128 v[124:127], v39 offset:49664
    ds_read_b128 v[104:107], v40 offset:0
    v_add_f32_dpp v4, v158, v157 row_ror:12 row_mask:0xf bank_mask:0xf
    ds_read_b128 v[128:131], v40 offset:49152
    ds_read_b128 v[108:111], v40 offset:256
    v_add_f32_dpp v4, v159, v4 row_ror:8 row_mask:0xf bank_mask:0xf
    ds_read_b128 v[132:135], v40 offset:49408
    ds_read_b128 v[112:115], v40 offset:512
    ds_read_b128 v[136:139], v40 offset:49664
    v_add_f32_dpp v22, v156, v4 row_ror:4 row_mask:0xf bank_mask:0x2
    s_waitcnt vmcnt(0)
    v_cvt_f32_i32 v68, v44
    v_cvt_f32_i32 v69, v45
    v_cvt_f32_i32 v70, v46
    v_cvt_f32_i32 v71, v47
    v_cvt_f32_i32 v72, v48
    v_cvt_f32_i32 v73, v49
    v_cvt_f32_i32 v74, v50
    v_cvt_f32_i32 v75, v51
    v_cvt_f32_i32 v76, v52
    v_cvt_f32_i32 v77, v53
    v_cvt_f32_i32 v78, v54
    v_cvt_f32_i32 v79, v55
    v_cvt_f32_i32 v80, v56
    v_cvt_f32_i32 v81, v57
    v_cvt_f32_i32 v82, v58
    v_cvt_f32_i32 v83, v59
    v_cvt_f32_i32 v84, v60
    v_cvt_f32_i32 v85, v61
    v_cvt_f32_i32 v86, v62
    v_cvt_f32_i32 v87, v63
    v_cvt_f32_i32 v88, v64
    v_cvt_f32_i32 v89, v65
    v_cvt_f32_i32 v90, v66
    v_cvt_f32_i32 v91, v67
    s_waitcnt lgkmcnt(0)
    v_sub_f32 v68, v68, v92
    v_sub_f32 v69, v69, v93
    v_sub_f32 v70, v70, v94
    v_sub_f32 v71, v71, v95
    v_sub_f32 v72, v72, v96
    v_sub_f32 v73, v73, v97
    v_sub_f32 v74, v74, v98
    v_sub_f32 v75, v75, v99
    v_sub_f32 v76, v76, v100
    v_sub_f32 v77, v77, v101
    v_sub_f32 v78, v78, v102
    v_sub_f32 v79, v79, v103
    v_cvt_pk_bf16_f32 v68, 0, v68
    v_cvt_pk_bf16_f32 v69, 0, v69
    v_cvt_pk_bf16_f32 v70, 0, v70
    v_cvt_pk_bf16_f32 v71, 0, v71
    v_cvt_pk_bf16_f32 v72, 0, v72
    v_cvt_pk_bf16_f32 v73, 0, v73
    v_cvt_pk_bf16_f32 v74, 0, v74
    v_cvt_pk_bf16_f32 v75, 0, v75
    v_cvt_pk_bf16_f32 v76, 0, v76
    v_cvt_pk_bf16_f32 v77, 0, v77
    v_cvt_pk_bf16_f32 v78, 0, v78
    v_cvt_pk_bf16_f32 v79, 0, v79
    v_mul_f32 v68, v68, v116
    v_mul_f32 v69, v69, v117
    v_mul_f32 v70, v70, v118
    v_mul_f32 v71, v71, v119
    v_mul_f32 v72, v72, v120
    v_mul_f32 v73, v73, v121
    v_mul_f32 v74, v74, v122
    v_mul_f32 v75, v75, v123
    v_mul_f32 v76, v76, v124
    v_mul_f32 v77, v77, v125
    v_mul_f32 v78, v78, v126
    s_add_u32 s60, s58, 152064
    buffer_load_dwordx4 v[44:47], v6, s[24:27], s60 offen offset:0 nt
    buffer_load_dwordx4 v[48:51], v6, s[24:27], s60 offen offset:256 nt
    buffer_load_dwordx4 v[52:55], v6, s[24:27], s60 offen offset:512 nt
    s_add_u32 s61, s58, 184320
    buffer_load_dwordx4 v[56:59], v6, s[24:27], s61 offen offset:0 nt
    buffer_load_dwordx4 v[60:63], v6, s[24:27], s61 offen offset:256 nt
    buffer_load_dwordx4 v[64:67], v6, s[24:27], s61 offen offset:512 nt
    v_mul_f32 v79, v79, v127
    v_cvt_pk_bf16_f32 v140, v68, v69
    v_cvt_pk_bf16_f32 v141, v70, v71
    v_cvt_pk_bf16_f32 v142, v72, v73
    v_cvt_pk_bf16_f32 v143, v74, v75
    v_cvt_pk_bf16_f32 v144, v76, v77
    v_cvt_pk_bf16_f32 v145, v78, v79
    v_mfma_f32_16x16x16_bf16 v[152:155], v[140:141], v[160:161], 0
    v_mfma_f32_16x16x16_bf16 v[152:155], v[142:143], v[162:163], v[152:155]
    v_mfma_f32_16x16x16_bf16 v[152:155], v[144:145], v[164:165], v[152:155]
    v_sub_f32 v80, v80, v104
    v_sub_f32 v81, v81, v105
    v_sub_f32 v82, v82, v106
    v_sub_f32 v83, v83, v107
    v_sub_f32 v84, v84, v108
    v_sub_f32 v85, v85, v109
    v_sub_f32 v86, v86, v110
    v_sub_f32 v87, v87, v111
    v_sub_f32 v88, v88, v112
    v_sub_f32 v89, v89, v113
    v_sub_f32 v90, v90, v114
    v_sub_f32 v91, v91, v115
    v_cvt_pk_bf16_f32 v80, 0, v80
    v_cvt_pk_bf16_f32 v81, 0, v81
    v_cvt_pk_bf16_f32 v82, 0, v82
    v_cvt_pk_bf16_f32 v83, 0, v83
    v_cvt_pk_bf16_f32 v84, 0, v84
    v_cvt_pk_bf16_f32 v85, 0, v85
    v_cvt_pk_bf16_f32 v86, 0, v86
    v_cvt_pk_bf16_f32 v87, 0, v87
    v_cvt_pk_bf16_f32 v88, 0, v88
    v_cvt_pk_bf16_f32 v89, 0, v89
    v_cvt_pk_bf16_f32 v90, 0, v90
    v_cvt_pk_bf16_f32 v91, 0, v91
    v_mul_f32 v80, v80, v128
    v_mul_f32 v81, v81, v129
    v_mul_f32 v82, v82, v130
    v_mul_f32 v83, v83, v131
    v_mul_f32 v84, v84, v132
    v_mul_f32 v85, v85, v133
    v_mul_f32 v86, v86, v134
    v_mul_f32 v87, v87, v135
    v_mul_f32 v88, v88, v136
    v_mul_f32 v89, v89, v137
    v_mul_f32 v90, v90, v138
    v_mul_f32 v91, v91, v139
    v_cvt_pk_bf16_f32 v146, v80, v81
    v_cvt_pk_bf16_f32 v147, v82, v83
    v_add_f32_dpp v3, v155, v154 row_ror:12 row_mask:0xf bank_mask:0xf
    v_cvt_pk_bf16_f32 v148, v84, v85
    v_cvt_pk_bf16_f32 v149, v86, v87
    v_add_f32_dpp v3, v152, v3 row_ror:8 row_mask:0xf bank_mask:0xf
    v_cvt_pk_bf16_f32 v150, v88, v89
    v_cvt_pk_bf16_f32 v151, v90, v91
    v_add_f32_dpp v21, v153, v3 row_ror:4 row_mask:0xf bank_mask:0x4
    v_mfma_f32_16x16x16_bf16 v[156:159], v[146:147], v[160:161], 0
    v_mfma_f32_16x16x16_bf16 v[156:159], v[148:149], v[162:163], v[156:159]
    v_mfma_f32_16x16x16_bf16 v[156:159], v[150:151], v[164:165], v[156:159]
    v_add_u32 v39, s71, v37
    v_add_u32 v40, s71, v38
    ds_read_b128 v[92:95], v39 offset:0
    ds_read_b128 v[116:119], v39 offset:49152
    ds_read_b128 v[96:99], v39 offset:256
    ds_read_b128 v[120:123], v39 offset:49408
    ds_read_b128 v[100:103], v39 offset:512
    ds_read_b128 v[124:127], v39 offset:49664
    ds_read_b128 v[104:107], v40 offset:0
    v_add_f32_dpp v4, v159, v158 row_ror:12 row_mask:0xf bank_mask:0xf
    ds_read_b128 v[128:131], v40 offset:49152
    ds_read_b128 v[108:111], v40 offset:256
    v_add_f32_dpp v4, v156, v4 row_ror:8 row_mask:0xf bank_mask:0xf
    ds_read_b128 v[132:135], v40 offset:49408
    ds_read_b128 v[112:115], v40 offset:512
    ds_read_b128 v[136:139], v40 offset:49664
    v_add_f32_dpp v22, v157, v4 row_ror:4 row_mask:0xf bank_mask:0x4
    s_waitcnt vmcnt(0)
    v_cvt_f32_i32 v68, v44
    v_cvt_f32_i32 v69, v45
    v_cvt_f32_i32 v70, v46
    v_cvt_f32_i32 v71, v47
    v_cvt_f32_i32 v72, v48
    v_cvt_f32_i32 v73, v49
    v_cvt_f32_i32 v74, v50
    v_cvt_f32_i32 v75, v51
    v_cvt_f32_i32 v76, v52
    v_cvt_f32_i32 v77, v53
    v_cvt_f32_i32 v78, v54
    v_cvt_f32_i32 v79, v55
    v_cvt_f32_i32 v80, v56
    v_cvt_f32_i32 v81, v57
    v_cvt_f32_i32 v82, v58
    v_cvt_f32_i32 v83, v59
    v_cvt_f32_i32 v84, v60
    v_cvt_f32_i32 v85, v61
    v_cvt_f32_i32 v86, v62
    v_cvt_f32_i32 v87, v63
    v_cvt_f32_i32 v88, v64
    v_cvt_f32_i32 v89, v65
    v_cvt_f32_i32 v90, v66
    v_cvt_f32_i32 v91, v67
    s_waitcnt lgkmcnt(0)
    v_sub_f32 v68, v68, v92
    v_sub_f32 v69, v69, v93
    v_sub_f32 v70, v70, v94
    v_sub_f32 v71, v71, v95
    v_sub_f32 v72, v72, v96
    v_sub_f32 v73, v73, v97
    v_sub_f32 v74, v74, v98
    v_sub_f32 v75, v75, v99
    v_sub_f32 v76, v76, v100
    v_sub_f32 v77, v77, v101
    v_sub_f32 v78, v78, v102
    v_sub_f32 v79, v79, v103
    v_cvt_pk_bf16_f32 v68, 0, v68
    v_cvt_pk_bf16_f32 v69, 0, v69
    v_cvt_pk_bf16_f32 v70, 0, v70
    v_cvt_pk_bf16_f32 v71, 0, v71
    v_cvt_pk_bf16_f32 v72, 0, v72
    v_cvt_pk_bf16_f32 v73, 0, v73
    v_cvt_pk_bf16_f32 v74, 0, v74
    v_cvt_pk_bf16_f32 v75, 0, v75
    v_cvt_pk_bf16_f32 v76, 0, v76
    v_cvt_pk_bf16_f32 v77, 0, v77
    v_cvt_pk_bf16_f32 v78, 0, v78
    v_cvt_pk_bf16_f32 v79, 0, v79
    v_mul_f32 v68, v68, v116
    v_mul_f32 v69, v69, v117
    v_mul_f32 v70, v70, v118
    v_mul_f32 v71, v71, v119
    v_mul_f32 v72, v72, v120
    v_mul_f32 v73, v73, v121
    v_mul_f32 v74, v74, v122
    v_mul_f32 v75, v75, v123
    v_mul_f32 v76, v76, v124
    v_mul_f32 v77, v77, v125
    v_mul_f32 v78, v78, v126
    s_cmp_eq_u32 s63, 15
    s_cbranch_scc1 L_kissue_v
    s_add_u32 s60, s59, 0
    buffer_load_dwordx4 v[44:47], v6, s[24:27], s60 offen offset:0 nt
    buffer_load_dwordx4 v[48:51], v6, s[24:27], s60 offen offset:256 nt
    buffer_load_dwordx4 v[52:55], v6, s[24:27], s60 offen offset:512 nt
    s_add_u32 s61, s59, 33024
    buffer_load_dwordx4 v[56:59], v6, s[24:27], s61 offen offset:0 nt
    buffer_load_dwordx4 v[60:63], v6, s[24:27], s61 offen offset:256 nt
    buffer_load_dwordx4 v[64:67], v6, s[24:27], s61 offen offset:512 nt
    s_branch L_kissue_done
L_kissue_v:
    s_add_u32 s60, s57, 0
    buffer_load_dwordx4 v[44:47], v10, s[28:31], s60 offen offset:0 nt
    buffer_load_dwordx4 v[48:51], v10, s[28:31], s60 offen offset:256 nt
    buffer_load_dwordx4 v[52:55], v10, s[28:31], s60 offen offset:512 nt
    s_add_u32 s61, s57, 33024
    buffer_load_dwordx4 v[56:59], v10, s[28:31], s61 offen offset:0 nt
    buffer_load_dwordx4 v[60:63], v10, s[28:31], s61 offen offset:256 nt
    buffer_load_dwordx4 v[64:67], v10, s[28:31], s61 offen offset:512 nt
L_kissue_done:
    v_mul_f32 v79, v79, v127
    v_cvt_pk_bf16_f32 v140, v68, v69
    v_cvt_pk_bf16_f32 v141, v70, v71
    v_cvt_pk_bf16_f32 v142, v72, v73
    v_cvt_pk_bf16_f32 v143, v74, v75
    v_cvt_pk_bf16_f32 v144, v76, v77
    v_cvt_pk_bf16_f32 v145, v78, v79
    v_mfma_f32_16x16x16_bf16 v[152:155], v[140:141], v[160:161], 0
    v_mfma_f32_16x16x16_bf16 v[152:155], v[142:143], v[162:163], v[152:155]
    v_mfma_f32_16x16x16_bf16 v[152:155], v[144:145], v[164:165], v[152:155]
    v_sub_f32 v80, v80, v104
    v_sub_f32 v81, v81, v105
    v_sub_f32 v82, v82, v106
    v_sub_f32 v83, v83, v107
    v_sub_f32 v84, v84, v108
    v_sub_f32 v85, v85, v109
    v_sub_f32 v86, v86, v110
    v_sub_f32 v87, v87, v111
    v_sub_f32 v88, v88, v112
    v_sub_f32 v89, v89, v113
    v_sub_f32 v90, v90, v114
    v_sub_f32 v91, v91, v115
    v_cvt_pk_bf16_f32 v80, 0, v80
    v_cvt_pk_bf16_f32 v81, 0, v81
    v_cvt_pk_bf16_f32 v82, 0, v82
    v_cvt_pk_bf16_f32 v83, 0, v83
    v_cvt_pk_bf16_f32 v84, 0, v84
    v_cvt_pk_bf16_f32 v85, 0, v85
    v_cvt_pk_bf16_f32 v86, 0, v86
    v_cvt_pk_bf16_f32 v87, 0, v87
    v_cvt_pk_bf16_f32 v88, 0, v88
    v_cvt_pk_bf16_f32 v89, 0, v89
    v_cvt_pk_bf16_f32 v90, 0, v90
    v_cvt_pk_bf16_f32 v91, 0, v91
    v_mul_f32 v80, v80, v128
    v_mul_f32 v81, v81, v129
    v_mul_f32 v82, v82, v130
    v_mul_f32 v83, v83, v131
    v_mul_f32 v84, v84, v132
    v_mul_f32 v85, v85, v133
    v_mul_f32 v86, v86, v134
    v_mul_f32 v87, v87, v135
    v_mul_f32 v88, v88, v136
    v_mul_f32 v89, v89, v137
    v_mul_f32 v90, v90, v138
    v_mul_f32 v91, v91, v139
    v_cvt_pk_bf16_f32 v146, v80, v81
    v_cvt_pk_bf16_f32 v147, v82, v83
    v_add_f32_dpp v3, v152, v155 row_ror:12 row_mask:0xf bank_mask:0xf
    v_cvt_pk_bf16_f32 v148, v84, v85
    v_cvt_pk_bf16_f32 v149, v86, v87
    v_add_f32_dpp v3, v153, v3 row_ror:8 row_mask:0xf bank_mask:0xf
    v_cvt_pk_bf16_f32 v150, v88, v89
    v_cvt_pk_bf16_f32 v151, v90, v91
    v_add_f32_dpp v21, v154, v3 row_ror:4 row_mask:0xf bank_mask:0x8
    v_mfma_f32_16x16x16_bf16 v[156:159], v[146:147], v[160:161], 0
    v_mfma_f32_16x16x16_bf16 v[156:159], v[148:149], v[162:163], v[156:159]
    v_mfma_f32_16x16x16_bf16 v[156:159], v[150:151], v[164:165], v[156:159]
    s_add_u32 s71, s71, 3072
    s_min_u32 s71, s71, 46080
    v_add_u32 v39, s71, v23
    v_add_u32 v40, s71, v24
    ds_read_b128 v[92:95], v39 offset:0
    ds_read_b128 v[116:119], v39 offset:49152
    ds_read_b128 v[96:99], v39 offset:256
    ds_read_b128 v[120:123], v39 offset:49408
    ds_read_b128 v[100:103], v39 offset:512
    ds_read_b128 v[124:127], v39 offset:49664
    ds_read_b128 v[104:107], v40 offset:0
    v_add_f32_dpp v4, v156, v159 row_ror:12 row_mask:0xf bank_mask:0xf
    ds_read_b128 v[128:131], v40 offset:49152
    ds_read_b128 v[108:111], v40 offset:256
    v_add_f32_dpp v4, v157, v4 row_ror:8 row_mask:0xf bank_mask:0xf
    ds_read_b128 v[132:135], v40 offset:49408
    ds_read_b128 v[112:115], v40 offset:512
    ds_read_b128 v[136:139], v40 offset:49664
    v_add_f32_dpp v22, v158, v4 row_ror:4 row_mask:0xf bank_mask:0x8
    v_cvt_pk_bf16_f32 v3, 0, v21
    v_cvt_pk_bf16_f32 v4, 0, v22
    v_mul_f32 v3, s67, v3
    v_mul_f32 v4, s67, v4
    v_cvt_pk_bf16_f32 v5, v3, v4
    v_max3_f32 v20, v20, v3, v4
    ds_write_b32 v18, v5 offset:256
    v_add_u32 v18, 512, v18
    s_mov_b32 s58, s59
    s_add_u32 s63, s63, 1
    s_and_b32 s62, s63, 15
    s_cbranch_scc1 L_kblk
    ds_write_b32 v19, v20
    v_add_u32 v19, 256, v19
    v_mov_b32 v20, 0xff800000
    s_cmp_lt_u32 s63, 16
    s_cbranch_scc1 L_kblk
    v_subrev_u32 v18, 8192, v18
    v_subrev_u32 v19, 256, v19
    v_mov_b32 v216, 0
    v_mov_b32 v217, 0
    v_mov_b32 v218, 0
    v_mov_b32 v219, 0
    s_mov_b32 s58, s57
    s_mov_b32 s63, 0
    s_mul_i32 s72, s56, 3072
    s_waitcnt lgkmcnt(0)
    s_barrier
    ds_read_b32 v223, v18 offset:0
    ds_read_b32 v224, v14
    ds_read_b32 v225, v15
L_vround:
    ds_read_b32 v20, v19
    v_mov_b32 v168, 0
    v_mov_b32 v169, 0
    v_mov_b32 v170, 0
    v_mov_b32 v171, 0
    v_mov_b32 v172, 0
    v_mov_b32 v173, 0
    v_mov_b32 v174, 0
    v_mov_b32 v175, 0
    v_mov_b32 v176, 0
    v_mov_b32 v177, 0
    v_mov_b32 v178, 0
    v_mov_b32 v179, 0
    v_mov_b32 v180, 0
    v_mov_b32 v181, 0
    v_mov_b32 v182, 0
    v_mov_b32 v183, 0
    v_mov_b32 v184, 0
    v_mov_b32 v185, 0
    v_mov_b32 v186, 0
    v_mov_b32 v187, 0
    v_mov_b32 v188, 0
    v_mov_b32 v189, 0
    v_mov_b32 v190, 0
    v_mov_b32 v191, 0
    v_mov_b32 v192, 0
    v_mov_b32 v193, 0
    v_mov_b32 v194, 0
    v_mov_b32 v195, 0
    v_mov_b32 v196, 0
    v_mov_b32 v197, 0
    v_mov_b32 v198, 0
    v_mov_b32 v199, 0
    v_mov_b32 v200, 0
    v_mov_b32 v201, 0
    v_mov_b32 v202, 0
    v_mov_b32 v203, 0
    v_mov_b32 v204, 0
    v_mov_b32 v205, 0
    v_mov_b32 v206, 0
    v_mov_b32 v207, 0
    v_mov_b32 v208, 0
    v_mov_b32 v209, 0
    v_mov_b32 v210, 0
    v_mov_b32 v211, 0
    v_mov_b32 v212, 0
    v_mov_b32 v213, 0
    v_mov_b32 v214, 0
    v_mov_b32 v215, 0
    v_mov_b32 v220, 0
    v_mov_b32 v221, 0
    s_waitcnt lgkmcnt(0)
    s_nop 1
    v_max_f32_dpp v20, v20, v20 row_ror:4 row_mask:0xf bank_mask:0xf
    s_nop 1
    v_max_f32_dpp v20, v20, v20 row_ror:8 row_mask:0xf bank_mask:0xf
    v_mov_b32 v3, v20
    s_nop 1
    v_permlane16_swap_b32 v20, v3
    v_max_f32 v20, v20, v3
    v_mov_b32 v3, v20
    s_nop 1
    v_permlane32_swap_b32 v20, v3
    v_max_f32 v20, v20, v3
    v_cvt_pk_bf16_f32 v20, 0, v20
    v_mul_f32 v20, s66, v20
L_vblk:
    s_add_u32 s62, s63, 1
    s_and_b32 s62, s62, 15
    s_cselect_b32 s62, 0, 802160640
    s_add_u32 s59, s58, s62
    s_add_u32 s59, s59, 196608
    s_waitcnt vmcnt(0)
    v_cvt_f32_i32 v68, v44
    v_cvt_f32_i32 v69, v45
    v_cvt_f32_i32 v70, v46
    v_cvt_f32_i32 v71, v47
    v_cvt_f32_i32 v72, v48
    v_cvt_f32_i32 v73, v49
    v_cvt_f32_i32 v74, v50
    v_cvt_f32_i32 v75, v51
    v_cvt_f32_i32 v76, v52
    v_cvt_f32_i32 v77, v53
    v_cvt_f32_i32 v78, v54
    v_cvt_f32_i32 v79, v55
    v_cvt_f32_i32 v80, v56
    v_cvt_f32_i32 v81, v57
    v_cvt_f32_i32 v82, v58
    v_cvt_f32_i32 v83, v59
    v_cvt_f32_i32 v84, v60
    v_cvt_f32_i32 v85, v61
    v_cvt_f32_i32 v86, v62
    v_cvt_f32_i32 v87, v63
    v_cvt_f32_i32 v88, v64
    v_cvt_f32_i32 v89, v65
    v_cvt_f32_i32 v90, v66
    v_cvt_f32_i32 v91, v67
    v_cvt_pk_bf16_f32 v92, v68, v80
    v_cvt_pk_bf16_f32 v96, v69, v81
    v_cvt_pk_bf16_f32 v100, v70, v82
    v_cvt_pk_bf16_f32 v104, v71, v83
    v_cvt_pk_bf16_f32 v108, v72, v84
    v_cvt_pk_bf16_f32 v112, v73, v85
    v_cvt_pk_bf16_f32 v116, v74, v86
    v_cvt_pk_bf16_f32 v120, v75, v87
    v_cvt_pk_bf16_f32 v124, v76, v88
    v_cvt_pk_bf16_f32 v128, v77, v89
    v_cvt_pk_bf16_f32 v132, v78, v90
    v_cvt_pk_bf16_f32 v136, v79, v91
    s_add_u32 s60, s58, 12288
    buffer_load_dwordx4 v[44:47], v10, s[28:31], s60 offen offset:0 nt
    buffer_load_dwordx4 v[48:51], v10, s[28:31], s60 offen offset:256 nt
    buffer_load_dwordx4 v[52:55], v10, s[28:31], s60 offen offset:512 nt
    s_add_u32 s61, s58, 45312
    buffer_load_dwordx4 v[56:59], v10, s[28:31], s61 offen offset:0 nt
    buffer_load_dwordx4 v[60:63], v10, s[28:31], s61 offen offset:256 nt
    buffer_load_dwordx4 v[64:67], v10, s[28:31], s61 offen offset:512 nt
    s_waitcnt lgkmcnt(0)
    v_lshlrev_b32 v226, 16, v223
    v_and_b32 v227, s68, v223
    v_fma_f32 v226, v226, s66, -v20
    v_fma_f32 v227, v227, s66, -v20
    v_exp_f32 v226, v226
    v_exp_f32 v227, v227
    v_and_b32 v228, s68, v224
    v_and_b32 v229, s68, v225
    v_mul_f32 v228, v226, v228
    v_mul_f32 v229, v227, v229
    v_add_f32 v220, v220, v226
    v_cvt_pk_bf16_f32 v228, v228, v229
    v_add_f32 v220, v220, v227
    v_lshlrev_b32 v230, 16, v224
    v_lshlrev_b32 v231, 16, v225
    v_lshlrev_b32 v226, 16, v228
    v_and_b32 v227, s68, v228
    v_fmac_f32 v221, v226, v230
    v_fmac_f32 v221, v227, v231
    v_mov_b32_dpp v216, v228 quad_perm:[0,1,2,3] row_mask:0xf bank_mask:0x1
    v_mov_b32_dpp v217, v228 quad_perm:[0,1,2,3] row_mask:0xf bank_mask:0x2
    v_mov_b32_dpp v218, v228 quad_perm:[0,1,2,3] row_mask:0xf bank_mask:0x4
    v_mov_b32_dpp v219, v228 quad_perm:[0,1,2,3] row_mask:0xf bank_mask:0x8
    ds_read_b32 v223, v18 offset:256
    ds_read_b32 v224, v16
    ds_read_b32 v225, v17
    v_add_u32 v16, 1024, v16
    v_add_u32 v17, 1024, v17
    s_waitcnt vmcnt(0)
    v_cvt_f32_i32 v68, v44
    v_cvt_f32_i32 v69, v45
    v_cvt_f32_i32 v70, v46
    v_cvt_f32_i32 v71, v47
    v_cvt_f32_i32 v72, v48
    v_cvt_f32_i32 v73, v49
    v_cvt_f32_i32 v74, v50
    v_cvt_f32_i32 v75, v51
    v_cvt_f32_i32 v76, v52
    v_cvt_f32_i32 v77, v53
    v_cvt_f32_i32 v78, v54
    v_cvt_f32_i32 v79, v55
    v_cvt_f32_i32 v80, v56
    v_cvt_f32_i32 v81, v57
    v_cvt_f32_i32 v82, v58
    v_cvt_f32_i32 v83, v59
    v_cvt_f32_i32 v84, v60
    v_cvt_f32_i32 v85, v61
    v_cvt_f32_i32 v86, v62
    v_cvt_f32_i32 v87, v63
    v_cvt_f32_i32 v88, v64
    v_cvt_f32_i32 v89, v65
    v_cvt_f32_i32 v90, v66
    v_cvt_f32_i32 v91, v67
    v_cvt_pk_bf16_f32 v93, v68, v80
    v_cvt_pk_bf16_f32 v97, v69, v81
    v_cvt_pk_bf16_f32 v101, v70, v82
    v_cvt_pk_bf16_f32 v105, v71, v83
    v_cvt_pk_bf16_f32 v109, v72, v84
    v_cvt_pk_bf16_f32 v113, v73, v85
    v_cvt_pk_bf16_f32 v117, v74, v86
    v_cvt_pk_bf16_f32 v121, v75, v87
    v_cvt_pk_bf16_f32 v125, v76, v88
    v_cvt_pk_bf16_f32 v129, v77, v89
    v_cvt_pk_bf16_f32 v133, v78, v90
    v_cvt_pk_bf16_f32 v137, v79, v91
    s_add_u32 s60, s58, 24576
    buffer_load_dwordx4 v[44:47], v11, s[28:31], s60 offen offset:0 nt
    buffer_load_dwordx4 v[48:51], v11, s[28:31], s60 offen offset:256 nt
    buffer_load_dwordx4 v[52:55], v11, s[28:31], s60 offen offset:512 nt
    s_add_u32 s61, s58, 57600
    buffer_load_dwordx4 v[56:59], v11, s[28:31], s61 offen offset:0 nt
    buffer_load_dwordx4 v[60:63], v11, s[28:31], s61 offen offset:256 nt
    buffer_load_dwordx4 v[64:67], v11, s[28:31], s61 offen offset:512 nt
    s_waitcnt vmcnt(0)
    v_cvt_f32_i32 v68, v44
    v_cvt_f32_i32 v69, v45
    v_cvt_f32_i32 v70, v46
    v_cvt_f32_i32 v71, v47
    v_cvt_f32_i32 v72, v48
    v_cvt_f32_i32 v73, v49
    v_cvt_f32_i32 v74, v50
    v_cvt_f32_i32 v75, v51
    v_cvt_f32_i32 v76, v52
    v_cvt_f32_i32 v77, v53
    v_cvt_f32_i32 v78, v54
    v_cvt_f32_i32 v79, v55
    v_cvt_f32_i32 v80, v56
    v_cvt_f32_i32 v81, v57
    v_cvt_f32_i32 v82, v58
    v_cvt_f32_i32 v83, v59
    v_cvt_f32_i32 v84, v60
    v_cvt_f32_i32 v85, v61
    v_cvt_f32_i32 v86, v62
    v_cvt_f32_i32 v87, v63
    v_cvt_f32_i32 v88, v64
    v_cvt_f32_i32 v89, v65
    v_cvt_f32_i32 v90, v66
    v_cvt_f32_i32 v91, v67
    v_cvt_pk_bf16_f32 v94, v68, v80
    v_cvt_pk_bf16_f32 v98, v69, v81
    v_cvt_pk_bf16_f32 v102, v70, v82
    v_cvt_pk_bf16_f32 v106, v71, v83
    v_cvt_pk_bf16_f32 v110, v72, v84
    v_cvt_pk_bf16_f32 v114, v73, v85
    v_cvt_pk_bf16_f32 v118, v74, v86
    v_cvt_pk_bf16_f32 v122, v75, v87
    v_cvt_pk_bf16_f32 v126, v76, v88
    v_cvt_pk_bf16_f32 v130, v77, v89
    v_cvt_pk_bf16_f32 v134, v78, v90
    v_cvt_pk_bf16_f32 v138, v79, v91
    s_add_u32 s60, s58, 69888
    buffer_load_dwordx4 v[44:47], v10, s[28:31], s60 offen offset:0 nt
    buffer_load_dwordx4 v[48:51], v10, s[28:31], s60 offen offset:256 nt
    buffer_load_dwordx4 v[52:55], v10, s[28:31], s60 offen offset:512 nt
    s_add_u32 s61, s58, 102912
    buffer_load_dwordx4 v[56:59], v10, s[28:31], s61 offen offset:0 nt
    buffer_load_dwordx4 v[60:63], v10, s[28:31], s61 offen offset:256 nt
    buffer_load_dwordx4 v[64:67], v10, s[28:31], s61 offen offset:512 nt
    s_waitcnt vmcnt(0)
    v_cvt_f32_i32 v68, v44
    v_cvt_f32_i32 v69, v45
    v_cvt_f32_i32 v70, v46
    v_cvt_f32_i32 v71, v47
    v_cvt_f32_i32 v72, v48
    v_cvt_f32_i32 v73, v49
    v_cvt_f32_i32 v74, v50
    v_cvt_f32_i32 v75, v51
    v_cvt_f32_i32 v76, v52
    v_cvt_f32_i32 v77, v53
    v_cvt_f32_i32 v78, v54
    v_cvt_f32_i32 v79, v55
    v_cvt_f32_i32 v80, v56
    v_cvt_f32_i32 v81, v57
    v_cvt_f32_i32 v82, v58
    v_cvt_f32_i32 v83, v59
    v_cvt_f32_i32 v84, v60
    v_cvt_f32_i32 v85, v61
    v_cvt_f32_i32 v86, v62
    v_cvt_f32_i32 v87, v63
    v_cvt_f32_i32 v88, v64
    v_cvt_f32_i32 v89, v65
    v_cvt_f32_i32 v90, v66
    v_cvt_f32_i32 v91, v67
    v_cvt_pk_bf16_f32 v95, v68, v80
    v_cvt_pk_bf16_f32 v99, v69, v81
    v_cvt_pk_bf16_f32 v103, v70, v82
    v_cvt_pk_bf16_f32 v107, v71, v83
    v_cvt_pk_bf16_f32 v111, v72, v84
    v_cvt_pk_bf16_f32 v115, v73, v85
    v_cvt_pk_bf16_f32 v119, v74, v86
    v_cvt_pk_bf16_f32 v123, v75, v87
    v_cvt_pk_bf16_f32 v127, v76, v88
    v_cvt_pk_bf16_f32 v131, v77, v89
    v_cvt_pk_bf16_f32 v135, v78, v90
    v_cvt_pk_bf16_f32 v139, v79, v91
    s_add_u32 s60, s58, 82176
    buffer_load_dwordx4 v[44:47], v10, s[28:31], s60 offen offset:0 nt
    buffer_load_dwordx4 v[48:51], v10, s[28:31], s60 offen offset:256 nt
    buffer_load_dwordx4 v[52:55], v10, s[28:31], s60 offen offset:512 nt
    s_add_u32 s61, s58, 115200
    buffer_load_dwordx4 v[56:59], v10, s[28:31], s61 offen offset:0 nt
    buffer_load_dwordx4 v[60:63], v10, s[28:31], s61 offen offset:256 nt
    buffer_load_dwordx4 v[64:67], v10, s[28:31], s61 offen offset:512 nt
    v_mfma_f32_16x16x32_bf16 v[168:171], v[216:219], v[92:95], v[168:171]
    v_mfma_f32_16x16x32_bf16 v[172:175], v[216:219], v[96:99], v[172:175]
    v_mfma_f32_16x16x32_bf16 v[176:179], v[216:219], v[100:103], v[176:179]
    v_mfma_f32_16x16x32_bf16 v[180:183], v[216:219], v[104:107], v[180:183]
    v_mfma_f32_16x16x32_bf16 v[184:187], v[216:219], v[108:111], v[184:187]
    v_mfma_f32_16x16x32_bf16 v[188:191], v[216:219], v[112:115], v[188:191]
    v_mfma_f32_16x16x32_bf16 v[192:195], v[216:219], v[116:119], v[192:195]
    v_mfma_f32_16x16x32_bf16 v[196:199], v[216:219], v[120:123], v[196:199]
    v_mfma_f32_16x16x32_bf16 v[200:203], v[216:219], v[124:127], v[200:203]
    v_mfma_f32_16x16x32_bf16 v[204:207], v[216:219], v[128:131], v[204:207]
    v_mfma_f32_16x16x32_bf16 v[208:211], v[216:219], v[132:135], v[208:211]
    v_mfma_f32_16x16x32_bf16 v[212:215], v[216:219], v[136:139], v[212:215]
    s_waitcnt vmcnt(0)
    v_cvt_f32_i32 v68, v44
    v_cvt_f32_i32 v69, v45
    v_cvt_f32_i32 v70, v46
    v_cvt_f32_i32 v71, v47
    v_cvt_f32_i32 v72, v48
    v_cvt_f32_i32 v73, v49
    v_cvt_f32_i32 v74, v50
    v_cvt_f32_i32 v75, v51
    v_cvt_f32_i32 v76, v52
    v_cvt_f32_i32 v77, v53
    v_cvt_f32_i32 v78, v54
    v_cvt_f32_i32 v79, v55
    v_cvt_f32_i32 v80, v56
    v_cvt_f32_i32 v81, v57
    v_cvt_f32_i32 v82, v58
    v_cvt_f32_i32 v83, v59
    v_cvt_f32_i32 v84, v60
    v_cvt_f32_i32 v85, v61
    v_cvt_f32_i32 v86, v62
    v_cvt_f32_i32 v87, v63
    v_cvt_f32_i32 v88, v64
    v_cvt_f32_i32 v89, v65
    v_cvt_f32_i32 v90, v66
    v_cvt_f32_i32 v91, v67
    v_cvt_pk_bf16_f32 v92, v68, v80
    v_cvt_pk_bf16_f32 v96, v69, v81
    v_cvt_pk_bf16_f32 v100, v70, v82
    v_cvt_pk_bf16_f32 v104, v71, v83
    v_cvt_pk_bf16_f32 v108, v72, v84
    v_cvt_pk_bf16_f32 v112, v73, v85
    v_cvt_pk_bf16_f32 v116, v74, v86
    v_cvt_pk_bf16_f32 v120, v75, v87
    v_cvt_pk_bf16_f32 v124, v76, v88
    v_cvt_pk_bf16_f32 v128, v77, v89
    v_cvt_pk_bf16_f32 v132, v78, v90
    v_cvt_pk_bf16_f32 v136, v79, v91
    s_add_u32 s60, s58, 94464
    buffer_load_dwordx4 v[44:47], v12, s[28:31], s60 offen offset:0 nt
    buffer_load_dwordx4 v[48:51], v12, s[28:31], s60 offen offset:256 nt
    buffer_load_dwordx4 v[52:55], v12, s[28:31], s60 offen offset:512 nt
    s_add_u32 s61, s58, 127488
    buffer_load_dwordx4 v[56:59], v13, s[28:31], s61 offen offset:0 nt
    buffer_load_dwordx4 v[60:63], v13, s[28:31], s61 offen offset:256 nt
    buffer_load_dwordx4 v[64:67], v13, s[28:31], s61 offen offset:512 nt
    s_waitcnt lgkmcnt(0)
    v_lshlrev_b32 v226, 16, v223
    v_and_b32 v227, s68, v223
    v_fma_f32 v226, v226, s66, -v20
    v_fma_f32 v227, v227, s66, -v20
    v_exp_f32 v226, v226
    v_exp_f32 v227, v227
    v_and_b32 v228, s68, v224
    v_and_b32 v229, s68, v225
    v_mul_f32 v228, v226, v228
    v_mul_f32 v229, v227, v229
    v_add_f32 v220, v220, v226
    v_cvt_pk_bf16_f32 v228, v228, v229
    v_add_f32 v220, v220, v227
    v_lshlrev_b32 v230, 16, v224
    v_lshlrev_b32 v231, 16, v225
    v_lshlrev_b32 v226, 16, v228
    v_and_b32 v227, s68, v228
    v_fmac_f32 v221, v226, v230
    v_fmac_f32 v221, v227, v231
    v_mov_b32_dpp v216, v228 quad_perm:[0,1,2,3] row_mask:0xf bank_mask:0x1
    v_mov_b32_dpp v217, v228 quad_perm:[0,1,2,3] row_mask:0xf bank_mask:0x2
    v_mov_b32_dpp v218, v228 quad_perm:[0,1,2,3] row_mask:0xf bank_mask:0x4
    v_mov_b32_dpp v219, v228 quad_perm:[0,1,2,3] row_mask:0xf bank_mask:0x8
    v_add_u32 v18, 512, v18
    v_add_u32 v14, 1024, v14
    v_add_u32 v15, 1024, v15
    ds_read_b32 v223, v18 offset:0
    ds_read_b32 v224, v14
    ds_read_b32 v225, v15
    s_waitcnt vmcnt(0)
    v_cvt_f32_i32 v68, v44
    v_cvt_f32_i32 v69, v45
    v_cvt_f32_i32 v70, v46
    v_cvt_f32_i32 v71, v47
    v_cvt_f32_i32 v72, v48
    v_cvt_f32_i32 v73, v49
    v_cvt_f32_i32 v74, v50
    v_cvt_f32_i32 v75, v51
    v_cvt_f32_i32 v76, v52
    v_cvt_f32_i32 v77, v53
    v_cvt_f32_i32 v78, v54
    v_cvt_f32_i32 v79, v55
    v_cvt_f32_i32 v80, v56
    v_cvt_f32_i32 v81, v57
    v_cvt_f32_i32 v82, v58
    v_cvt_f32_i32 v83, v59
    v_cvt_f32_i32 v84, v60
    v_cvt_f32_i32 v85, v61
    v_cvt_f32_i32 v86, v62
    v_cvt_f32_i32 v87, v63
    v_cvt_f32_i32 v88, v64
    v_cvt_f32_i32 v89, v65
    v_cvt_f32_i32 v90, v66
    v_cvt_f32_i32 v91, v67
    v_cvt_pk_bf16_f32 v93, v68, v80
    v_cvt_pk_bf16_f32 v97, v69, v81
    v_cvt_pk_bf16_f32 v101, v70, v82
    v_cvt_pk_bf16_f32 v105, v71, v83
    v_cvt_pk_bf16_f32 v109, v72, v84
    v_cvt_pk_bf16_f32 v113, v73, v85
    v_cvt_pk_bf16_f32 v117, v74, v86
    v_cvt_pk_bf16_f32 v121, v75, v87
    v_cvt_pk_bf16_f32 v125, v76, v88
    v_cvt_pk_bf16_f32 v129, v77, v89
    v_cvt_pk_bf16_f32 v133, v78, v90
    v_cvt_pk_bf16_f32 v137, v79, v91
    s_add_u32 s60, s58, 139776
    buffer_load_dwordx4 v[44:47], v10, s[28:31], s60 offen offset:0 nt
    buffer_load_dwordx4 v[48:51], v10, s[28:31], s60 offen offset:256 nt
    buffer_load_dwordx4 v[52:55], v10, s[28:31], s60 offen offset:512 nt
    s_add_u32 s61, s58, 172032
    buffer_load_dwordx4 v[56:59], v10, s[28:31], s61 offen offset:0 nt
    buffer_load_dwordx4 v[60:63], v10, s[28:31], s61 offen offset:256 nt
    buffer_load_dwordx4 v[64:67], v10, s[28:31], s61 offen offset:512 nt
    s_waitcnt vmcnt(0)
    v_cvt_f32_i32 v68, v44
    v_cvt_f32_i32 v69, v45
    v_cvt_f32_i32 v70, v46
    v_cvt_f32_i32 v71, v47
    v_cvt_f32_i32 v72, v48
    v_cvt_f32_i32 v73, v49
    v_cvt_f32_i32 v74, v50
    v_cvt_f32_i32 v75, v51
    v_cvt_f32_i32 v76, v52
    v_cvt_f32_i32 v77, v53
    v_cvt_f32_i32 v78, v54
    v_cvt_f32_i32 v79, v55
    v_cvt_f32_i32 v80, v56
    v_cvt_f32_i32 v81, v57
    v_cvt_f32_i32 v82, v58
    v_cvt_f32_i32 v83, v59
    v_cvt_f32_i32 v84, v60
    v_cvt_f32_i32 v85, v61
    v_cvt_f32_i32 v86, v62
    v_cvt_f32_i32 v87, v63
    v_cvt_f32_i32 v88, v64
    v_cvt_f32_i32 v89, v65
    v_cvt_f32_i32 v90, v66
    v_cvt_f32_i32 v91, v67
    v_cvt_pk_bf16_f32 v94, v68, v80
    v_cvt_pk_bf16_f32 v98, v69, v81
    v_cvt_pk_bf16_f32 v102, v70, v82
    v_cvt_pk_bf16_f32 v106, v71, v83
    v_cvt_pk_bf16_f32 v110, v72, v84
    v_cvt_pk_bf16_f32 v114, v73, v85
    v_cvt_pk_bf16_f32 v118, v74, v86
    v_cvt_pk_bf16_f32 v122, v75, v87
    v_cvt_pk_bf16_f32 v126, v76, v88
    v_cvt_pk_bf16_f32 v130, v77, v89
    v_cvt_pk_bf16_f32 v134, v78, v90
    v_cvt_pk_bf16_f32 v138, v79, v91
    s_add_u32 s60, s58, 152064
    buffer_load_dwordx4 v[44:47], v10, s[28:31], s60 offen offset:0 nt
    buffer_load_dwordx4 v[48:51], v10, s[28:31], s60 offen offset:256 nt
    buffer_load_dwordx4 v[52:55], v10, s[28:31], s60 offen offset:512 nt
    s_add_u32 s61, s58, 184320
    buffer_load_dwordx4 v[56:59], v10, s[28:31], s61 offen offset:0 nt
    buffer_load_dwordx4 v[60:63], v10, s[28:31], s61 offen offset:256 nt
    buffer_load_dwordx4 v[64:67], v10, s[28:31], s61 offen offset:512 nt
    s_waitcnt vmcnt(0)
    v_cvt_f32_i32 v68, v44
    v_cvt_f32_i32 v69, v45
    v_cvt_f32_i32 v70, v46
    v_cvt_f32_i32 v71, v47
    v_cvt_f32_i32 v72, v48
    v_cvt_f32_i32 v73, v49
    v_cvt_f32_i32 v74, v50
    v_cvt_f32_i32 v75, v51
    v_cvt_f32_i32 v76, v52
    v_cvt_f32_i32 v77, v53
    v_cvt_f32_i32 v78, v54
    v_cvt_f32_i32 v79, v55
    v_cvt_f32_i32 v80, v56
    v_cvt_f32_i32 v81, v57
    v_cvt_f32_i32 v82, v58
    v_cvt_f32_i32 v83, v59
    v_cvt_f32_i32 v84, v60
    v_cvt_f32_i32 v85, v61
    v_cvt_f32_i32 v86, v62
    v_cvt_f32_i32 v87, v63
    v_cvt_f32_i32 v88, v64
    v_cvt_f32_i32 v89, v65
    v_cvt_f32_i32 v90, v66
    v_cvt_f32_i32 v91, v67
    v_cvt_pk_bf16_f32 v95, v68, v80
    v_cvt_pk_bf16_f32 v99, v69, v81
    v_cvt_pk_bf16_f32 v103, v70, v82
    v_cvt_pk_bf16_f32 v107, v71, v83
    v_cvt_pk_bf16_f32 v111, v72, v84
    v_cvt_pk_bf16_f32 v115, v73, v85
    v_cvt_pk_bf16_f32 v119, v74, v86
    v_cvt_pk_bf16_f32 v123, v75, v87
    v_cvt_pk_bf16_f32 v127, v76, v88
    v_cvt_pk_bf16_f32 v131, v77, v89
    v_cvt_pk_bf16_f32 v135, v78, v90
    v_cvt_pk_bf16_f32 v139, v79, v91
    s_cmp_eq_u32 s63, 15
    s_cbranch_scc1 L_vissue_done
    s_add_u32 s60, s59, 0
    buffer_load_dwordx4 v[44:47], v10, s[28:31], s60 offen offset:0 nt
    buffer_load_dwordx4 v[48:51], v10, s[28:31], s60 offen offset:256 nt
    buffer_load_dwordx4 v[52:55], v10, s[28:31], s60 offen offset:512 nt
    s_add_u32 s61, s59, 33024
    buffer_load_dwordx4 v[56:59], v10, s[28:31], s61 offen offset:0 nt
    buffer_load_dwordx4 v[60:63], v10, s[28:31], s61 offen offset:256 nt
    buffer_load_dwordx4 v[64:67], v10, s[28:31], s61 offen offset:512 nt
L_vissue_done:
    v_mfma_f32_16x16x32_bf16 v[168:171], v[216:219], v[92:95], v[168:171]
    v_mfma_f32_16x16x32_bf16 v[172:175], v[216:219], v[96:99], v[172:175]
    v_mfma_f32_16x16x32_bf16 v[176:179], v[216:219], v[100:103], v[176:179]
    v_mfma_f32_16x16x32_bf16 v[180:183], v[216:219], v[104:107], v[180:183]
    v_mfma_f32_16x16x32_bf16 v[184:187], v[216:219], v[108:111], v[184:187]
    v_mfma_f32_16x16x32_bf16 v[188:191], v[216:219], v[112:115], v[188:191]
    v_mfma_f32_16x16x32_bf16 v[192:195], v[216:219], v[116:119], v[192:195]
    v_mfma_f32_16x16x32_bf16 v[196:199], v[216:219], v[120:123], v[196:199]
    v_mfma_f32_16x16x32_bf16 v[200:203], v[216:219], v[124:127], v[200:203]
    v_mfma_f32_16x16x32_bf16 v[204:207], v[216:219], v[128:131], v[204:207]
    v_mfma_f32_16x16x32_bf16 v[208:211], v[216:219], v[132:135], v[208:211]
    v_mfma_f32_16x16x32_bf16 v[212:215], v[216:219], v[136:139], v[212:215]
    s_mov_b32 s58, s59
    s_add_u32 s63, s63, 1
    s_and_b32 s62, s63, 15
    s_cbranch_scc1 L_vblk
    s_nop 1
    v_add_f32_dpp v220, v220, v220 row_ror:4 row_mask:0xf bank_mask:0xf
    s_nop 1
    v_add_f32_dpp v220, v220, v220 row_ror:8 row_mask:0xf bank_mask:0xf
    v_mov_b32 v3, v220
    s_nop 1
    v_permlane16_swap_b32 v220, v3
    v_add_f32 v220, v220, v3
    v_mov_b32 v3, v220
    s_nop 1
    v_permlane32_swap_b32 v220, v3
    v_add_f32 v220, v220, v3
    s_nop 1
    v_add_f32_dpp v221, v221, v221 row_ror:4 row_mask:0xf bank_mask:0xf
    s_nop 1
    v_add_f32_dpp v221, v221, v221 row_ror:8 row_mask:0xf bank_mask:0xf
    v_mov_b32 v3, v221
    s_nop 1
    v_permlane16_swap_b32 v221, v3
    v_add_f32 v221, v221, v3
    v_mov_b32 v3, v221
    s_nop 1
    v_permlane32_swap_b32 v221, v3
    v_add_f32 v221, v221, v3
    v_mov_b32 v68, v20
    v_mov_b32 v69, v220
    v_mov_b32 v70, v221
    v_mov_b32 v71, 0
    v_lshlrev_b32 v3, 2, v1
    v_sub_u32 v3, v19, v3
    v_and_b32 v4, 3, v1
    v_lshl_add_u32 v3, v4, 4, v3
    ds_write_b128 v3, v[68:71]
    v_add_u32 v19, 256, v19
    v_permlane32_swap_b32 v168, v170
    v_permlane32_swap_b32 v169, v171
    v_permlane32_swap_b32 v172, v174
    v_permlane32_swap_b32 v173, v175
    v_permlane32_swap_b32 v176, v178
    v_permlane32_swap_b32 v177, v179
    v_permlane32_swap_b32 v180, v182
    v_permlane32_swap_b32 v181, v183
    v_permlane32_swap_b32 v184, v186
    v_permlane32_swap_b32 v185, v187
    v_permlane32_swap_b32 v188, v190
    v_permlane32_swap_b32 v189, v191
    v_permlane32_swap_b32 v192, v194
    v_permlane32_swap_b32 v193, v195
    v_permlane32_swap_b32 v196, v198
    v_permlane32_swap_b32 v197, v199
    v_permlane32_swap_b32 v200, v202
    v_permlane32_swap_b32 v201, v203
    v_permlane32_swap_b32 v204, v206
    v_permlane32_swap_b32 v205, v207
    v_permlane32_swap_b32 v208, v210
    v_permlane32_swap_b32 v209, v211
    v_permlane32_swap_b32 v212, v214
    v_permlane32_swap_b32 v213, v215
    v_add_f32 v168, v168, v170
    v_add_f32 v169, v169, v171
    v_add_f32 v172, v172, v174
    v_add_f32 v173, v173, v175
    v_add_f32 v176, v176, v178
    v_add_f32 v177, v177, v179
    v_add_f32 v180, v180, v182
    v_add_f32 v181, v181, v183
    v_add_f32 v184, v184, v186
    v_add_f32 v185, v185, v187
    v_add_f32 v188, v188, v190
    v_add_f32 v189, v189, v191
    v_add_f32 v192, v192, v194
    v_add_f32 v193, v193, v195
    v_add_f32 v196, v196, v198
    v_add_f32 v197, v197, v199
    v_add_f32 v200, v200, v202
    v_add_f32 v201, v201, v203
    v_add_f32 v204, v204, v206
    v_add_f32 v205, v205, v207
    v_add_f32 v208, v208, v210
    v_add_f32 v209, v209, v211
    v_add_f32 v212, v212, v214
    v_add_f32 v213, v213, v215
    s_nop 1
    v_permlane16_swap_b32 v168, v169
    v_permlane16_swap_b32 v172, v173
    v_permlane16_swap_b32 v176, v177
    v_permlane16_swap_b32 v180, v181
    v_permlane16_swap_b32 v184, v185
    v_permlane16_swap_b32 v188, v189
    v_permlane16_swap_b32 v192, v193
    v_permlane16_swap_b32 v196, v197
    v_permlane16_swap_b32 v200, v201
    v_permlane16_swap_b32 v204, v205
    v_permlane16_swap_b32 v208, v209
    v_permlane16_swap_b32 v212, v213
    v_add_f32 v72, v168, v169
    v_add_f32 v73, v172, v173
    v_add_f32 v74, v176, v177
    v_add_f32 v75, v180, v181
    v_add_f32 v76, v184, v185
    v_add_f32 v77, v188, v189
    v_add_f32 v78, v192, v193
    v_add_f32 v79, v196, v197
    v_add_f32 v80, v200, v201
    v_add_f32 v81, v204, v205
    v_add_f32 v82, v208, v209
    v_add_f32 v83, v212, v213
    v_lshrrev_b32 v3, 4, v1
    v_mul_u32_u24 v3, 768, v3
    v_and_b32 v4, 15, v1
    v_lshl_add_u32 v3, v4, 4, v3
    v_add_u32 v4, s72, v3
    ds_write_b128 v4, v[72:75] offset:0
    ds_write_b128 v4, v[76:79] offset:256
    ds_write_b128 v4, v[80:83] offset:512
    s_add_u32 s72, s72, 12288
    s_cmp_lt_u32 s63, 16
    s_cbranch_scc1 L_vround
    s_waitcnt lgkmcnt(0)
    s_barrier
    s_cmp_ge_u32 s56, 1
    s_cbranch_scc1 L_fin
    s_mov_b32 s52, s18
    s_and_b32 s53, s19, 0xffff
    s_mov_b32 s54, 393216
    s_mov_b32 s55, 0x20000
    s_mov_b32 s64, s56
L_comb:
    s_mul_i32 s60, s64, 12288
    v_add_u32 v4, s60, v3
    s_lshl_b32 s60, s64, 8
    s_add_u32 s60, s60, 147456
    v_and_b32 v5, 48, v1
    v_add_u32 v5, s60, v5
    ds_read_b128 v[44:47], v5 offset:0
    ds_read_b128 v[48:51], v5 offset:256
    ds_read_b128 v[52:55], v5 offset:512
    ds_read_b128 v[56:59], v5 offset:768
    ds_read_b128 v[168:171], v4 offset:0
    ds_read_b128 v[172:175], v4 offset:256
    ds_read_b128 v[176:179], v4 offset:512
    ds_read_b128 v[180:183], v4 offset:3072
    ds_read_b128 v[184:187], v4 offset:3328
    ds_read_b128 v[188:191], v4 offset:3584
    ds_read_b128 v[192:195], v4 offset:6144
    ds_read_b128 v[196:199], v4 offset:6400
    ds_read_b128 v[200:203], v4 offset:6656
    ds_read_b128 v[204:207], v4 offset:9216
    ds_read_b128 v[208:211], v4 offset:9472
    ds_read_b128 v[212:215], v4 offset:9728
    s_waitcnt lgkmcnt(12)
    v_mov_b32 v20, v44
    v_max_f32 v20, v20, v48
    v_max_f32 v20, v20, v52
    v_max_f32 v20, v20, v56
    v_sub_f32 v44, v44, v20
    v_sub_f32 v48, v48, v20
    v_sub_f32 v52, v52, v20
    v_sub_f32 v56, v56, v20
    v_exp_f32 v44, v44
    v_exp_f32 v48, v48
    v_exp_f32 v52, v52
    v_exp_f32 v56, v56
    s_nop 0
    v_mul_f32 v220, v44, v45
    v_fmac_f32 v220, v48, v49
    v_fmac_f32 v220, v52, v53
    v_fmac_f32 v220, v56, v57
    s_waitcnt lgkmcnt(0)
    v_sub_f32 v168, v168, v46
    v_mul_f32 v168, v168, v44
    v_sub_f32 v169, v169, v46
    v_mul_f32 v169, v169, v44
    v_sub_f32 v170, v170, v46
    v_mul_f32 v170, v170, v44
    v_sub_f32 v171, v171, v46
    v_mul_f32 v171, v171, v44
    v_sub_f32 v172, v172, v46
    v_mul_f32 v172, v172, v44
    v_sub_f32 v173, v173, v46
    v_mul_f32 v173, v173, v44
    v_sub_f32 v174, v174, v46
    v_mul_f32 v174, v174, v44
    v_sub_f32 v175, v175, v46
    v_mul_f32 v175, v175, v44
    v_sub_f32 v176, v176, v46
    v_mul_f32 v176, v176, v44
    v_sub_f32 v177, v177, v46
    v_mul_f32 v177, v177, v44
    v_sub_f32 v178, v178, v46
    v_mul_f32 v178, v178, v44
    v_sub_f32 v179, v179, v46
    v_mul_f32 v179, v179, v44
    v_sub_f32 v180, v180, v50
    v_fmac_f32 v168, v180, v48
    v_sub_f32 v181, v181, v50
    v_fmac_f32 v169, v181, v48
    v_sub_f32 v182, v182, v50
    v_fmac_f32 v170, v182, v48
    v_sub_f32 v183, v183, v50
    v_fmac_f32 v171, v183, v48
    v_sub_f32 v184, v184, v50
    v_fmac_f32 v172, v184, v48
    v_sub_f32 v185, v185, v50
    v_fmac_f32 v173, v185, v48
    v_sub_f32 v186, v186, v50
    v_fmac_f32 v174, v186, v48
    v_sub_f32 v187, v187, v50
    v_fmac_f32 v175, v187, v48
    v_sub_f32 v188, v188, v50
    v_fmac_f32 v176, v188, v48
    v_sub_f32 v189, v189, v50
    v_fmac_f32 v177, v189, v48
    v_sub_f32 v190, v190, v50
    v_fmac_f32 v178, v190, v48
    v_sub_f32 v191, v191, v50
    v_fmac_f32 v179, v191, v48
    v_sub_f32 v192, v192, v54
    v_fmac_f32 v168, v192, v52
    v_sub_f32 v193, v193, v54
    v_fmac_f32 v169, v193, v52
    v_sub_f32 v194, v194, v54
    v_fmac_f32 v170, v194, v52
    v_sub_f32 v195, v195, v54
    v_fmac_f32 v171, v195, v52
    v_sub_f32 v196, v196, v54
    v_fmac_f32 v172, v196, v52
    v_sub_f32 v197, v197, v54
    v_fmac_f32 v173, v197, v52
    v_sub_f32 v198, v198, v54
    v_fmac_f32 v174, v198, v52
    v_sub_f32 v199, v199, v54
    v_fmac_f32 v175, v199, v52
    v_sub_f32 v200, v200, v54
    v_fmac_f32 v176, v200, v52
    v_sub_f32 v201, v201, v54
    v_fmac_f32 v177, v201, v52
    v_sub_f32 v202, v202, v54
    v_fmac_f32 v178, v202, v52
    v_sub_f32 v203, v203, v54
    v_fmac_f32 v179, v203, v52
    v_sub_f32 v204, v204, v58
    v_fmac_f32 v168, v204, v56
    v_sub_f32 v205, v205, v58
    v_fmac_f32 v169, v205, v56
    v_sub_f32 v206, v206, v58
    v_fmac_f32 v170, v206, v56
    v_sub_f32 v207, v207, v58
    v_fmac_f32 v171, v207, v56
    v_sub_f32 v208, v208, v58
    v_fmac_f32 v172, v208, v56
    v_sub_f32 v209, v209, v58
    v_fmac_f32 v173, v209, v56
    v_sub_f32 v210, v210, v58
    v_fmac_f32 v174, v210, v56
    v_sub_f32 v211, v211, v58
    v_fmac_f32 v175, v211, v56
    v_sub_f32 v212, v212, v58
    v_fmac_f32 v176, v212, v56
    v_sub_f32 v213, v213, v58
    v_fmac_f32 v177, v213, v56
    v_sub_f32 v214, v214, v58
    v_fmac_f32 v178, v214, v56
    v_sub_f32 v215, v215, v58
    v_fmac_f32 v179, v215, v56
    s_lshl_b32 s60, s64, 8
    s_add_u32 s60, s60, s2
    v_rcp_f32 v220, v220
    v_lshrrev_b32 v4, 1, v3
    s_mul_i32 s61, s60, 1536
    v_mul_f32 v168, v168, v220
    v_mul_f32 v169, v169, v220
    v_mul_f32 v170, v170, v220
    v_mul_f32 v171, v171, v220
    v_mul_f32 v172, v172, v220
    v_mul_f32 v173, v173, v220
    v_mul_f32 v174, v174, v220
    v_mul_f32 v175, v175, v220
    v_mul_f32 v176, v176, v220
    v_mul_f32 v177, v177, v220
    v_mul_f32 v178, v178, v220
    v_mul_f32 v179, v179, v220
    v_cvt_pk_bf16_f32 v180, v168, v169
    v_cvt_pk_bf16_f32 v181, v170, v171
    v_cvt_pk_bf16_f32 v182, v172, v173
    v_cvt_pk_bf16_f32 v183, v174, v175
    v_cvt_pk_bf16_f32 v184, v176, v177
    v_cvt_pk_bf16_f32 v185, v178, v179
    buffer_store_dwordx2 v[180:181], v4, s[52:55], s61 offen offset:0
    buffer_store_dwordx2 v[182:183], v4, s[52:55], s61 offen offset:128
    buffer_store_dwordx2 v[184:185], v4, s[52:55], s61 offen offset:256
L_fin:
L_end:
    s_endpgm
.section .rodata,"a"
.p2align 6
.amdhsa_kernel standalone__kv_cache_quant_int4_int2_kv_with_per_channel_or_per_token_scales__sampling_kernel
  .amdhsa_next_free_vgpr 256
  .amdhsa_next_free_sgpr 96
  .amdhsa_accum_offset 256
  .amdhsa_group_segment_fixed_size 0
  .amdhsa_kernarg_size 80
  .amdhsa_user_sgpr_count 2
  .amdhsa_user_sgpr_kernarg_segment_ptr 1
  .amdhsa_system_sgpr_workgroup_id_x 1
  .amdhsa_float_denorm_mode_32 3
.end_amdhsa_kernel
```

```asm
; @launch grid=(256,1,1) block=(320,1,1) lds=154880
.amdgcn_target "amdgcn-amd-amdhsa--gfx950"
.text
.globl standalone__kv_cache_quant_int4_int2_kv_with_per_channel_or_per_token_scales__sampling_kernel
.p2align 8
.type standalone__kv_cache_quant_int4_int2_kv_with_per_channel_or_per_token_scales__sampling_kernel,@function
standalone__kv_cache_quant_int4_int2_kv_with_per_channel_or_per_token_scales__sampling_kernel:
    s_cmp_ge_u32 s2, 256
    s_cbranch_scc1 L_end
    s_load_dwordx16 s[4:19], s[0:1], 0
    s_load_dwordx4 s[20:23], s[0:1], 64
    v_lshrrev_b32 v2, 6, v0
    v_and_b32 v1, 63, v0
    v_readfirstlane_b32 s56, v2
    s_mov_b32 s67, 768
    s_mul_i32 s72, s2, 1
    s_lshr_b32 s72, s72, 0
    s_and_b32 s72, s72, 15
    s_cmp_eq_u32 s56, 4
    s_cbranch_scc0 L_consumer
    s_setprio 3
    v_bfe_u32 v8, v1, 2, 1
    v_bfe_u32 v9, v1, 3, 1
    v_lshrrev_b32 v13, 4, v1
    v_and_b32 v14, 3, v1
    v_lshl_add_u32 v10, v13, 2, v14
    v_lshlrev_b32 v10, 4, v10
    s_mul_i32 s73, s2, 3145728
    s_mul_i32 s57, s72, 196608
    s_add_u32 s57, s57, s73
    s_mov_b32 s68, 0
    s_mov_b32 s69, 0
    s_waitcnt lgkmcnt(0)
    s_mov_b32 s24, s6
    s_and_b32 s25, s7, 0xffff
    s_mov_b32 s26, 805306368
    s_mov_b32 s27, 0x20000
    s_and_b32 s58, s68, 63
    v_lshl_add_u32 v12, s58, 1, v8
    v_cmp_le_u32 vcc, 43, v12
    v_add_u32 v13, 43, v12
    v_mov_b32 v14, 42
    v_cndmask_b32 v11, v12, v13, vcc
    v_cmp_le_u32 vcc, 86, v12
    v_add_u32 v13, 43, v11
    s_nop 0
    v_cndmask_b32 v11, v11, v13, vcc
    v_cndmask_b32 v14, 43, v14, vcc
    v_mad_u32_u24 v11, v14, v9, v11
    v_mad_u32_u24 v11, v11, s67, v10
    s_mov_b32 m0, s69
    s_nop 0
    buffer_load_dwordx4 v11, s[24:27], s57 offen offset:0 nt lds
    s_add_u32 m0, m0, 768
    s_add_u32 s69, s69, 3072
    buffer_load_dwordx4 v11, s[24:27], s57 offen offset:256 nt lds
    s_add_u32 m0, m0, 768
    s_add_u32 s68, s68, 1
    buffer_load_dwordx4 v11, s[24:27], s57 offen offset:512 nt lds
    s_and_b32 s58, s68, 63
    v_lshl_add_u32 v12, s58, 1, v8
    v_cmp_le_u32 vcc, 43, v12
    v_add_u32 v13, 43, v12
    v_mov_b32 v14, 42
    v_cndmask_b32 v11, v12, v13, vcc
    v_cmp_le_u32 vcc, 86, v12
    v_add_u32 v13, 43, v11
    s_nop 0
    v_cndmask_b32 v11, v11, v13, vcc
    v_cndmask_b32 v14, 43, v14, vcc
    v_mad_u32_u24 v11, v14, v9, v11
    v_mad_u32_u24 v11, v11, s67, v10
    s_mov_b32 m0, s69
    s_nop 0
    buffer_load_dwordx4 v11, s[24:27], s57 offen offset:0 nt lds
    s_add_u32 m0, m0, 768
    s_add_u32 s69, s69, 3072
    buffer_load_dwordx4 v11, s[24:27], s57 offen offset:256 nt lds
    s_add_u32 m0, m0, 768
    s_add_u32 s68, s68, 1
    buffer_load_dwordx4 v11, s[24:27], s57 offen offset:512 nt lds
    s_and_b32 s58, s68, 63
    v_lshl_add_u32 v12, s58, 1, v8
    v_cmp_le_u32 vcc, 43, v12
    v_add_u32 v13, 43, v12
    v_mov_b32 v14, 42
    v_cndmask_b32 v11, v12, v13, vcc
    v_cmp_le_u32 vcc, 86, v12
    v_add_u32 v13, 43, v11
    s_nop 0
    v_cndmask_b32 v11, v11, v13, vcc
    v_cndmask_b32 v14, 43, v14, vcc
    v_mad_u32_u24 v11, v14, v9, v11
    v_mad_u32_u24 v11, v11, s67, v10
    s_mov_b32 m0, s69
    s_nop 0
    buffer_load_dwordx4 v11, s[24:27], s57 offen offset:0 nt lds
    s_add_u32 m0, m0, 768
    s_add_u32 s69, s69, 3072
    buffer_load_dwordx4 v11, s[24:27], s57 offen offset:256 nt lds
    s_add_u32 m0, m0, 768
    s_add_u32 s68, s68, 1
    buffer_load_dwordx4 v11, s[24:27], s57 offen offset:512 nt lds
    s_and_b32 s58, s68, 63
    v_lshl_add_u32 v12, s58, 1, v8
    v_cmp_le_u32 vcc, 43, v12
    v_add_u32 v13, 43, v12
    v_mov_b32 v14, 42
    v_cndmask_b32 v11, v12, v13, vcc
    v_cmp_le_u32 vcc, 86, v12
    v_add_u32 v13, 43, v11
    s_nop 0
    v_cndmask_b32 v11, v11, v13, vcc
    v_cndmask_b32 v14, 43, v14, vcc
    v_mad_u32_u24 v11, v14, v9, v11
    v_mad_u32_u24 v11, v11, s67, v10
    s_mov_b32 m0, s69
    s_nop 0
    buffer_load_dwordx4 v11, s[24:27], s57 offen offset:0 nt lds
    s_add_u32 m0, m0, 768
    s_add_u32 s69, s69, 3072
    buffer_load_dwordx4 v11, s[24:27], s57 offen offset:256 nt lds
    s_add_u32 m0, m0, 768
    s_add_u32 s68, s68, 1
    buffer_load_dwordx4 v11, s[24:27], s57 offen offset:512 nt lds
    s_and_b32 s58, s68, 63
    v_lshl_add_u32 v12, s58, 1, v8
    v_cmp_le_u32 vcc, 43, v12
    v_add_u32 v13, 43, v12
    v_mov_b32 v14, 42
    v_cndmask_b32 v11, v12, v13, vcc
    v_cmp_le_u32 vcc, 86, v12
    v_add_u32 v13, 43, v11
    s_nop 0
    v_cndmask_b32 v11, v11, v13, vcc
    v_cndmask_b32 v14, 43, v14, vcc
    v_mad_u32_u24 v11, v14, v9, v11
    v_mad_u32_u24 v11, v11, s67, v10
    s_mov_b32 m0, s69
    s_nop 0
    buffer_load_dwordx4 v11, s[24:27], s57 offen offset:0 nt lds
    s_add_u32 m0, m0, 768
    s_add_u32 s69, s69, 3072
    buffer_load_dwordx4 v11, s[24:27], s57 offen offset:256 nt lds
    s_add_u32 m0, m0, 768
    s_add_u32 s68, s68, 1
    buffer_load_dwordx4 v11, s[24:27], s57 offen offset:512 nt lds
    s_and_b32 s58, s68, 63
    v_lshl_add_u32 v12, s58, 1, v8
    v_cmp_le_u32 vcc, 43, v12
    v_add_u32 v13, 43, v12
    v_mov_b32 v14, 42
    v_cndmask_b32 v11, v12, v13, vcc
    v_cmp_le_u32 vcc, 86, v12
    v_add_u32 v13, 43, v11
    s_nop 0
    v_cndmask_b32 v11, v11, v13, vcc
    v_cndmask_b32 v14, 43, v14, vcc
    v_mad_u32_u24 v11, v14, v9, v11
    v_mad_u32_u24 v11, v11, s67, v10
    s_mov_b32 m0, s69
    s_nop 0
    buffer_load_dwordx4 v11, s[24:27], s57 offen offset:0 nt lds
    s_add_u32 m0, m0, 768
    s_add_u32 s69, s69, 3072
    buffer_load_dwordx4 v11, s[24:27], s57 offen offset:256 nt lds
    s_add_u32 m0, m0, 768
    s_add_u32 s68, s68, 1
    buffer_load_dwordx4 v11, s[24:27], s57 offen offset:512 nt lds
    s_mov_b32 s70, 3
    s_mov_b32 s52, s22
    s_and_b32 s53, s23, 0xffff
    s_mov_b32 s54, 16785664
    s_mov_b32 s55, 0x20000
    s_mov_b32 s71, 0
    s_mov_b32 s74, 0
    s_add_u32 s98, s22, 16777216
    s_addc_u32 s99, s23, 0
    s_lshl_b32 s59, s2, 2
    s_add_u32 s59, s59, 16777216
    v_mov_b32 v16, s59
    s_memrealtime s[96:97]
    s_branch L_lsel
L_ldisp:
    s_cmp_eq_u32 s69, 73728
    s_cselect_b32 s69, 0, s69
    s_cmp_le_u32 s68, 16
    s_cbranch_scc1 L_lfirst
L_lbar:
    s_barrier
L_lnobar:
    s_bfe_u32 s58, s68, 196611
    s_cmp_eq_u32 s58, 0
    s_cbranch_scc1 L_lev0
    s_cmp_eq_u32 s58, 1
    s_cbranch_scc1 L_lev1
    s_cmp_eq_u32 s58, 6
    s_cbranch_scc1 L_lev6
    s_cmp_eq_u32 s58, 7
    s_cbranch_scc1 L_lev7
L_lsel:
    s_cmp_eq_u32 s70, 0
    s_cbranch_scc1 L_lvl0
    s_cmp_eq_u32 s70, 1
    s_cbranch_scc1 L_lvl1
    s_cmp_eq_u32 s70, 2
    s_cbranch_scc1 L_lvl2
    s_cmp_eq_u32 s70, 3
    s_cbranch_scc1 L_lvl3
    s_cmp_eq_u32 s70, 4
    s_cbranch_scc1 L_lvl4
    s_cmp_eq_u32 s70, 5
    s_cbranch_scc1 L_lvl5
L_lvl6:
    s_and_b32 s58, s68, 63
    v_lshl_add_u32 v12, s58, 1, v8
    v_cmp_le_u32 vcc, 43, v12
    v_add_u32 v13, 43, v12
    v_mov_b32 v14, 42
    v_cndmask_b32 v11, v12, v13, vcc
    v_cmp_le_u32 vcc, 86, v12
    v_add_u32 v13, 43, v11
    s_nop 0
    v_cndmask_b32 v11, v11, v13, vcc
    v_cndmask_b32 v14, 43, v14, vcc
    v_mad_u32_u24 v11, v14, v9, v11
    v_mad_u32_u24 v11, v11, s67, v10
    s_mov_b32 m0, s69
    s_waitcnt vmcnt(15)
    buffer_load_dwordx4 v11, s[24:27], s57 offen offset:0 nt lds
    s_add_u32 m0, m0, 768
    s_add_u32 s69, s69, 3072
    buffer_load_dwordx4 v11, s[24:27], s57 offen offset:256 nt lds
    s_add_u32 m0, m0, 768
    s_add_u32 s68, s68, 1
    buffer_load_dwordx4 v11, s[24:27], s57 offen offset:512 nt lds
    s_and_b32 s58, s68, 63
    v_lshl_add_u32 v12, s58, 1, v8
    v_cmp_le_u32 vcc, 43, v12
    v_add_u32 v13, 43, v12
    v_mov_b32 v14, 42
    v_cndmask_b32 v11, v12, v13, vcc
    v_cmp_le_u32 vcc, 86, v12
    v_add_u32 v13, 43, v11
    s_nop 0
    v_cndmask_b32 v11, v11, v13, vcc
    v_cndmask_b32 v14, 43, v14, vcc
    v_mad_u32_u24 v11, v14, v9, v11
    v_mad_u32_u24 v11, v11, s67, v10
    s_mov_b32 m0, s69
    s_waitcnt vmcnt(15)
    buffer_load_dwordx4 v11, s[24:27], s57 offen offset:0 nt lds
    s_add_u32 m0, m0, 768
    s_add_u32 s69, s69, 3072
    buffer_load_dwordx4 v11, s[24:27], s57 offen offset:256 nt lds
    s_add_u32 m0, m0, 768
    s_add_u32 s68, s68, 1
    buffer_load_dwordx4 v11, s[24:27], s57 offen offset:512 nt lds
    s_and_b32 s58, s68, 7
    s_cbranch_scc1 L_lvl6
    s_branch L_ldisp
L_lvl5:
    s_and_b32 s58, s68, 63
    v_lshl_add_u32 v12, s58, 1, v8
    v_cmp_le_u32 vcc, 43, v12
    v_add_u32 v13, 43, v12
    v_mov_b32 v14, 42
    v_cndmask_b32 v11, v12, v13, vcc
    v_cmp_le_u32 vcc, 86, v12
    v_add_u32 v13, 43, v11
    s_nop 0
    v_cndmask_b32 v11, v11, v13, vcc
    v_cndmask_b32 v14, 43, v14, vcc
    v_mad_u32_u24 v11, v14, v9, v11
    v_mad_u32_u24 v11, v11, s67, v10
    s_mov_b32 m0, s69
    s_waitcnt vmcnt(16)
    buffer_load_dwordx4 v11, s[24:27], s57 offen offset:0 nt lds
    s_add_u32 m0, m0, 768
    s_add_u32 s69, s69, 3072
    buffer_load_dwordx4 v11, s[24:27], s57 offen offset:256 nt lds
    s_add_u32 m0, m0, 768
    s_add_u32 s68, s68, 1
    buffer_load_dwordx4 v11, s[24:27], s57 offen offset:512 nt lds
    s_and_b32 s58, s68, 63
    v_lshl_add_u32 v12, s58, 1, v8
    v_cmp_le_u32 vcc, 43, v12
    v_add_u32 v13, 43, v12
    v_mov_b32 v14, 42
    v_cndmask_b32 v11, v12, v13, vcc
    v_cmp_le_u32 vcc, 86, v12
    v_add_u32 v13, 43, v11
    s_nop 0
    v_cndmask_b32 v11, v11, v13, vcc
    v_cndmask_b32 v14, 43, v14, vcc
    v_mad_u32_u24 v11, v14, v9, v11
    v_mad_u32_u24 v11, v11, s67, v10
    s_mov_b32 m0, s69
    s_waitcnt vmcnt(16)
    buffer_load_dwordx4 v11, s[24:27], s57 offen offset:0 nt lds
    s_add_u32 m0, m0, 768
    s_add_u32 s69, s69, 3072
    buffer_load_dwordx4 v11, s[24:27], s57 offen offset:256 nt lds
    s_add_u32 m0, m0, 768
    s_add_u32 s68, s68, 1
    buffer_load_dwordx4 v11, s[24:27], s57 offen offset:512 nt lds
    s_and_b32 s58, s68, 7
    s_cbranch_scc1 L_lvl5
    s_branch L_ldisp
L_lvl4:
    s_and_b32 s58, s68, 63
    v_lshl_add_u32 v12, s58, 1, v8
    v_cmp_le_u32 vcc, 43, v12
    v_add_u32 v13, 43, v12
    v_mov_b32 v14, 42
    v_cndmask_b32 v11, v12, v13, vcc
    v_cmp_le_u32 vcc, 86, v12
    v_add_u32 v13, 43, v11
    s_nop 0
    v_cndmask_b32 v11, v11, v13, vcc
    v_cndmask_b32 v14, 43, v14, vcc
    v_mad_u32_u24 v11, v14, v9, v11
    v_mad_u32_u24 v11, v11, s67, v10
    s_mov_b32 m0, s69
    s_waitcnt vmcnt(17)
    buffer_load_dwordx4 v11, s[24:27], s57 offen offset:0 nt lds
    s_add_u32 m0, m0, 768
    s_add_u32 s69, s69, 3072
    buffer_load_dwordx4 v11, s[24:27], s57 offen offset:256 nt lds
    s_add_u32 m0, m0, 768
    s_add_u32 s68, s68, 1
    buffer_load_dwordx4 v11, s[24:27], s57 offen offset:512 nt lds
    s_and_b32 s58, s68, 63
    v_lshl_add_u32 v12, s58, 1, v8
    v_cmp_le_u32 vcc, 43, v12
    v_add_u32 v13, 43, v12
    v_mov_b32 v14, 42
    v_cndmask_b32 v11, v12, v13, vcc
    v_cmp_le_u32 vcc, 86, v12
    v_add_u32 v13, 43, v11
    s_nop 0
    v_cndmask_b32 v11, v11, v13, vcc
    v_cndmask_b32 v14, 43, v14, vcc
    v_mad_u32_u24 v11, v14, v9, v11
    v_mad_u32_u24 v11, v11, s67, v10
    s_mov_b32 m0, s69
    s_waitcnt vmcnt(17)
    buffer_load_dwordx4 v11, s[24:27], s57 offen offset:0 nt lds
    s_add_u32 m0, m0, 768
    s_add_u32 s69, s69, 3072
    buffer_load_dwordx4 v11, s[24:27], s57 offen offset:256 nt lds
    s_add_u32 m0, m0, 768
    s_add_u32 s68, s68, 1
    buffer_load_dwordx4 v11, s[24:27], s57 offen offset:512 nt lds
    s_and_b32 s58, s68, 7
    s_cbranch_scc1 L_lvl4
    s_branch L_ldisp
L_lvl3:
    s_and_b32 s58, s68, 63
    v_lshl_add_u32 v12, s58, 1, v8
    v_cmp_le_u32 vcc, 43, v12
    v_add_u32 v13, 43, v12
    v_mov_b32 v14, 42
    v_cndmask_b32 v11, v12, v13, vcc
    v_cmp_le_u32 vcc, 86, v12
    v_add_u32 v13, 43, v11
    s_nop 0
    v_cndmask_b32 v11, v11, v13, vcc
    v_cndmask_b32 v14, 43, v14, vcc
    v_mad_u32_u24 v11, v14, v9, v11
    v_mad_u32_u24 v11, v11, s67, v10
    s_mov_b32 m0, s69
    s_waitcnt vmcnt(18)
    buffer_load_dwordx4 v11, s[24:27], s57 offen offset:0 nt lds
    s_add_u32 m0, m0, 768
    s_add_u32 s69, s69, 3072
    buffer_load_dwordx4 v11, s[24:27], s57 offen offset:256 nt lds
    s_add_u32 m0, m0, 768
    s_add_u32 s68, s68, 1
    buffer_load_dwordx4 v11, s[24:27], s57 offen offset:512 nt lds
    s_and_b32 s58, s68, 63
    v_lshl_add_u32 v12, s58, 1, v8
    v_cmp_le_u32 vcc, 43, v12
    v_add_u32 v13, 43, v12
    v_mov_b32 v14, 42
    v_cndmask_b32 v11, v12, v13, vcc
    v_cmp_le_u32 vcc, 86, v12
    v_add_u32 v13, 43, v11
    s_nop 0
    v_cndmask_b32 v11, v11, v13, vcc
    v_cndmask_b32 v14, 43, v14, vcc
    v_mad_u32_u24 v11, v14, v9, v11
    v_mad_u32_u24 v11, v11, s67, v10
    s_mov_b32 m0, s69
    s_waitcnt vmcnt(18)
    buffer_load_dwordx4 v11, s[24:27], s57 offen offset:0 nt lds
    s_add_u32 m0, m0, 768
    s_add_u32 s69, s69, 3072
    buffer_load_dwordx4 v11, s[24:27], s57 offen offset:256 nt lds
    s_add_u32 m0, m0, 768
    s_add_u32 s68, s68, 1
    buffer_load_dwordx4 v11, s[24:27], s57 offen offset:512 nt lds
    s_and_b32 s58, s68, 7
    s_cbranch_scc1 L_lvl3
    s_branch L_ldisp
L_lvl2:
    s_and_b32 s58, s68, 63
    v_lshl_add_u32 v12, s58, 1, v8
    v_cmp_le_u32 vcc, 43, v12
    v_add_u32 v13, 43, v12
    v_mov_b32 v14, 42
    v_cndmask_b32 v11, v12, v13, vcc
    v_cmp_le_u32 vcc, 86, v12
    v_add_u32 v13, 43, v11
    s_nop 0
    v_cndmask_b32 v11, v11, v13, vcc
    v_cndmask_b32 v14, 43, v14, vcc
    v_mad_u32_u24 v11, v14, v9, v11
    v_mad_u32_u24 v11, v11, s67, v10
    s_mov_b32 m0, s69
    s_waitcnt vmcnt(19)
    buffer_load_dwordx4 v11, s[24:27], s57 offen offset:0 nt lds
    s_add_u32 m0, m0, 768
    s_add_u32 s69, s69, 3072
    buffer_load_dwordx4 v11, s[24:27], s57 offen offset:256 nt lds
    s_add_u32 m0, m0, 768
    s_add_u32 s68, s68, 1
    buffer_load_dwordx4 v11, s[24:27], s57 offen offset:512 nt lds
    s_and_b32 s58, s68, 63
    v_lshl_add_u32 v12, s58, 1, v8
    v_cmp_le_u32 vcc, 43, v12
    v_add_u32 v13, 43, v12
    v_mov_b32 v14, 42
    v_cndmask_b32 v11, v12, v13, vcc
    v_cmp_le_u32 vcc, 86, v12
    v_add_u32 v13, 43, v11
    s_nop 0
    v_cndmask_b32 v11, v11, v13, vcc
    v_cndmask_b32 v14, 43, v14, vcc
    v_mad_u32_u24 v11, v14, v9, v11
    v_mad_u32_u24 v11, v11, s67, v10
    s_mov_b32 m0, s69
    s_waitcnt vmcnt(19)
    buffer_load_dwordx4 v11, s[24:27], s57 offen offset:0 nt lds
    s_add_u32 m0, m0, 768
    s_add_u32 s69, s69, 3072
    buffer_load_dwordx4 v11, s[24:27], s57 offen offset:256 nt lds
    s_add_u32 m0, m0, 768
    s_add_u32 s68, s68, 1
    buffer_load_dwordx4 v11, s[24:27], s57 offen offset:512 nt lds
    s_and_b32 s58, s68, 7
    s_cbranch_scc1 L_lvl2
    s_branch L_ldisp
L_lvl1:
    s_and_b32 s58, s68, 63
    v_lshl_add_u32 v12, s58, 1, v8
    v_cmp_le_u32 vcc, 43, v12
    v_add_u32 v13, 43, v12
    v_mov_b32 v14, 42
    v_cndmask_b32 v11, v12, v13, vcc
    v_cmp_le_u32 vcc, 86, v12
    v_add_u32 v13, 43, v11
    s_nop 0
    v_cndmask_b32 v11, v11, v13, vcc
    v_cndmask_b32 v14, 43, v14, vcc
    v_mad_u32_u24 v11, v14, v9, v11
    v_mad_u32_u24 v11, v11, s67, v10
    s_mov_b32 m0, s69
    s_waitcnt vmcnt(20)
    buffer_load_dwordx4 v11, s[24:27], s57 offen offset:0 nt lds
    s_add_u32 m0, m0, 768
    s_add_u32 s69, s69, 3072
    buffer_load_dwordx4 v11, s[24:27], s57 offen offset:256 nt lds
    s_add_u32 m0, m0, 768
    s_add_u32 s68, s68, 1
    buffer_load_dwordx4 v11, s[24:27], s57 offen offset:512 nt lds
    s_and_b32 s58, s68, 63
    v_lshl_add_u32 v12, s58, 1, v8
    v_cmp_le_u32 vcc, 43, v12
    v_add_u32 v13, 43, v12
    v_mov_b32 v14, 42
    v_cndmask_b32 v11, v12, v13, vcc
    v_cmp_le_u32 vcc, 86, v12
    v_add_u32 v13, 43, v11
    s_nop 0
    v_cndmask_b32 v11, v11, v13, vcc
    v_cndmask_b32 v14, 43, v14, vcc
    v_mad_u32_u24 v11, v14, v9, v11
    v_mad_u32_u24 v11, v11, s67, v10
    s_mov_b32 m0, s69
    s_waitcnt vmcnt(20)
    buffer_load_dwordx4 v11, s[24:27], s57 offen offset:0 nt lds
    s_add_u32 m0, m0, 768
    s_add_u32 s69, s69, 3072
    buffer_load_dwordx4 v11, s[24:27], s57 offen offset:256 nt lds
    s_add_u32 m0, m0, 768
    s_add_u32 s68, s68, 1
    buffer_load_dwordx4 v11, s[24:27], s57 offen offset:512 nt lds
    s_and_b32 s58, s68, 7
    s_cbranch_scc1 L_lvl1
    s_branch L_ldisp
L_lvl0:
    s_and_b32 s58, s68, 63
    v_lshl_add_u32 v12, s58, 1, v8
    v_cmp_le_u32 vcc, 43, v12
    v_add_u32 v13, 43, v12
    v_mov_b32 v14, 42
    v_cndmask_b32 v11, v12, v13, vcc
    v_cmp_le_u32 vcc, 86, v12
    v_add_u32 v13, 43, v11
    s_nop 0
    v_cndmask_b32 v11, v11, v13, vcc
    v_cndmask_b32 v14, 43, v14, vcc
    v_mad_u32_u24 v11, v14, v9, v11
    v_mad_u32_u24 v11, v11, s67, v10
    s_mov_b32 m0, s69
    s_waitcnt vmcnt(21)
    buffer_load_dwordx4 v11, s[24:27], s57 offen offset:0 nt lds
    s_add_u32 m0, m0, 768
    s_add_u32 s69, s69, 3072
    buffer_load_dwordx4 v11, s[24:27], s57 offen offset:256 nt lds
    s_add_u32 m0, m0, 768
    s_add_u32 s68, s68, 1
    buffer_load_dwordx4 v11, s[24:27], s57 offen offset:512 nt lds
    s_and_b32 s58, s68, 63
    v_lshl_add_u32 v12, s58, 1, v8
    v_cmp_le_u32 vcc, 43, v12
    v_add_u32 v13, 43, v12
    v_mov_b32 v14, 42
    v_cndmask_b32 v11, v12, v13, vcc
    v_cmp_le_u32 vcc, 86, v12
    v_add_u32 v13, 43, v11
    s_nop 0
    v_cndmask_b32 v11, v11, v13, vcc
    v_cndmask_b32 v14, 43, v14, vcc
    v_mad_u32_u24 v11, v14, v9, v11
    v_mad_u32_u24 v11, v11, s67, v10
    s_mov_b32 m0, s69
    s_waitcnt vmcnt(21)
    buffer_load_dwordx4 v11, s[24:27], s57 offen offset:0 nt lds
    s_add_u32 m0, m0, 768
    s_add_u32 s69, s69, 3072
    buffer_load_dwordx4 v11, s[24:27], s57 offen offset:256 nt lds
    s_add_u32 m0, m0, 768
    s_add_u32 s68, s68, 1
    buffer_load_dwordx4 v11, s[24:27], s57 offen offset:512 nt lds
    s_and_b32 s58, s68, 7
    s_cbranch_scc1 L_lvl0
    s_branch L_ldisp
L_lev0:
    s_cmp_eq_u32 s68, 2048
    s_cbranch_scc1 L_ldone
    s_memrealtime s[96:97]
    s_lshr_b32 s58, s68, 6
    s_add_u32 s58, s58, s72
    s_and_b32 s58, s58, 15
    s_mul_i32 s57, s58, 196608
    s_add_u32 s57, s57, s73
    s_cmp_eq_u32 s68, 1024
    s_cbranch_scc0 L_lsel
    s_mov_b32 s24, s8
    s_and_b32 s25, s9, 0xffff
    v_bfe_u32 v8, v1, 4, 1
    v_lshrrev_b32 v9, 5, v1
    v_and_b32 v10, 15, v1
    v_lshlrev_b32 v10, 4, v10
    s_branch L_lsel
L_lfirst:
    s_cmp_eq_u32 s68, 8
    s_cbranch_scc1 L_lnobar
    s_barrier
    s_branch L_lbar
L_lev1:
    s_cmp_lt_u32 s2, 8
    s_cbranch_scc0 L_lsel
    s_waitcnt lgkmcnt(0)
    v_mov_b32 v17, s96
    s_mov_b64 exec, 1
    buffer_store_dword v17, v16, s[52:55], s71 offen sc1
    s_mov_b64 exec, -1
    s_branch L_lsel
L_lev6:
    s_load_dwordx8 s[84:91], s[98:99], s71
    s_add_u32 s71, s71, 256
    s_branch L_lsel
L_lev7:
    s_waitcnt lgkmcnt(0)
    s_mov_b32 s58, 0
    s_sub_i32 s59, s84, s96
    s_add_i32 s60, s59, 5000
    s_cmp_lt_u32 s60, 10000
    s_cselect_b32 s59, s59, 450
    s_add_i32 s58, s58, s59
    s_sub_i32 s59, s85, s96
    s_add_i32 s60, s59, 5000
    s_cmp_lt_u32 s60, 10000
    s_cselect_b32 s59, s59, 450
    s_add_i32 s58, s58, s59
    s_sub_i32 s59, s86, s96
    s_add_i32 s60, s59, 5000
    s_cmp_lt_u32 s60, 10000
    s_cselect_b32 s59, s59, 450
    s_add_i32 s58, s58, s59
    s_sub_i32 s59, s87, s96
    s_add_i32 s60, s59, 5000
    s_cmp_lt_u32 s60, 10000
    s_cselect_b32 s59, s59, 450
    s_add_i32 s58, s58, s59
    s_sub_i32 s59, s88, s96
    s_add_i32 s60, s59, 5000
    s_cmp_lt_u32 s60, 10000
    s_cselect_b32 s59, s59, 450
    s_add_i32 s58, s58, s59
    s_sub_i32 s59, s89, s96
    s_add_i32 s60, s59, 5000
    s_cmp_lt_u32 s60, 10000
    s_cselect_b32 s59, s59, 450
    s_add_i32 s58, s58, s59
    s_sub_i32 s59, s90, s96
    s_add_i32 s60, s59, 5000
    s_cmp_lt_u32 s60, 10000
    s_cselect_b32 s59, s59, 450
    s_add_i32 s58, s58, s59
    s_sub_i32 s59, s91, s96
    s_add_i32 s60, s59, 5000
    s_cmp_lt_u32 s60, 10000
    s_cselect_b32 s59, s59, 450
    s_add_i32 s58, s58, s59
    s_mul_i32 s58, s58, 3
    s_add_i32 s58, s58, 14336
    s_ashr_i32 s58, s58, 12
    s_max_i32 s58, s58, 0
    s_min_i32 s70, s58, 6
    s_branch L_lsel
L_ldone:
    s_waitcnt vmcnt(0)
    s_barrier
    s_endpgm
L_consumer:
    v_lshrrev_b32 v3, 2, v1
    v_lshlrev_b32 v3, 3, v3
    v_and_b32 v4, 3, v1
    v_mul_u32_u24 v5, 384, v4
    v_add_u32 v3, v3, v5
    s_mul_i32 s59, s2, 1536
    v_lshlrev_b32 v6, 4, v1
    s_mul_i32 s57, s2, 24576
    s_mul_i32 s63, s56, 3072
    s_add_u32 s63, s63, 76800
    s_add_u32 s61, s56, s72
    s_waitcnt lgkmcnt(0)
    s_mov_b32 s32, s12
    s_and_b32 s33, s13, 0xffff
    s_mov_b32 s34, 6291456
    s_mov_b32 s35, 0x20000
    s_mov_b32 s28, s10
    s_and_b32 s29, s11, 0xffff
    s_mov_b32 s30, 6291456
    s_mov_b32 s31, 0x20000
    s_mov_b32 exec_hi, 0xffff
    s_and_b32 s58, s61, 15
    s_mul_i32 s58, s58, 1536
    s_add_u32 m0, s63, 0
    s_add_u32 s58, s58, s57
    buffer_load_dwordx4 v6, s[32:35], s58 offen nt lds
    buffer_load_dwordx4 v6, s[32:35], s58 offen offset:768 nt lds
    s_add_u32 m0, m0, 1536
    s_add_u32 s61, s61, 4
    buffer_load_dwordx4 v6, s[28:31], s58 offen nt lds
    buffer_load_dwordx4 v6, s[28:31], s58 offen offset:768 nt lds
    s_and_b32 s58, s61, 15
    s_mul_i32 s58, s58, 1536
    s_add_u32 m0, s63, 12288
    s_add_u32 s58, s58, s57
    buffer_load_dwordx4 v6, s[32:35], s58 offen nt lds
    buffer_load_dwordx4 v6, s[32:35], s58 offen offset:768 nt lds
    s_add_u32 m0, m0, 1536
    s_add_u32 s61, s61, 4
    buffer_load_dwordx4 v6, s[28:31], s58 offen nt lds
    buffer_load_dwordx4 v6, s[28:31], s58 offen offset:768 nt lds
    s_and_b32 s58, s61, 15
    s_mul_i32 s58, s58, 1536
    s_add_u32 m0, s63, 24576
    s_add_u32 s58, s58, s57
    buffer_load_dwordx4 v6, s[32:35], s58 offen nt lds
    buffer_load_dwordx4 v6, s[32:35], s58 offen offset:768 nt lds
    s_add_u32 m0, m0, 1536
    s_add_u32 s61, s61, 4
    buffer_load_dwordx4 v6, s[28:31], s58 offen nt lds
    buffer_load_dwordx4 v6, s[28:31], s58 offen offset:768 nt lds
    s_and_b32 s58, s61, 15
    s_mul_i32 s58, s58, 1536
    s_add_u32 m0, s63, 36864
    s_add_u32 s58, s58, s57
    buffer_load_dwordx4 v6, s[32:35], s58 offen nt lds
    buffer_load_dwordx4 v6, s[32:35], s58 offen offset:768 nt lds
    s_add_u32 m0, m0, 1536
    s_add_u32 s61, s61, 4
    buffer_load_dwordx4 v6, s[28:31], s58 offen nt lds
    buffer_load_dwordx4 v6, s[28:31], s58 offen offset:768 nt lds
    s_mov_b32 exec_hi, -1
    s_mov_b32 s36, s14
    s_and_b32 s37, s15, 0xffff
    s_mov_b32 s38, 2097152
    s_mov_b32 s39, 0x20000
    s_mov_b32 s40, s16
    s_and_b32 s41, s17, 0xffff
    s_mov_b32 s42, 2097152
    s_mov_b32 s43, 0x20000
    s_lshl_b32 s60, s56, 11
    s_lshl_b32 s58, s2, 13
    s_add_u32 m0, s60, 125952
    s_add_u32 s58, s58, s60
    buffer_load_dwordx4 v6, s[36:39], s58 offen nt lds
    buffer_load_dwordx4 v6, s[36:39], s58 offen offset:1024 nt lds
    s_add_u32 m0, m0, 8192
    s_nop 0
    buffer_load_dwordx4 v6, s[40:43], s58 offen nt lds
    buffer_load_dwordx4 v6, s[40:43], s58 offen offset:1024 nt lds
    s_mov_b32 s44, s4
    s_and_b32 s45, s5, 0xffff
    s_mov_b32 s46, 393216
    s_mov_b32 s47, 0x20000
    buffer_load_dwordx2 v[152:153], v3, s[44:47], s59 offen offset:0
    buffer_load_dwordx2 v[154:155], v3, s[44:47], s59 offen offset:128
    buffer_load_dwordx2 v[156:157], v3, s[44:47], s59 offen offset:256
    s_mov_b32 s48, s18
    s_and_b32 s49, s19, 0xffff
    s_mov_b32 s50, 393216
    s_mov_b32 s51, 0x20000
    s_mov_b32 s64, 0x3fb8aa3b
    s_mov_b32 s65, 0x3d93cd3a
    s_mov_b32 s66, 0xffff0000
    v_bfe_u32 v36, v1, 2, 1
    v_lshl_add_u32 v36, v2, 2, v36
    v_bfe_u32 v37, v1, 3, 1
    v_lshrrev_b32 v38, 4, v1
    v_lshl_add_u32 v38, v38, 2, v4
    v_lshlrev_b32 v38, 3, v38
    v_add_u32 v38, 73728, v38
    s_movk_i32 s58, 384
    v_add_u32 v3, 0, v36
    v_cmp_le_u32 vcc, 43, v3
    v_add_u32 v5, 43, v3
    v_mov_b32 v6, 42
    v_cndmask_b32 v17, v3, v5, vcc
    v_cmp_le_u32 vcc, 86, v3
    v_add_u32 v5, 43, v17
    s_nop 0
    v_cndmask_b32 v17, v17, v5, vcc
    v_cndmask_b32 v6, 43, v6, vcc
    v_mad_u32_u24 v17, v6, v37, v17
    v_lshrrev_b32 v17, 6, v17
    v_mad_u32_u24 v17, v17, s58, v38
    v_add_u32 v3, 2, v36
    v_cmp_le_u32 vcc, 43, v3
    v_add_u32 v5, 43, v3
    v_mov_b32 v6, 42
    v_cndmask_b32 v18, v3, v5, vcc
    v_cmp_le_u32 vcc, 86, v3
    v_add_u32 v5, 43, v18
    s_nop 0
    v_cndmask_b32 v18, v18, v5, vcc
    v_cndmask_b32 v6, 43, v6, vcc
    v_mad_u32_u24 v18, v6, v37, v18
    v_lshrrev_b32 v18, 6, v18
    v_mad_u32_u24 v18, v18, s58, v38
    v_add_u32 v3, 16, v36
    v_cmp_le_u32 vcc, 43, v3
    v_add_u32 v5, 43, v3
    v_mov_b32 v6, 42
    v_cndmask_b32 v19, v3, v5, vcc
    v_cmp_le_u32 vcc, 86, v3
    v_add_u32 v5, 43, v19
    s_nop 0
    v_cndmask_b32 v19, v19, v5, vcc
    v_cndmask_b32 v6, 43, v6, vcc
    v_mad_u32_u24 v19, v6, v37, v19
    v_lshrrev_b32 v19, 6, v19
    v_mad_u32_u24 v19, v19, s58, v38
    v_add_u32 v3, 18, v36
    v_cmp_le_u32 vcc, 43, v3
    v_add_u32 v5, 43, v3
    v_mov_b32 v6, 42
    v_cndmask_b32 v20, v3, v5, vcc
    v_cmp_le_u32 vcc, 86, v3
    v_add_u32 v5, 43, v20
    s_nop 0
    v_cndmask_b32 v20, v20, v5, vcc
    v_cndmask_b32 v6, 43, v6, vcc
    v_mad_u32_u24 v20, v6, v37, v20
    v_lshrrev_b32 v20, 6, v20
    v_mad_u32_u24 v20, v20, s58, v38
    v_add_u32 v3, 32, v36
    v_cmp_le_u32 vcc, 43, v3
    v_add_u32 v5, 43, v3
    v_mov_b32 v6, 42
    v_cndmask_b32 v21, v3, v5, vcc
    v_cmp_le_u32 vcc, 86, v3
    v_add_u32 v5, 43, v21
    s_nop 0
    v_cndmask_b32 v21, v21, v5, vcc
    v_cndmask_b32 v6, 43, v6, vcc
    v_mad_u32_u24 v21, v6, v37, v21
    v_lshrrev_b32 v21, 6, v21
    v_mad_u32_u24 v21, v21, s58, v38
    v_add_u32 v3, 34, v36
    v_cmp_le_u32 vcc, 43, v3
    v_add_u32 v5, 43, v3
    v_mov_b32 v6, 42
    v_cndmask_b32 v22, v3, v5, vcc
    v_cmp_le_u32 vcc, 86, v3
    v_add_u32 v5, 43, v22
    s_nop 0
    v_cndmask_b32 v22, v22, v5, vcc
    v_cndmask_b32 v6, 43, v6, vcc
    v_mad_u32_u24 v22, v6, v37, v22
    v_lshrrev_b32 v22, 6, v22
    v_mad_u32_u24 v22, v22, s58, v38
    v_add_u32 v3, 48, v36
    v_cmp_le_u32 vcc, 43, v3
    v_add_u32 v5, 43, v3
    v_mov_b32 v6, 42
    v_cndmask_b32 v23, v3, v5, vcc
    v_cmp_le_u32 vcc, 86, v3
    v_add_u32 v5, 43, v23
    s_nop 0
    v_cndmask_b32 v23, v23, v5, vcc
    v_cndmask_b32 v6, 43, v6, vcc
    v_mad_u32_u24 v23, v6, v37, v23
    v_lshrrev_b32 v23, 6, v23
    v_mad_u32_u24 v23, v23, s58, v38
    v_add_u32 v3, 50, v36
    v_cmp_le_u32 vcc, 43, v3
    v_add_u32 v5, 43, v3
    v_mov_b32 v6, 42
    v_cndmask_b32 v24, v3, v5, vcc
    v_cmp_le_u32 vcc, 86, v3
    v_add_u32 v5, 43, v24
    s_nop 0
    v_cndmask_b32 v24, v24, v5, vcc
    v_cndmask_b32 v6, 43, v6, vcc
    v_mad_u32_u24 v24, v6, v37, v24
    v_lshrrev_b32 v24, 6, v24
    v_mad_u32_u24 v24, v24, s58, v38
    v_add_u32 v3, 64, v36
    v_cmp_le_u32 vcc, 43, v3
    v_add_u32 v5, 43, v3
    v_mov_b32 v6, 42
    v_cndmask_b32 v25, v3, v5, vcc
    v_cmp_le_u32 vcc, 86, v3
    v_add_u32 v5, 43, v25
    s_nop 0
    v_cndmask_b32 v25, v25, v5, vcc
    v_cndmask_b32 v6, 43, v6, vcc
    v_mad_u32_u24 v25, v6, v37, v25
    v_lshrrev_b32 v25, 6, v25
    v_mad_u32_u24 v25, v25, s58, v38
    v_add_u32 v3, 66, v36
    v_cmp_le_u32 vcc, 43, v3
    v_add_u32 v5, 43, v3
    v_mov_b32 v6, 42
    v_cndmask_b32 v26, v3, v5, vcc
    v_cmp_le_u32 vcc, 86, v3
    v_add_u32 v5, 43, v26
    s_nop 0
    v_cndmask_b32 v26, v26, v5, vcc
    v_cndmask_b32 v6, 43, v6, vcc
    v_mad_u32_u24 v26, v6, v37, v26
    v_lshrrev_b32 v26, 6, v26
    v_mad_u32_u24 v26, v26, s58, v38
    v_add_u32 v3, 80, v36
    v_cmp_le_u32 vcc, 43, v3
    v_add_u32 v5, 43, v3
    v_mov_b32 v6, 42
    v_cndmask_b32 v27, v3, v5, vcc
    v_cmp_le_u32 vcc, 86, v3
    v_add_u32 v5, 43, v27
    s_nop 0
    v_cndmask_b32 v27, v27, v5, vcc
    v_cndmask_b32 v6, 43, v6, vcc
    v_mad_u32_u24 v27, v6, v37, v27
    v_lshrrev_b32 v27, 6, v27
    v_mad_u32_u24 v27, v27, s58, v38
    v_add_u32 v3, 82, v36
    v_cmp_le_u32 vcc, 43, v3
    v_add_u32 v5, 43, v3
    v_mov_b32 v6, 42
    v_cndmask_b32 v28, v3, v5, vcc
    v_cmp_le_u32 vcc, 86, v3
    v_add_u32 v5, 43, v28
    s_nop 0
    v_cndmask_b32 v28, v28, v5, vcc
    v_cndmask_b32 v6, 43, v6, vcc
    v_mad_u32_u24 v28, v6, v37, v28
    v_lshrrev_b32 v28, 6, v28
    v_mad_u32_u24 v28, v28, s58, v38
    v_add_u32 v3, 96, v36
    v_cmp_le_u32 vcc, 43, v3
    v_add_u32 v5, 43, v3
    v_mov_b32 v6, 42
    v_cndmask_b32 v29, v3, v5, vcc
    v_cmp_le_u32 vcc, 86, v3
    v_add_u32 v5, 43, v29
    s_nop 0
    v_cndmask_b32 v29, v29, v5, vcc
    v_cndmask_b32 v6, 43, v6, vcc
    v_mad_u32_u24 v29, v6, v37, v29
    v_lshrrev_b32 v29, 6, v29
    v_mad_u32_u24 v29, v29, s58, v38
    v_add_u32 v3, 98, v36
    v_cmp_le_u32 vcc, 43, v3
    v_add_u32 v5, 43, v3
    v_mov_b32 v6, 42
    v_cndmask_b32 v30, v3, v5, vcc
    v_cmp_le_u32 vcc, 86, v3
    v_add_u32 v5, 43, v30
    s_nop 0
    v_cndmask_b32 v30, v30, v5, vcc
    v_cndmask_b32 v6, 43, v6, vcc
    v_mad_u32_u24 v30, v6, v37, v30
    v_lshrrev_b32 v30, 6, v30
    v_mad_u32_u24 v30, v30, s58, v38
    v_add_u32 v3, 112, v36
    v_cmp_le_u32 vcc, 43, v3
    v_add_u32 v5, 43, v3
    v_mov_b32 v6, 42
    v_cndmask_b32 v31, v3, v5, vcc
    v_cmp_le_u32 vcc, 86, v3
    v_add_u32 v5, 43, v31
    s_nop 0
    v_cndmask_b32 v31, v31, v5, vcc
    v_cndmask_b32 v6, 43, v6, vcc
    v_mad_u32_u24 v31, v6, v37, v31
    v_lshrrev_b32 v31, 6, v31
    v_mad_u32_u24 v31, v31, s58, v38
    v_add_u32 v3, 114, v36
    v_cmp_le_u32 vcc, 43, v3
    v_add_u32 v5, 43, v3
    v_mov_b32 v6, 42
    v_cndmask_b32 v32, v3, v5, vcc
    v_cmp_le_u32 vcc, 86, v3
    v_add_u32 v5, 43, v32
    s_nop 0
    v_cndmask_b32 v32, v32, v5, vcc
    v_cndmask_b32 v6, 43, v6, vcc
    v_mad_u32_u24 v32, v6, v37, v32
    v_lshrrev_b32 v32, 6, v32
    v_mad_u32_u24 v32, v32, s58, v38
    v_bfe_u32 v36, v1, 4, 1
    v_lshl_add_u32 v36, v2, 2, v36
    v_bfe_u32 v3, v1, 2, 2
    v_lshl_add_u32 v36, v3, 4, v36
    v_lshrrev_b32 v37, 5, v1
    s_mov_b32 s58, 125952
    v_add_u32 v3, 0, v36
    v_cmp_le_u32 vcc, 43, v3
    v_add_u32 v5, 43, v3
    v_mov_b32 v6, 42
    v_cndmask_b32 v7, v3, v5, vcc
    v_cmp_le_u32 vcc, 86, v3
    v_add_u32 v5, 43, v7
    s_nop 0
    v_cndmask_b32 v7, v7, v5, vcc
    v_cndmask_b32 v6, 43, v6, vcc
    v_mad_u32_u24 v7, v6, v37, v7
    v_lshl_add_u32 v7, v7, 1, s58
    v_add_u32 v3, 2, v36
    v_cmp_le_u32 vcc, 43, v3
    v_add_u32 v5, 43, v3
    v_mov_b32 v6, 42
    v_cndmask_b32 v8, v3, v5, vcc
    v_cmp_le_u32 vcc, 86, v3
    v_add_u32 v5, 43, v8
    s_nop 0
    v_cndmask_b32 v8, v8, v5, vcc
    v_cndmask_b32 v6, 43, v6, vcc
    v_mad_u32_u24 v8, v6, v37, v8
    v_lshl_add_u32 v8, v8, 1, s58
    v_add_u32 v3, 64, v36
    v_cmp_le_u32 vcc, 43, v3
    v_add_u32 v5, 43, v3
    v_mov_b32 v6, 42
    v_cndmask_b32 v9, v3, v5, vcc
    v_cmp_le_u32 vcc, 86, v3
    v_add_u32 v5, 43, v9
    s_nop 0
    v_cndmask_b32 v9, v9, v5, vcc
    v_cndmask_b32 v6, 43, v6, vcc
    v_mad_u32_u24 v9, v6, v37, v9
    v_lshl_add_u32 v9, v9, 1, s58
    v_add_u32 v3, 66, v36
    v_cmp_le_u32 vcc, 43, v3
    v_add_u32 v5, 43, v3
    v_mov_b32 v6, 42
    v_cndmask_b32 v10, v3, v5, vcc
    v_cmp_le_u32 vcc, 86, v3
    v_add_u32 v5, 43, v10
    s_nop 0
    v_cndmask_b32 v10, v10, v5, vcc
    v_cndmask_b32 v6, 43, v6, vcc
    v_mad_u32_u24 v10, v6, v37, v10
    v_lshl_add_u32 v10, v10, 1, s58
    v_lshlrev_b32 v11, 2, v1
    v_lshl_add_u32 v11, v2, 9, v11
    v_add_u32 v11, 73728, v11
    v_mul_u32_u24 v12, 6144, v2
    v_lshl_add_u32 v12, v1, 4, v12
    v_mov_b32 v14, 0xff800000
    s_mov_b32 s61, 0
    s_mov_b32 s62, 0
    s_movk_i32 s63, 3072
    s_waitcnt vmcnt(0)
    s_barrier
    v_add_u32 v33, s63, v17
    v_add_u32 v34, s63, v18
    ds_read_b64 v[108:109], v33 offset:0
    ds_read_b64 v[110:111], v33 offset:1536
    ds_read_b64 v[112:113], v33 offset:128
    ds_read_b64 v[114:115], v33 offset:1664
    ds_read_b64 v[116:117], v33 offset:256
    ds_read_b64 v[118:119], v33 offset:1792
    ds_read_b64 v[120:121], v34 offset:0
    ds_read_b64 v[122:123], v34 offset:1536
    ds_read_b64 v[124:125], v34 offset:128
    ds_read_b64 v[126:127], v34 offset:1664
    ds_read_b64 v[128:129], v34 offset:256
    ds_read_b64 v[130:131], v34 offset:1792
    s_waitcnt lgkmcnt(0)
    v_lshlrev_b32 v60, 16, v108
    v_and_b32 v61, s66, v108
    v_lshlrev_b32 v62, 16, v109
    v_and_b32 v63, s66, v109
    v_lshlrev_b32 v84, 16, v110
    v_and_b32 v85, s66, v110
    v_lshlrev_b32 v86, 16, v111
    v_and_b32 v87, s66, v111
    v_lshlrev_b32 v64, 16, v112
    v_and_b32 v65, s66, v112
    v_lshlrev_b32 v66, 16, v113
    v_and_b32 v67, s66, v113
    v_lshlrev_b32 v88, 16, v114
    v_and_b32 v89, s66, v114
    v_lshlrev_b32 v90, 16, v115
    v_and_b32 v91, s66, v115
    v_lshlrev_b32 v68, 16, v116
    v_and_b32 v69, s66, v116
    v_lshlrev_b32 v70, 16, v117
    v_and_b32 v71, s66, v117
    v_lshlrev_b32 v92, 16, v118
    v_and_b32 v93, s66, v118
    v_lshlrev_b32 v94, 16, v119
    v_and_b32 v95, s66, v119
    v_lshlrev_b32 v72, 16, v120
    v_and_b32 v73, s66, v120
    v_lshlrev_b32 v74, 16, v121
    v_and_b32 v75, s66, v121
    v_lshlrev_b32 v96, 16, v122
    v_and_b32 v97, s66, v122
    v_lshlrev_b32 v98, 16, v123
    v_and_b32 v99, s66, v123
    v_lshlrev_b32 v76, 16, v124
    v_and_b32 v77, s66, v124
    v_lshlrev_b32 v78, 16, v125
    v_and_b32 v79, s66, v125
    v_lshlrev_b32 v100, 16, v126
    v_and_b32 v101, s66, v126
    v_lshlrev_b32 v102, 16, v127
    v_and_b32 v103, s66, v127
    v_lshlrev_b32 v80, 16, v128
    v_and_b32 v81, s66, v128
    v_lshlrev_b32 v82, 16, v129
    v_and_b32 v83, s66, v129
    v_lshlrev_b32 v104, 16, v130
    v_and_b32 v105, s66, v130
    v_lshlrev_b32 v106, 16, v131
    v_and_b32 v107, s66, v131
L_kblk:
    v_add_u32 v13, s62, v12
    s_add_u32 s62, s62, 24576
    s_cmp_eq_u32 s62, 73728
    s_cselect_b32 s62, 0, s62
    s_barrier
    ds_read_b128 v[36:39], v13 offset:0
    ds_read_b128 v[40:43], v13 offset:1024
    ds_read_b128 v[44:47], v13 offset:2048
    ds_read_b128 v[48:51], v13 offset:3072
    ds_read_b128 v[52:55], v13 offset:4096
    ds_read_b128 v[56:59], v13 offset:5120
    s_waitcnt lgkmcnt(3)
    v_cvt_f32_i32 v36, v36
    v_cvt_f32_i32 v37, v37
    v_cvt_f32_i32 v38, v38
    v_cvt_f32_i32 v39, v39
    v_cvt_f32_i32 v40, v40
    v_cvt_f32_i32 v41, v41
    v_cvt_f32_i32 v42, v42
    v_cvt_f32_i32 v43, v43
    v_cvt_f32_i32 v44, v44
    v_cvt_f32_i32 v45, v45
    v_cvt_f32_i32 v46, v46
    v_cvt_f32_i32 v47, v47
    v_sub_f32 v36, v36, v60
    v_sub_f32 v37, v37, v61
    v_sub_f32 v38, v38, v62
    v_sub_f32 v39, v39, v63
    v_sub_f32 v40, v40, v64
    v_sub_f32 v41, v41, v65
    v_sub_f32 v42, v42, v66
    v_sub_f32 v43, v43, v67
    v_sub_f32 v44, v44, v68
    v_sub_f32 v45, v45, v69
    v_sub_f32 v46, v46, v70
    v_sub_f32 v47, v47, v71
    v_cvt_pk_bf16_f32 v36, 0, v36
    v_cvt_pk_bf16_f32 v37, 0, v37
    v_cvt_pk_bf16_f32 v38, 0, v38
    v_cvt_pk_bf16_f32 v39, 0, v39
    v_cvt_pk_bf16_f32 v40, 0, v40
    v_cvt_pk_bf16_f32 v41, 0, v41
    v_cvt_pk_bf16_f32 v42, 0, v42
    v_cvt_pk_bf16_f32 v43, 0, v43
    v_cvt_pk_bf16_f32 v44, 0, v44
    v_cvt_pk_bf16_f32 v45, 0, v45
    v_cvt_pk_bf16_f32 v46, 0, v46
    v_cvt_pk_bf16_f32 v47, 0, v47
    v_mul_f32 v36, v36, v84
    v_mul_f32 v37, v37, v85
    v_mul_f32 v38, v38, v86
    v_mul_f32 v39, v39, v87
    v_mul_f32 v40, v40, v88
    v_mul_f32 v41, v41, v89
    v_mul_f32 v42, v42, v90
    v_mul_f32 v43, v43, v91
    v_mul_f32 v44, v44, v92
    v_mul_f32 v45, v45, v93
    v_mul_f32 v46, v46, v94
    v_mul_f32 v47, v47, v95
    v_cvt_pk_bf16_f32 v132, v36, v37
    v_cvt_pk_bf16_f32 v133, v38, v39
    v_cvt_pk_bf16_f32 v134, v40, v41
    v_cvt_pk_bf16_f32 v135, v42, v43
    v_cvt_pk_bf16_f32 v136, v44, v45
    v_cvt_pk_bf16_f32 v137, v46, v47
    v_mfma_f32_16x16x16_bf16 v[144:147], v[132:133], v[152:153], 0
    v_mfma_f32_16x16x16_bf16 v[144:147], v[134:135], v[154:155], v[144:147]
    v_mfma_f32_16x16x16_bf16 v[144:147], v[136:137], v[156:157], v[144:147]
    s_waitcnt lgkmcnt(0)
    v_cvt_f32_i32 v48, v48
    v_cvt_f32_i32 v49, v49
    v_cvt_f32_i32 v50, v50
    v_cvt_f32_i32 v51, v51
    v_cvt_f32_i32 v52, v52
    v_cvt_f32_i32 v53, v53
    v_cvt_f32_i32 v54, v54
    v_cvt_f32_i32 v55, v55
    v_cvt_f32_i32 v56, v56
    v_cvt_f32_i32 v57, v57
    v_cvt_f32_i32 v58, v58
    v_cvt_f32_i32 v59, v59
    v_sub_f32 v48, v48, v72
    v_sub_f32 v49, v49, v73
    v_sub_f32 v50, v50, v74
    v_sub_f32 v51, v51, v75
    v_sub_f32 v52, v52, v76
    v_sub_f32 v53, v53, v77
    v_sub_f32 v54, v54, v78
    v_sub_f32 v55, v55, v79
    v_sub_f32 v56, v56, v80
    v_sub_f32 v57, v57, v81
    v_sub_f32 v58, v58, v82
    v_sub_f32 v59, v59, v83
    v_cvt_pk_bf16_f32 v48, 0, v48
    v_cvt_pk_bf16_f32 v49, 0, v49
    v_cvt_pk_bf16_f32 v50, 0, v50
    v_cvt_pk_bf16_f32 v51, 0, v51
    v_cvt_pk_bf16_f32 v52, 0, v52
    v_cvt_pk_bf16_f32 v53, 0, v53
    v_cvt_pk_bf16_f32 v54, 0, v54
    v_cvt_pk_bf16_f32 v55, 0, v55
    v_cvt_pk_bf16_f32 v56, 0, v56
    v_cvt_pk_bf16_f32 v57, 0, v57
    v_cvt_pk_bf16_f32 v58, 0, v58
    v_cvt_pk_bf16_f32 v59, 0, v59
    v_mul_f32 v48, v48, v96
    v_mul_f32 v49, v49, v97
    v_mul_f32 v50, v50, v98
    v_mul_f32 v51, v51, v99
    v_mul_f32 v52, v52, v100
    v_mul_f32 v53, v53, v101
    v_mul_f32 v54, v54, v102
    v_mul_f32 v55, v55, v103
    v_mul_f32 v56, v56, v104
    v_mul_f32 v57, v57, v105
    v_mul_f32 v58, v58, v106
    v_mul_f32 v59, v59, v107
    v_cvt_pk_bf16_f32 v138, v48, v49
    v_cvt_pk_bf16_f32 v139, v50, v51
    v_add_f32_dpp v3, v145, v144 row_ror:12 row_mask:0xf bank_mask:0xf
    v_cvt_pk_bf16_f32 v140, v52, v53
    v_cvt_pk_bf16_f32 v141, v54, v55
    v_add_f32_dpp v3, v146, v3 row_ror:8 row_mask:0xf bank_mask:0xf
    v_cvt_pk_bf16_f32 v142, v56, v57
    v_cvt_pk_bf16_f32 v143, v58, v59
    v_add_f32_dpp v15, v147, v3 row_ror:4 row_mask:0xf bank_mask:0x1
    v_mfma_f32_16x16x16_bf16 v[148:151], v[138:139], v[152:153], 0
    v_mfma_f32_16x16x16_bf16 v[148:151], v[140:141], v[154:155], v[148:151]
    v_mfma_f32_16x16x16_bf16 v[148:151], v[142:143], v[156:157], v[148:151]
    v_add_u32 v33, s63, v19
    v_add_u32 v34, s63, v20
    ds_read_b64 v[108:109], v33 offset:0
    ds_read_b64 v[110:111], v33 offset:1536
    ds_read_b64 v[112:113], v33 offset:128
    ds_read_b64 v[114:115], v33 offset:1664
    ds_read_b64 v[116:117], v33 offset:256
    ds_read_b64 v[118:119], v33 offset:1792
    ds_read_b64 v[120:121], v34 offset:0
    v_add_f32_dpp v4, v149, v148 row_ror:12 row_mask:0xf bank_mask:0xf
    ds_read_b64 v[122:123], v34 offset:1536
    ds_read_b64 v[124:125], v34 offset:128
    v_add_f32_dpp v4, v150, v4 row_ror:8 row_mask:0xf bank_mask:0xf
    ds_read_b64 v[126:127], v34 offset:1664
    ds_read_b64 v[128:129], v34 offset:256
    ds_read_b64 v[130:131], v34 offset:1792
    v_add_f32_dpp v16, v151, v4 row_ror:4 row_mask:0xf bank_mask:0x1
    s_waitcnt lgkmcnt(0)
    v_lshlrev_b32 v60, 16, v108
    v_and_b32 v61, s66, v108
    v_lshlrev_b32 v62, 16, v109
    v_and_b32 v63, s66, v109
    v_lshlrev_b32 v84, 16, v110
    v_and_b32 v85, s66, v110
    v_lshlrev_b32 v86, 16, v111
    v_and_b32 v87, s66, v111
    v_lshlrev_b32 v64, 16, v112
    v_and_b32 v65, s66, v112
    v_lshlrev_b32 v66, 16, v113
    v_and_b32 v67, s66, v113
    v_lshlrev_b32 v88, 16, v114
    v_and_b32 v89, s66, v114
    v_lshlrev_b32 v90, 16, v115
    v_and_b32 v91, s66, v115
    v_lshlrev_b32 v68, 16, v116
    v_and_b32 v69, s66, v116
    v_lshlrev_b32 v70, 16, v117
    v_and_b32 v71, s66, v117
    v_lshlrev_b32 v92, 16, v118
    v_and_b32 v93, s66, v118
    v_lshlrev_b32 v94, 16, v119
    v_and_b32 v95, s66, v119
    v_lshlrev_b32 v72, 16, v120
    v_and_b32 v73, s66, v120
    v_lshlrev_b32 v74, 16, v121
    v_and_b32 v75, s66, v121
    v_lshlrev_b32 v96, 16, v122
    v_and_b32 v97, s66, v122
    v_lshlrev_b32 v98, 16, v123
    v_and_b32 v99, s66, v123
    v_lshlrev_b32 v76, 16, v124
    v_and_b32 v77, s66, v124
    v_lshlrev_b32 v78, 16, v125
    v_and_b32 v79, s66, v125
    v_lshlrev_b32 v100, 16, v126
    v_and_b32 v101, s66, v126
    v_lshlrev_b32 v102, 16, v127
    v_and_b32 v103, s66, v127
    v_lshlrev_b32 v80, 16, v128
    v_and_b32 v81, s66, v128
    v_lshlrev_b32 v82, 16, v129
    v_and_b32 v83, s66, v129
    v_lshlrev_b32 v104, 16, v130
    v_and_b32 v105, s66, v130
    v_lshlrev_b32 v106, 16, v131
    v_and_b32 v107, s66, v131
    v_add_u32 v13, s62, v12
    s_add_u32 s62, s62, 24576
    s_cmp_eq_u32 s62, 73728
    s_cselect_b32 s62, 0, s62
    s_barrier
    ds_read_b128 v[36:39], v13 offset:0
    ds_read_b128 v[40:43], v13 offset:1024
    ds_read_b128 v[44:47], v13 offset:2048
    ds_read_b128 v[48:51], v13 offset:3072
    ds_read_b128 v[52:55], v13 offset:4096
    ds_read_b128 v[56:59], v13 offset:5120
    s_waitcnt lgkmcnt(3)
    v_cvt_f32_i32 v36, v36
    v_cvt_f32_i32 v37, v37
    v_cvt_f32_i32 v38, v38
    v_cvt_f32_i32 v39, v39
    v_cvt_f32_i32 v40, v40
    v_cvt_f32_i32 v41, v41
    v_cvt_f32_i32 v42, v42
    v_cvt_f32_i32 v43, v43
    v_cvt_f32_i32 v44, v44
    v_cvt_f32_i32 v45, v45
    v_cvt_f32_i32 v46, v46
    v_cvt_f32_i32 v47, v47
    v_sub_f32 v36, v36, v60
    v_sub_f32 v37, v37, v61
    v_sub_f32 v38, v38, v62
    v_sub_f32 v39, v39, v63
    v_sub_f32 v40, v40, v64
    v_sub_f32 v41, v41, v65
    v_sub_f32 v42, v42, v66
    v_sub_f32 v43, v43, v67
    v_sub_f32 v44, v44, v68
    v_sub_f32 v45, v45, v69
    v_sub_f32 v46, v46, v70
    v_sub_f32 v47, v47, v71
    v_cvt_pk_bf16_f32 v36, 0, v36
    v_cvt_pk_bf16_f32 v37, 0, v37
    v_cvt_pk_bf16_f32 v38, 0, v38
    v_cvt_pk_bf16_f32 v39, 0, v39
    v_cvt_pk_bf16_f32 v40, 0, v40
    v_cvt_pk_bf16_f32 v41, 0, v41
    v_cvt_pk_bf16_f32 v42, 0, v42
    v_cvt_pk_bf16_f32 v43, 0, v43
    v_cvt_pk_bf16_f32 v44, 0, v44
    v_cvt_pk_bf16_f32 v45, 0, v45
    v_cvt_pk_bf16_f32 v46, 0, v46
    v_cvt_pk_bf16_f32 v47, 0, v47
    v_mul_f32 v36, v36, v84
    v_mul_f32 v37, v37, v85
    v_mul_f32 v38, v38, v86
    v_mul_f32 v39, v39, v87
    v_mul_f32 v40, v40, v88
    v_mul_f32 v41, v41, v89
    v_mul_f32 v42, v42, v90
    v_mul_f32 v43, v43, v91
    v_mul_f32 v44, v44, v92
    v_mul_f32 v45, v45, v93
    v_mul_f32 v46, v46, v94
    v_mul_f32 v47, v47, v95
    v_cvt_pk_bf16_f32 v132, v36, v37
    v_cvt_pk_bf16_f32 v133, v38, v39
    v_cvt_pk_bf16_f32 v134, v40, v41
    v_cvt_pk_bf16_f32 v135, v42, v43
    v_cvt_pk_bf16_f32 v136, v44, v45
    v_cvt_pk_bf16_f32 v137, v46, v47
    v_mfma_f32_16x16x16_bf16 v[144:147], v[132:133], v[152:153], 0
    v_mfma_f32_16x16x16_bf16 v[144:147], v[134:135], v[154:155], v[144:147]
    v_mfma_f32_16x16x16_bf16 v[144:147], v[136:137], v[156:157], v[144:147]
    s_waitcnt lgkmcnt(0)
    v_cvt_f32_i32 v48, v48
    v_cvt_f32_i32 v49, v49
    v_cvt_f32_i32 v50, v50
    v_cvt_f32_i32 v51, v51
    v_cvt_f32_i32 v52, v52
    v_cvt_f32_i32 v53, v53
    v_cvt_f32_i32 v54, v54
    v_cvt_f32_i32 v55, v55
    v_cvt_f32_i32 v56, v56
    v_cvt_f32_i32 v57, v57
    v_cvt_f32_i32 v58, v58
    v_cvt_f32_i32 v59, v59
    v_sub_f32 v48, v48, v72
    v_sub_f32 v49, v49, v73
    v_sub_f32 v50, v50, v74
    v_sub_f32 v51, v51, v75
    v_sub_f32 v52, v52, v76
    v_sub_f32 v53, v53, v77
    v_sub_f32 v54, v54, v78
    v_sub_f32 v55, v55, v79
    v_sub_f32 v56, v56, v80
    v_sub_f32 v57, v57, v81
    v_sub_f32 v58, v58, v82
    v_sub_f32 v59, v59, v83
    v_cvt_pk_bf16_f32 v48, 0, v48
    v_cvt_pk_bf16_f32 v49, 0, v49
    v_cvt_pk_bf16_f32 v50, 0, v50
    v_cvt_pk_bf16_f32 v51, 0, v51
    v_cvt_pk_bf16_f32 v52, 0, v52
    v_cvt_pk_bf16_f32 v53, 0, v53
    v_cvt_pk_bf16_f32 v54, 0, v54
    v_cvt_pk_bf16_f32 v55, 0, v55
    v_cvt_pk_bf16_f32 v56, 0, v56
    v_cvt_pk_bf16_f32 v57, 0, v57
    v_cvt_pk_bf16_f32 v58, 0, v58
    v_cvt_pk_bf16_f32 v59, 0, v59
    v_mul_f32 v48, v48, v96
    v_mul_f32 v49, v49, v97
    v_mul_f32 v50, v50, v98
    v_mul_f32 v51, v51, v99
    v_mul_f32 v52, v52, v100
    v_mul_f32 v53, v53, v101
    v_mul_f32 v54, v54, v102
    v_mul_f32 v55, v55, v103
    v_mul_f32 v56, v56, v104
    v_mul_f32 v57, v57, v105
    v_mul_f32 v58, v58, v106
    v_mul_f32 v59, v59, v107
    v_cvt_pk_bf16_f32 v138, v48, v49
    v_cvt_pk_bf16_f32 v139, v50, v51
    v_add_f32_dpp v3, v146, v145 row_ror:12 row_mask:0xf bank_mask:0xf
    v_cvt_pk_bf16_f32 v140, v52, v53
    v_cvt_pk_bf16_f32 v141, v54, v55
    v_add_f32_dpp v3, v147, v3 row_ror:8 row_mask:0xf bank_mask:0xf
    v_cvt_pk_bf16_f32 v142, v56, v57
    v_cvt_pk_bf16_f32 v143, v58, v59
    v_add_f32_dpp v15, v144, v3 row_ror:4 row_mask:0xf bank_mask:0x2
    v_mfma_f32_16x16x16_bf16 v[148:151], v[138:139], v[152:153], 0
    v_mfma_f32_16x16x16_bf16 v[148:151], v[140:141], v[154:155], v[148:151]
    v_mfma_f32_16x16x16_bf16 v[148:151], v[142:143], v[156:157], v[148:151]
    v_add_u32 v33, s63, v21
    v_add_u32 v34, s63, v22
    ds_read_b64 v[108:109], v33 offset:0
    ds_read_b64 v[110:111], v33 offset:1536
    ds_read_b64 v[112:113], v33 offset:128
    ds_read_b64 v[114:115], v33 offset:1664
    ds_read_b64 v[116:117], v33 offset:256
    ds_read_b64 v[118:119], v33 offset:1792
    ds_read_b64 v[120:121], v34 offset:0
    v_add_f32_dpp v4, v150, v149 row_ror:12 row_mask:0xf bank_mask:0xf
    ds_read_b64 v[122:123], v34 offset:1536
    ds_read_b64 v[124:125], v34 offset:128
    v_add_f32_dpp v4, v151, v4 row_ror:8 row_mask:0xf bank_mask:0xf
    ds_read_b64 v[126:127], v34 offset:1664
    ds_read_b64 v[128:129], v34 offset:256
    ds_read_b64 v[130:131], v34 offset:1792
    v_add_f32_dpp v16, v148, v4 row_ror:4 row_mask:0xf bank_mask:0x2
    s_waitcnt lgkmcnt(0)
    v_lshlrev_b32 v60, 16, v108
    v_and_b32 v61, s66, v108
    v_lshlrev_b32 v62, 16, v109
    v_and_b32 v63, s66, v109
    v_lshlrev_b32 v84, 16, v110
    v_and_b32 v85, s66, v110
    v_lshlrev_b32 v86, 16, v111
    v_and_b32 v87, s66, v111
    v_lshlrev_b32 v64, 16, v112
    v_and_b32 v65, s66, v112
    v_lshlrev_b32 v66, 16, v113
    v_and_b32 v67, s66, v113
    v_lshlrev_b32 v88, 16, v114
    v_and_b32 v89, s66, v114
    v_lshlrev_b32 v90, 16, v115
    v_and_b32 v91, s66, v115
    v_lshlrev_b32 v68, 16, v116
    v_and_b32 v69, s66, v116
    v_lshlrev_b32 v70, 16, v117
    v_and_b32 v71, s66, v117
    v_lshlrev_b32 v92, 16, v118
    v_and_b32 v93, s66, v118
    v_lshlrev_b32 v94, 16, v119
    v_and_b32 v95, s66, v119
    v_lshlrev_b32 v72, 16, v120
    v_and_b32 v73, s66, v120
    v_lshlrev_b32 v74, 16, v121
    v_and_b32 v75, s66, v121
    v_lshlrev_b32 v96, 16, v122
    v_and_b32 v97, s66, v122
    v_lshlrev_b32 v98, 16, v123
    v_and_b32 v99, s66, v123
    v_lshlrev_b32 v76, 16, v124
    v_and_b32 v77, s66, v124
    v_lshlrev_b32 v78, 16, v125
    v_and_b32 v79, s66, v125
    v_lshlrev_b32 v100, 16, v126
    v_and_b32 v101, s66, v126
    v_lshlrev_b32 v102, 16, v127
    v_and_b32 v103, s66, v127
    v_lshlrev_b32 v80, 16, v128
    v_and_b32 v81, s66, v128
    v_lshlrev_b32 v82, 16, v129
    v_and_b32 v83, s66, v129
    v_lshlrev_b32 v104, 16, v130
    v_and_b32 v105, s66, v130
    v_lshlrev_b32 v106, 16, v131
    v_and_b32 v107, s66, v131
    v_add_u32 v13, s62, v12
    s_add_u32 s62, s62, 24576
    s_cmp_eq_u32 s62, 73728
    s_cselect_b32 s62, 0, s62
    s_barrier
    ds_read_b128 v[36:39], v13 offset:0
    ds_read_b128 v[40:43], v13 offset:1024
    ds_read_b128 v[44:47], v13 offset:2048
    ds_read_b128 v[48:51], v13 offset:3072
    ds_read_b128 v[52:55], v13 offset:4096
    ds_read_b128 v[56:59], v13 offset:5120
    s_waitcnt lgkmcnt(3)
    v_cvt_f32_i32 v36, v36
    v_cvt_f32_i32 v37, v37
    v_cvt_f32_i32 v38, v38
    v_cvt_f32_i32 v39, v39
    v_cvt_f32_i32 v40, v40
    v_cvt_f32_i32 v41, v41
    v_cvt_f32_i32 v42, v42
    v_cvt_f32_i32 v43, v43
    v_cvt_f32_i32 v44, v44
    v_cvt_f32_i32 v45, v45
    v_cvt_f32_i32 v46, v46
    v_cvt_f32_i32 v47, v47
    v_sub_f32 v36, v36, v60
    v_sub_f32 v37, v37, v61
    v_sub_f32 v38, v38, v62
    v_sub_f32 v39, v39, v63
    v_sub_f32 v40, v40, v64
    v_sub_f32 v41, v41, v65
    v_sub_f32 v42, v42, v66
    v_sub_f32 v43, v43, v67
    v_sub_f32 v44, v44, v68
    v_sub_f32 v45, v45, v69
    v_sub_f32 v46, v46, v70
    v_sub_f32 v47, v47, v71
    v_cvt_pk_bf16_f32 v36, 0, v36
    v_cvt_pk_bf16_f32 v37, 0, v37
    v_cvt_pk_bf16_f32 v38, 0, v38
    v_cvt_pk_bf16_f32 v39, 0, v39
    v_cvt_pk_bf16_f32 v40, 0, v40
    v_cvt_pk_bf16_f32 v41, 0, v41
    v_cvt_pk_bf16_f32 v42, 0, v42
    v_cvt_pk_bf16_f32 v43, 0, v43
    v_cvt_pk_bf16_f32 v44, 0, v44
    v_cvt_pk_bf16_f32 v45, 0, v45
    v_cvt_pk_bf16_f32 v46, 0, v46
    v_cvt_pk_bf16_f32 v47, 0, v47
    v_mul_f32 v36, v36, v84
    v_mul_f32 v37, v37, v85
    v_mul_f32 v38, v38, v86
    v_mul_f32 v39, v39, v87
    v_mul_f32 v40, v40, v88
    v_mul_f32 v41, v41, v89
    v_mul_f32 v42, v42, v90
    v_mul_f32 v43, v43, v91
    v_mul_f32 v44, v44, v92
    v_mul_f32 v45, v45, v93
    v_mul_f32 v46, v46, v94
    v_mul_f32 v47, v47, v95
    v_cvt_pk_bf16_f32 v132, v36, v37
    v_cvt_pk_bf16_f32 v133, v38, v39
    v_cvt_pk_bf16_f32 v134, v40, v41
    v_cvt_pk_bf16_f32 v135, v42, v43
    v_cvt_pk_bf16_f32 v136, v44, v45
    v_cvt_pk_bf16_f32 v137, v46, v47
    v_mfma_f32_16x16x16_bf16 v[144:147], v[132:133], v[152:153], 0
    v_mfma_f32_16x16x16_bf16 v[144:147], v[134:135], v[154:155], v[144:147]
    v_mfma_f32_16x16x16_bf16 v[144:147], v[136:137], v[156:157], v[144:147]
    s_waitcnt lgkmcnt(0)
    v_cvt_f32_i32 v48, v48
    v_cvt_f32_i32 v49, v49
    v_cvt_f32_i32 v50, v50
    v_cvt_f32_i32 v51, v51
    v_cvt_f32_i32 v52, v52
    v_cvt_f32_i32 v53, v53
    v_cvt_f32_i32 v54, v54
    v_cvt_f32_i32 v55, v55
    v_cvt_f32_i32 v56, v56
    v_cvt_f32_i32 v57, v57
    v_cvt_f32_i32 v58, v58
    v_cvt_f32_i32 v59, v59
    v_sub_f32 v48, v48, v72
    v_sub_f32 v49, v49, v73
    v_sub_f32 v50, v50, v74
    v_sub_f32 v51, v51, v75
    v_sub_f32 v52, v52, v76
    v_sub_f32 v53, v53, v77
    v_sub_f32 v54, v54, v78
    v_sub_f32 v55, v55, v79
    v_sub_f32 v56, v56, v80
    v_sub_f32 v57, v57, v81
    v_sub_f32 v58, v58, v82
    v_sub_f32 v59, v59, v83
    v_cvt_pk_bf16_f32 v48, 0, v48
    v_cvt_pk_bf16_f32 v49, 0, v49
    v_cvt_pk_bf16_f32 v50, 0, v50
    v_cvt_pk_bf16_f32 v51, 0, v51
    v_cvt_pk_bf16_f32 v52, 0, v52
    v_cvt_pk_bf16_f32 v53, 0, v53
    v_cvt_pk_bf16_f32 v54, 0, v54
    v_cvt_pk_bf16_f32 v55, 0, v55
    v_cvt_pk_bf16_f32 v56, 0, v56
    v_cvt_pk_bf16_f32 v57, 0, v57
    v_cvt_pk_bf16_f32 v58, 0, v58
    v_cvt_pk_bf16_f32 v59, 0, v59
    v_mul_f32 v48, v48, v96
    v_mul_f32 v49, v49, v97
    v_mul_f32 v50, v50, v98
    v_mul_f32 v51, v51, v99
    v_mul_f32 v52, v52, v100
    v_mul_f32 v53, v53, v101
    v_mul_f32 v54, v54, v102
    v_mul_f32 v55, v55, v103
    v_mul_f32 v56, v56, v104
    v_mul_f32 v57, v57, v105
    v_mul_f32 v58, v58, v106
    v_mul_f32 v59, v59, v107
    v_cvt_pk_bf16_f32 v138, v48, v49
    v_cvt_pk_bf16_f32 v139, v50, v51
    v_add_f32_dpp v3, v147, v146 row_ror:12 row_mask:0xf bank_mask:0xf
    v_cvt_pk_bf16_f32 v140, v52, v53
    v_cvt_pk_bf16_f32 v141, v54, v55
    v_add_f32_dpp v3, v144, v3 row_ror:8 row_mask:0xf bank_mask:0xf
    v_cvt_pk_bf16_f32 v142, v56, v57
    v_cvt_pk_bf16_f32 v143, v58, v59
    v_add_f32_dpp v15, v145, v3 row_ror:4 row_mask:0xf bank_mask:0x4
    v_mfma_f32_16x16x16_bf16 v[148:151], v[138:139], v[152:153], 0
    v_mfma_f32_16x16x16_bf16 v[148:151], v[140:141], v[154:155], v[148:151]
    v_mfma_f32_16x16x16_bf16 v[148:151], v[142:143], v[156:157], v[148:151]
    v_add_u32 v33, s63, v23
    v_add_u32 v34, s63, v24
    ds_read_b64 v[108:109], v33 offset:0
    ds_read_b64 v[110:111], v33 offset:1536
    ds_read_b64 v[112:113], v33 offset:128
    ds_read_b64 v[114:115], v33 offset:1664
    ds_read_b64 v[116:117], v33 offset:256
    ds_read_b64 v[118:119], v33 offset:1792
    ds_read_b64 v[120:121], v34 offset:0
    v_add_f32_dpp v4, v151, v150 row_ror:12 row_mask:0xf bank_mask:0xf
    ds_read_b64 v[122:123], v34 offset:1536
    ds_read_b64 v[124:125], v34 offset:128
    v_add_f32_dpp v4, v148, v4 row_ror:8 row_mask:0xf bank_mask:0xf
    ds_read_b64 v[126:127], v34 offset:1664
    ds_read_b64 v[128:129], v34 offset:256
    ds_read_b64 v[130:131], v34 offset:1792
    v_add_f32_dpp v16, v149, v4 row_ror:4 row_mask:0xf bank_mask:0x4
    s_waitcnt lgkmcnt(0)
    v_lshlrev_b32 v60, 16, v108
    v_and_b32 v61, s66, v108
    v_lshlrev_b32 v62, 16, v109
    v_and_b32 v63, s66, v109
    v_lshlrev_b32 v84, 16, v110
    v_and_b32 v85, s66, v110
    v_lshlrev_b32 v86, 16, v111
    v_and_b32 v87, s66, v111
    v_lshlrev_b32 v64, 16, v112
    v_and_b32 v65, s66, v112
    v_lshlrev_b32 v66, 16, v113
    v_and_b32 v67, s66, v113
    v_lshlrev_b32 v88, 16, v114
    v_and_b32 v89, s66, v114
    v_lshlrev_b32 v90, 16, v115
    v_and_b32 v91, s66, v115
    v_lshlrev_b32 v68, 16, v116
    v_and_b32 v69, s66, v116
    v_lshlrev_b32 v70, 16, v117
    v_and_b32 v71, s66, v117
    v_lshlrev_b32 v92, 16, v118
    v_and_b32 v93, s66, v118
    v_lshlrev_b32 v94, 16, v119
    v_and_b32 v95, s66, v119
    v_lshlrev_b32 v72, 16, v120
    v_and_b32 v73, s66, v120
    v_lshlrev_b32 v74, 16, v121
    v_and_b32 v75, s66, v121
    v_lshlrev_b32 v96, 16, v122
    v_and_b32 v97, s66, v122
    v_lshlrev_b32 v98, 16, v123
    v_and_b32 v99, s66, v123
    v_lshlrev_b32 v76, 16, v124
    v_and_b32 v77, s66, v124
    v_lshlrev_b32 v78, 16, v125
    v_and_b32 v79, s66, v125
    v_lshlrev_b32 v100, 16, v126
    v_and_b32 v101, s66, v126
    v_lshlrev_b32 v102, 16, v127
    v_and_b32 v103, s66, v127
    v_lshlrev_b32 v80, 16, v128
    v_and_b32 v81, s66, v128
    v_lshlrev_b32 v82, 16, v129
    v_and_b32 v83, s66, v129
    v_lshlrev_b32 v104, 16, v130
    v_and_b32 v105, s66, v130
    v_lshlrev_b32 v106, 16, v131
    v_and_b32 v107, s66, v131
    v_add_u32 v13, s62, v12
    s_add_u32 s62, s62, 24576
    s_cmp_eq_u32 s62, 73728
    s_cselect_b32 s62, 0, s62
    s_barrier
    ds_read_b128 v[36:39], v13 offset:0
    ds_read_b128 v[40:43], v13 offset:1024
    ds_read_b128 v[44:47], v13 offset:2048
    ds_read_b128 v[48:51], v13 offset:3072
    ds_read_b128 v[52:55], v13 offset:4096
    ds_read_b128 v[56:59], v13 offset:5120
    s_waitcnt lgkmcnt(3)
    v_cvt_f32_i32 v36, v36
    v_cvt_f32_i32 v37, v37
    v_cvt_f32_i32 v38, v38
    v_cvt_f32_i32 v39, v39
    v_cvt_f32_i32 v40, v40
    v_cvt_f32_i32 v41, v41
    v_cvt_f32_i32 v42, v42
    v_cvt_f32_i32 v43, v43
    v_cvt_f32_i32 v44, v44
    v_cvt_f32_i32 v45, v45
    v_cvt_f32_i32 v46, v46
    v_cvt_f32_i32 v47, v47
    v_sub_f32 v36, v36, v60
    v_sub_f32 v37, v37, v61
    v_sub_f32 v38, v38, v62
    v_sub_f32 v39, v39, v63
    v_sub_f32 v40, v40, v64
    v_sub_f32 v41, v41, v65
    v_sub_f32 v42, v42, v66
    v_sub_f32 v43, v43, v67
    v_sub_f32 v44, v44, v68
    v_sub_f32 v45, v45, v69
    v_sub_f32 v46, v46, v70
    v_sub_f32 v47, v47, v71
    v_cvt_pk_bf16_f32 v36, 0, v36
    v_cvt_pk_bf16_f32 v37, 0, v37
    v_cvt_pk_bf16_f32 v38, 0, v38
    v_cvt_pk_bf16_f32 v39, 0, v39
    v_cvt_pk_bf16_f32 v40, 0, v40
    v_cvt_pk_bf16_f32 v41, 0, v41
    v_cvt_pk_bf16_f32 v42, 0, v42
    v_cvt_pk_bf16_f32 v43, 0, v43
    v_cvt_pk_bf16_f32 v44, 0, v44
    v_cvt_pk_bf16_f32 v45, 0, v45
    v_cvt_pk_bf16_f32 v46, 0, v46
    v_cvt_pk_bf16_f32 v47, 0, v47
    v_mul_f32 v36, v36, v84
    v_mul_f32 v37, v37, v85
    v_mul_f32 v38, v38, v86
    v_mul_f32 v39, v39, v87
    v_mul_f32 v40, v40, v88
    v_mul_f32 v41, v41, v89
    v_mul_f32 v42, v42, v90
    v_mul_f32 v43, v43, v91
    v_mul_f32 v44, v44, v92
    v_mul_f32 v45, v45, v93
    v_mul_f32 v46, v46, v94
    v_mul_f32 v47, v47, v95
    v_cvt_pk_bf16_f32 v132, v36, v37
    v_cvt_pk_bf16_f32 v133, v38, v39
    v_cvt_pk_bf16_f32 v134, v40, v41
    v_cvt_pk_bf16_f32 v135, v42, v43
    v_cvt_pk_bf16_f32 v136, v44, v45
    v_cvt_pk_bf16_f32 v137, v46, v47
    v_mfma_f32_16x16x16_bf16 v[144:147], v[132:133], v[152:153], 0
    v_mfma_f32_16x16x16_bf16 v[144:147], v[134:135], v[154:155], v[144:147]
    v_mfma_f32_16x16x16_bf16 v[144:147], v[136:137], v[156:157], v[144:147]
    s_waitcnt lgkmcnt(0)
    v_cvt_f32_i32 v48, v48
    v_cvt_f32_i32 v49, v49
    v_cvt_f32_i32 v50, v50
    v_cvt_f32_i32 v51, v51
    v_cvt_f32_i32 v52, v52
    v_cvt_f32_i32 v53, v53
    v_cvt_f32_i32 v54, v54
    v_cvt_f32_i32 v55, v55
    v_cvt_f32_i32 v56, v56
    v_cvt_f32_i32 v57, v57
    v_cvt_f32_i32 v58, v58
    v_cvt_f32_i32 v59, v59
    v_sub_f32 v48, v48, v72
    v_sub_f32 v49, v49, v73
    v_sub_f32 v50, v50, v74
    v_sub_f32 v51, v51, v75
    v_sub_f32 v52, v52, v76
    v_sub_f32 v53, v53, v77
    v_sub_f32 v54, v54, v78
    v_sub_f32 v55, v55, v79
    v_sub_f32 v56, v56, v80
    v_sub_f32 v57, v57, v81
    v_sub_f32 v58, v58, v82
    v_sub_f32 v59, v59, v83
    v_cvt_pk_bf16_f32 v48, 0, v48
    v_cvt_pk_bf16_f32 v49, 0, v49
    v_cvt_pk_bf16_f32 v50, 0, v50
    v_cvt_pk_bf16_f32 v51, 0, v51
    v_cvt_pk_bf16_f32 v52, 0, v52
    v_cvt_pk_bf16_f32 v53, 0, v53
    v_cvt_pk_bf16_f32 v54, 0, v54
    v_cvt_pk_bf16_f32 v55, 0, v55
    v_cvt_pk_bf16_f32 v56, 0, v56
    v_cvt_pk_bf16_f32 v57, 0, v57
    v_cvt_pk_bf16_f32 v58, 0, v58
    v_cvt_pk_bf16_f32 v59, 0, v59
    v_mul_f32 v48, v48, v96
    v_mul_f32 v49, v49, v97
    v_mul_f32 v50, v50, v98
    v_mul_f32 v51, v51, v99
    v_mul_f32 v52, v52, v100
    v_mul_f32 v53, v53, v101
    v_mul_f32 v54, v54, v102
    v_mul_f32 v55, v55, v103
    v_mul_f32 v56, v56, v104
    v_mul_f32 v57, v57, v105
    v_mul_f32 v58, v58, v106
    v_mul_f32 v59, v59, v107
    v_cvt_pk_bf16_f32 v138, v48, v49
    v_cvt_pk_bf16_f32 v139, v50, v51
    v_add_f32_dpp v3, v144, v147 row_ror:12 row_mask:0xf bank_mask:0xf
    v_cvt_pk_bf16_f32 v140, v52, v53
    v_cvt_pk_bf16_f32 v141, v54, v55
    v_add_f32_dpp v3, v145, v3 row_ror:8 row_mask:0xf bank_mask:0xf
    v_cvt_pk_bf16_f32 v142, v56, v57
    v_cvt_pk_bf16_f32 v143, v58, v59
    v_add_f32_dpp v15, v146, v3 row_ror:4 row_mask:0xf bank_mask:0x8
    v_mfma_f32_16x16x16_bf16 v[148:151], v[138:139], v[152:153], 0
    v_mfma_f32_16x16x16_bf16 v[148:151], v[140:141], v[154:155], v[148:151]
    v_mfma_f32_16x16x16_bf16 v[148:151], v[142:143], v[156:157], v[148:151]
    v_add_u32 v33, s63, v25
    v_add_u32 v34, s63, v26
    ds_read_b64 v[108:109], v33 offset:0
    ds_read_b64 v[110:111], v33 offset:1536
    ds_read_b64 v[112:113], v33 offset:128
    ds_read_b64 v[114:115], v33 offset:1664
    ds_read_b64 v[116:117], v33 offset:256
    ds_read_b64 v[118:119], v33 offset:1792
    ds_read_b64 v[120:121], v34 offset:0
    v_add_f32_dpp v4, v148, v151 row_ror:12 row_mask:0xf bank_mask:0xf
    ds_read_b64 v[122:123], v34 offset:1536
    ds_read_b64 v[124:125], v34 offset:128
    v_add_f32_dpp v4, v149, v4 row_ror:8 row_mask:0xf bank_mask:0xf
    ds_read_b64 v[126:127], v34 offset:1664
    ds_read_b64 v[128:129], v34 offset:256
    ds_read_b64 v[130:131], v34 offset:1792
    v_add_f32_dpp v16, v150, v4 row_ror:4 row_mask:0xf bank_mask:0x8
    v_cvt_pk_bf16_f32 v3, 0, v15
    v_cvt_pk_bf16_f32 v4, 0, v16
    v_mul_f32 v3, s65, v3
    v_mul_f32 v4, s65, v4
    v_cvt_pk_bf16_f32 v5, v3, v4
    v_max3_f32 v14, v14, v3, v4
    ds_write_b32 v11, v5 offset:0
    s_waitcnt lgkmcnt(0)
    v_lshlrev_b32 v60, 16, v108
    v_and_b32 v61, s66, v108
    v_lshlrev_b32 v62, 16, v109
    v_and_b32 v63, s66, v109
    v_lshlrev_b32 v84, 16, v110
    v_and_b32 v85, s66, v110
    v_lshlrev_b32 v86, 16, v111
    v_and_b32 v87, s66, v111
    v_lshlrev_b32 v64, 16, v112
    v_and_b32 v65, s66, v112
    v_lshlrev_b32 v66, 16, v113
    v_and_b32 v67, s66, v113
    v_lshlrev_b32 v88, 16, v114
    v_and_b32 v89, s66, v114
    v_lshlrev_b32 v90, 16, v115
    v_and_b32 v91, s66, v115
    v_lshlrev_b32 v68, 16, v116
    v_and_b32 v69, s66, v116
    v_lshlrev_b32 v70, 16, v117
    v_and_b32 v71, s66, v117
    v_lshlrev_b32 v92, 16, v118
    v_and_b32 v93, s66, v118
    v_lshlrev_b32 v94, 16, v119
    v_and_b32 v95, s66, v119
    v_lshlrev_b32 v72, 16, v120
    v_and_b32 v73, s66, v120
    v_lshlrev_b32 v74, 16, v121
    v_and_b32 v75, s66, v121
    v_lshlrev_b32 v96, 16, v122
    v_and_b32 v97, s66, v122
    v_lshlrev_b32 v98, 16, v123
    v_and_b32 v99, s66, v123
    v_lshlrev_b32 v76, 16, v124
    v_and_b32 v77, s66, v124
    v_lshlrev_b32 v78, 16, v125
    v_and_b32 v79, s66, v125
    v_lshlrev_b32 v100, 16, v126
    v_and_b32 v101, s66, v126
    v_lshlrev_b32 v102, 16, v127
    v_and_b32 v103, s66, v127
    v_lshlrev_b32 v80, 16, v128
    v_and_b32 v81, s66, v128
    v_lshlrev_b32 v82, 16, v129
    v_and_b32 v83, s66, v129
    v_lshlrev_b32 v104, 16, v130
    v_and_b32 v105, s66, v130
    v_lshlrev_b32 v106, 16, v131
    v_and_b32 v107, s66, v131
    v_add_u32 v13, s62, v12
    s_add_u32 s62, s62, 24576
    s_cmp_eq_u32 s62, 73728
    s_cselect_b32 s62, 0, s62
    s_barrier
    ds_read_b128 v[36:39], v13 offset:0
    ds_read_b128 v[40:43], v13 offset:1024
    ds_read_b128 v[44:47], v13 offset:2048
    ds_read_b128 v[48:51], v13 offset:3072
    ds_read_b128 v[52:55], v13 offset:4096
    ds_read_b128 v[56:59], v13 offset:5120
    s_waitcnt lgkmcnt(3)
    v_cvt_f32_i32 v36, v36
    v_cvt_f32_i32 v37, v37
    v_cvt_f32_i32 v38, v38
    v_cvt_f32_i32 v39, v39
    v_cvt_f32_i32 v40, v40
    v_cvt_f32_i32 v41, v41
    v_cvt_f32_i32 v42, v42
    v_cvt_f32_i32 v43, v43
    v_cvt_f32_i32 v44, v44
    v_cvt_f32_i32 v45, v45
    v_cvt_f32_i32 v46, v46
    v_cvt_f32_i32 v47, v47
    v_sub_f32 v36, v36, v60
    v_sub_f32 v37, v37, v61
    v_sub_f32 v38, v38, v62
    v_sub_f32 v39, v39, v63
    v_sub_f32 v40, v40, v64
    v_sub_f32 v41, v41, v65
    v_sub_f32 v42, v42, v66
    v_sub_f32 v43, v43, v67
    v_sub_f32 v44, v44, v68
    v_sub_f32 v45, v45, v69
    v_sub_f32 v46, v46, v70
    v_sub_f32 v47, v47, v71
    v_cvt_pk_bf16_f32 v36, 0, v36
    v_cvt_pk_bf16_f32 v37, 0, v37
    v_cvt_pk_bf16_f32 v38, 0, v38
    v_cvt_pk_bf16_f32 v39, 0, v39
    v_cvt_pk_bf16_f32 v40, 0, v40
    v_cvt_pk_bf16_f32 v41, 0, v41
    v_cvt_pk_bf16_f32 v42, 0, v42
    v_cvt_pk_bf16_f32 v43, 0, v43
    v_cvt_pk_bf16_f32 v44, 0, v44
    v_cvt_pk_bf16_f32 v45, 0, v45
    v_cvt_pk_bf16_f32 v46, 0, v46
    v_cvt_pk_bf16_f32 v47, 0, v47
    v_mul_f32 v36, v36, v84
    v_mul_f32 v37, v37, v85
    v_mul_f32 v38, v38, v86
    v_mul_f32 v39, v39, v87
    v_mul_f32 v40, v40, v88
    v_mul_f32 v41, v41, v89
    v_mul_f32 v42, v42, v90
    v_mul_f32 v43, v43, v91
    v_mul_f32 v44, v44, v92
    v_mul_f32 v45, v45, v93
    v_mul_f32 v46, v46, v94
    v_mul_f32 v47, v47, v95
    v_cvt_pk_bf16_f32 v132, v36, v37
    v_cvt_pk_bf16_f32 v133, v38, v39
    v_cvt_pk_bf16_f32 v134, v40, v41
    v_cvt_pk_bf16_f32 v135, v42, v43
    v_cvt_pk_bf16_f32 v136, v44, v45
    v_cvt_pk_bf16_f32 v137, v46, v47
    v_mfma_f32_16x16x16_bf16 v[144:147], v[132:133], v[152:153], 0
    v_mfma_f32_16x16x16_bf16 v[144:147], v[134:135], v[154:155], v[144:147]
    v_mfma_f32_16x16x16_bf16 v[144:147], v[136:137], v[156:157], v[144:147]
    s_waitcnt lgkmcnt(0)
    v_cvt_f32_i32 v48, v48
    v_cvt_f32_i32 v49, v49
    v_cvt_f32_i32 v50, v50
    v_cvt_f32_i32 v51, v51
    v_cvt_f32_i32 v52, v52
    v_cvt_f32_i32 v53, v53
    v_cvt_f32_i32 v54, v54
    v_cvt_f32_i32 v55, v55
    v_cvt_f32_i32 v56, v56
    v_cvt_f32_i32 v57, v57
    v_cvt_f32_i32 v58, v58
    v_cvt_f32_i32 v59, v59
    v_sub_f32 v48, v48, v72
    v_sub_f32 v49, v49, v73
    v_sub_f32 v50, v50, v74
    v_sub_f32 v51, v51, v75
    v_sub_f32 v52, v52, v76
    v_sub_f32 v53, v53, v77
    v_sub_f32 v54, v54, v78
    v_sub_f32 v55, v55, v79
    v_sub_f32 v56, v56, v80
    v_sub_f32 v57, v57, v81
    v_sub_f32 v58, v58, v82
    v_sub_f32 v59, v59, v83
    v_cvt_pk_bf16_f32 v48, 0, v48
    v_cvt_pk_bf16_f32 v49, 0, v49
    v_cvt_pk_bf16_f32 v50, 0, v50
    v_cvt_pk_bf16_f32 v51, 0, v51
    v_cvt_pk_bf16_f32 v52, 0, v52
    v_cvt_pk_bf16_f32 v53, 0, v53
    v_cvt_pk_bf16_f32 v54, 0, v54
    v_cvt_pk_bf16_f32 v55, 0, v55
    v_cvt_pk_bf16_f32 v56, 0, v56
    v_cvt_pk_bf16_f32 v57, 0, v57
    v_cvt_pk_bf16_f32 v58, 0, v58
    v_cvt_pk_bf16_f32 v59, 0, v59
    v_mul_f32 v48, v48, v96
    v_mul_f32 v49, v49, v97
    v_mul_f32 v50, v50, v98
    v_mul_f32 v51, v51, v99
    v_mul_f32 v52, v52, v100
    v_mul_f32 v53, v53, v101
    v_mul_f32 v54, v54, v102
    v_mul_f32 v55, v55, v103
    v_mul_f32 v56, v56, v104
    v_mul_f32 v57, v57, v105
    v_mul_f32 v58, v58, v106
    v_mul_f32 v59, v59, v107
    v_cvt_pk_bf16_f32 v138, v48, v49
    v_cvt_pk_bf16_f32 v139, v50, v51
    v_add_f32_dpp v3, v145, v144 row_ror:12 row_mask:0xf bank_mask:0xf
    v_cvt_pk_bf16_f32 v140, v52, v53
    v_cvt_pk_bf16_f32 v141, v54, v55
    v_add_f32_dpp v3, v146, v3 row_ror:8 row_mask:0xf bank_mask:0xf
    v_cvt_pk_bf16_f32 v142, v56, v57
    v_cvt_pk_bf16_f32 v143, v58, v59
    v_add_f32_dpp v15, v147, v3 row_ror:4 row_mask:0xf bank_mask:0x1
    v_mfma_f32_16x16x16_bf16 v[148:151], v[138:139], v[152:153], 0
    v_mfma_f32_16x16x16_bf16 v[148:151], v[140:141], v[154:155], v[148:151]
    v_mfma_f32_16x16x16_bf16 v[148:151], v[142:143], v[156:157], v[148:151]
    v_add_u32 v33, s63, v27
    v_add_u32 v34, s63, v28
    ds_read_b64 v[108:109], v33 offset:0
    ds_read_b64 v[110:111], v33 offset:1536
    ds_read_b64 v[112:113], v33 offset:128
    ds_read_b64 v[114:115], v33 offset:1664
    ds_read_b64 v[116:117], v33 offset:256
    ds_read_b64 v[118:119], v33 offset:1792
    ds_read_b64 v[120:121], v34 offset:0
    v_add_f32_dpp v4, v149, v148 row_ror:12 row_mask:0xf bank_mask:0xf
    ds_read_b64 v[122:123], v34 offset:1536
    ds_read_b64 v[124:125], v34 offset:128
    v_add_f32_dpp v4, v150, v4 row_ror:8 row_mask:0xf bank_mask:0xf
    ds_read_b64 v[126:127], v34 offset:1664
    ds_read_b64 v[128:129], v34 offset:256
    ds_read_b64 v[130:131], v34 offset:1792
    v_add_f32_dpp v16, v151, v4 row_ror:4 row_mask:0xf bank_mask:0x1
    s_waitcnt lgkmcnt(0)
    v_lshlrev_b32 v60, 16, v108
    v_and_b32 v61, s66, v108
    v_lshlrev_b32 v62, 16, v109
    v_and_b32 v63, s66, v109
    v_lshlrev_b32 v84, 16, v110
    v_and_b32 v85, s66, v110
    v_lshlrev_b32 v86, 16, v111
    v_and_b32 v87, s66, v111
    v_lshlrev_b32 v64, 16, v112
    v_and_b32 v65, s66, v112
    v_lshlrev_b32 v66, 16, v113
    v_and_b32 v67, s66, v113
    v_lshlrev_b32 v88, 16, v114
    v_and_b32 v89, s66, v114
    v_lshlrev_b32 v90, 16, v115
    v_and_b32 v91, s66, v115
    v_lshlrev_b32 v68, 16, v116
    v_and_b32 v69, s66, v116
    v_lshlrev_b32 v70, 16, v117
    v_and_b32 v71, s66, v117
    v_lshlrev_b32 v92, 16, v118
    v_and_b32 v93, s66, v118
    v_lshlrev_b32 v94, 16, v119
    v_and_b32 v95, s66, v119
    v_lshlrev_b32 v72, 16, v120
    v_and_b32 v73, s66, v120
    v_lshlrev_b32 v74, 16, v121
    v_and_b32 v75, s66, v121
    v_lshlrev_b32 v96, 16, v122
    v_and_b32 v97, s66, v122
    v_lshlrev_b32 v98, 16, v123
    v_and_b32 v99, s66, v123
    v_lshlrev_b32 v76, 16, v124
    v_and_b32 v77, s66, v124
    v_lshlrev_b32 v78, 16, v125
    v_and_b32 v79, s66, v125
    v_lshlrev_b32 v100, 16, v126
    v_and_b32 v101, s66, v126
    v_lshlrev_b32 v102, 16, v127
    v_and_b32 v103, s66, v127
    v_lshlrev_b32 v80, 16, v128
    v_and_b32 v81, s66, v128
    v_lshlrev_b32 v82, 16, v129
    v_and_b32 v83, s66, v129
    v_lshlrev_b32 v104, 16, v130
    v_and_b32 v105, s66, v130
    v_lshlrev_b32 v106, 16, v131
    v_and_b32 v107, s66, v131
    v_add_u32 v13, s62, v12
    s_add_u32 s62, s62, 24576
    s_cmp_eq_u32 s62, 73728
    s_cselect_b32 s62, 0, s62
    s_barrier
    ds_read_b128 v[36:39], v13 offset:0
    ds_read_b128 v[40:43], v13 offset:1024
    ds_read_b128 v[44:47], v13 offset:2048
    ds_read_b128 v[48:51], v13 offset:3072
    ds_read_b128 v[52:55], v13 offset:4096
    ds_read_b128 v[56:59], v13 offset:5120
    s_waitcnt lgkmcnt(3)
    v_cvt_f32_i32 v36, v36
    v_cvt_f32_i32 v37, v37
    v_cvt_f32_i32 v38, v38
    v_cvt_f32_i32 v39, v39
    v_cvt_f32_i32 v40, v40
    v_cvt_f32_i32 v41, v41
    v_cvt_f32_i32 v42, v42
    v_cvt_f32_i32 v43, v43
    v_cvt_f32_i32 v44, v44
    v_cvt_f32_i32 v45, v45
    v_cvt_f32_i32 v46, v46
    v_cvt_f32_i32 v47, v47
    v_sub_f32 v36, v36, v60
    v_sub_f32 v37, v37, v61
    v_sub_f32 v38, v38, v62
    v_sub_f32 v39, v39, v63
    v_sub_f32 v40, v40, v64
    v_sub_f32 v41, v41, v65
    v_sub_f32 v42, v42, v66
    v_sub_f32 v43, v43, v67
    v_sub_f32 v44, v44, v68
    v_sub_f32 v45, v45, v69
    v_sub_f32 v46, v46, v70
    v_sub_f32 v47, v47, v71
    v_cvt_pk_bf16_f32 v36, 0, v36
    v_cvt_pk_bf16_f32 v37, 0, v37
    v_cvt_pk_bf16_f32 v38, 0, v38
    v_cvt_pk_bf16_f32 v39, 0, v39
    v_cvt_pk_bf16_f32 v40, 0, v40
    v_cvt_pk_bf16_f32 v41, 0, v41
    v_cvt_pk_bf16_f32 v42, 0, v42
    v_cvt_pk_bf16_f32 v43, 0, v43
    v_cvt_pk_bf16_f32 v44, 0, v44
    v_cvt_pk_bf16_f32 v45, 0, v45
    v_cvt_pk_bf16_f32 v46, 0, v46
    v_cvt_pk_bf16_f32 v47, 0, v47
    v_mul_f32 v36, v36, v84
    v_mul_f32 v37, v37, v85
    v_mul_f32 v38, v38, v86
    v_mul_f32 v39, v39, v87
    v_mul_f32 v40, v40, v88
    v_mul_f32 v41, v41, v89
    v_mul_f32 v42, v42, v90
    v_mul_f32 v43, v43, v91
    v_mul_f32 v44, v44, v92
    v_mul_f32 v45, v45, v93
    v_mul_f32 v46, v46, v94
    v_mul_f32 v47, v47, v95
    v_cvt_pk_bf16_f32 v132, v36, v37
    v_cvt_pk_bf16_f32 v133, v38, v39
    v_cvt_pk_bf16_f32 v134, v40, v41
    v_cvt_pk_bf16_f32 v135, v42, v43
    v_cvt_pk_bf16_f32 v136, v44, v45
    v_cvt_pk_bf16_f32 v137, v46, v47
    v_mfma_f32_16x16x16_bf16 v[144:147], v[132:133], v[152:153], 0
    v_mfma_f32_16x16x16_bf16 v[144:147], v[134:135], v[154:155], v[144:147]
    v_mfma_f32_16x16x16_bf16 v[144:147], v[136:137], v[156:157], v[144:147]
    s_waitcnt lgkmcnt(0)
    v_cvt_f32_i32 v48, v48
    v_cvt_f32_i32 v49, v49
    v_cvt_f32_i32 v50, v50
    v_cvt_f32_i32 v51, v51
    v_cvt_f32_i32 v52, v52
    v_cvt_f32_i32 v53, v53
    v_cvt_f32_i32 v54, v54
    v_cvt_f32_i32 v55, v55
    v_cvt_f32_i32 v56, v56
    v_cvt_f32_i32 v57, v57
    v_cvt_f32_i32 v58, v58
    v_cvt_f32_i32 v59, v59
    v_sub_f32 v48, v48, v72
    v_sub_f32 v49, v49, v73
    v_sub_f32 v50, v50, v74
    v_sub_f32 v51, v51, v75
    v_sub_f32 v52, v52, v76
    v_sub_f32 v53, v53, v77
    v_sub_f32 v54, v54, v78
    v_sub_f32 v55, v55, v79
    v_sub_f32 v56, v56, v80
    v_sub_f32 v57, v57, v81
    v_sub_f32 v58, v58, v82
    v_sub_f32 v59, v59, v83
    v_cvt_pk_bf16_f32 v48, 0, v48
    v_cvt_pk_bf16_f32 v49, 0, v49
    v_cvt_pk_bf16_f32 v50, 0, v50
    v_cvt_pk_bf16_f32 v51, 0, v51
    v_cvt_pk_bf16_f32 v52, 0, v52
    v_cvt_pk_bf16_f32 v53, 0, v53
    v_cvt_pk_bf16_f32 v54, 0, v54
    v_cvt_pk_bf16_f32 v55, 0, v55
    v_cvt_pk_bf16_f32 v56, 0, v56
    v_cvt_pk_bf16_f32 v57, 0, v57
    v_cvt_pk_bf16_f32 v58, 0, v58
    v_cvt_pk_bf16_f32 v59, 0, v59
    v_mul_f32 v48, v48, v96
    v_mul_f32 v49, v49, v97
    v_mul_f32 v50, v50, v98
    v_mul_f32 v51, v51, v99
    v_mul_f32 v52, v52, v100
    v_mul_f32 v53, v53, v101
    v_mul_f32 v54, v54, v102
    v_mul_f32 v55, v55, v103
    v_mul_f32 v56, v56, v104
    v_mul_f32 v57, v57, v105
    v_mul_f32 v58, v58, v106
    v_mul_f32 v59, v59, v107
    v_cvt_pk_bf16_f32 v138, v48, v49
    v_cvt_pk_bf16_f32 v139, v50, v51
    v_add_f32_dpp v3, v146, v145 row_ror:12 row_mask:0xf bank_mask:0xf
    v_cvt_pk_bf16_f32 v140, v52, v53
    v_cvt_pk_bf16_f32 v141, v54, v55
    v_add_f32_dpp v3, v147, v3 row_ror:8 row_mask:0xf bank_mask:0xf
    v_cvt_pk_bf16_f32 v142, v56, v57
    v_cvt_pk_bf16_f32 v143, v58, v59
    v_add_f32_dpp v15, v144, v3 row_ror:4 row_mask:0xf bank_mask:0x2
    v_mfma_f32_16x16x16_bf16 v[148:151], v[138:139], v[152:153], 0
    v_mfma_f32_16x16x16_bf16 v[148:151], v[140:141], v[154:155], v[148:151]
    v_mfma_f32_16x16x16_bf16 v[148:151], v[142:143], v[156:157], v[148:151]
    v_add_u32 v33, s63, v29
    v_add_u32 v34, s63, v30
    ds_read_b64 v[108:109], v33 offset:0
    ds_read_b64 v[110:111], v33 offset:1536
    ds_read_b64 v[112:113], v33 offset:128
    ds_read_b64 v[114:115], v33 offset:1664
    ds_read_b64 v[116:117], v33 offset:256
    ds_read_b64 v[118:119], v33 offset:1792
    ds_read_b64 v[120:121], v34 offset:0
    v_add_f32_dpp v4, v150, v149 row_ror:12 row_mask:0xf bank_mask:0xf
    ds_read_b64 v[122:123], v34 offset:1536
    ds_read_b64 v[124:125], v34 offset:128
    v_add_f32_dpp v4, v151, v4 row_ror:8 row_mask:0xf bank_mask:0xf
    ds_read_b64 v[126:127], v34 offset:1664
    ds_read_b64 v[128:129], v34 offset:256
    ds_read_b64 v[130:131], v34 offset:1792
    v_add_f32_dpp v16, v148, v4 row_ror:4 row_mask:0xf bank_mask:0x2
    s_waitcnt lgkmcnt(0)
    v_lshlrev_b32 v60, 16, v108
    v_and_b32 v61, s66, v108
    v_lshlrev_b32 v62, 16, v109
    v_and_b32 v63, s66, v109
    v_lshlrev_b32 v84, 16, v110
    v_and_b32 v85, s66, v110
    v_lshlrev_b32 v86, 16, v111
    v_and_b32 v87, s66, v111
    v_lshlrev_b32 v64, 16, v112
    v_and_b32 v65, s66, v112
    v_lshlrev_b32 v66, 16, v113
    v_and_b32 v67, s66, v113
    v_lshlrev_b32 v88, 16, v114
    v_and_b32 v89, s66, v114
    v_lshlrev_b32 v90, 16, v115
    v_and_b32 v91, s66, v115
    v_lshlrev_b32 v68, 16, v116
    v_and_b32 v69, s66, v116
    v_lshlrev_b32 v70, 16, v117
    v_and_b32 v71, s66, v117
    v_lshlrev_b32 v92, 16, v118
    v_and_b32 v93, s66, v118
    v_lshlrev_b32 v94, 16, v119
    v_and_b32 v95, s66, v119
    v_lshlrev_b32 v72, 16, v120
    v_and_b32 v73, s66, v120
    v_lshlrev_b32 v74, 16, v121
    v_and_b32 v75, s66, v121
    v_lshlrev_b32 v96, 16, v122
    v_and_b32 v97, s66, v122
    v_lshlrev_b32 v98, 16, v123
    v_and_b32 v99, s66, v123
    v_lshlrev_b32 v76, 16, v124
    v_and_b32 v77, s66, v124
    v_lshlrev_b32 v78, 16, v125
    v_and_b32 v79, s66, v125
    v_lshlrev_b32 v100, 16, v126
    v_and_b32 v101, s66, v126
    v_lshlrev_b32 v102, 16, v127
    v_and_b32 v103, s66, v127
    v_lshlrev_b32 v80, 16, v128
    v_and_b32 v81, s66, v128
    v_lshlrev_b32 v82, 16, v129
    v_and_b32 v83, s66, v129
    v_lshlrev_b32 v104, 16, v130
    v_and_b32 v105, s66, v130
    v_lshlrev_b32 v106, 16, v131
    v_and_b32 v107, s66, v131
    v_add_u32 v13, s62, v12
    s_add_u32 s62, s62, 24576
    s_cmp_eq_u32 s62, 73728
    s_cselect_b32 s62, 0, s62
    s_barrier
    ds_read_b128 v[36:39], v13 offset:0
    ds_read_b128 v[40:43], v13 offset:1024
    ds_read_b128 v[44:47], v13 offset:2048
    ds_read_b128 v[48:51], v13 offset:3072
    ds_read_b128 v[52:55], v13 offset:4096
    ds_read_b128 v[56:59], v13 offset:5120
    s_waitcnt lgkmcnt(3)
    v_cvt_f32_i32 v36, v36
    v_cvt_f32_i32 v37, v37
    v_cvt_f32_i32 v38, v38
    v_cvt_f32_i32 v39, v39
    v_cvt_f32_i32 v40, v40
    v_cvt_f32_i32 v41, v41
    v_cvt_f32_i32 v42, v42
    v_cvt_f32_i32 v43, v43
    v_cvt_f32_i32 v44, v44
    v_cvt_f32_i32 v45, v45
    v_cvt_f32_i32 v46, v46
    v_cvt_f32_i32 v47, v47
    v_sub_f32 v36, v36, v60
    v_sub_f32 v37, v37, v61
    v_sub_f32 v38, v38, v62
    v_sub_f32 v39, v39, v63
    v_sub_f32 v40, v40, v64
    v_sub_f32 v41, v41, v65
    v_sub_f32 v42, v42, v66
    v_sub_f32 v43, v43, v67
    v_sub_f32 v44, v44, v68
    v_sub_f32 v45, v45, v69
    v_sub_f32 v46, v46, v70
    v_sub_f32 v47, v47, v71
    v_cvt_pk_bf16_f32 v36, 0, v36
    v_cvt_pk_bf16_f32 v37, 0, v37
    v_cvt_pk_bf16_f32 v38, 0, v38
    v_cvt_pk_bf16_f32 v39, 0, v39
    v_cvt_pk_bf16_f32 v40, 0, v40
    v_cvt_pk_bf16_f32 v41, 0, v41
    v_cvt_pk_bf16_f32 v42, 0, v42
    v_cvt_pk_bf16_f32 v43, 0, v43
    v_cvt_pk_bf16_f32 v44, 0, v44
    v_cvt_pk_bf16_f32 v45, 0, v45
    v_cvt_pk_bf16_f32 v46, 0, v46
    v_cvt_pk_bf16_f32 v47, 0, v47
    v_mul_f32 v36, v36, v84
    v_mul_f32 v37, v37, v85
    v_mul_f32 v38, v38, v86
    v_mul_f32 v39, v39, v87
    v_mul_f32 v40, v40, v88
    v_mul_f32 v41, v41, v89
    v_mul_f32 v42, v42, v90
    v_mul_f32 v43, v43, v91
    v_mul_f32 v44, v44, v92
    v_mul_f32 v45, v45, v93
    v_mul_f32 v46, v46, v94
    v_mul_f32 v47, v47, v95
    v_cvt_pk_bf16_f32 v132, v36, v37
    v_cvt_pk_bf16_f32 v133, v38, v39
    v_cvt_pk_bf16_f32 v134, v40, v41
    v_cvt_pk_bf16_f32 v135, v42, v43
    v_cvt_pk_bf16_f32 v136, v44, v45
    v_cvt_pk_bf16_f32 v137, v46, v47
    v_mfma_f32_16x16x16_bf16 v[144:147], v[132:133], v[152:153], 0
    v_mfma_f32_16x16x16_bf16 v[144:147], v[134:135], v[154:155], v[144:147]
    v_mfma_f32_16x16x16_bf16 v[144:147], v[136:137], v[156:157], v[144:147]
    s_waitcnt lgkmcnt(0)
    v_cvt_f32_i32 v48, v48
    v_cvt_f32_i32 v49, v49
    v_cvt_f32_i32 v50, v50
    v_cvt_f32_i32 v51, v51
    v_cvt_f32_i32 v52, v52
    v_cvt_f32_i32 v53, v53
    v_cvt_f32_i32 v54, v54
    v_cvt_f32_i32 v55, v55
    v_cvt_f32_i32 v56, v56
    v_cvt_f32_i32 v57, v57
    v_cvt_f32_i32 v58, v58
    v_cvt_f32_i32 v59, v59
    v_sub_f32 v48, v48, v72
    v_sub_f32 v49, v49, v73
    v_sub_f32 v50, v50, v74
    v_sub_f32 v51, v51, v75
    v_sub_f32 v52, v52, v76
    v_sub_f32 v53, v53, v77
    v_sub_f32 v54, v54, v78
    v_sub_f32 v55, v55, v79
    v_sub_f32 v56, v56, v80
    v_sub_f32 v57, v57, v81
    v_sub_f32 v58, v58, v82
    v_sub_f32 v59, v59, v83
    v_cvt_pk_bf16_f32 v48, 0, v48
    v_cvt_pk_bf16_f32 v49, 0, v49
    v_cvt_pk_bf16_f32 v50, 0, v50
    v_cvt_pk_bf16_f32 v51, 0, v51
    v_cvt_pk_bf16_f32 v52, 0, v52
    v_cvt_pk_bf16_f32 v53, 0, v53
    v_cvt_pk_bf16_f32 v54, 0, v54
    v_cvt_pk_bf16_f32 v55, 0, v55
    v_cvt_pk_bf16_f32 v56, 0, v56
    v_cvt_pk_bf16_f32 v57, 0, v57
    v_cvt_pk_bf16_f32 v58, 0, v58
    v_cvt_pk_bf16_f32 v59, 0, v59
    v_mul_f32 v48, v48, v96
    v_mul_f32 v49, v49, v97
    v_mul_f32 v50, v50, v98
    v_mul_f32 v51, v51, v99
    v_mul_f32 v52, v52, v100
    v_mul_f32 v53, v53, v101
    v_mul_f32 v54, v54, v102
    v_mul_f32 v55, v55, v103
    v_mul_f32 v56, v56, v104
    v_mul_f32 v57, v57, v105
    v_mul_f32 v58, v58, v106
    v_mul_f32 v59, v59, v107
    v_cvt_pk_bf16_f32 v138, v48, v49
    v_cvt_pk_bf16_f32 v139, v50, v51
    v_add_f32_dpp v3, v147, v146 row_ror:12 row_mask:0xf bank_mask:0xf
    v_cvt_pk_bf16_f32 v140, v52, v53
    v_cvt_pk_bf16_f32 v141, v54, v55
    v_add_f32_dpp v3, v144, v3 row_ror:8 row_mask:0xf bank_mask:0xf
    v_cvt_pk_bf16_f32 v142, v56, v57
    v_cvt_pk_bf16_f32 v143, v58, v59
    v_add_f32_dpp v15, v145, v3 row_ror:4 row_mask:0xf bank_mask:0x4
    v_mfma_f32_16x16x16_bf16 v[148:151], v[138:139], v[152:153], 0
    v_mfma_f32_16x16x16_bf16 v[148:151], v[140:141], v[154:155], v[148:151]
    v_mfma_f32_16x16x16_bf16 v[148:151], v[142:143], v[156:157], v[148:151]
    v_add_u32 v33, s63, v31
    v_add_u32 v34, s63, v32
    ds_read_b64 v[108:109], v33 offset:0
    ds_read_b64 v[110:111], v33 offset:1536
    ds_read_b64 v[112:113], v33 offset:128
    ds_read_b64 v[114:115], v33 offset:1664
    ds_read_b64 v[116:117], v33 offset:256
    ds_read_b64 v[118:119], v33 offset:1792
    ds_read_b64 v[120:121], v34 offset:0
    v_add_f32_dpp v4, v151, v150 row_ror:12 row_mask:0xf bank_mask:0xf
    ds_read_b64 v[122:123], v34 offset:1536
    ds_read_b64 v[124:125], v34 offset:128
    v_add_f32_dpp v4, v148, v4 row_ror:8 row_mask:0xf bank_mask:0xf
    ds_read_b64 v[126:127], v34 offset:1664
    ds_read_b64 v[128:129], v34 offset:256
    ds_read_b64 v[130:131], v34 offset:1792
    v_add_f32_dpp v16, v149, v4 row_ror:4 row_mask:0xf bank_mask:0x4
    s_waitcnt lgkmcnt(0)
    v_lshlrev_b32 v60, 16, v108
    v_and_b32 v61, s66, v108
    v_lshlrev_b32 v62, 16, v109
    v_and_b32 v63, s66, v109
    v_lshlrev_b32 v84, 16, v110
    v_and_b32 v85, s66, v110
    v_lshlrev_b32 v86, 16, v111
    v_and_b32 v87, s66, v111
    v_lshlrev_b32 v64, 16, v112
    v_and_b32 v65, s66, v112
    v_lshlrev_b32 v66, 16, v113
    v_and_b32 v67, s66, v113
    v_lshlrev_b32 v88, 16, v114
    v_and_b32 v89, s66, v114
    v_lshlrev_b32 v90, 16, v115
    v_and_b32 v91, s66, v115
    v_lshlrev_b32 v68, 16, v116
    v_and_b32 v69, s66, v116
    v_lshlrev_b32 v70, 16, v117
    v_and_b32 v71, s66, v117
    v_lshlrev_b32 v92, 16, v118
    v_and_b32 v93, s66, v118
    v_lshlrev_b32 v94, 16, v119
    v_and_b32 v95, s66, v119
    v_lshlrev_b32 v72, 16, v120
    v_and_b32 v73, s66, v120
    v_lshlrev_b32 v74, 16, v121
    v_and_b32 v75, s66, v121
    v_lshlrev_b32 v96, 16, v122
    v_and_b32 v97, s66, v122
    v_lshlrev_b32 v98, 16, v123
    v_and_b32 v99, s66, v123
    v_lshlrev_b32 v76, 16, v124
    v_and_b32 v77, s66, v124
    v_lshlrev_b32 v78, 16, v125
    v_and_b32 v79, s66, v125
    v_lshlrev_b32 v100, 16, v126
    v_and_b32 v101, s66, v126
    v_lshlrev_b32 v102, 16, v127
    v_and_b32 v103, s66, v127
    v_lshlrev_b32 v80, 16, v128
    v_and_b32 v81, s66, v128
    v_lshlrev_b32 v82, 16, v129
    v_and_b32 v83, s66, v129
    v_lshlrev_b32 v104, 16, v130
    v_and_b32 v105, s66, v130
    v_lshlrev_b32 v106, 16, v131
    v_and_b32 v107, s66, v131
    v_add_u32 v13, s62, v12
    s_add_u32 s62, s62, 24576
    s_cmp_eq_u32 s62, 73728
    s_cselect_b32 s62, 0, s62
    s_barrier
    ds_read_b128 v[36:39], v13 offset:0
    ds_read_b128 v[40:43], v13 offset:1024
    ds_read_b128 v[44:47], v13 offset:2048
    ds_read_b128 v[48:51], v13 offset:3072
    ds_read_b128 v[52:55], v13 offset:4096
    ds_read_b128 v[56:59], v13 offset:5120
    s_waitcnt lgkmcnt(3)
    v_cvt_f32_i32 v36, v36
    v_cvt_f32_i32 v37, v37
    v_cvt_f32_i32 v38, v38
    v_cvt_f32_i32 v39, v39
    v_cvt_f32_i32 v40, v40
    v_cvt_f32_i32 v41, v41
    v_cvt_f32_i32 v42, v42
    v_cvt_f32_i32 v43, v43
    v_cvt_f32_i32 v44, v44
    v_cvt_f32_i32 v45, v45
    v_cvt_f32_i32 v46, v46
    v_cvt_f32_i32 v47, v47
    v_sub_f32 v36, v36, v60
    v_sub_f32 v37, v37, v61
    v_sub_f32 v38, v38, v62
    v_sub_f32 v39, v39, v63
    v_sub_f32 v40, v40, v64
    v_sub_f32 v41, v41, v65
    v_sub_f32 v42, v42, v66
    v_sub_f32 v43, v43, v67
    v_sub_f32 v44, v44, v68
    v_sub_f32 v45, v45, v69
    v_sub_f32 v46, v46, v70
    v_sub_f32 v47, v47, v71
    v_cvt_pk_bf16_f32 v36, 0, v36
    v_cvt_pk_bf16_f32 v37, 0, v37
    v_cvt_pk_bf16_f32 v38, 0, v38
    v_cvt_pk_bf16_f32 v39, 0, v39
    v_cvt_pk_bf16_f32 v40, 0, v40
    v_cvt_pk_bf16_f32 v41, 0, v41
    v_cvt_pk_bf16_f32 v42, 0, v42
    v_cvt_pk_bf16_f32 v43, 0, v43
    v_cvt_pk_bf16_f32 v44, 0, v44
    v_cvt_pk_bf16_f32 v45, 0, v45
    v_cvt_pk_bf16_f32 v46, 0, v46
    v_cvt_pk_bf16_f32 v47, 0, v47
    v_mul_f32 v36, v36, v84
    v_mul_f32 v37, v37, v85
    v_mul_f32 v38, v38, v86
    v_mul_f32 v39, v39, v87
    v_mul_f32 v40, v40, v88
    v_mul_f32 v41, v41, v89
    v_mul_f32 v42, v42, v90
    v_mul_f32 v43, v43, v91
    v_mul_f32 v44, v44, v92
    v_mul_f32 v45, v45, v93
    v_mul_f32 v46, v46, v94
    v_mul_f32 v47, v47, v95
    v_cvt_pk_bf16_f32 v132, v36, v37
    v_cvt_pk_bf16_f32 v133, v38, v39
    v_cvt_pk_bf16_f32 v134, v40, v41
    v_cvt_pk_bf16_f32 v135, v42, v43
    v_cvt_pk_bf16_f32 v136, v44, v45
    v_cvt_pk_bf16_f32 v137, v46, v47
    v_mfma_f32_16x16x16_bf16 v[144:147], v[132:133], v[152:153], 0
    v_mfma_f32_16x16x16_bf16 v[144:147], v[134:135], v[154:155], v[144:147]
    v_mfma_f32_16x16x16_bf16 v[144:147], v[136:137], v[156:157], v[144:147]
    s_waitcnt lgkmcnt(0)
    v_cvt_f32_i32 v48, v48
    v_cvt_f32_i32 v49, v49
    v_cvt_f32_i32 v50, v50
    v_cvt_f32_i32 v51, v51
    v_cvt_f32_i32 v52, v52
    v_cvt_f32_i32 v53, v53
    v_cvt_f32_i32 v54, v54
    v_cvt_f32_i32 v55, v55
    v_cvt_f32_i32 v56, v56
    v_cvt_f32_i32 v57, v57
    v_cvt_f32_i32 v58, v58
    v_cvt_f32_i32 v59, v59
    v_sub_f32 v48, v48, v72
    v_sub_f32 v49, v49, v73
    v_sub_f32 v50, v50, v74
    v_sub_f32 v51, v51, v75
    v_sub_f32 v52, v52, v76
    v_sub_f32 v53, v53, v77
    v_sub_f32 v54, v54, v78
    v_sub_f32 v55, v55, v79
    v_sub_f32 v56, v56, v80
    v_sub_f32 v57, v57, v81
    v_sub_f32 v58, v58, v82
    v_sub_f32 v59, v59, v83
    v_cvt_pk_bf16_f32 v48, 0, v48
    v_cvt_pk_bf16_f32 v49, 0, v49
    v_cvt_pk_bf16_f32 v50, 0, v50
    v_cvt_pk_bf16_f32 v51, 0, v51
    v_cvt_pk_bf16_f32 v52, 0, v52
    v_cvt_pk_bf16_f32 v53, 0, v53
    v_cvt_pk_bf16_f32 v54, 0, v54
    v_cvt_pk_bf16_f32 v55, 0, v55
    v_cvt_pk_bf16_f32 v56, 0, v56
    v_cvt_pk_bf16_f32 v57, 0, v57
    v_cvt_pk_bf16_f32 v58, 0, v58
    v_cvt_pk_bf16_f32 v59, 0, v59
    v_mul_f32 v48, v48, v96
    v_mul_f32 v49, v49, v97
    v_mul_f32 v50, v50, v98
    v_mul_f32 v51, v51, v99
    v_mul_f32 v52, v52, v100
    v_mul_f32 v53, v53, v101
    v_mul_f32 v54, v54, v102
    v_mul_f32 v55, v55, v103
    v_mul_f32 v56, v56, v104
    v_mul_f32 v57, v57, v105
    v_mul_f32 v58, v58, v106
    v_mul_f32 v59, v59, v107
    v_cvt_pk_bf16_f32 v138, v48, v49
    v_cvt_pk_bf16_f32 v139, v50, v51
    v_add_f32_dpp v3, v144, v147 row_ror:12 row_mask:0xf bank_mask:0xf
    v_cvt_pk_bf16_f32 v140, v52, v53
    v_cvt_pk_bf16_f32 v141, v54, v55
    v_add_f32_dpp v3, v145, v3 row_ror:8 row_mask:0xf bank_mask:0xf
    v_cvt_pk_bf16_f32 v142, v56, v57
    v_cvt_pk_bf16_f32 v143, v58, v59
    v_add_f32_dpp v15, v146, v3 row_ror:4 row_mask:0xf bank_mask:0x8
    v_mfma_f32_16x16x16_bf16 v[148:151], v[138:139], v[152:153], 0
    v_mfma_f32_16x16x16_bf16 v[148:151], v[140:141], v[154:155], v[148:151]
    v_mfma_f32_16x16x16_bf16 v[148:151], v[142:143], v[156:157], v[148:151]
    s_add_u32 s63, s63, 3072
    v_add_u32 v33, s63, v17
    v_add_u32 v34, s63, v18
    ds_read_b64 v[108:109], v33 offset:0
    ds_read_b64 v[110:111], v33 offset:1536
    ds_read_b64 v[112:113], v33 offset:128
    ds_read_b64 v[114:115], v33 offset:1664
    ds_read_b64 v[116:117], v33 offset:256
    ds_read_b64 v[118:119], v33 offset:1792
    ds_read_b64 v[120:121], v34 offset:0
    v_add_f32_dpp v4, v148, v151 row_ror:12 row_mask:0xf bank_mask:0xf
    ds_read_b64 v[122:123], v34 offset:1536
    ds_read_b64 v[124:125], v34 offset:128
    v_add_f32_dpp v4, v149, v4 row_ror:8 row_mask:0xf bank_mask:0xf
    ds_read_b64 v[126:127], v34 offset:1664
    ds_read_b64 v[128:129], v34 offset:256
    ds_read_b64 v[130:131], v34 offset:1792
    v_add_f32_dpp v16, v150, v4 row_ror:4 row_mask:0xf bank_mask:0x8
    v_cvt_pk_bf16_f32 v3, 0, v15
    v_cvt_pk_bf16_f32 v4, 0, v16
    v_mul_f32 v3, s65, v3
    v_mul_f32 v4, s65, v4
    v_cvt_pk_bf16_f32 v5, v3, v4
    v_max3_f32 v14, v14, v3, v4
    ds_write_b32 v11, v5 offset:256
    s_waitcnt lgkmcnt(0)
    v_lshlrev_b32 v60, 16, v108
    v_and_b32 v61, s66, v108
    v_lshlrev_b32 v62, 16, v109
    v_and_b32 v63, s66, v109
    v_lshlrev_b32 v84, 16, v110
    v_and_b32 v85, s66, v110
    v_lshlrev_b32 v86, 16, v111
    v_and_b32 v87, s66, v111
    v_lshlrev_b32 v64, 16, v112
    v_and_b32 v65, s66, v112
    v_lshlrev_b32 v66, 16, v113
    v_and_b32 v67, s66, v113
    v_lshlrev_b32 v88, 16, v114
    v_and_b32 v89, s66, v114
    v_lshlrev_b32 v90, 16, v115
    v_and_b32 v91, s66, v115
    v_lshlrev_b32 v68, 16, v116
    v_and_b32 v69, s66, v116
    v_lshlrev_b32 v70, 16, v117
    v_and_b32 v71, s66, v117
    v_lshlrev_b32 v92, 16, v118
    v_and_b32 v93, s66, v118
    v_lshlrev_b32 v94, 16, v119
    v_and_b32 v95, s66, v119
    v_lshlrev_b32 v72, 16, v120
    v_and_b32 v73, s66, v120
    v_lshlrev_b32 v74, 16, v121
    v_and_b32 v75, s66, v121
    v_lshlrev_b32 v96, 16, v122
    v_and_b32 v97, s66, v122
    v_lshlrev_b32 v98, 16, v123
    v_and_b32 v99, s66, v123
    v_lshlrev_b32 v76, 16, v124
    v_and_b32 v77, s66, v124
    v_lshlrev_b32 v78, 16, v125
    v_and_b32 v79, s66, v125
    v_lshlrev_b32 v100, 16, v126
    v_and_b32 v101, s66, v126
    v_lshlrev_b32 v102, 16, v127
    v_and_b32 v103, s66, v127
    v_lshlrev_b32 v80, 16, v128
    v_and_b32 v81, s66, v128
    v_lshlrev_b32 v82, 16, v129
    v_and_b32 v83, s66, v129
    v_lshlrev_b32 v104, 16, v130
    v_and_b32 v105, s66, v130
    v_lshlrev_b32 v106, 16, v131
    v_and_b32 v107, s66, v131
    v_add_u32 v11, 3072, v11
    s_add_u32 s61, s61, 1
    s_cmp_lt_u32 s61, 16
    s_cbranch_scc1 L_kblk
    v_subrev_u32 v11, 49152, v11
    s_lshl_b32 s63, s72, 9
    v_add_u32 v215, s63, v7
    v_add_u32 v216, s63, v8
    ds_read_b32 v214, v11 offset:0
    ds_read_u16 v217, v215 offset:8192
    ds_read_u16 v218, v216 offset:8192
    ds_read_u16 v215, v215
    ds_read_u16 v216, v216
    v_mov_b32 v208, 0
    v_mov_b32 v209, 0
    v_mov_b32 v210, 0
    v_mov_b32 v211, 0
    v_mov_b32 v160, 0
    v_mov_b32 v161, 0
    v_mov_b32 v162, 0
    v_mov_b32 v163, 0
    v_mov_b32 v164, 0
    v_mov_b32 v165, 0
    v_mov_b32 v166, 0
    v_mov_b32 v167, 0
    v_mov_b32 v168, 0
    v_mov_b32 v169, 0
    v_mov_b32 v170, 0
    v_mov_b32 v171, 0
    v_mov_b32 v172, 0
    v_mov_b32 v173, 0
    v_mov_b32 v174, 0
    v_mov_b32 v175, 0
    v_mov_b32 v176, 0
    v_mov_b32 v177, 0
    v_mov_b32 v178, 0
    v_mov_b32 v179, 0
    v_mov_b32 v180, 0
    v_mov_b32 v181, 0
    v_mov_b32 v182, 0
    v_mov_b32 v183, 0
    v_mov_b32 v184, 0
    v_mov_b32 v185, 0
    v_mov_b32 v186, 0
    v_mov_b32 v187, 0
    v_mov_b32 v188, 0
    v_mov_b32 v189, 0
    v_mov_b32 v190, 0
    v_mov_b32 v191, 0
    v_mov_b32 v192, 0
    v_mov_b32 v193, 0
    v_mov_b32 v194, 0
    v_mov_b32 v195, 0
    v_mov_b32 v196, 0
    v_mov_b32 v197, 0
    v_mov_b32 v198, 0
    v_mov_b32 v199, 0
    v_mov_b32 v200, 0
    v_mov_b32 v201, 0
    v_mov_b32 v202, 0
    v_mov_b32 v203, 0
    v_mov_b32 v204, 0
    v_mov_b32 v205, 0
    v_mov_b32 v206, 0
    v_mov_b32 v207, 0
    v_mov_b32 v212, 0
    v_mov_b32 v213, 0
    s_nop 1
    v_max_f32_dpp v14, v14, v14 row_ror:4 row_mask:0xf bank_mask:0xf
    s_nop 1
    v_max_f32_dpp v14, v14, v14 row_ror:8 row_mask:0xf bank_mask:0xf
    v_mov_b32 v3, v14
    s_nop 1
    v_permlane16_swap_b32 v14, v3
    v_max_f32 v14, v14, v3
    v_mov_b32 v3, v14
    s_nop 1
    v_permlane32_swap_b32 v14, v3
    v_max_f32 v14, v14, v3
    v_cvt_pk_bf16_f32 v14, 0, v14
    v_mul_f32 v14, s64, v14
    s_mov_b32 s61, 0
L_vblk:
    v_add_u32 v13, s62, v12
    s_add_u32 s62, s62, 24576
    s_cmp_eq_u32 s62, 73728
    s_cselect_b32 s62, 0, s62
    s_barrier
    ds_read_b128 v[36:39], v13 offset:0
    ds_read_b128 v[40:43], v13 offset:1024
    ds_read_b128 v[44:47], v13 offset:2048
    ds_read_b128 v[48:51], v13 offset:3072
    ds_read_b128 v[52:55], v13 offset:4096
    ds_read_b128 v[56:59], v13 offset:5120
    s_waitcnt lgkmcnt(6)
    v_lshlrev_b32 v219, 16, v214
    v_and_b32 v220, s66, v214
    v_fma_f32 v219, v219, s64, -v14
    v_fma_f32 v220, v220, s64, -v14
    v_exp_f32 v219, v219
    v_exp_f32 v220, v220
    v_lshlrev_b32 v221, 16, v215
    v_lshlrev_b32 v222, 16, v216
    v_mul_f32 v221, v219, v221
    v_mul_f32 v222, v220, v222
    v_add_f32 v212, v212, v219
    v_cvt_pk_bf16_f32 v221, v221, v222
    v_add_f32 v212, v212, v220
    v_lshlrev_b32 v223, 16, v217
    v_lshlrev_b32 v224, 16, v218
    v_lshlrev_b32 v219, 16, v221
    v_and_b32 v220, s66, v221
    v_fmac_f32 v213, v219, v223
    v_fmac_f32 v213, v220, v224
    v_mov_b32_dpp v208, v221 quad_perm:[0,1,2,3] row_mask:0xf bank_mask:0x1
    v_mov_b32_dpp v209, v221 quad_perm:[0,1,2,3] row_mask:0xf bank_mask:0x2
    v_mov_b32_dpp v210, v221 quad_perm:[0,1,2,3] row_mask:0xf bank_mask:0x4
    v_mov_b32_dpp v211, v221 quad_perm:[0,1,2,3] row_mask:0xf bank_mask:0x8
    s_waitcnt lgkmcnt(3)
    v_cvt_f32_i32 v36, v36
    v_cvt_f32_i32 v37, v37
    v_cvt_f32_i32 v38, v38
    v_cvt_f32_i32 v39, v39
    v_cvt_f32_i32 v40, v40
    v_cvt_f32_i32 v41, v41
    v_cvt_f32_i32 v42, v42
    v_cvt_f32_i32 v43, v43
    v_cvt_f32_i32 v44, v44
    v_cvt_f32_i32 v45, v45
    v_cvt_f32_i32 v46, v46
    v_cvt_f32_i32 v47, v47
    s_waitcnt lgkmcnt(0)
    v_cvt_f32_i32 v48, v48
    v_cvt_f32_i32 v49, v49
    v_cvt_f32_i32 v50, v50
    v_cvt_f32_i32 v51, v51
    v_cvt_f32_i32 v52, v52
    v_cvt_f32_i32 v53, v53
    v_cvt_f32_i32 v54, v54
    v_cvt_f32_i32 v55, v55
    v_cvt_f32_i32 v56, v56
    v_cvt_f32_i32 v57, v57
    v_cvt_f32_i32 v58, v58
    v_cvt_f32_i32 v59, v59
    v_cvt_pk_bf16_f32 v60, v36, v48
    v_cvt_pk_bf16_f32 v64, v37, v49
    v_cvt_pk_bf16_f32 v68, v38, v50
    v_cvt_pk_bf16_f32 v72, v39, v51
    v_cvt_pk_bf16_f32 v76, v40, v52
    v_cvt_pk_bf16_f32 v80, v41, v53
    v_cvt_pk_bf16_f32 v84, v42, v54
    v_cvt_pk_bf16_f32 v88, v43, v55
    v_cvt_pk_bf16_f32 v92, v44, v56
    v_cvt_pk_bf16_f32 v96, v45, v57
    v_cvt_pk_bf16_f32 v100, v46, v58
    v_cvt_pk_bf16_f32 v104, v47, v59
    v_add_u32 v215, s63, v9
    v_add_u32 v216, s63, v10
    ds_read_b32 v214, v11 offset:256
    ds_read_u16 v217, v215 offset:8192
    ds_read_u16 v218, v216 offset:8192
    ds_read_u16 v215, v215
    ds_read_u16 v216, v216
    v_add_u32 v13, s62, v12
    s_add_u32 s62, s62, 24576
    s_cmp_eq_u32 s62, 73728
    s_cselect_b32 s62, 0, s62
    s_barrier
    ds_read_b128 v[36:39], v13 offset:0
    ds_read_b128 v[40:43], v13 offset:1024
    ds_read_b128 v[44:47], v13 offset:2048
    ds_read_b128 v[48:51], v13 offset:3072
    ds_read_b128 v[52:55], v13 offset:4096
    ds_read_b128 v[56:59], v13 offset:5120
    s_waitcnt lgkmcnt(3)
    v_cvt_f32_i32 v36, v36
    v_cvt_f32_i32 v37, v37
    v_cvt_f32_i32 v38, v38
    v_cvt_f32_i32 v39, v39
    v_cvt_f32_i32 v40, v40
    v_cvt_f32_i32 v41, v41
    v_cvt_f32_i32 v42, v42
    v_cvt_f32_i32 v43, v43
    v_cvt_f32_i32 v44, v44
    v_cvt_f32_i32 v45, v45
    v_cvt_f32_i32 v46, v46
    v_cvt_f32_i32 v47, v47
    s_waitcnt lgkmcnt(0)
    v_cvt_f32_i32 v48, v48
    v_cvt_f32_i32 v49, v49
    v_cvt_f32_i32 v50, v50
    v_cvt_f32_i32 v51, v51
    v_cvt_f32_i32 v52, v52
    v_cvt_f32_i32 v53, v53
    v_cvt_f32_i32 v54, v54
    v_cvt_f32_i32 v55, v55
    v_cvt_f32_i32 v56, v56
    v_cvt_f32_i32 v57, v57
    v_cvt_f32_i32 v58, v58
    v_cvt_f32_i32 v59, v59
    v_cvt_pk_bf16_f32 v61, v36, v48
    v_cvt_pk_bf16_f32 v65, v37, v49
    v_cvt_pk_bf16_f32 v69, v38, v50
    v_cvt_pk_bf16_f32 v73, v39, v51
    v_cvt_pk_bf16_f32 v77, v40, v52
    v_cvt_pk_bf16_f32 v81, v41, v53
    v_cvt_pk_bf16_f32 v85, v42, v54
    v_cvt_pk_bf16_f32 v89, v43, v55
    v_cvt_pk_bf16_f32 v93, v44, v56
    v_cvt_pk_bf16_f32 v97, v45, v57
    v_cvt_pk_bf16_f32 v101, v46, v58
    v_cvt_pk_bf16_f32 v105, v47, v59
    v_add_u32 v13, s62, v12
    s_add_u32 s62, s62, 24576
    s_cmp_eq_u32 s62, 73728
    s_cselect_b32 s62, 0, s62
    s_barrier
    ds_read_b128 v[36:39], v13 offset:0
    ds_read_b128 v[40:43], v13 offset:1024
    ds_read_b128 v[44:47], v13 offset:2048
    ds_read_b128 v[48:51], v13 offset:3072
    ds_read_b128 v[52:55], v13 offset:4096
    ds_read_b128 v[56:59], v13 offset:5120
    s_waitcnt lgkmcnt(3)
    v_cvt_f32_i32 v36, v36
    v_cvt_f32_i32 v37, v37
    v_cvt_f32_i32 v38, v38
    v_cvt_f32_i32 v39, v39
    v_cvt_f32_i32 v40, v40
    v_cvt_f32_i32 v41, v41
    v_cvt_f32_i32 v42, v42
    v_cvt_f32_i32 v43, v43
    v_cvt_f32_i32 v44, v44
    v_cvt_f32_i32 v45, v45
    v_cvt_f32_i32 v46, v46
    v_cvt_f32_i32 v47, v47
    s_waitcnt lgkmcnt(0)
    v_cvt_f32_i32 v48, v48
    v_cvt_f32_i32 v49, v49
    v_cvt_f32_i32 v50, v50
    v_cvt_f32_i32 v51, v51
    v_cvt_f32_i32 v52, v52
    v_cvt_f32_i32 v53, v53
    v_cvt_f32_i32 v54, v54
    v_cvt_f32_i32 v55, v55
    v_cvt_f32_i32 v56, v56
    v_cvt_f32_i32 v57, v57
    v_cvt_f32_i32 v58, v58
    v_cvt_f32_i32 v59, v59
    v_cvt_pk_bf16_f32 v62, v36, v48
    v_cvt_pk_bf16_f32 v66, v37, v49
    v_cvt_pk_bf16_f32 v70, v38, v50
    v_cvt_pk_bf16_f32 v74, v39, v51
    v_cvt_pk_bf16_f32 v78, v40, v52
    v_cvt_pk_bf16_f32 v82, v41, v53
    v_cvt_pk_bf16_f32 v86, v42, v54
    v_cvt_pk_bf16_f32 v90, v43, v55
    v_cvt_pk_bf16_f32 v94, v44, v56
    v_cvt_pk_bf16_f32 v98, v45, v57
    v_cvt_pk_bf16_f32 v102, v46, v58
    v_cvt_pk_bf16_f32 v106, v47, v59
    v_add_u32 v13, s62, v12
    s_add_u32 s62, s62, 24576
    s_cmp_eq_u32 s62, 73728
    s_cselect_b32 s62, 0, s62
    s_barrier
    ds_read_b128 v[36:39], v13 offset:0
    ds_read_b128 v[40:43], v13 offset:1024
    ds_read_b128 v[44:47], v13 offset:2048
    ds_read_b128 v[48:51], v13 offset:3072
    ds_read_b128 v[52:55], v13 offset:4096
    ds_read_b128 v[56:59], v13 offset:5120
    s_waitcnt lgkmcnt(3)
    v_cvt_f32_i32 v36, v36
    v_cvt_f32_i32 v37, v37
    v_cvt_f32_i32 v38, v38
    v_cvt_f32_i32 v39, v39
    v_cvt_f32_i32 v40, v40
    v_cvt_f32_i32 v41, v41
    v_cvt_f32_i32 v42, v42
    v_cvt_f32_i32 v43, v43
    v_cvt_f32_i32 v44, v44
    v_cvt_f32_i32 v45, v45
    v_cvt_f32_i32 v46, v46
    v_cvt_f32_i32 v47, v47
    s_waitcnt lgkmcnt(0)
    v_cvt_f32_i32 v48, v48
    v_cvt_f32_i32 v49, v49
    v_cvt_f32_i32 v50, v50
    v_cvt_f32_i32 v51, v51
    v_cvt_f32_i32 v52, v52
    v_cvt_f32_i32 v53, v53
    v_cvt_f32_i32 v54, v54
    v_cvt_f32_i32 v55, v55
    v_cvt_f32_i32 v56, v56
    v_cvt_f32_i32 v57, v57
    v_cvt_f32_i32 v58, v58
    v_cvt_f32_i32 v59, v59
    v_cvt_pk_bf16_f32 v63, v36, v48
    v_cvt_pk_bf16_f32 v67, v37, v49
    v_cvt_pk_bf16_f32 v71, v38, v50
    v_cvt_pk_bf16_f32 v75, v39, v51
    v_cvt_pk_bf16_f32 v79, v40, v52
    v_cvt_pk_bf16_f32 v83, v41, v53
    v_cvt_pk_bf16_f32 v87, v42, v54
    v_cvt_pk_bf16_f32 v91, v43, v55
    v_cvt_pk_bf16_f32 v95, v44, v56
    v_cvt_pk_bf16_f32 v99, v45, v57
    v_cvt_pk_bf16_f32 v103, v46, v58
    v_cvt_pk_bf16_f32 v107, v47, v59
    v_mfma_f32_16x16x32_bf16 v[160:163], v[208:211], v[60:63], v[160:163]
    v_mfma_f32_16x16x32_bf16 v[164:167], v[208:211], v[64:67], v[164:167]
    v_mfma_f32_16x16x32_bf16 v[168:171], v[208:211], v[68:71], v[168:171]
    v_mfma_f32_16x16x32_bf16 v[172:175], v[208:211], v[72:75], v[172:175]
    v_mfma_f32_16x16x32_bf16 v[176:179], v[208:211], v[76:79], v[176:179]
    v_mfma_f32_16x16x32_bf16 v[180:183], v[208:211], v[80:83], v[180:183]
    v_mfma_f32_16x16x32_bf16 v[184:187], v[208:211], v[84:87], v[184:187]
    v_mfma_f32_16x16x32_bf16 v[188:191], v[208:211], v[88:91], v[188:191]
    v_mfma_f32_16x16x32_bf16 v[192:195], v[208:211], v[92:95], v[192:195]
    v_mfma_f32_16x16x32_bf16 v[196:199], v[208:211], v[96:99], v[196:199]
    v_mfma_f32_16x16x32_bf16 v[200:203], v[208:211], v[100:103], v[200:203]
    v_mfma_f32_16x16x32_bf16 v[204:207], v[208:211], v[104:107], v[204:207]
    v_add_u32 v13, s62, v12
    s_add_u32 s62, s62, 24576
    s_cmp_eq_u32 s62, 73728
    s_cselect_b32 s62, 0, s62
    s_barrier
    ds_read_b128 v[36:39], v13 offset:0
    ds_read_b128 v[40:43], v13 offset:1024
    ds_read_b128 v[44:47], v13 offset:2048
    ds_read_b128 v[48:51], v13 offset:3072
    ds_read_b128 v[52:55], v13 offset:4096
    ds_read_b128 v[56:59], v13 offset:5120
    s_waitcnt lgkmcnt(6)
    v_lshlrev_b32 v219, 16, v214
    v_and_b32 v220, s66, v214
    v_fma_f32 v219, v219, s64, -v14
    v_fma_f32 v220, v220, s64, -v14
    v_exp_f32 v219, v219
    v_exp_f32 v220, v220
    v_lshlrev_b32 v221, 16, v215
    v_lshlrev_b32 v222, 16, v216
    v_mul_f32 v221, v219, v221
    v_mul_f32 v222, v220, v222
    v_add_f32 v212, v212, v219
    v_cvt_pk_bf16_f32 v221, v221, v222
    v_add_f32 v212, v212, v220
    v_lshlrev_b32 v223, 16, v217
    v_lshlrev_b32 v224, 16, v218
    v_lshlrev_b32 v219, 16, v221
    v_and_b32 v220, s66, v221
    v_fmac_f32 v213, v219, v223
    v_fmac_f32 v213, v220, v224
    v_mov_b32_dpp v208, v221 quad_perm:[0,1,2,3] row_mask:0xf bank_mask:0x1
    v_mov_b32_dpp v209, v221 quad_perm:[0,1,2,3] row_mask:0xf bank_mask:0x2
    v_mov_b32_dpp v210, v221 quad_perm:[0,1,2,3] row_mask:0xf bank_mask:0x4
    v_mov_b32_dpp v211, v221 quad_perm:[0,1,2,3] row_mask:0xf bank_mask:0x8
    s_waitcnt lgkmcnt(3)
    v_cvt_f32_i32 v36, v36
    v_cvt_f32_i32 v37, v37
    v_cvt_f32_i32 v38, v38
    v_cvt_f32_i32 v39, v39
    v_cvt_f32_i32 v40, v40
    v_cvt_f32_i32 v41, v41
    v_cvt_f32_i32 v42, v42
    v_cvt_f32_i32 v43, v43
    v_cvt_f32_i32 v44, v44
    v_cvt_f32_i32 v45, v45
    v_cvt_f32_i32 v46, v46
    v_cvt_f32_i32 v47, v47
    s_waitcnt lgkmcnt(0)
    v_cvt_f32_i32 v48, v48
    v_cvt_f32_i32 v49, v49
    v_cvt_f32_i32 v50, v50
    v_cvt_f32_i32 v51, v51
    v_cvt_f32_i32 v52, v52
    v_cvt_f32_i32 v53, v53
    v_cvt_f32_i32 v54, v54
    v_cvt_f32_i32 v55, v55
    v_cvt_f32_i32 v56, v56
    v_cvt_f32_i32 v57, v57
    v_cvt_f32_i32 v58, v58
    v_cvt_f32_i32 v59, v59
    v_cvt_pk_bf16_f32 v60, v36, v48
    v_cvt_pk_bf16_f32 v64, v37, v49
    v_cvt_pk_bf16_f32 v68, v38, v50
    v_cvt_pk_bf16_f32 v72, v39, v51
    v_cvt_pk_bf16_f32 v76, v40, v52
    v_cvt_pk_bf16_f32 v80, v41, v53
    v_cvt_pk_bf16_f32 v84, v42, v54
    v_cvt_pk_bf16_f32 v88, v43, v55
    v_cvt_pk_bf16_f32 v92, v44, v56
    v_cvt_pk_bf16_f32 v96, v45, v57
    v_cvt_pk_bf16_f32 v100, v46, v58
    v_cvt_pk_bf16_f32 v104, v47, v59
    v_add_u32 v11, 3072, v11
    s_add_u32 s63, s63, 512
    s_and_b32 s63, s63, 8191
    v_add_u32 v215, s63, v7
    v_add_u32 v216, s63, v8
    ds_read_b32 v214, v11 offset:0
    ds_read_u16 v217, v215 offset:8192
    ds_read_u16 v218, v216 offset:8192
    ds_read_u16 v215, v215
    ds_read_u16 v216, v216
    v_add_u32 v13, s62, v12
    s_add_u32 s62, s62, 24576
    s_cmp_eq_u32 s62, 73728
    s_cselect_b32 s62, 0, s62
    s_barrier
    ds_read_b128 v[36:39], v13 offset:0
    ds_read_b128 v[40:43], v13 offset:1024
    ds_read_b128 v[44:47], v13 offset:2048
    ds_read_b128 v[48:51], v13 offset:3072
    ds_read_b128 v[52:55], v13 offset:4096
    ds_read_b128 v[56:59], v13 offset:5120
    s_waitcnt lgkmcnt(3)
    v_cvt_f32_i32 v36, v36
    v_cvt_f32_i32 v37, v37
    v_cvt_f32_i32 v38, v38
    v_cvt_f32_i32 v39, v39
    v_cvt_f32_i32 v40, v40
    v_cvt_f32_i32 v41, v41
    v_cvt_f32_i32 v42, v42
    v_cvt_f32_i32 v43, v43
    v_cvt_f32_i32 v44, v44
    v_cvt_f32_i32 v45, v45
    v_cvt_f32_i32 v46, v46
    v_cvt_f32_i32 v47, v47
    s_waitcnt lgkmcnt(0)
    v_cvt_f32_i32 v48, v48
    v_cvt_f32_i32 v49, v49
    v_cvt_f32_i32 v50, v50
    v_cvt_f32_i32 v51, v51
    v_cvt_f32_i32 v52, v52
    v_cvt_f32_i32 v53, v53
    v_cvt_f32_i32 v54, v54
    v_cvt_f32_i32 v55, v55
    v_cvt_f32_i32 v56, v56
    v_cvt_f32_i32 v57, v57
    v_cvt_f32_i32 v58, v58
    v_cvt_f32_i32 v59, v59
    v_cvt_pk_bf16_f32 v61, v36, v48
    v_cvt_pk_bf16_f32 v65, v37, v49
    v_cvt_pk_bf16_f32 v69, v38, v50
    v_cvt_pk_bf16_f32 v73, v39, v51
    v_cvt_pk_bf16_f32 v77, v40, v52
    v_cvt_pk_bf16_f32 v81, v41, v53
    v_cvt_pk_bf16_f32 v85, v42, v54
    v_cvt_pk_bf16_f32 v89, v43, v55
    v_cvt_pk_bf16_f32 v93, v44, v56
    v_cvt_pk_bf16_f32 v97, v45, v57
    v_cvt_pk_bf16_f32 v101, v46, v58
    v_cvt_pk_bf16_f32 v105, v47, v59
    v_add_u32 v13, s62, v12
    s_add_u32 s62, s62, 24576
    s_cmp_eq_u32 s62, 73728
    s_cselect_b32 s62, 0, s62
    s_barrier
    ds_read_b128 v[36:39], v13 offset:0
    ds_read_b128 v[40:43], v13 offset:1024
    ds_read_b128 v[44:47], v13 offset:2048
    ds_read_b128 v[48:51], v13 offset:3072
    ds_read_b128 v[52:55], v13 offset:4096
    ds_read_b128 v[56:59], v13 offset:5120
    s_waitcnt lgkmcnt(3)
    v_cvt_f32_i32 v36, v36
    v_cvt_f32_i32 v37, v37
    v_cvt_f32_i32 v38, v38
    v_cvt_f32_i32 v39, v39
    v_cvt_f32_i32 v40, v40
    v_cvt_f32_i32 v41, v41
    v_cvt_f32_i32 v42, v42
    v_cvt_f32_i32 v43, v43
    v_cvt_f32_i32 v44, v44
    v_cvt_f32_i32 v45, v45
    v_cvt_f32_i32 v46, v46
    v_cvt_f32_i32 v47, v47
    s_waitcnt lgkmcnt(0)
    v_cvt_f32_i32 v48, v48
    v_cvt_f32_i32 v49, v49
    v_cvt_f32_i32 v50, v50
    v_cvt_f32_i32 v51, v51
    v_cvt_f32_i32 v52, v52
    v_cvt_f32_i32 v53, v53
    v_cvt_f32_i32 v54, v54
    v_cvt_f32_i32 v55, v55
    v_cvt_f32_i32 v56, v56
    v_cvt_f32_i32 v57, v57
    v_cvt_f32_i32 v58, v58
    v_cvt_f32_i32 v59, v59
    v_cvt_pk_bf16_f32 v62, v36, v48
    v_cvt_pk_bf16_f32 v66, v37, v49
    v_cvt_pk_bf16_f32 v70, v38, v50
    v_cvt_pk_bf16_f32 v74, v39, v51
    v_cvt_pk_bf16_f32 v78, v40, v52
    v_cvt_pk_bf16_f32 v82, v41, v53
    v_cvt_pk_bf16_f32 v86, v42, v54
    v_cvt_pk_bf16_f32 v90, v43, v55
    v_cvt_pk_bf16_f32 v94, v44, v56
    v_cvt_pk_bf16_f32 v98, v45, v57
    v_cvt_pk_bf16_f32 v102, v46, v58
    v_cvt_pk_bf16_f32 v106, v47, v59
    v_add_u32 v13, s62, v12
    s_add_u32 s62, s62, 24576
    s_cmp_eq_u32 s62, 73728
    s_cselect_b32 s62, 0, s62
    s_barrier
    ds_read_b128 v[36:39], v13 offset:0
    ds_read_b128 v[40:43], v13 offset:1024
    ds_read_b128 v[44:47], v13 offset:2048
    ds_read_b128 v[48:51], v13 offset:3072
    ds_read_b128 v[52:55], v13 offset:4096
    ds_read_b128 v[56:59], v13 offset:5120
    s_waitcnt lgkmcnt(3)
    v_cvt_f32_i32 v36, v36
    v_cvt_f32_i32 v37, v37
    v_cvt_f32_i32 v38, v38
    v_cvt_f32_i32 v39, v39
    v_cvt_f32_i32 v40, v40
    v_cvt_f32_i32 v41, v41
    v_cvt_f32_i32 v42, v42
    v_cvt_f32_i32 v43, v43
    v_cvt_f32_i32 v44, v44
    v_cvt_f32_i32 v45, v45
    v_cvt_f32_i32 v46, v46
    v_cvt_f32_i32 v47, v47
    s_waitcnt lgkmcnt(0)
    v_cvt_f32_i32 v48, v48
    v_cvt_f32_i32 v49, v49
    v_cvt_f32_i32 v50, v50
    v_cvt_f32_i32 v51, v51
    v_cvt_f32_i32 v52, v52
    v_cvt_f32_i32 v53, v53
    v_cvt_f32_i32 v54, v54
    v_cvt_f32_i32 v55, v55
    v_cvt_f32_i32 v56, v56
    v_cvt_f32_i32 v57, v57
    v_cvt_f32_i32 v58, v58
    v_cvt_f32_i32 v59, v59
    v_cvt_pk_bf16_f32 v63, v36, v48
    v_cvt_pk_bf16_f32 v67, v37, v49
    v_cvt_pk_bf16_f32 v71, v38, v50
    v_cvt_pk_bf16_f32 v75, v39, v51
    v_cvt_pk_bf16_f32 v79, v40, v52
    v_cvt_pk_bf16_f32 v83, v41, v53
    v_cvt_pk_bf16_f32 v87, v42, v54
    v_cvt_pk_bf16_f32 v91, v43, v55
    v_cvt_pk_bf16_f32 v95, v44, v56
    v_cvt_pk_bf16_f32 v99, v45, v57
    v_cvt_pk_bf16_f32 v103, v46, v58
    v_cvt_pk_bf16_f32 v107, v47, v59
    v_mfma_f32_16x16x32_bf16 v[160:163], v[208:211], v[60:63], v[160:163]
    v_mfma_f32_16x16x32_bf16 v[164:167], v[208:211], v[64:67], v[164:167]
    v_mfma_f32_16x16x32_bf16 v[168:171], v[208:211], v[68:71], v[168:171]
    v_mfma_f32_16x16x32_bf16 v[172:175], v[208:211], v[72:75], v[172:175]
    v_mfma_f32_16x16x32_bf16 v[176:179], v[208:211], v[76:79], v[176:179]
    v_mfma_f32_16x16x32_bf16 v[180:183], v[208:211], v[80:83], v[180:183]
    v_mfma_f32_16x16x32_bf16 v[184:187], v[208:211], v[84:87], v[184:187]
    v_mfma_f32_16x16x32_bf16 v[188:191], v[208:211], v[88:91], v[188:191]
    v_mfma_f32_16x16x32_bf16 v[192:195], v[208:211], v[92:95], v[192:195]
    v_mfma_f32_16x16x32_bf16 v[196:199], v[208:211], v[96:99], v[196:199]
    v_mfma_f32_16x16x32_bf16 v[200:203], v[208:211], v[100:103], v[200:203]
    v_mfma_f32_16x16x32_bf16 v[204:207], v[208:211], v[104:107], v[204:207]
    s_add_u32 s61, s61, 1
    s_cmp_lt_u32 s61, 16
    s_cbranch_scc1 L_vblk
    s_nop 1
    v_add_f32_dpp v212, v212, v212 row_ror:4 row_mask:0xf bank_mask:0xf
    s_nop 1
    v_add_f32_dpp v212, v212, v212 row_ror:8 row_mask:0xf bank_mask:0xf
    v_mov_b32 v3, v212
    s_nop 1
    v_permlane16_swap_b32 v212, v3
    v_add_f32 v212, v212, v3
    v_mov_b32 v3, v212
    s_nop 1
    v_permlane32_swap_b32 v212, v3
    v_add_f32 v212, v212, v3
    s_nop 1
    v_add_f32_dpp v213, v213, v213 row_ror:4 row_mask:0xf bank_mask:0xf
    s_nop 1
    v_add_f32_dpp v213, v213, v213 row_ror:8 row_mask:0xf bank_mask:0xf
    v_mov_b32 v3, v213
    s_nop 1
    v_permlane16_swap_b32 v213, v3
    v_add_f32 v213, v213, v3
    v_mov_b32 v3, v213
    s_nop 1
    v_permlane32_swap_b32 v213, v3
    v_add_f32 v213, v213, v3
    v_mov_b32 v36, v14
    v_mov_b32 v37, v212
    v_mov_b32 v38, v213
    v_mov_b32 v39, 0
    v_and_b32 v4, 3, v1
    v_lshl_add_u32 v4, v2, 2, v4
    v_lshlrev_b32 v4, 4, v4
    v_add_u32 v4, 142336, v4
    ds_write_b128 v4, v[36:39]
    v_permlane32_swap_b32 v160, v162
    v_permlane32_swap_b32 v161, v163
    v_permlane32_swap_b32 v164, v166
    v_permlane32_swap_b32 v165, v167
    v_permlane32_swap_b32 v168, v170
    v_permlane32_swap_b32 v169, v171
    v_permlane32_swap_b32 v172, v174
    v_permlane32_swap_b32 v173, v175
    v_permlane32_swap_b32 v176, v178
    v_permlane32_swap_b32 v177, v179
    v_permlane32_swap_b32 v180, v182
    v_permlane32_swap_b32 v181, v183
    v_permlane32_swap_b32 v184, v186
    v_permlane32_swap_b32 v185, v187
    v_permlane32_swap_b32 v188, v190
    v_permlane32_swap_b32 v189, v191
    v_permlane32_swap_b32 v192, v194
    v_permlane32_swap_b32 v193, v195
    v_permlane32_swap_b32 v196, v198
    v_permlane32_swap_b32 v197, v199
    v_permlane32_swap_b32 v200, v202
    v_permlane32_swap_b32 v201, v203
    v_permlane32_swap_b32 v204, v206
    v_permlane32_swap_b32 v205, v207
    v_add_f32 v160, v160, v162
    v_add_f32 v161, v161, v163
    v_add_f32 v164, v164, v166
    v_add_f32 v165, v165, v167
    v_add_f32 v168, v168, v170
    v_add_f32 v169, v169, v171
    v_add_f32 v172, v172, v174
    v_add_f32 v173, v173, v175
    v_add_f32 v176, v176, v178
    v_add_f32 v177, v177, v179
    v_add_f32 v180, v180, v182
    v_add_f32 v181, v181, v183
    v_add_f32 v184, v184, v186
    v_add_f32 v185, v185, v187
    v_add_f32 v188, v188, v190
    v_add_f32 v189, v189, v191
    v_add_f32 v192, v192, v194
    v_add_f32 v193, v193, v195
    v_add_f32 v196, v196, v198
    v_add_f32 v197, v197, v199
    v_add_f32 v200, v200, v202
    v_add_f32 v201, v201, v203
    v_add_f32 v204, v204, v206
    v_add_f32 v205, v205, v207
    s_nop 1
    v_permlane16_swap_b32 v160, v161
    v_permlane16_swap_b32 v164, v165
    v_permlane16_swap_b32 v168, v169
    v_permlane16_swap_b32 v172, v173
    v_permlane16_swap_b32 v176, v177
    v_permlane16_swap_b32 v180, v181
    v_permlane16_swap_b32 v184, v185
    v_permlane16_swap_b32 v188, v189
    v_permlane16_swap_b32 v192, v193
    v_permlane16_swap_b32 v196, v197
    v_permlane16_swap_b32 v200, v201
    v_permlane16_swap_b32 v204, v205
    v_add_f32 v40, v160, v161
    v_add_f32 v41, v164, v165
    v_add_f32 v42, v168, v169
    v_add_f32 v43, v172, v173
    v_add_f32 v44, v176, v177
    v_add_f32 v45, v180, v181
    v_add_f32 v46, v184, v185
    v_add_f32 v47, v188, v189
    v_add_f32 v48, v192, v193
    v_add_f32 v49, v196, v197
    v_add_f32 v50, v200, v201
    v_add_f32 v51, v204, v205
    v_lshrrev_b32 v3, 4, v1
    v_mul_u32_u24 v3, 768, v3
    v_and_b32 v4, 15, v1
    v_lshl_add_u32 v3, v4, 4, v3
    v_mul_u32_u24 v4, 3072, v2
    s_mov_b32 s58, 142592
    v_add3_u32 v4, v4, v3, s58
    ds_write_b128 v4, v[40:43] offset:0
    ds_write_b128 v4, v[44:47] offset:256
    ds_write_b128 v4, v[48:51] offset:512
    v_lshl_add_u32 v3, v2, 8, v3
    v_add_u32 v4, 142592, v3
    v_and_b32 v5, 48, v1
    v_add_u32 v5, 142336, v5
    s_waitcnt lgkmcnt(0)
    s_barrier
    s_cmp_eq_u32 s56, 3
    s_cbranch_scc1 L_fin
    ds_read_b128 v[36:39], v5 offset:0
    ds_read_b128 v[40:43], v5 offset:64
    ds_read_b128 v[44:47], v5 offset:128
    ds_read_b128 v[48:51], v5 offset:192
    ds_read_b128 v[160:163], v4 offset:0
    ds_read_b128 v[164:167], v4 offset:3072
    ds_read_b128 v[168:171], v4 offset:6144
    ds_read_b128 v[172:175], v4 offset:9216
    v_lshrrev_b32 v3, 1, v3
    s_mul_i32 s58, s2, 1536
    s_waitcnt lgkmcnt(4)
    v_max_f32 v14, v36, v40
    v_max3_f32 v14, v14, v44, v48
    v_sub_f32 v36, v36, v14
    v_sub_f32 v40, v40, v14
    v_sub_f32 v44, v44, v14
    v_sub_f32 v48, v48, v14
    v_exp_f32 v36, v36
    v_exp_f32 v40, v40
    v_exp_f32 v44, v44
    v_exp_f32 v48, v48
    s_nop 0
    v_mul_f32 v212, v36, v37
    v_fmac_f32 v212, v40, v41
    v_fmac_f32 v212, v44, v45
    v_fmac_f32 v212, v48, v49
    v_rcp_f32 v212, v212
    s_waitcnt lgkmcnt(0)
    v_sub_f32 v160, v160, v38
    v_mul_f32 v160, v160, v36
    v_sub_f32 v161, v161, v38
    v_mul_f32 v161, v161, v36
    v_sub_f32 v162, v162, v38
    v_mul_f32 v162, v162, v36
    v_sub_f32 v163, v163, v38
    v_mul_f32 v163, v163, v36
    v_sub_f32 v164, v164, v42
    v_fmac_f32 v160, v164, v40
    v_sub_f32 v165, v165, v42
    v_fmac_f32 v161, v165, v40
    v_sub_f32 v166, v166, v42
    v_fmac_f32 v162, v166, v40
    v_sub_f32 v167, v167, v42
    v_fmac_f32 v163, v167, v40
    v_sub_f32 v168, v168, v46
    v_fmac_f32 v160, v168, v44
    v_sub_f32 v169, v169, v46
    v_fmac_f32 v161, v169, v44
    v_sub_f32 v170, v170, v46
    v_fmac_f32 v162, v170, v44
    v_sub_f32 v171, v171, v46
    v_fmac_f32 v163, v171, v44
    v_sub_f32 v172, v172, v50
    v_fmac_f32 v160, v172, v48
    v_sub_f32 v173, v173, v50
    v_fmac_f32 v161, v173, v48
    v_sub_f32 v174, v174, v50
    v_fmac_f32 v162, v174, v48
    v_sub_f32 v175, v175, v50
    v_fmac_f32 v163, v175, v48
    v_mul_f32 v160, v160, v212
    v_mul_f32 v161, v161, v212
    v_mul_f32 v162, v162, v212
    v_mul_f32 v163, v163, v212
    v_cvt_pk_bf16_f32 v164, v160, v161
    v_cvt_pk_bf16_f32 v165, v162, v163
    buffer_store_dwordx2 v[164:165], v3, s[48:51], s58 offen
L_fin:
L_end:
    s_endpgm
.section .rodata,"a"
.p2align 6
.amdhsa_kernel standalone__kv_cache_quant_int4_int2_kv_with_per_channel_or_per_token_scales__sampling_kernel
  .amdhsa_next_free_vgpr 232
  .amdhsa_next_free_sgpr 100
  .amdhsa_accum_offset 232
  .amdhsa_group_segment_fixed_size 0
  .amdhsa_kernarg_size 80
  .amdhsa_user_sgpr_count 2
  .amdhsa_user_sgpr_kernarg_segment_ptr 1
  .amdhsa_system_sgpr_workgroup_id_x 1
  .amdhsa_float_denorm_mode_32 3
.end_amdhsa_kernel
```

```asm
; @launch grid=(256,1,1) block=(384,1,1) lds=154880
.amdgcn_target "amdgcn-amd-amdhsa--gfx950"
.text
.globl standalone__kv_cache_quant_int4_int2_kv_with_per_channel_or_per_token_scales__sampling_kernel
.p2align 8
.type standalone__kv_cache_quant_int4_int2_kv_with_per_channel_or_per_token_scales__sampling_kernel,@function
standalone__kv_cache_quant_int4_int2_kv_with_per_channel_or_per_token_scales__sampling_kernel:
    s_cmp_ge_u32 s2, 256
    s_cbranch_scc1 L_end
    s_load_dwordx16 s[4:19], s[0:1], 0
    s_load_dwordx4 s[20:23], s[0:1], 64
    v_lshrrev_b32 v2, 6, v0
    v_and_b32 v1, 63, v0
    v_readfirstlane_b32 s56, v2
    s_mov_b32 s67, 768
    s_mul_i32 s100, s2, 43691
    s_lshr_b32 s100, s100, 17
    s_mul_i32 s101, s100, 3
    s_sub_u32 s101, s2, s101
    s_cmp_eq_u32 s2, 255
    s_cselect_b32 s73, 16, 11
    s_cmp_eq_u32 s101, 1
    s_cselect_b32 s3, 5, s73
    s_cselect_b32 s73, 10, s73
    s_mul_i32 s58, s101, 21
    s_add_u32 s58, s58, 1
    s_lshr_b32 s58, s58, 1
    s_lshl_b32 s59, s100, 5
    s_add_u32 s57, s58, s59
    s_mul_i32 s58, s101, 11
    s_lshr_b32 s58, s58, 1
    s_lshl_b32 s59, s100, 4
    s_add_u32 s58, s58, s59
    s_add_u32 s58, s58, 2736
    s_sub_u32 s58, s58, s73
    v_cmp_le_u32 vcc, s73, v1
    v_add_u32 v3, s57, v1
    v_add_u32 v4, s58, v1
    v_cndmask_b32 v152, v3, v4, vcc
    s_cmp_eq_u32 s56, 5
    s_cbranch_scc1 L_finisher
    s_cmp_eq_u32 s56, 4
    s_cbranch_scc0 L_consumer
    s_setprio 3
    v_bfe_u32 v8, v1, 2, 1
    v_bfe_u32 v9, v1, 3, 1
    v_lshrrev_b32 v13, 4, v1
    v_and_b32 v14, 3, v1
    v_lshl_add_u32 v10, v13, 2, v14
    v_lshlrev_b32 v10, 4, v10
    s_mov_b32 s68, 0
    s_mov_b32 s69, 0
    s_mul_i32 s57, s57, 196608
    s_waitcnt lgkmcnt(0)
    s_mov_b32 s24, s6
    s_and_b32 s25, s7, 0xffff
    s_mov_b32 s26, 805306368
    s_mov_b32 s27, 0x20000
    s_and_b32 s58, s68, 63
    v_lshl_add_u32 v12, s58, 1, v8
    v_cmp_le_u32 vcc, 43, v12
    v_add_u32 v13, 43, v12
    v_mov_b32 v14, 42
    v_cndmask_b32 v11, v12, v13, vcc
    v_cmp_le_u32 vcc, 86, v12
    v_add_u32 v13, 43, v11
    s_nop 0
    v_cndmask_b32 v11, v11, v13, vcc
    v_cndmask_b32 v14, 43, v14, vcc
    v_mad_u32_u24 v11, v14, v9, v11
    v_mad_u32_u24 v11, v11, s67, v10
    s_mov_b32 m0, s69
    s_nop 0
    buffer_load_dwordx4 v11, s[24:27], s57 offen offset:0 nt lds
    s_add_u32 m0, m0, 768
    s_add_u32 s69, s69, 3072
    buffer_load_dwordx4 v11, s[24:27], s57 offen offset:256 nt lds
    s_add_u32 m0, m0, 768
    s_add_u32 s68, s68, 1
    buffer_load_dwordx4 v11, s[24:27], s57 offen offset:512 nt lds
    s_and_b32 s58, s68, 63
    v_lshl_add_u32 v12, s58, 1, v8
    v_cmp_le_u32 vcc, 43, v12
    v_add_u32 v13, 43, v12
    v_mov_b32 v14, 42
    v_cndmask_b32 v11, v12, v13, vcc
    v_cmp_le_u32 vcc, 86, v12
    v_add_u32 v13, 43, v11
    s_nop 0
    v_cndmask_b32 v11, v11, v13, vcc
    v_cndmask_b32 v14, 43, v14, vcc
    v_mad_u32_u24 v11, v14, v9, v11
    v_mad_u32_u24 v11, v11, s67, v10
    s_mov_b32 m0, s69
    s_nop 0
    buffer_load_dwordx4 v11, s[24:27], s57 offen offset:0 nt lds
    s_add_u32 m0, m0, 768
    s_add_u32 s69, s69, 3072
    buffer_load_dwordx4 v11, s[24:27], s57 offen offset:256 nt lds
    s_add_u32 m0, m0, 768
    s_add_u32 s68, s68, 1
    buffer_load_dwordx4 v11, s[24:27], s57 offen offset:512 nt lds
    s_and_b32 s58, s68, 63
    v_lshl_add_u32 v12, s58, 1, v8
    v_cmp_le_u32 vcc, 43, v12
    v_add_u32 v13, 43, v12
    v_mov_b32 v14, 42
    v_cndmask_b32 v11, v12, v13, vcc
    v_cmp_le_u32 vcc, 86, v12
    v_add_u32 v13, 43, v11
    s_nop 0
    v_cndmask_b32 v11, v11, v13, vcc
    v_cndmask_b32 v14, 43, v14, vcc
    v_mad_u32_u24 v11, v14, v9, v11
    v_mad_u32_u24 v11, v11, s67, v10
    s_mov_b32 m0, s69
    s_nop 0
    buffer_load_dwordx4 v11, s[24:27], s57 offen offset:0 nt lds
    s_add_u32 m0, m0, 768
    s_add_u32 s69, s69, 3072
    buffer_load_dwordx4 v11, s[24:27], s57 offen offset:256 nt lds
    s_add_u32 m0, m0, 768
    s_add_u32 s68, s68, 1
    buffer_load_dwordx4 v11, s[24:27], s57 offen offset:512 nt lds
    s_and_b32 s58, s68, 63
    v_lshl_add_u32 v12, s58, 1, v8
    v_cmp_le_u32 vcc, 43, v12
    v_add_u32 v13, 43, v12
    v_mov_b32 v14, 42
    v_cndmask_b32 v11, v12, v13, vcc
    v_cmp_le_u32 vcc, 86, v12
    v_add_u32 v13, 43, v11
    s_nop 0
    v_cndmask_b32 v11, v11, v13, vcc
    v_cndmask_b32 v14, 43, v14, vcc
    v_mad_u32_u24 v11, v14, v9, v11
    v_mad_u32_u24 v11, v11, s67, v10
    s_mov_b32 m0, s69
    s_nop 0
    buffer_load_dwordx4 v11, s[24:27], s57 offen offset:0 nt lds
    s_add_u32 m0, m0, 768
    s_add_u32 s69, s69, 3072
    buffer_load_dwordx4 v11, s[24:27], s57 offen offset:256 nt lds
    s_add_u32 m0, m0, 768
    s_add_u32 s68, s68, 1
    buffer_load_dwordx4 v11, s[24:27], s57 offen offset:512 nt lds
    s_and_b32 s58, s68, 63
    v_lshl_add_u32 v12, s58, 1, v8
    v_cmp_le_u32 vcc, 43, v12
    v_add_u32 v13, 43, v12
    v_mov_b32 v14, 42
    v_cndmask_b32 v11, v12, v13, vcc
    v_cmp_le_u32 vcc, 86, v12
    v_add_u32 v13, 43, v11
    s_nop 0
    v_cndmask_b32 v11, v11, v13, vcc
    v_cndmask_b32 v14, 43, v14, vcc
    v_mad_u32_u24 v11, v14, v9, v11
    v_mad_u32_u24 v11, v11, s67, v10
    s_mov_b32 m0, s69
    s_nop 0
    buffer_load_dwordx4 v11, s[24:27], s57 offen offset:0 nt lds
    s_add_u32 m0, m0, 768
    s_add_u32 s69, s69, 3072
    buffer_load_dwordx4 v11, s[24:27], s57 offen offset:256 nt lds
    s_add_u32 m0, m0, 768
    s_add_u32 s68, s68, 1
    buffer_load_dwordx4 v11, s[24:27], s57 offen offset:512 nt lds
    s_and_b32 s58, s68, 63
    v_lshl_add_u32 v12, s58, 1, v8
    v_cmp_le_u32 vcc, 43, v12
    v_add_u32 v13, 43, v12
    v_mov_b32 v14, 42
    v_cndmask_b32 v11, v12, v13, vcc
    v_cmp_le_u32 vcc, 86, v12
    v_add_u32 v13, 43, v11
    s_nop 0
    v_cndmask_b32 v11, v11, v13, vcc
    v_cndmask_b32 v14, 43, v14, vcc
    v_mad_u32_u24 v11, v14, v9, v11
    v_mad_u32_u24 v11, v11, s67, v10
    s_mov_b32 m0, s69
    s_nop 0
    buffer_load_dwordx4 v11, s[24:27], s57 offen offset:0 nt lds
    s_add_u32 m0, m0, 768
    s_add_u32 s69, s69, 3072
    buffer_load_dwordx4 v11, s[24:27], s57 offen offset:256 nt lds
    s_add_u32 m0, m0, 768
    s_add_u32 s68, s68, 1
    buffer_load_dwordx4 v11, s[24:27], s57 offen offset:512 nt lds
    s_mov_b32 s70, 3
    s_mov_b32 s52, s22
    s_and_b32 s53, s23, 0xffff
    s_mov_b32 s54, 16785664
    s_mov_b32 s55, 0x20000
    s_mov_b32 s71, 0
    s_mov_b32 s74, 0
    s_add_u32 s98, s22, 16777216
    s_addc_u32 s99, s23, 0
    s_lshl_b32 s59, s2, 2
    s_add_u32 s59, s59, 16777216
    v_mov_b32 v16, s59
    s_memrealtime s[96:97]
    s_branch L_lsel
L_ldisp:
    s_cmp_eq_u32 s69, 73728
    s_cselect_b32 s69, 0, s69
    s_cmp_le_u32 s68, 16
    s_cbranch_scc1 L_lfirst
L_lbar:
    s_barrier
L_lnobar:
    s_bfe_u32 s58, s68, 196611
    s_cmp_eq_u32 s58, 0
    s_cbranch_scc1 L_lev0
    s_cmp_eq_u32 s58, 1
    s_cbranch_scc1 L_lev1
    s_cmp_eq_u32 s58, 6
    s_cbranch_scc1 L_lev6
    s_cmp_eq_u32 s58, 7
    s_cbranch_scc1 L_lev7
L_lsel:
    s_cmp_eq_u32 s70, 0
    s_cbranch_scc1 L_lvl0
    s_cmp_eq_u32 s70, 1
    s_cbranch_scc1 L_lvl1
    s_cmp_eq_u32 s70, 2
    s_cbranch_scc1 L_lvl2
    s_cmp_eq_u32 s70, 3
    s_cbranch_scc1 L_lvl3
    s_cmp_eq_u32 s70, 4
    s_cbranch_scc1 L_lvl4
    s_cmp_eq_u32 s70, 5
    s_cbranch_scc1 L_lvl5
L_lvl6:
    s_and_b32 s58, s68, 63
    v_lshl_add_u32 v12, s58, 1, v8
    v_cmp_le_u32 vcc, 43, v12
    v_add_u32 v13, 43, v12
    v_mov_b32 v14, 42
    v_cndmask_b32 v11, v12, v13, vcc
    v_cmp_le_u32 vcc, 86, v12
    v_add_u32 v13, 43, v11
    s_nop 0
    v_cndmask_b32 v11, v11, v13, vcc
    v_cndmask_b32 v14, 43, v14, vcc
    v_mad_u32_u24 v11, v14, v9, v11
    v_mad_u32_u24 v11, v11, s67, v10
    s_mov_b32 m0, s69
    s_waitcnt vmcnt(16)
    buffer_load_dwordx4 v11, s[24:27], s57 offen offset:0 nt lds
    s_add_u32 m0, m0, 768
    s_add_u32 s69, s69, 3072
    buffer_load_dwordx4 v11, s[24:27], s57 offen offset:256 nt lds
    s_add_u32 m0, m0, 768
    s_add_u32 s68, s68, 1
    buffer_load_dwordx4 v11, s[24:27], s57 offen offset:512 nt lds
    s_and_b32 s58, s68, 63
    v_lshl_add_u32 v12, s58, 1, v8
    v_cmp_le_u32 vcc, 43, v12
    v_add_u32 v13, 43, v12
    v_mov_b32 v14, 42
    v_cndmask_b32 v11, v12, v13, vcc
    v_cmp_le_u32 vcc, 86, v12
    v_add_u32 v13, 43, v11
    s_nop 0
    v_cndmask_b32 v11, v11, v13, vcc
    v_cndmask_b32 v14, 43, v14, vcc
    v_mad_u32_u24 v11, v14, v9, v11
    v_mad_u32_u24 v11, v11, s67, v10
    s_mov_b32 m0, s69
    s_waitcnt vmcnt(17)
    buffer_load_dwordx4 v11, s[24:27], s57 offen offset:0 nt lds
    s_add_u32 m0, m0, 768
    s_add_u32 s69, s69, 3072
    buffer_load_dwordx4 v11, s[24:27], s57 offen offset:256 nt lds
    s_add_u32 m0, m0, 768
    s_add_u32 s68, s68, 1
    buffer_load_dwordx4 v11, s[24:27], s57 offen offset:512 nt lds
    s_and_b32 s58, s68, 7
    s_cbranch_scc1 L_lvl6
    s_branch L_ldisp
L_lvl5:
    s_and_b32 s58, s68, 63
    v_lshl_add_u32 v12, s58, 1, v8
    v_cmp_le_u32 vcc, 43, v12
    v_add_u32 v13, 43, v12
    v_mov_b32 v14, 42
    v_cndmask_b32 v11, v12, v13, vcc
    v_cmp_le_u32 vcc, 86, v12
    v_add_u32 v13, 43, v11
    s_nop 0
    v_cndmask_b32 v11, v11, v13, vcc
    v_cndmask_b32 v14, 43, v14, vcc
    v_mad_u32_u24 v11, v14, v9, v11
    v_mad_u32_u24 v11, v11, s67, v10
    s_mov_b32 m0, s69
    s_waitcnt vmcnt(17)
    buffer_load_dwordx4 v11, s[24:27], s57 offen offset:0 nt lds
    s_add_u32 m0, m0, 768
    s_add_u32 s69, s69, 3072
    buffer_load_dwordx4 v11, s[24:27], s57 offen offset:256 nt lds
    s_add_u32 m0, m0, 768
    s_add_u32 s68, s68, 1
    buffer_load_dwordx4 v11, s[24:27], s57 offen offset:512 nt lds
    s_and_b32 s58, s68, 63
    v_lshl_add_u32 v12, s58, 1, v8
    v_cmp_le_u32 vcc, 43, v12
    v_add_u32 v13, 43, v12
    v_mov_b32 v14, 42
    v_cndmask_b32 v11, v12, v13, vcc
    v_cmp_le_u32 vcc, 86, v12
    v_add_u32 v13, 43, v11
    s_nop 0
    v_cndmask_b32 v11, v11, v13, vcc
    v_cndmask_b32 v14, 43, v14, vcc
    v_mad_u32_u24 v11, v14, v9, v11
    v_mad_u32_u24 v11, v11, s67, v10
    s_mov_b32 m0, s69
    s_waitcnt vmcnt(17)
    buffer_load_dwordx4 v11, s[24:27], s57 offen offset:0 nt lds
    s_add_u32 m0, m0, 768
    s_add_u32 s69, s69, 3072
    buffer_load_dwordx4 v11, s[24:27], s57 offen offset:256 nt lds
    s_add_u32 m0, m0, 768
    s_add_u32 s68, s68, 1
    buffer_load_dwordx4 v11, s[24:27], s57 offen offset:512 nt lds
    s_and_b32 s58, s68, 7
    s_cbranch_scc1 L_lvl5
    s_branch L_ldisp
L_lvl4:
    s_and_b32 s58, s68, 63
    v_lshl_add_u32 v12, s58, 1, v8
    v_cmp_le_u32 vcc, 43, v12
    v_add_u32 v13, 43, v12
    v_mov_b32 v14, 42
    v_cndmask_b32 v11, v12, v13, vcc
    v_cmp_le_u32 vcc, 86, v12
    v_add_u32 v13, 43, v11
    s_nop 0
    v_cndmask_b32 v11, v11, v13, vcc
    v_cndmask_b32 v14, 43, v14, vcc
    v_mad_u32_u24 v11, v14, v9, v11
    v_mad_u32_u24 v11, v11, s67, v10
    s_mov_b32 m0, s69
    s_waitcnt vmcnt(17)
    buffer_load_dwordx4 v11, s[24:27], s57 offen offset:0 nt lds
    s_add_u32 m0, m0, 768
    s_add_u32 s69, s69, 3072
    buffer_load_dwordx4 v11, s[24:27], s57 offen offset:256 nt lds
    s_add_u32 m0, m0, 768
    s_add_u32 s68, s68, 1
    buffer_load_dwordx4 v11, s[24:27], s57 offen offset:512 nt lds
    s_and_b32 s58, s68, 63
    v_lshl_add_u32 v12, s58, 1, v8
    v_cmp_le_u32 vcc, 43, v12
    v_add_u32 v13, 43, v12
    v_mov_b32 v14, 42
    v_cndmask_b32 v11, v12, v13, vcc
    v_cmp_le_u32 vcc, 86, v12
    v_add_u32 v13, 43, v11
    s_nop 0
    v_cndmask_b32 v11, v11, v13, vcc
    v_cndmask_b32 v14, 43, v14, vcc
    v_mad_u32_u24 v11, v14, v9, v11
    v_mad_u32_u24 v11, v11, s67, v10
    s_mov_b32 m0, s69
    s_waitcnt vmcnt(18)
    buffer_load_dwordx4 v11, s[24:27], s57 offen offset:0 nt lds
    s_add_u32 m0, m0, 768
    s_add_u32 s69, s69, 3072
    buffer_load_dwordx4 v11, s[24:27], s57 offen offset:256 nt lds
    s_add_u32 m0, m0, 768
    s_add_u32 s68, s68, 1
    buffer_load_dwordx4 v11, s[24:27], s57 offen offset:512 nt lds
    s_and_b32 s58, s68, 7
    s_cbranch_scc1 L_lvl4
    s_branch L_ldisp
L_lvl3:
    s_and_b32 s58, s68, 63
    v_lshl_add_u32 v12, s58, 1, v8
    v_cmp_le_u32 vcc, 43, v12
    v_add_u32 v13, 43, v12
    v_mov_b32 v14, 42
    v_cndmask_b32 v11, v12, v13, vcc
    v_cmp_le_u32 vcc, 86, v12
    v_add_u32 v13, 43, v11
    s_nop 0
    v_cndmask_b32 v11, v11, v13, vcc
    v_cndmask_b32 v14, 43, v14, vcc
    v_mad_u32_u24 v11, v14, v9, v11
    v_mad_u32_u24 v11, v11, s67, v10
    s_mov_b32 m0, s69
    s_waitcnt vmcnt(18)
    buffer_load_dwordx4 v11, s[24:27], s57 offen offset:0 nt lds
    s_add_u32 m0, m0, 768
    s_add_u32 s69, s69, 3072
    buffer_load_dwordx4 v11, s[24:27], s57 offen offset:256 nt lds
    s_add_u32 m0, m0, 768
    s_add_u32 s68, s68, 1
    buffer_load_dwordx4 v11, s[24:27], s57 offen offset:512 nt lds
    s_and_b32 s58, s68, 63
    v_lshl_add_u32 v12, s58, 1, v8
    v_cmp_le_u32 vcc, 43, v12
    v_add_u32 v13, 43, v12
    v_mov_b32 v14, 42
    v_cndmask_b32 v11, v12, v13, vcc
    v_cmp_le_u32 vcc, 86, v12
    v_add_u32 v13, 43, v11
    s_nop 0
    v_cndmask_b32 v11, v11, v13, vcc
    v_cndmask_b32 v14, 43, v14, vcc
    v_mad_u32_u24 v11, v14, v9, v11
    v_mad_u32_u24 v11, v11, s67, v10
    s_mov_b32 m0, s69
    s_waitcnt vmcnt(18)
    buffer_load_dwordx4 v11, s[24:27], s57 offen offset:0 nt lds
    s_add_u32 m0, m0, 768
    s_add_u32 s69, s69, 3072
    buffer_load_dwordx4 v11, s[24:27], s57 offen offset:256 nt lds
    s_add_u32 m0, m0, 768
    s_add_u32 s68, s68, 1
    buffer_load_dwordx4 v11, s[24:27], s57 offen offset:512 nt lds
    s_and_b32 s58, s68, 7
    s_cbranch_scc1 L_lvl3
    s_branch L_ldisp
L_lvl2:
    s_and_b32 s58, s68, 63
    v_lshl_add_u32 v12, s58, 1, v8
    v_cmp_le_u32 vcc, 43, v12
    v_add_u32 v13, 43, v12
    v_mov_b32 v14, 42
    v_cndmask_b32 v11, v12, v13, vcc
    v_cmp_le_u32 vcc, 86, v12
    v_add_u32 v13, 43, v11
    s_nop 0
    v_cndmask_b32 v11, v11, v13, vcc
    v_cndmask_b32 v14, 43, v14, vcc
    v_mad_u32_u24 v11, v14, v9, v11
    v_mad_u32_u24 v11, v11, s67, v10
    s_mov_b32 m0, s69
    s_waitcnt vmcnt(18)
    buffer_load_dwordx4 v11, s[24:27], s57 offen offset:0 nt lds
    s_add_u32 m0, m0, 768
    s_add_u32 s69, s69, 3072
    buffer_load_dwordx4 v11, s[24:27], s57 offen offset:256 nt lds
    s_add_u32 m0, m0, 768
    s_add_u32 s68, s68, 1
    buffer_load_dwordx4 v11, s[24:27], s57 offen offset:512 nt lds
    s_and_b32 s58, s68, 63
    v_lshl_add_u32 v12, s58, 1, v8
    v_cmp_le_u32 vcc, 43, v12
    v_add_u32 v13, 43, v12
    v_mov_b32 v14, 42
    v_cndmask_b32 v11, v12, v13, vcc
    v_cmp_le_u32 vcc, 86, v12
    v_add_u32 v13, 43, v11
    s_nop 0
    v_cndmask_b32 v11, v11, v13, vcc
    v_cndmask_b32 v14, 43, v14, vcc
    v_mad_u32_u24 v11, v14, v9, v11
    v_mad_u32_u24 v11, v11, s67, v10
    s_mov_b32 m0, s69
    s_waitcnt vmcnt(19)
    buffer_load_dwordx4 v11, s[24:27], s57 offen offset:0 nt lds
    s_add_u32 m0, m0, 768
    s_add_u32 s69, s69, 3072
    buffer_load_dwordx4 v11, s[24:27], s57 offen offset:256 nt lds
    s_add_u32 m0, m0, 768
    s_add_u32 s68, s68, 1
    buffer_load_dwordx4 v11, s[24:27], s57 offen offset:512 nt lds
    s_and_b32 s58, s68, 7
    s_cbranch_scc1 L_lvl2
    s_branch L_ldisp
L_lvl1:
    s_and_b32 s58, s68, 63
    v_lshl_add_u32 v12, s58, 1, v8
    v_cmp_le_u32 vcc, 43, v12
    v_add_u32 v13, 43, v12
    v_mov_b32 v14, 42
    v_cndmask_b32 v11, v12, v13, vcc
    v_cmp_le_u32 vcc, 86, v12
    v_add_u32 v13, 43, v11
    s_nop 0
    v_cndmask_b32 v11, v11, v13, vcc
    v_cndmask_b32 v14, 43, v14, vcc
    v_mad_u32_u24 v11, v14, v9, v11
    v_mad_u32_u24 v11, v11, s67, v10
    s_mov_b32 m0, s69
    s_waitcnt vmcnt(19)
    buffer_load_dwordx4 v11, s[24:27], s57 offen offset:0 nt lds
    s_add_u32 m0, m0, 768
    s_add_u32 s69, s69, 3072
    buffer_load_dwordx4 v11, s[24:27], s57 offen offset:256 nt lds
    s_add_u32 m0, m0, 768
    s_add_u32 s68, s68, 1
    buffer_load_dwordx4 v11, s[24:27], s57 offen offset:512 nt lds
    s_and_b32 s58, s68, 63
    v_lshl_add_u32 v12, s58, 1, v8
    v_cmp_le_u32 vcc, 43, v12
    v_add_u32 v13, 43, v12
    v_mov_b32 v14, 42
    v_cndmask_b32 v11, v12, v13, vcc
    v_cmp_le_u32 vcc, 86, v12
    v_add_u32 v13, 43, v11
    s_nop 0
    v_cndmask_b32 v11, v11, v13, vcc
    v_cndmask_b32 v14, 43, v14, vcc
    v_mad_u32_u24 v11, v14, v9, v11
    v_mad_u32_u24 v11, v11, s67, v10
    s_mov_b32 m0, s69
    s_waitcnt vmcnt(19)
    buffer_load_dwordx4 v11, s[24:27], s57 offen offset:0 nt lds
    s_add_u32 m0, m0, 768
    s_add_u32 s69, s69, 3072
    buffer_load_dwordx4 v11, s[24:27], s57 offen offset:256 nt lds
    s_add_u32 m0, m0, 768
    s_add_u32 s68, s68, 1
    buffer_load_dwordx4 v11, s[24:27], s57 offen offset:512 nt lds
    s_and_b32 s58, s68, 7
    s_cbranch_scc1 L_lvl1
    s_branch L_ldisp
L_lvl0:
    s_and_b32 s58, s68, 63
    v_lshl_add_u32 v12, s58, 1, v8
    v_cmp_le_u32 vcc, 43, v12
    v_add_u32 v13, 43, v12
    v_mov_b32 v14, 42
    v_cndmask_b32 v11, v12, v13, vcc
    v_cmp_le_u32 vcc, 86, v12
    v_add_u32 v13, 43, v11
    s_nop 0
    v_cndmask_b32 v11, v11, v13, vcc
    v_cndmask_b32 v14, 43, v14, vcc
    v_mad_u32_u24 v11, v14, v9, v11
    v_mad_u32_u24 v11, v11, s67, v10
    s_mov_b32 m0, s69
    s_waitcnt vmcnt(19)
    buffer_load_dwordx4 v11, s[24:27], s57 offen offset:0 nt lds
    s_add_u32 m0, m0, 768
    s_add_u32 s69, s69, 3072
    buffer_load_dwordx4 v11, s[24:27], s57 offen offset:256 nt lds
    s_add_u32 m0, m0, 768
    s_add_u32 s68, s68, 1
    buffer_load_dwordx4 v11, s[24:27], s57 offen offset:512 nt lds
    s_and_b32 s58, s68, 63
    v_lshl_add_u32 v12, s58, 1, v8
    v_cmp_le_u32 vcc, 43, v12
    v_add_u32 v13, 43, v12
    v_mov_b32 v14, 42
    v_cndmask_b32 v11, v12, v13, vcc
    v_cmp_le_u32 vcc, 86, v12
    v_add_u32 v13, 43, v11
    s_nop 0
    v_cndmask_b32 v11, v11, v13, vcc
    v_cndmask_b32 v14, 43, v14, vcc
    v_mad_u32_u24 v11, v14, v9, v11
    v_mad_u32_u24 v11, v11, s67, v10
    s_mov_b32 m0, s69
    s_waitcnt vmcnt(20)
    buffer_load_dwordx4 v11, s[24:27], s57 offen offset:0 nt lds
    s_add_u32 m0, m0, 768
    s_add_u32 s69, s69, 3072
    buffer_load_dwordx4 v11, s[24:27], s57 offen offset:256 nt lds
    s_add_u32 m0, m0, 768
    s_add_u32 s68, s68, 1
    buffer_load_dwordx4 v11, s[24:27], s57 offen offset:512 nt lds
    s_and_b32 s58, s68, 7
    s_cbranch_scc1 L_lvl0
    s_branch L_ldisp
L_lev0:
    s_cmp_eq_u32 s68, 2048
    s_cbranch_scc1 L_ldone
    s_memrealtime s[96:97]
    s_bfe_u32 s58, s68, 262150
    v_readlane_b32 s57, v152, s58
    s_nop 3
    s_mul_i32 s57, s57, 196608
    s_cmp_eq_u32 s68, 1024
    s_cbranch_scc0 L_lsel
    s_mov_b32 s24, s8
    s_and_b32 s25, s9, 0xffff
    v_bfe_u32 v8, v1, 4, 1
    v_lshrrev_b32 v9, 5, v1
    v_and_b32 v10, 15, v1
    v_lshlrev_b32 v10, 4, v10
    s_branch L_lsel
L_lfirst:
    s_cmp_eq_u32 s68, 8
    s_cbranch_scc1 L_lnobar
    s_barrier
    s_branch L_lbar
L_lev1:
    s_waitcnt lgkmcnt(0)
    s_cmp_lt_u32 s2, 8
    s_cbranch_scc0 L_lsel
    v_mov_b32 v17, s96
    s_mov_b64 exec, 1
    buffer_store_dword v17, v16, s[52:55], s71 offen sc1
    s_mov_b64 exec, -1
    s_branch L_lsel
L_lev6:
    s_load_dwordx8 s[84:91], s[98:99], s71
    s_add_u32 s71, s71, 256
    s_branch L_lsel
L_lev7:
    s_waitcnt lgkmcnt(0)
    s_mov_b32 s58, 0
    s_sub_i32 s59, s84, s96
    s_add_i32 s60, s59, 5000
    s_cmp_lt_u32 s60, 10000
    s_cselect_b32 s59, s59, 450
    s_add_i32 s58, s58, s59
    s_sub_i32 s59, s85, s96
    s_add_i32 s60, s59, 5000
    s_cmp_lt_u32 s60, 10000
    s_cselect_b32 s59, s59, 450
    s_add_i32 s58, s58, s59
    s_sub_i32 s59, s86, s96
    s_add_i32 s60, s59, 5000
    s_cmp_lt_u32 s60, 10000
    s_cselect_b32 s59, s59, 450
    s_add_i32 s58, s58, s59
    s_sub_i32 s59, s87, s96
    s_add_i32 s60, s59, 5000
    s_cmp_lt_u32 s60, 10000
    s_cselect_b32 s59, s59, 450
    s_add_i32 s58, s58, s59
    s_sub_i32 s59, s88, s96
    s_add_i32 s60, s59, 5000
    s_cmp_lt_u32 s60, 10000
    s_cselect_b32 s59, s59, 450
    s_add_i32 s58, s58, s59
    s_sub_i32 s59, s89, s96
    s_add_i32 s60, s59, 5000
    s_cmp_lt_u32 s60, 10000
    s_cselect_b32 s59, s59, 450
    s_add_i32 s58, s58, s59
    s_sub_i32 s59, s90, s96
    s_add_i32 s60, s59, 5000
    s_cmp_lt_u32 s60, 10000
    s_cselect_b32 s59, s59, 450
    s_add_i32 s58, s58, s59
    s_sub_i32 s59, s91, s96
    s_add_i32 s60, s59, 5000
    s_cmp_lt_u32 s60, 10000
    s_cselect_b32 s59, s59, 450
    s_add_i32 s58, s58, s59
    s_mul_i32 s58, s58, 8
    s_add_i32 s58, s58, 14336
    s_ashr_i32 s58, s58, 12
    s_max_i32 s58, s58, 0
    s_min_i32 s70, s58, 6
    s_branch L_lsel
L_ldone:
    s_waitcnt vmcnt(0)
    s_barrier
    s_endpgm
L_consumer:
    v_lshrrev_b32 v3, 2, v1
    v_lshlrev_b32 v3, 3, v3
    v_and_b32 v4, 3, v1
    v_mul_u32_u24 v5, 384, v4
    v_add_u32 v3, v3, v5
    v_lshlrev_b32 v6, 4, v1
    s_mul_i32 s63, s56, 3072
    s_add_u32 s63, s63, 76800
    s_add_u32 s58, s56, 0
    v_readlane_b32 s84, v152, s58
    s_add_u32 s58, s56, 4
    v_readlane_b32 s85, v152, s58
    s_add_u32 s58, s56, 8
    v_readlane_b32 s86, v152, s58
    s_add_u32 s58, s56, 12
    v_readlane_b32 s87, v152, s58
    v_readlane_b32 s88, v152, 0
    s_min_u32 s58, s3, 15
    v_readlane_b32 s89, v152, s58
    v_readlane_b32 s90, v152, 15
    s_waitcnt lgkmcnt(0)
    s_mov_b32 s32, s12
    s_and_b32 s33, s13, 0xffff
    s_mov_b32 s34, 6291456
    s_mov_b32 s35, 0x20000
    s_mov_b32 s28, s10
    s_and_b32 s29, s11, 0xffff
    s_mov_b32 s30, 6291456
    s_mov_b32 s31, 0x20000
    s_mov_b32 exec_hi, 0xffff
    s_add_u32 m0, s63, 0
    s_mul_i32 s58, s84, 1536
    buffer_load_dwordx4 v6, s[32:35], s58 offen nt lds
    buffer_load_dwordx4 v6, s[32:35], s58 offen offset:768 nt lds
    s_add_u32 m0, m0, 1536
    s_nop 0
    buffer_load_dwordx4 v6, s[28:31], s58 offen nt lds
    buffer_load_dwordx4 v6, s[28:31], s58 offen offset:768 nt lds
    s_add_u32 m0, s63, 12288
    s_mul_i32 s58, s85, 1536
    buffer_load_dwordx4 v6, s[32:35], s58 offen nt lds
    buffer_load_dwordx4 v6, s[32:35], s58 offen offset:768 nt lds
    s_add_u32 m0, m0, 1536
    s_nop 0
    buffer_load_dwordx4 v6, s[28:31], s58 offen nt lds
    buffer_load_dwordx4 v6, s[28:31], s58 offen offset:768 nt lds
    s_add_u32 m0, s63, 24576
    s_mul_i32 s58, s86, 1536
    buffer_load_dwordx4 v6, s[32:35], s58 offen nt lds
    buffer_load_dwordx4 v6, s[32:35], s58 offen offset:768 nt lds
    s_add_u32 m0, m0, 1536
    s_nop 0
    buffer_load_dwordx4 v6, s[28:31], s58 offen nt lds
    buffer_load_dwordx4 v6, s[28:31], s58 offen offset:768 nt lds
    s_add_u32 m0, s63, 36864
    s_mul_i32 s58, s87, 1536
    buffer_load_dwordx4 v6, s[32:35], s58 offen nt lds
    buffer_load_dwordx4 v6, s[32:35], s58 offen offset:768 nt lds
    s_add_u32 m0, m0, 1536
    s_nop 0
    buffer_load_dwordx4 v6, s[28:31], s58 offen nt lds
    buffer_load_dwordx4 v6, s[28:31], s58 offen offset:768 nt lds
    s_mov_b32 s36, s14
    s_and_b32 s37, s15, 0xffff
    s_mov_b32 s38, 2097152
    s_mov_b32 s39, 0x20000
    s_mov_b32 s40, s16
    s_and_b32 s41, s17, 0xffff
    s_mov_b32 s42, 2097152
    s_mov_b32 s43, 0x20000
    s_mov_b32 exec_hi, 0
    s_lshl_b32 s60, s56, 10
    s_add_u32 m0, s60, 125952
    s_lshl_b32 s58, s84, 9
    buffer_load_dwordx4 v6, s[36:39], s58 offen nt lds
    s_add_u32 m0, m0, 512
    s_nop 0
    buffer_load_dwordx4 v6, s[40:43], s58 offen nt lds
    s_add_u32 m0, s60, 130048
    s_lshl_b32 s58, s85, 9
    buffer_load_dwordx4 v6, s[36:39], s58 offen nt lds
    s_add_u32 m0, m0, 512
    s_nop 0
    buffer_load_dwordx4 v6, s[40:43], s58 offen nt lds
    s_add_u32 m0, s60, 134144
    s_lshl_b32 s58, s86, 9
    buffer_load_dwordx4 v6, s[36:39], s58 offen nt lds
    s_add_u32 m0, m0, 512
    s_nop 0
    buffer_load_dwordx4 v6, s[40:43], s58 offen nt lds
    s_add_u32 m0, s60, 138240
    s_lshl_b32 s58, s87, 9
    buffer_load_dwordx4 v6, s[36:39], s58 offen nt lds
    s_add_u32 m0, m0, 512
    s_nop 0
    buffer_load_dwordx4 v6, s[40:43], s58 offen nt lds
    s_mov_b32 exec_hi, -1
    s_mov_b32 s44, s4
    s_and_b32 s45, s5, 0xffff
    s_mov_b32 s46, 393216
    s_mov_b32 s47, 0x20000
    s_lshr_b32 s58, s88, 4
    s_mul_i32 s58, s58, 1536
    buffer_load_dwordx2 v[156:157], v3, s[44:47], s58 offen offset:0 nt
    buffer_load_dwordx2 v[158:159], v3, s[44:47], s58 offen offset:128 nt
    buffer_load_dwordx2 v[160:161], v3, s[44:47], s58 offen offset:256 nt
    s_lshr_b32 s58, s89, 4
    s_mul_i32 s58, s58, 1536
    buffer_load_dwordx2 v[162:163], v3, s[44:47], s58 offen offset:0 nt
    buffer_load_dwordx2 v[164:165], v3, s[44:47], s58 offen offset:128 nt
    buffer_load_dwordx2 v[166:167], v3, s[44:47], s58 offen offset:256 nt
    s_lshr_b32 s58, s90, 4
    s_mul_i32 s58, s58, 1536
    buffer_load_dwordx2 v[168:169], v3, s[44:47], s58 offen offset:0 nt
    buffer_load_dwordx2 v[170:171], v3, s[44:47], s58 offen offset:128 nt
    buffer_load_dwordx2 v[172:173], v3, s[44:47], s58 offen offset:256 nt
    s_mov_b32 s64, 0x3fb8aa3b
    s_mov_b32 s65, 0x3d93cd3a
    s_mov_b32 s66, 0xffff0000
    v_bfe_u32 v36, v1, 2, 1
    v_lshl_add_u32 v36, v2, 2, v36
    v_bfe_u32 v37, v1, 3, 1
    v_lshrrev_b32 v38, 4, v1
    v_lshl_add_u32 v38, v38, 2, v4
    v_lshlrev_b32 v38, 3, v38
    v_add_u32 v38, 73728, v38
    s_movk_i32 s58, 384
    v_add_u32 v3, 0, v36
    v_cmp_le_u32 vcc, 43, v3
    v_add_u32 v5, 43, v3
    v_mov_b32 v6, 42
    v_cndmask_b32 v17, v3, v5, vcc
    v_cmp_le_u32 vcc, 86, v3
    v_add_u32 v5, 43, v17
    s_nop 0
    v_cndmask_b32 v17, v17, v5, vcc
    v_cndmask_b32 v6, 43, v6, vcc
    v_mad_u32_u24 v17, v6, v37, v17
    v_lshrrev_b32 v17, 6, v17
    v_mad_u32_u24 v17, v17, s58, v38
    v_add_u32 v3, 2, v36
    v_cmp_le_u32 vcc, 43, v3
    v_add_u32 v5, 43, v3
    v_mov_b32 v6, 42
    v_cndmask_b32 v18, v3, v5, vcc
    v_cmp_le_u32 vcc, 86, v3
    v_add_u32 v5, 43, v18
    s_nop 0
    v_cndmask_b32 v18, v18, v5, vcc
    v_cndmask_b32 v6, 43, v6, vcc
    v_mad_u32_u24 v18, v6, v37, v18
    v_lshrrev_b32 v18, 6, v18
    v_mad_u32_u24 v18, v18, s58, v38
    v_add_u32 v3, 16, v36
    v_cmp_le_u32 vcc, 43, v3
    v_add_u32 v5, 43, v3
    v_mov_b32 v6, 42
    v_cndmask_b32 v19, v3, v5, vcc
    v_cmp_le_u32 vcc, 86, v3
    v_add_u32 v5, 43, v19
    s_nop 0
    v_cndmask_b32 v19, v19, v5, vcc
    v_cndmask_b32 v6, 43, v6, vcc
    v_mad_u32_u24 v19, v6, v37, v19
    v_lshrrev_b32 v19, 6, v19
    v_mad_u32_u24 v19, v19, s58, v38
    v_add_u32 v3, 18, v36
    v_cmp_le_u32 vcc, 43, v3
    v_add_u32 v5, 43, v3
    v_mov_b32 v6, 42
    v_cndmask_b32 v20, v3, v5, vcc
    v_cmp_le_u32 vcc, 86, v3
    v_add_u32 v5, 43, v20
    s_nop 0
    v_cndmask_b32 v20, v20, v5, vcc
    v_cndmask_b32 v6, 43, v6, vcc
    v_mad_u32_u24 v20, v6, v37, v20
    v_lshrrev_b32 v20, 6, v20
    v_mad_u32_u24 v20, v20, s58, v38
    v_add_u32 v3, 32, v36
    v_cmp_le_u32 vcc, 43, v3
    v_add_u32 v5, 43, v3
    v_mov_b32 v6, 42
    v_cndmask_b32 v21, v3, v5, vcc
    v_cmp_le_u32 vcc, 86, v3
    v_add_u32 v5, 43, v21
    s_nop 0
    v_cndmask_b32 v21, v21, v5, vcc
    v_cndmask_b32 v6, 43, v6, vcc
    v_mad_u32_u24 v21, v6, v37, v21
    v_lshrrev_b32 v21, 6, v21
    v_mad_u32_u24 v21, v21, s58, v38
    v_add_u32 v3, 34, v36
    v_cmp_le_u32 vcc, 43, v3
    v_add_u32 v5, 43, v3
    v_mov_b32 v6, 42
    v_cndmask_b32 v22, v3, v5, vcc
    v_cmp_le_u32 vcc, 86, v3
    v_add_u32 v5, 43, v22
    s_nop 0
    v_cndmask_b32 v22, v22, v5, vcc
    v_cndmask_b32 v6, 43, v6, vcc
    v_mad_u32_u24 v22, v6, v37, v22
    v_lshrrev_b32 v22, 6, v22
    v_mad_u32_u24 v22, v22, s58, v38
    v_add_u32 v3, 48, v36
    v_cmp_le_u32 vcc, 43, v3
    v_add_u32 v5, 43, v3
    v_mov_b32 v6, 42
    v_cndmask_b32 v23, v3, v5, vcc
    v_cmp_le_u32 vcc, 86, v3
    v_add_u32 v5, 43, v23
    s_nop 0
    v_cndmask_b32 v23, v23, v5, vcc
    v_cndmask_b32 v6, 43, v6, vcc
    v_mad_u32_u24 v23, v6, v37, v23
    v_lshrrev_b32 v23, 6, v23
    v_mad_u32_u24 v23, v23, s58, v38
    v_add_u32 v3, 50, v36
    v_cmp_le_u32 vcc, 43, v3
    v_add_u32 v5, 43, v3
    v_mov_b32 v6, 42
    v_cndmask_b32 v24, v3, v5, vcc
    v_cmp_le_u32 vcc, 86, v3
    v_add_u32 v5, 43, v24
    s_nop 0
    v_cndmask_b32 v24, v24, v5, vcc
    v_cndmask_b32 v6, 43, v6, vcc
    v_mad_u32_u24 v24, v6, v37, v24
    v_lshrrev_b32 v24, 6, v24
    v_mad_u32_u24 v24, v24, s58, v38
    v_add_u32 v3, 64, v36
    v_cmp_le_u32 vcc, 43, v3
    v_add_u32 v5, 43, v3
    v_mov_b32 v6, 42
    v_cndmask_b32 v25, v3, v5, vcc
    v_cmp_le_u32 vcc, 86, v3
    v_add_u32 v5, 43, v25
    s_nop 0
    v_cndmask_b32 v25, v25, v5, vcc
    v_cndmask_b32 v6, 43, v6, vcc
    v_mad_u32_u24 v25, v6, v37, v25
    v_lshrrev_b32 v25, 6, v25
    v_mad_u32_u24 v25, v25, s58, v38
    v_add_u32 v3, 66, v36
    v_cmp_le_u32 vcc, 43, v3
    v_add_u32 v5, 43, v3
    v_mov_b32 v6, 42
    v_cndmask_b32 v26, v3, v5, vcc
    v_cmp_le_u32 vcc, 86, v3
    v_add_u32 v5, 43, v26
    s_nop 0
    v_cndmask_b32 v26, v26, v5, vcc
    v_cndmask_b32 v6, 43, v6, vcc
    v_mad_u32_u24 v26, v6, v37, v26
    v_lshrrev_b32 v26, 6, v26
    v_mad_u32_u24 v26, v26, s58, v38
    v_add_u32 v3, 80, v36
    v_cmp_le_u32 vcc, 43, v3
    v_add_u32 v5, 43, v3
    v_mov_b32 v6, 42
    v_cndmask_b32 v27, v3, v5, vcc
    v_cmp_le_u32 vcc, 86, v3
    v_add_u32 v5, 43, v27
    s_nop 0
    v_cndmask_b32 v27, v27, v5, vcc
    v_cndmask_b32 v6, 43, v6, vcc
    v_mad_u32_u24 v27, v6, v37, v27
    v_lshrrev_b32 v27, 6, v27
    v_mad_u32_u24 v27, v27, s58, v38
    v_add_u32 v3, 82, v36
    v_cmp_le_u32 vcc, 43, v3
    v_add_u32 v5, 43, v3
    v_mov_b32 v6, 42
    v_cndmask_b32 v28, v3, v5, vcc
    v_cmp_le_u32 vcc, 86, v3
    v_add_u32 v5, 43, v28
    s_nop 0
    v_cndmask_b32 v28, v28, v5, vcc
    v_cndmask_b32 v6, 43, v6, vcc
    v_mad_u32_u24 v28, v6, v37, v28
    v_lshrrev_b32 v28, 6, v28
    v_mad_u32_u24 v28, v28, s58, v38
    v_add_u32 v3, 96, v36
    v_cmp_le_u32 vcc, 43, v3
    v_add_u32 v5, 43, v3
    v_mov_b32 v6, 42
    v_cndmask_b32 v29, v3, v5, vcc
    v_cmp_le_u32 vcc, 86, v3
    v_add_u32 v5, 43, v29
    s_nop 0
    v_cndmask_b32 v29, v29, v5, vcc
    v_cndmask_b32 v6, 43, v6, vcc
    v_mad_u32_u24 v29, v6, v37, v29
    v_lshrrev_b32 v29, 6, v29
    v_mad_u32_u24 v29, v29, s58, v38
    v_add_u32 v3, 98, v36
    v_cmp_le_u32 vcc, 43, v3
    v_add_u32 v5, 43, v3
    v_mov_b32 v6, 42
    v_cndmask_b32 v30, v3, v5, vcc
    v_cmp_le_u32 vcc, 86, v3
    v_add_u32 v5, 43, v30
    s_nop 0
    v_cndmask_b32 v30, v30, v5, vcc
    v_cndmask_b32 v6, 43, v6, vcc
    v_mad_u32_u24 v30, v6, v37, v30
    v_lshrrev_b32 v30, 6, v30
    v_mad_u32_u24 v30, v30, s58, v38
    v_add_u32 v3, 112, v36
    v_cmp_le_u32 vcc, 43, v3
    v_add_u32 v5, 43, v3
    v_mov_b32 v6, 42
    v_cndmask_b32 v31, v3, v5, vcc
    v_cmp_le_u32 vcc, 86, v3
    v_add_u32 v5, 43, v31
    s_nop 0
    v_cndmask_b32 v31, v31, v5, vcc
    v_cndmask_b32 v6, 43, v6, vcc
    v_mad_u32_u24 v31, v6, v37, v31
    v_lshrrev_b32 v31, 6, v31
    v_mad_u32_u24 v31, v31, s58, v38
    v_add_u32 v3, 114, v36
    v_cmp_le_u32 vcc, 43, v3
    v_add_u32 v5, 43, v3
    v_mov_b32 v6, 42
    v_cndmask_b32 v32, v3, v5, vcc
    v_cmp_le_u32 vcc, 86, v3
    v_add_u32 v5, 43, v32
    s_nop 0
    v_cndmask_b32 v32, v32, v5, vcc
    v_cndmask_b32 v6, 43, v6, vcc
    v_mad_u32_u24 v32, v6, v37, v32
    v_lshrrev_b32 v32, 6, v32
    v_mad_u32_u24 v32, v32, s58, v38
    v_bfe_u32 v36, v1, 4, 1
    v_lshl_add_u32 v36, v2, 2, v36
    v_bfe_u32 v3, v1, 2, 2
    v_lshl_add_u32 v36, v3, 4, v36
    v_lshrrev_b32 v37, 5, v1
    s_mov_b32 s58, 125952
    v_add_u32 v3, 0, v36
    v_cmp_le_u32 vcc, 43, v3
    v_add_u32 v5, 43, v3
    v_mov_b32 v6, 42
    v_cndmask_b32 v7, v3, v5, vcc
    v_cmp_le_u32 vcc, 86, v3
    v_add_u32 v5, 43, v7
    s_nop 0
    v_cndmask_b32 v7, v7, v5, vcc
    v_cndmask_b32 v6, 43, v6, vcc
    v_mad_u32_u24 v7, v6, v37, v7
    v_lshl_add_u32 v7, v7, 1, s58
    v_add_u32 v3, 2, v36
    v_cmp_le_u32 vcc, 43, v3
    v_add_u32 v5, 43, v3
    v_mov_b32 v6, 42
    v_cndmask_b32 v8, v3, v5, vcc
    v_cmp_le_u32 vcc, 86, v3
    v_add_u32 v5, 43, v8
    s_nop 0
    v_cndmask_b32 v8, v8, v5, vcc
    v_cndmask_b32 v6, 43, v6, vcc
    v_mad_u32_u24 v8, v6, v37, v8
    v_lshl_add_u32 v8, v8, 1, s58
    v_add_u32 v3, 64, v36
    v_cmp_le_u32 vcc, 43, v3
    v_add_u32 v5, 43, v3
    v_mov_b32 v6, 42
    v_cndmask_b32 v9, v3, v5, vcc
    v_cmp_le_u32 vcc, 86, v3
    v_add_u32 v5, 43, v9
    s_nop 0
    v_cndmask_b32 v9, v9, v5, vcc
    v_cndmask_b32 v6, 43, v6, vcc
    v_mad_u32_u24 v9, v6, v37, v9
    v_lshl_add_u32 v9, v9, 1, s58
    v_add_u32 v3, 66, v36
    v_cmp_le_u32 vcc, 43, v3
    v_add_u32 v5, 43, v3
    v_mov_b32 v6, 42
    v_cndmask_b32 v10, v3, v5, vcc
    v_cmp_le_u32 vcc, 86, v3
    v_add_u32 v5, 43, v10
    s_nop 0
    v_cndmask_b32 v10, v10, v5, vcc
    v_cndmask_b32 v6, 43, v6, vcc
    v_mad_u32_u24 v10, v6, v37, v10
    v_lshl_add_u32 v10, v10, 1, s58
    v_lshlrev_b32 v11, 2, v1
    v_lshl_add_u32 v11, v2, 9, v11
    v_add_u32 v11, 73728, v11
    v_mul_u32_u24 v12, 6144, v2
    v_lshl_add_u32 v12, v1, 4, v12
    v_mov_b32 v14, 0xff800000
    s_mov_b32 s74, 0
    s_mov_b32 s61, 0
    s_mov_b32 s62, 0
    s_movk_i32 s63, 3072
    s_waitcnt vmcnt(0)
    s_barrier
    v_add_u32 v33, s63, v17
    v_add_u32 v34, s63, v18
    ds_read_b64 v[108:109], v33 offset:0
    ds_read_b64 v[110:111], v33 offset:1536
    ds_read_b64 v[112:113], v33 offset:128
    ds_read_b64 v[114:115], v33 offset:1664
    ds_read_b64 v[116:117], v33 offset:256
    ds_read_b64 v[118:119], v33 offset:1792
    ds_read_b64 v[120:121], v34 offset:0
    ds_read_b64 v[122:123], v34 offset:1536
    ds_read_b64 v[124:125], v34 offset:128
    ds_read_b64 v[126:127], v34 offset:1664
    ds_read_b64 v[128:129], v34 offset:256
    ds_read_b64 v[130:131], v34 offset:1792
    s_waitcnt lgkmcnt(0)
    v_lshlrev_b32 v60, 16, v108
    v_and_b32 v61, s66, v108
    v_lshlrev_b32 v62, 16, v109
    v_and_b32 v63, s66, v109
    v_lshlrev_b32 v84, 16, v110
    v_and_b32 v85, s66, v110
    v_lshlrev_b32 v86, 16, v111
    v_and_b32 v87, s66, v111
    v_lshlrev_b32 v64, 16, v112
    v_and_b32 v65, s66, v112
    v_lshlrev_b32 v66, 16, v113
    v_and_b32 v67, s66, v113
    v_lshlrev_b32 v88, 16, v114
    v_and_b32 v89, s66, v114
    v_lshlrev_b32 v90, 16, v115
    v_and_b32 v91, s66, v115
    v_lshlrev_b32 v68, 16, v116
    v_and_b32 v69, s66, v116
    v_lshlrev_b32 v70, 16, v117
    v_and_b32 v71, s66, v117
    v_lshlrev_b32 v92, 16, v118
    v_and_b32 v93, s66, v118
    v_lshlrev_b32 v94, 16, v119
    v_and_b32 v95, s66, v119
    v_lshlrev_b32 v72, 16, v120
    v_and_b32 v73, s66, v120
    v_lshlrev_b32 v74, 16, v121
    v_and_b32 v75, s66, v121
    v_lshlrev_b32 v96, 16, v122
    v_and_b32 v97, s66, v122
    v_lshlrev_b32 v98, 16, v123
    v_and_b32 v99, s66, v123
    v_lshlrev_b32 v76, 16, v124
    v_and_b32 v77, s66, v124
    v_lshlrev_b32 v78, 16, v125
    v_and_b32 v79, s66, v125
    v_lshlrev_b32 v100, 16, v126
    v_and_b32 v101, s66, v126
    v_lshlrev_b32 v102, 16, v127
    v_and_b32 v103, s66, v127
    v_lshlrev_b32 v80, 16, v128
    v_and_b32 v81, s66, v128
    v_lshlrev_b32 v82, 16, v129
    v_and_b32 v83, s66, v129
    v_lshlrev_b32 v104, 16, v130
    v_and_b32 v105, s66, v130
    v_lshlrev_b32 v106, 16, v131
    v_and_b32 v107, s66, v131
L_kblk:
    v_add_u32 v13, s62, v12
    s_add_u32 s62, s62, 24576
    s_cmp_eq_u32 s62, 73728
    s_cselect_b32 s62, 0, s62
    s_barrier
    ds_read_b128 v[36:39], v13 offset:0
    ds_read_b128 v[40:43], v13 offset:1024
    ds_read_b128 v[44:47], v13 offset:2048
    ds_read_b128 v[48:51], v13 offset:3072
    ds_read_b128 v[52:55], v13 offset:4096
    ds_read_b128 v[56:59], v13 offset:5120
    s_waitcnt lgkmcnt(3)
    v_cvt_f32_i32 v36, v36
    v_cvt_f32_i32 v37, v37
    v_cvt_f32_i32 v38, v38
    v_cvt_f32_i32 v39, v39
    v_cvt_f32_i32 v40, v40
    v_cvt_f32_i32 v41, v41
    v_cvt_f32_i32 v42, v42
    v_cvt_f32_i32 v43, v43
    v_cvt_f32_i32 v44, v44
    v_cvt_f32_i32 v45, v45
    v_cvt_f32_i32 v46, v46
    v_cvt_f32_i32 v47, v47
    v_sub_f32 v36, v36, v60
    v_sub_f32 v37, v37, v61
    v_sub_f32 v38, v38, v62
    v_sub_f32 v39, v39, v63
    v_sub_f32 v40, v40, v64
    v_sub_f32 v41, v41, v65
    v_sub_f32 v42, v42, v66
    v_sub_f32 v43, v43, v67
    v_sub_f32 v44, v44, v68
    v_sub_f32 v45, v45, v69
    v_sub_f32 v46, v46, v70
    v_sub_f32 v47, v47, v71
    v_cvt_pk_bf16_f32 v36, 0, v36
    v_cvt_pk_bf16_f32 v37, 0, v37
    v_cvt_pk_bf16_f32 v38, 0, v38
    v_cvt_pk_bf16_f32 v39, 0, v39
    v_cvt_pk_bf16_f32 v40, 0, v40
    v_cvt_pk_bf16_f32 v41, 0, v41
    v_cvt_pk_bf16_f32 v42, 0, v42
    v_cvt_pk_bf16_f32 v43, 0, v43
    v_cvt_pk_bf16_f32 v44, 0, v44
    v_cvt_pk_bf16_f32 v45, 0, v45
    v_cvt_pk_bf16_f32 v46, 0, v46
    v_cvt_pk_bf16_f32 v47, 0, v47
    v_mul_f32 v36, v36, v84
    v_mul_f32 v37, v37, v85
    v_mul_f32 v38, v38, v86
    v_mul_f32 v39, v39, v87
    v_mul_f32 v40, v40, v88
    v_mul_f32 v41, v41, v89
    v_mul_f32 v42, v42, v90
    v_mul_f32 v43, v43, v91
    v_mul_f32 v44, v44, v92
    v_mul_f32 v45, v45, v93
    v_mul_f32 v46, v46, v94
    v_mul_f32 v47, v47, v95
    v_cvt_pk_bf16_f32 v132, v36, v37
    v_cvt_pk_bf16_f32 v133, v38, v39
    v_cvt_pk_bf16_f32 v134, v40, v41
    v_cvt_pk_bf16_f32 v135, v42, v43
    v_cvt_pk_bf16_f32 v136, v44, v45
    v_cvt_pk_bf16_f32 v137, v46, v47
    v_mfma_f32_16x16x16_bf16 v[144:147], v[132:133], v[156:157], 0
    v_mfma_f32_16x16x16_bf16 v[144:147], v[134:135], v[158:159], v[144:147]
    v_mfma_f32_16x16x16_bf16 v[144:147], v[136:137], v[160:161], v[144:147]
    s_waitcnt lgkmcnt(0)
    v_cvt_f32_i32 v48, v48
    v_cvt_f32_i32 v49, v49
    v_cvt_f32_i32 v50, v50
    v_cvt_f32_i32 v51, v51
    v_cvt_f32_i32 v52, v52
    v_cvt_f32_i32 v53, v53
    v_cvt_f32_i32 v54, v54
    v_cvt_f32_i32 v55, v55
    v_cvt_f32_i32 v56, v56
    v_cvt_f32_i32 v57, v57
    v_cvt_f32_i32 v58, v58
    v_cvt_f32_i32 v59, v59
    v_sub_f32 v48, v48, v72
    v_sub_f32 v49, v49, v73
    v_sub_f32 v50, v50, v74
    v_sub_f32 v51, v51, v75
    v_sub_f32 v52, v52, v76
    v_sub_f32 v53, v53, v77
    v_sub_f32 v54, v54, v78
    v_sub_f32 v55, v55, v79
    v_sub_f32 v56, v56, v80
    v_sub_f32 v57, v57, v81
    v_sub_f32 v58, v58, v82
    v_sub_f32 v59, v59, v83
    v_cvt_pk_bf16_f32 v48, 0, v48
    v_cvt_pk_bf16_f32 v49, 0, v49
    v_cvt_pk_bf16_f32 v50, 0, v50
    v_cvt_pk_bf16_f32 v51, 0, v51
    v_cvt_pk_bf16_f32 v52, 0, v52
    v_cvt_pk_bf16_f32 v53, 0, v53
    v_cvt_pk_bf16_f32 v54, 0, v54
    v_cvt_pk_bf16_f32 v55, 0, v55
    v_cvt_pk_bf16_f32 v56, 0, v56
    v_cvt_pk_bf16_f32 v57, 0, v57
    v_cvt_pk_bf16_f32 v58, 0, v58
    v_cvt_pk_bf16_f32 v59, 0, v59
    v_mul_f32 v48, v48, v96
    v_mul_f32 v49, v49, v97
    v_mul_f32 v50, v50, v98
    v_mul_f32 v51, v51, v99
    v_mul_f32 v52, v52, v100
    v_mul_f32 v53, v53, v101
    v_mul_f32 v54, v54, v102
    v_mul_f32 v55, v55, v103
    v_mul_f32 v56, v56, v104
    v_mul_f32 v57, v57, v105
    v_mul_f32 v58, v58, v106
    v_mul_f32 v59, v59, v107
    v_cvt_pk_bf16_f32 v138, v48, v49
    v_cvt_pk_bf16_f32 v139, v50, v51
    v_add_f32_dpp v3, v145, v144 row_ror:12 row_mask:0xf bank_mask:0xf
    v_cvt_pk_bf16_f32 v140, v52, v53
    v_cvt_pk_bf16_f32 v141, v54, v55
    v_add_f32_dpp v3, v146, v3 row_ror:8 row_mask:0xf bank_mask:0xf
    v_cvt_pk_bf16_f32 v142, v56, v57
    v_cvt_pk_bf16_f32 v143, v58, v59
    v_add_f32_dpp v15, v147, v3 row_ror:4 row_mask:0xf bank_mask:0x1
    v_mfma_f32_16x16x16_bf16 v[148:151], v[138:139], v[156:157], 0
    v_mfma_f32_16x16x16_bf16 v[148:151], v[140:141], v[158:159], v[148:151]
    v_mfma_f32_16x16x16_bf16 v[148:151], v[142:143], v[160:161], v[148:151]
    v_add_u32 v33, s63, v19
    v_add_u32 v34, s63, v20
    ds_read_b64 v[108:109], v33 offset:0
    ds_read_b64 v[110:111], v33 offset:1536
    ds_read_b64 v[112:113], v33 offset:128
    ds_read_b64 v[114:115], v33 offset:1664
    ds_read_b64 v[116:117], v33 offset:256
    ds_read_b64 v[118:119], v33 offset:1792
    ds_read_b64 v[120:121], v34 offset:0
    v_add_f32_dpp v4, v149, v148 row_ror:12 row_mask:0xf bank_mask:0xf
    ds_read_b64 v[122:123], v34 offset:1536
    ds_read_b64 v[124:125], v34 offset:128
    v_add_f32_dpp v4, v150, v4 row_ror:8 row_mask:0xf bank_mask:0xf
    ds_read_b64 v[126:127], v34 offset:1664
    ds_read_b64 v[128:129], v34 offset:256
    ds_read_b64 v[130:131], v34 offset:1792
    v_add_f32_dpp v16, v151, v4 row_ror:4 row_mask:0xf bank_mask:0x1
    s_waitcnt lgkmcnt(0)
    v_lshlrev_b32 v60, 16, v108
    v_and_b32 v61, s66, v108
    v_lshlrev_b32 v62, 16, v109
    v_and_b32 v63, s66, v109
    v_lshlrev_b32 v84, 16, v110
    v_and_b32 v85, s66, v110
    v_lshlrev_b32 v86, 16, v111
    v_and_b32 v87, s66, v111
    v_lshlrev_b32 v64, 16, v112
    v_and_b32 v65, s66, v112
    v_lshlrev_b32 v66, 16, v113
    v_and_b32 v67, s66, v113
    v_lshlrev_b32 v88, 16, v114
    v_and_b32 v89, s66, v114
    v_lshlrev_b32 v90, 16, v115
    v_and_b32 v91, s66, v115
    v_lshlrev_b32 v68, 16, v116
    v_and_b32 v69, s66, v116
    v_lshlrev_b32 v70, 16, v117
    v_and_b32 v71, s66, v117
    v_lshlrev_b32 v92, 16, v118
    v_and_b32 v93, s66, v118
    v_lshlrev_b32 v94, 16, v119
    v_and_b32 v95, s66, v119
    v_lshlrev_b32 v72, 16, v120
    v_and_b32 v73, s66, v120
    v_lshlrev_b32 v74, 16, v121
    v_and_b32 v75, s66, v121
    v_lshlrev_b32 v96, 16, v122
    v_and_b32 v97, s66, v122
    v_lshlrev_b32 v98, 16, v123
    v_and_b32 v99, s66, v123
    v_lshlrev_b32 v76, 16, v124
    v_and_b32 v77, s66, v124
    v_lshlrev_b32 v78, 16, v125
    v_and_b32 v79, s66, v125
    v_lshlrev_b32 v100, 16, v126
    v_and_b32 v101, s66, v126
    v_lshlrev_b32 v102, 16, v127
    v_and_b32 v103, s66, v127
    v_lshlrev_b32 v80, 16, v128
    v_and_b32 v81, s66, v128
    v_lshlrev_b32 v82, 16, v129
    v_and_b32 v83, s66, v129
    v_lshlrev_b32 v104, 16, v130
    v_and_b32 v105, s66, v130
    v_lshlrev_b32 v106, 16, v131
    v_and_b32 v107, s66, v131
    v_add_u32 v13, s62, v12
    s_add_u32 s62, s62, 24576
    s_cmp_eq_u32 s62, 73728
    s_cselect_b32 s62, 0, s62
    s_barrier
    ds_read_b128 v[36:39], v13 offset:0
    ds_read_b128 v[40:43], v13 offset:1024
    ds_read_b128 v[44:47], v13 offset:2048
    ds_read_b128 v[48:51], v13 offset:3072
    ds_read_b128 v[52:55], v13 offset:4096
    ds_read_b128 v[56:59], v13 offset:5120
    s_waitcnt lgkmcnt(3)
    v_cvt_f32_i32 v36, v36
    v_cvt_f32_i32 v37, v37
    v_cvt_f32_i32 v38, v38
    v_cvt_f32_i32 v39, v39
    v_cvt_f32_i32 v40, v40
    v_cvt_f32_i32 v41, v41
    v_cvt_f32_i32 v42, v42
    v_cvt_f32_i32 v43, v43
    v_cvt_f32_i32 v44, v44
    v_cvt_f32_i32 v45, v45
    v_cvt_f32_i32 v46, v46
    v_cvt_f32_i32 v47, v47
    v_sub_f32 v36, v36, v60
    v_sub_f32 v37, v37, v61
    v_sub_f32 v38, v38, v62
    v_sub_f32 v39, v39, v63
    v_sub_f32 v40, v40, v64
    v_sub_f32 v41, v41, v65
    v_sub_f32 v42, v42, v66
    v_sub_f32 v43, v43, v67
    v_sub_f32 v44, v44, v68
    v_sub_f32 v45, v45, v69
    v_sub_f32 v46, v46, v70
    v_sub_f32 v47, v47, v71
    v_cvt_pk_bf16_f32 v36, 0, v36
    v_cvt_pk_bf16_f32 v37, 0, v37
    v_cvt_pk_bf16_f32 v38, 0, v38
    v_cvt_pk_bf16_f32 v39, 0, v39
    v_cvt_pk_bf16_f32 v40, 0, v40
    v_cvt_pk_bf16_f32 v41, 0, v41
    v_cvt_pk_bf16_f32 v42, 0, v42
    v_cvt_pk_bf16_f32 v43, 0, v43
    v_cvt_pk_bf16_f32 v44, 0, v44
    v_cvt_pk_bf16_f32 v45, 0, v45
    v_cvt_pk_bf16_f32 v46, 0, v46
    v_cvt_pk_bf16_f32 v47, 0, v47
    v_mul_f32 v36, v36, v84
    v_mul_f32 v37, v37, v85
    v_mul_f32 v38, v38, v86
    v_mul_f32 v39, v39, v87
    v_mul_f32 v40, v40, v88
    v_mul_f32 v41, v41, v89
    v_mul_f32 v42, v42, v90
    v_mul_f32 v43, v43, v91
    v_mul_f32 v44, v44, v92
    v_mul_f32 v45, v45, v93
    v_mul_f32 v46, v46, v94
    v_mul_f32 v47, v47, v95
    v_cvt_pk_bf16_f32 v132, v36, v37
    v_cvt_pk_bf16_f32 v133, v38, v39
    v_cvt_pk_bf16_f32 v134, v40, v41
    v_cvt_pk_bf16_f32 v135, v42, v43
    v_cvt_pk_bf16_f32 v136, v44, v45
    v_cvt_pk_bf16_f32 v137, v46, v47
    v_mfma_f32_16x16x16_bf16 v[144:147], v[132:133], v[156:157], 0
    v_mfma_f32_16x16x16_bf16 v[144:147], v[134:135], v[158:159], v[144:147]
    v_mfma_f32_16x16x16_bf16 v[144:147], v[136:137], v[160:161], v[144:147]
    s_waitcnt lgkmcnt(0)
    v_cvt_f32_i32 v48, v48
    v_cvt_f32_i32 v49, v49
    v_cvt_f32_i32 v50, v50
    v_cvt_f32_i32 v51, v51
    v_cvt_f32_i32 v52, v52
    v_cvt_f32_i32 v53, v53
    v_cvt_f32_i32 v54, v54
    v_cvt_f32_i32 v55, v55
    v_cvt_f32_i32 v56, v56
    v_cvt_f32_i32 v57, v57
    v_cvt_f32_i32 v58, v58
    v_cvt_f32_i32 v59, v59
    v_sub_f32 v48, v48, v72
    v_sub_f32 v49, v49, v73
    v_sub_f32 v50, v50, v74
    v_sub_f32 v51, v51, v75
    v_sub_f32 v52, v52, v76
    v_sub_f32 v53, v53, v77
    v_sub_f32 v54, v54, v78
    v_sub_f32 v55, v55, v79
    v_sub_f32 v56, v56, v80
    v_sub_f32 v57, v57, v81
    v_sub_f32 v58, v58, v82
    v_sub_f32 v59, v59, v83
    v_cvt_pk_bf16_f32 v48, 0, v48
    v_cvt_pk_bf16_f32 v49, 0, v49
    v_cvt_pk_bf16_f32 v50, 0, v50
    v_cvt_pk_bf16_f32 v51, 0, v51
    v_cvt_pk_bf16_f32 v52, 0, v52
    v_cvt_pk_bf16_f32 v53, 0, v53
    v_cvt_pk_bf16_f32 v54, 0, v54
    v_cvt_pk_bf16_f32 v55, 0, v55
    v_cvt_pk_bf16_f32 v56, 0, v56
    v_cvt_pk_bf16_f32 v57, 0, v57
    v_cvt_pk_bf16_f32 v58, 0, v58
    v_cvt_pk_bf16_f32 v59, 0, v59
    v_mul_f32 v48, v48, v96
    v_mul_f32 v49, v49, v97
    v_mul_f32 v50, v50, v98
    v_mul_f32 v51, v51, v99
    v_mul_f32 v52, v52, v100
    v_mul_f32 v53, v53, v101
    v_mul_f32 v54, v54, v102
    v_mul_f32 v55, v55, v103
    v_mul_f32 v56, v56, v104
    v_mul_f32 v57, v57, v105
    v_mul_f32 v58, v58, v106
    v_mul_f32 v59, v59, v107
    v_cvt_pk_bf16_f32 v138, v48, v49
    v_cvt_pk_bf16_f32 v139, v50, v51
    v_add_f32_dpp v3, v146, v145 row_ror:12 row_mask:0xf bank_mask:0xf
    v_cvt_pk_bf16_f32 v140, v52, v53
    v_cvt_pk_bf16_f32 v141, v54, v55
    v_add_f32_dpp v3, v147, v3 row_ror:8 row_mask:0xf bank_mask:0xf
    v_cvt_pk_bf16_f32 v142, v56, v57
    v_cvt_pk_bf16_f32 v143, v58, v59
    v_add_f32_dpp v15, v144, v3 row_ror:4 row_mask:0xf bank_mask:0x2
    v_mfma_f32_16x16x16_bf16 v[148:151], v[138:139], v[156:157], 0
    v_mfma_f32_16x16x16_bf16 v[148:151], v[140:141], v[158:159], v[148:151]
    v_mfma_f32_16x16x16_bf16 v[148:151], v[142:143], v[160:161], v[148:151]
    v_add_u32 v33, s63, v21
    v_add_u32 v34, s63, v22
    ds_read_b64 v[108:109], v33 offset:0
    ds_read_b64 v[110:111], v33 offset:1536
    ds_read_b64 v[112:113], v33 offset:128
    ds_read_b64 v[114:115], v33 offset:1664
    ds_read_b64 v[116:117], v33 offset:256
    ds_read_b64 v[118:119], v33 offset:1792
    ds_read_b64 v[120:121], v34 offset:0
    v_add_f32_dpp v4, v150, v149 row_ror:12 row_mask:0xf bank_mask:0xf
    ds_read_b64 v[122:123], v34 offset:1536
    ds_read_b64 v[124:125], v34 offset:128
    v_add_f32_dpp v4, v151, v4 row_ror:8 row_mask:0xf bank_mask:0xf
    ds_read_b64 v[126:127], v34 offset:1664
    ds_read_b64 v[128:129], v34 offset:256
    ds_read_b64 v[130:131], v34 offset:1792
    v_add_f32_dpp v16, v148, v4 row_ror:4 row_mask:0xf bank_mask:0x2
    s_waitcnt lgkmcnt(0)
    v_lshlrev_b32 v60, 16, v108
    v_and_b32 v61, s66, v108
    v_lshlrev_b32 v62, 16, v109
    v_and_b32 v63, s66, v109
    v_lshlrev_b32 v84, 16, v110
    v_and_b32 v85, s66, v110
    v_lshlrev_b32 v86, 16, v111
    v_and_b32 v87, s66, v111
    v_lshlrev_b32 v64, 16, v112
    v_and_b32 v65, s66, v112
    v_lshlrev_b32 v66, 16, v113
    v_and_b32 v67, s66, v113
    v_lshlrev_b32 v88, 16, v114
    v_and_b32 v89, s66, v114
    v_lshlrev_b32 v90, 16, v115
    v_and_b32 v91, s66, v115
    v_lshlrev_b32 v68, 16, v116
    v_and_b32 v69, s66, v116
    v_lshlrev_b32 v70, 16, v117
    v_and_b32 v71, s66, v117
    v_lshlrev_b32 v92, 16, v118
    v_and_b32 v93, s66, v118
    v_lshlrev_b32 v94, 16, v119
    v_and_b32 v95, s66, v119
    v_lshlrev_b32 v72, 16, v120
    v_and_b32 v73, s66, v120
    v_lshlrev_b32 v74, 16, v121
    v_and_b32 v75, s66, v121
    v_lshlrev_b32 v96, 16, v122
    v_and_b32 v97, s66, v122
    v_lshlrev_b32 v98, 16, v123
    v_and_b32 v99, s66, v123
    v_lshlrev_b32 v76, 16, v124
    v_and_b32 v77, s66, v124
    v_lshlrev_b32 v78, 16, v125
    v_and_b32 v79, s66, v125
    v_lshlrev_b32 v100, 16, v126
    v_and_b32 v101, s66, v126
    v_lshlrev_b32 v102, 16, v127
    v_and_b32 v103, s66, v127
    v_lshlrev_b32 v80, 16, v128
    v_and_b32 v81, s66, v128
    v_lshlrev_b32 v82, 16, v129
    v_and_b32 v83, s66, v129
    v_lshlrev_b32 v104, 16, v130
    v_and_b32 v105, s66, v130
    v_lshlrev_b32 v106, 16, v131
    v_and_b32 v107, s66, v131
    v_add_u32 v13, s62, v12
    s_add_u32 s62, s62, 24576
    s_cmp_eq_u32 s62, 73728
    s_cselect_b32 s62, 0, s62
    s_barrier
    ds_read_b128 v[36:39], v13 offset:0
    ds_read_b128 v[40:43], v13 offset:1024
    ds_read_b128 v[44:47], v13 offset:2048
    ds_read_b128 v[48:51], v13 offset:3072
    ds_read_b128 v[52:55], v13 offset:4096
    ds_read_b128 v[56:59], v13 offset:5120
    s_waitcnt lgkmcnt(3)
    v_cvt_f32_i32 v36, v36
    v_cvt_f32_i32 v37, v37
    v_cvt_f32_i32 v38, v38
    v_cvt_f32_i32 v39, v39
    v_cvt_f32_i32 v40, v40
    v_cvt_f32_i32 v41, v41
    v_cvt_f32_i32 v42, v42
    v_cvt_f32_i32 v43, v43
    v_cvt_f32_i32 v44, v44
    v_cvt_f32_i32 v45, v45
    v_cvt_f32_i32 v46, v46
    v_cvt_f32_i32 v47, v47
    v_sub_f32 v36, v36, v60
    v_sub_f32 v37, v37, v61
    v_sub_f32 v38, v38, v62
    v_sub_f32 v39, v39, v63
    v_sub_f32 v40, v40, v64
    v_sub_f32 v41, v41, v65
    v_sub_f32 v42, v42, v66
    v_sub_f32 v43, v43, v67
    v_sub_f32 v44, v44, v68
    v_sub_f32 v45, v45, v69
    v_sub_f32 v46, v46, v70
    v_sub_f32 v47, v47, v71
    v_cvt_pk_bf16_f32 v36, 0, v36
    v_cvt_pk_bf16_f32 v37, 0, v37
    v_cvt_pk_bf16_f32 v38, 0, v38
    v_cvt_pk_bf16_f32 v39, 0, v39
    v_cvt_pk_bf16_f32 v40, 0, v40
    v_cvt_pk_bf16_f32 v41, 0, v41
    v_cvt_pk_bf16_f32 v42, 0, v42
    v_cvt_pk_bf16_f32 v43, 0, v43
    v_cvt_pk_bf16_f32 v44, 0, v44
    v_cvt_pk_bf16_f32 v45, 0, v45
    v_cvt_pk_bf16_f32 v46, 0, v46
    v_cvt_pk_bf16_f32 v47, 0, v47
    v_mul_f32 v36, v36, v84
    v_mul_f32 v37, v37, v85
    v_mul_f32 v38, v38, v86
    v_mul_f32 v39, v39, v87
    v_mul_f32 v40, v40, v88
    v_mul_f32 v41, v41, v89
    v_mul_f32 v42, v42, v90
    v_mul_f32 v43, v43, v91
    v_mul_f32 v44, v44, v92
    v_mul_f32 v45, v45, v93
    v_mul_f32 v46, v46, v94
    v_mul_f32 v47, v47, v95
    v_cvt_pk_bf16_f32 v132, v36, v37
    v_cvt_pk_bf16_f32 v133, v38, v39
    v_cvt_pk_bf16_f32 v134, v40, v41
    v_cvt_pk_bf16_f32 v135, v42, v43
    v_cvt_pk_bf16_f32 v136, v44, v45
    v_cvt_pk_bf16_f32 v137, v46, v47
    v_mfma_f32_16x16x16_bf16 v[144:147], v[132:133], v[156:157], 0
    v_mfma_f32_16x16x16_bf16 v[144:147], v[134:135], v[158:159], v[144:147]
    v_mfma_f32_16x16x16_bf16 v[144:147], v[136:137], v[160:161], v[144:147]
    s_waitcnt lgkmcnt(0)
    v_cvt_f32_i32 v48, v48
    v_cvt_f32_i32 v49, v49
    v_cvt_f32_i32 v50, v50
    v_cvt_f32_i32 v51, v51
    v_cvt_f32_i32 v52, v52
    v_cvt_f32_i32 v53, v53
    v_cvt_f32_i32 v54, v54
    v_cvt_f32_i32 v55, v55
    v_cvt_f32_i32 v56, v56
    v_cvt_f32_i32 v57, v57
    v_cvt_f32_i32 v58, v58
    v_cvt_f32_i32 v59, v59
    v_sub_f32 v48, v48, v72
    v_sub_f32 v49, v49, v73
    v_sub_f32 v50, v50, v74
    v_sub_f32 v51, v51, v75
    v_sub_f32 v52, v52, v76
    v_sub_f32 v53, v53, v77
    v_sub_f32 v54, v54, v78
    v_sub_f32 v55, v55, v79
    v_sub_f32 v56, v56, v80
    v_sub_f32 v57, v57, v81
    v_sub_f32 v58, v58, v82
    v_sub_f32 v59, v59, v83
    v_cvt_pk_bf16_f32 v48, 0, v48
    v_cvt_pk_bf16_f32 v49, 0, v49
    v_cvt_pk_bf16_f32 v50, 0, v50
    v_cvt_pk_bf16_f32 v51, 0, v51
    v_cvt_pk_bf16_f32 v52, 0, v52
    v_cvt_pk_bf16_f32 v53, 0, v53
    v_cvt_pk_bf16_f32 v54, 0, v54
    v_cvt_pk_bf16_f32 v55, 0, v55
    v_cvt_pk_bf16_f32 v56, 0, v56
    v_cvt_pk_bf16_f32 v57, 0, v57
    v_cvt_pk_bf16_f32 v58, 0, v58
    v_cvt_pk_bf16_f32 v59, 0, v59
    v_mul_f32 v48, v48, v96
    v_mul_f32 v49, v49, v97
    v_mul_f32 v50, v50, v98
    v_mul_f32 v51, v51, v99
    v_mul_f32 v52, v52, v100
    v_mul_f32 v53, v53, v101
    v_mul_f32 v54, v54, v102
    v_mul_f32 v55, v55, v103
    v_mul_f32 v56, v56, v104
    v_mul_f32 v57, v57, v105
    v_mul_f32 v58, v58, v106
    v_mul_f32 v59, v59, v107
    v_cvt_pk_bf16_f32 v138, v48, v49
    v_cvt_pk_bf16_f32 v139, v50, v51
    v_add_f32_dpp v3, v147, v146 row_ror:12 row_mask:0xf bank_mask:0xf
    v_cvt_pk_bf16_f32 v140, v52, v53
    v_cvt_pk_bf16_f32 v141, v54, v55
    v_add_f32_dpp v3, v144, v3 row_ror:8 row_mask:0xf bank_mask:0xf
    v_cvt_pk_bf16_f32 v142, v56, v57
    v_cvt_pk_bf16_f32 v143, v58, v59
    v_add_f32_dpp v15, v145, v3 row_ror:4 row_mask:0xf bank_mask:0x4
    v_mfma_f32_16x16x16_bf16 v[148:151], v[138:139], v[156:157], 0
    v_mfma_f32_16x16x16_bf16 v[148:151], v[140:141], v[158:159], v[148:151]
    v_mfma_f32_16x16x16_bf16 v[148:151], v[142:143], v[160:161], v[148:151]
    v_add_u32 v33, s63, v23
    v_add_u32 v34, s63, v24
    ds_read_b64 v[108:109], v33 offset:0
    ds_read_b64 v[110:111], v33 offset:1536
    ds_read_b64 v[112:113], v33 offset:128
    ds_read_b64 v[114:115], v33 offset:1664
    ds_read_b64 v[116:117], v33 offset:256
    ds_read_b64 v[118:119], v33 offset:1792
    ds_read_b64 v[120:121], v34 offset:0
    v_add_f32_dpp v4, v151, v150 row_ror:12 row_mask:0xf bank_mask:0xf
    ds_read_b64 v[122:123], v34 offset:1536
    ds_read_b64 v[124:125], v34 offset:128
    v_add_f32_dpp v4, v148, v4 row_ror:8 row_mask:0xf bank_mask:0xf
    ds_read_b64 v[126:127], v34 offset:1664
    ds_read_b64 v[128:129], v34 offset:256
    ds_read_b64 v[130:131], v34 offset:1792
    v_add_f32_dpp v16, v149, v4 row_ror:4 row_mask:0xf bank_mask:0x4
    s_waitcnt lgkmcnt(0)
    v_lshlrev_b32 v60, 16, v108
    v_and_b32 v61, s66, v108
    v_lshlrev_b32 v62, 16, v109
    v_and_b32 v63, s66, v109
    v_lshlrev_b32 v84, 16, v110
    v_and_b32 v85, s66, v110
    v_lshlrev_b32 v86, 16, v111
    v_and_b32 v87, s66, v111
    v_lshlrev_b32 v64, 16, v112
    v_and_b32 v65, s66, v112
    v_lshlrev_b32 v66, 16, v113
    v_and_b32 v67, s66, v113
    v_lshlrev_b32 v88, 16, v114
    v_and_b32 v89, s66, v114
    v_lshlrev_b32 v90, 16, v115
    v_and_b32 v91, s66, v115
    v_lshlrev_b32 v68, 16, v116
    v_and_b32 v69, s66, v116
    v_lshlrev_b32 v70, 16, v117
    v_and_b32 v71, s66, v117
    v_lshlrev_b32 v92, 16, v118
    v_and_b32 v93, s66, v118
    v_lshlrev_b32 v94, 16, v119
    v_and_b32 v95, s66, v119
    v_lshlrev_b32 v72, 16, v120
    v_and_b32 v73, s66, v120
    v_lshlrev_b32 v74, 16, v121
    v_and_b32 v75, s66, v121
    v_lshlrev_b32 v96, 16, v122
    v_and_b32 v97, s66, v122
    v_lshlrev_b32 v98, 16, v123
    v_and_b32 v99, s66, v123
    v_lshlrev_b32 v76, 16, v124
    v_and_b32 v77, s66, v124
    v_lshlrev_b32 v78, 16, v125
    v_and_b32 v79, s66, v125
    v_lshlrev_b32 v100, 16, v126
    v_and_b32 v101, s66, v126
    v_lshlrev_b32 v102, 16, v127
    v_and_b32 v103, s66, v127
    v_lshlrev_b32 v80, 16, v128
    v_and_b32 v81, s66, v128
    v_lshlrev_b32 v82, 16, v129
    v_and_b32 v83, s66, v129
    v_lshlrev_b32 v104, 16, v130
    v_and_b32 v105, s66, v130
    v_lshlrev_b32 v106, 16, v131
    v_and_b32 v107, s66, v131
    v_add_u32 v13, s62, v12
    s_add_u32 s62, s62, 24576
    s_cmp_eq_u32 s62, 73728
    s_cselect_b32 s62, 0, s62
    s_barrier
    ds_read_b128 v[36:39], v13 offset:0
    ds_read_b128 v[40:43], v13 offset:1024
    ds_read_b128 v[44:47], v13 offset:2048
    ds_read_b128 v[48:51], v13 offset:3072
    ds_read_b128 v[52:55], v13 offset:4096
    ds_read_b128 v[56:59], v13 offset:5120
    s_waitcnt lgkmcnt(3)
    v_cvt_f32_i32 v36, v36
    v_cvt_f32_i32 v37, v37
    v_cvt_f32_i32 v38, v38
    v_cvt_f32_i32 v39, v39
    v_cvt_f32_i32 v40, v40
    v_cvt_f32_i32 v41, v41
    v_cvt_f32_i32 v42, v42
    v_cvt_f32_i32 v43, v43
    v_cvt_f32_i32 v44, v44
    v_cvt_f32_i32 v45, v45
    v_cvt_f32_i32 v46, v46
    v_cvt_f32_i32 v47, v47
    v_sub_f32 v36, v36, v60
    v_sub_f32 v37, v37, v61
    v_sub_f32 v38, v38, v62
    v_sub_f32 v39, v39, v63
    v_sub_f32 v40, v40, v64
    v_sub_f32 v41, v41, v65
    v_sub_f32 v42, v42, v66
    v_sub_f32 v43, v43, v67
    v_sub_f32 v44, v44, v68
    v_sub_f32 v45, v45, v69
    v_sub_f32 v46, v46, v70
    v_sub_f32 v47, v47, v71
    v_cvt_pk_bf16_f32 v36, 0, v36
    v_cvt_pk_bf16_f32 v37, 0, v37
    v_cvt_pk_bf16_f32 v38, 0, v38
    v_cvt_pk_bf16_f32 v39, 0, v39
    v_cvt_pk_bf16_f32 v40, 0, v40
    v_cvt_pk_bf16_f32 v41, 0, v41
    v_cvt_pk_bf16_f32 v42, 0, v42
    v_cvt_pk_bf16_f32 v43, 0, v43
    v_cvt_pk_bf16_f32 v44, 0, v44
    v_cvt_pk_bf16_f32 v45, 0, v45
    v_cvt_pk_bf16_f32 v46, 0, v46
    v_cvt_pk_bf16_f32 v47, 0, v47
    v_mul_f32 v36, v36, v84
    v_mul_f32 v37, v37, v85
    v_mul_f32 v38, v38, v86
    v_mul_f32 v39, v39, v87
    v_mul_f32 v40, v40, v88
    v_mul_f32 v41, v41, v89
    v_mul_f32 v42, v42, v90
    v_mul_f32 v43, v43, v91
    v_mul_f32 v44, v44, v92
    v_mul_f32 v45, v45, v93
    v_mul_f32 v46, v46, v94
    v_mul_f32 v47, v47, v95
    v_cvt_pk_bf16_f32 v132, v36, v37
    v_cvt_pk_bf16_f32 v133, v38, v39
    v_cvt_pk_bf16_f32 v134, v40, v41
    v_cvt_pk_bf16_f32 v135, v42, v43
    v_cvt_pk_bf16_f32 v136, v44, v45
    v_cvt_pk_bf16_f32 v137, v46, v47
    v_mfma_f32_16x16x16_bf16 v[144:147], v[132:133], v[156:157], 0
    v_mfma_f32_16x16x16_bf16 v[144:147], v[134:135], v[158:159], v[144:147]
    v_mfma_f32_16x16x16_bf16 v[144:147], v[136:137], v[160:161], v[144:147]
    s_waitcnt lgkmcnt(0)
    v_cvt_f32_i32 v48, v48
    v_cvt_f32_i32 v49, v49
    v_cvt_f32_i32 v50, v50
    v_cvt_f32_i32 v51, v51
    v_cvt_f32_i32 v52, v52
    v_cvt_f32_i32 v53, v53
    v_cvt_f32_i32 v54, v54
    v_cvt_f32_i32 v55, v55
    v_cvt_f32_i32 v56, v56
    v_cvt_f32_i32 v57, v57
    v_cvt_f32_i32 v58, v58
    v_cvt_f32_i32 v59, v59
    v_sub_f32 v48, v48, v72
    v_sub_f32 v49, v49, v73
    v_sub_f32 v50, v50, v74
    v_sub_f32 v51, v51, v75
    v_sub_f32 v52, v52, v76
    v_sub_f32 v53, v53, v77
    v_sub_f32 v54, v54, v78
    v_sub_f32 v55, v55, v79
    v_sub_f32 v56, v56, v80
    v_sub_f32 v57, v57, v81
    v_sub_f32 v58, v58, v82
    v_sub_f32 v59, v59, v83
    v_cvt_pk_bf16_f32 v48, 0, v48
    v_cvt_pk_bf16_f32 v49, 0, v49
    v_cvt_pk_bf16_f32 v50, 0, v50
    v_cvt_pk_bf16_f32 v51, 0, v51
    v_cvt_pk_bf16_f32 v52, 0, v52
    v_cvt_pk_bf16_f32 v53, 0, v53
    v_cvt_pk_bf16_f32 v54, 0, v54
    v_cvt_pk_bf16_f32 v55, 0, v55
    v_cvt_pk_bf16_f32 v56, 0, v56
    v_cvt_pk_bf16_f32 v57, 0, v57
    v_cvt_pk_bf16_f32 v58, 0, v58
    v_cvt_pk_bf16_f32 v59, 0, v59
    v_mul_f32 v48, v48, v96
    v_mul_f32 v49, v49, v97
    v_mul_f32 v50, v50, v98
    v_mul_f32 v51, v51, v99
    v_mul_f32 v52, v52, v100
    v_mul_f32 v53, v53, v101
    v_mul_f32 v54, v54, v102
    v_mul_f32 v55, v55, v103
    v_mul_f32 v56, v56, v104
    v_mul_f32 v57, v57, v105
    v_mul_f32 v58, v58, v106
    v_mul_f32 v59, v59, v107
    v_cvt_pk_bf16_f32 v138, v48, v49
    v_cvt_pk_bf16_f32 v139, v50, v51
    v_add_f32_dpp v3, v144, v147 row_ror:12 row_mask:0xf bank_mask:0xf
    v_cvt_pk_bf16_f32 v140, v52, v53
    v_cvt_pk_bf16_f32 v141, v54, v55
    v_add_f32_dpp v3, v145, v3 row_ror:8 row_mask:0xf bank_mask:0xf
    v_cvt_pk_bf16_f32 v142, v56, v57
    v_cvt_pk_bf16_f32 v143, v58, v59
    v_add_f32_dpp v15, v146, v3 row_ror:4 row_mask:0xf bank_mask:0x8
    v_mfma_f32_16x16x16_bf16 v[148:151], v[138:139], v[156:157], 0
    v_mfma_f32_16x16x16_bf16 v[148:151], v[140:141], v[158:159], v[148:151]
    v_mfma_f32_16x16x16_bf16 v[148:151], v[142:143], v[160:161], v[148:151]
    v_add_u32 v33, s63, v25
    v_add_u32 v34, s63, v26
    ds_read_b64 v[108:109], v33 offset:0
    ds_read_b64 v[110:111], v33 offset:1536
    ds_read_b64 v[112:113], v33 offset:128
    ds_read_b64 v[114:115], v33 offset:1664
    ds_read_b64 v[116:117], v33 offset:256
    ds_read_b64 v[118:119], v33 offset:1792
    ds_read_b64 v[120:121], v34 offset:0
    v_add_f32_dpp v4, v148, v151 row_ror:12 row_mask:0xf bank_mask:0xf
    ds_read_b64 v[122:123], v34 offset:1536
    ds_read_b64 v[124:125], v34 offset:128
    v_add_f32_dpp v4, v149, v4 row_ror:8 row_mask:0xf bank_mask:0xf
    ds_read_b64 v[126:127], v34 offset:1664
    ds_read_b64 v[128:129], v34 offset:256
    ds_read_b64 v[130:131], v34 offset:1792
    v_add_f32_dpp v16, v150, v4 row_ror:4 row_mask:0xf bank_mask:0x8
    v_cvt_pk_bf16_f32 v3, 0, v15
    v_cvt_pk_bf16_f32 v4, 0, v16
    v_mul_f32 v3, s65, v3
    v_mul_f32 v4, s65, v4
    v_cvt_pk_bf16_f32 v5, v3, v4
    v_max3_f32 v14, v14, v3, v4
    ds_write_b32 v11, v5 offset:0
    s_waitcnt lgkmcnt(0)
    v_lshlrev_b32 v60, 16, v108
    v_and_b32 v61, s66, v108
    v_lshlrev_b32 v62, 16, v109
    v_and_b32 v63, s66, v109
    v_lshlrev_b32 v84, 16, v110
    v_and_b32 v85, s66, v110
    v_lshlrev_b32 v86, 16, v111
    v_and_b32 v87, s66, v111
    v_lshlrev_b32 v64, 16, v112
    v_and_b32 v65, s66, v112
    v_lshlrev_b32 v66, 16, v113
    v_and_b32 v67, s66, v113
    v_lshlrev_b32 v88, 16, v114
    v_and_b32 v89, s66, v114
    v_lshlrev_b32 v90, 16, v115
    v_and_b32 v91, s66, v115
    v_lshlrev_b32 v68, 16, v116
    v_and_b32 v69, s66, v116
    v_lshlrev_b32 v70, 16, v117
    v_and_b32 v71, s66, v117
    v_lshlrev_b32 v92, 16, v118
    v_and_b32 v93, s66, v118
    v_lshlrev_b32 v94, 16, v119
    v_and_b32 v95, s66, v119
    v_lshlrev_b32 v72, 16, v120
    v_and_b32 v73, s66, v120
    v_lshlrev_b32 v74, 16, v121
    v_and_b32 v75, s66, v121
    v_lshlrev_b32 v96, 16, v122
    v_and_b32 v97, s66, v122
    v_lshlrev_b32 v98, 16, v123
    v_and_b32 v99, s66, v123
    v_lshlrev_b32 v76, 16, v124
    v_and_b32 v77, s66, v124
    v_lshlrev_b32 v78, 16, v125
    v_and_b32 v79, s66, v125
    v_lshlrev_b32 v100, 16, v126
    v_and_b32 v101, s66, v126
    v_lshlrev_b32 v102, 16, v127
    v_and_b32 v103, s66, v127
    v_lshlrev_b32 v80, 16, v128
    v_and_b32 v81, s66, v128
    v_lshlrev_b32 v82, 16, v129
    v_and_b32 v83, s66, v129
    v_lshlrev_b32 v104, 16, v130
    v_and_b32 v105, s66, v130
    v_lshlrev_b32 v106, 16, v131
    v_and_b32 v107, s66, v131
    v_add_u32 v13, s62, v12
    s_add_u32 s62, s62, 24576
    s_cmp_eq_u32 s62, 73728
    s_cselect_b32 s62, 0, s62
    s_barrier
    ds_read_b128 v[36:39], v13 offset:0
    ds_read_b128 v[40:43], v13 offset:1024
    ds_read_b128 v[44:47], v13 offset:2048
    ds_read_b128 v[48:51], v13 offset:3072
    ds_read_b128 v[52:55], v13 offset:4096
    ds_read_b128 v[56:59], v13 offset:5120
    s_waitcnt lgkmcnt(3)
    v_cvt_f32_i32 v36, v36
    v_cvt_f32_i32 v37, v37
    v_cvt_f32_i32 v38, v38
    v_cvt_f32_i32 v39, v39
    v_cvt_f32_i32 v40, v40
    v_cvt_f32_i32 v41, v41
    v_cvt_f32_i32 v42, v42
    v_cvt_f32_i32 v43, v43
    v_cvt_f32_i32 v44, v44
    v_cvt_f32_i32 v45, v45
    v_cvt_f32_i32 v46, v46
    v_cvt_f32_i32 v47, v47
    v_sub_f32 v36, v36, v60
    v_sub_f32 v37, v37, v61
    v_sub_f32 v38, v38, v62
    v_sub_f32 v39, v39, v63
    v_sub_f32 v40, v40, v64
    v_sub_f32 v41, v41, v65
    v_sub_f32 v42, v42, v66
    v_sub_f32 v43, v43, v67
    v_sub_f32 v44, v44, v68
    v_sub_f32 v45, v45, v69
    v_sub_f32 v46, v46, v70
    v_sub_f32 v47, v47, v71
    v_cvt_pk_bf16_f32 v36, 0, v36
    v_cvt_pk_bf16_f32 v37, 0, v37
    v_cvt_pk_bf16_f32 v38, 0, v38
    v_cvt_pk_bf16_f32 v39, 0, v39
    v_cvt_pk_bf16_f32 v40, 0, v40
    v_cvt_pk_bf16_f32 v41, 0, v41
    v_cvt_pk_bf16_f32 v42, 0, v42
    v_cvt_pk_bf16_f32 v43, 0, v43
    v_cvt_pk_bf16_f32 v44, 0, v44
    v_cvt_pk_bf16_f32 v45, 0, v45
    v_cvt_pk_bf16_f32 v46, 0, v46
    v_cvt_pk_bf16_f32 v47, 0, v47
    v_mul_f32 v36, v36, v84
    v_mul_f32 v37, v37, v85
    v_mul_f32 v38, v38, v86
    v_mul_f32 v39, v39, v87
    v_mul_f32 v40, v40, v88
    v_mul_f32 v41, v41, v89
    v_mul_f32 v42, v42, v90
    v_mul_f32 v43, v43, v91
    v_mul_f32 v44, v44, v92
    v_mul_f32 v45, v45, v93
    v_mul_f32 v46, v46, v94
    v_mul_f32 v47, v47, v95
    v_cvt_pk_bf16_f32 v132, v36, v37
    v_cvt_pk_bf16_f32 v133, v38, v39
    v_cvt_pk_bf16_f32 v134, v40, v41
    v_cvt_pk_bf16_f32 v135, v42, v43
    v_cvt_pk_bf16_f32 v136, v44, v45
    v_cvt_pk_bf16_f32 v137, v46, v47
    v_mfma_f32_16x16x16_bf16 v[144:147], v[132:133], v[156:157], 0
    v_mfma_f32_16x16x16_bf16 v[144:147], v[134:135], v[158:159], v[144:147]
    v_mfma_f32_16x16x16_bf16 v[144:147], v[136:137], v[160:161], v[144:147]
    s_waitcnt lgkmcnt(0)
    v_cvt_f32_i32 v48, v48
    v_cvt_f32_i32 v49, v49
    v_cvt_f32_i32 v50, v50
    v_cvt_f32_i32 v51, v51
    v_cvt_f32_i32 v52, v52
    v_cvt_f32_i32 v53, v53
    v_cvt_f32_i32 v54, v54
    v_cvt_f32_i32 v55, v55
    v_cvt_f32_i32 v56, v56
    v_cvt_f32_i32 v57, v57
    v_cvt_f32_i32 v58, v58
    v_cvt_f32_i32 v59, v59
    v_sub_f32 v48, v48, v72
    v_sub_f32 v49, v49, v73
    v_sub_f32 v50, v50, v74
    v_sub_f32 v51, v51, v75
    v_sub_f32 v52, v52, v76
    v_sub_f32 v53, v53, v77
    v_sub_f32 v54, v54, v78
    v_sub_f32 v55, v55, v79
    v_sub_f32 v56, v56, v80
    v_sub_f32 v57, v57, v81
    v_sub_f32 v58, v58, v82
    v_sub_f32 v59, v59, v83
    v_cvt_pk_bf16_f32 v48, 0, v48
    v_cvt_pk_bf16_f32 v49, 0, v49
    v_cvt_pk_bf16_f32 v50, 0, v50
    v_cvt_pk_bf16_f32 v51, 0, v51
    v_cvt_pk_bf16_f32 v52, 0, v52
    v_cvt_pk_bf16_f32 v53, 0, v53
    v_cvt_pk_bf16_f32 v54, 0, v54
    v_cvt_pk_bf16_f32 v55, 0, v55
    v_cvt_pk_bf16_f32 v56, 0, v56
    v_cvt_pk_bf16_f32 v57, 0, v57
    v_cvt_pk_bf16_f32 v58, 0, v58
    v_cvt_pk_bf16_f32 v59, 0, v59
    v_mul_f32 v48, v48, v96
    v_mul_f32 v49, v49, v97
    v_mul_f32 v50, v50, v98
    v_mul_f32 v51, v51, v99
    v_mul_f32 v52, v52, v100
    v_mul_f32 v53, v53, v101
    v_mul_f32 v54, v54, v102
    v_mul_f32 v55, v55, v103
    v_mul_f32 v56, v56, v104
    v_mul_f32 v57, v57, v105
    v_mul_f32 v58, v58, v106
    v_mul_f32 v59, v59, v107
    v_cvt_pk_bf16_f32 v138, v48, v49
    v_cvt_pk_bf16_f32 v139, v50, v51
    v_add_f32_dpp v3, v145, v144 row_ror:12 row_mask:0xf bank_mask:0xf
    v_cvt_pk_bf16_f32 v140, v52, v53
    v_cvt_pk_bf16_f32 v141, v54, v55
    v_add_f32_dpp v3, v146, v3 row_ror:8 row_mask:0xf bank_mask:0xf
    v_cvt_pk_bf16_f32 v142, v56, v57
    v_cvt_pk_bf16_f32 v143, v58, v59
    v_add_f32_dpp v15, v147, v3 row_ror:4 row_mask:0xf bank_mask:0x1
    v_mfma_f32_16x16x16_bf16 v[148:151], v[138:139], v[156:157], 0
    v_mfma_f32_16x16x16_bf16 v[148:151], v[140:141], v[158:159], v[148:151]
    v_mfma_f32_16x16x16_bf16 v[148:151], v[142:143], v[160:161], v[148:151]
    v_add_u32 v33, s63, v27
    v_add_u32 v34, s63, v28
    ds_read_b64 v[108:109], v33 offset:0
    ds_read_b64 v[110:111], v33 offset:1536
    ds_read_b64 v[112:113], v33 offset:128
    ds_read_b64 v[114:115], v33 offset:1664
    ds_read_b64 v[116:117], v33 offset:256
    ds_read_b64 v[118:119], v33 offset:1792
    ds_read_b64 v[120:121], v34 offset:0
    v_add_f32_dpp v4, v149, v148 row_ror:12 row_mask:0xf bank_mask:0xf
    ds_read_b64 v[122:123], v34 offset:1536
    ds_read_b64 v[124:125], v34 offset:128
    v_add_f32_dpp v4, v150, v4 row_ror:8 row_mask:0xf bank_mask:0xf
    ds_read_b64 v[126:127], v34 offset:1664
    ds_read_b64 v[128:129], v34 offset:256
    ds_read_b64 v[130:131], v34 offset:1792
    v_add_f32_dpp v16, v151, v4 row_ror:4 row_mask:0xf bank_mask:0x1
    s_waitcnt lgkmcnt(0)
    v_lshlrev_b32 v60, 16, v108
    v_and_b32 v61, s66, v108
    v_lshlrev_b32 v62, 16, v109
    v_and_b32 v63, s66, v109
    v_lshlrev_b32 v84, 16, v110
    v_and_b32 v85, s66, v110
    v_lshlrev_b32 v86, 16, v111
    v_and_b32 v87, s66, v111
    v_lshlrev_b32 v64, 16, v112
    v_and_b32 v65, s66, v112
    v_lshlrev_b32 v66, 16, v113
    v_and_b32 v67, s66, v113
    v_lshlrev_b32 v88, 16, v114
    v_and_b32 v89, s66, v114
    v_lshlrev_b32 v90, 16, v115
    v_and_b32 v91, s66, v115
    v_lshlrev_b32 v68, 16, v116
    v_and_b32 v69, s66, v116
    v_lshlrev_b32 v70, 16, v117
    v_and_b32 v71, s66, v117
    v_lshlrev_b32 v92, 16, v118
    v_and_b32 v93, s66, v118
    v_lshlrev_b32 v94, 16, v119
    v_and_b32 v95, s66, v119
    v_lshlrev_b32 v72, 16, v120
    v_and_b32 v73, s66, v120
    v_lshlrev_b32 v74, 16, v121
    v_and_b32 v75, s66, v121
    v_lshlrev_b32 v96, 16, v122
    v_and_b32 v97, s66, v122
    v_lshlrev_b32 v98, 16, v123
    v_and_b32 v99, s66, v123
    v_lshlrev_b32 v76, 16, v124
    v_and_b32 v77, s66, v124
    v_lshlrev_b32 v78, 16, v125
    v_and_b32 v79, s66, v125
    v_lshlrev_b32 v100, 16, v126
    v_and_b32 v101, s66, v126
    v_lshlrev_b32 v102, 16, v127
    v_and_b32 v103, s66, v127
    v_lshlrev_b32 v80, 16, v128
    v_and_b32 v81, s66, v128
    v_lshlrev_b32 v82, 16, v129
    v_and_b32 v83, s66, v129
    v_lshlrev_b32 v104, 16, v130
    v_and_b32 v105, s66, v130
    v_lshlrev_b32 v106, 16, v131
    v_and_b32 v107, s66, v131
    v_add_u32 v13, s62, v12
    s_add_u32 s62, s62, 24576
    s_cmp_eq_u32 s62, 73728
    s_cselect_b32 s62, 0, s62
    s_barrier
    ds_read_b128 v[36:39], v13 offset:0
    ds_read_b128 v[40:43], v13 offset:1024
    ds_read_b128 v[44:47], v13 offset:2048
    ds_read_b128 v[48:51], v13 offset:3072
    ds_read_b128 v[52:55], v13 offset:4096
    ds_read_b128 v[56:59], v13 offset:5120
    s_waitcnt lgkmcnt(3)
    v_cvt_f32_i32 v36, v36
    v_cvt_f32_i32 v37, v37
    v_cvt_f32_i32 v38, v38
    v_cvt_f32_i32 v39, v39
    v_cvt_f32_i32 v40, v40
    v_cvt_f32_i32 v41, v41
    v_cvt_f32_i32 v42, v42
    v_cvt_f32_i32 v43, v43
    v_cvt_f32_i32 v44, v44
    v_cvt_f32_i32 v45, v45
    v_cvt_f32_i32 v46, v46
    v_cvt_f32_i32 v47, v47
    v_sub_f32 v36, v36, v60
    v_sub_f32 v37, v37, v61
    v_sub_f32 v38, v38, v62
    v_sub_f32 v39, v39, v63
    v_sub_f32 v40, v40, v64
    v_sub_f32 v41, v41, v65
    v_sub_f32 v42, v42, v66
    v_sub_f32 v43, v43, v67
    v_sub_f32 v44, v44, v68
    v_sub_f32 v45, v45, v69
    v_sub_f32 v46, v46, v70
    v_sub_f32 v47, v47, v71
    v_cvt_pk_bf16_f32 v36, 0, v36
    v_cvt_pk_bf16_f32 v37, 0, v37
    v_cvt_pk_bf16_f32 v38, 0, v38
    v_cvt_pk_bf16_f32 v39, 0, v39
    v_cvt_pk_bf16_f32 v40, 0, v40
    v_cvt_pk_bf16_f32 v41, 0, v41
    v_cvt_pk_bf16_f32 v42, 0, v42
    v_cvt_pk_bf16_f32 v43, 0, v43
    v_cvt_pk_bf16_f32 v44, 0, v44
    v_cvt_pk_bf16_f32 v45, 0, v45
    v_cvt_pk_bf16_f32 v46, 0, v46
    v_cvt_pk_bf16_f32 v47, 0, v47
    v_mul_f32 v36, v36, v84
    v_mul_f32 v37, v37, v85
    v_mul_f32 v38, v38, v86
    v_mul_f32 v39, v39, v87
    v_mul_f32 v40, v40, v88
    v_mul_f32 v41, v41, v89
    v_mul_f32 v42, v42, v90
    v_mul_f32 v43, v43, v91
    v_mul_f32 v44, v44, v92
    v_mul_f32 v45, v45, v93
    v_mul_f32 v46, v46, v94
    v_mul_f32 v47, v47, v95
    v_cvt_pk_bf16_f32 v132, v36, v37
    v_cvt_pk_bf16_f32 v133, v38, v39
    v_cvt_pk_bf16_f32 v134, v40, v41
    v_cvt_pk_bf16_f32 v135, v42, v43
    v_cvt_pk_bf16_f32 v136, v44, v45
    v_cvt_pk_bf16_f32 v137, v46, v47
    v_mfma_f32_16x16x16_bf16 v[144:147], v[132:133], v[156:157], 0
    v_mfma_f32_16x16x16_bf16 v[144:147], v[134:135], v[158:159], v[144:147]
    v_mfma_f32_16x16x16_bf16 v[144:147], v[136:137], v[160:161], v[144:147]
    s_waitcnt lgkmcnt(0)
    v_cvt_f32_i32 v48, v48
    v_cvt_f32_i32 v49, v49
    v_cvt_f32_i32 v50, v50
    v_cvt_f32_i32 v51, v51
    v_cvt_f32_i32 v52, v52
    v_cvt_f32_i32 v53, v53
    v_cvt_f32_i32 v54, v54
    v_cvt_f32_i32 v55, v55
    v_cvt_f32_i32 v56, v56
    v_cvt_f32_i32 v57, v57
    v_cvt_f32_i32 v58, v58
    v_cvt_f32_i32 v59, v59
    v_sub_f32 v48, v48, v72
    v_sub_f32 v49, v49, v73
    v_sub_f32 v50, v50, v74
    v_sub_f32 v51, v51, v75
    v_sub_f32 v52, v52, v76
    v_sub_f32 v53, v53, v77
    v_sub_f32 v54, v54, v78
    v_sub_f32 v55, v55, v79
    v_sub_f32 v56, v56, v80
    v_sub_f32 v57, v57, v81
    v_sub_f32 v58, v58, v82
    v_sub_f32 v59, v59, v83
    v_cvt_pk_bf16_f32 v48, 0, v48
    v_cvt_pk_bf16_f32 v49, 0, v49
    v_cvt_pk_bf16_f32 v50, 0, v50
    v_cvt_pk_bf16_f32 v51, 0, v51
    v_cvt_pk_bf16_f32 v52, 0, v52
    v_cvt_pk_bf16_f32 v53, 0, v53
    v_cvt_pk_bf16_f32 v54, 0, v54
    v_cvt_pk_bf16_f32 v55, 0, v55
    v_cvt_pk_bf16_f32 v56, 0, v56
    v_cvt_pk_bf16_f32 v57, 0, v57
    v_cvt_pk_bf16_f32 v58, 0, v58
    v_cvt_pk_bf16_f32 v59, 0, v59
    v_mul_f32 v48, v48, v96
    v_mul_f32 v49, v49, v97
    v_mul_f32 v50, v50, v98
    v_mul_f32 v51, v51, v99
    v_mul_f32 v52, v52, v100
    v_mul_f32 v53, v53, v101
    v_mul_f32 v54, v54, v102
    v_mul_f32 v55, v55, v103
    v_mul_f32 v56, v56, v104
    v_mul_f32 v57, v57, v105
    v_mul_f32 v58, v58, v106
    v_mul_f32 v59, v59, v107
    v_cvt_pk_bf16_f32 v138, v48, v49
    v_cvt_pk_bf16_f32 v139, v50, v51
    v_add_f32_dpp v3, v146, v145 row_ror:12 row_mask:0xf bank_mask:0xf
    v_cvt_pk_bf16_f32 v140, v52, v53
    v_cvt_pk_bf16_f32 v141, v54, v55
    v_add_f32_dpp v3, v147, v3 row_ror:8 row_mask:0xf bank_mask:0xf
    v_cvt_pk_bf16_f32 v142, v56, v57
    v_cvt_pk_bf16_f32 v143, v58, v59
    v_add_f32_dpp v15, v144, v3 row_ror:4 row_mask:0xf bank_mask:0x2
    v_mfma_f32_16x16x16_bf16 v[148:151], v[138:139], v[156:157], 0
    v_mfma_f32_16x16x16_bf16 v[148:151], v[140:141], v[158:159], v[148:151]
    v_mfma_f32_16x16x16_bf16 v[148:151], v[142:143], v[160:161], v[148:151]
    v_add_u32 v33, s63, v29
    v_add_u32 v34, s63, v30
    ds_read_b64 v[108:109], v33 offset:0
    ds_read_b64 v[110:111], v33 offset:1536
    ds_read_b64 v[112:113], v33 offset:128
    ds_read_b64 v[114:115], v33 offset:1664
    ds_read_b64 v[116:117], v33 offset:256
    ds_read_b64 v[118:119], v33 offset:1792
    ds_read_b64 v[120:121], v34 offset:0
    v_add_f32_dpp v4, v150, v149 row_ror:12 row_mask:0xf bank_mask:0xf
    ds_read_b64 v[122:123], v34 offset:1536
    ds_read_b64 v[124:125], v34 offset:128
    v_add_f32_dpp v4, v151, v4 row_ror:8 row_mask:0xf bank_mask:0xf
    ds_read_b64 v[126:127], v34 offset:1664
    ds_read_b64 v[128:129], v34 offset:256
    ds_read_b64 v[130:131], v34 offset:1792
    v_add_f32_dpp v16, v148, v4 row_ror:4 row_mask:0xf bank_mask:0x2
    s_waitcnt lgkmcnt(0)
    v_lshlrev_b32 v60, 16, v108
    v_and_b32 v61, s66, v108
    v_lshlrev_b32 v62, 16, v109
    v_and_b32 v63, s66, v109
    v_lshlrev_b32 v84, 16, v110
    v_and_b32 v85, s66, v110
    v_lshlrev_b32 v86, 16, v111
    v_and_b32 v87, s66, v111
    v_lshlrev_b32 v64, 16, v112
    v_and_b32 v65, s66, v112
    v_lshlrev_b32 v66, 16, v113
    v_and_b32 v67, s66, v113
    v_lshlrev_b32 v88, 16, v114
    v_and_b32 v89, s66, v114
    v_lshlrev_b32 v90, 16, v115
    v_and_b32 v91, s66, v115
    v_lshlrev_b32 v68, 16, v116
    v_and_b32 v69, s66, v116
    v_lshlrev_b32 v70, 16, v117
    v_and_b32 v71, s66, v117
    v_lshlrev_b32 v92, 16, v118
    v_and_b32 v93, s66, v118
    v_lshlrev_b32 v94, 16, v119
    v_and_b32 v95, s66, v119
    v_lshlrev_b32 v72, 16, v120
    v_and_b32 v73, s66, v120
    v_lshlrev_b32 v74, 16, v121
    v_and_b32 v75, s66, v121
    v_lshlrev_b32 v96, 16, v122
    v_and_b32 v97, s66, v122
    v_lshlrev_b32 v98, 16, v123
    v_and_b32 v99, s66, v123
    v_lshlrev_b32 v76, 16, v124
    v_and_b32 v77, s66, v124
    v_lshlrev_b32 v78, 16, v125
    v_and_b32 v79, s66, v125
    v_lshlrev_b32 v100, 16, v126
    v_and_b32 v101, s66, v126
    v_lshlrev_b32 v102, 16, v127
    v_and_b32 v103, s66, v127
    v_lshlrev_b32 v80, 16, v128
    v_and_b32 v81, s66, v128
    v_lshlrev_b32 v82, 16, v129
    v_and_b32 v83, s66, v129
    v_lshlrev_b32 v104, 16, v130
    v_and_b32 v105, s66, v130
    v_lshlrev_b32 v106, 16, v131
    v_and_b32 v107, s66, v131
    v_add_u32 v13, s62, v12
    s_add_u32 s62, s62, 24576
    s_cmp_eq_u32 s62, 73728
    s_cselect_b32 s62, 0, s62
    s_barrier
    ds_read_b128 v[36:39], v13 offset:0
    ds_read_b128 v[40:43], v13 offset:1024
    ds_read_b128 v[44:47], v13 offset:2048
    ds_read_b128 v[48:51], v13 offset:3072
    ds_read_b128 v[52:55], v13 offset:4096
    ds_read_b128 v[56:59], v13 offset:5120
    s_waitcnt lgkmcnt(3)
    v_cvt_f32_i32 v36, v36
    v_cvt_f32_i32 v37, v37
    v_cvt_f32_i32 v38, v38
    v_cvt_f32_i32 v39, v39
    v_cvt_f32_i32 v40, v40
    v_cvt_f32_i32 v41, v41
    v_cvt_f32_i32 v42, v42
    v_cvt_f32_i32 v43, v43
    v_cvt_f32_i32 v44, v44
    v_cvt_f32_i32 v45, v45
    v_cvt_f32_i32 v46, v46
    v_cvt_f32_i32 v47, v47
    v_sub_f32 v36, v36, v60
    v_sub_f32 v37, v37, v61
    v_sub_f32 v38, v38, v62
    v_sub_f32 v39, v39, v63
    v_sub_f32 v40, v40, v64
    v_sub_f32 v41, v41, v65
    v_sub_f32 v42, v42, v66
    v_sub_f32 v43, v43, v67
    v_sub_f32 v44, v44, v68
    v_sub_f32 v45, v45, v69
    v_sub_f32 v46, v46, v70
    v_sub_f32 v47, v47, v71
    v_cvt_pk_bf16_f32 v36, 0, v36
    v_cvt_pk_bf16_f32 v37, 0, v37
    v_cvt_pk_bf16_f32 v38, 0, v38
    v_cvt_pk_bf16_f32 v39, 0, v39
    v_cvt_pk_bf16_f32 v40, 0, v40
    v_cvt_pk_bf16_f32 v41, 0, v41
    v_cvt_pk_bf16_f32 v42, 0, v42
    v_cvt_pk_bf16_f32 v43, 0, v43
    v_cvt_pk_bf16_f32 v44, 0, v44
    v_cvt_pk_bf16_f32 v45, 0, v45
    v_cvt_pk_bf16_f32 v46, 0, v46
    v_cvt_pk_bf16_f32 v47, 0, v47
    v_mul_f32 v36, v36, v84
    v_mul_f32 v37, v37, v85
    v_mul_f32 v38, v38, v86
    v_mul_f32 v39, v39, v87
    v_mul_f32 v40, v40, v88
    v_mul_f32 v41, v41, v89
    v_mul_f32 v42, v42, v90
    v_mul_f32 v43, v43, v91
    v_mul_f32 v44, v44, v92
    v_mul_f32 v45, v45, v93
    v_mul_f32 v46, v46, v94
    v_mul_f32 v47, v47, v95
    v_cvt_pk_bf16_f32 v132, v36, v37
    v_cvt_pk_bf16_f32 v133, v38, v39
    v_cvt_pk_bf16_f32 v134, v40, v41
    v_cvt_pk_bf16_f32 v135, v42, v43
    v_cvt_pk_bf16_f32 v136, v44, v45
    v_cvt_pk_bf16_f32 v137, v46, v47
    v_mfma_f32_16x16x16_bf16 v[144:147], v[132:133], v[156:157], 0
    v_mfma_f32_16x16x16_bf16 v[144:147], v[134:135], v[158:159], v[144:147]
    v_mfma_f32_16x16x16_bf16 v[144:147], v[136:137], v[160:161], v[144:147]
    s_waitcnt lgkmcnt(0)
    v_cvt_f32_i32 v48, v48
    v_cvt_f32_i32 v49, v49
    v_cvt_f32_i32 v50, v50
    v_cvt_f32_i32 v51, v51
    v_cvt_f32_i32 v52, v52
    v_cvt_f32_i32 v53, v53
    v_cvt_f32_i32 v54, v54
    v_cvt_f32_i32 v55, v55
    v_cvt_f32_i32 v56, v56
    v_cvt_f32_i32 v57, v57
    v_cvt_f32_i32 v58, v58
    v_cvt_f32_i32 v59, v59
    v_sub_f32 v48, v48, v72
    v_sub_f32 v49, v49, v73
    v_sub_f32 v50, v50, v74
    v_sub_f32 v51, v51, v75
    v_sub_f32 v52, v52, v76
    v_sub_f32 v53, v53, v77
    v_sub_f32 v54, v54, v78
    v_sub_f32 v55, v55, v79
    v_sub_f32 v56, v56, v80
    v_sub_f32 v57, v57, v81
    v_sub_f32 v58, v58, v82
    v_sub_f32 v59, v59, v83
    v_cvt_pk_bf16_f32 v48, 0, v48
    v_cvt_pk_bf16_f32 v49, 0, v49
    v_cvt_pk_bf16_f32 v50, 0, v50
    v_cvt_pk_bf16_f32 v51, 0, v51
    v_cvt_pk_bf16_f32 v52, 0, v52
    v_cvt_pk_bf16_f32 v53, 0, v53
    v_cvt_pk_bf16_f32 v54, 0, v54
    v_cvt_pk_bf16_f32 v55, 0, v55
    v_cvt_pk_bf16_f32 v56, 0, v56
    v_cvt_pk_bf16_f32 v57, 0, v57
    v_cvt_pk_bf16_f32 v58, 0, v58
    v_cvt_pk_bf16_f32 v59, 0, v59
    v_mul_f32 v48, v48, v96
    v_mul_f32 v49, v49, v97
    v_mul_f32 v50, v50, v98
    v_mul_f32 v51, v51, v99
    v_mul_f32 v52, v52, v100
    v_mul_f32 v53, v53, v101
    v_mul_f32 v54, v54, v102
    v_mul_f32 v55, v55, v103
    v_mul_f32 v56, v56, v104
    v_mul_f32 v57, v57, v105
    v_mul_f32 v58, v58, v106
    v_mul_f32 v59, v59, v107
    v_cvt_pk_bf16_f32 v138, v48, v49
    v_cvt_pk_bf16_f32 v139, v50, v51
    v_add_f32_dpp v3, v147, v146 row_ror:12 row_mask:0xf bank_mask:0xf
    v_cvt_pk_bf16_f32 v140, v52, v53
    v_cvt_pk_bf16_f32 v141, v54, v55
    v_add_f32_dpp v3, v144, v3 row_ror:8 row_mask:0xf bank_mask:0xf
    v_cvt_pk_bf16_f32 v142, v56, v57
    v_cvt_pk_bf16_f32 v143, v58, v59
    v_add_f32_dpp v15, v145, v3 row_ror:4 row_mask:0xf bank_mask:0x4
    v_mfma_f32_16x16x16_bf16 v[148:151], v[138:139], v[156:157], 0
    v_mfma_f32_16x16x16_bf16 v[148:151], v[140:141], v[158:159], v[148:151]
    v_mfma_f32_16x16x16_bf16 v[148:151], v[142:143], v[160:161], v[148:151]
    v_add_u32 v33, s63, v31
    v_add_u32 v34, s63, v32
    ds_read_b64 v[108:109], v33 offset:0
    ds_read_b64 v[110:111], v33 offset:1536
    ds_read_b64 v[112:113], v33 offset:128
    ds_read_b64 v[114:115], v33 offset:1664
    ds_read_b64 v[116:117], v33 offset:256
    ds_read_b64 v[118:119], v33 offset:1792
    ds_read_b64 v[120:121], v34 offset:0
    v_add_f32_dpp v4, v151, v150 row_ror:12 row_mask:0xf bank_mask:0xf
    ds_read_b64 v[122:123], v34 offset:1536
    ds_read_b64 v[124:125], v34 offset:128
    v_add_f32_dpp v4, v148, v4 row_ror:8 row_mask:0xf bank_mask:0xf
    ds_read_b64 v[126:127], v34 offset:1664
    ds_read_b64 v[128:129], v34 offset:256
    ds_read_b64 v[130:131], v34 offset:1792
    v_add_f32_dpp v16, v149, v4 row_ror:4 row_mask:0xf bank_mask:0x4
    s_waitcnt lgkmcnt(0)
    v_lshlrev_b32 v60, 16, v108
    v_and_b32 v61, s66, v108
    v_lshlrev_b32 v62, 16, v109
    v_and_b32 v63, s66, v109
    v_lshlrev_b32 v84, 16, v110
    v_and_b32 v85, s66, v110
    v_lshlrev_b32 v86, 16, v111
    v_and_b32 v87, s66, v111
    v_lshlrev_b32 v64, 16, v112
    v_and_b32 v65, s66, v112
    v_lshlrev_b32 v66, 16, v113
    v_and_b32 v67, s66, v113
    v_lshlrev_b32 v88, 16, v114
    v_and_b32 v89, s66, v114
    v_lshlrev_b32 v90, 16, v115
    v_and_b32 v91, s66, v115
    v_lshlrev_b32 v68, 16, v116
    v_and_b32 v69, s66, v116
    v_lshlrev_b32 v70, 16, v117
    v_and_b32 v71, s66, v117
    v_lshlrev_b32 v92, 16, v118
    v_and_b32 v93, s66, v118
    v_lshlrev_b32 v94, 16, v119
    v_and_b32 v95, s66, v119
    v_lshlrev_b32 v72, 16, v120
    v_and_b32 v73, s66, v120
    v_lshlrev_b32 v74, 16, v121
    v_and_b32 v75, s66, v121
    v_lshlrev_b32 v96, 16, v122
    v_and_b32 v97, s66, v122
    v_lshlrev_b32 v98, 16, v123
    v_and_b32 v99, s66, v123
    v_lshlrev_b32 v76, 16, v124
    v_and_b32 v77, s66, v124
    v_lshlrev_b32 v78, 16, v125
    v_and_b32 v79, s66, v125
    v_lshlrev_b32 v100, 16, v126
    v_and_b32 v101, s66, v126
    v_lshlrev_b32 v102, 16, v127
    v_and_b32 v103, s66, v127
    v_lshlrev_b32 v80, 16, v128
    v_and_b32 v81, s66, v128
    v_lshlrev_b32 v82, 16, v129
    v_and_b32 v83, s66, v129
    v_lshlrev_b32 v104, 16, v130
    v_and_b32 v105, s66, v130
    v_lshlrev_b32 v106, 16, v131
    v_and_b32 v107, s66, v131
    v_add_u32 v13, s62, v12
    s_add_u32 s62, s62, 24576
    s_cmp_eq_u32 s62, 73728
    s_cselect_b32 s62, 0, s62
    s_barrier
    ds_read_b128 v[36:39], v13 offset:0
    ds_read_b128 v[40:43], v13 offset:1024
    ds_read_b128 v[44:47], v13 offset:2048
    ds_read_b128 v[48:51], v13 offset:3072
    ds_read_b128 v[52:55], v13 offset:4096
    ds_read_b128 v[56:59], v13 offset:5120
    s_waitcnt lgkmcnt(3)
    v_cvt_f32_i32 v36, v36
    v_cvt_f32_i32 v37, v37
    v_cvt_f32_i32 v38, v38
    v_cvt_f32_i32 v39, v39
    v_cvt_f32_i32 v40, v40
    v_cvt_f32_i32 v41, v41
    v_cvt_f32_i32 v42, v42
    v_cvt_f32_i32 v43, v43
    v_cvt_f32_i32 v44, v44
    v_cvt_f32_i32 v45, v45
    v_cvt_f32_i32 v46, v46
    v_cvt_f32_i32 v47, v47
    v_sub_f32 v36, v36, v60
    v_sub_f32 v37, v37, v61
    v_sub_f32 v38, v38, v62
    v_sub_f32 v39, v39, v63
    v_sub_f32 v40, v40, v64
    v_sub_f32 v41, v41, v65
    v_sub_f32 v42, v42, v66
    v_sub_f32 v43, v43, v67
    v_sub_f32 v44, v44, v68
    v_sub_f32 v45, v45, v69
    v_sub_f32 v46, v46, v70
    v_sub_f32 v47, v47, v71
    v_cvt_pk_bf16_f32 v36, 0, v36
    v_cvt_pk_bf16_f32 v37, 0, v37
    v_cvt_pk_bf16_f32 v38, 0, v38
    v_cvt_pk_bf16_f32 v39, 0, v39
    v_cvt_pk_bf16_f32 v40, 0, v40
    v_cvt_pk_bf16_f32 v41, 0, v41
    v_cvt_pk_bf16_f32 v42, 0, v42
    v_cvt_pk_bf16_f32 v43, 0, v43
    v_cvt_pk_bf16_f32 v44, 0, v44
    v_cvt_pk_bf16_f32 v45, 0, v45
    v_cvt_pk_bf16_f32 v46, 0, v46
    v_cvt_pk_bf16_f32 v47, 0, v47
    v_mul_f32 v36, v36, v84
    v_mul_f32 v37, v37, v85
    v_mul_f32 v38, v38, v86
    v_mul_f32 v39, v39, v87
    v_mul_f32 v40, v40, v88
    v_mul_f32 v41, v41, v89
    v_mul_f32 v42, v42, v90
    v_mul_f32 v43, v43, v91
    v_mul_f32 v44, v44, v92
    v_mul_f32 v45, v45, v93
    v_mul_f32 v46, v46, v94
    v_mul_f32 v47, v47, v95
    v_cvt_pk_bf16_f32 v132, v36, v37
    v_cvt_pk_bf16_f32 v133, v38, v39
    v_cvt_pk_bf16_f32 v134, v40, v41
    v_cvt_pk_bf16_f32 v135, v42, v43
    v_cvt_pk_bf16_f32 v136, v44, v45
    v_cvt_pk_bf16_f32 v137, v46, v47
    v_mfma_f32_16x16x16_bf16 v[144:147], v[132:133], v[156:157], 0
    v_mfma_f32_16x16x16_bf16 v[144:147], v[134:135], v[158:159], v[144:147]
    v_mfma_f32_16x16x16_bf16 v[144:147], v[136:137], v[160:161], v[144:147]
    s_waitcnt lgkmcnt(0)
    v_cvt_f32_i32 v48, v48
    v_cvt_f32_i32 v49, v49
    v_cvt_f32_i32 v50, v50
    v_cvt_f32_i32 v51, v51
    v_cvt_f32_i32 v52, v52
    v_cvt_f32_i32 v53, v53
    v_cvt_f32_i32 v54, v54
    v_cvt_f32_i32 v55, v55
    v_cvt_f32_i32 v56, v56
    v_cvt_f32_i32 v57, v57
    v_cvt_f32_i32 v58, v58
    v_cvt_f32_i32 v59, v59
    v_sub_f32 v48, v48, v72
    v_sub_f32 v49, v49, v73
    v_sub_f32 v50, v50, v74
    v_sub_f32 v51, v51, v75
    v_sub_f32 v52, v52, v76
    v_sub_f32 v53, v53, v77
    v_sub_f32 v54, v54, v78
    v_sub_f32 v55, v55, v79
    v_sub_f32 v56, v56, v80
    v_sub_f32 v57, v57, v81
    v_sub_f32 v58, v58, v82
    v_sub_f32 v59, v59, v83
    v_cvt_pk_bf16_f32 v48, 0, v48
    v_cvt_pk_bf16_f32 v49, 0, v49
    v_cvt_pk_bf16_f32 v50, 0, v50
    v_cvt_pk_bf16_f32 v51, 0, v51
    v_cvt_pk_bf16_f32 v52, 0, v52
    v_cvt_pk_bf16_f32 v53, 0, v53
    v_cvt_pk_bf16_f32 v54, 0, v54
    v_cvt_pk_bf16_f32 v55, 0, v55
    v_cvt_pk_bf16_f32 v56, 0, v56
    v_cvt_pk_bf16_f32 v57, 0, v57
    v_cvt_pk_bf16_f32 v58, 0, v58
    v_cvt_pk_bf16_f32 v59, 0, v59
    v_mul_f32 v48, v48, v96
    v_mul_f32 v49, v49, v97
    v_mul_f32 v50, v50, v98
    v_mul_f32 v51, v51, v99
    v_mul_f32 v52, v52, v100
    v_mul_f32 v53, v53, v101
    v_mul_f32 v54, v54, v102
    v_mul_f32 v55, v55, v103
    v_mul_f32 v56, v56, v104
    v_mul_f32 v57, v57, v105
    v_mul_f32 v58, v58, v106
    v_mul_f32 v59, v59, v107
    v_cvt_pk_bf16_f32 v138, v48, v49
    v_cvt_pk_bf16_f32 v139, v50, v51
    v_add_f32_dpp v3, v144, v147 row_ror:12 row_mask:0xf bank_mask:0xf
    v_cvt_pk_bf16_f32 v140, v52, v53
    v_cvt_pk_bf16_f32 v141, v54, v55
    v_add_f32_dpp v3, v145, v3 row_ror:8 row_mask:0xf bank_mask:0xf
    v_cvt_pk_bf16_f32 v142, v56, v57
    v_cvt_pk_bf16_f32 v143, v58, v59
    v_add_f32_dpp v15, v146, v3 row_ror:4 row_mask:0xf bank_mask:0x8
    v_mfma_f32_16x16x16_bf16 v[148:151], v[138:139], v[156:157], 0
    v_mfma_f32_16x16x16_bf16 v[148:151], v[140:141], v[158:159], v[148:151]
    v_mfma_f32_16x16x16_bf16 v[148:151], v[142:143], v[160:161], v[148:151]
    s_add_u32 s63, s63, 3072
    v_add_u32 v33, s63, v17
    v_add_u32 v34, s63, v18
    ds_read_b64 v[108:109], v33 offset:0
    ds_read_b64 v[110:111], v33 offset:1536
    ds_read_b64 v[112:113], v33 offset:128
    ds_read_b64 v[114:115], v33 offset:1664
    ds_read_b64 v[116:117], v33 offset:256
    ds_read_b64 v[118:119], v33 offset:1792
    ds_read_b64 v[120:121], v34 offset:0
    v_add_f32_dpp v4, v148, v151 row_ror:12 row_mask:0xf bank_mask:0xf
    ds_read_b64 v[122:123], v34 offset:1536
    ds_read_b64 v[124:125], v34 offset:128
    v_add_f32_dpp v4, v149, v4 row_ror:8 row_mask:0xf bank_mask:0xf
    ds_read_b64 v[126:127], v34 offset:1664
    ds_read_b64 v[128:129], v34 offset:256
    ds_read_b64 v[130:131], v34 offset:1792
    v_add_f32_dpp v16, v150, v4 row_ror:4 row_mask:0xf bank_mask:0x8
    v_cvt_pk_bf16_f32 v3, 0, v15
    v_cvt_pk_bf16_f32 v4, 0, v16
    v_mul_f32 v3, s65, v3
    v_mul_f32 v4, s65, v4
    v_cvt_pk_bf16_f32 v5, v3, v4
    v_max3_f32 v14, v14, v3, v4
    ds_write_b32 v11, v5 offset:256
    s_waitcnt lgkmcnt(0)
    v_lshlrev_b32 v60, 16, v108
    v_and_b32 v61, s66, v108
    v_lshlrev_b32 v62, 16, v109
    v_and_b32 v63, s66, v109
    v_lshlrev_b32 v84, 16, v110
    v_and_b32 v85, s66, v110
    v_lshlrev_b32 v86, 16, v111
    v_and_b32 v87, s66, v111
    v_lshlrev_b32 v64, 16, v112
    v_and_b32 v65, s66, v112
    v_lshlrev_b32 v66, 16, v113
    v_and_b32 v67, s66, v113
    v_lshlrev_b32 v88, 16, v114
    v_and_b32 v89, s66, v114
    v_lshlrev_b32 v90, 16, v115
    v_and_b32 v91, s66, v115
    v_lshlrev_b32 v68, 16, v116
    v_and_b32 v69, s66, v116
    v_lshlrev_b32 v70, 16, v117
    v_and_b32 v71, s66, v117
    v_lshlrev_b32 v92, 16, v118
    v_and_b32 v93, s66, v118
    v_lshlrev_b32 v94, 16, v119
    v_and_b32 v95, s66, v119
    v_lshlrev_b32 v72, 16, v120
    v_and_b32 v73, s66, v120
    v_lshlrev_b32 v74, 16, v121
    v_and_b32 v75, s66, v121
    v_lshlrev_b32 v96, 16, v122
    v_and_b32 v97, s66, v122
    v_lshlrev_b32 v98, 16, v123
    v_and_b32 v99, s66, v123
    v_lshlrev_b32 v76, 16, v124
    v_and_b32 v77, s66, v124
    v_lshlrev_b32 v78, 16, v125
    v_and_b32 v79, s66, v125
    v_lshlrev_b32 v100, 16, v126
    v_and_b32 v101, s66, v126
    v_lshlrev_b32 v102, 16, v127
    v_and_b32 v103, s66, v127
    v_lshlrev_b32 v80, 16, v128
    v_and_b32 v81, s66, v128
    v_lshlrev_b32 v82, 16, v129
    v_and_b32 v83, s66, v129
    v_lshlrev_b32 v104, 16, v130
    v_and_b32 v105, s66, v130
    v_lshlrev_b32 v106, 16, v131
    v_and_b32 v107, s66, v131
    v_add_u32 v11, 3072, v11
    s_add_u32 s61, s61, 1
    s_cmp_eq_u32 s61, s3
    s_cbranch_scc1 L_kblk_end
    s_cmp_eq_u32 s61, s73
    s_cbranch_scc1 L_kblk_end
    s_cmp_lt_u32 s61, 16
    s_cbranch_scc1 L_kblk
L_kblk_end:
    s_cmp_eq_u32 s74, 0
    s_cselect_b64 vcc, -1, 0
    v_cndmask_b32 v153, v153, v14, vcc
    s_cmp_eq_u32 s74, 1
    s_cselect_b64 vcc, -1, 0
    v_cndmask_b32 v154, v154, v14, vcc
    s_cmp_eq_u32 s74, 2
    s_cselect_b64 vcc, -1, 0
    v_cndmask_b32 v155, v155, v14, vcc
    s_add_u32 s74, s74, 1
    v_mov_b32 v156, v162
    v_mov_b32 v157, v163
    v_mov_b32 v158, v164
    v_mov_b32 v159, v165
    v_mov_b32 v160, v166
    v_mov_b32 v161, v167
    v_mov_b32 v162, v168
    v_mov_b32 v163, v169
    v_mov_b32 v164, v170
    v_mov_b32 v165, v171
    v_mov_b32 v166, v172
    v_mov_b32 v167, v173
    v_mov_b32 v14, 0xff800000
    s_cmp_lt_u32 s61, 16
    s_cbranch_scc1 L_kblk
    v_subrev_u32 v11, 49152, v11
    s_mov_b32 s63, 0
    v_add_u32 v211, s63, v7
    v_add_u32 v212, s63, v8
    ds_read_b32 v210, v11 offset:0
    ds_read_u16 v213, v211 offset:512
    ds_read_u16 v214, v212 offset:512
    ds_read_u16 v211, v211
    ds_read_u16 v212, v212
    v_mov_b32 v204, 0
    v_mov_b32 v205, 0
    v_mov_b32 v206, 0
    v_mov_b32 v207, 0
    s_mov_b32 s61, 0
L_vround:
    v_mov_b32 v14, v153
    v_mov_b32 v153, v154
    v_mov_b32 v154, v155
    v_mov_b32 v156, 0
    v_mov_b32 v157, 0
    v_mov_b32 v158, 0
    v_mov_b32 v159, 0
    v_mov_b32 v160, 0
    v_mov_b32 v161, 0
    v_mov_b32 v162, 0
    v_mov_b32 v163, 0
    v_mov_b32 v164, 0
    v_mov_b32 v165, 0
    v_mov_b32 v166, 0
    v_mov_b32 v167, 0
    v_mov_b32 v168, 0
    v_mov_b32 v169, 0
    v_mov_b32 v170, 0
    v_mov_b32 v171, 0
    v_mov_b32 v172, 0
    v_mov_b32 v173, 0
    v_mov_b32 v174, 0
    v_mov_b32 v175, 0
    v_mov_b32 v176, 0
    v_mov_b32 v177, 0
    v_mov_b32 v178, 0
    v_mov_b32 v179, 0
    v_mov_b32 v180, 0
    v_mov_b32 v181, 0
    v_mov_b32 v182, 0
    v_mov_b32 v183, 0
    v_mov_b32 v184, 0
    v_mov_b32 v185, 0
    v_mov_b32 v186, 0
    v_mov_b32 v187, 0
    v_mov_b32 v188, 0
    v_mov_b32 v189, 0
    v_mov_b32 v190, 0
    v_mov_b32 v191, 0
    v_mov_b32 v192, 0
    v_mov_b32 v193, 0
    v_mov_b32 v194, 0
    v_mov_b32 v195, 0
    v_mov_b32 v196, 0
    v_mov_b32 v197, 0
    v_mov_b32 v198, 0
    v_mov_b32 v199, 0
    v_mov_b32 v200, 0
    v_mov_b32 v201, 0
    v_mov_b32 v202, 0
    v_mov_b32 v203, 0
    v_mov_b32 v208, 0
    v_mov_b32 v209, 0
    s_nop 1
    v_max_f32_dpp v14, v14, v14 row_ror:4 row_mask:0xf bank_mask:0xf
    s_nop 1
    v_max_f32_dpp v14, v14, v14 row_ror:8 row_mask:0xf bank_mask:0xf
    v_mov_b32 v3, v14
    s_nop 1
    v_permlane16_swap_b32 v14, v3
    v_max_f32 v14, v14, v3
    v_mov_b32 v3, v14
    s_nop 1
    v_permlane32_swap_b32 v14, v3
    v_max_f32 v14, v14, v3
    v_cvt_pk_bf16_f32 v14, 0, v14
    v_mul_f32 v14, s64, v14
L_vblk:
    v_add_u32 v13, s62, v12
    s_add_u32 s62, s62, 24576
    s_cmp_eq_u32 s62, 73728
    s_cselect_b32 s62, 0, s62
    s_barrier
    ds_read_b128 v[36:39], v13 offset:0
    ds_read_b128 v[40:43], v13 offset:1024
    ds_read_b128 v[44:47], v13 offset:2048
    ds_read_b128 v[48:51], v13 offset:3072
    ds_read_b128 v[52:55], v13 offset:4096
    ds_read_b128 v[56:59], v13 offset:5120
    s_waitcnt lgkmcnt(6)
    v_lshlrev_b32 v215, 16, v210
    v_and_b32 v216, s66, v210
    v_fma_f32 v215, v215, s64, -v14
    v_fma_f32 v216, v216, s64, -v14
    v_exp_f32 v215, v215
    v_exp_f32 v216, v216
    v_lshlrev_b32 v217, 16, v211
    v_lshlrev_b32 v218, 16, v212
    v_mul_f32 v217, v215, v217
    v_mul_f32 v218, v216, v218
    v_add_f32 v208, v208, v215
    v_cvt_pk_bf16_f32 v217, v217, v218
    v_add_f32 v208, v208, v216
    v_lshlrev_b32 v219, 16, v213
    v_lshlrev_b32 v220, 16, v214
    v_lshlrev_b32 v215, 16, v217
    v_and_b32 v216, s66, v217
    v_fmac_f32 v209, v215, v219
    v_fmac_f32 v209, v216, v220
    v_mov_b32_dpp v204, v217 quad_perm:[0,1,2,3] row_mask:0xf bank_mask:0x1
    v_mov_b32_dpp v205, v217 quad_perm:[0,1,2,3] row_mask:0xf bank_mask:0x2
    v_mov_b32_dpp v206, v217 quad_perm:[0,1,2,3] row_mask:0xf bank_mask:0x4
    v_mov_b32_dpp v207, v217 quad_perm:[0,1,2,3] row_mask:0xf bank_mask:0x8
    s_waitcnt lgkmcnt(3)
    v_cvt_f32_i32 v36, v36
    v_cvt_f32_i32 v37, v37
    v_cvt_f32_i32 v38, v38
    v_cvt_f32_i32 v39, v39
    v_cvt_f32_i32 v40, v40
    v_cvt_f32_i32 v41, v41
    v_cvt_f32_i32 v42, v42
    v_cvt_f32_i32 v43, v43
    v_cvt_f32_i32 v44, v44
    v_cvt_f32_i32 v45, v45
    v_cvt_f32_i32 v46, v46
    v_cvt_f32_i32 v47, v47
    s_waitcnt lgkmcnt(0)
    v_cvt_f32_i32 v48, v48
    v_cvt_f32_i32 v49, v49
    v_cvt_f32_i32 v50, v50
    v_cvt_f32_i32 v51, v51
    v_cvt_f32_i32 v52, v52
    v_cvt_f32_i32 v53, v53
    v_cvt_f32_i32 v54, v54
    v_cvt_f32_i32 v55, v55
    v_cvt_f32_i32 v56, v56
    v_cvt_f32_i32 v57, v57
    v_cvt_f32_i32 v58, v58
    v_cvt_f32_i32 v59, v59
    v_cvt_pk_bf16_f32 v60, v36, v48
    v_cvt_pk_bf16_f32 v64, v37, v49
    v_cvt_pk_bf16_f32 v68, v38, v50
    v_cvt_pk_bf16_f32 v72, v39, v51
    v_cvt_pk_bf16_f32 v76, v40, v52
    v_cvt_pk_bf16_f32 v80, v41, v53
    v_cvt_pk_bf16_f32 v84, v42, v54
    v_cvt_pk_bf16_f32 v88, v43, v55
    v_cvt_pk_bf16_f32 v92, v44, v56
    v_cvt_pk_bf16_f32 v96, v45, v57
    v_cvt_pk_bf16_f32 v100, v46, v58
    v_cvt_pk_bf16_f32 v104, v47, v59
    v_add_u32 v211, s63, v9
    v_add_u32 v212, s63, v10
    ds_read_b32 v210, v11 offset:256
    ds_read_u16 v213, v211 offset:512
    ds_read_u16 v214, v212 offset:512
    ds_read_u16 v211, v211
    ds_read_u16 v212, v212
    v_add_u32 v13, s62, v12
    s_add_u32 s62, s62, 24576
    s_cmp_eq_u32 s62, 73728
    s_cselect_b32 s62, 0, s62
    s_barrier
    ds_read_b128 v[36:39], v13 offset:0
    ds_read_b128 v[40:43], v13 offset:1024
    ds_read_b128 v[44:47], v13 offset:2048
    ds_read_b128 v[48:51], v13 offset:3072
    ds_read_b128 v[52:55], v13 offset:4096
    ds_read_b128 v[56:59], v13 offset:5120
    s_waitcnt lgkmcnt(3)
    v_cvt_f32_i32 v36, v36
    v_cvt_f32_i32 v37, v37
    v_cvt_f32_i32 v38, v38
    v_cvt_f32_i32 v39, v39
    v_cvt_f32_i32 v40, v40
    v_cvt_f32_i32 v41, v41
    v_cvt_f32_i32 v42, v42
    v_cvt_f32_i32 v43, v43
    v_cvt_f32_i32 v44, v44
    v_cvt_f32_i32 v45, v45
    v_cvt_f32_i32 v46, v46
    v_cvt_f32_i32 v47, v47
    s_waitcnt lgkmcnt(0)
    v_cvt_f32_i32 v48, v48
    v_cvt_f32_i32 v49, v49
    v_cvt_f32_i32 v50, v50
    v_cvt_f32_i32 v51, v51
    v_cvt_f32_i32 v52, v52
    v_cvt_f32_i32 v53, v53
    v_cvt_f32_i32 v54, v54
    v_cvt_f32_i32 v55, v55
    v_cvt_f32_i32 v56, v56
    v_cvt_f32_i32 v57, v57
    v_cvt_f32_i32 v58, v58
    v_cvt_f32_i32 v59, v59
    v_cvt_pk_bf16_f32 v61, v36, v48
    v_cvt_pk_bf16_f32 v65, v37, v49
    v_cvt_pk_bf16_f32 v69, v38, v50
    v_cvt_pk_bf16_f32 v73, v39, v51
    v_cvt_pk_bf16_f32 v77, v40, v52
    v_cvt_pk_bf16_f32 v81, v41, v53
    v_cvt_pk_bf16_f32 v85, v42, v54
    v_cvt_pk_bf16_f32 v89, v43, v55
    v_cvt_pk_bf16_f32 v93, v44, v56
    v_cvt_pk_bf16_f32 v97, v45, v57
    v_cvt_pk_bf16_f32 v101, v46, v58
    v_cvt_pk_bf16_f32 v105, v47, v59
    v_add_u32 v13, s62, v12
    s_add_u32 s62, s62, 24576
    s_cmp_eq_u32 s62, 73728
    s_cselect_b32 s62, 0, s62
    s_barrier
    ds_read_b128 v[36:39], v13 offset:0
    ds_read_b128 v[40:43], v13 offset:1024
    ds_read_b128 v[44:47], v13 offset:2048
    ds_read_b128 v[48:51], v13 offset:3072
    ds_read_b128 v[52:55], v13 offset:4096
    ds_read_b128 v[56:59], v13 offset:5120
    s_waitcnt lgkmcnt(3)
    v_cvt_f32_i32 v36, v36
    v_cvt_f32_i32 v37, v37
    v_cvt_f32_i32 v38, v38
    v_cvt_f32_i32 v39, v39
    v_cvt_f32_i32 v40, v40
    v_cvt_f32_i32 v41, v41
    v_cvt_f32_i32 v42, v42
    v_cvt_f32_i32 v43, v43
    v_cvt_f32_i32 v44, v44
    v_cvt_f32_i32 v45, v45
    v_cvt_f32_i32 v46, v46
    v_cvt_f32_i32 v47, v47
    s_waitcnt lgkmcnt(0)
    v_cvt_f32_i32 v48, v48
    v_cvt_f32_i32 v49, v49
    v_cvt_f32_i32 v50, v50
    v_cvt_f32_i32 v51, v51
    v_cvt_f32_i32 v52, v52
    v_cvt_f32_i32 v53, v53
    v_cvt_f32_i32 v54, v54
    v_cvt_f32_i32 v55, v55
    v_cvt_f32_i32 v56, v56
    v_cvt_f32_i32 v57, v57
    v_cvt_f32_i32 v58, v58
    v_cvt_f32_i32 v59, v59
    v_cvt_pk_bf16_f32 v62, v36, v48
    v_cvt_pk_bf16_f32 v66, v37, v49
    v_cvt_pk_bf16_f32 v70, v38, v50
    v_cvt_pk_bf16_f32 v74, v39, v51
    v_cvt_pk_bf16_f32 v78, v40, v52
    v_cvt_pk_bf16_f32 v82, v41, v53
    v_cvt_pk_bf16_f32 v86, v42, v54
    v_cvt_pk_bf16_f32 v90, v43, v55
    v_cvt_pk_bf16_f32 v94, v44, v56
    v_cvt_pk_bf16_f32 v98, v45, v57
    v_cvt_pk_bf16_f32 v102, v46, v58
    v_cvt_pk_bf16_f32 v106, v47, v59
    v_add_u32 v13, s62, v12
    s_add_u32 s62, s62, 24576
    s_cmp_eq_u32 s62, 73728
    s_cselect_b32 s62, 0, s62
    s_barrier
    ds_read_b128 v[36:39], v13 offset:0
    ds_read_b128 v[40:43], v13 offset:1024
    ds_read_b128 v[44:47], v13 offset:2048
    ds_read_b128 v[48:51], v13 offset:3072
    ds_read_b128 v[52:55], v13 offset:4096
    ds_read_b128 v[56:59], v13 offset:5120
    s_waitcnt lgkmcnt(3)
    v_cvt_f32_i32 v36, v36
    v_cvt_f32_i32 v37, v37
    v_cvt_f32_i32 v38, v38
    v_cvt_f32_i32 v39, v39
    v_cvt_f32_i32 v40, v40
    v_cvt_f32_i32 v41, v41
    v_cvt_f32_i32 v42, v42
    v_cvt_f32_i32 v43, v43
    v_cvt_f32_i32 v44, v44
    v_cvt_f32_i32 v45, v45
    v_cvt_f32_i32 v46, v46
    v_cvt_f32_i32 v47, v47
    s_waitcnt lgkmcnt(0)
    v_cvt_f32_i32 v48, v48
    v_cvt_f32_i32 v49, v49
    v_cvt_f32_i32 v50, v50
    v_cvt_f32_i32 v51, v51
    v_cvt_f32_i32 v52, v52
    v_cvt_f32_i32 v53, v53
    v_cvt_f32_i32 v54, v54
    v_cvt_f32_i32 v55, v55
    v_cvt_f32_i32 v56, v56
    v_cvt_f32_i32 v57, v57
    v_cvt_f32_i32 v58, v58
    v_cvt_f32_i32 v59, v59
    v_cvt_pk_bf16_f32 v63, v36, v48
    v_cvt_pk_bf16_f32 v67, v37, v49
    v_cvt_pk_bf16_f32 v71, v38, v50
    v_cvt_pk_bf16_f32 v75, v39, v51
    v_cvt_pk_bf16_f32 v79, v40, v52
    v_cvt_pk_bf16_f32 v83, v41, v53
    v_cvt_pk_bf16_f32 v87, v42, v54
    v_cvt_pk_bf16_f32 v91, v43, v55
    v_cvt_pk_bf16_f32 v95, v44, v56
    v_cvt_pk_bf16_f32 v99, v45, v57
    v_cvt_pk_bf16_f32 v103, v46, v58
    v_cvt_pk_bf16_f32 v107, v47, v59
    v_mfma_f32_16x16x32_bf16 v[156:159], v[204:207], v[60:63], v[156:159]
    v_mfma_f32_16x16x32_bf16 v[160:163], v[204:207], v[64:67], v[160:163]
    v_mfma_f32_16x16x32_bf16 v[164:167], v[204:207], v[68:71], v[164:167]
    v_mfma_f32_16x16x32_bf16 v[168:171], v[204:207], v[72:75], v[168:171]
    v_mfma_f32_16x16x32_bf16 v[172:175], v[204:207], v[76:79], v[172:175]
    v_mfma_f32_16x16x32_bf16 v[176:179], v[204:207], v[80:83], v[176:179]
    v_mfma_f32_16x16x32_bf16 v[180:183], v[204:207], v[84:87], v[180:183]
    v_mfma_f32_16x16x32_bf16 v[184:187], v[204:207], v[88:91], v[184:187]
    v_mfma_f32_16x16x32_bf16 v[188:191], v[204:207], v[92:95], v[188:191]
    v_mfma_f32_16x16x32_bf16 v[192:195], v[204:207], v[96:99], v[192:195]
    v_mfma_f32_16x16x32_bf16 v[196:199], v[204:207], v[100:103], v[196:199]
    v_mfma_f32_16x16x32_bf16 v[200:203], v[204:207], v[104:107], v[200:203]
    v_add_u32 v13, s62, v12
    s_add_u32 s62, s62, 24576
    s_cmp_eq_u32 s62, 73728
    s_cselect_b32 s62, 0, s62
    s_barrier
    ds_read_b128 v[36:39], v13 offset:0
    ds_read_b128 v[40:43], v13 offset:1024
    ds_read_b128 v[44:47], v13 offset:2048
    ds_read_b128 v[48:51], v13 offset:3072
    ds_read_b128 v[52:55], v13 offset:4096
    ds_read_b128 v[56:59], v13 offset:5120
    s_waitcnt lgkmcnt(6)
    v_lshlrev_b32 v215, 16, v210
    v_and_b32 v216, s66, v210
    v_fma_f32 v215, v215, s64, -v14
    v_fma_f32 v216, v216, s64, -v14
    v_exp_f32 v215, v215
    v_exp_f32 v216, v216
    v_lshlrev_b32 v217, 16, v211
    v_lshlrev_b32 v218, 16, v212
    v_mul_f32 v217, v215, v217
    v_mul_f32 v218, v216, v218
    v_add_f32 v208, v208, v215
    v_cvt_pk_bf16_f32 v217, v217, v218
    v_add_f32 v208, v208, v216
    v_lshlrev_b32 v219, 16, v213
    v_lshlrev_b32 v220, 16, v214
    v_lshlrev_b32 v215, 16, v217
    v_and_b32 v216, s66, v217
    v_fmac_f32 v209, v215, v219
    v_fmac_f32 v209, v216, v220
    v_mov_b32_dpp v204, v217 quad_perm:[0,1,2,3] row_mask:0xf bank_mask:0x1
    v_mov_b32_dpp v205, v217 quad_perm:[0,1,2,3] row_mask:0xf bank_mask:0x2
    v_mov_b32_dpp v206, v217 quad_perm:[0,1,2,3] row_mask:0xf bank_mask:0x4
    v_mov_b32_dpp v207, v217 quad_perm:[0,1,2,3] row_mask:0xf bank_mask:0x8
    s_waitcnt lgkmcnt(3)
    v_cvt_f32_i32 v36, v36
    v_cvt_f32_i32 v37, v37
    v_cvt_f32_i32 v38, v38
    v_cvt_f32_i32 v39, v39
    v_cvt_f32_i32 v40, v40
    v_cvt_f32_i32 v41, v41
    v_cvt_f32_i32 v42, v42
    v_cvt_f32_i32 v43, v43
    v_cvt_f32_i32 v44, v44
    v_cvt_f32_i32 v45, v45
    v_cvt_f32_i32 v46, v46
    v_cvt_f32_i32 v47, v47
    s_waitcnt lgkmcnt(0)
    v_cvt_f32_i32 v48, v48
    v_cvt_f32_i32 v49, v49
    v_cvt_f32_i32 v50, v50
    v_cvt_f32_i32 v51, v51
    v_cvt_f32_i32 v52, v52
    v_cvt_f32_i32 v53, v53
    v_cvt_f32_i32 v54, v54
    v_cvt_f32_i32 v55, v55
    v_cvt_f32_i32 v56, v56
    v_cvt_f32_i32 v57, v57
    v_cvt_f32_i32 v58, v58
    v_cvt_f32_i32 v59, v59
    v_cvt_pk_bf16_f32 v60, v36, v48
    v_cvt_pk_bf16_f32 v64, v37, v49
    v_cvt_pk_bf16_f32 v68, v38, v50
    v_cvt_pk_bf16_f32 v72, v39, v51
    v_cvt_pk_bf16_f32 v76, v40, v52
    v_cvt_pk_bf16_f32 v80, v41, v53
    v_cvt_pk_bf16_f32 v84, v42, v54
    v_cvt_pk_bf16_f32 v88, v43, v55
    v_cvt_pk_bf16_f32 v92, v44, v56
    v_cvt_pk_bf16_f32 v96, v45, v57
    v_cvt_pk_bf16_f32 v100, v46, v58
    v_cvt_pk_bf16_f32 v104, v47, v59
    v_add_u32 v11, 3072, v11
    s_add_u32 s63, s63, 1024
    v_add_u32 v211, s63, v7
    v_add_u32 v212, s63, v8
    ds_read_b32 v210, v11 offset:0
    ds_read_u16 v213, v211 offset:512
    ds_read_u16 v214, v212 offset:512
    ds_read_u16 v211, v211
    ds_read_u16 v212, v212
    v_add_u32 v13, s62, v12
    s_add_u32 s62, s62, 24576
    s_cmp_eq_u32 s62, 73728
    s_cselect_b32 s62, 0, s62
    s_barrier
    ds_read_b128 v[36:39], v13 offset:0
    ds_read_b128 v[40:43], v13 offset:1024
    ds_read_b128 v[44:47], v13 offset:2048
    ds_read_b128 v[48:51], v13 offset:3072
    ds_read_b128 v[52:55], v13 offset:4096
    ds_read_b128 v[56:59], v13 offset:5120
    s_waitcnt lgkmcnt(3)
    v_cvt_f32_i32 v36, v36
    v_cvt_f32_i32 v37, v37
    v_cvt_f32_i32 v38, v38
    v_cvt_f32_i32 v39, v39
    v_cvt_f32_i32 v40, v40
    v_cvt_f32_i32 v41, v41
    v_cvt_f32_i32 v42, v42
    v_cvt_f32_i32 v43, v43
    v_cvt_f32_i32 v44, v44
    v_cvt_f32_i32 v45, v45
    v_cvt_f32_i32 v46, v46
    v_cvt_f32_i32 v47, v47
    s_waitcnt lgkmcnt(0)
    v_cvt_f32_i32 v48, v48
    v_cvt_f32_i32 v49, v49
    v_cvt_f32_i32 v50, v50
    v_cvt_f32_i32 v51, v51
    v_cvt_f32_i32 v52, v52
    v_cvt_f32_i32 v53, v53
    v_cvt_f32_i32 v54, v54
    v_cvt_f32_i32 v55, v55
    v_cvt_f32_i32 v56, v56
    v_cvt_f32_i32 v57, v57
    v_cvt_f32_i32 v58, v58
    v_cvt_f32_i32 v59, v59
    v_cvt_pk_bf16_f32 v61, v36, v48
    v_cvt_pk_bf16_f32 v65, v37, v49
    v_cvt_pk_bf16_f32 v69, v38, v50
    v_cvt_pk_bf16_f32 v73, v39, v51
    v_cvt_pk_bf16_f32 v77, v40, v52
    v_cvt_pk_bf16_f32 v81, v41, v53
    v_cvt_pk_bf16_f32 v85, v42, v54
    v_cvt_pk_bf16_f32 v89, v43, v55
    v_cvt_pk_bf16_f32 v93, v44, v56
    v_cvt_pk_bf16_f32 v97, v45, v57
    v_cvt_pk_bf16_f32 v101, v46, v58
    v_cvt_pk_bf16_f32 v105, v47, v59
    v_add_u32 v13, s62, v12
    s_add_u32 s62, s62, 24576
    s_cmp_eq_u32 s62, 73728
    s_cselect_b32 s62, 0, s62
    s_barrier
    ds_read_b128 v[36:39], v13 offset:0
    ds_read_b128 v[40:43], v13 offset:1024
    ds_read_b128 v[44:47], v13 offset:2048
    ds_read_b128 v[48:51], v13 offset:3072
    ds_read_b128 v[52:55], v13 offset:4096
    ds_read_b128 v[56:59], v13 offset:5120
    s_waitcnt lgkmcnt(3)
    v_cvt_f32_i32 v36, v36
    v_cvt_f32_i32 v37, v37
    v_cvt_f32_i32 v38, v38
    v_cvt_f32_i32 v39, v39
    v_cvt_f32_i32 v40, v40
    v_cvt_f32_i32 v41, v41
    v_cvt_f32_i32 v42, v42
    v_cvt_f32_i32 v43, v43
    v_cvt_f32_i32 v44, v44
    v_cvt_f32_i32 v45, v45
    v_cvt_f32_i32 v46, v46
    v_cvt_f32_i32 v47, v47
    s_waitcnt lgkmcnt(0)
    v_cvt_f32_i32 v48, v48
    v_cvt_f32_i32 v49, v49
    v_cvt_f32_i32 v50, v50
    v_cvt_f32_i32 v51, v51
    v_cvt_f32_i32 v52, v52
    v_cvt_f32_i32 v53, v53
    v_cvt_f32_i32 v54, v54
    v_cvt_f32_i32 v55, v55
    v_cvt_f32_i32 v56, v56
    v_cvt_f32_i32 v57, v57
    v_cvt_f32_i32 v58, v58
    v_cvt_f32_i32 v59, v59
    v_cvt_pk_bf16_f32 v62, v36, v48
    v_cvt_pk_bf16_f32 v66, v37, v49
    v_cvt_pk_bf16_f32 v70, v38, v50
    v_cvt_pk_bf16_f32 v74, v39, v51
    v_cvt_pk_bf16_f32 v78, v40, v52
    v_cvt_pk_bf16_f32 v82, v41, v53
    v_cvt_pk_bf16_f32 v86, v42, v54
    v_cvt_pk_bf16_f32 v90, v43, v55
    v_cvt_pk_bf16_f32 v94, v44, v56
    v_cvt_pk_bf16_f32 v98, v45, v57
    v_cvt_pk_bf16_f32 v102, v46, v58
    v_cvt_pk_bf16_f32 v106, v47, v59
    v_add_u32 v13, s62, v12
    s_add_u32 s62, s62, 24576
    s_cmp_eq_u32 s62, 73728
    s_cselect_b32 s62, 0, s62
    s_barrier
    ds_read_b128 v[36:39], v13 offset:0
    ds_read_b128 v[40:43], v13 offset:1024
    ds_read_b128 v[44:47], v13 offset:2048
    ds_read_b128 v[48:51], v13 offset:3072
    ds_read_b128 v[52:55], v13 offset:4096
    ds_read_b128 v[56:59], v13 offset:5120
    s_waitcnt lgkmcnt(3)
    v_cvt_f32_i32 v36, v36
    v_cvt_f32_i32 v37, v37
    v_cvt_f32_i32 v38, v38
    v_cvt_f32_i32 v39, v39
    v_cvt_f32_i32 v40, v40
    v_cvt_f32_i32 v41, v41
    v_cvt_f32_i32 v42, v42
    v_cvt_f32_i32 v43, v43
    v_cvt_f32_i32 v44, v44
    v_cvt_f32_i32 v45, v45
    v_cvt_f32_i32 v46, v46
    v_cvt_f32_i32 v47, v47
    s_waitcnt lgkmcnt(0)
    v_cvt_f32_i32 v48, v48
    v_cvt_f32_i32 v49, v49
    v_cvt_f32_i32 v50, v50
    v_cvt_f32_i32 v51, v51
    v_cvt_f32_i32 v52, v52
    v_cvt_f32_i32 v53, v53
    v_cvt_f32_i32 v54, v54
    v_cvt_f32_i32 v55, v55
    v_cvt_f32_i32 v56, v56
    v_cvt_f32_i32 v57, v57
    v_cvt_f32_i32 v58, v58
    v_cvt_f32_i32 v59, v59
    v_cvt_pk_bf16_f32 v63, v36, v48
    v_cvt_pk_bf16_f32 v67, v37, v49
    v_cvt_pk_bf16_f32 v71, v38, v50
    v_cvt_pk_bf16_f32 v75, v39, v51
    v_cvt_pk_bf16_f32 v79, v40, v52
    v_cvt_pk_bf16_f32 v83, v41, v53
    v_cvt_pk_bf16_f32 v87, v42, v54
    v_cvt_pk_bf16_f32 v91, v43, v55
    v_cvt_pk_bf16_f32 v95, v44, v56
    v_cvt_pk_bf16_f32 v99, v45, v57
    v_cvt_pk_bf16_f32 v103, v46, v58
    v_cvt_pk_bf16_f32 v107, v47, v59
    v_mfma_f32_16x16x32_bf16 v[156:159], v[204:207], v[60:63], v[156:159]
    v_mfma_f32_16x16x32_bf16 v[160:163], v[204:207], v[64:67], v[160:163]
    v_mfma_f32_16x16x32_bf16 v[164:167], v[204:207], v[68:71], v[164:167]
    v_mfma_f32_16x16x32_bf16 v[168:171], v[204:207], v[72:75], v[168:171]
    v_mfma_f32_16x16x32_bf16 v[172:175], v[204:207], v[76:79], v[172:175]
    v_mfma_f32_16x16x32_bf16 v[176:179], v[204:207], v[80:83], v[176:179]
    v_mfma_f32_16x16x32_bf16 v[180:183], v[204:207], v[84:87], v[180:183]
    v_mfma_f32_16x16x32_bf16 v[184:187], v[204:207], v[88:91], v[184:187]
    v_mfma_f32_16x16x32_bf16 v[188:191], v[204:207], v[92:95], v[188:191]
    v_mfma_f32_16x16x32_bf16 v[192:195], v[204:207], v[96:99], v[192:195]
    v_mfma_f32_16x16x32_bf16 v[196:199], v[204:207], v[100:103], v[196:199]
    v_mfma_f32_16x16x32_bf16 v[200:203], v[204:207], v[104:107], v[200:203]
    s_add_u32 s61, s61, 1
    s_cmp_eq_u32 s61, s3
    s_cbranch_scc1 L_vblk_end
    s_cmp_eq_u32 s61, s73
    s_cbranch_scc1 L_vblk_end
    s_cmp_lt_u32 s61, 16
    s_cbranch_scc1 L_vblk
L_vblk_end:
    s_nop 1
    v_add_f32_dpp v208, v208, v208 row_ror:4 row_mask:0xf bank_mask:0xf
    s_nop 1
    v_add_f32_dpp v208, v208, v208 row_ror:8 row_mask:0xf bank_mask:0xf
    v_mov_b32 v3, v208
    s_nop 1
    v_permlane16_swap_b32 v208, v3
    v_add_f32 v208, v208, v3
    v_mov_b32 v3, v208
    s_nop 1
    v_permlane32_swap_b32 v208, v3
    v_add_f32 v208, v208, v3
    s_nop 1
    v_add_f32_dpp v209, v209, v209 row_ror:4 row_mask:0xf bank_mask:0xf
    s_nop 1
    v_add_f32_dpp v209, v209, v209 row_ror:8 row_mask:0xf bank_mask:0xf
    v_mov_b32 v3, v209
    s_nop 1
    v_permlane16_swap_b32 v209, v3
    v_add_f32 v209, v209, v3
    v_mov_b32 v3, v209
    s_nop 1
    v_permlane32_swap_b32 v209, v3
    v_add_f32 v209, v209, v3
    v_mov_b32 v36, v14
    v_mov_b32 v37, v208
    v_mov_b32 v38, v209
    v_mov_b32 v39, 0
    v_and_b32 v4, 3, v1
    v_lshl_add_u32 v4, v2, 2, v4
    v_lshlrev_b32 v4, 4, v4
    v_add_u32 v4, 142336, v4
    ds_write_b128 v4, v[36:39]
    v_permlane32_swap_b32 v156, v158
    v_permlane32_swap_b32 v157, v159
    v_permlane32_swap_b32 v160, v162
    v_permlane32_swap_b32 v161, v163
    v_permlane32_swap_b32 v164, v166
    v_permlane32_swap_b32 v165, v167
    v_permlane32_swap_b32 v168, v170
    v_permlane32_swap_b32 v169, v171
    v_permlane32_swap_b32 v172, v174
    v_permlane32_swap_b32 v173, v175
    v_permlane32_swap_b32 v176, v178
    v_permlane32_swap_b32 v177, v179
    v_permlane32_swap_b32 v180, v182
    v_permlane32_swap_b32 v181, v183
    v_permlane32_swap_b32 v184, v186
    v_permlane32_swap_b32 v185, v187
    v_permlane32_swap_b32 v188, v190
    v_permlane32_swap_b32 v189, v191
    v_permlane32_swap_b32 v192, v194
    v_permlane32_swap_b32 v193, v195
    v_permlane32_swap_b32 v196, v198
    v_permlane32_swap_b32 v197, v199
    v_permlane32_swap_b32 v200, v202
    v_permlane32_swap_b32 v201, v203
    v_add_f32 v156, v156, v158
    v_add_f32 v157, v157, v159
    v_add_f32 v160, v160, v162
    v_add_f32 v161, v161, v163
    v_add_f32 v164, v164, v166
    v_add_f32 v165, v165, v167
    v_add_f32 v168, v168, v170
    v_add_f32 v169, v169, v171
    v_add_f32 v172, v172, v174
    v_add_f32 v173, v173, v175
    v_add_f32 v176, v176, v178
    v_add_f32 v177, v177, v179
    v_add_f32 v180, v180, v182
    v_add_f32 v181, v181, v183
    v_add_f32 v184, v184, v186
    v_add_f32 v185, v185, v187
    v_add_f32 v188, v188, v190
    v_add_f32 v189, v189, v191
    v_add_f32 v192, v192, v194
    v_add_f32 v193, v193, v195
    v_add_f32 v196, v196, v198
    v_add_f32 v197, v197, v199
    v_add_f32 v200, v200, v202
    v_add_f32 v201, v201, v203
    s_nop 1
    v_permlane16_swap_b32 v156, v157
    v_permlane16_swap_b32 v160, v161
    v_permlane16_swap_b32 v164, v165
    v_permlane16_swap_b32 v168, v169
    v_permlane16_swap_b32 v172, v173
    v_permlane16_swap_b32 v176, v177
    v_permlane16_swap_b32 v180, v181
    v_permlane16_swap_b32 v184, v185
    v_permlane16_swap_b32 v188, v189
    v_permlane16_swap_b32 v192, v193
    v_permlane16_swap_b32 v196, v197
    v_permlane16_swap_b32 v200, v201
    v_add_f32 v40, v156, v157
    v_add_f32 v41, v160, v161
    v_add_f32 v42, v164, v165
    v_add_f32 v43, v168, v169
    v_add_f32 v44, v172, v173
    v_add_f32 v45, v176, v177
    v_add_f32 v46, v180, v181
    v_add_f32 v47, v184, v185
    v_add_f32 v48, v188, v189
    v_add_f32 v49, v192, v193
    v_add_f32 v50, v196, v197
    v_add_f32 v51, v200, v201
    v_lshrrev_b32 v3, 4, v1
    v_mul_u32_u24 v3, 768, v3
    v_and_b32 v4, 15, v1
    v_lshl_add_u32 v3, v4, 4, v3
    v_mul_u32_u24 v4, 3072, v2
    s_mov_b32 s58, 142592
    v_add3_u32 v4, v4, v3, s58
    ds_write_b128 v4, v[40:43] offset:0
    ds_write_b128 v4, v[44:47] offset:256
    ds_write_b128 v4, v[48:51] offset:512
    s_waitcnt lgkmcnt(0)
    s_cmp_lt_u32 s61, 16
    s_cbranch_scc1 L_vround
    s_barrier
    s_branch L_fin
L_finisher:
    v_lshrrev_b32 v8, 4, v1
    v_mul_u32_u24 v8, 768, v8
    v_and_b32 v13, 15, v1
    v_lshl_add_u32 v8, v13, 4, v8
    v_lshlrev_b32 v9, 4, v1
    v_and_b32 v14, 48, v1
    s_memrealtime s[96:97]
    s_waitcnt lgkmcnt(0)
    s_mov_b32 s48, s18
    s_and_b32 s49, s19, 0xffff
    s_mov_b32 s50, 393216
    s_mov_b32 s51, 0x20000
    s_mov_b32 s52, s20
    s_and_b32 s53, s21, 0xffff
    s_mov_b32 s54, 256
    s_mov_b32 s55, 0x20000
    s_mov_b32 s24, s22
    s_and_b32 s25, s23, 0xffff
    s_mov_b32 s26, 2611200
    s_mov_b32 s27, 0x20000
    s_cmp_eq_u32 s2, 0
    s_cbranch_scc0 L_fk
    s_or_b32 s71, s96, 1
    v_mov_b32 v16, s71
    v_mov_b32 v17, 0
    s_mov_b64 exec, 1
    buffer_atomic_cmpswap v[16:17], v9, s[52:55], 0 offen sc0 sc1
    s_mov_b64 exec, -1
    s_waitcnt vmcnt(0)
    v_readfirstlane_b32 s58, v16
    s_nop 3
    s_cmp_eq_u32 s58, 0
    s_cselect_b32 s71, s71, s58
L_fk:
    s_movk_i32 s69, 128
L_fb1:
    s_barrier
    s_sub_u32 s69, s69, 1
    s_cmp_lg_u32 s69, 0
    s_cbranch_scc1 L_fb1
    s_load_dword s71, s[20:21], 0
    s_barrier
    s_waitcnt lgkmcnt(0)
    s_cmp_eq_u32 s71, 0
    s_cbranch_scc0 L_ftag
    s_or_b32 s71, s96, 1
    v_mov_b32 v16, s71
    v_mov_b32 v17, 0
    s_mov_b64 exec, 1
    buffer_atomic_cmpswap v[16:17], v9, s[52:55], 0 offen sc0 sc1
    s_mov_b64 exec, -1
    s_waitcnt vmcnt(0)
    v_readfirstlane_b32 s58, v16
    s_nop 3
    s_cmp_eq_u32 s58, 0
    s_cselect_b32 s71, s71, s58
L_ftag:
    v_mov_b32 v10, s71
    s_mul_i32 s68, s100, 13056
    s_lshr_b32 s63, s101, 1
    s_lshl_b32 s58, s100, 1
    s_add_u32 s63, s63, s58
    s_mul_i32 s62, s63, 8704
    s_add_u32 s62, s62, 1114112
    s_cmp_eq_u32 s2, 255
    s_cbranch_scc1 L_fsolo
    s_cmp_eq_u32 s101, 1
    s_cbranch_scc1 L_fmid
    s_movk_i32 s69, 89
L_fb2:
    s_barrier
    s_sub_u32 s69, s69, 1
    s_cmp_lg_u32 s69, 0
    s_cbranch_scc1 L_fb2
    v_add_u32 v13, 142336, v14
    v_add_u32 v11, 142592, v8
    ds_read_b128 v[16:19], v13 offset:0
    ds_read_b128 v[20:23], v13 offset:64
    ds_read_b128 v[24:27], v13 offset:128
    ds_read_b128 v[28:31], v13 offset:192
    ds_read_b128 v[32:35], v11 offset:0
    ds_read_b128 v[36:39], v11 offset:256
    ds_read_b128 v[40:43], v11 offset:512
    ds_read_b128 v[44:47], v11 offset:3072
    ds_read_b128 v[48:51], v11 offset:3328
    ds_read_b128 v[52:55], v11 offset:3584
    ds_read_b128 v[56:59], v11 offset:6144
    ds_read_b128 v[60:63], v11 offset:6400
    ds_read_b128 v[64:67], v11 offset:6656
    s_waitcnt lgkmcnt(9)
    ds_read_b128 v[68:71], v11 offset:9216
    ds_read_b128 v[72:75], v11 offset:9472
    ds_read_b128 v[76:79], v11 offset:9728
    v_max_f32 v156, v16, v20
    v_max3_f32 v156, v156, v24, v28
    v_sub_f32 v16, v16, v156
    v_sub_f32 v20, v20, v156
    v_sub_f32 v24, v24, v156
    v_sub_f32 v28, v28, v156
    v_exp_f32 v16, v16
    v_exp_f32 v20, v20
    v_exp_f32 v24, v24
    v_exp_f32 v28, v28
    v_mov_b32 v143, v10
    v_mov_b32 v147, v10
    v_mov_b32 v151, v10
    v_mov_b32 v155, v10
    v_mov_b32 v159, v10
    v_mul_f32 v157, v16, v17
    v_mul_f32 v158, v16, v18
    v_fmac_f32 v157, v20, v21
    v_fmac_f32 v158, v20, v22
    v_fmac_f32 v157, v24, v25
    v_fmac_f32 v158, v24, v26
    v_fmac_f32 v157, v28, v29
    v_fmac_f32 v158, v28, v30
    s_waitcnt lgkmcnt(9)
    v_fma_f32 v140, v32, v16, -v158
    v_fma_f32 v141, v33, v16, -v158
    v_fma_f32 v142, v34, v16, -v158
    v_fma_f32 v144, v35, v16, -v158
    v_fma_f32 v145, v36, v16, -v158
    v_fma_f32 v146, v37, v16, -v158
    v_fma_f32 v148, v38, v16, -v158
    v_fma_f32 v149, v39, v16, -v158
    v_fma_f32 v150, v40, v16, -v158
    v_fma_f32 v152, v41, v16, -v158
    v_fma_f32 v153, v42, v16, -v158
    v_fma_f32 v154, v43, v16, -v158
    s_waitcnt lgkmcnt(6)
    v_fmac_f32 v140, v44, v20
    v_fmac_f32 v141, v45, v20
    v_fmac_f32 v142, v46, v20
    v_fmac_f32 v144, v47, v20
    v_fmac_f32 v145, v48, v20
    v_fmac_f32 v146, v49, v20
    v_fmac_f32 v148, v50, v20
    v_fmac_f32 v149, v51, v20
    v_fmac_f32 v150, v52, v20
    v_fmac_f32 v152, v53, v20
    v_fmac_f32 v153, v54, v20
    v_fmac_f32 v154, v55, v20
    s_waitcnt lgkmcnt(3)
    v_fmac_f32 v140, v56, v24
    v_fmac_f32 v141, v57, v24
    v_fmac_f32 v142, v58, v24
    v_fmac_f32 v144, v59, v24
    v_fmac_f32 v145, v60, v24
    v_fmac_f32 v146, v61, v24
    v_fmac_f32 v148, v62, v24
    v_fmac_f32 v149, v63, v24
    v_fmac_f32 v150, v64, v24
    v_fmac_f32 v152, v65, v24
    v_fmac_f32 v153, v66, v24
    v_fmac_f32 v154, v67, v24
    s_waitcnt lgkmcnt(0)
    v_fmac_f32 v140, v68, v28
    v_fmac_f32 v141, v69, v28
    v_fmac_f32 v142, v70, v28
    v_fmac_f32 v144, v71, v28
    v_fmac_f32 v145, v72, v28
    v_fmac_f32 v146, v73, v28
    v_fmac_f32 v148, v74, v28
    v_fmac_f32 v149, v75, v28
    v_fmac_f32 v150, v76, v28
    v_fmac_f32 v152, v77, v28
    v_fmac_f32 v153, v78, v28
    v_fmac_f32 v154, v79, v28
    s_movk_i32 s69, 39
L_fb3:
    s_barrier
    s_sub_u32 s69, s69, 1
    s_cmp_lg_u32 s69, 0
    s_cbranch_scc1 L_fb3
    s_add_u32 s58, s62, 4352
    s_add_u32 s59, s62, 8448
    buffer_load_dwordx4 v[176:179], v14, s[24:27], s59 offen sc1
    buffer_load_dwordx4 v[160:163], v9, s[24:27], s58 offen offset:0 sc1
    buffer_load_dwordx4 v[164:167], v9, s[24:27], s58 offen offset:1024 sc1
    buffer_load_dwordx4 v[168:171], v9, s[24:27], s58 offen offset:2048 sc1
    buffer_load_dwordx4 v[172:175], v9, s[24:27], s58 offen offset:3072 sc1
    s_barrier
    s_cmp_eq_u32 s101, 2
    s_cbranch_scc1 L_fo2
    v_add_u32 v13, 142336, v14
    v_add_u32 v11, 142592, v8
    ds_read_b128 v[16:19], v13 offset:0
    ds_read_b128 v[20:23], v13 offset:64
    ds_read_b128 v[24:27], v13 offset:128
    ds_read_b128 v[28:31], v13 offset:192
    ds_read_b128 v[32:35], v11 offset:0
    ds_read_b128 v[36:39], v11 offset:256
    ds_read_b128 v[40:43], v11 offset:512
    ds_read_b128 v[44:47], v11 offset:3072
    ds_read_b128 v[48:51], v11 offset:3328
    ds_read_b128 v[52:55], v11 offset:3584
    ds_read_b128 v[56:59], v11 offset:6144
    ds_read_b128 v[60:63], v11 offset:6400
    ds_read_b128 v[64:67], v11 offset:6656
    s_waitcnt lgkmcnt(9)
    ds_read_b128 v[68:71], v11 offset:9216
    ds_read_b128 v[72:75], v11 offset:9472
    ds_read_b128 v[76:79], v11 offset:9728
    v_max_f32 v96, v16, v20
    v_max3_f32 v96, v96, v24, v28
    v_sub_f32 v16, v16, v96
    v_sub_f32 v20, v20, v96
    v_sub_f32 v24, v24, v96
    v_sub_f32 v28, v28, v96
    v_exp_f32 v16, v16
    v_exp_f32 v20, v20
    v_exp_f32 v24, v24
    v_exp_f32 v28, v28
    v_mov_b32 v83, v10
    v_mov_b32 v87, v10
    v_mov_b32 v91, v10
    v_mov_b32 v95, v10
    v_mov_b32 v99, v10
    v_mul_f32 v97, v16, v17
    v_mul_f32 v98, v16, v18
    v_fmac_f32 v97, v20, v21
    v_fmac_f32 v98, v20, v22
    v_fmac_f32 v97, v24, v25
    v_fmac_f32 v98, v24, v26
    v_fmac_f32 v97, v28, v29
    v_fmac_f32 v98, v28, v30
    s_waitcnt lgkmcnt(9)
    v_fma_f32 v80, v32, v16, -v98
    v_fma_f32 v81, v33, v16, -v98
    v_fma_f32 v82, v34, v16, -v98
    v_fma_f32 v84, v35, v16, -v98
    v_fma_f32 v85, v36, v16, -v98
    v_fma_f32 v86, v37, v16, -v98
    v_fma_f32 v88, v38, v16, -v98
    v_fma_f32 v89, v39, v16, -v98
    v_fma_f32 v90, v40, v16, -v98
    v_fma_f32 v92, v41, v16, -v98
    v_fma_f32 v93, v42, v16, -v98
    v_fma_f32 v94, v43, v16, -v98
    s_waitcnt lgkmcnt(6)
    v_fmac_f32 v80, v44, v20
    v_fmac_f32 v81, v45, v20
    v_fmac_f32 v82, v46, v20
    v_fmac_f32 v84, v47, v20
    v_fmac_f32 v85, v48, v20
    v_fmac_f32 v86, v49, v20
    v_fmac_f32 v88, v50, v20
    v_fmac_f32 v89, v51, v20
    v_fmac_f32 v90, v52, v20
    v_fmac_f32 v92, v53, v20
    v_fmac_f32 v93, v54, v20
    v_fmac_f32 v94, v55, v20
    s_waitcnt lgkmcnt(3)
    v_fmac_f32 v80, v56, v24
    v_fmac_f32 v81, v57, v24
    v_fmac_f32 v82, v58, v24
    v_fmac_f32 v84, v59, v24
    v_fmac_f32 v85, v60, v24
    v_fmac_f32 v86, v61, v24
    v_fmac_f32 v88, v62, v24
    v_fmac_f32 v89, v63, v24
    v_fmac_f32 v90, v64, v24
    v_fmac_f32 v92, v65, v24
    v_fmac_f32 v93, v66, v24
    v_fmac_f32 v94, v67, v24
    s_waitcnt lgkmcnt(0)
    v_fmac_f32 v80, v68, v28
    v_fmac_f32 v81, v69, v28
    v_fmac_f32 v82, v70, v28
    v_fmac_f32 v84, v71, v28
    v_fmac_f32 v85, v72, v28
    v_fmac_f32 v86, v73, v28
    v_fmac_f32 v88, v74, v28
    v_fmac_f32 v89, v75, v28
    v_fmac_f32 v90, v76, v28
    v_fmac_f32 v92, v77, v28
    v_fmac_f32 v93, v78, v28
    v_fmac_f32 v94, v79, v28
    s_add_u32 s58, s68, 0
    s_add_u32 s59, s68, 4096
    buffer_store_dwordx4 v[80:83], v9, s[24:27], s58 offen offset:0 sc1
    buffer_store_dwordx4 v[84:87], v9, s[24:27], s58 offen offset:1024 sc1
    buffer_store_dwordx4 v[88:91], v9, s[24:27], s58 offen offset:2048 sc1
    buffer_store_dwordx4 v[92:95], v9, s[24:27], s58 offen offset:3072 sc1
    s_mov_b32 exec_lo, 0x00010001
    s_mov_b32 exec_hi, 0x00010001
    buffer_store_dwordx4 v[96:99], v14, s[24:27], s59 offen sc1
    s_mov_b64 exec, -1
    s_mov_b32 s70, 0
    s_waitcnt vmcnt(5)
    v_xor_b32 v13, v10, v163
    v_xor_b32 v11, v10, v167
    v_or_b32 v13, v13, v11
    v_xor_b32 v11, v10, v171
    v_or_b32 v13, v13, v11
    v_xor_b32 v11, v10, v175
    v_or_b32 v13, v13, v11
    v_xor_b32 v11, v10, v179
    v_or_b32 v13, v13, v11
    v_cmp_ne_u32 vcc, 0, v13
    s_nop 4
    s_cmp_eq_u64 vcc, 0
    s_cbranch_scc0 L_fo30
    v_max_f32 v11, v156, v176
    v_sub_f32 v16, v156, v11
    v_sub_f32 v17, v176, v11
    v_exp_f32 v16, v16
    v_exp_f32 v17, v17
    v_lshrrev_b32 v13, 1, v8
    v_mul_f32 v12, v16, v157
    v_fmac_f32 v12, v17, v177
    v_rcp_f32 v12, v12
    s_add_u32 s58, s63, 0
    s_mul_i32 s58, s58, 1536
    v_mul_f32 v16, v16, v12
    v_mul_f32 v17, v17, v12
    v_mul_f32 v32, v140, v16
    v_fmac_f32 v32, v160, v17
    v_mul_f32 v33, v141, v16
    v_fmac_f32 v33, v161, v17
    v_mul_f32 v34, v142, v16
    v_fmac_f32 v34, v162, v17
    v_mul_f32 v35, v144, v16
    v_fmac_f32 v35, v164, v17
    v_mul_f32 v36, v145, v16
    v_fmac_f32 v36, v165, v17
    v_mul_f32 v37, v146, v16
    v_fmac_f32 v37, v166, v17
    v_mul_f32 v38, v148, v16
    v_fmac_f32 v38, v168, v17
    v_mul_f32 v39, v149, v16
    v_fmac_f32 v39, v169, v17
    v_mul_f32 v40, v150, v16
    v_fmac_f32 v40, v170, v17
    v_mul_f32 v41, v152, v16
    v_fmac_f32 v41, v172, v17
    v_mul_f32 v42, v153, v16
    v_fmac_f32 v42, v173, v17
    v_mul_f32 v43, v154, v16
    v_fmac_f32 v43, v174, v17
    v_cvt_pk_bf16_f32 v44, v32, v33
    v_cvt_pk_bf16_f32 v45, v34, v35
    v_cvt_pk_bf16_f32 v46, v36, v37
    v_cvt_pk_bf16_f32 v47, v38, v39
    v_cvt_pk_bf16_f32 v48, v40, v41
    v_cvt_pk_bf16_f32 v49, v42, v43
    buffer_store_dwordx2 v[44:45], v13, s[48:51], s58 offen offset:0
    buffer_store_dwordx2 v[46:47], v13, s[48:51], s58 offen offset:128
    buffer_store_dwordx2 v[48:49], v13, s[48:51], s58 offen offset:256
    s_mov_b32 s70, 1
    s_waitcnt vmcnt(0)
    s_branch L_fo40
L_fo30:
    s_waitcnt vmcnt(0)
    s_add_u32 s58, s62, 4352
    s_add_u32 s59, s62, 8448
    buffer_load_dwordx4 v[176:179], v14, s[24:27], s59 offen sc1
    buffer_load_dwordx4 v[160:163], v9, s[24:27], s58 offen offset:0 sc1
    buffer_load_dwordx4 v[164:167], v9, s[24:27], s58 offen offset:1024 sc1
    buffer_load_dwordx4 v[168:171], v9, s[24:27], s58 offen offset:2048 sc1
    buffer_load_dwordx4 v[172:175], v9, s[24:27], s58 offen offset:3072 sc1
L_fo40:
    s_add_u32 s58, s68, 8704
    s_add_u32 s59, s68, 12800
    buffer_load_dwordx4 v[136:139], v14, s[24:27], s59 offen sc1
    buffer_load_dwordx4 v[120:123], v9, s[24:27], s58 offen offset:0 sc1
    buffer_load_dwordx4 v[124:127], v9, s[24:27], s58 offen offset:1024 sc1
    buffer_load_dwordx4 v[128:131], v9, s[24:27], s58 offen offset:2048 sc1
    buffer_load_dwordx4 v[132:135], v9, s[24:27], s58 offen offset:3072 sc1
    s_branch L_fo5
L_fo2:
    v_add_u32 v13, 142336, v14
    v_add_u32 v11, 142592, v8
    ds_read_b128 v[16:19], v13 offset:0
    ds_read_b128 v[20:23], v13 offset:64
    ds_read_b128 v[24:27], v13 offset:128
    ds_read_b128 v[28:31], v13 offset:192
    ds_read_b128 v[32:35], v11 offset:0
    ds_read_b128 v[36:39], v11 offset:256
    ds_read_b128 v[40:43], v11 offset:512
    ds_read_b128 v[44:47], v11 offset:3072
    ds_read_b128 v[48:51], v11 offset:3328
    ds_read_b128 v[52:55], v11 offset:3584
    ds_read_b128 v[56:59], v11 offset:6144
    ds_read_b128 v[60:63], v11 offset:6400
    ds_read_b128 v[64:67], v11 offset:6656
    s_waitcnt lgkmcnt(9)
    ds_read_b128 v[68:71], v11 offset:9216
    ds_read_b128 v[72:75], v11 offset:9472
    ds_read_b128 v[76:79], v11 offset:9728
    v_max_f32 v136, v16, v20
    v_max3_f32 v136, v136, v24, v28
    v_sub_f32 v16, v16, v136
    v_sub_f32 v20, v20, v136
    v_sub_f32 v24, v24, v136
    v_sub_f32 v28, v28, v136
    v_exp_f32 v16, v16
    v_exp_f32 v20, v20
    v_exp_f32 v24, v24
    v_exp_f32 v28, v28
    v_mov_b32 v123, v10
    v_mov_b32 v127, v10
    v_mov_b32 v131, v10
    v_mov_b32 v135, v10
    v_mov_b32 v139, v10
    v_mul_f32 v137, v16, v17
    v_mul_f32 v138, v16, v18
    v_fmac_f32 v137, v20, v21
    v_fmac_f32 v138, v20, v22
    v_fmac_f32 v137, v24, v25
    v_fmac_f32 v138, v24, v26
    v_fmac_f32 v137, v28, v29
    v_fmac_f32 v138, v28, v30
    s_waitcnt lgkmcnt(9)
    v_fma_f32 v120, v32, v16, -v138
    v_fma_f32 v121, v33, v16, -v138
    v_fma_f32 v122, v34, v16, -v138
    v_fma_f32 v124, v35, v16, -v138
    v_fma_f32 v125, v36, v16, -v138
    v_fma_f32 v126, v37, v16, -v138
    v_fma_f32 v128, v38, v16, -v138
    v_fma_f32 v129, v39, v16, -v138
    v_fma_f32 v130, v40, v16, -v138
    v_fma_f32 v132, v41, v16, -v138
    v_fma_f32 v133, v42, v16, -v138
    v_fma_f32 v134, v43, v16, -v138
    s_waitcnt lgkmcnt(6)
    v_fmac_f32 v120, v44, v20
    v_fmac_f32 v121, v45, v20
    v_fmac_f32 v122, v46, v20
    v_fmac_f32 v124, v47, v20
    v_fmac_f32 v125, v48, v20
    v_fmac_f32 v126, v49, v20
    v_fmac_f32 v128, v50, v20
    v_fmac_f32 v129, v51, v20
    v_fmac_f32 v130, v52, v20
    v_fmac_f32 v132, v53, v20
    v_fmac_f32 v133, v54, v20
    v_fmac_f32 v134, v55, v20
    s_waitcnt lgkmcnt(3)
    v_fmac_f32 v120, v56, v24
    v_fmac_f32 v121, v57, v24
    v_fmac_f32 v122, v58, v24
    v_fmac_f32 v124, v59, v24
    v_fmac_f32 v125, v60, v24
    v_fmac_f32 v126, v61, v24
    v_fmac_f32 v128, v62, v24
    v_fmac_f32 v129, v63, v24
    v_fmac_f32 v130, v64, v24
    v_fmac_f32 v132, v65, v24
    v_fmac_f32 v133, v66, v24
    v_fmac_f32 v134, v67, v24
    s_waitcnt lgkmcnt(0)
    v_fmac_f32 v120, v68, v28
    v_fmac_f32 v121, v69, v28
    v_fmac_f32 v122, v70, v28
    v_fmac_f32 v124, v71, v28
    v_fmac_f32 v125, v72, v28
    v_fmac_f32 v126, v73, v28
    v_fmac_f32 v128, v74, v28
    v_fmac_f32 v129, v75, v28
    v_fmac_f32 v130, v76, v28
    v_fmac_f32 v132, v77, v28
    v_fmac_f32 v133, v78, v28
    v_fmac_f32 v134, v79, v28
    s_add_u32 s58, s68, 8704
    s_add_u32 s59, s68, 12800
    buffer_store_dwordx4 v[120:123], v9, s[24:27], s58 offen offset:0 sc1
    buffer_store_dwordx4 v[124:127], v9, s[24:27], s58 offen offset:1024 sc1
    buffer_store_dwordx4 v[128:131], v9, s[24:27], s58 offen offset:2048 sc1
    buffer_store_dwordx4 v[132:135], v9, s[24:27], s58 offen offset:3072 sc1
    s_mov_b32 exec_lo, 0x00010001
    s_mov_b32 exec_hi, 0x00010001
    buffer_store_dwordx4 v[136:139], v14, s[24:27], s59 offen sc1
    s_mov_b64 exec, -1
    s_mov_b32 s70, 0
    s_waitcnt vmcnt(5)
    v_xor_b32 v13, v10, v163
    v_xor_b32 v11, v10, v167
    v_or_b32 v13, v13, v11
    v_xor_b32 v11, v10, v171
    v_or_b32 v13, v13, v11
    v_xor_b32 v11, v10, v175
    v_or_b32 v13, v13, v11
    v_xor_b32 v11, v10, v179
    v_or_b32 v13, v13, v11
    v_cmp_ne_u32 vcc, 0, v13
    s_nop 4
    s_cmp_eq_u64 vcc, 0
    s_cbranch_scc0 L_fo32
    v_max_f32 v11, v156, v176
    v_sub_f32 v16, v156, v11
    v_sub_f32 v17, v176, v11
    v_exp_f32 v16, v16
    v_exp_f32 v17, v17
    v_lshrrev_b32 v13, 1, v8
    v_mul_f32 v12, v16, v157
    v_fmac_f32 v12, v17, v177
    v_rcp_f32 v12, v12
    s_add_u32 s58, s63, 0
    s_mul_i32 s58, s58, 1536
    v_mul_f32 v16, v16, v12
    v_mul_f32 v17, v17, v12
    v_mul_f32 v32, v140, v16
    v_fmac_f32 v32, v160, v17
    v_mul_f32 v33, v141, v16
    v_fmac_f32 v33, v161, v17
    v_mul_f32 v34, v142, v16
    v_fmac_f32 v34, v162, v17
    v_mul_f32 v35, v144, v16
    v_fmac_f32 v35, v164, v17
    v_mul_f32 v36, v145, v16
    v_fmac_f32 v36, v165, v17
    v_mul_f32 v37, v146, v16
    v_fmac_f32 v37, v166, v17
    v_mul_f32 v38, v148, v16
    v_fmac_f32 v38, v168, v17
    v_mul_f32 v39, v149, v16
    v_fmac_f32 v39, v169, v17
    v_mul_f32 v40, v150, v16
    v_fmac_f32 v40, v170, v17
    v_mul_f32 v41, v152, v16
    v_fmac_f32 v41, v172, v17
    v_mul_f32 v42, v153, v16
    v_fmac_f32 v42, v173, v17
    v_mul_f32 v43, v154, v16
    v_fmac_f32 v43, v174, v17
    v_cvt_pk_bf16_f32 v44, v32, v33
    v_cvt_pk_bf16_f32 v45, v34, v35
    v_cvt_pk_bf16_f32 v46, v36, v37
    v_cvt_pk_bf16_f32 v47, v38, v39
    v_cvt_pk_bf16_f32 v48, v40, v41
    v_cvt_pk_bf16_f32 v49, v42, v43
    buffer_store_dwordx2 v[44:45], v13, s[48:51], s58 offen offset:0
    buffer_store_dwordx2 v[46:47], v13, s[48:51], s58 offen offset:128
    buffer_store_dwordx2 v[48:49], v13, s[48:51], s58 offen offset:256
    s_mov_b32 s70, 1
    s_waitcnt vmcnt(0)
    s_branch L_fo42
L_fo32:
    s_waitcnt vmcnt(0)
    s_add_u32 s58, s62, 4352
    s_add_u32 s59, s62, 8448
    buffer_load_dwordx4 v[176:179], v14, s[24:27], s59 offen sc1
    buffer_load_dwordx4 v[160:163], v9, s[24:27], s58 offen offset:0 sc1
    buffer_load_dwordx4 v[164:167], v9, s[24:27], s58 offen offset:1024 sc1
    buffer_load_dwordx4 v[168:171], v9, s[24:27], s58 offen offset:2048 sc1
    buffer_load_dwordx4 v[172:175], v9, s[24:27], s58 offen offset:3072 sc1
L_fo42:
    s_add_u32 s58, s68, 0
    s_add_u32 s59, s68, 4096
    buffer_load_dwordx4 v[96:99], v14, s[24:27], s59 offen sc1
    buffer_load_dwordx4 v[80:83], v9, s[24:27], s58 offen offset:0 sc1
    buffer_load_dwordx4 v[84:87], v9, s[24:27], s58 offen offset:1024 sc1
    buffer_load_dwordx4 v[88:91], v9, s[24:27], s58 offen offset:2048 sc1
    buffer_load_dwordx4 v[92:95], v9, s[24:27], s58 offen offset:3072 sc1
L_fo5:
    s_add_u32 s58, s68, 4352
    s_add_u32 s59, s68, 8448
    buffer_load_dwordx4 v[116:119], v14, s[24:27], s59 offen sc1
    buffer_load_dwordx4 v[100:103], v9, s[24:27], s58 offen offset:0 sc1
    buffer_load_dwordx4 v[104:107], v9, s[24:27], s58 offen offset:1024 sc1
    buffer_load_dwordx4 v[108:111], v9, s[24:27], s58 offen offset:2048 sc1
    buffer_load_dwordx4 v[112:115], v9, s[24:27], s58 offen offset:3072 sc1
    s_waitcnt vmcnt(0)
    v_xor_b32 v13, v10, v83
    v_xor_b32 v11, v10, v87
    v_or_b32 v13, v13, v11
    v_xor_b32 v11, v10, v91
    v_or_b32 v13, v13, v11
    v_xor_b32 v11, v10, v95
    v_or_b32 v13, v13, v11
    v_xor_b32 v11, v10, v99
    v_or_b32 v13, v13, v11
    v_xor_b32 v11, v10, v103
    v_or_b32 v13, v13, v11
    v_xor_b32 v11, v10, v107
    v_or_b32 v13, v13, v11
    v_xor_b32 v11, v10, v111
    v_or_b32 v13, v13, v11
    v_xor_b32 v11, v10, v115
    v_or_b32 v13, v13, v11
    v_xor_b32 v11, v10, v119
    v_or_b32 v13, v13, v11
    v_xor_b32 v11, v10, v123
    v_or_b32 v13, v13, v11
    v_xor_b32 v11, v10, v127
    v_or_b32 v13, v13, v11
    v_xor_b32 v11, v10, v131
    v_or_b32 v13, v13, v11
    v_xor_b32 v11, v10, v135
    v_or_b32 v13, v13, v11
    v_xor_b32 v11, v10, v139
    v_or_b32 v13, v13, v11
    v_cmp_ne_u32 vcc, 0, v13
    s_nop 4
    s_cmp_eq_u64 vcc, 0
    s_cbranch_scc0 L_fo6
    v_max3_f32 v11, v96, v116, v136
    v_sub_f32 v16, v96, v11
    v_sub_f32 v17, v116, v11
    v_sub_f32 v18, v136, v11
    v_exp_f32 v16, v16
    v_exp_f32 v17, v17
    v_exp_f32 v18, v18
    v_lshrrev_b32 v13, 1, v8
    v_mul_f32 v12, v16, v97
    v_fmac_f32 v12, v17, v117
    v_fmac_f32 v12, v18, v137
    v_rcp_f32 v12, v12
    s_add_u32 s58, s100, 171
    s_mul_i32 s58, s58, 1536
    v_mul_f32 v16, v16, v12
    v_mul_f32 v17, v17, v12
    v_mul_f32 v18, v18, v12
    v_mul_f32 v32, v80, v16
    v_fmac_f32 v32, v100, v17
    v_fmac_f32 v32, v120, v18
    v_mul_f32 v33, v81, v16
    v_fmac_f32 v33, v101, v17
    v_fmac_f32 v33, v121, v18
    v_mul_f32 v34, v82, v16
    v_fmac_f32 v34, v102, v17
    v_fmac_f32 v34, v122, v18
    v_mul_f32 v35, v84, v16
    v_fmac_f32 v35, v104, v17
    v_fmac_f32 v35, v124, v18
    v_mul_f32 v36, v85, v16
    v_fmac_f32 v36, v105, v17
    v_fmac_f32 v36, v125, v18
    v_mul_f32 v37, v86, v16
    v_fmac_f32 v37, v106, v17
    v_fmac_f32 v37, v126, v18
    v_mul_f32 v38, v88, v16
    v_fmac_f32 v38, v108, v17
    v_fmac_f32 v38, v128, v18
    v_mul_f32 v39, v89, v16
    v_fmac_f32 v39, v109, v17
    v_fmac_f32 v39, v129, v18
    v_mul_f32 v40, v90, v16
    v_fmac_f32 v40, v110, v17
    v_fmac_f32 v40, v130, v18
    v_mul_f32 v41, v92, v16
    v_fmac_f32 v41, v112, v17
    v_fmac_f32 v41, v132, v18
    v_mul_f32 v42, v93, v16
    v_fmac_f32 v42, v113, v17
    v_fmac_f32 v42, v133, v18
    v_mul_f32 v43, v94, v16
    v_fmac_f32 v43, v114, v17
    v_fmac_f32 v43, v134, v18
    v_cvt_pk_bf16_f32 v44, v32, v33
    v_cvt_pk_bf16_f32 v45, v34, v35
    v_cvt_pk_bf16_f32 v46, v36, v37
    v_cvt_pk_bf16_f32 v47, v38, v39
    v_cvt_pk_bf16_f32 v48, v40, v41
    v_cvt_pk_bf16_f32 v49, v42, v43
    buffer_store_dwordx2 v[44:45], v13, s[48:51], s58 offen offset:0
    buffer_store_dwordx2 v[46:47], v13, s[48:51], s58 offen offset:128
    buffer_store_dwordx2 v[48:49], v13, s[48:51], s58 offen offset:256
L_fo6:
    s_cmp_eq_u32 s70, 1
    s_cbranch_scc1 L_fin
    v_xor_b32 v13, v10, v163
    v_xor_b32 v11, v10, v167
    v_or_b32 v13, v13, v11
    v_xor_b32 v11, v10, v171
    v_or_b32 v13, v13, v11
    v_xor_b32 v11, v10, v175
    v_or_b32 v13, v13, v11
    v_xor_b32 v11, v10, v179
    v_or_b32 v13, v13, v11
    v_cmp_ne_u32 vcc, 0, v13
    s_nop 4
    s_cmp_eq_u64 vcc, 0
    s_cbranch_scc1 L_fo7
    s_add_u32 s58, s62, 0
    s_add_u32 s59, s62, 4096
    buffer_store_dwordx4 v[140:143], v9, s[24:27], s58 offen offset:0 sc1
    buffer_store_dwordx4 v[144:147], v9, s[24:27], s58 offen offset:1024 sc1
    buffer_store_dwordx4 v[148:151], v9, s[24:27], s58 offen offset:2048 sc1
    buffer_store_dwordx4 v[152:155], v9, s[24:27], s58 offen offset:3072 sc1
    s_mov_b32 exec_lo, 0x00010001
    s_mov_b32 exec_hi, 0x00010001
    buffer_store_dwordx4 v[156:159], v14, s[24:27], s59 offen sc1
    s_mov_b64 exec, -1
    s_waitcnt vmcnt(0)
    s_add_u32 s58, s62, 4352
    s_add_u32 s59, s62, 8448
    buffer_load_dwordx4 v[176:179], v14, s[24:27], s59 offen sc1
    buffer_load_dwordx4 v[160:163], v9, s[24:27], s58 offen offset:0 sc1
    buffer_load_dwordx4 v[164:167], v9, s[24:27], s58 offen offset:1024 sc1
    buffer_load_dwordx4 v[168:171], v9, s[24:27], s58 offen offset:2048 sc1
    buffer_load_dwordx4 v[172:175], v9, s[24:27], s58 offen offset:3072 sc1
    s_waitcnt vmcnt(0)
    v_xor_b32 v13, v10, v163
    v_xor_b32 v11, v10, v167
    v_or_b32 v13, v13, v11
    v_xor_b32 v11, v10, v171
    v_or_b32 v13, v13, v11
    v_xor_b32 v11, v10, v175
    v_or_b32 v13, v13, v11
    v_xor_b32 v11, v10, v179
    v_or_b32 v13, v13, v11
    v_cmp_ne_u32 vcc, 0, v13
    s_nop 4
    s_cmp_eq_u64 vcc, 0
    s_cbranch_scc0 L_fin
L_fo7:
    v_max_f32 v11, v156, v176
    v_sub_f32 v16, v156, v11
    v_sub_f32 v17, v176, v11
    v_exp_f32 v16, v16
    v_exp_f32 v17, v17
    v_lshrrev_b32 v13, 1, v8
    v_mul_f32 v12, v16, v157
    v_fmac_f32 v12, v17, v177
    v_rcp_f32 v12, v12
    s_add_u32 s58, s63, 0
    s_mul_i32 s58, s58, 1536
    v_mul_f32 v16, v16, v12
    v_mul_f32 v17, v17, v12
    v_mul_f32 v32, v140, v16
    v_fmac_f32 v32, v160, v17
    v_mul_f32 v33, v141, v16
    v_fmac_f32 v33, v161, v17
    v_mul_f32 v34, v142, v16
    v_fmac_f32 v34, v162, v17
    v_mul_f32 v35, v144, v16
    v_fmac_f32 v35, v164, v17
    v_mul_f32 v36, v145, v16
    v_fmac_f32 v36, v165, v17
    v_mul_f32 v37, v146, v16
    v_fmac_f32 v37, v166, v17
    v_mul_f32 v38, v148, v16
    v_fmac_f32 v38, v168, v17
    v_mul_f32 v39, v149, v16
    v_fmac_f32 v39, v169, v17
    v_mul_f32 v40, v150, v16
    v_fmac_f32 v40, v170, v17
    v_mul_f32 v41, v152, v16
    v_fmac_f32 v41, v172, v17
    v_mul_f32 v42, v153, v16
    v_fmac_f32 v42, v173, v17
    v_mul_f32 v43, v154, v16
    v_fmac_f32 v43, v174, v17
    v_cvt_pk_bf16_f32 v44, v32, v33
    v_cvt_pk_bf16_f32 v45, v34, v35
    v_cvt_pk_bf16_f32 v46, v36, v37
    v_cvt_pk_bf16_f32 v47, v38, v39
    v_cvt_pk_bf16_f32 v48, v40, v41
    v_cvt_pk_bf16_f32 v49, v42, v43
    buffer_store_dwordx2 v[44:45], v13, s[48:51], s58 offen offset:0
    buffer_store_dwordx2 v[46:47], v13, s[48:51], s58 offen offset:128
    buffer_store_dwordx2 v[48:49], v13, s[48:51], s58 offen offset:256
    s_branch L_fin
L_fmid:
    v_and_b32 v7, 1, v1
    v_mul_u32_u24 v7, 8704, v7
    v_add_u32 v7, 4108, v7
    s_movk_i32 s69, 41
L_fb4:
    s_barrier
    s_sub_u32 s69, s69, 1
    s_cmp_lg_u32 s69, 0
    s_cbranch_scc1 L_fb4
    v_add_u32 v13, 142336, v14
    v_add_u32 v11, 142592, v8
    ds_read_b128 v[16:19], v13 offset:0
    ds_read_b128 v[20:23], v13 offset:64
    ds_read_b128 v[24:27], v13 offset:128
    ds_read_b128 v[28:31], v13 offset:192
    ds_read_b128 v[32:35], v11 offset:0
    ds_read_b128 v[36:39], v11 offset:256
    ds_read_b128 v[40:43], v11 offset:512
    ds_read_b128 v[44:47], v11 offset:3072
    ds_read_b128 v[48:51], v11 offset:3328
    ds_read_b128 v[52:55], v11 offset:3584
    ds_read_b128 v[56:59], v11 offset:6144
    ds_read_b128 v[60:63], v11 offset:6400
    ds_read_b128 v[64:67], v11 offset:6656
    s_waitcnt lgkmcnt(9)
    ds_read_b128 v[68:71], v11 offset:9216
    ds_read_b128 v[72:75], v11 offset:9472
    ds_read_b128 v[76:79], v11 offset:9728
    v_max_f32 v156, v16, v20
    v_max3_f32 v156, v156, v24, v28
    v_sub_f32 v16, v16, v156
    v_sub_f32 v20, v20, v156
    v_sub_f32 v24, v24, v156
    v_sub_f32 v28, v28, v156
    v_exp_f32 v16, v16
    v_exp_f32 v20, v20
    v_exp_f32 v24, v24
    v_exp_f32 v28, v28
    v_mov_b32 v143, v10
    v_mov_b32 v147, v10
    v_mov_b32 v151, v10
    v_mov_b32 v155, v10
    v_mov_b32 v159, v10
    v_mul_f32 v157, v16, v17
    v_mul_f32 v158, v16, v18
    v_fmac_f32 v157, v20, v21
    v_fmac_f32 v158, v20, v22
    v_fmac_f32 v157, v24, v25
    v_fmac_f32 v158, v24, v26
    v_fmac_f32 v157, v28, v29
    v_fmac_f32 v158, v28, v30
    s_waitcnt lgkmcnt(9)
    v_fma_f32 v140, v32, v16, -v158
    v_fma_f32 v141, v33, v16, -v158
    v_fma_f32 v142, v34, v16, -v158
    v_fma_f32 v144, v35, v16, -v158
    v_fma_f32 v145, v36, v16, -v158
    v_fma_f32 v146, v37, v16, -v158
    v_fma_f32 v148, v38, v16, -v158
    v_fma_f32 v149, v39, v16, -v158
    v_fma_f32 v150, v40, v16, -v158
    v_fma_f32 v152, v41, v16, -v158
    v_fma_f32 v153, v42, v16, -v158
    v_fma_f32 v154, v43, v16, -v158
    s_waitcnt lgkmcnt(6)
    v_fmac_f32 v140, v44, v20
    v_fmac_f32 v141, v45, v20
    v_fmac_f32 v142, v46, v20
    v_fmac_f32 v144, v47, v20
    v_fmac_f32 v145, v48, v20
    v_fmac_f32 v146, v49, v20
    v_fmac_f32 v148, v50, v20
    v_fmac_f32 v149, v51, v20
    v_fmac_f32 v150, v52, v20
    v_fmac_f32 v152, v53, v20
    v_fmac_f32 v153, v54, v20
    v_fmac_f32 v154, v55, v20
    s_waitcnt lgkmcnt(3)
    v_fmac_f32 v140, v56, v24
    v_fmac_f32 v141, v57, v24
    v_fmac_f32 v142, v58, v24
    v_fmac_f32 v144, v59, v24
    v_fmac_f32 v145, v60, v24
    v_fmac_f32 v146, v61, v24
    v_fmac_f32 v148, v62, v24
    v_fmac_f32 v149, v63, v24
    v_fmac_f32 v150, v64, v24
    v_fmac_f32 v152, v65, v24
    v_fmac_f32 v153, v66, v24
    v_fmac_f32 v154, v67, v24
    s_waitcnt lgkmcnt(0)
    v_fmac_f32 v140, v68, v28
    v_fmac_f32 v141, v69, v28
    v_fmac_f32 v142, v70, v28
    v_fmac_f32 v144, v71, v28
    v_fmac_f32 v145, v72, v28
    v_fmac_f32 v146, v73, v28
    v_fmac_f32 v148, v74, v28
    v_fmac_f32 v149, v75, v28
    v_fmac_f32 v150, v76, v28
    v_fmac_f32 v152, v77, v28
    v_fmac_f32 v153, v78, v28
    v_fmac_f32 v154, v79, v28
    s_movk_i32 s69, 40
L_fb5:
    s_barrier
    s_sub_u32 s69, s69, 1
    s_cmp_lg_u32 s69, 0
    s_cbranch_scc1 L_fb5
    v_add_u32 v13, 142336, v14
    v_add_u32 v11, 142592, v8
    ds_read_b128 v[16:19], v13 offset:0
    ds_read_b128 v[20:23], v13 offset:64
    ds_read_b128 v[24:27], v13 offset:128
    ds_read_b128 v[28:31], v13 offset:192
    ds_read_b128 v[32:35], v11 offset:0
    ds_read_b128 v[36:39], v11 offset:256
    ds_read_b128 v[40:43], v11 offset:512
    ds_read_b128 v[44:47], v11 offset:3072
    ds_read_b128 v[48:51], v11 offset:3328
    ds_read_b128 v[52:55], v11 offset:3584
    ds_read_b128 v[56:59], v11 offset:6144
    ds_read_b128 v[60:63], v11 offset:6400
    ds_read_b128 v[64:67], v11 offset:6656
    s_waitcnt lgkmcnt(9)
    ds_read_b128 v[68:71], v11 offset:9216
    ds_read_b128 v[72:75], v11 offset:9472
    ds_read_b128 v[76:79], v11 offset:9728
    v_max_f32 v176, v16, v20
    v_max3_f32 v176, v176, v24, v28
    v_sub_f32 v16, v16, v176
    v_sub_f32 v20, v20, v176
    v_sub_f32 v24, v24, v176
    v_sub_f32 v28, v28, v176
    v_exp_f32 v16, v16
    v_exp_f32 v20, v20
    v_exp_f32 v24, v24
    v_exp_f32 v28, v28
    v_mov_b32 v163, v10
    v_mov_b32 v167, v10
    v_mov_b32 v171, v10
    v_mov_b32 v175, v10
    v_mov_b32 v179, v10
    v_mul_f32 v177, v16, v17
    v_mul_f32 v178, v16, v18
    v_fmac_f32 v177, v20, v21
    v_fmac_f32 v178, v20, v22
    v_fmac_f32 v177, v24, v25
    v_fmac_f32 v178, v24, v26
    v_fmac_f32 v177, v28, v29
    v_fmac_f32 v178, v28, v30
    s_waitcnt lgkmcnt(9)
    v_fma_f32 v160, v32, v16, -v178
    v_fma_f32 v161, v33, v16, -v178
    v_fma_f32 v162, v34, v16, -v178
    v_fma_f32 v164, v35, v16, -v178
    v_fma_f32 v165, v36, v16, -v178
    v_fma_f32 v166, v37, v16, -v178
    v_fma_f32 v168, v38, v16, -v178
    v_fma_f32 v169, v39, v16, -v178
    v_fma_f32 v170, v40, v16, -v178
    v_fma_f32 v172, v41, v16, -v178
    v_fma_f32 v173, v42, v16, -v178
    v_fma_f32 v174, v43, v16, -v178
    s_waitcnt lgkmcnt(6)
    v_fmac_f32 v160, v44, v20
    v_fmac_f32 v161, v45, v20
    v_fmac_f32 v162, v46, v20
    v_fmac_f32 v164, v47, v20
    v_fmac_f32 v165, v48, v20
    v_fmac_f32 v166, v49, v20
    v_fmac_f32 v168, v50, v20
    v_fmac_f32 v169, v51, v20
    v_fmac_f32 v170, v52, v20
    v_fmac_f32 v172, v53, v20
    v_fmac_f32 v173, v54, v20
    v_fmac_f32 v174, v55, v20
    s_waitcnt lgkmcnt(3)
    v_fmac_f32 v160, v56, v24
    v_fmac_f32 v161, v57, v24
    v_fmac_f32 v162, v58, v24
    v_fmac_f32 v164, v59, v24
    v_fmac_f32 v165, v60, v24
    v_fmac_f32 v166, v61, v24
    v_fmac_f32 v168, v62, v24
    v_fmac_f32 v169, v63, v24
    v_fmac_f32 v170, v64, v24
    v_fmac_f32 v172, v65, v24
    v_fmac_f32 v173, v66, v24
    v_fmac_f32 v174, v67, v24
    s_waitcnt lgkmcnt(0)
    v_fmac_f32 v160, v68, v28
    v_fmac_f32 v161, v69, v28
    v_fmac_f32 v162, v70, v28
    v_fmac_f32 v164, v71, v28
    v_fmac_f32 v165, v72, v28
    v_fmac_f32 v166, v73, v28
    v_fmac_f32 v168, v74, v28
    v_fmac_f32 v169, v75, v28
    v_fmac_f32 v170, v76, v28
    v_fmac_f32 v172, v77, v28
    v_fmac_f32 v173, v78, v28
    v_fmac_f32 v174, v79, v28
    s_movk_i32 s69, 46
L_fb6:
    s_barrier
    s_sub_u32 s69, s69, 1
    s_cmp_lg_u32 s69, 0
    s_cbranch_scc1 L_fb6
    s_add_u32 s58, s62, 4352
    s_add_u32 s59, s62, 8448
    buffer_store_dwordx4 v[140:143], v9, s[24:27], s58 offen offset:0 sc1
    buffer_store_dwordx4 v[144:147], v9, s[24:27], s58 offen offset:1024 sc1
    buffer_store_dwordx4 v[148:151], v9, s[24:27], s58 offen offset:2048 sc1
    buffer_store_dwordx4 v[152:155], v9, s[24:27], s58 offen offset:3072 sc1
    s_mov_b32 exec_lo, 0x00010001
    s_mov_b32 exec_hi, 0x00010001
    buffer_store_dwordx4 v[156:159], v14, s[24:27], s59 offen sc1
    s_mov_b64 exec, -1
    s_add_u32 s58, s62, 13056
    s_add_u32 s59, s62, 17152
    buffer_store_dwordx4 v[160:163], v9, s[24:27], s58 offen offset:0 sc1
    buffer_store_dwordx4 v[164:167], v9, s[24:27], s58 offen offset:1024 sc1
    buffer_store_dwordx4 v[168:171], v9, s[24:27], s58 offen offset:2048 sc1
    buffer_store_dwordx4 v[172:175], v9, s[24:27], s58 offen offset:3072 sc1
    s_mov_b32 exec_lo, 0x00010001
    s_mov_b32 exec_hi, 0x00010001
    buffer_store_dwordx4 v[176:179], v14, s[24:27], s59 offen sc1
    s_mov_b64 exec, -1
    s_barrier
    s_add_u32 s58, s68, 0
    s_add_u32 s59, s68, 4096
    buffer_load_dwordx4 v[96:99], v14, s[24:27], s59 offen sc1
    buffer_load_dwordx4 v[80:83], v9, s[24:27], s58 offen offset:0 sc1
    buffer_load_dwordx4 v[84:87], v9, s[24:27], s58 offen offset:1024 sc1
    buffer_load_dwordx4 v[88:91], v9, s[24:27], s58 offen offset:2048 sc1
    buffer_load_dwordx4 v[92:95], v9, s[24:27], s58 offen offset:3072 sc1
    s_add_u32 s58, s68, 8704
    s_add_u32 s59, s68, 12800
    buffer_load_dwordx4 v[136:139], v14, s[24:27], s59 offen sc1
    buffer_load_dwordx4 v[120:123], v9, s[24:27], s58 offen offset:0 sc1
    buffer_load_dwordx4 v[124:127], v9, s[24:27], s58 offen offset:1024 sc1
    buffer_load_dwordx4 v[128:131], v9, s[24:27], s58 offen offset:2048 sc1
    buffer_load_dwordx4 v[132:135], v9, s[24:27], s58 offen offset:3072 sc1
    s_barrier
    v_add_u32 v13, 142336, v14
    v_add_u32 v11, 142592, v8
    ds_read_b128 v[16:19], v13 offset:0
    ds_read_b128 v[20:23], v13 offset:64
    ds_read_b128 v[24:27], v13 offset:128
    ds_read_b128 v[28:31], v13 offset:192
    ds_read_b128 v[32:35], v11 offset:0
    ds_read_b128 v[36:39], v11 offset:256
    ds_read_b128 v[40:43], v11 offset:512
    ds_read_b128 v[44:47], v11 offset:3072
    ds_read_b128 v[48:51], v11 offset:3328
    ds_read_b128 v[52:55], v11 offset:3584
    ds_read_b128 v[56:59], v11 offset:6144
    ds_read_b128 v[60:63], v11 offset:6400
    ds_read_b128 v[64:67], v11 offset:6656
    s_waitcnt lgkmcnt(9)
    ds_read_b128 v[68:71], v11 offset:9216
    ds_read_b128 v[72:75], v11 offset:9472
    ds_read_b128 v[76:79], v11 offset:9728
    v_max_f32 v116, v16, v20
    v_max3_f32 v116, v116, v24, v28
    v_sub_f32 v16, v16, v116
    v_sub_f32 v20, v20, v116
    v_sub_f32 v24, v24, v116
    v_sub_f32 v28, v28, v116
    v_exp_f32 v16, v16
    v_exp_f32 v20, v20
    v_exp_f32 v24, v24
    v_exp_f32 v28, v28
    v_mov_b32 v103, v10
    v_mov_b32 v107, v10
    v_mov_b32 v111, v10
    v_mov_b32 v115, v10
    v_mov_b32 v119, v10
    v_mul_f32 v117, v16, v17
    v_mul_f32 v118, v16, v18
    v_fmac_f32 v117, v20, v21
    v_fmac_f32 v118, v20, v22
    v_fmac_f32 v117, v24, v25
    v_fmac_f32 v118, v24, v26
    v_fmac_f32 v117, v28, v29
    v_fmac_f32 v118, v28, v30
    s_waitcnt lgkmcnt(9)
    v_fma_f32 v100, v32, v16, -v118
    v_fma_f32 v101, v33, v16, -v118
    v_fma_f32 v102, v34, v16, -v118
    v_fma_f32 v104, v35, v16, -v118
    v_fma_f32 v105, v36, v16, -v118
    v_fma_f32 v106, v37, v16, -v118
    v_fma_f32 v108, v38, v16, -v118
    v_fma_f32 v109, v39, v16, -v118
    v_fma_f32 v110, v40, v16, -v118
    v_fma_f32 v112, v41, v16, -v118
    v_fma_f32 v113, v42, v16, -v118
    v_fma_f32 v114, v43, v16, -v118
    s_waitcnt lgkmcnt(6)
    v_fmac_f32 v100, v44, v20
    v_fmac_f32 v101, v45, v20
    v_fmac_f32 v102, v46, v20
    v_fmac_f32 v104, v47, v20
    v_fmac_f32 v105, v48, v20
    v_fmac_f32 v106, v49, v20
    v_fmac_f32 v108, v50, v20
    v_fmac_f32 v109, v51, v20
    v_fmac_f32 v110, v52, v20
    v_fmac_f32 v112, v53, v20
    v_fmac_f32 v113, v54, v20
    v_fmac_f32 v114, v55, v20
    s_waitcnt lgkmcnt(3)
    v_fmac_f32 v100, v56, v24
    v_fmac_f32 v101, v57, v24
    v_fmac_f32 v102, v58, v24
    v_fmac_f32 v104, v59, v24
    v_fmac_f32 v105, v60, v24
    v_fmac_f32 v106, v61, v24
    v_fmac_f32 v108, v62, v24
    v_fmac_f32 v109, v63, v24
    v_fmac_f32 v110, v64, v24
    v_fmac_f32 v112, v65, v24
    v_fmac_f32 v113, v66, v24
    v_fmac_f32 v114, v67, v24
    s_waitcnt lgkmcnt(0)
    v_fmac_f32 v100, v68, v28
    v_fmac_f32 v101, v69, v28
    v_fmac_f32 v102, v70, v28
    v_fmac_f32 v104, v71, v28
    v_fmac_f32 v105, v72, v28
    v_fmac_f32 v106, v73, v28
    v_fmac_f32 v108, v74, v28
    v_fmac_f32 v109, v75, v28
    v_fmac_f32 v110, v76, v28
    v_fmac_f32 v112, v77, v28
    v_fmac_f32 v113, v78, v28
    v_fmac_f32 v114, v79, v28
    s_waitcnt vmcnt(0)
    buffer_load_dword v15, v7, s[24:27], s62 offen sc1
    v_xor_b32 v13, v10, v83
    v_xor_b32 v11, v10, v87
    v_or_b32 v13, v13, v11
    v_xor_b32 v11, v10, v91
    v_or_b32 v13, v13, v11
    v_xor_b32 v11, v10, v95
    v_or_b32 v13, v13, v11
    v_xor_b32 v11, v10, v99
    v_or_b32 v13, v13, v11
    v_xor_b32 v11, v10, v123
    v_or_b32 v13, v13, v11
    v_xor_b32 v11, v10, v127
    v_or_b32 v13, v13, v11
    v_xor_b32 v11, v10, v131
    v_or_b32 v13, v13, v11
    v_xor_b32 v11, v10, v135
    v_or_b32 v13, v13, v11
    v_xor_b32 v11, v10, v139
    v_or_b32 v13, v13, v11
    v_cmp_ne_u32 vcc, 0, v13
    s_nop 4
    s_cmp_eq_u64 vcc, 0
    s_cbranch_scc1 L_fm1
    s_add_u32 s58, s68, 4352
    s_add_u32 s59, s68, 8448
    buffer_store_dwordx4 v[100:103], v9, s[24:27], s58 offen offset:0 sc1
    buffer_store_dwordx4 v[104:107], v9, s[24:27], s58 offen offset:1024 sc1
    buffer_store_dwordx4 v[108:111], v9, s[24:27], s58 offen offset:2048 sc1
    buffer_store_dwordx4 v[112:115], v9, s[24:27], s58 offen offset:3072 sc1
    s_mov_b32 exec_lo, 0x00010001
    s_mov_b32 exec_hi, 0x00010001
    buffer_store_dwordx4 v[116:119], v14, s[24:27], s59 offen sc1
    s_mov_b64 exec, -1
    s_waitcnt vmcnt(0)
    s_add_u32 s58, s68, 0
    s_add_u32 s59, s68, 4096
    buffer_load_dwordx4 v[96:99], v14, s[24:27], s59 offen sc1
    buffer_load_dwordx4 v[80:83], v9, s[24:27], s58 offen offset:0 sc1
    buffer_load_dwordx4 v[84:87], v9, s[24:27], s58 offen offset:1024 sc1
    buffer_load_dwordx4 v[88:91], v9, s[24:27], s58 offen offset:2048 sc1
    buffer_load_dwordx4 v[92:95], v9, s[24:27], s58 offen offset:3072 sc1
    s_add_u32 s58, s68, 8704
    s_add_u32 s59, s68, 12800
    buffer_load_dwordx4 v[136:139], v14, s[24:27], s59 offen sc1
    buffer_load_dwordx4 v[120:123], v9, s[24:27], s58 offen offset:0 sc1
    buffer_load_dwordx4 v[124:127], v9, s[24:27], s58 offen offset:1024 sc1
    buffer_load_dwordx4 v[128:131], v9, s[24:27], s58 offen offset:2048 sc1
    buffer_load_dwordx4 v[132:135], v9, s[24:27], s58 offen offset:3072 sc1
    s_waitcnt vmcnt(0)
    v_xor_b32 v13, v10, v83
    v_xor_b32 v11, v10, v87
    v_or_b32 v13, v13, v11
    v_xor_b32 v11, v10, v91
    v_or_b32 v13, v13, v11
    v_xor_b32 v11, v10, v95
    v_or_b32 v13, v13, v11
    v_xor_b32 v11, v10, v99
    v_or_b32 v13, v13, v11
    v_xor_b32 v11, v10, v123
    v_or_b32 v13, v13, v11
    v_xor_b32 v11, v10, v127
    v_or_b32 v13, v13, v11
    v_xor_b32 v11, v10, v131
    v_or_b32 v13, v13, v11
    v_xor_b32 v11, v10, v135
    v_or_b32 v13, v13, v11
    v_xor_b32 v11, v10, v139
    v_or_b32 v13, v13, v11
    v_cmp_ne_u32 vcc, 0, v13
    s_nop 4
    s_cmp_eq_u64 vcc, 0
    s_cbranch_scc0 L_fm2
L_fm1:
    v_max3_f32 v11, v96, v116, v136
    v_sub_f32 v16, v96, v11
    v_sub_f32 v17, v116, v11
    v_sub_f32 v18, v136, v11
    v_exp_f32 v16, v16
    v_exp_f32 v17, v17
    v_exp_f32 v18, v18
    v_lshrrev_b32 v13, 1, v8
    v_mul_f32 v12, v16, v97
    v_fmac_f32 v12, v17, v117
    v_fmac_f32 v12, v18, v137
    v_rcp_f32 v12, v12
    s_add_u32 s58, s100, 171
    s_mul_i32 s58, s58, 1536
    v_mul_f32 v16, v16, v12
    v_mul_f32 v17, v17, v12
    v_mul_f32 v18, v18, v12
    v_mul_f32 v32, v80, v16
    v_fmac_f32 v32, v100, v17
    v_fmac_f32 v32, v120, v18
    v_mul_f32 v33, v81, v16
    v_fmac_f32 v33, v101, v17
    v_fmac_f32 v33, v121, v18
    v_mul_f32 v34, v82, v16
    v_fmac_f32 v34, v102, v17
    v_fmac_f32 v34, v122, v18
    v_mul_f32 v35, v84, v16
    v_fmac_f32 v35, v104, v17
    v_fmac_f32 v35, v124, v18
    v_mul_f32 v36, v85, v16
    v_fmac_f32 v36, v105, v17
    v_fmac_f32 v36, v125, v18
    v_mul_f32 v37, v86, v16
    v_fmac_f32 v37, v106, v17
    v_fmac_f32 v37, v126, v18
    v_mul_f32 v38, v88, v16
    v_fmac_f32 v38, v108, v17
    v_fmac_f32 v38, v128, v18
    v_mul_f32 v39, v89, v16
    v_fmac_f32 v39, v109, v17
    v_fmac_f32 v39, v129, v18
    v_mul_f32 v40, v90, v16
    v_fmac_f32 v40, v110, v17
    v_fmac_f32 v40, v130, v18
    v_mul_f32 v41, v92, v16
    v_fmac_f32 v41, v112, v17
    v_fmac_f32 v41, v132, v18
    v_mul_f32 v42, v93, v16
    v_fmac_f32 v42, v113, v17
    v_fmac_f32 v42, v133, v18
    v_mul_f32 v43, v94, v16
    v_fmac_f32 v43, v114, v17
    v_fmac_f32 v43, v134, v18
    v_cvt_pk_bf16_f32 v44, v32, v33
    v_cvt_pk_bf16_f32 v45, v34, v35
    v_cvt_pk_bf16_f32 v46, v36, v37
    v_cvt_pk_bf16_f32 v47, v38, v39
    v_cvt_pk_bf16_f32 v48, v40, v41
    v_cvt_pk_bf16_f32 v49, v42, v43
    buffer_store_dwordx2 v[44:45], v13, s[48:51], s58 offen offset:0
    buffer_store_dwordx2 v[46:47], v13, s[48:51], s58 offen offset:128
    buffer_store_dwordx2 v[48:49], v13, s[48:51], s58 offen offset:256
    s_waitcnt vmcnt(3)
L_fm2:
    v_cmp_eq_u32 vcc, v15, v10
    s_nop 4
    s_and_b32 s70, vcc_lo, 3
    s_cbranch_scc0 L_fin
    s_bitcmp1_b32 s70, 0
    s_cbranch_scc0 L_fm30
    s_waitcnt vmcnt(0)
    s_add_u32 s58, s62, 0
    s_add_u32 s59, s62, 4096
    buffer_load_dwordx4 v[96:99], v14, s[24:27], s59 offen sc1
    buffer_load_dwordx4 v[80:83], v9, s[24:27], s58 offen offset:0 sc1
    buffer_load_dwordx4 v[84:87], v9, s[24:27], s58 offen offset:1024 sc1
    buffer_load_dwordx4 v[88:91], v9, s[24:27], s58 offen offset:2048 sc1
    buffer_load_dwordx4 v[92:95], v9, s[24:27], s58 offen offset:3072 sc1
    s_waitcnt vmcnt(0)
    v_xor_b32 v13, v10, v83
    v_xor_b32 v11, v10, v87
    v_or_b32 v13, v13, v11
    v_xor_b32 v11, v10, v91
    v_or_b32 v13, v13, v11
    v_xor_b32 v11, v10, v95
    v_or_b32 v13, v13, v11
    v_xor_b32 v11, v10, v99
    v_or_b32 v13, v13, v11
    v_cmp_ne_u32 vcc, 0, v13
    s_nop 4
    s_cmp_eq_u64 vcc, 0
    s_cbranch_scc0 L_fm30
    v_max_f32 v11, v96, v156
    v_sub_f32 v16, v96, v11
    v_sub_f32 v17, v156, v11
    v_exp_f32 v16, v16
    v_exp_f32 v17, v17
    v_lshrrev_b32 v13, 1, v8
    v_mul_f32 v12, v16, v97
    v_fmac_f32 v12, v17, v157
    v_rcp_f32 v12, v12
    s_add_u32 s58, s63, 0
    s_mul_i32 s58, s58, 1536
    v_mul_f32 v16, v16, v12
    v_mul_f32 v17, v17, v12
    v_mul_f32 v32, v80, v16
    v_fmac_f32 v32, v140, v17
    v_mul_f32 v33, v81, v16
    v_fmac_f32 v33, v141, v17
    v_mul_f32 v34, v82, v16
    v_fmac_f32 v34, v142, v17
    v_mul_f32 v35, v84, v16
    v_fmac_f32 v35, v144, v17
    v_mul_f32 v36, v85, v16
    v_fmac_f32 v36, v145, v17
    v_mul_f32 v37, v86, v16
    v_fmac_f32 v37, v146, v17
    v_mul_f32 v38, v88, v16
    v_fmac_f32 v38, v148, v17
    v_mul_f32 v39, v89, v16
    v_fmac_f32 v39, v149, v17
    v_mul_f32 v40, v90, v16
    v_fmac_f32 v40, v150, v17
    v_mul_f32 v41, v92, v16
    v_fmac_f32 v41, v152, v17
    v_mul_f32 v42, v93, v16
    v_fmac_f32 v42, v153, v17
    v_mul_f32 v43, v94, v16
    v_fmac_f32 v43, v154, v17
    v_cvt_pk_bf16_f32 v44, v32, v33
    v_cvt_pk_bf16_f32 v45, v34, v35
    v_cvt_pk_bf16_f32 v46, v36, v37
    v_cvt_pk_bf16_f32 v47, v38, v39
    v_cvt_pk_bf16_f32 v48, v40, v41
    v_cvt_pk_bf16_f32 v49, v42, v43
    buffer_store_dwordx2 v[44:45], v13, s[48:51], s58 offen offset:0
    buffer_store_dwordx2 v[46:47], v13, s[48:51], s58 offen offset:128
    buffer_store_dwordx2 v[48:49], v13, s[48:51], s58 offen offset:256
L_fm30:
    s_bitcmp1_b32 s70, 1
    s_cbranch_scc0 L_fm31
    s_waitcnt vmcnt(0)
    s_add_u32 s58, s62, 8704
    s_add_u32 s59, s62, 12800
    buffer_load_dwordx4 v[96:99], v14, s[24:27], s59 offen sc1
    buffer_load_dwordx4 v[80:83], v9, s[24:27], s58 offen offset:0 sc1
    buffer_load_dwordx4 v[84:87], v9, s[24:27], s58 offen offset:1024 sc1
    buffer_load_dwordx4 v[88:91], v9, s[24:27], s58 offen offset:2048 sc1
    buffer_load_dwordx4 v[92:95], v9, s[24:27], s58 offen offset:3072 sc1
    s_waitcnt vmcnt(0)
    v_xor_b32 v13, v10, v83
    v_xor_b32 v11, v10, v87
    v_or_b32 v13, v13, v11
    v_xor_b32 v11, v10, v91
    v_or_b32 v13, v13, v11
    v_xor_b32 v11, v10, v95
    v_or_b32 v13, v13, v11
    v_xor_b32 v11, v10, v99
    v_or_b32 v13, v13, v11
    v_cmp_ne_u32 vcc, 0, v13
    s_nop 4
    s_cmp_eq_u64 vcc, 0
    s_cbranch_scc0 L_fm31
    v_max_f32 v11, v96, v176
    v_sub_f32 v16, v96, v11
    v_sub_f32 v17, v176, v11
    v_exp_f32 v16, v16
    v_exp_f32 v17, v17
    v_lshrrev_b32 v13, 1, v8
    v_mul_f32 v12, v16, v97
    v_fmac_f32 v12, v17, v177
    v_rcp_f32 v12, v12
    s_add_u32 s58, s63, 1
    s_mul_i32 s58, s58, 1536
    v_mul_f32 v16, v16, v12
    v_mul_f32 v17, v17, v12
    v_mul_f32 v32, v80, v16
    v_fmac_f32 v32, v160, v17
    v_mul_f32 v33, v81, v16
    v_fmac_f32 v33, v161, v17
    v_mul_f32 v34, v82, v16
    v_fmac_f32 v34, v162, v17
    v_mul_f32 v35, v84, v16
    v_fmac_f32 v35, v164, v17
    v_mul_f32 v36, v85, v16
    v_fmac_f32 v36, v165, v17
    v_mul_f32 v37, v86, v16
    v_fmac_f32 v37, v166, v17
    v_mul_f32 v38, v88, v16
    v_fmac_f32 v38, v168, v17
    v_mul_f32 v39, v89, v16
    v_fmac_f32 v39, v169, v17
    v_mul_f32 v40, v90, v16
    v_fmac_f32 v40, v170, v17
    v_mul_f32 v41, v92, v16
    v_fmac_f32 v41, v172, v17
    v_mul_f32 v42, v93, v16
    v_fmac_f32 v42, v173, v17
    v_mul_f32 v43, v94, v16
    v_fmac_f32 v43, v174, v17
    v_cvt_pk_bf16_f32 v44, v32, v33
    v_cvt_pk_bf16_f32 v45, v34, v35
    v_cvt_pk_bf16_f32 v46, v36, v37
    v_cvt_pk_bf16_f32 v47, v38, v39
    v_cvt_pk_bf16_f32 v48, v40, v41
    v_cvt_pk_bf16_f32 v49, v42, v43
    buffer_store_dwordx2 v[44:45], v13, s[48:51], s58 offen offset:0
    buffer_store_dwordx2 v[46:47], v13, s[48:51], s58 offen offset:128
    buffer_store_dwordx2 v[48:49], v13, s[48:51], s58 offen offset:256
L_fm31:
    s_branch L_fin
L_fsolo:
    s_movk_i32 s69, 129
L_fb7:
    s_barrier
    s_sub_u32 s69, s69, 1
    s_cmp_lg_u32 s69, 0
    s_cbranch_scc1 L_fb7
    v_add_u32 v13, 142336, v14
    v_add_u32 v11, 142592, v8
    ds_read_b128 v[16:19], v13 offset:0
    ds_read_b128 v[20:23], v13 offset:64
    ds_read_b128 v[24:27], v13 offset:128
    ds_read_b128 v[28:31], v13 offset:192
    ds_read_b128 v[32:35], v11 offset:0
    ds_read_b128 v[36:39], v11 offset:256
    ds_read_b128 v[40:43], v11 offset:512
    ds_read_b128 v[44:47], v11 offset:3072
    ds_read_b128 v[48:51], v11 offset:3328
    ds_read_b128 v[52:55], v11 offset:3584
    ds_read_b128 v[56:59], v11 offset:6144
    ds_read_b128 v[60:63], v11 offset:6400
    ds_read_b128 v[64:67], v11 offset:6656
    s_waitcnt lgkmcnt(9)
    ds_read_b128 v[68:71], v11 offset:9216
    ds_read_b128 v[72:75], v11 offset:9472
    ds_read_b128 v[76:79], v11 offset:9728
    v_max_f32 v96, v16, v20
    v_max3_f32 v96, v96, v24, v28
    v_sub_f32 v16, v16, v96
    v_sub_f32 v20, v20, v96
    v_sub_f32 v24, v24, v96
    v_sub_f32 v28, v28, v96
    v_exp_f32 v16, v16
    v_exp_f32 v20, v20
    v_exp_f32 v24, v24
    v_exp_f32 v28, v28
    v_mov_b32 v83, v10
    v_mov_b32 v87, v10
    v_mov_b32 v91, v10
    v_mov_b32 v95, v10
    v_mov_b32 v99, v10
    v_mul_f32 v97, v16, v17
    v_mul_f32 v98, v16, v18
    v_fmac_f32 v97, v20, v21
    v_fmac_f32 v98, v20, v22
    v_fmac_f32 v97, v24, v25
    v_fmac_f32 v98, v24, v26
    v_fmac_f32 v97, v28, v29
    v_fmac_f32 v98, v28, v30
    s_waitcnt lgkmcnt(9)
    v_fma_f32 v80, v32, v16, -v98
    v_fma_f32 v81, v33, v16, -v98
    v_fma_f32 v82, v34, v16, -v98
    v_fma_f32 v84, v35, v16, -v98
    v_fma_f32 v85, v36, v16, -v98
    v_fma_f32 v86, v37, v16, -v98
    v_fma_f32 v88, v38, v16, -v98
    v_fma_f32 v89, v39, v16, -v98
    v_fma_f32 v90, v40, v16, -v98
    v_fma_f32 v92, v41, v16, -v98
    v_fma_f32 v93, v42, v16, -v98
    v_fma_f32 v94, v43, v16, -v98
    s_waitcnt lgkmcnt(6)
    v_fmac_f32 v80, v44, v20
    v_fmac_f32 v81, v45, v20
    v_fmac_f32 v82, v46, v20
    v_fmac_f32 v84, v47, v20
    v_fmac_f32 v85, v48, v20
    v_fmac_f32 v86, v49, v20
    v_fmac_f32 v88, v50, v20
    v_fmac_f32 v89, v51, v20
    v_fmac_f32 v90, v52, v20
    v_fmac_f32 v92, v53, v20
    v_fmac_f32 v93, v54, v20
    v_fmac_f32 v94, v55, v20
    s_waitcnt lgkmcnt(3)
    v_fmac_f32 v80, v56, v24
    v_fmac_f32 v81, v57, v24
    v_fmac_f32 v82, v58, v24
    v_fmac_f32 v84, v59, v24
    v_fmac_f32 v85, v60, v24
    v_fmac_f32 v86, v61, v24
    v_fmac_f32 v88, v62, v24
    v_fmac_f32 v89, v63, v24
    v_fmac_f32 v90, v64, v24
    v_fmac_f32 v92, v65, v24
    v_fmac_f32 v93, v66, v24
    v_fmac_f32 v94, v67, v24
    s_waitcnt lgkmcnt(0)
    v_fmac_f32 v80, v68, v28
    v_fmac_f32 v81, v69, v28
    v_fmac_f32 v82, v70, v28
    v_fmac_f32 v84, v71, v28
    v_fmac_f32 v85, v72, v28
    v_fmac_f32 v86, v73, v28
    v_fmac_f32 v88, v74, v28
    v_fmac_f32 v89, v75, v28
    v_fmac_f32 v90, v76, v28
    v_fmac_f32 v92, v77, v28
    v_fmac_f32 v93, v78, v28
    v_fmac_f32 v94, v79, v28
    v_max_f32 v11, v96, v96
    v_sub_f32 v16, v96, v11
    v_exp_f32 v16, v16
    v_lshrrev_b32 v13, 1, v8
    v_mul_f32 v12, v16, v97
    v_rcp_f32 v12, v12
    s_add_u32 s58, s63, 0
    s_mul_i32 s58, s58, 1536
    v_mul_f32 v16, v16, v12
    v_mul_f32 v32, v80, v16
    v_mul_f32 v33, v81, v16
    v_mul_f32 v34, v82, v16
    v_mul_f32 v35, v84, v16
    v_mul_f32 v36, v85, v16
    v_mul_f32 v37, v86, v16
    v_mul_f32 v38, v88, v16
    v_mul_f32 v39, v89, v16
    v_mul_f32 v40, v90, v16
    v_mul_f32 v41, v92, v16
    v_mul_f32 v42, v93, v16
    v_mul_f32 v43, v94, v16
    v_cvt_pk_bf16_f32 v44, v32, v33
    v_cvt_pk_bf16_f32 v45, v34, v35
    v_cvt_pk_bf16_f32 v46, v36, v37
    v_cvt_pk_bf16_f32 v47, v38, v39
    v_cvt_pk_bf16_f32 v48, v40, v41
    v_cvt_pk_bf16_f32 v49, v42, v43
    buffer_store_dwordx2 v[44:45], v13, s[48:51], s58 offen offset:0
    buffer_store_dwordx2 v[46:47], v13, s[48:51], s58 offen offset:128
    buffer_store_dwordx2 v[48:49], v13, s[48:51], s58 offen offset:256
L_fin:
L_end:
    s_endpgm
.section .rodata,"a"
.p2align 6
.amdhsa_kernel standalone__kv_cache_quant_int4_int2_kv_with_per_channel_or_per_token_scales__sampling_kernel
  .amdhsa_next_free_vgpr 224
  .amdhsa_next_free_sgpr 102
  .amdhsa_accum_offset 224
  .amdhsa_group_segment_fixed_size 0
  .amdhsa_kernarg_size 80
  .amdhsa_user_sgpr_count 2
  .amdhsa_user_sgpr_kernarg_segment_ptr 1
  .amdhsa_system_sgpr_workgroup_id_x 1
  .amdhsa_float_denorm_mode_32 3
.end_amdhsa_kernel
```

```asm
; @launch grid=(256,1,1) block=(448,1,1) lds=154944
.amdgcn_target "amdgcn-amd-amdhsa--gfx950"
.text
.globl standalone__kv_cache_quant_int4_int2_kv_with_per_channel_or_per_token_scales__sampling_kernel
.p2align 8
.type standalone__kv_cache_quant_int4_int2_kv_with_per_channel_or_per_token_scales__sampling_kernel,@function
standalone__kv_cache_quant_int4_int2_kv_with_per_channel_or_per_token_scales__sampling_kernel:
    s_cmp_ge_u32 s2, 256
    s_cbranch_scc1 L_end
    s_load_dwordx16 s[4:19], s[0:1], 0
    s_load_dwordx4 s[20:23], s[0:1], 64
    v_lshrrev_b32 v2, 6, v0
    v_and_b32 v1, 63, v0
    v_readfirstlane_b32 s56, v2
    s_mov_b32 s67, 768
    s_mul_i32 s100, s2, 43691
    s_lshr_b32 s100, s100, 17
    s_mul_i32 s101, s100, 3
    s_sub_u32 s101, s2, s101
    s_cmp_eq_u32 s2, 255
    s_cselect_b32 s73, 16, 11
    s_cmp_eq_u32 s101, 1
    s_cselect_b32 s3, 5, s73
    s_cselect_b32 s73, 10, s73
    s_mul_i32 s58, s101, 21
    s_add_u32 s58, s58, 1
    s_lshr_b32 s58, s58, 1
    s_lshl_b32 s59, s100, 5
    s_add_u32 s57, s58, s59
    s_mul_i32 s58, s101, 11
    s_lshr_b32 s58, s58, 1
    s_lshl_b32 s59, s100, 4
    s_add_u32 s58, s58, s59
    s_add_u32 s58, s58, 2736
    s_sub_u32 s58, s58, s73
    v_cmp_le_u32 vcc, s73, v1
    v_add_u32 v3, s57, v1
    v_add_u32 v4, s58, v1
    v_cndmask_b32 v152, v3, v4, vcc
    s_cmp_eq_u32 s56, 4
    s_cbranch_scc0 L_roles
    s_setprio 3
    v_bfe_u32 v8, v1, 2, 1
    v_bfe_u32 v9, v1, 3, 1
    v_lshrrev_b32 v13, 4, v1
    v_and_b32 v14, 3, v1
    v_lshl_add_u32 v10, v13, 2, v14
    v_mul_u32_u24 v13, 33024, v9
    v_lshl_add_u32 v10, v10, 4, v13
    v_add_u32 v17, 43, v8
    v_sub_u32 v9, 43, v9
    v_mad_u32_u24 v11, v8, s67, v10
    s_mov_b32 s68, 0
    s_mov_b32 m0, 0
    s_movk_i32 s71, 1536
    s_mul_i32 s57, s57, 196608
    s_mov_b32 s70, 18
    s_mov_b32 s74, 0
    v_mov_b32 v15, 4736
    v_mov_b32 v16, 154880
    ds_write_b32 v16, v15
    s_waitcnt lgkmcnt(0)
    s_mov_b32 s24, s6
    s_and_b32 s25, s7, 0xffff
    s_mov_b32 s26, 805306368
    s_mov_b32 s27, 0x20000
L_lw16:
    s_waitcnt vmcnt(16)
L_lw17:
    s_waitcnt vmcnt(17)
L_lw18:
    s_waitcnt vmcnt(18)
L_lw19:
    s_waitcnt vmcnt(19)
L_lw20:
    s_waitcnt vmcnt(20)
L_lw21:
    s_waitcnt vmcnt(21)
    buffer_load_dwordx4 v11, s[24:27], s57 offen nt lds
    s_add_u32 m0, m0, s67
    s_add_u32 s68, s68, 1
    s_and_b32 s58, s68, 63
    v_lshl_add_u32 v12, s58, 1, v8
    v_cmp_le_u32 vcc, 43, v12
    buffer_load_dwordx4 v11, s[24:27], s57 offen offset:256 nt lds
    s_add_u32 m0, m0, s67
    v_cndmask_b32 v13, v8, v17, vcc
    v_cmp_le_u32 vcc, 86, v12
    v_add_u32 v14, v13, v9
    buffer_load_dwordx4 v11, s[24:27], s57 offen offset:512 nt lds
    s_add_u32 m0, m0, s71
    s_add_u32 s57, s57, s71
    v_cndmask_b32 v13, v13, v14, vcc
    v_mad_u32_u24 v11, v13, s67, v10
    s_and_b32 s59, s68, 7
    s_cbranch_scc0 L_lunit
L_lad:
    s_cmp_eq_u32 s70, 21
    s_cbranch_scc1 L_lw21
    s_cmp_eq_u32 s70, 20
    s_cbranch_scc1 L_lw20
    s_cmp_eq_u32 s70, 19
    s_cbranch_scc1 L_lw19
    s_cmp_eq_u32 s70, 18
    s_cbranch_scc1 L_lw18
    s_cmp_eq_u32 s70, 17
    s_cbranch_scc1 L_lw17
    s_branch L_lw16
L_lunit:
    s_cmp_le_u32 s68, 16
    s_cbranch_scc1 L_lfirst
L_lbar:
    s_barrier
L_lnobar:
    s_waitcnt lgkmcnt(0)
    v_readfirstlane_b32 s59, v15
    ds_read_b32 v15, v16
    s_cmp_eq_u32 m0, 73728
    s_cselect_b32 m0, 0, m0
    s_and_b32 s74, s74, 255
    s_add_u32 s74, s74, s59
    s_lshr_b32 s70, s74, 8
    s_cmp_eq_u32 s58, 0
    s_cbranch_scc0 L_lad
L_lblock:
    s_bfe_u32 s58, s68, 262150
    v_readlane_b32 s57, v152, s58
    s_nop 3
    s_mul_i32 s57, s57, 196608
    s_cmp_eq_u32 s58, 0
    s_cbranch_scc0 L_lad
    s_cmp_eq_u32 s68, 2048
    s_cbranch_scc1 L_ldone
    s_mov_b32 s24, s8
    s_and_b32 s25, s9, 0xffff
    v_bfe_u32 v8, v1, 4, 1
    v_lshrrev_b32 v9, 5, v1
    v_and_b32 v10, 15, v1
    v_mul_u32_u24 v13, 33024, v9
    v_lshl_add_u32 v10, v10, 4, v13
    v_add_u32 v17, 43, v8
    v_sub_u32 v9, 43, v9
    v_mad_u32_u24 v11, v8, s67, v10
    s_branch L_lad
L_lfirst:
    s_cmp_eq_u32 s68, 8
    s_cbranch_scc1 L_lnobar
    s_barrier
    s_branch L_lbar
L_ldone:
    s_waitcnt vmcnt(0)
    s_barrier
    s_endpgm
L_roles:
    s_cmp_lt_u32 s56, 4
    s_cbranch_scc1 L_consumer
    s_cmp_eq_u32 s56, 5
    s_cbranch_scc1 L_finisher
    s_sub_u32 s58, s2, 8
    s_cmp_lt_u32 s58, 8
    s_cbranch_scc0 L_pw
    s_getpc_b64 s[44:45]
L_pc:
    s_and_b32 s45, s45, 0xffff
    s_mov_b32 s46, L_end - L_pc
    s_mov_b32 s47, 0x20000
    v_lshlrev_b32 v9, 7, v1
    s_movk_i32 s58, 0
    buffer_load_dword v12, v9, s[44:47], s58 offen
    s_movk_i32 s58, 8192
    buffer_load_dword v13, v9, s[44:47], s58 offen
    s_movk_i32 s58, 16384
    buffer_load_dword v14, v9, s[44:47], s58 offen
    s_movk_i32 s58, 24576
    buffer_load_dword v15, v9, s[44:47], s58 offen
L_pw:
    s_waitcnt lgkmcnt(0)
    s_mov_b32 s52, s22
    s_and_b32 s53, s23, 0xffff
    s_mov_b32 s54, 16793856
    s_mov_b32 s55, 0x20000
    s_mov_b32 s71, 0
    s_add_u32 s98, s22, 16777216
    s_addc_u32 s99, s23, 0
    s_lshl_b32 s59, s2, 2
    s_add_u32 s59, s59, 16777216
    v_mov_b32 v8, s59
    v_mov_b32 v10, 154880
    s_mov_b32 s96, 0
    s_mov_b64 exec, 1
    s_barrier
    s_mov_b32 s63, 0
L_pace:
    s_barrier
    s_mov_b32 s62, s96
    s_memrealtime s[96:97]
    s_waitcnt lgkmcnt(0)
    s_cmp_eq_u32 s63, 0
    s_cbranch_scc1 L_pnext
    s_mov_b32 s58, 0
    s_sub_i32 s59, s84, s62
    s_add_i32 s60, s59, 5000
    s_cmp_lt_u32 s60, 10000
    s_cselect_b32 s59, s59, 200
    s_add_i32 s58, s58, s59
    s_sub_i32 s59, s85, s62
    s_add_i32 s60, s59, 5000
    s_cmp_lt_u32 s60, 10000
    s_cselect_b32 s59, s59, 200
    s_add_i32 s58, s58, s59
    s_sub_i32 s59, s86, s62
    s_add_i32 s60, s59, 5000
    s_cmp_lt_u32 s60, 10000
    s_cselect_b32 s59, s59, 200
    s_add_i32 s58, s58, s59
    s_sub_i32 s59, s87, s62
    s_add_i32 s60, s59, 5000
    s_cmp_lt_u32 s60, 10000
    s_cselect_b32 s59, s59, 200
    s_add_i32 s58, s58, s59
    s_sub_i32 s59, s88, s62
    s_add_i32 s60, s59, 5000
    s_cmp_lt_u32 s60, 10000
    s_cselect_b32 s59, s59, 200
    s_add_i32 s58, s58, s59
    s_sub_i32 s59, s89, s62
    s_add_i32 s60, s59, 5000
    s_cmp_lt_u32 s60, 10000
    s_cselect_b32 s59, s59, 200
    s_add_i32 s58, s58, s59
    s_sub_i32 s59, s90, s62
    s_add_i32 s60, s59, 5000
    s_cmp_lt_u32 s60, 10000
    s_cselect_b32 s59, s59, 200
    s_add_i32 s58, s58, s59
    s_sub_i32 s59, s91, s62
    s_add_i32 s60, s59, 5000
    s_cmp_lt_u32 s60, 10000
    s_cselect_b32 s59, s59, 200
    s_add_i32 s58, s58, s59
    s_mul_i32 s58, s58, s63
    s_ashr_i32 s58, s58, 5
    s_sub_i32 s58, 4736, s58
    s_max_i32 s58, s58, 4096
    s_min_i32 s70, s58, 5376
    v_mov_b32 v9, s70
    ds_write_b32 v10, v9
L_pnext:
    s_and_b32 s58, s71, 256
    s_cselect_b32 s63, 0, 6
    s_cmp_ge_u32 s71, 14848
    s_cselect_b32 s63, 24, s63
    s_cmp_eq_u32 s63, 0
    s_cselect_b32 s58, 8, s2
    s_cmp_lt_u32 s58, 8
    s_cbranch_scc0 L_pnorep
    v_mov_b32 v11, s96
    buffer_store_dword v11, v8, s[52:55], s71 offen sc1
L_pnorep:
    s_barrier
    s_barrier
    s_barrier
    s_cmp_eq_u32 s63, 0
    s_cbranch_scc1 L_pnold
    s_load_dwordx8 s[84:91], s[98:99], s71
L_pnold:
    s_add_u32 s71, s71, 256
    s_cmp_lt_u32 s71, 16384
    s_cbranch_scc1 L_pace
    s_waitcnt lgkmcnt(0)
    s_mov_b64 exec, -1
    s_endpgm
L_consumer:
    v_lshrrev_b32 v3, 2, v1
    v_lshlrev_b32 v3, 3, v3
    v_and_b32 v4, 3, v1
    v_mul_u32_u24 v5, 384, v4
    v_add_u32 v15, v3, v5
    v_lshlrev_b32 v13, 4, v1
    s_mul_i32 s63, s56, 3072
    s_add_u32 s63, s63, 76800
    s_add_u32 s58, s56, 0
    v_readlane_b32 s84, v152, s58
    s_add_u32 s58, s56, 4
    v_readlane_b32 s85, v152, s58
    s_add_u32 s58, s56, 8
    v_readlane_b32 s86, v152, s58
    s_add_u32 s58, s56, 12
    v_readlane_b32 s87, v152, s58
    v_readlane_b32 s88, v152, 0
    s_min_u32 s58, s3, 15
    v_readlane_b32 s89, v152, s58
    v_readlane_b32 s90, v152, 15
    s_waitcnt lgkmcnt(0)
    s_mov_b32 s32, s12
    s_and_b32 s33, s13, 0xffff
    s_mov_b32 s34, 6291456
    s_mov_b32 s35, 0x20000
    s_mov_b32 s28, s10
    s_and_b32 s29, s11, 0xffff
    s_mov_b32 s30, 6291456
    s_mov_b32 s31, 0x20000
    s_mov_b32 exec_hi, 0xffff
    s_add_u32 m0, s63, 0
    s_mul_i32 s58, s84, 1536
    buffer_load_dwordx4 v13, s[32:35], s58 offen nt lds
    buffer_load_dwordx4 v13, s[32:35], s58 offen offset:768 nt lds
    s_add_u32 m0, m0, 1536
    s_nop 0
    buffer_load_dwordx4 v13, s[28:31], s58 offen nt lds
    buffer_load_dwordx4 v13, s[28:31], s58 offen offset:768 nt lds
    s_mov_b32 exec_hi, -1
    s_mov_b32 s44, s4
    s_and_b32 s45, s5, 0xffff
    s_mov_b32 s46, 393216
    s_mov_b32 s47, 0x20000
    s_lshr_b32 s58, s88, 4
    s_mul_i32 s58, s58, 1536
    buffer_load_dwordx2 v[156:157], v15, s[44:47], s58 offen offset:0 nt
    buffer_load_dwordx2 v[158:159], v15, s[44:47], s58 offen offset:128 nt
    buffer_load_dwordx2 v[160:161], v15, s[44:47], s58 offen offset:256 nt
    s_mov_b32 s64, 0x3fb8aa3b
    s_mov_b32 s65, 0x3d93cd3a
    s_mov_b32 s66, 0xffff0000
    v_bfe_u32 v36, v1, 2, 1
    v_lshl_add_u32 v36, v2, 2, v36
    v_bfe_u32 v37, v1, 3, 1
    v_lshrrev_b32 v38, 4, v1
    v_lshl_add_u32 v38, v38, 2, v4
    v_lshlrev_b32 v38, 3, v38
    v_add_u32 v38, 73728, v38
    s_movk_i32 s58, 384
    v_add_u32 v3, 0, v36
    v_cmp_le_u32 vcc, 43, v3
    v_add_u32 v5, 43, v3
    v_mov_b32 v6, 42
    v_cndmask_b32 v17, v3, v5, vcc
    v_cmp_le_u32 vcc, 86, v3
    v_add_u32 v5, 43, v17
    s_nop 0
    v_cndmask_b32 v17, v17, v5, vcc
    v_cndmask_b32 v6, 43, v6, vcc
    v_mad_u32_u24 v17, v6, v37, v17
    v_lshrrev_b32 v17, 6, v17
    v_mad_u32_u24 v17, v17, s58, v38
    v_add_u32 v3, 2, v36
    v_cmp_le_u32 vcc, 43, v3
    v_add_u32 v5, 43, v3
    v_mov_b32 v6, 42
    v_cndmask_b32 v18, v3, v5, vcc
    v_cmp_le_u32 vcc, 86, v3
    v_add_u32 v5, 43, v18
    s_nop 0
    v_cndmask_b32 v18, v18, v5, vcc
    v_cndmask_b32 v6, 43, v6, vcc
    v_mad_u32_u24 v18, v6, v37, v18
    v_lshrrev_b32 v18, 6, v18
    v_mad_u32_u24 v18, v18, s58, v38
    v_add_u32 v3, 16, v36
    v_cmp_le_u32 vcc, 43, v3
    v_add_u32 v5, 43, v3
    v_mov_b32 v6, 42
    v_cndmask_b32 v19, v3, v5, vcc
    v_cmp_le_u32 vcc, 86, v3
    v_add_u32 v5, 43, v19
    s_nop 0
    v_cndmask_b32 v19, v19, v5, vcc
    v_cndmask_b32 v6, 43, v6, vcc
    v_mad_u32_u24 v19, v6, v37, v19
    v_lshrrev_b32 v19, 6, v19
    v_mad_u32_u24 v19, v19, s58, v38
    v_add_u32 v3, 18, v36
    v_cmp_le_u32 vcc, 43, v3
    v_add_u32 v5, 43, v3
    v_mov_b32 v6, 42
    v_cndmask_b32 v20, v3, v5, vcc
    v_cmp_le_u32 vcc, 86, v3
    v_add_u32 v5, 43, v20
    s_nop 0
    v_cndmask_b32 v20, v20, v5, vcc
    v_cndmask_b32 v6, 43, v6, vcc
    v_mad_u32_u24 v20, v6, v37, v20
    v_lshrrev_b32 v20, 6, v20
    v_mad_u32_u24 v20, v20, s58, v38
    v_add_u32 v3, 32, v36
    v_cmp_le_u32 vcc, 43, v3
    v_add_u32 v5, 43, v3
    v_mov_b32 v6, 42
    v_cndmask_b32 v21, v3, v5, vcc
    v_cmp_le_u32 vcc, 86, v3
    v_add_u32 v5, 43, v21
    s_nop 0
    v_cndmask_b32 v21, v21, v5, vcc
    v_cndmask_b32 v6, 43, v6, vcc
    v_mad_u32_u24 v21, v6, v37, v21
    v_lshrrev_b32 v21, 6, v21
    v_mad_u32_u24 v21, v21, s58, v38
    v_add_u32 v3, 34, v36
    v_cmp_le_u32 vcc, 43, v3
    v_add_u32 v5, 43, v3
    v_mov_b32 v6, 42
    v_cndmask_b32 v22, v3, v5, vcc
    v_cmp_le_u32 vcc, 86, v3
    v_add_u32 v5, 43, v22
    s_nop 0
    v_cndmask_b32 v22, v22, v5, vcc
    v_cndmask_b32 v6, 43, v6, vcc
    v_mad_u32_u24 v22, v6, v37, v22
    v_lshrrev_b32 v22, 6, v22
    v_mad_u32_u24 v22, v22, s58, v38
    v_add_u32 v3, 48, v36
    v_cmp_le_u32 vcc, 43, v3
    v_add_u32 v5, 43, v3
    v_mov_b32 v6, 42
    v_cndmask_b32 v23, v3, v5, vcc
    v_cmp_le_u32 vcc, 86, v3
    v_add_u32 v5, 43, v23
    s_nop 0
    v_cndmask_b32 v23, v23, v5, vcc
    v_cndmask_b32 v6, 43, v6, vcc
    v_mad_u32_u24 v23, v6, v37, v23
    v_lshrrev_b32 v23, 6, v23
    v_mad_u32_u24 v23, v23, s58, v38
    v_add_u32 v3, 50, v36
    v_cmp_le_u32 vcc, 43, v3
    v_add_u32 v5, 43, v3
    v_mov_b32 v6, 42
    v_cndmask_b32 v24, v3, v5, vcc
    v_cmp_le_u32 vcc, 86, v3
    v_add_u32 v5, 43, v24
    s_nop 0
    v_cndmask_b32 v24, v24, v5, vcc
    v_cndmask_b32 v6, 43, v6, vcc
    v_mad_u32_u24 v24, v6, v37, v24
    v_lshrrev_b32 v24, 6, v24
    v_mad_u32_u24 v24, v24, s58, v38
    v_add_u32 v3, 64, v36
    v_cmp_le_u32 vcc, 43, v3
    v_add_u32 v5, 43, v3
    v_mov_b32 v6, 42
    v_cndmask_b32 v25, v3, v5, vcc
    v_cmp_le_u32 vcc, 86, v3
    v_add_u32 v5, 43, v25
    s_nop 0
    v_cndmask_b32 v25, v25, v5, vcc
    v_cndmask_b32 v6, 43, v6, vcc
    v_mad_u32_u24 v25, v6, v37, v25
    v_lshrrev_b32 v25, 6, v25
    v_mad_u32_u24 v25, v25, s58, v38
    v_add_u32 v3, 66, v36
    v_cmp_le_u32 vcc, 43, v3
    v_add_u32 v5, 43, v3
    v_mov_b32 v6, 42
    v_cndmask_b32 v26, v3, v5, vcc
    v_cmp_le_u32 vcc, 86, v3
    v_add_u32 v5, 43, v26
    s_nop 0
    v_cndmask_b32 v26, v26, v5, vcc
    v_cndmask_b32 v6, 43, v6, vcc
    v_mad_u32_u24 v26, v6, v37, v26
    v_lshrrev_b32 v26, 6, v26
    v_mad_u32_u24 v26, v26, s58, v38
    v_add_u32 v3, 80, v36
    v_cmp_le_u32 vcc, 43, v3
    v_add_u32 v5, 43, v3
    v_mov_b32 v6, 42
    v_cndmask_b32 v27, v3, v5, vcc
    v_cmp_le_u32 vcc, 86, v3
    v_add_u32 v5, 43, v27
    s_nop 0
    v_cndmask_b32 v27, v27, v5, vcc
    v_cndmask_b32 v6, 43, v6, vcc
    v_mad_u32_u24 v27, v6, v37, v27
    v_lshrrev_b32 v27, 6, v27
    v_mad_u32_u24 v27, v27, s58, v38
    v_add_u32 v3, 82, v36
    v_cmp_le_u32 vcc, 43, v3
    v_add_u32 v5, 43, v3
    v_mov_b32 v6, 42
    v_cndmask_b32 v28, v3, v5, vcc
    v_cmp_le_u32 vcc, 86, v3
    v_add_u32 v5, 43, v28
    s_nop 0
    v_cndmask_b32 v28, v28, v5, vcc
    v_cndmask_b32 v6, 43, v6, vcc
    v_mad_u32_u24 v28, v6, v37, v28
    v_lshrrev_b32 v28, 6, v28
    v_mad_u32_u24 v28, v28, s58, v38
    v_add_u32 v3, 96, v36
    v_cmp_le_u32 vcc, 43, v3
    v_add_u32 v5, 43, v3
    v_mov_b32 v6, 42
    v_cndmask_b32 v29, v3, v5, vcc
    v_cmp_le_u32 vcc, 86, v3
    v_add_u32 v5, 43, v29
    s_nop 0
    v_cndmask_b32 v29, v29, v5, vcc
    v_cndmask_b32 v6, 43, v6, vcc
    v_mad_u32_u24 v29, v6, v37, v29
    v_lshrrev_b32 v29, 6, v29
    v_mad_u32_u24 v29, v29, s58, v38
    v_add_u32 v3, 98, v36
    v_cmp_le_u32 vcc, 43, v3
    v_add_u32 v5, 43, v3
    v_mov_b32 v6, 42
    v_cndmask_b32 v30, v3, v5, vcc
    v_cmp_le_u32 vcc, 86, v3
    v_add_u32 v5, 43, v30
    s_nop 0
    v_cndmask_b32 v30, v30, v5, vcc
    v_cndmask_b32 v6, 43, v6, vcc
    v_mad_u32_u24 v30, v6, v37, v30
    v_lshrrev_b32 v30, 6, v30
    v_mad_u32_u24 v30, v30, s58, v38
    v_add_u32 v3, 112, v36
    v_cmp_le_u32 vcc, 43, v3
    v_add_u32 v5, 43, v3
    v_mov_b32 v6, 42
    v_cndmask_b32 v31, v3, v5, vcc
    v_cmp_le_u32 vcc, 86, v3
    v_add_u32 v5, 43, v31
    s_nop 0
    v_cndmask_b32 v31, v31, v5, vcc
    v_cndmask_b32 v6, 43, v6, vcc
    v_mad_u32_u24 v31, v6, v37, v31
    v_lshrrev_b32 v31, 6, v31
    v_mad_u32_u24 v31, v31, s58, v38
    v_add_u32 v3, 114, v36
    v_cmp_le_u32 vcc, 43, v3
    v_add_u32 v5, 43, v3
    v_mov_b32 v6, 42
    v_cndmask_b32 v32, v3, v5, vcc
    v_cmp_le_u32 vcc, 86, v3
    v_add_u32 v5, 43, v32
    s_nop 0
    v_cndmask_b32 v32, v32, v5, vcc
    v_cndmask_b32 v6, 43, v6, vcc
    v_mad_u32_u24 v32, v6, v37, v32
    v_lshrrev_b32 v32, 6, v32
    v_mad_u32_u24 v32, v32, s58, v38
    v_bfe_u32 v36, v1, 4, 1
    v_lshl_add_u32 v36, v2, 2, v36
    v_bfe_u32 v3, v1, 2, 2
    v_lshl_add_u32 v36, v3, 4, v36
    v_lshrrev_b32 v37, 5, v1
    s_mov_b32 s58, 125952
    v_add_u32 v3, 0, v36
    v_cmp_le_u32 vcc, 43, v3
    v_add_u32 v5, 43, v3
    v_mov_b32 v6, 42
    v_cndmask_b32 v7, v3, v5, vcc
    v_cmp_le_u32 vcc, 86, v3
    v_add_u32 v5, 43, v7
    s_nop 0
    v_cndmask_b32 v7, v7, v5, vcc
    v_cndmask_b32 v6, 43, v6, vcc
    v_mad_u32_u24 v7, v6, v37, v7
    v_lshl_add_u32 v7, v7, 1, s58
    v_add_u32 v3, 2, v36
    v_cmp_le_u32 vcc, 43, v3
    v_add_u32 v5, 43, v3
    v_mov_b32 v6, 42
    v_cndmask_b32 v8, v3, v5, vcc
    v_cmp_le_u32 vcc, 86, v3
    v_add_u32 v5, 43, v8
    s_nop 0
    v_cndmask_b32 v8, v8, v5, vcc
    v_cndmask_b32 v6, 43, v6, vcc
    v_mad_u32_u24 v8, v6, v37, v8
    v_lshl_add_u32 v8, v8, 1, s58
    v_add_u32 v3, 64, v36
    v_cmp_le_u32 vcc, 43, v3
    v_add_u32 v5, 43, v3
    v_mov_b32 v6, 42
    v_cndmask_b32 v9, v3, v5, vcc
    v_cmp_le_u32 vcc, 86, v3
    v_add_u32 v5, 43, v9
    s_nop 0
    v_cndmask_b32 v9, v9, v5, vcc
    v_cndmask_b32 v6, 43, v6, vcc
    v_mad_u32_u24 v9, v6, v37, v9
    v_lshl_add_u32 v9, v9, 1, s58
    v_add_u32 v3, 66, v36
    v_cmp_le_u32 vcc, 43, v3
    v_add_u32 v5, 43, v3
    v_mov_b32 v6, 42
    v_cndmask_b32 v10, v3, v5, vcc
    v_cmp_le_u32 vcc, 86, v3
    v_add_u32 v5, 43, v10
    s_nop 0
    v_cndmask_b32 v10, v10, v5, vcc
    v_cndmask_b32 v6, 43, v6, vcc
    v_mad_u32_u24 v10, v6, v37, v10
    v_lshl_add_u32 v10, v10, 1, s58
    v_lshlrev_b32 v11, 2, v1
    v_lshl_add_u32 v11, v2, 9, v11
    v_add_u32 v11, 73728, v11
    v_mul_u32_u24 v12, 6144, v2
    v_lshl_add_u32 v12, v1, 4, v12
    v_mov_b32 v14, 0xff800000
    s_mov_b32 exec_hi, 0xffff
    s_add_u32 m0, s63, 12288
    s_mul_i32 s58, s85, 1536
    buffer_load_dwordx4 v13, s[32:35], s58 offen nt lds
    buffer_load_dwordx4 v13, s[32:35], s58 offen offset:768 nt lds
    s_add_u32 m0, m0, 1536
    s_nop 0
    buffer_load_dwordx4 v13, s[28:31], s58 offen nt lds
    buffer_load_dwordx4 v13, s[28:31], s58 offen offset:768 nt lds
    s_add_u32 m0, s63, 24576
    s_mul_i32 s58, s86, 1536
    buffer_load_dwordx4 v13, s[32:35], s58 offen nt lds
    buffer_load_dwordx4 v13, s[32:35], s58 offen offset:768 nt lds
    s_add_u32 m0, m0, 1536
    s_nop 0
    buffer_load_dwordx4 v13, s[28:31], s58 offen nt lds
    buffer_load_dwordx4 v13, s[28:31], s58 offen offset:768 nt lds
    s_add_u32 m0, s63, 36864
    s_mul_i32 s58, s87, 1536
    buffer_load_dwordx4 v13, s[32:35], s58 offen nt lds
    buffer_load_dwordx4 v13, s[32:35], s58 offen offset:768 nt lds
    s_add_u32 m0, m0, 1536
    s_nop 0
    buffer_load_dwordx4 v13, s[28:31], s58 offen nt lds
    buffer_load_dwordx4 v13, s[28:31], s58 offen offset:768 nt lds
    s_mov_b32 exec_hi, -1
    s_mov_b32 s36, s14
    s_and_b32 s37, s15, 0xffff
    s_mov_b32 s38, 2097152
    s_mov_b32 s39, 0x20000
    s_mov_b32 s40, s16
    s_and_b32 s41, s17, 0xffff
    s_mov_b32 s42, 2097152
    s_mov_b32 s43, 0x20000
    s_mov_b32 exec_hi, 0
    s_lshl_b32 s60, s56, 10
    s_add_u32 m0, s60, 125952
    s_lshl_b32 s58, s84, 9
    buffer_load_dwordx4 v13, s[36:39], s58 offen nt lds
    s_add_u32 m0, m0, 512
    s_nop 0
    buffer_load_dwordx4 v13, s[40:43], s58 offen nt lds
    s_add_u32 m0, s60, 130048
    s_lshl_b32 s58, s85, 9
    buffer_load_dwordx4 v13, s[36:39], s58 offen nt lds
    s_add_u32 m0, m0, 512
    s_nop 0
    buffer_load_dwordx4 v13, s[40:43], s58 offen nt lds
    s_add_u32 m0, s60, 134144
    s_lshl_b32 s58, s86, 9
    buffer_load_dwordx4 v13, s[36:39], s58 offen nt lds
    s_add_u32 m0, m0, 512
    s_nop 0
    buffer_load_dwordx4 v13, s[40:43], s58 offen nt lds
    s_add_u32 m0, s60, 138240
    s_lshl_b32 s58, s87, 9
    buffer_load_dwordx4 v13, s[36:39], s58 offen nt lds
    s_add_u32 m0, m0, 512
    s_nop 0
    buffer_load_dwordx4 v13, s[40:43], s58 offen nt lds
    s_mov_b32 exec_hi, -1
    s_lshr_b32 s58, s89, 4
    s_mul_i32 s58, s58, 1536
    buffer_load_dwordx2 v[162:163], v15, s[44:47], s58 offen offset:0 nt
    buffer_load_dwordx2 v[164:165], v15, s[44:47], s58 offen offset:128 nt
    buffer_load_dwordx2 v[166:167], v15, s[44:47], s58 offen offset:256 nt
    s_lshr_b32 s58, s90, 4
    s_mul_i32 s58, s58, 1536
    buffer_load_dwordx2 v[168:169], v15, s[44:47], s58 offen offset:0 nt
    buffer_load_dwordx2 v[170:171], v15, s[44:47], s58 offen offset:128 nt
    buffer_load_dwordx2 v[172:173], v15, s[44:47], s58 offen offset:256 nt
    s_mov_b32 s74, 0
    s_mov_b32 s61, 0
    s_mov_b32 s62, 0
    s_movk_i32 s63, 3072
    s_waitcnt vmcnt(26)
    s_barrier
    v_add_u32 v33, s63, v17
    v_add_u32 v34, s63, v18
    ds_read_b64 v[108:109], v33 offset:0
    ds_read_b64 v[110:111], v33 offset:1536
    ds_read_b64 v[112:113], v33 offset:128
    ds_read_b64 v[114:115], v33 offset:1664
    ds_read_b64 v[116:117], v33 offset:256
    ds_read_b64 v[118:119], v33 offset:1792
    ds_read_b64 v[120:121], v34 offset:0
    ds_read_b64 v[122:123], v34 offset:1536
    ds_read_b64 v[124:125], v34 offset:128
    ds_read_b64 v[126:127], v34 offset:1664
    ds_read_b64 v[128:129], v34 offset:256
    ds_read_b64 v[130:131], v34 offset:1792
    s_waitcnt lgkmcnt(0)
    v_lshlrev_b32 v60, 16, v108
    v_and_b32 v61, s66, v108
    v_lshlrev_b32 v62, 16, v109
    v_and_b32 v63, s66, v109
    v_lshlrev_b32 v84, 16, v110
    v_and_b32 v85, s66, v110
    v_lshlrev_b32 v86, 16, v111
    v_and_b32 v87, s66, v111
    v_lshlrev_b32 v64, 16, v112
    v_and_b32 v65, s66, v112
    v_lshlrev_b32 v66, 16, v113
    v_and_b32 v67, s66, v113
    v_lshlrev_b32 v88, 16, v114
    v_and_b32 v89, s66, v114
    v_lshlrev_b32 v90, 16, v115
    v_and_b32 v91, s66, v115
    v_lshlrev_b32 v68, 16, v116
    v_and_b32 v69, s66, v116
    v_lshlrev_b32 v70, 16, v117
    v_and_b32 v71, s66, v117
    v_lshlrev_b32 v92, 16, v118
    v_and_b32 v93, s66, v118
    v_lshlrev_b32 v94, 16, v119
    v_and_b32 v95, s66, v119
    v_lshlrev_b32 v72, 16, v120
    v_and_b32 v73, s66, v120
    v_lshlrev_b32 v74, 16, v121
    v_and_b32 v75, s66, v121
    v_lshlrev_b32 v96, 16, v122
    v_and_b32 v97, s66, v122
    v_lshlrev_b32 v98, 16, v123
    v_and_b32 v99, s66, v123
    v_lshlrev_b32 v76, 16, v124
    v_and_b32 v77, s66, v124
    v_lshlrev_b32 v78, 16, v125
    v_and_b32 v79, s66, v125
    v_lshlrev_b32 v100, 16, v126
    v_and_b32 v101, s66, v126
    v_lshlrev_b32 v102, 16, v127
    v_and_b32 v103, s66, v127
    v_lshlrev_b32 v80, 16, v128
    v_and_b32 v81, s66, v128
    v_lshlrev_b32 v82, 16, v129
    v_and_b32 v83, s66, v129
    v_lshlrev_b32 v104, 16, v130
    v_and_b32 v105, s66, v130
    v_lshlrev_b32 v106, 16, v131
    v_and_b32 v107, s66, v131
L_kblk:
    v_add_u32 v13, s62, v12
    s_add_u32 s62, s62, 24576
    s_cmp_eq_u32 s62, 73728
    s_cselect_b32 s62, 0, s62
    s_barrier
    ds_read_b128 v[36:39], v13 offset:0
    ds_read_b128 v[40:43], v13 offset:1024
    ds_read_b128 v[44:47], v13 offset:2048
    ds_read_b128 v[48:51], v13 offset:3072
    ds_read_b128 v[52:55], v13 offset:4096
    ds_read_b128 v[56:59], v13 offset:5120
    s_waitcnt lgkmcnt(3)
    v_cvt_f32_i32 v36, v36
    v_cvt_f32_i32 v37, v37
    v_cvt_f32_i32 v38, v38
    v_cvt_f32_i32 v39, v39
    v_cvt_f32_i32 v40, v40
    v_cvt_f32_i32 v41, v41
    v_cvt_f32_i32 v42, v42
    v_cvt_f32_i32 v43, v43
    v_cvt_f32_i32 v44, v44
    v_cvt_f32_i32 v45, v45
    v_cvt_f32_i32 v46, v46
    v_cvt_f32_i32 v47, v47
    v_sub_f32 v36, v36, v60
    v_sub_f32 v37, v37, v61
    v_sub_f32 v38, v38, v62
    v_sub_f32 v39, v39, v63
    v_sub_f32 v40, v40, v64
    v_sub_f32 v41, v41, v65
    v_sub_f32 v42, v42, v66
    v_sub_f32 v43, v43, v67
    v_sub_f32 v44, v44, v68
    v_sub_f32 v45, v45, v69
    v_sub_f32 v46, v46, v70
    v_sub_f32 v47, v47, v71
    v_cvt_pk_bf16_f32 v36, 0, v36
    v_cvt_pk_bf16_f32 v37, 0, v37
    v_cvt_pk_bf16_f32 v38, 0, v38
    v_cvt_pk_bf16_f32 v39, 0, v39
    v_cvt_pk_bf16_f32 v40, 0, v40
    v_cvt_pk_bf16_f32 v41, 0, v41
    v_cvt_pk_bf16_f32 v42, 0, v42
    v_cvt_pk_bf16_f32 v43, 0, v43
    v_cvt_pk_bf16_f32 v44, 0, v44
    v_cvt_pk_bf16_f32 v45, 0, v45
    v_cvt_pk_bf16_f32 v46, 0, v46
    v_cvt_pk_bf16_f32 v47, 0, v47
    v_mul_f32 v36, v36, v84
    v_mul_f32 v37, v37, v85
    v_mul_f32 v38, v38, v86
    v_mul_f32 v39, v39, v87
    v_mul_f32 v40, v40, v88
    v_mul_f32 v41, v41, v89
    v_mul_f32 v42, v42, v90
    v_mul_f32 v43, v43, v91
    v_mul_f32 v44, v44, v92
    v_mul_f32 v45, v45, v93
    v_mul_f32 v46, v46, v94
    v_mul_f32 v47, v47, v95
    v_cvt_pk_bf16_f32 v132, v36, v37
    v_cvt_pk_bf16_f32 v133, v38, v39
    v_cvt_pk_bf16_f32 v134, v40, v41
    v_cvt_pk_bf16_f32 v135, v42, v43
    v_cvt_pk_bf16_f32 v136, v44, v45
    v_cvt_pk_bf16_f32 v137, v46, v47
    v_mfma_f32_16x16x16_bf16 v[144:147], v[132:133], v[156:157], 0
    v_mfma_f32_16x16x16_bf16 v[144:147], v[134:135], v[158:159], v[144:147]
    v_mfma_f32_16x16x16_bf16 v[144:147], v[136:137], v[160:161], v[144:147]
    s_waitcnt lgkmcnt(0)
    v_cvt_f32_i32 v48, v48
    v_cvt_f32_i32 v49, v49
    v_cvt_f32_i32 v50, v50
    v_cvt_f32_i32 v51, v51
    v_cvt_f32_i32 v52, v52
    v_cvt_f32_i32 v53, v53
    v_cvt_f32_i32 v54, v54
    v_cvt_f32_i32 v55, v55
    v_cvt_f32_i32 v56, v56
    v_cvt_f32_i32 v57, v57
    v_cvt_f32_i32 v58, v58
    v_cvt_f32_i32 v59, v59
    v_sub_f32 v48, v48, v72
    v_sub_f32 v49, v49, v73
    v_sub_f32 v50, v50, v74
    v_sub_f32 v51, v51, v75
    v_sub_f32 v52, v52, v76
    v_sub_f32 v53, v53, v77
    v_sub_f32 v54, v54, v78
    v_sub_f32 v55, v55, v79
    v_sub_f32 v56, v56, v80
    v_sub_f32 v57, v57, v81
    v_sub_f32 v58, v58, v82
    v_sub_f32 v59, v59, v83
    v_cvt_pk_bf16_f32 v48, 0, v48
    v_cvt_pk_bf16_f32 v49, 0, v49
    v_cvt_pk_bf16_f32 v50, 0, v50
    v_cvt_pk_bf16_f32 v51, 0, v51
    v_cvt_pk_bf16_f32 v52, 0, v52
    v_cvt_pk_bf16_f32 v53, 0, v53
    v_cvt_pk_bf16_f32 v54, 0, v54
    v_cvt_pk_bf16_f32 v55, 0, v55
    v_cvt_pk_bf16_f32 v56, 0, v56
    v_cvt_pk_bf16_f32 v57, 0, v57
    v_cvt_pk_bf16_f32 v58, 0, v58
    v_cvt_pk_bf16_f32 v59, 0, v59
    v_mul_f32 v48, v48, v96
    v_mul_f32 v49, v49, v97
    v_mul_f32 v50, v50, v98
    v_mul_f32 v51, v51, v99
    v_mul_f32 v52, v52, v100
    v_mul_f32 v53, v53, v101
    v_mul_f32 v54, v54, v102
    v_mul_f32 v55, v55, v103
    v_mul_f32 v56, v56, v104
    v_mul_f32 v57, v57, v105
    v_mul_f32 v58, v58, v106
    v_mul_f32 v59, v59, v107
    v_cvt_pk_bf16_f32 v138, v48, v49
    v_cvt_pk_bf16_f32 v139, v50, v51
    v_add_f32_dpp v3, v145, v144 row_ror:12 row_mask:0xf bank_mask:0xf
    v_cvt_pk_bf16_f32 v140, v52, v53
    v_cvt_pk_bf16_f32 v141, v54, v55
    v_add_f32_dpp v3, v146, v3 row_ror:8 row_mask:0xf bank_mask:0xf
    v_cvt_pk_bf16_f32 v142, v56, v57
    v_cvt_pk_bf16_f32 v143, v58, v59
    v_add_f32_dpp v15, v147, v3 row_ror:4 row_mask:0xf bank_mask:0x1
    v_mfma_f32_16x16x16_bf16 v[148:151], v[138:139], v[156:157], 0
    v_mfma_f32_16x16x16_bf16 v[148:151], v[140:141], v[158:159], v[148:151]
    v_mfma_f32_16x16x16_bf16 v[148:151], v[142:143], v[160:161], v[148:151]
    v_add_u32 v33, s63, v19
    v_add_u32 v34, s63, v20
    ds_read_b64 v[108:109], v33 offset:0
    ds_read_b64 v[110:111], v33 offset:1536
    ds_read_b64 v[112:113], v33 offset:128
    ds_read_b64 v[114:115], v33 offset:1664
    ds_read_b64 v[116:117], v33 offset:256
    ds_read_b64 v[118:119], v33 offset:1792
    ds_read_b64 v[120:121], v34 offset:0
    v_add_f32_dpp v4, v149, v148 row_ror:12 row_mask:0xf bank_mask:0xf
    ds_read_b64 v[122:123], v34 offset:1536
    ds_read_b64 v[124:125], v34 offset:128
    v_add_f32_dpp v4, v150, v4 row_ror:8 row_mask:0xf bank_mask:0xf
    ds_read_b64 v[126:127], v34 offset:1664
    ds_read_b64 v[128:129], v34 offset:256
    ds_read_b64 v[130:131], v34 offset:1792
    v_add_f32_dpp v16, v151, v4 row_ror:4 row_mask:0xf bank_mask:0x1
    s_waitcnt lgkmcnt(0)
    v_lshlrev_b32 v60, 16, v108
    v_and_b32 v61, s66, v108
    v_lshlrev_b32 v62, 16, v109
    v_and_b32 v63, s66, v109
    v_lshlrev_b32 v84, 16, v110
    v_and_b32 v85, s66, v110
    v_lshlrev_b32 v86, 16, v111
    v_and_b32 v87, s66, v111
    v_lshlrev_b32 v64, 16, v112
    v_and_b32 v65, s66, v112
    v_lshlrev_b32 v66, 16, v113
    v_and_b32 v67, s66, v113
    v_lshlrev_b32 v88, 16, v114
    v_and_b32 v89, s66, v114
    v_lshlrev_b32 v90, 16, v115
    v_and_b32 v91, s66, v115
    v_lshlrev_b32 v68, 16, v116
    v_and_b32 v69, s66, v116
    v_lshlrev_b32 v70, 16, v117
    v_and_b32 v71, s66, v117
    v_lshlrev_b32 v92, 16, v118
    v_and_b32 v93, s66, v118
    v_lshlrev_b32 v94, 16, v119
    v_and_b32 v95, s66, v119
    v_lshlrev_b32 v72, 16, v120
    v_and_b32 v73, s66, v120
    v_lshlrev_b32 v74, 16, v121
    v_and_b32 v75, s66, v121
    v_lshlrev_b32 v96, 16, v122
    v_and_b32 v97, s66, v122
    v_lshlrev_b32 v98, 16, v123
    v_and_b32 v99, s66, v123
    v_lshlrev_b32 v76, 16, v124
    v_and_b32 v77, s66, v124
    v_lshlrev_b32 v78, 16, v125
    v_and_b32 v79, s66, v125
    v_lshlrev_b32 v100, 16, v126
    v_and_b32 v101, s66, v126
    v_lshlrev_b32 v102, 16, v127
    v_and_b32 v103, s66, v127
    v_lshlrev_b32 v80, 16, v128
    v_and_b32 v81, s66, v128
    v_lshlrev_b32 v82, 16, v129
    v_and_b32 v83, s66, v129
    v_lshlrev_b32 v104, 16, v130
    v_and_b32 v105, s66, v130
    v_lshlrev_b32 v106, 16, v131
    v_and_b32 v107, s66, v131
    v_add_u32 v13, s62, v12
    s_add_u32 s62, s62, 24576
    s_cmp_eq_u32 s62, 73728
    s_cselect_b32 s62, 0, s62
    s_barrier
    ds_read_b128 v[36:39], v13 offset:0
    ds_read_b128 v[40:43], v13 offset:1024
    ds_read_b128 v[44:47], v13 offset:2048
    ds_read_b128 v[48:51], v13 offset:3072
    ds_read_b128 v[52:55], v13 offset:4096
    ds_read_b128 v[56:59], v13 offset:5120
    s_waitcnt lgkmcnt(3)
    v_cvt_f32_i32 v36, v36
    v_cvt_f32_i32 v37, v37
    v_cvt_f32_i32 v38, v38
    v_cvt_f32_i32 v39, v39
    v_cvt_f32_i32 v40, v40
    v_cvt_f32_i32 v41, v41
    v_cvt_f32_i32 v42, v42
    v_cvt_f32_i32 v43, v43
    v_cvt_f32_i32 v44, v44
    v_cvt_f32_i32 v45, v45
    v_cvt_f32_i32 v46, v46
    v_cvt_f32_i32 v47, v47
    v_sub_f32 v36, v36, v60
    v_sub_f32 v37, v37, v61
    v_sub_f32 v38, v38, v62
    v_sub_f32 v39, v39, v63
    v_sub_f32 v40, v40, v64
    v_sub_f32 v41, v41, v65
    v_sub_f32 v42, v42, v66
    v_sub_f32 v43, v43, v67
    v_sub_f32 v44, v44, v68
    v_sub_f32 v45, v45, v69
    v_sub_f32 v46, v46, v70
    v_sub_f32 v47, v47, v71
    v_cvt_pk_bf16_f32 v36, 0, v36
    v_cvt_pk_bf16_f32 v37, 0, v37
    v_cvt_pk_bf16_f32 v38, 0, v38
    v_cvt_pk_bf16_f32 v39, 0, v39
    v_cvt_pk_bf16_f32 v40, 0, v40
    v_cvt_pk_bf16_f32 v41, 0, v41
    v_cvt_pk_bf16_f32 v42, 0, v42
    v_cvt_pk_bf16_f32 v43, 0, v43
    v_cvt_pk_bf16_f32 v44, 0, v44
    v_cvt_pk_bf16_f32 v45, 0, v45
    v_cvt_pk_bf16_f32 v46, 0, v46
    v_cvt_pk_bf16_f32 v47, 0, v47
    v_mul_f32 v36, v36, v84
    v_mul_f32 v37, v37, v85
    v_mul_f32 v38, v38, v86
    v_mul_f32 v39, v39, v87
    v_mul_f32 v40, v40, v88
    v_mul_f32 v41, v41, v89
    v_mul_f32 v42, v42, v90
    v_mul_f32 v43, v43, v91
    v_mul_f32 v44, v44, v92
    v_mul_f32 v45, v45, v93
    v_mul_f32 v46, v46, v94
    v_mul_f32 v47, v47, v95
    v_cvt_pk_bf16_f32 v132, v36, v37
    v_cvt_pk_bf16_f32 v133, v38, v39
    v_cvt_pk_bf16_f32 v134, v40, v41
    v_cvt_pk_bf16_f32 v135, v42, v43
    v_cvt_pk_bf16_f32 v136, v44, v45
    v_cvt_pk_bf16_f32 v137, v46, v47
    v_mfma_f32_16x16x16_bf16 v[144:147], v[132:133], v[156:157], 0
    v_mfma_f32_16x16x16_bf16 v[144:147], v[134:135], v[158:159], v[144:147]
    v_mfma_f32_16x16x16_bf16 v[144:147], v[136:137], v[160:161], v[144:147]
    s_waitcnt lgkmcnt(0)
    v_cvt_f32_i32 v48, v48
    v_cvt_f32_i32 v49, v49
    v_cvt_f32_i32 v50, v50
    v_cvt_f32_i32 v51, v51
    v_cvt_f32_i32 v52, v52
    v_cvt_f32_i32 v53, v53
    v_cvt_f32_i32 v54, v54
    v_cvt_f32_i32 v55, v55
    v_cvt_f32_i32 v56, v56
    v_cvt_f32_i32 v57, v57
    v_cvt_f32_i32 v58, v58
    v_cvt_f32_i32 v59, v59
    v_sub_f32 v48, v48, v72
    v_sub_f32 v49, v49, v73
    v_sub_f32 v50, v50, v74
    v_sub_f32 v51, v51, v75
    v_sub_f32 v52, v52, v76
    v_sub_f32 v53, v53, v77
    v_sub_f32 v54, v54, v78
    v_sub_f32 v55, v55, v79
    v_sub_f32 v56, v56, v80
    v_sub_f32 v57, v57, v81
    v_sub_f32 v58, v58, v82
    v_sub_f32 v59, v59, v83
    v_cvt_pk_bf16_f32 v48, 0, v48
    v_cvt_pk_bf16_f32 v49, 0, v49
    v_cvt_pk_bf16_f32 v50, 0, v50
    v_cvt_pk_bf16_f32 v51, 0, v51
    v_cvt_pk_bf16_f32 v52, 0, v52
    v_cvt_pk_bf16_f32 v53, 0, v53
    v_cvt_pk_bf16_f32 v54, 0, v54
    v_cvt_pk_bf16_f32 v55, 0, v55
    v_cvt_pk_bf16_f32 v56, 0, v56
    v_cvt_pk_bf16_f32 v57, 0, v57
    v_cvt_pk_bf16_f32 v58, 0, v58
    v_cvt_pk_bf16_f32 v59, 0, v59
    v_mul_f32 v48, v48, v96
    v_mul_f32 v49, v49, v97
    v_mul_f32 v50, v50, v98
    v_mul_f32 v51, v51, v99
    v_mul_f32 v52, v52, v100
    v_mul_f32 v53, v53, v101
    v_mul_f32 v54, v54, v102
    v_mul_f32 v55, v55, v103
    v_mul_f32 v56, v56, v104
    v_mul_f32 v57, v57, v105
    v_mul_f32 v58, v58, v106
    v_mul_f32 v59, v59, v107
    v_cvt_pk_bf16_f32 v138, v48, v49
    v_cvt_pk_bf16_f32 v139, v50, v51
    v_add_f32_dpp v3, v146, v145 row_ror:12 row_mask:0xf bank_mask:0xf
    v_cvt_pk_bf16_f32 v140, v52, v53
    v_cvt_pk_bf16_f32 v141, v54, v55
    v_add_f32_dpp v3, v147, v3 row_ror:8 row_mask:0xf bank_mask:0xf
    v_cvt_pk_bf16_f32 v142, v56, v57
    v_cvt_pk_bf16_f32 v143, v58, v59
    v_add_f32_dpp v15, v144, v3 row_ror:4 row_mask:0xf bank_mask:0x2
    v_mfma_f32_16x16x16_bf16 v[148:151], v[138:139], v[156:157], 0
    v_mfma_f32_16x16x16_bf16 v[148:151], v[140:141], v[158:159], v[148:151]
    v_mfma_f32_16x16x16_bf16 v[148:151], v[142:143], v[160:161], v[148:151]
    v_add_u32 v33, s63, v21
    v_add_u32 v34, s63, v22
    ds_read_b64 v[108:109], v33 offset:0
    ds_read_b64 v[110:111], v33 offset:1536
    ds_read_b64 v[112:113], v33 offset:128
    ds_read_b64 v[114:115], v33 offset:1664
    ds_read_b64 v[116:117], v33 offset:256
    ds_read_b64 v[118:119], v33 offset:1792
    ds_read_b64 v[120:121], v34 offset:0
    v_add_f32_dpp v4, v150, v149 row_ror:12 row_mask:0xf bank_mask:0xf
    ds_read_b64 v[122:123], v34 offset:1536
    ds_read_b64 v[124:125], v34 offset:128
    v_add_f32_dpp v4, v151, v4 row_ror:8 row_mask:0xf bank_mask:0xf
    ds_read_b64 v[126:127], v34 offset:1664
    ds_read_b64 v[128:129], v34 offset:256
    ds_read_b64 v[130:131], v34 offset:1792
    v_add_f32_dpp v16, v148, v4 row_ror:4 row_mask:0xf bank_mask:0x2
    s_waitcnt lgkmcnt(0)
    v_lshlrev_b32 v60, 16, v108
    v_and_b32 v61, s66, v108
    v_lshlrev_b32 v62, 16, v109
    v_and_b32 v63, s66, v109
    v_lshlrev_b32 v84, 16, v110
    v_and_b32 v85, s66, v110
    v_lshlrev_b32 v86, 16, v111
    v_and_b32 v87, s66, v111
    v_lshlrev_b32 v64, 16, v112
    v_and_b32 v65, s66, v112
    v_lshlrev_b32 v66, 16, v113
    v_and_b32 v67, s66, v113
    v_lshlrev_b32 v88, 16, v114
    v_and_b32 v89, s66, v114
    v_lshlrev_b32 v90, 16, v115
    v_and_b32 v91, s66, v115
    v_lshlrev_b32 v68, 16, v116
    v_and_b32 v69, s66, v116
    v_lshlrev_b32 v70, 16, v117
    v_and_b32 v71, s66, v117
    v_lshlrev_b32 v92, 16, v118
    v_and_b32 v93, s66, v118
    v_lshlrev_b32 v94, 16, v119
    v_and_b32 v95, s66, v119
    v_lshlrev_b32 v72, 16, v120
    v_and_b32 v73, s66, v120
    v_lshlrev_b32 v74, 16, v121
    v_and_b32 v75, s66, v121
    v_lshlrev_b32 v96, 16, v122
    v_and_b32 v97, s66, v122
    v_lshlrev_b32 v98, 16, v123
    v_and_b32 v99, s66, v123
    v_lshlrev_b32 v76, 16, v124
    v_and_b32 v77, s66, v124
    v_lshlrev_b32 v78, 16, v125
    v_and_b32 v79, s66, v125
    v_lshlrev_b32 v100, 16, v126
    v_and_b32 v101, s66, v126
    v_lshlrev_b32 v102, 16, v127
    v_and_b32 v103, s66, v127
    v_lshlrev_b32 v80, 16, v128
    v_and_b32 v81, s66, v128
    v_lshlrev_b32 v82, 16, v129
    v_and_b32 v83, s66, v129
    v_lshlrev_b32 v104, 16, v130
    v_and_b32 v105, s66, v130
    v_lshlrev_b32 v106, 16, v131
    v_and_b32 v107, s66, v131
    v_add_u32 v13, s62, v12
    s_add_u32 s62, s62, 24576
    s_cmp_eq_u32 s62, 73728
    s_cselect_b32 s62, 0, s62
    s_barrier
    ds_read_b128 v[36:39], v13 offset:0
    ds_read_b128 v[40:43], v13 offset:1024
    ds_read_b128 v[44:47], v13 offset:2048
    ds_read_b128 v[48:51], v13 offset:3072
    ds_read_b128 v[52:55], v13 offset:4096
    ds_read_b128 v[56:59], v13 offset:5120
    s_waitcnt lgkmcnt(3)
    v_cvt_f32_i32 v36, v36
    v_cvt_f32_i32 v37, v37
    v_cvt_f32_i32 v38, v38
    v_cvt_f32_i32 v39, v39
    v_cvt_f32_i32 v40, v40
    v_cvt_f32_i32 v41, v41
    v_cvt_f32_i32 v42, v42
    v_cvt_f32_i32 v43, v43
    v_cvt_f32_i32 v44, v44
    v_cvt_f32_i32 v45, v45
    v_cvt_f32_i32 v46, v46
    v_cvt_f32_i32 v47, v47
    v_sub_f32 v36, v36, v60
    v_sub_f32 v37, v37, v61
    v_sub_f32 v38, v38, v62
    v_sub_f32 v39, v39, v63
    v_sub_f32 v40, v40, v64
    v_sub_f32 v41, v41, v65
    v_sub_f32 v42, v42, v66
    v_sub_f32 v43, v43, v67
    v_sub_f32 v44, v44, v68
    v_sub_f32 v45, v45, v69
    v_sub_f32 v46, v46, v70
    v_sub_f32 v47, v47, v71
    v_cvt_pk_bf16_f32 v36, 0, v36
    v_cvt_pk_bf16_f32 v37, 0, v37
    v_cvt_pk_bf16_f32 v38, 0, v38
    v_cvt_pk_bf16_f32 v39, 0, v39
    v_cvt_pk_bf16_f32 v40, 0, v40
    v_cvt_pk_bf16_f32 v41, 0, v41
    v_cvt_pk_bf16_f32 v42, 0, v42
    v_cvt_pk_bf16_f32 v43, 0, v43
    v_cvt_pk_bf16_f32 v44, 0, v44
    v_cvt_pk_bf16_f32 v45, 0, v45
    v_cvt_pk_bf16_f32 v46, 0, v46
    v_cvt_pk_bf16_f32 v47, 0, v47
    v_mul_f32 v36, v36, v84
    v_mul_f32 v37, v37, v85
    v_mul_f32 v38, v38, v86
    v_mul_f32 v39, v39, v87
    v_mul_f32 v40, v40, v88
    v_mul_f32 v41, v41, v89
    v_mul_f32 v42, v42, v90
    v_mul_f32 v43, v43, v91
    v_mul_f32 v44, v44, v92
    v_mul_f32 v45, v45, v93
    v_mul_f32 v46, v46, v94
    v_mul_f32 v47, v47, v95
    v_cvt_pk_bf16_f32 v132, v36, v37
    v_cvt_pk_bf16_f32 v133, v38, v39
    v_cvt_pk_bf16_f32 v134, v40, v41
    v_cvt_pk_bf16_f32 v135, v42, v43
    v_cvt_pk_bf16_f32 v136, v44, v45
    v_cvt_pk_bf16_f32 v137, v46, v47
    v_mfma_f32_16x16x16_bf16 v[144:147], v[132:133], v[156:157], 0
    v_mfma_f32_16x16x16_bf16 v[144:147], v[134:135], v[158:159], v[144:147]
    v_mfma_f32_16x16x16_bf16 v[144:147], v[136:137], v[160:161], v[144:147]
    s_waitcnt lgkmcnt(0)
    v_cvt_f32_i32 v48, v48
    v_cvt_f32_i32 v49, v49
    v_cvt_f32_i32 v50, v50
    v_cvt_f32_i32 v51, v51
    v_cvt_f32_i32 v52, v52
    v_cvt_f32_i32 v53, v53
    v_cvt_f32_i32 v54, v54
    v_cvt_f32_i32 v55, v55
    v_cvt_f32_i32 v56, v56
    v_cvt_f32_i32 v57, v57
    v_cvt_f32_i32 v58, v58
    v_cvt_f32_i32 v59, v59
    v_sub_f32 v48, v48, v72
    v_sub_f32 v49, v49, v73
    v_sub_f32 v50, v50, v74
    v_sub_f32 v51, v51, v75
    v_sub_f32 v52, v52, v76
    v_sub_f32 v53, v53, v77
    v_sub_f32 v54, v54, v78
    v_sub_f32 v55, v55, v79
    v_sub_f32 v56, v56, v80
    v_sub_f32 v57, v57, v81
    v_sub_f32 v58, v58, v82
    v_sub_f32 v59, v59, v83
    v_cvt_pk_bf16_f32 v48, 0, v48
    v_cvt_pk_bf16_f32 v49, 0, v49
    v_cvt_pk_bf16_f32 v50, 0, v50
    v_cvt_pk_bf16_f32 v51, 0, v51
    v_cvt_pk_bf16_f32 v52, 0, v52
    v_cvt_pk_bf16_f32 v53, 0, v53
    v_cvt_pk_bf16_f32 v54, 0, v54
    v_cvt_pk_bf16_f32 v55, 0, v55
    v_cvt_pk_bf16_f32 v56, 0, v56
    v_cvt_pk_bf16_f32 v57, 0, v57
    v_cvt_pk_bf16_f32 v58, 0, v58
    v_cvt_pk_bf16_f32 v59, 0, v59
    v_mul_f32 v48, v48, v96
    v_mul_f32 v49, v49, v97
    v_mul_f32 v50, v50, v98
    v_mul_f32 v51, v51, v99
    v_mul_f32 v52, v52, v100
    v_mul_f32 v53, v53, v101
    v_mul_f32 v54, v54, v102
    v_mul_f32 v55, v55, v103
    v_mul_f32 v56, v56, v104
    v_mul_f32 v57, v57, v105
    v_mul_f32 v58, v58, v106
    v_mul_f32 v59, v59, v107
    v_cvt_pk_bf16_f32 v138, v48, v49
    v_cvt_pk_bf16_f32 v139, v50, v51
    v_add_f32_dpp v3, v147, v146 row_ror:12 row_mask:0xf bank_mask:0xf
    v_cvt_pk_bf16_f32 v140, v52, v53
    v_cvt_pk_bf16_f32 v141, v54, v55
    v_add_f32_dpp v3, v144, v3 row_ror:8 row_mask:0xf bank_mask:0xf
    v_cvt_pk_bf16_f32 v142, v56, v57
    v_cvt_pk_bf16_f32 v143, v58, v59
    v_add_f32_dpp v15, v145, v3 row_ror:4 row_mask:0xf bank_mask:0x4
    v_mfma_f32_16x16x16_bf16 v[148:151], v[138:139], v[156:157], 0
    v_mfma_f32_16x16x16_bf16 v[148:151], v[140:141], v[158:159], v[148:151]
    v_mfma_f32_16x16x16_bf16 v[148:151], v[142:143], v[160:161], v[148:151]
    v_add_u32 v33, s63, v23
    v_add_u32 v34, s63, v24
    ds_read_b64 v[108:109], v33 offset:0
    ds_read_b64 v[110:111], v33 offset:1536
    ds_read_b64 v[112:113], v33 offset:128
    ds_read_b64 v[114:115], v33 offset:1664
    ds_read_b64 v[116:117], v33 offset:256
    ds_read_b64 v[118:119], v33 offset:1792
    ds_read_b64 v[120:121], v34 offset:0
    v_add_f32_dpp v4, v151, v150 row_ror:12 row_mask:0xf bank_mask:0xf
    ds_read_b64 v[122:123], v34 offset:1536
    ds_read_b64 v[124:125], v34 offset:128
    v_add_f32_dpp v4, v148, v4 row_ror:8 row_mask:0xf bank_mask:0xf
    ds_read_b64 v[126:127], v34 offset:1664
    ds_read_b64 v[128:129], v34 offset:256
    ds_read_b64 v[130:131], v34 offset:1792
    v_add_f32_dpp v16, v149, v4 row_ror:4 row_mask:0xf bank_mask:0x4
    s_waitcnt lgkmcnt(0)
    v_lshlrev_b32 v60, 16, v108
    v_and_b32 v61, s66, v108
    v_lshlrev_b32 v62, 16, v109
    v_and_b32 v63, s66, v109
    v_lshlrev_b32 v84, 16, v110
    v_and_b32 v85, s66, v110
    v_lshlrev_b32 v86, 16, v111
    v_and_b32 v87, s66, v111
    v_lshlrev_b32 v64, 16, v112
    v_and_b32 v65, s66, v112
    v_lshlrev_b32 v66, 16, v113
    v_and_b32 v67, s66, v113
    v_lshlrev_b32 v88, 16, v114
    v_and_b32 v89, s66, v114
    v_lshlrev_b32 v90, 16, v115
    v_and_b32 v91, s66, v115
    v_lshlrev_b32 v68, 16, v116
    v_and_b32 v69, s66, v116
    v_lshlrev_b32 v70, 16, v117
    v_and_b32 v71, s66, v117
    v_lshlrev_b32 v92, 16, v118
    v_and_b32 v93, s66, v118
    v_lshlrev_b32 v94, 16, v119
    v_and_b32 v95, s66, v119
    v_lshlrev_b32 v72, 16, v120
    v_and_b32 v73, s66, v120
    v_lshlrev_b32 v74, 16, v121
    v_and_b32 v75, s66, v121
    v_lshlrev_b32 v96, 16, v122
    v_and_b32 v97, s66, v122
    v_lshlrev_b32 v98, 16, v123
    v_and_b32 v99, s66, v123
    v_lshlrev_b32 v76, 16, v124
    v_and_b32 v77, s66, v124
    v_lshlrev_b32 v78, 16, v125
    v_and_b32 v79, s66, v125
    v_lshlrev_b32 v100, 16, v126
    v_and_b32 v101, s66, v126
    v_lshlrev_b32 v102, 16, v127
    v_and_b32 v103, s66, v127
    v_lshlrev_b32 v80, 16, v128
    v_and_b32 v81, s66, v128
    v_lshlrev_b32 v82, 16, v129
    v_and_b32 v83, s66, v129
    v_lshlrev_b32 v104, 16, v130
    v_and_b32 v105, s66, v130
    v_lshlrev_b32 v106, 16, v131
    v_and_b32 v107, s66, v131
    v_add_u32 v13, s62, v12
    s_add_u32 s62, s62, 24576
    s_cmp_eq_u32 s62, 73728
    s_cselect_b32 s62, 0, s62
    s_barrier
    ds_read_b128 v[36:39], v13 offset:0
    ds_read_b128 v[40:43], v13 offset:1024
    ds_read_b128 v[44:47], v13 offset:2048
    ds_read_b128 v[48:51], v13 offset:3072
    ds_read_b128 v[52:55], v13 offset:4096
    ds_read_b128 v[56:59], v13 offset:5120
    s_waitcnt lgkmcnt(3)
    v_cvt_f32_i32 v36, v36
    v_cvt_f32_i32 v37, v37
    v_cvt_f32_i32 v38, v38
    v_cvt_f32_i32 v39, v39
    v_cvt_f32_i32 v40, v40
    v_cvt_f32_i32 v41, v41
    v_cvt_f32_i32 v42, v42
    v_cvt_f32_i32 v43, v43
    v_cvt_f32_i32 v44, v44
    v_cvt_f32_i32 v45, v45
    v_cvt_f32_i32 v46, v46
    v_cvt_f32_i32 v47, v47
    v_sub_f32 v36, v36, v60
    v_sub_f32 v37, v37, v61
    v_sub_f32 v38, v38, v62
    v_sub_f32 v39, v39, v63
    v_sub_f32 v40, v40, v64
    v_sub_f32 v41, v41, v65
    v_sub_f32 v42, v42, v66
    v_sub_f32 v43, v43, v67
    v_sub_f32 v44, v44, v68
    v_sub_f32 v45, v45, v69
    v_sub_f32 v46, v46, v70
    v_sub_f32 v47, v47, v71
    v_cvt_pk_bf16_f32 v36, 0, v36
    v_cvt_pk_bf16_f32 v37, 0, v37
    v_cvt_pk_bf16_f32 v38, 0, v38
    v_cvt_pk_bf16_f32 v39, 0, v39
    v_cvt_pk_bf16_f32 v40, 0, v40
    v_cvt_pk_bf16_f32 v41, 0, v41
    v_cvt_pk_bf16_f32 v42, 0, v42
    v_cvt_pk_bf16_f32 v43, 0, v43
    v_cvt_pk_bf16_f32 v44, 0, v44
    v_cvt_pk_bf16_f32 v45, 0, v45
    v_cvt_pk_bf16_f32 v46, 0, v46
    v_cvt_pk_bf16_f32 v47, 0, v47
    v_mul_f32 v36, v36, v84
    v_mul_f32 v37, v37, v85
    v_mul_f32 v38, v38, v86
    v_mul_f32 v39, v39, v87
    v_mul_f32 v40, v40, v88
    v_mul_f32 v41, v41, v89
    v_mul_f32 v42, v42, v90
    v_mul_f32 v43, v43, v91
    v_mul_f32 v44, v44, v92
    v_mul_f32 v45, v45, v93
    v_mul_f32 v46, v46, v94
    v_mul_f32 v47, v47, v95
    v_cvt_pk_bf16_f32 v132, v36, v37
    v_cvt_pk_bf16_f32 v133, v38, v39
    v_cvt_pk_bf16_f32 v134, v40, v41
    v_cvt_pk_bf16_f32 v135, v42, v43
    v_cvt_pk_bf16_f32 v136, v44, v45
    v_cvt_pk_bf16_f32 v137, v46, v47
    v_mfma_f32_16x16x16_bf16 v[144:147], v[132:133], v[156:157], 0
    v_mfma_f32_16x16x16_bf16 v[144:147], v[134:135], v[158:159], v[144:147]
    v_mfma_f32_16x16x16_bf16 v[144:147], v[136:137], v[160:161], v[144:147]
    s_waitcnt lgkmcnt(0)
    v_cvt_f32_i32 v48, v48
    v_cvt_f32_i32 v49, v49
    v_cvt_f32_i32 v50, v50
    v_cvt_f32_i32 v51, v51
    v_cvt_f32_i32 v52, v52
    v_cvt_f32_i32 v53, v53
    v_cvt_f32_i32 v54, v54
    v_cvt_f32_i32 v55, v55
    v_cvt_f32_i32 v56, v56
    v_cvt_f32_i32 v57, v57
    v_cvt_f32_i32 v58, v58
    v_cvt_f32_i32 v59, v59
    v_sub_f32 v48, v48, v72
    v_sub_f32 v49, v49, v73
    v_sub_f32 v50, v50, v74
    v_sub_f32 v51, v51, v75
    v_sub_f32 v52, v52, v76
    v_sub_f32 v53, v53, v77
    v_sub_f32 v54, v54, v78
    v_sub_f32 v55, v55, v79
    v_sub_f32 v56, v56, v80
    v_sub_f32 v57, v57, v81
    v_sub_f32 v58, v58, v82
    v_sub_f32 v59, v59, v83
    v_cvt_pk_bf16_f32 v48, 0, v48
    v_cvt_pk_bf16_f32 v49, 0, v49
    v_cvt_pk_bf16_f32 v50, 0, v50
    v_cvt_pk_bf16_f32 v51, 0, v51
    v_cvt_pk_bf16_f32 v52, 0, v52
    v_cvt_pk_bf16_f32 v53, 0, v53
    v_cvt_pk_bf16_f32 v54, 0, v54
    v_cvt_pk_bf16_f32 v55, 0, v55
    v_cvt_pk_bf16_f32 v56, 0, v56
    v_cvt_pk_bf16_f32 v57, 0, v57
    v_cvt_pk_bf16_f32 v58, 0, v58
    v_cvt_pk_bf16_f32 v59, 0, v59
    v_mul_f32 v48, v48, v96
    v_mul_f32 v49, v49, v97
    v_mul_f32 v50, v50, v98
    v_mul_f32 v51, v51, v99
    v_mul_f32 v52, v52, v100
    v_mul_f32 v53, v53, v101
    v_mul_f32 v54, v54, v102
    v_mul_f32 v55, v55, v103
    v_mul_f32 v56, v56, v104
    v_mul_f32 v57, v57, v105
    v_mul_f32 v58, v58, v106
    v_mul_f32 v59, v59, v107
    v_cvt_pk_bf16_f32 v138, v48, v49
    v_cvt_pk_bf16_f32 v139, v50, v51
    v_add_f32_dpp v3, v144, v147 row_ror:12 row_mask:0xf bank_mask:0xf
    v_cvt_pk_bf16_f32 v140, v52, v53
    v_cvt_pk_bf16_f32 v141, v54, v55
    v_add_f32_dpp v3, v145, v3 row_ror:8 row_mask:0xf bank_mask:0xf
    v_cvt_pk_bf16_f32 v142, v56, v57
    v_cvt_pk_bf16_f32 v143, v58, v59
    v_add_f32_dpp v15, v146, v3 row_ror:4 row_mask:0xf bank_mask:0x8
    v_mfma_f32_16x16x16_bf16 v[148:151], v[138:139], v[156:157], 0
    v_mfma_f32_16x16x16_bf16 v[148:151], v[140:141], v[158:159], v[148:151]
    v_mfma_f32_16x16x16_bf16 v[148:151], v[142:143], v[160:161], v[148:151]
    v_add_u32 v33, s63, v25
    v_add_u32 v34, s63, v26
    ds_read_b64 v[108:109], v33 offset:0
    ds_read_b64 v[110:111], v33 offset:1536
    ds_read_b64 v[112:113], v33 offset:128
    ds_read_b64 v[114:115], v33 offset:1664
    ds_read_b64 v[116:117], v33 offset:256
    ds_read_b64 v[118:119], v33 offset:1792
    ds_read_b64 v[120:121], v34 offset:0
    v_add_f32_dpp v4, v148, v151 row_ror:12 row_mask:0xf bank_mask:0xf
    ds_read_b64 v[122:123], v34 offset:1536
    ds_read_b64 v[124:125], v34 offset:128
    v_add_f32_dpp v4, v149, v4 row_ror:8 row_mask:0xf bank_mask:0xf
    ds_read_b64 v[126:127], v34 offset:1664
    ds_read_b64 v[128:129], v34 offset:256
    ds_read_b64 v[130:131], v34 offset:1792
    v_add_f32_dpp v16, v150, v4 row_ror:4 row_mask:0xf bank_mask:0x8
    v_cvt_pk_bf16_f32 v3, 0, v15
    v_cvt_pk_bf16_f32 v4, 0, v16
    v_mul_f32 v3, s65, v3
    v_mul_f32 v4, s65, v4
    v_cvt_pk_bf16_f32 v5, v3, v4
    v_max3_f32 v14, v14, v3, v4
    ds_write_b32 v11, v5 offset:0
    s_waitcnt lgkmcnt(0)
    v_lshlrev_b32 v60, 16, v108
    v_and_b32 v61, s66, v108
    v_lshlrev_b32 v62, 16, v109
    v_and_b32 v63, s66, v109
    v_lshlrev_b32 v84, 16, v110
    v_and_b32 v85, s66, v110
    v_lshlrev_b32 v86, 16, v111
    v_and_b32 v87, s66, v111
    v_lshlrev_b32 v64, 16, v112
    v_and_b32 v65, s66, v112
    v_lshlrev_b32 v66, 16, v113
    v_and_b32 v67, s66, v113
    v_lshlrev_b32 v88, 16, v114
    v_and_b32 v89, s66, v114
    v_lshlrev_b32 v90, 16, v115
    v_and_b32 v91, s66, v115
    v_lshlrev_b32 v68, 16, v116
    v_and_b32 v69, s66, v116
    v_lshlrev_b32 v70, 16, v117
    v_and_b32 v71, s66, v117
    v_lshlrev_b32 v92, 16, v118
    v_and_b32 v93, s66, v118
    v_lshlrev_b32 v94, 16, v119
    v_and_b32 v95, s66, v119
    v_lshlrev_b32 v72, 16, v120
    v_and_b32 v73, s66, v120
    v_lshlrev_b32 v74, 16, v121
    v_and_b32 v75, s66, v121
    v_lshlrev_b32 v96, 16, v122
    v_and_b32 v97, s66, v122
    v_lshlrev_b32 v98, 16, v123
    v_and_b32 v99, s66, v123
    v_lshlrev_b32 v76, 16, v124
    v_and_b32 v77, s66, v124
    v_lshlrev_b32 v78, 16, v125
    v_and_b32 v79, s66, v125
    v_lshlrev_b32 v100, 16, v126
    v_and_b32 v101, s66, v126
    v_lshlrev_b32 v102, 16, v127
    v_and_b32 v103, s66, v127
    v_lshlrev_b32 v80, 16, v128
    v_and_b32 v81, s66, v128
    v_lshlrev_b32 v82, 16, v129
    v_and_b32 v83, s66, v129
    v_lshlrev_b32 v104, 16, v130
    v_and_b32 v105, s66, v130
    v_lshlrev_b32 v106, 16, v131
    v_and_b32 v107, s66, v131
    s_waitcnt vmcnt(0)
    v_add_u32 v13, s62, v12
    s_add_u32 s62, s62, 24576
    s_cmp_eq_u32 s62, 73728
    s_cselect_b32 s62, 0, s62
    s_barrier
    ds_read_b128 v[36:39], v13 offset:0
    ds_read_b128 v[40:43], v13 offset:1024
    ds_read_b128 v[44:47], v13 offset:2048
    ds_read_b128 v[48:51], v13 offset:3072
    ds_read_b128 v[52:55], v13 offset:4096
    ds_read_b128 v[56:59], v13 offset:5120
    s_waitcnt lgkmcnt(3)
    v_cvt_f32_i32 v36, v36
    v_cvt_f32_i32 v37, v37
    v_cvt_f32_i32 v38, v38
    v_cvt_f32_i32 v39, v39
    v_cvt_f32_i32 v40, v40
    v_cvt_f32_i32 v41, v41
    v_cvt_f32_i32 v42, v42
    v_cvt_f32_i32 v43, v43
    v_cvt_f32_i32 v44, v44
    v_cvt_f32_i32 v45, v45
    v_cvt_f32_i32 v46, v46
    v_cvt_f32_i32 v47, v47
    v_sub_f32 v36, v36, v60
    v_sub_f32 v37, v37, v61
    v_sub_f32 v38, v38, v62
    v_sub_f32 v39, v39, v63
    v_sub_f32 v40, v40, v64
    v_sub_f32 v41, v41, v65
    v_sub_f32 v42, v42, v66
    v_sub_f32 v43, v43, v67
    v_sub_f32 v44, v44, v68
    v_sub_f32 v45, v45, v69
    v_sub_f32 v46, v46, v70
    v_sub_f32 v47, v47, v71
    v_cvt_pk_bf16_f32 v36, 0, v36
    v_cvt_pk_bf16_f32 v37, 0, v37
    v_cvt_pk_bf16_f32 v38, 0, v38
    v_cvt_pk_bf16_f32 v39, 0, v39
    v_cvt_pk_bf16_f32 v40, 0, v40
    v_cvt_pk_bf16_f32 v41, 0, v41
    v_cvt_pk_bf16_f32 v42, 0, v42
    v_cvt_pk_bf16_f32 v43, 0, v43
    v_cvt_pk_bf16_f32 v44, 0, v44
    v_cvt_pk_bf16_f32 v45, 0, v45
    v_cvt_pk_bf16_f32 v46, 0, v46
    v_cvt_pk_bf16_f32 v47, 0, v47
    v_mul_f32 v36, v36, v84
    v_mul_f32 v37, v37, v85
    v_mul_f32 v38, v38, v86
    v_mul_f32 v39, v39, v87
    v_mul_f32 v40, v40, v88
    v_mul_f32 v41, v41, v89
    v_mul_f32 v42, v42, v90
    v_mul_f32 v43, v43, v91
    v_mul_f32 v44, v44, v92
    v_mul_f32 v45, v45, v93
    v_mul_f32 v46, v46, v94
    v_mul_f32 v47, v47, v95
    v_cvt_pk_bf16_f32 v132, v36, v37
    v_cvt_pk_bf16_f32 v133, v38, v39
    v_cvt_pk_bf16_f32 v134, v40, v41
    v_cvt_pk_bf16_f32 v135, v42, v43
    v_cvt_pk_bf16_f32 v136, v44, v45
    v_cvt_pk_bf16_f32 v137, v46, v47
    v_mfma_f32_16x16x16_bf16 v[144:147], v[132:133], v[156:157], 0
    v_mfma_f32_16x16x16_bf16 v[144:147], v[134:135], v[158:159], v[144:147]
    v_mfma_f32_16x16x16_bf16 v[144:147], v[136:137], v[160:161], v[144:147]
    s_waitcnt lgkmcnt(0)
    v_cvt_f32_i32 v48, v48
    v_cvt_f32_i32 v49, v49
    v_cvt_f32_i32 v50, v50
    v_cvt_f32_i32 v51, v51
    v_cvt_f32_i32 v52, v52
    v_cvt_f32_i32 v53, v53
    v_cvt_f32_i32 v54, v54
    v_cvt_f32_i32 v55, v55
    v_cvt_f32_i32 v56, v56
    v_cvt_f32_i32 v57, v57
    v_cvt_f32_i32 v58, v58
    v_cvt_f32_i32 v59, v59
    v_sub_f32 v48, v48, v72
    v_sub_f32 v49, v49, v73
    v_sub_f32 v50, v50, v74
    v_sub_f32 v51, v51, v75
    v_sub_f32 v52, v52, v76
    v_sub_f32 v53, v53, v77
    v_sub_f32 v54, v54, v78
    v_sub_f32 v55, v55, v79
    v_sub_f32 v56, v56, v80
    v_sub_f32 v57, v57, v81
    v_sub_f32 v58, v58, v82
    v_sub_f32 v59, v59, v83
    v_cvt_pk_bf16_f32 v48, 0, v48
    v_cvt_pk_bf16_f32 v49, 0, v49
    v_cvt_pk_bf16_f32 v50, 0, v50
    v_cvt_pk_bf16_f32 v51, 0, v51
    v_cvt_pk_bf16_f32 v52, 0, v52
    v_cvt_pk_bf16_f32 v53, 0, v53
    v_cvt_pk_bf16_f32 v54, 0, v54
    v_cvt_pk_bf16_f32 v55, 0, v55
    v_cvt_pk_bf16_f32 v56, 0, v56
    v_cvt_pk_bf16_f32 v57, 0, v57
    v_cvt_pk_bf16_f32 v58, 0, v58
    v_cvt_pk_bf16_f32 v59, 0, v59
    v_mul_f32 v48, v48, v96
    v_mul_f32 v49, v49, v97
    v_mul_f32 v50, v50, v98
    v_mul_f32 v51, v51, v99
    v_mul_f32 v52, v52, v100
    v_mul_f32 v53, v53, v101
    v_mul_f32 v54, v54, v102
    v_mul_f32 v55, v55, v103
    v_mul_f32 v56, v56, v104
    v_mul_f32 v57, v57, v105
    v_mul_f32 v58, v58, v106
    v_mul_f32 v59, v59, v107
    v_cvt_pk_bf16_f32 v138, v48, v49
    v_cvt_pk_bf16_f32 v139, v50, v51
    v_add_f32_dpp v3, v145, v144 row_ror:12 row_mask:0xf bank_mask:0xf
    v_cvt_pk_bf16_f32 v140, v52, v53
    v_cvt_pk_bf16_f32 v141, v54, v55
    v_add_f32_dpp v3, v146, v3 row_ror:8 row_mask:0xf bank_mask:0xf
    v_cvt_pk_bf16_f32 v142, v56, v57
    v_cvt_pk_bf16_f32 v143, v58, v59
    v_add_f32_dpp v15, v147, v3 row_ror:4 row_mask:0xf bank_mask:0x1
    v_mfma_f32_16x16x16_bf16 v[148:151], v[138:139], v[156:157], 0
    v_mfma_f32_16x16x16_bf16 v[148:151], v[140:141], v[158:159], v[148:151]
    v_mfma_f32_16x16x16_bf16 v[148:151], v[142:143], v[160:161], v[148:151]
    v_add_u32 v33, s63, v27
    v_add_u32 v34, s63, v28
    ds_read_b64 v[108:109], v33 offset:0
    ds_read_b64 v[110:111], v33 offset:1536
    ds_read_b64 v[112:113], v33 offset:128
    ds_read_b64 v[114:115], v33 offset:1664
    ds_read_b64 v[116:117], v33 offset:256
    ds_read_b64 v[118:119], v33 offset:1792
    ds_read_b64 v[120:121], v34 offset:0
    v_add_f32_dpp v4, v149, v148 row_ror:12 row_mask:0xf bank_mask:0xf
    ds_read_b64 v[122:123], v34 offset:1536
    ds_read_b64 v[124:125], v34 offset:128
    v_add_f32_dpp v4, v150, v4 row_ror:8 row_mask:0xf bank_mask:0xf
    ds_read_b64 v[126:127], v34 offset:1664
    ds_read_b64 v[128:129], v34 offset:256
    ds_read_b64 v[130:131], v34 offset:1792
    v_add_f32_dpp v16, v151, v4 row_ror:4 row_mask:0xf bank_mask:0x1
    s_waitcnt lgkmcnt(0)
    v_lshlrev_b32 v60, 16, v108
    v_and_b32 v61, s66, v108
    v_lshlrev_b32 v62, 16, v109
    v_and_b32 v63, s66, v109
    v_lshlrev_b32 v84, 16, v110
    v_and_b32 v85, s66, v110
    v_lshlrev_b32 v86, 16, v111
    v_and_b32 v87, s66, v111
    v_lshlrev_b32 v64, 16, v112
    v_and_b32 v65, s66, v112
    v_lshlrev_b32 v66, 16, v113
    v_and_b32 v67, s66, v113
    v_lshlrev_b32 v88, 16, v114
    v_and_b32 v89, s66, v114
    v_lshlrev_b32 v90, 16, v115
    v_and_b32 v91, s66, v115
    v_lshlrev_b32 v68, 16, v116
    v_and_b32 v69, s66, v116
    v_lshlrev_b32 v70, 16, v117
    v_and_b32 v71, s66, v117
    v_lshlrev_b32 v92, 16, v118
    v_and_b32 v93, s66, v118
    v_lshlrev_b32 v94, 16, v119
    v_and_b32 v95, s66, v119
    v_lshlrev_b32 v72, 16, v120
    v_and_b32 v73, s66, v120
    v_lshlrev_b32 v74, 16, v121
    v_and_b32 v75, s66, v121
    v_lshlrev_b32 v96, 16, v122
    v_and_b32 v97, s66, v122
    v_lshlrev_b32 v98, 16, v123
    v_and_b32 v99, s66, v123
    v_lshlrev_b32 v76, 16, v124
    v_and_b32 v77, s66, v124
    v_lshlrev_b32 v78, 16, v125
    v_and_b32 v79, s66, v125
    v_lshlrev_b32 v100, 16, v126
    v_and_b32 v101, s66, v126
    v_lshlrev_b32 v102, 16, v127
    v_and_b32 v103, s66, v127
    v_lshlrev_b32 v80, 16, v128
    v_and_b32 v81, s66, v128
    v_lshlrev_b32 v82, 16, v129
    v_and_b32 v83, s66, v129
    v_lshlrev_b32 v104, 16, v130
    v_and_b32 v105, s66, v130
    v_lshlrev_b32 v106, 16, v131
    v_and_b32 v107, s66, v131
    v_add_u32 v13, s62, v12
    s_add_u32 s62, s62, 24576
    s_cmp_eq_u32 s62, 73728
    s_cselect_b32 s62, 0, s62
    s_barrier
    ds_read_b128 v[36:39], v13 offset:0
    ds_read_b128 v[40:43], v13 offset:1024
    ds_read_b128 v[44:47], v13 offset:2048
    ds_read_b128 v[48:51], v13 offset:3072
    ds_read_b128 v[52:55], v13 offset:4096
    ds_read_b128 v[56:59], v13 offset:5120
    s_waitcnt lgkmcnt(3)
    v_cvt_f32_i32 v36, v36
    v_cvt_f32_i32 v37, v37
    v_cvt_f32_i32 v38, v38
    v_cvt_f32_i32 v39, v39
    v_cvt_f32_i32 v40, v40
    v_cvt_f32_i32 v41, v41
    v_cvt_f32_i32 v42, v42
    v_cvt_f32_i32 v43, v43
    v_cvt_f32_i32 v44, v44
    v_cvt_f32_i32 v45, v45
    v_cvt_f32_i32 v46, v46
    v_cvt_f32_i32 v47, v47
    v_sub_f32 v36, v36, v60
    v_sub_f32 v37, v37, v61
    v_sub_f32 v38, v38, v62
    v_sub_f32 v39, v39, v63
    v_sub_f32 v40, v40, v64
    v_sub_f32 v41, v41, v65
    v_sub_f32 v42, v42, v66
    v_sub_f32 v43, v43, v67
    v_sub_f32 v44, v44, v68
    v_sub_f32 v45, v45, v69
    v_sub_f32 v46, v46, v70
    v_sub_f32 v47, v47, v71
    v_cvt_pk_bf16_f32 v36, 0, v36
    v_cvt_pk_bf16_f32 v37, 0, v37
    v_cvt_pk_bf16_f32 v38, 0, v38
    v_cvt_pk_bf16_f32 v39, 0, v39
    v_cvt_pk_bf16_f32 v40, 0, v40
    v_cvt_pk_bf16_f32 v41, 0, v41
    v_cvt_pk_bf16_f32 v42, 0, v42
    v_cvt_pk_bf16_f32 v43, 0, v43
    v_cvt_pk_bf16_f32 v44, 0, v44
    v_cvt_pk_bf16_f32 v45, 0, v45
    v_cvt_pk_bf16_f32 v46, 0, v46
    v_cvt_pk_bf16_f32 v47, 0, v47
    v_mul_f32 v36, v36, v84
    v_mul_f32 v37, v37, v85
    v_mul_f32 v38, v38, v86
    v_mul_f32 v39, v39, v87
    v_mul_f32 v40, v40, v88
    v_mul_f32 v41, v41, v89
    v_mul_f32 v42, v42, v90
    v_mul_f32 v43, v43, v91
    v_mul_f32 v44, v44, v92
    v_mul_f32 v45, v45, v93
    v_mul_f32 v46, v46, v94
    v_mul_f32 v47, v47, v95
    v_cvt_pk_bf16_f32 v132, v36, v37
    v_cvt_pk_bf16_f32 v133, v38, v39
    v_cvt_pk_bf16_f32 v134, v40, v41
    v_cvt_pk_bf16_f32 v135, v42, v43
    v_cvt_pk_bf16_f32 v136, v44, v45
    v_cvt_pk_bf16_f32 v137, v46, v47
    v_mfma_f32_16x16x16_bf16 v[144:147], v[132:133], v[156:157], 0
    v_mfma_f32_16x16x16_bf16 v[144:147], v[134:135], v[158:159], v[144:147]
    v_mfma_f32_16x16x16_bf16 v[144:147], v[136:137], v[160:161], v[144:147]
    s_waitcnt lgkmcnt(0)
    v_cvt_f32_i32 v48, v48
    v_cvt_f32_i32 v49, v49
    v_cvt_f32_i32 v50, v50
    v_cvt_f32_i32 v51, v51
    v_cvt_f32_i32 v52, v52
    v_cvt_f32_i32 v53, v53
    v_cvt_f32_i32 v54, v54
    v_cvt_f32_i32 v55, v55
    v_cvt_f32_i32 v56, v56
    v_cvt_f32_i32 v57, v57
    v_cvt_f32_i32 v58, v58
    v_cvt_f32_i32 v59, v59
    v_sub_f32 v48, v48, v72
    v_sub_f32 v49, v49, v73
    v_sub_f32 v50, v50, v74
    v_sub_f32 v51, v51, v75
    v_sub_f32 v52, v52, v76
    v_sub_f32 v53, v53, v77
    v_sub_f32 v54, v54, v78
    v_sub_f32 v55, v55, v79
    v_sub_f32 v56, v56, v80
    v_sub_f32 v57, v57, v81
    v_sub_f32 v58, v58, v82
    v_sub_f32 v59, v59, v83
    v_cvt_pk_bf16_f32 v48, 0, v48
    v_cvt_pk_bf16_f32 v49, 0, v49
    v_cvt_pk_bf16_f32 v50, 0, v50
    v_cvt_pk_bf16_f32 v51, 0, v51
    v_cvt_pk_bf16_f32 v52, 0, v52
    v_cvt_pk_bf16_f32 v53, 0, v53
    v_cvt_pk_bf16_f32 v54, 0, v54
    v_cvt_pk_bf16_f32 v55, 0, v55
    v_cvt_pk_bf16_f32 v56, 0, v56
    v_cvt_pk_bf16_f32 v57, 0, v57
    v_cvt_pk_bf16_f32 v58, 0, v58
    v_cvt_pk_bf16_f32 v59, 0, v59
    v_mul_f32 v48, v48, v96
    v_mul_f32 v49, v49, v97
    v_mul_f32 v50, v50, v98
    v_mul_f32 v51, v51, v99
    v_mul_f32 v52, v52, v100
    v_mul_f32 v53, v53, v101
    v_mul_f32 v54, v54, v102
    v_mul_f32 v55, v55, v103
    v_mul_f32 v56, v56, v104
    v_mul_f32 v57, v57, v105
    v_mul_f32 v58, v58, v106
    v_mul_f32 v59, v59, v107
    v_cvt_pk_bf16_f32 v138, v48, v49
    v_cvt_pk_bf16_f32 v139, v50, v51
    v_add_f32_dpp v3, v146, v145 row_ror:12 row_mask:0xf bank_mask:0xf
    v_cvt_pk_bf16_f32 v140, v52, v53
    v_cvt_pk_bf16_f32 v141, v54, v55
    v_add_f32_dpp v3, v147, v3 row_ror:8 row_mask:0xf bank_mask:0xf
    v_cvt_pk_bf16_f32 v142, v56, v57
    v_cvt_pk_bf16_f32 v143, v58, v59
    v_add_f32_dpp v15, v144, v3 row_ror:4 row_mask:0xf bank_mask:0x2
    v_mfma_f32_16x16x16_bf16 v[148:151], v[138:139], v[156:157], 0
    v_mfma_f32_16x16x16_bf16 v[148:151], v[140:141], v[158:159], v[148:151]
    v_mfma_f32_16x16x16_bf16 v[148:151], v[142:143], v[160:161], v[148:151]
    v_add_u32 v33, s63, v29
    v_add_u32 v34, s63, v30
    ds_read_b64 v[108:109], v33 offset:0
    ds_read_b64 v[110:111], v33 offset:1536
    ds_read_b64 v[112:113], v33 offset:128
    ds_read_b64 v[114:115], v33 offset:1664
    ds_read_b64 v[116:117], v33 offset:256
    ds_read_b64 v[118:119], v33 offset:1792
    ds_read_b64 v[120:121], v34 offset:0
    v_add_f32_dpp v4, v150, v149 row_ror:12 row_mask:0xf bank_mask:0xf
    ds_read_b64 v[122:123], v34 offset:1536
    ds_read_b64 v[124:125], v34 offset:128
    v_add_f32_dpp v4, v151, v4 row_ror:8 row_mask:0xf bank_mask:0xf
    ds_read_b64 v[126:127], v34 offset:1664
    ds_read_b64 v[128:129], v34 offset:256
    ds_read_b64 v[130:131], v34 offset:1792
    v_add_f32_dpp v16, v148, v4 row_ror:4 row_mask:0xf bank_mask:0x2
    s_waitcnt lgkmcnt(0)
    v_lshlrev_b32 v60, 16, v108
    v_and_b32 v61, s66, v108
    v_lshlrev_b32 v62, 16, v109
    v_and_b32 v63, s66, v109
    v_lshlrev_b32 v84, 16, v110
    v_and_b32 v85, s66, v110
    v_lshlrev_b32 v86, 16, v111
    v_and_b32 v87, s66, v111
    v_lshlrev_b32 v64, 16, v112
    v_and_b32 v65, s66, v112
    v_lshlrev_b32 v66, 16, v113
    v_and_b32 v67, s66, v113
    v_lshlrev_b32 v88, 16, v114
    v_and_b32 v89, s66, v114
    v_lshlrev_b32 v90, 16, v115
    v_and_b32 v91, s66, v115
    v_lshlrev_b32 v68, 16, v116
    v_and_b32 v69, s66, v116
    v_lshlrev_b32 v70, 16, v117
    v_and_b32 v71, s66, v117
    v_lshlrev_b32 v92, 16, v118
    v_and_b32 v93, s66, v118
    v_lshlrev_b32 v94, 16, v119
    v_and_b32 v95, s66, v119
    v_lshlrev_b32 v72, 16, v120
    v_and_b32 v73, s66, v120
    v_lshlrev_b32 v74, 16, v121
    v_and_b32 v75, s66, v121
    v_lshlrev_b32 v96, 16, v122
    v_and_b32 v97, s66, v122
    v_lshlrev_b32 v98, 16, v123
    v_and_b32 v99, s66, v123
    v_lshlrev_b32 v76, 16, v124
    v_and_b32 v77, s66, v124
    v_lshlrev_b32 v78, 16, v125
    v_and_b32 v79, s66, v125
    v_lshlrev_b32 v100, 16, v126
    v_and_b32 v101, s66, v126
    v_lshlrev_b32 v102, 16, v127
    v_and_b32 v103, s66, v127
    v_lshlrev_b32 v80, 16, v128
    v_and_b32 v81, s66, v128
    v_lshlrev_b32 v82, 16, v129
    v_and_b32 v83, s66, v129
    v_lshlrev_b32 v104, 16, v130
    v_and_b32 v105, s66, v130
    v_lshlrev_b32 v106, 16, v131
    v_and_b32 v107, s66, v131
    v_add_u32 v13, s62, v12
    s_add_u32 s62, s62, 24576
    s_cmp_eq_u32 s62, 73728
    s_cselect_b32 s62, 0, s62
    s_barrier
    ds_read_b128 v[36:39], v13 offset:0
    ds_read_b128 v[40:43], v13 offset:1024
    ds_read_b128 v[44:47], v13 offset:2048
    ds_read_b128 v[48:51], v13 offset:3072
    ds_read_b128 v[52:55], v13 offset:4096
    ds_read_b128 v[56:59], v13 offset:5120
    s_waitcnt lgkmcnt(3)
    v_cvt_f32_i32 v36, v36
    v_cvt_f32_i32 v37, v37
    v_cvt_f32_i32 v38, v38
    v_cvt_f32_i32 v39, v39
    v_cvt_f32_i32 v40, v40
    v_cvt_f32_i32 v41, v41
    v_cvt_f32_i32 v42, v42
    v_cvt_f32_i32 v43, v43
    v_cvt_f32_i32 v44, v44
    v_cvt_f32_i32 v45, v45
    v_cvt_f32_i32 v46, v46
    v_cvt_f32_i32 v47, v47
    v_sub_f32 v36, v36, v60
    v_sub_f32 v37, v37, v61
    v_sub_f32 v38, v38, v62
    v_sub_f32 v39, v39, v63
    v_sub_f32 v40, v40, v64
    v_sub_f32 v41, v41, v65
    v_sub_f32 v42, v42, v66
    v_sub_f32 v43, v43, v67
    v_sub_f32 v44, v44, v68
    v_sub_f32 v45, v45, v69
    v_sub_f32 v46, v46, v70
    v_sub_f32 v47, v47, v71
    v_cvt_pk_bf16_f32 v36, 0, v36
    v_cvt_pk_bf16_f32 v37, 0, v37
    v_cvt_pk_bf16_f32 v38, 0, v38
    v_cvt_pk_bf16_f32 v39, 0, v39
    v_cvt_pk_bf16_f32 v40, 0, v40
    v_cvt_pk_bf16_f32 v41, 0, v41
    v_cvt_pk_bf16_f32 v42, 0, v42
    v_cvt_pk_bf16_f32 v43, 0, v43
    v_cvt_pk_bf16_f32 v44, 0, v44
    v_cvt_pk_bf16_f32 v45, 0, v45
    v_cvt_pk_bf16_f32 v46, 0, v46
    v_cvt_pk_bf16_f32 v47, 0, v47
    v_mul_f32 v36, v36, v84
    v_mul_f32 v37, v37, v85
    v_mul_f32 v38, v38, v86
    v_mul_f32 v39, v39, v87
    v_mul_f32 v40, v40, v88
    v_mul_f32 v41, v41, v89
    v_mul_f32 v42, v42, v90
    v_mul_f32 v43, v43, v91
    v_mul_f32 v44, v44, v92
    v_mul_f32 v45, v45, v93
    v_mul_f32 v46, v46, v94
    v_mul_f32 v47, v47, v95
    v_cvt_pk_bf16_f32 v132, v36, v37
    v_cvt_pk_bf16_f32 v133, v38, v39
    v_cvt_pk_bf16_f32 v134, v40, v41
    v_cvt_pk_bf16_f32 v135, v42, v43
    v_cvt_pk_bf16_f32 v136, v44, v45
    v_cvt_pk_bf16_f32 v137, v46, v47
    v_mfma_f32_16x16x16_bf16 v[144:147], v[132:133], v[156:157], 0
    v_mfma_f32_16x16x16_bf16 v[144:147], v[134:135], v[158:159], v[144:147]
    v_mfma_f32_16x16x16_bf16 v[144:147], v[136:137], v[160:161], v[144:147]
    s_waitcnt lgkmcnt(0)
    v_cvt_f32_i32 v48, v48
    v_cvt_f32_i32 v49, v49
    v_cvt_f32_i32 v50, v50
    v_cvt_f32_i32 v51, v51
    v_cvt_f32_i32 v52, v52
    v_cvt_f32_i32 v53, v53
    v_cvt_f32_i32 v54, v54
    v_cvt_f32_i32 v55, v55
    v_cvt_f32_i32 v56, v56
    v_cvt_f32_i32 v57, v57
    v_cvt_f32_i32 v58, v58
    v_cvt_f32_i32 v59, v59
    v_sub_f32 v48, v48, v72
    v_sub_f32 v49, v49, v73
    v_sub_f32 v50, v50, v74
    v_sub_f32 v51, v51, v75
    v_sub_f32 v52, v52, v76
    v_sub_f32 v53, v53, v77
    v_sub_f32 v54, v54, v78
    v_sub_f32 v55, v55, v79
    v_sub_f32 v56, v56, v80
    v_sub_f32 v57, v57, v81
    v_sub_f32 v58, v58, v82
    v_sub_f32 v59, v59, v83
    v_cvt_pk_bf16_f32 v48, 0, v48
    v_cvt_pk_bf16_f32 v49, 0, v49
    v_cvt_pk_bf16_f32 v50, 0, v50
    v_cvt_pk_bf16_f32 v51, 0, v51
    v_cvt_pk_bf16_f32 v52, 0, v52
    v_cvt_pk_bf16_f32 v53, 0, v53
    v_cvt_pk_bf16_f32 v54, 0, v54
    v_cvt_pk_bf16_f32 v55, 0, v55
    v_cvt_pk_bf16_f32 v56, 0, v56
    v_cvt_pk_bf16_f32 v57, 0, v57
    v_cvt_pk_bf16_f32 v58, 0, v58
    v_cvt_pk_bf16_f32 v59, 0, v59
    v_mul_f32 v48, v48, v96
    v_mul_f32 v49, v49, v97
    v_mul_f32 v50, v50, v98
    v_mul_f32 v51, v51, v99
    v_mul_f32 v52, v52, v100
    v_mul_f32 v53, v53, v101
    v_mul_f32 v54, v54, v102
    v_mul_f32 v55, v55, v103
    v_mul_f32 v56, v56, v104
    v_mul_f32 v57, v57, v105
    v_mul_f32 v58, v58, v106
    v_mul_f32 v59, v59, v107
    v_cvt_pk_bf16_f32 v138, v48, v49
    v_cvt_pk_bf16_f32 v139, v50, v51
    v_add_f32_dpp v3, v147, v146 row_ror:12 row_mask:0xf bank_mask:0xf
    v_cvt_pk_bf16_f32 v140, v52, v53
    v_cvt_pk_bf16_f32 v141, v54, v55
    v_add_f32_dpp v3, v144, v3 row_ror:8 row_mask:0xf bank_mask:0xf
    v_cvt_pk_bf16_f32 v142, v56, v57
    v_cvt_pk_bf16_f32 v143, v58, v59
    v_add_f32_dpp v15, v145, v3 row_ror:4 row_mask:0xf bank_mask:0x4
    v_mfma_f32_16x16x16_bf16 v[148:151], v[138:139], v[156:157], 0
    v_mfma_f32_16x16x16_bf16 v[148:151], v[140:141], v[158:159], v[148:151]
    v_mfma_f32_16x16x16_bf16 v[148:151], v[142:143], v[160:161], v[148:151]
    v_add_u32 v33, s63, v31
    v_add_u32 v34, s63, v32
    ds_read_b64 v[108:109], v33 offset:0
    ds_read_b64 v[110:111], v33 offset:1536
    ds_read_b64 v[112:113], v33 offset:128
    ds_read_b64 v[114:115], v33 offset:1664
    ds_read_b64 v[116:117], v33 offset:256
    ds_read_b64 v[118:119], v33 offset:1792
    ds_read_b64 v[120:121], v34 offset:0
    v_add_f32_dpp v4, v151, v150 row_ror:12 row_mask:0xf bank_mask:0xf
    ds_read_b64 v[122:123], v34 offset:1536
    ds_read_b64 v[124:125], v34 offset:128
    v_add_f32_dpp v4, v148, v4 row_ror:8 row_mask:0xf bank_mask:0xf
    ds_read_b64 v[126:127], v34 offset:1664
    ds_read_b64 v[128:129], v34 offset:256
    ds_read_b64 v[130:131], v34 offset:1792
    v_add_f32_dpp v16, v149, v4 row_ror:4 row_mask:0xf bank_mask:0x4
    s_waitcnt lgkmcnt(0)
    v_lshlrev_b32 v60, 16, v108
    v_and_b32 v61, s66, v108
    v_lshlrev_b32 v62, 16, v109
    v_and_b32 v63, s66, v109
    v_lshlrev_b32 v84, 16, v110
    v_and_b32 v85, s66, v110
    v_lshlrev_b32 v86, 16, v111
    v_and_b32 v87, s66, v111
    v_lshlrev_b32 v64, 16, v112
    v_and_b32 v65, s66, v112
    v_lshlrev_b32 v66, 16, v113
    v_and_b32 v67, s66, v113
    v_lshlrev_b32 v88, 16, v114
    v_and_b32 v89, s66, v114
    v_lshlrev_b32 v90, 16, v115
    v_and_b32 v91, s66, v115
    v_lshlrev_b32 v68, 16, v116
    v_and_b32 v69, s66, v116
    v_lshlrev_b32 v70, 16, v117
    v_and_b32 v71, s66, v117
    v_lshlrev_b32 v92, 16, v118
    v_and_b32 v93, s66, v118
    v_lshlrev_b32 v94, 16, v119
    v_and_b32 v95, s66, v119
    v_lshlrev_b32 v72, 16, v120
    v_and_b32 v73, s66, v120
    v_lshlrev_b32 v74, 16, v121
    v_and_b32 v75, s66, v121
    v_lshlrev_b32 v96, 16, v122
    v_and_b32 v97, s66, v122
    v_lshlrev_b32 v98, 16, v123
    v_and_b32 v99, s66, v123
    v_lshlrev_b32 v76, 16, v124
    v_and_b32 v77, s66, v124
    v_lshlrev_b32 v78, 16, v125
    v_and_b32 v79, s66, v125
    v_lshlrev_b32 v100, 16, v126
    v_and_b32 v101, s66, v126
    v_lshlrev_b32 v102, 16, v127
    v_and_b32 v103, s66, v127
    v_lshlrev_b32 v80, 16, v128
    v_and_b32 v81, s66, v128
    v_lshlrev_b32 v82, 16, v129
    v_and_b32 v83, s66, v129
    v_lshlrev_b32 v104, 16, v130
    v_and_b32 v105, s66, v130
    v_lshlrev_b32 v106, 16, v131
    v_and_b32 v107, s66, v131
    v_add_u32 v13, s62, v12
    s_add_u32 s62, s62, 24576
    s_cmp_eq_u32 s62, 73728
    s_cselect_b32 s62, 0, s62
    s_barrier
    ds_read_b128 v[36:39], v13 offset:0
    ds_read_b128 v[40:43], v13 offset:1024
    ds_read_b128 v[44:47], v13 offset:2048
    ds_read_b128 v[48:51], v13 offset:3072
    ds_read_b128 v[52:55], v13 offset:4096
    ds_read_b128 v[56:59], v13 offset:5120
    s_waitcnt lgkmcnt(3)
    v_cvt_f32_i32 v36, v36
    v_cvt_f32_i32 v37, v37
    v_cvt_f32_i32 v38, v38
    v_cvt_f32_i32 v39, v39
    v_cvt_f32_i32 v40, v40
    v_cvt_f32_i32 v41, v41
    v_cvt_f32_i32 v42, v42
    v_cvt_f32_i32 v43, v43
    v_cvt_f32_i32 v44, v44
    v_cvt_f32_i32 v45, v45
    v_cvt_f32_i32 v46, v46
    v_cvt_f32_i32 v47, v47
    v_sub_f32 v36, v36, v60
    v_sub_f32 v37, v37, v61
    v_sub_f32 v38, v38, v62
    v_sub_f32 v39, v39, v63
    v_sub_f32 v40, v40, v64
    v_sub_f32 v41, v41, v65
    v_sub_f32 v42, v42, v66
    v_sub_f32 v43, v43, v67
    v_sub_f32 v44, v44, v68
    v_sub_f32 v45, v45, v69
    v_sub_f32 v46, v46, v70
    v_sub_f32 v47, v47, v71
    v_cvt_pk_bf16_f32 v36, 0, v36
    v_cvt_pk_bf16_f32 v37, 0, v37
    v_cvt_pk_bf16_f32 v38, 0, v38
    v_cvt_pk_bf16_f32 v39, 0, v39
    v_cvt_pk_bf16_f32 v40, 0, v40
    v_cvt_pk_bf16_f32 v41, 0, v41
    v_cvt_pk_bf16_f32 v42, 0, v42
    v_cvt_pk_bf16_f32 v43, 0, v43
    v_cvt_pk_bf16_f32 v44, 0, v44
    v_cvt_pk_bf16_f32 v45, 0, v45
    v_cvt_pk_bf16_f32 v46, 0, v46
    v_cvt_pk_bf16_f32 v47, 0, v47
    v_mul_f32 v36, v36, v84
    v_mul_f32 v37, v37, v85
    v_mul_f32 v38, v38, v86
    v_mul_f32 v39, v39, v87
    v_mul_f32 v40, v40, v88
    v_mul_f32 v41, v41, v89
    v_mul_f32 v42, v42, v90
    v_mul_f32 v43, v43, v91
    v_mul_f32 v44, v44, v92
    v_mul_f32 v45, v45, v93
    v_mul_f32 v46, v46, v94
    v_mul_f32 v47, v47, v95
    v_cvt_pk_bf16_f32 v132, v36, v37
    v_cvt_pk_bf16_f32 v133, v38, v39
    v_cvt_pk_bf16_f32 v134, v40, v41
    v_cvt_pk_bf16_f32 v135, v42, v43
    v_cvt_pk_bf16_f32 v136, v44, v45
    v_cvt_pk_bf16_f32 v137, v46, v47
    v_mfma_f32_16x16x16_bf16 v[144:147], v[132:133], v[156:157], 0
    v_mfma_f32_16x16x16_bf16 v[144:147], v[134:135], v[158:159], v[144:147]
    v_mfma_f32_16x16x16_bf16 v[144:147], v[136:137], v[160:161], v[144:147]
    s_waitcnt lgkmcnt(0)
    v_cvt_f32_i32 v48, v48
    v_cvt_f32_i32 v49, v49
    v_cvt_f32_i32 v50, v50
    v_cvt_f32_i32 v51, v51
    v_cvt_f32_i32 v52, v52
    v_cvt_f32_i32 v53, v53
    v_cvt_f32_i32 v54, v54
    v_cvt_f32_i32 v55, v55
    v_cvt_f32_i32 v56, v56
    v_cvt_f32_i32 v57, v57
    v_cvt_f32_i32 v58, v58
    v_cvt_f32_i32 v59, v59
    v_sub_f32 v48, v48, v72
    v_sub_f32 v49, v49, v73
    v_sub_f32 v50, v50, v74
    v_sub_f32 v51, v51, v75
    v_sub_f32 v52, v52, v76
    v_sub_f32 v53, v53, v77
    v_sub_f32 v54, v54, v78
    v_sub_f32 v55, v55, v79
    v_sub_f32 v56, v56, v80
    v_sub_f32 v57, v57, v81
    v_sub_f32 v58, v58, v82
    v_sub_f32 v59, v59, v83
    v_cvt_pk_bf16_f32 v48, 0, v48
    v_cvt_pk_bf16_f32 v49, 0, v49
    v_cvt_pk_bf16_f32 v50, 0, v50
    v_cvt_pk_bf16_f32 v51, 0, v51
    v_cvt_pk_bf16_f32 v52, 0, v52
    v_cvt_pk_bf16_f32 v53, 0, v53
    v_cvt_pk_bf16_f32 v54, 0, v54
    v_cvt_pk_bf16_f32 v55, 0, v55
    v_cvt_pk_bf16_f32 v56, 0, v56
    v_cvt_pk_bf16_f32 v57, 0, v57
    v_cvt_pk_bf16_f32 v58, 0, v58
    v_cvt_pk_bf16_f32 v59, 0, v59
    v_mul_f32 v48, v48, v96
    v_mul_f32 v49, v49, v97
    v_mul_f32 v50, v50, v98
    v_mul_f32 v51, v51, v99
    v_mul_f32 v52, v52, v100
    v_mul_f32 v53, v53, v101
    v_mul_f32 v54, v54, v102
    v_mul_f32 v55, v55, v103
    v_mul_f32 v56, v56, v104
    v_mul_f32 v57, v57, v105
    v_mul_f32 v58, v58, v106
    v_mul_f32 v59, v59, v107
    v_cvt_pk_bf16_f32 v138, v48, v49
    v_cvt_pk_bf16_f32 v139, v50, v51
    v_add_f32_dpp v3, v144, v147 row_ror:12 row_mask:0xf bank_mask:0xf
    v_cvt_pk_bf16_f32 v140, v52, v53
    v_cvt_pk_bf16_f32 v141, v54, v55
    v_add_f32_dpp v3, v145, v3 row_ror:8 row_mask:0xf bank_mask:0xf
    v_cvt_pk_bf16_f32 v142, v56, v57
    v_cvt_pk_bf16_f32 v143, v58, v59
    v_add_f32_dpp v15, v146, v3 row_ror:4 row_mask:0xf bank_mask:0x8
    v_mfma_f32_16x16x16_bf16 v[148:151], v[138:139], v[156:157], 0
    v_mfma_f32_16x16x16_bf16 v[148:151], v[140:141], v[158:159], v[148:151]
    v_mfma_f32_16x16x16_bf16 v[148:151], v[142:143], v[160:161], v[148:151]
    s_add_u32 s63, s63, 3072
    v_add_u32 v33, s63, v17
    v_add_u32 v34, s63, v18
    ds_read_b64 v[108:109], v33 offset:0
    ds_read_b64 v[110:111], v33 offset:1536
    ds_read_b64 v[112:113], v33 offset:128
    ds_read_b64 v[114:115], v33 offset:1664
    ds_read_b64 v[116:117], v33 offset:256
    ds_read_b64 v[118:119], v33 offset:1792
    ds_read_b64 v[120:121], v34 offset:0
    v_add_f32_dpp v4, v148, v151 row_ror:12 row_mask:0xf bank_mask:0xf
    ds_read_b64 v[122:123], v34 offset:1536
    ds_read_b64 v[124:125], v34 offset:128
    v_add_f32_dpp v4, v149, v4 row_ror:8 row_mask:0xf bank_mask:0xf
    ds_read_b64 v[126:127], v34 offset:1664
    ds_read_b64 v[128:129], v34 offset:256
    ds_read_b64 v[130:131], v34 offset:1792
    v_add_f32_dpp v16, v150, v4 row_ror:4 row_mask:0xf bank_mask:0x8
    v_cvt_pk_bf16_f32 v3, 0, v15
    v_cvt_pk_bf16_f32 v4, 0, v16
    v_mul_f32 v3, s65, v3
    v_mul_f32 v4, s65, v4
    v_cvt_pk_bf16_f32 v5, v3, v4
    v_max3_f32 v14, v14, v3, v4
    ds_write_b32 v11, v5 offset:256
    s_waitcnt lgkmcnt(0)
    v_lshlrev_b32 v60, 16, v108
    v_and_b32 v61, s66, v108
    v_lshlrev_b32 v62, 16, v109
    v_and_b32 v63, s66, v109
    v_lshlrev_b32 v84, 16, v110
    v_and_b32 v85, s66, v110
    v_lshlrev_b32 v86, 16, v111
    v_and_b32 v87, s66, v111
    v_lshlrev_b32 v64, 16, v112
    v_and_b32 v65, s66, v112
    v_lshlrev_b32 v66, 16, v113
    v_and_b32 v67, s66, v113
    v_lshlrev_b32 v88, 16, v114
    v_and_b32 v89, s66, v114
    v_lshlrev_b32 v90, 16, v115
    v_and_b32 v91, s66, v115
    v_lshlrev_b32 v68, 16, v116
    v_and_b32 v69, s66, v116
    v_lshlrev_b32 v70, 16, v117
    v_and_b32 v71, s66, v117
    v_lshlrev_b32 v92, 16, v118
    v_and_b32 v93, s66, v118
    v_lshlrev_b32 v94, 16, v119
    v_and_b32 v95, s66, v119
    v_lshlrev_b32 v72, 16, v120
    v_and_b32 v73, s66, v120
    v_lshlrev_b32 v74, 16, v121
    v_and_b32 v75, s66, v121
    v_lshlrev_b32 v96, 16, v122
    v_and_b32 v97, s66, v122
    v_lshlrev_b32 v98, 16, v123
    v_and_b32 v99, s66, v123
    v_lshlrev_b32 v76, 16, v124
    v_and_b32 v77, s66, v124
    v_lshlrev_b32 v78, 16, v125
    v_and_b32 v79, s66, v125
    v_lshlrev_b32 v100, 16, v126
    v_and_b32 v101, s66, v126
    v_lshlrev_b32 v102, 16, v127
    v_and_b32 v103, s66, v127
    v_lshlrev_b32 v80, 16, v128
    v_and_b32 v81, s66, v128
    v_lshlrev_b32 v82, 16, v129
    v_and_b32 v83, s66, v129
    v_lshlrev_b32 v104, 16, v130
    v_and_b32 v105, s66, v130
    v_lshlrev_b32 v106, 16, v131
    v_and_b32 v107, s66, v131
    v_add_u32 v11, 3072, v11
    s_add_u32 s61, s61, 1
    s_cmp_eq_u32 s61, s3
    s_cbranch_scc1 L_kblk_end
    s_cmp_eq_u32 s61, s73
    s_cbranch_scc1 L_kblk_end
    s_cmp_lt_u32 s61, 16
    s_cbranch_scc1 L_kblk
L_kblk_end:
    s_cmp_eq_u32 s74, 0
    s_cselect_b64 vcc, -1, 0
    v_cndmask_b32 v153, v153, v14, vcc
    s_cmp_eq_u32 s74, 1
    s_cselect_b64 vcc, -1, 0
    v_cndmask_b32 v154, v154, v14, vcc
    s_cmp_eq_u32 s74, 2
    s_cselect_b64 vcc, -1, 0
    v_cndmask_b32 v155, v155, v14, vcc
    s_add_u32 s74, s74, 1
    v_mov_b32 v156, v162
    v_mov_b32 v157, v163
    v_mov_b32 v158, v164
    v_mov_b32 v159, v165
    v_mov_b32 v160, v166
    v_mov_b32 v161, v167
    v_mov_b32 v162, v168
    v_mov_b32 v163, v169
    v_mov_b32 v164, v170
    v_mov_b32 v165, v171
    v_mov_b32 v166, v172
    v_mov_b32 v167, v173
    v_mov_b32 v14, 0xff800000
    s_cmp_lt_u32 s61, 16
    s_cbranch_scc1 L_kblk
    v_subrev_u32 v11, 49152, v11
    s_mov_b32 s63, 0
    v_add_u32 v211, s63, v7
    v_add_u32 v212, s63, v8
    ds_read_b32 v210, v11 offset:0
    ds_read_u16 v213, v211 offset:512
    ds_read_u16 v214, v212 offset:512
    ds_read_u16 v211, v211
    ds_read_u16 v212, v212
    v_mov_b32 v204, 0
    v_mov_b32 v205, 0
    v_mov_b32 v206, 0
    v_mov_b32 v207, 0
    s_mov_b32 s61, 0
L_vround:
    v_mov_b32 v14, v153
    v_mov_b32 v153, v154
    v_mov_b32 v154, v155
    v_mov_b32 v156, 0
    v_mov_b32 v157, 0
    v_mov_b32 v158, 0
    v_mov_b32 v159, 0
    v_mov_b32 v160, 0
    v_mov_b32 v161, 0
    v_mov_b32 v162, 0
    v_mov_b32 v163, 0
    v_mov_b32 v164, 0
    v_mov_b32 v165, 0
    v_mov_b32 v166, 0
    v_mov_b32 v167, 0
    v_mov_b32 v168, 0
    v_mov_b32 v169, 0
    v_mov_b32 v170, 0
    v_mov_b32 v171, 0
    v_mov_b32 v172, 0
    v_mov_b32 v173, 0
    v_mov_b32 v174, 0
    v_mov_b32 v175, 0
    v_mov_b32 v176, 0
    v_mov_b32 v177, 0
    v_mov_b32 v178, 0
    v_mov_b32 v179, 0
    v_mov_b32 v180, 0
    v_mov_b32 v181, 0
    v_mov_b32 v182, 0
    v_mov_b32 v183, 0
    v_mov_b32 v184, 0
    v_mov_b32 v185, 0
    v_mov_b32 v186, 0
    v_mov_b32 v187, 0
    v_mov_b32 v188, 0
    v_mov_b32 v189, 0
    v_mov_b32 v190, 0
    v_mov_b32 v191, 0
    v_mov_b32 v192, 0
    v_mov_b32 v193, 0
    v_mov_b32 v194, 0
    v_mov_b32 v195, 0
    v_mov_b32 v196, 0
    v_mov_b32 v197, 0
    v_mov_b32 v198, 0
    v_mov_b32 v199, 0
    v_mov_b32 v200, 0
    v_mov_b32 v201, 0
    v_mov_b32 v202, 0
    v_mov_b32 v203, 0
    v_mov_b32 v208, 0
    v_mov_b32 v209, 0
    s_nop 1
    v_max_f32_dpp v14, v14, v14 row_ror:4 row_mask:0xf bank_mask:0xf
    s_nop 1
    v_max_f32_dpp v14, v14, v14 row_ror:8 row_mask:0xf bank_mask:0xf
    v_mov_b32 v3, v14
    s_nop 1
    v_permlane16_swap_b32 v14, v3
    v_max_f32 v14, v14, v3
    v_mov_b32 v3, v14
    s_nop 1
    v_permlane32_swap_b32 v14, v3
    v_max_f32 v14, v14, v3
    v_cvt_pk_bf16_f32 v14, 0, v14
    v_mul_f32 v14, s64, v14
L_vblk:
    v_add_u32 v13, s62, v12
    s_add_u32 s62, s62, 24576
    s_cmp_eq_u32 s62, 73728
    s_cselect_b32 s62, 0, s62
    s_barrier
    ds_read_b128 v[36:39], v13 offset:0
    ds_read_b128 v[40:43], v13 offset:1024
    ds_read_b128 v[44:47], v13 offset:2048
    ds_read_b128 v[48:51], v13 offset:3072
    ds_read_b128 v[52:55], v13 offset:4096
    ds_read_b128 v[56:59], v13 offset:5120
    s_waitcnt lgkmcnt(6)
    v_lshlrev_b32 v215, 16, v210
    v_and_b32 v216, s66, v210
    v_fma_f32 v215, v215, s64, -v14
    v_fma_f32 v216, v216, s64, -v14
    v_exp_f32 v215, v215
    v_exp_f32 v216, v216
    v_lshlrev_b32 v217, 16, v211
    v_lshlrev_b32 v218, 16, v212
    v_mul_f32 v217, v215, v217
    v_mul_f32 v218, v216, v218
    v_add_f32 v208, v208, v215
    v_cvt_pk_bf16_f32 v217, v217, v218
    v_add_f32 v208, v208, v216
    v_lshlrev_b32 v219, 16, v213
    v_lshlrev_b32 v220, 16, v214
    v_lshlrev_b32 v215, 16, v217
    v_and_b32 v216, s66, v217
    v_fmac_f32 v209, v215, v219
    v_fmac_f32 v209, v216, v220
    v_mov_b32_dpp v204, v217 quad_perm:[0,1,2,3] row_mask:0xf bank_mask:0x1
    v_mov_b32_dpp v205, v217 quad_perm:[0,1,2,3] row_mask:0xf bank_mask:0x2
    v_mov_b32_dpp v206, v217 quad_perm:[0,1,2,3] row_mask:0xf bank_mask:0x4
    v_mov_b32_dpp v207, v217 quad_perm:[0,1,2,3] row_mask:0xf bank_mask:0x8
    s_waitcnt lgkmcnt(3)
    v_cvt_f32_i32 v36, v36
    v_cvt_f32_i32 v37, v37
    v_cvt_f32_i32 v38, v38
    v_cvt_f32_i32 v39, v39
    v_cvt_f32_i32 v40, v40
    v_cvt_f32_i32 v41, v41
    v_cvt_f32_i32 v42, v42
    v_cvt_f32_i32 v43, v43
    v_cvt_f32_i32 v44, v44
    v_cvt_f32_i32 v45, v45
    v_cvt_f32_i32 v46, v46
    v_cvt_f32_i32 v47, v47
    s_waitcnt lgkmcnt(0)
    v_cvt_f32_i32 v48, v48
    v_cvt_f32_i32 v49, v49
    v_cvt_f32_i32 v50, v50
    v_cvt_f32_i32 v51, v51
    v_cvt_f32_i32 v52, v52
    v_cvt_f32_i32 v53, v53
    v_cvt_f32_i32 v54, v54
    v_cvt_f32_i32 v55, v55
    v_cvt_f32_i32 v56, v56
    v_cvt_f32_i32 v57, v57
    v_cvt_f32_i32 v58, v58
    v_cvt_f32_i32 v59, v59
    v_cvt_pk_bf16_f32 v60, v36, v48
    v_cvt_pk_bf16_f32 v64, v37, v49
    v_cvt_pk_bf16_f32 v68, v38, v50
    v_cvt_pk_bf16_f32 v72, v39, v51
    v_cvt_pk_bf16_f32 v76, v40, v52
    v_cvt_pk_bf16_f32 v80, v41, v53
    v_cvt_pk_bf16_f32 v84, v42, v54
    v_cvt_pk_bf16_f32 v88, v43, v55
    v_cvt_pk_bf16_f32 v92, v44, v56
    v_cvt_pk_bf16_f32 v96, v45, v57
    v_cvt_pk_bf16_f32 v100, v46, v58
    v_cvt_pk_bf16_f32 v104, v47, v59
    v_add_u32 v211, s63, v9
    v_add_u32 v212, s63, v10
    ds_read_b32 v210, v11 offset:256
    ds_read_u16 v213, v211 offset:512
    ds_read_u16 v214, v212 offset:512
    ds_read_u16 v211, v211
    ds_read_u16 v212, v212
    v_add_u32 v13, s62, v12
    s_add_u32 s62, s62, 24576
    s_cmp_eq_u32 s62, 73728
    s_cselect_b32 s62, 0, s62
    s_barrier
    ds_read_b128 v[36:39], v13 offset:0
    ds_read_b128 v[40:43], v13 offset:1024
    ds_read_b128 v[44:47], v13 offset:2048
    ds_read_b128 v[48:51], v13 offset:3072
    ds_read_b128 v[52:55], v13 offset:4096
    ds_read_b128 v[56:59], v13 offset:5120
    s_waitcnt lgkmcnt(3)
    v_cvt_f32_i32 v36, v36
    v_cvt_f32_i32 v37, v37
    v_cvt_f32_i32 v38, v38
    v_cvt_f32_i32 v39, v39
    v_cvt_f32_i32 v40, v40
    v_cvt_f32_i32 v41, v41
    v_cvt_f32_i32 v42, v42
    v_cvt_f32_i32 v43, v43
    v_cvt_f32_i32 v44, v44
    v_cvt_f32_i32 v45, v45
    v_cvt_f32_i32 v46, v46
    v_cvt_f32_i32 v47, v47
    s_waitcnt lgkmcnt(0)
    v_cvt_f32_i32 v48, v48
    v_cvt_f32_i32 v49, v49
    v_cvt_f32_i32 v50, v50
    v_cvt_f32_i32 v51, v51
    v_cvt_f32_i32 v52, v52
    v_cvt_f32_i32 v53, v53
    v_cvt_f32_i32 v54, v54
    v_cvt_f32_i32 v55, v55
    v_cvt_f32_i32 v56, v56
    v_cvt_f32_i32 v57, v57
    v_cvt_f32_i32 v58, v58
    v_cvt_f32_i32 v59, v59
    v_cvt_pk_bf16_f32 v61, v36, v48
    v_cvt_pk_bf16_f32 v65, v37, v49
    v_cvt_pk_bf16_f32 v69, v38, v50
    v_cvt_pk_bf16_f32 v73, v39, v51
    v_cvt_pk_bf16_f32 v77, v40, v52
    v_cvt_pk_bf16_f32 v81, v41, v53
    v_cvt_pk_bf16_f32 v85, v42, v54
    v_cvt_pk_bf16_f32 v89, v43, v55
    v_cvt_pk_bf16_f32 v93, v44, v56
    v_cvt_pk_bf16_f32 v97, v45, v57
    v_cvt_pk_bf16_f32 v101, v46, v58
    v_cvt_pk_bf16_f32 v105, v47, v59
    v_add_u32 v13, s62, v12
    s_add_u32 s62, s62, 24576
    s_cmp_eq_u32 s62, 73728
    s_cselect_b32 s62, 0, s62
    s_barrier
    ds_read_b128 v[36:39], v13 offset:0
    ds_read_b128 v[40:43], v13 offset:1024
    ds_read_b128 v[44:47], v13 offset:2048
    ds_read_b128 v[48:51], v13 offset:3072
    ds_read_b128 v[52:55], v13 offset:4096
    ds_read_b128 v[56:59], v13 offset:5120
    s_waitcnt lgkmcnt(3)
    v_cvt_f32_i32 v36, v36
    v_cvt_f32_i32 v37, v37
    v_cvt_f32_i32 v38, v38
    v_cvt_f32_i32 v39, v39
    v_cvt_f32_i32 v40, v40
    v_cvt_f32_i32 v41, v41
    v_cvt_f32_i32 v42, v42
    v_cvt_f32_i32 v43, v43
    v_cvt_f32_i32 v44, v44
    v_cvt_f32_i32 v45, v45
    v_cvt_f32_i32 v46, v46
    v_cvt_f32_i32 v47, v47
    s_waitcnt lgkmcnt(0)
    v_cvt_f32_i32 v48, v48
    v_cvt_f32_i32 v49, v49
    v_cvt_f32_i32 v50, v50
    v_cvt_f32_i32 v51, v51
    v_cvt_f32_i32 v52, v52
    v_cvt_f32_i32 v53, v53
    v_cvt_f32_i32 v54, v54
    v_cvt_f32_i32 v55, v55
    v_cvt_f32_i32 v56, v56
    v_cvt_f32_i32 v57, v57
    v_cvt_f32_i32 v58, v58
    v_cvt_f32_i32 v59, v59
    v_cvt_pk_bf16_f32 v62, v36, v48
    v_cvt_pk_bf16_f32 v66, v37, v49
    v_cvt_pk_bf16_f32 v70, v38, v50
    v_cvt_pk_bf16_f32 v74, v39, v51
    v_cvt_pk_bf16_f32 v78, v40, v52
    v_cvt_pk_bf16_f32 v82, v41, v53
    v_cvt_pk_bf16_f32 v86, v42, v54
    v_cvt_pk_bf16_f32 v90, v43, v55
    v_cvt_pk_bf16_f32 v94, v44, v56
    v_cvt_pk_bf16_f32 v98, v45, v57
    v_cvt_pk_bf16_f32 v102, v46, v58
    v_cvt_pk_bf16_f32 v106, v47, v59
    v_add_u32 v13, s62, v12
    s_add_u32 s62, s62, 24576
    s_cmp_eq_u32 s62, 73728
    s_cselect_b32 s62, 0, s62
    s_barrier
    ds_read_b128 v[36:39], v13 offset:0
    ds_read_b128 v[40:43], v13 offset:1024
    ds_read_b128 v[44:47], v13 offset:2048
    ds_read_b128 v[48:51], v13 offset:3072
    ds_read_b128 v[52:55], v13 offset:4096
    ds_read_b128 v[56:59], v13 offset:5120
    s_waitcnt lgkmcnt(3)
    v_cvt_f32_i32 v36, v36
    v_cvt_f32_i32 v37, v37
    v_cvt_f32_i32 v38, v38
    v_cvt_f32_i32 v39, v39
    v_cvt_f32_i32 v40, v40
    v_cvt_f32_i32 v41, v41
    v_cvt_f32_i32 v42, v42
    v_cvt_f32_i32 v43, v43
    v_cvt_f32_i32 v44, v44
    v_cvt_f32_i32 v45, v45
    v_cvt_f32_i32 v46, v46
    v_cvt_f32_i32 v47, v47
    s_waitcnt lgkmcnt(0)
    v_cvt_f32_i32 v48, v48
    v_cvt_f32_i32 v49, v49
    v_cvt_f32_i32 v50, v50
    v_cvt_f32_i32 v51, v51
    v_cvt_f32_i32 v52, v52
    v_cvt_f32_i32 v53, v53
    v_cvt_f32_i32 v54, v54
    v_cvt_f32_i32 v55, v55
    v_cvt_f32_i32 v56, v56
    v_cvt_f32_i32 v57, v57
    v_cvt_f32_i32 v58, v58
    v_cvt_f32_i32 v59, v59
    v_cvt_pk_bf16_f32 v63, v36, v48
    v_cvt_pk_bf16_f32 v67, v37, v49
    v_cvt_pk_bf16_f32 v71, v38, v50
    v_cvt_pk_bf16_f32 v75, v39, v51
    v_cvt_pk_bf16_f32 v79, v40, v52
    v_cvt_pk_bf16_f32 v83, v41, v53
    v_cvt_pk_bf16_f32 v87, v42, v54
    v_cvt_pk_bf16_f32 v91, v43, v55
    v_cvt_pk_bf16_f32 v95, v44, v56
    v_cvt_pk_bf16_f32 v99, v45, v57
    v_cvt_pk_bf16_f32 v103, v46, v58
    v_cvt_pk_bf16_f32 v107, v47, v59
    v_mfma_f32_16x16x32_bf16 v[156:159], v[204:207], v[60:63], v[156:159]
    v_mfma_f32_16x16x32_bf16 v[160:163], v[204:207], v[64:67], v[160:163]
    v_mfma_f32_16x16x32_bf16 v[164:167], v[204:207], v[68:71], v[164:167]
    v_mfma_f32_16x16x32_bf16 v[168:171], v[204:207], v[72:75], v[168:171]
    v_mfma_f32_16x16x32_bf16 v[172:175], v[204:207], v[76:79], v[172:175]
    v_mfma_f32_16x16x32_bf16 v[176:179], v[204:207], v[80:83], v[176:179]
    v_mfma_f32_16x16x32_bf16 v[180:183], v[204:207], v[84:87], v[180:183]
    v_mfma_f32_16x16x32_bf16 v[184:187], v[204:207], v[88:91], v[184:187]
    v_mfma_f32_16x16x32_bf16 v[188:191], v[204:207], v[92:95], v[188:191]
    v_mfma_f32_16x16x32_bf16 v[192:195], v[204:207], v[96:99], v[192:195]
    v_mfma_f32_16x16x32_bf16 v[196:199], v[204:207], v[100:103], v[196:199]
    v_mfma_f32_16x16x32_bf16 v[200:203], v[204:207], v[104:107], v[200:203]
    v_add_u32 v13, s62, v12
    s_add_u32 s62, s62, 24576
    s_cmp_eq_u32 s62, 73728
    s_cselect_b32 s62, 0, s62
    s_barrier
    ds_read_b128 v[36:39], v13 offset:0
    ds_read_b128 v[40:43], v13 offset:1024
    ds_read_b128 v[44:47], v13 offset:2048
    ds_read_b128 v[48:51], v13 offset:3072
    ds_read_b128 v[52:55], v13 offset:4096
    ds_read_b128 v[56:59], v13 offset:5120
    s_waitcnt lgkmcnt(6)
    v_lshlrev_b32 v215, 16, v210
    v_and_b32 v216, s66, v210
    v_fma_f32 v215, v215, s64, -v14
    v_fma_f32 v216, v216, s64, -v14
    v_exp_f32 v215, v215
    v_exp_f32 v216, v216
    v_lshlrev_b32 v217, 16, v211
    v_lshlrev_b32 v218, 16, v212
    v_mul_f32 v217, v215, v217
    v_mul_f32 v218, v216, v218
    v_add_f32 v208, v208, v215
    v_cvt_pk_bf16_f32 v217, v217, v218
    v_add_f32 v208, v208, v216
    v_lshlrev_b32 v219, 16, v213
    v_lshlrev_b32 v220, 16, v214
    v_lshlrev_b32 v215, 16, v217
    v_and_b32 v216, s66, v217
    v_fmac_f32 v209, v215, v219
    v_fmac_f32 v209, v216, v220
    v_mov_b32_dpp v204, v217 quad_perm:[0,1,2,3] row_mask:0xf bank_mask:0x1
    v_mov_b32_dpp v205, v217 quad_perm:[0,1,2,3] row_mask:0xf bank_mask:0x2
    v_mov_b32_dpp v206, v217 quad_perm:[0,1,2,3] row_mask:0xf bank_mask:0x4
    v_mov_b32_dpp v207, v217 quad_perm:[0,1,2,3] row_mask:0xf bank_mask:0x8
    s_waitcnt lgkmcnt(3)
    v_cvt_f32_i32 v36, v36
    v_cvt_f32_i32 v37, v37
    v_cvt_f32_i32 v38, v38
    v_cvt_f32_i32 v39, v39
    v_cvt_f32_i32 v40, v40
    v_cvt_f32_i32 v41, v41
    v_cvt_f32_i32 v42, v42
    v_cvt_f32_i32 v43, v43
    v_cvt_f32_i32 v44, v44
    v_cvt_f32_i32 v45, v45
    v_cvt_f32_i32 v46, v46
    v_cvt_f32_i32 v47, v47
    s_waitcnt lgkmcnt(0)
    v_cvt_f32_i32 v48, v48
    v_cvt_f32_i32 v49, v49
    v_cvt_f32_i32 v50, v50
    v_cvt_f32_i32 v51, v51
    v_cvt_f32_i32 v52, v52
    v_cvt_f32_i32 v53, v53
    v_cvt_f32_i32 v54, v54
    v_cvt_f32_i32 v55, v55
    v_cvt_f32_i32 v56, v56
    v_cvt_f32_i32 v57, v57
    v_cvt_f32_i32 v58, v58
    v_cvt_f32_i32 v59, v59
    v_cvt_pk_bf16_f32 v60, v36, v48
    v_cvt_pk_bf16_f32 v64, v37, v49
    v_cvt_pk_bf16_f32 v68, v38, v50
    v_cvt_pk_bf16_f32 v72, v39, v51
    v_cvt_pk_bf16_f32 v76, v40, v52
    v_cvt_pk_bf16_f32 v80, v41, v53
    v_cvt_pk_bf16_f32 v84, v42, v54
    v_cvt_pk_bf16_f32 v88, v43, v55
    v_cvt_pk_bf16_f32 v92, v44, v56
    v_cvt_pk_bf16_f32 v96, v45, v57
    v_cvt_pk_bf16_f32 v100, v46, v58
    v_cvt_pk_bf16_f32 v104, v47, v59
    v_add_u32 v11, 3072, v11
    s_add_u32 s63, s63, 1024
    v_add_u32 v211, s63, v7
    v_add_u32 v212, s63, v8
    ds_read_b32 v210, v11 offset:0
    ds_read_u16 v213, v211 offset:512
    ds_read_u16 v214, v212 offset:512
    ds_read_u16 v211, v211
    ds_read_u16 v212, v212
    v_add_u32 v13, s62, v12
    s_add_u32 s62, s62, 24576
    s_cmp_eq_u32 s62, 73728
    s_cselect_b32 s62, 0, s62
    s_barrier
    ds_read_b128 v[36:39], v13 offset:0
    ds_read_b128 v[40:43], v13 offset:1024
    ds_read_b128 v[44:47], v13 offset:2048
    ds_read_b128 v[48:51], v13 offset:3072
    ds_read_b128 v[52:55], v13 offset:4096
    ds_read_b128 v[56:59], v13 offset:5120
    s_waitcnt lgkmcnt(3)
    v_cvt_f32_i32 v36, v36
    v_cvt_f32_i32 v37, v37
    v_cvt_f32_i32 v38, v38
    v_cvt_f32_i32 v39, v39
    v_cvt_f32_i32 v40, v40
    v_cvt_f32_i32 v41, v41
    v_cvt_f32_i32 v42, v42
    v_cvt_f32_i32 v43, v43
    v_cvt_f32_i32 v44, v44
    v_cvt_f32_i32 v45, v45
    v_cvt_f32_i32 v46, v46
    v_cvt_f32_i32 v47, v47
    s_waitcnt lgkmcnt(0)
    v_cvt_f32_i32 v48, v48
    v_cvt_f32_i32 v49, v49
    v_cvt_f32_i32 v50, v50
    v_cvt_f32_i32 v51, v51
    v_cvt_f32_i32 v52, v52
    v_cvt_f32_i32 v53, v53
    v_cvt_f32_i32 v54, v54
    v_cvt_f32_i32 v55, v55
    v_cvt_f32_i32 v56, v56
    v_cvt_f32_i32 v57, v57
    v_cvt_f32_i32 v58, v58
    v_cvt_f32_i32 v59, v59
    v_cvt_pk_bf16_f32 v61, v36, v48
    v_cvt_pk_bf16_f32 v65, v37, v49
    v_cvt_pk_bf16_f32 v69, v38, v50
    v_cvt_pk_bf16_f32 v73, v39, v51
    v_cvt_pk_bf16_f32 v77, v40, v52
    v_cvt_pk_bf16_f32 v81, v41, v53
    v_cvt_pk_bf16_f32 v85, v42, v54
    v_cvt_pk_bf16_f32 v89, v43, v55
    v_cvt_pk_bf16_f32 v93, v44, v56
    v_cvt_pk_bf16_f32 v97, v45, v57
    v_cvt_pk_bf16_f32 v101, v46, v58
    v_cvt_pk_bf16_f32 v105, v47, v59
    v_add_u32 v13, s62, v12
    s_add_u32 s62, s62, 24576
    s_cmp_eq_u32 s62, 73728
    s_cselect_b32 s62, 0, s62
    s_barrier
    ds_read_b128 v[36:39], v13 offset:0
    ds_read_b128 v[40:43], v13 offset:1024
    ds_read_b128 v[44:47], v13 offset:2048
    ds_read_b128 v[48:51], v13 offset:3072
    ds_read_b128 v[52:55], v13 offset:4096
    ds_read_b128 v[56:59], v13 offset:5120
    s_waitcnt lgkmcnt(3)
    v_cvt_f32_i32 v36, v36
    v_cvt_f32_i32 v37, v37
    v_cvt_f32_i32 v38, v38
    v_cvt_f32_i32 v39, v39
    v_cvt_f32_i32 v40, v40
    v_cvt_f32_i32 v41, v41
    v_cvt_f32_i32 v42, v42
    v_cvt_f32_i32 v43, v43
    v_cvt_f32_i32 v44, v44
    v_cvt_f32_i32 v45, v45
    v_cvt_f32_i32 v46, v46
    v_cvt_f32_i32 v47, v47
    s_waitcnt lgkmcnt(0)
    v_cvt_f32_i32 v48, v48
    v_cvt_f32_i32 v49, v49
    v_cvt_f32_i32 v50, v50
    v_cvt_f32_i32 v51, v51
    v_cvt_f32_i32 v52, v52
    v_cvt_f32_i32 v53, v53
    v_cvt_f32_i32 v54, v54
    v_cvt_f32_i32 v55, v55
    v_cvt_f32_i32 v56, v56
    v_cvt_f32_i32 v57, v57
    v_cvt_f32_i32 v58, v58
    v_cvt_f32_i32 v59, v59
    v_cvt_pk_bf16_f32 v62, v36, v48
    v_cvt_pk_bf16_f32 v66, v37, v49
    v_cvt_pk_bf16_f32 v70, v38, v50
    v_cvt_pk_bf16_f32 v74, v39, v51
    v_cvt_pk_bf16_f32 v78, v40, v52
    v_cvt_pk_bf16_f32 v82, v41, v53
    v_cvt_pk_bf16_f32 v86, v42, v54
    v_cvt_pk_bf16_f32 v90, v43, v55
    v_cvt_pk_bf16_f32 v94, v44, v56
    v_cvt_pk_bf16_f32 v98, v45, v57
    v_cvt_pk_bf16_f32 v102, v46, v58
    v_cvt_pk_bf16_f32 v106, v47, v59
    v_add_u32 v13, s62, v12
    s_add_u32 s62, s62, 24576
    s_cmp_eq_u32 s62, 73728
    s_cselect_b32 s62, 0, s62
    s_barrier
    ds_read_b128 v[36:39], v13 offset:0
    ds_read_b128 v[40:43], v13 offset:1024
    ds_read_b128 v[44:47], v13 offset:2048
    ds_read_b128 v[48:51], v13 offset:3072
    ds_read_b128 v[52:55], v13 offset:4096
    ds_read_b128 v[56:59], v13 offset:5120
    s_waitcnt lgkmcnt(3)
    v_cvt_f32_i32 v36, v36
    v_cvt_f32_i32 v37, v37
    v_cvt_f32_i32 v38, v38
    v_cvt_f32_i32 v39, v39
    v_cvt_f32_i32 v40, v40
    v_cvt_f32_i32 v41, v41
    v_cvt_f32_i32 v42, v42
    v_cvt_f32_i32 v43, v43
    v_cvt_f32_i32 v44, v44
    v_cvt_f32_i32 v45, v45
    v_cvt_f32_i32 v46, v46
    v_cvt_f32_i32 v47, v47
    s_waitcnt lgkmcnt(0)
    v_cvt_f32_i32 v48, v48
    v_cvt_f32_i32 v49, v49
    v_cvt_f32_i32 v50, v50
    v_cvt_f32_i32 v51, v51
    v_cvt_f32_i32 v52, v52
    v_cvt_f32_i32 v53, v53
    v_cvt_f32_i32 v54, v54
    v_cvt_f32_i32 v55, v55
    v_cvt_f32_i32 v56, v56
    v_cvt_f32_i32 v57, v57
    v_cvt_f32_i32 v58, v58
    v_cvt_f32_i32 v59, v59
    v_cvt_pk_bf16_f32 v63, v36, v48
    v_cvt_pk_bf16_f32 v67, v37, v49
    v_cvt_pk_bf16_f32 v71, v38, v50
    v_cvt_pk_bf16_f32 v75, v39, v51
    v_cvt_pk_bf16_f32 v79, v40, v52
    v_cvt_pk_bf16_f32 v83, v41, v53
    v_cvt_pk_bf16_f32 v87, v42, v54
    v_cvt_pk_bf16_f32 v91, v43, v55
    v_cvt_pk_bf16_f32 v95, v44, v56
    v_cvt_pk_bf16_f32 v99, v45, v57
    v_cvt_pk_bf16_f32 v103, v46, v58
    v_cvt_pk_bf16_f32 v107, v47, v59
    v_mfma_f32_16x16x32_bf16 v[156:159], v[204:207], v[60:63], v[156:159]
    v_mfma_f32_16x16x32_bf16 v[160:163], v[204:207], v[64:67], v[160:163]
    v_mfma_f32_16x16x32_bf16 v[164:167], v[204:207], v[68:71], v[164:167]
    v_mfma_f32_16x16x32_bf16 v[168:171], v[204:207], v[72:75], v[168:171]
    v_mfma_f32_16x16x32_bf16 v[172:175], v[204:207], v[76:79], v[172:175]
    v_mfma_f32_16x16x32_bf16 v[176:179], v[204:207], v[80:83], v[176:179]
    v_mfma_f32_16x16x32_bf16 v[180:183], v[204:207], v[84:87], v[180:183]
    v_mfma_f32_16x16x32_bf16 v[184:187], v[204:207], v[88:91], v[184:187]
    v_mfma_f32_16x16x32_bf16 v[188:191], v[204:207], v[92:95], v[188:191]
    v_mfma_f32_16x16x32_bf16 v[192:195], v[204:207], v[96:99], v[192:195]
    v_mfma_f32_16x16x32_bf16 v[196:199], v[204:207], v[100:103], v[196:199]
    v_mfma_f32_16x16x32_bf16 v[200:203], v[204:207], v[104:107], v[200:203]
    s_add_u32 s61, s61, 1
    s_cmp_eq_u32 s61, s3
    s_cbranch_scc1 L_vblk_end
    s_cmp_eq_u32 s61, s73
    s_cbranch_scc1 L_vblk_end
    s_cmp_lt_u32 s61, 16
    s_cbranch_scc1 L_vblk
L_vblk_end:
    s_nop 1
    v_add_f32_dpp v208, v208, v208 row_ror:4 row_mask:0xf bank_mask:0xf
    s_nop 1
    v_add_f32_dpp v208, v208, v208 row_ror:8 row_mask:0xf bank_mask:0xf
    v_mov_b32 v3, v208
    s_nop 1
    v_permlane16_swap_b32 v208, v3
    v_add_f32 v208, v208, v3
    v_mov_b32 v3, v208
    s_nop 1
    v_permlane32_swap_b32 v208, v3
    v_add_f32 v208, v208, v3
    s_nop 1
    v_add_f32_dpp v209, v209, v209 row_ror:4 row_mask:0xf bank_mask:0xf
    s_nop 1
    v_add_f32_dpp v209, v209, v209 row_ror:8 row_mask:0xf bank_mask:0xf
    v_mov_b32 v3, v209
    s_nop 1
    v_permlane16_swap_b32 v209, v3
    v_add_f32 v209, v209, v3
    v_mov_b32 v3, v209
    s_nop 1
    v_permlane32_swap_b32 v209, v3
    v_add_f32 v209, v209, v3
    v_mov_b32 v36, v14
    v_mov_b32 v37, v208
    v_mov_b32 v38, v209
    v_mov_b32 v39, 0
    v_and_b32 v4, 3, v1
    v_lshl_add_u32 v4, v2, 2, v4
    v_lshlrev_b32 v4, 4, v4
    v_add_u32 v4, 142336, v4
    ds_write_b128 v4, v[36:39]
    v_permlane32_swap_b32 v156, v158
    v_permlane32_swap_b32 v157, v159
    v_permlane32_swap_b32 v160, v162
    v_permlane32_swap_b32 v161, v163
    v_permlane32_swap_b32 v164, v166
    v_permlane32_swap_b32 v165, v167
    v_permlane32_swap_b32 v168, v170
    v_permlane32_swap_b32 v169, v171
    v_permlane32_swap_b32 v172, v174
    v_permlane32_swap_b32 v173, v175
    v_permlane32_swap_b32 v176, v178
    v_permlane32_swap_b32 v177, v179
    v_permlane32_swap_b32 v180, v182
    v_permlane32_swap_b32 v181, v183
    v_permlane32_swap_b32 v184, v186
    v_permlane32_swap_b32 v185, v187
    v_permlane32_swap_b32 v188, v190
    v_permlane32_swap_b32 v189, v191
    v_permlane32_swap_b32 v192, v194
    v_permlane32_swap_b32 v193, v195
    v_permlane32_swap_b32 v196, v198
    v_permlane32_swap_b32 v197, v199
    v_permlane32_swap_b32 v200, v202
    v_permlane32_swap_b32 v201, v203
    v_add_f32 v156, v156, v158
    v_add_f32 v157, v157, v159
    v_add_f32 v160, v160, v162
    v_add_f32 v161, v161, v163
    v_add_f32 v164, v164, v166
    v_add_f32 v165, v165, v167
    v_add_f32 v168, v168, v170
    v_add_f32 v169, v169, v171
    v_add_f32 v172, v172, v174
    v_add_f32 v173, v173, v175
    v_add_f32 v176, v176, v178
    v_add_f32 v177, v177, v179
    v_add_f32 v180, v180, v182
    v_add_f32 v181, v181, v183
    v_add_f32 v184, v184, v186
    v_add_f32 v185, v185, v187
    v_add_f32 v188, v188, v190
    v_add_f32 v189, v189, v191
    v_add_f32 v192, v192, v194
    v_add_f32 v193, v193, v195
    v_add_f32 v196, v196, v198
    v_add_f32 v197, v197, v199
    v_add_f32 v200, v200, v202
    v_add_f32 v201, v201, v203
    s_nop 1
    v_permlane16_swap_b32 v156, v157
    v_permlane16_swap_b32 v160, v161
    v_permlane16_swap_b32 v164, v165
    v_permlane16_swap_b32 v168, v169
    v_permlane16_swap_b32 v172, v173
    v_permlane16_swap_b32 v176, v177
    v_permlane16_swap_b32 v180, v181
    v_permlane16_swap_b32 v184, v185
    v_permlane16_swap_b32 v188, v189
    v_permlane16_swap_b32 v192, v193
    v_permlane16_swap_b32 v196, v197
    v_permlane16_swap_b32 v200, v201
    v_add_f32 v40, v156, v157
    v_add_f32 v41, v160, v161
    v_add_f32 v42, v164, v165
    v_add_f32 v43, v168, v169
    v_add_f32 v44, v172, v173
    v_add_f32 v45, v176, v177
    v_add_f32 v46, v180, v181
    v_add_f32 v47, v184, v185
    v_add_f32 v48, v188, v189
    v_add_f32 v49, v192, v193
    v_add_f32 v50, v196, v197
    v_add_f32 v51, v200, v201
    v_lshrrev_b32 v3, 4, v1
    v_mul_u32_u24 v3, 768, v3
    v_and_b32 v4, 15, v1
    v_lshl_add_u32 v3, v4, 4, v3
    v_mul_u32_u24 v4, 3072, v2
    s_mov_b32 s58, 142592
    v_add3_u32 v4, v4, v3, s58
    ds_write_b128 v4, v[40:43] offset:0
    ds_write_b128 v4, v[44:47] offset:256
    ds_write_b128 v4, v[48:51] offset:512
    s_waitcnt lgkmcnt(0)
    s_cmp_lt_u32 s61, 16
    s_cbranch_scc1 L_vround
    s_barrier
    s_branch L_fin
L_finisher:
    v_lshrrev_b32 v8, 4, v1
    v_mul_u32_u24 v8, 768, v8
    v_and_b32 v13, 15, v1
    v_lshl_add_u32 v8, v13, 4, v8
    v_lshlrev_b32 v9, 4, v1
    v_and_b32 v14, 48, v1
    s_memrealtime s[96:97]
    s_waitcnt lgkmcnt(0)
    s_mov_b32 s48, s18
    s_and_b32 s49, s19, 0xffff
    s_mov_b32 s50, 393216
    s_mov_b32 s51, 0x20000
    s_mov_b32 s52, s20
    s_and_b32 s53, s21, 0xffff
    s_mov_b32 s54, 256
    s_mov_b32 s55, 0x20000
    s_mov_b32 s24, s22
    s_and_b32 s25, s23, 0xffff
    s_mov_b32 s26, 2611200
    s_mov_b32 s27, 0x20000
    s_cmp_eq_u32 s2, 0
    s_cbranch_scc0 L_fk
    s_or_b32 s71, s96, 1
    v_mov_b32 v16, s71
    v_mov_b32 v17, 0
    s_mov_b64 exec, 1
    buffer_atomic_cmpswap v[16:17], v9, s[52:55], 0 offen sc0 sc1
    s_mov_b64 exec, -1
    s_waitcnt vmcnt(0)
    v_readfirstlane_b32 s58, v16
    s_nop 3
    s_cmp_eq_u32 s58, 0
    s_cselect_b32 s71, s71, s58
L_fk:
    s_movk_i32 s69, 128
L_fb1:
    s_barrier
    s_sub_u32 s69, s69, 1
    s_cmp_lg_u32 s69, 0
    s_cbranch_scc1 L_fb1
    s_load_dword s71, s[20:21], 0
    s_barrier
    s_waitcnt lgkmcnt(0)
    s_cmp_eq_u32 s71, 0
    s_cbranch_scc0 L_ftag
    s_or_b32 s71, s96, 1
    v_mov_b32 v16, s71
    v_mov_b32 v17, 0
    s_mov_b64 exec, 1
    buffer_atomic_cmpswap v[16:17], v9, s[52:55], 0 offen sc0 sc1
    s_mov_b64 exec, -1
    s_waitcnt vmcnt(0)
    v_readfirstlane_b32 s58, v16
    s_nop 3
    s_cmp_eq_u32 s58, 0
    s_cselect_b32 s71, s71, s58
L_ftag:
    v_mov_b32 v10, s71
    s_mul_i32 s68, s100, 13056
    s_lshr_b32 s63, s101, 1
    s_lshl_b32 s58, s100, 1
    s_add_u32 s63, s63, s58
    s_mul_i32 s62, s63, 8704
    s_add_u32 s62, s62, 1114112
    s_cmp_eq_u32 s2, 255
    s_cbranch_scc1 L_fsolo
    s_cmp_eq_u32 s101, 1
    s_cbranch_scc1 L_fmid
    s_movk_i32 s69, 89
L_fb2:
    s_barrier
    s_sub_u32 s69, s69, 1
    s_cmp_lg_u32 s69, 0
    s_cbranch_scc1 L_fb2
    v_add_u32 v13, 142336, v14
    v_add_u32 v11, 142592, v8
    ds_read_b128 v[16:19], v13 offset:0
    ds_read_b128 v[20:23], v13 offset:64
    ds_read_b128 v[24:27], v13 offset:128
    ds_read_b128 v[28:31], v13 offset:192
    ds_read_b128 v[32:35], v11 offset:0
    ds_read_b128 v[36:39], v11 offset:256
    ds_read_b128 v[40:43], v11 offset:512
    ds_read_b128 v[44:47], v11 offset:3072
    ds_read_b128 v[48:51], v11 offset:3328
    ds_read_b128 v[52:55], v11 offset:3584
    ds_read_b128 v[56:59], v11 offset:6144
    ds_read_b128 v[60:63], v11 offset:6400
    ds_read_b128 v[64:67], v11 offset:6656
    s_waitcnt lgkmcnt(9)
    ds_read_b128 v[68:71], v11 offset:9216
    ds_read_b128 v[72:75], v11 offset:9472
    ds_read_b128 v[76:79], v11 offset:9728
    v_max_f32 v156, v16, v20
    v_max3_f32 v156, v156, v24, v28
    v_sub_f32 v16, v16, v156
    v_sub_f32 v20, v20, v156
    v_sub_f32 v24, v24, v156
    v_sub_f32 v28, v28, v156
    v_exp_f32 v16, v16
    v_exp_f32 v20, v20
    v_exp_f32 v24, v24
    v_exp_f32 v28, v28
    v_mov_b32 v143, v10
    v_mov_b32 v147, v10
    v_mov_b32 v151, v10
    v_mov_b32 v155, v10
    v_mov_b32 v159, v10
    v_mul_f32 v157, v16, v17
    v_mul_f32 v158, v16, v18
    v_fmac_f32 v157, v20, v21
    v_fmac_f32 v158, v20, v22
    v_fmac_f32 v157, v24, v25
    v_fmac_f32 v158, v24, v26
    v_fmac_f32 v157, v28, v29
    v_fmac_f32 v158, v28, v30
    s_waitcnt lgkmcnt(9)
    v_fma_f32 v140, v32, v16, -v158
    v_fma_f32 v141, v33, v16, -v158
    v_fma_f32 v142, v34, v16, -v158
    v_fma_f32 v144, v35, v16, -v158
    v_fma_f32 v145, v36, v16, -v158
    v_fma_f32 v146, v37, v16, -v158
    v_fma_f32 v148, v38, v16, -v158
    v_fma_f32 v149, v39, v16, -v158
    v_fma_f32 v150, v40, v16, -v158
    v_fma_f32 v152, v41, v16, -v158
    v_fma_f32 v153, v42, v16, -v158
    v_fma_f32 v154, v43, v16, -v158
    s_waitcnt lgkmcnt(6)
    v_fmac_f32 v140, v44, v20
    v_fmac_f32 v141, v45, v20
    v_fmac_f32 v142, v46, v20
    v_fmac_f32 v144, v47, v20
    v_fmac_f32 v145, v48, v20
    v_fmac_f32 v146, v49, v20
    v_fmac_f32 v148, v50, v20
    v_fmac_f32 v149, v51, v20
    v_fmac_f32 v150, v52, v20
    v_fmac_f32 v152, v53, v20
    v_fmac_f32 v153, v54, v20
    v_fmac_f32 v154, v55, v20
    s_waitcnt lgkmcnt(3)
    v_fmac_f32 v140, v56, v24
    v_fmac_f32 v141, v57, v24
    v_fmac_f32 v142, v58, v24
    v_fmac_f32 v144, v59, v24
    v_fmac_f32 v145, v60, v24
    v_fmac_f32 v146, v61, v24
    v_fmac_f32 v148, v62, v24
    v_fmac_f32 v149, v63, v24
    v_fmac_f32 v150, v64, v24
    v_fmac_f32 v152, v65, v24
    v_fmac_f32 v153, v66, v24
    v_fmac_f32 v154, v67, v24
    s_waitcnt lgkmcnt(0)
    v_fmac_f32 v140, v68, v28
    v_fmac_f32 v141, v69, v28
    v_fmac_f32 v142, v70, v28
    v_fmac_f32 v144, v71, v28
    v_fmac_f32 v145, v72, v28
    v_fmac_f32 v146, v73, v28
    v_fmac_f32 v148, v74, v28
    v_fmac_f32 v149, v75, v28
    v_fmac_f32 v150, v76, v28
    v_fmac_f32 v152, v77, v28
    v_fmac_f32 v153, v78, v28
    v_fmac_f32 v154, v79, v28
    s_movk_i32 s69, 39
L_fb3:
    s_barrier
    s_sub_u32 s69, s69, 1
    s_cmp_lg_u32 s69, 0
    s_cbranch_scc1 L_fb3
    s_add_u32 s58, s62, 4352
    s_add_u32 s59, s62, 8448
    buffer_load_dwordx4 v[176:179], v14, s[24:27], s59 offen sc1
    buffer_load_dwordx4 v[160:163], v9, s[24:27], s58 offen offset:0 sc1
    buffer_load_dwordx4 v[164:167], v9, s[24:27], s58 offen offset:1024 sc1
    buffer_load_dwordx4 v[168:171], v9, s[24:27], s58 offen offset:2048 sc1
    buffer_load_dwordx4 v[172:175], v9, s[24:27], s58 offen offset:3072 sc1
    s_barrier
    s_cmp_eq_u32 s101, 2
    s_cbranch_scc1 L_fo2
    v_add_u32 v13, 142336, v14
    v_add_u32 v11, 142592, v8
    ds_read_b128 v[16:19], v13 offset:0
    ds_read_b128 v[20:23], v13 offset:64
    ds_read_b128 v[24:27], v13 offset:128
    ds_read_b128 v[28:31], v13 offset:192
    ds_read_b128 v[32:35], v11 offset:0
    ds_read_b128 v[36:39], v11 offset:256
    ds_read_b128 v[40:43], v11 offset:512
    ds_read_b128 v[44:47], v11 offset:3072
    ds_read_b128 v[48:51], v11 offset:3328
    ds_read_b128 v[52:55], v11 offset:3584
    ds_read_b128 v[56:59], v11 offset:6144
    ds_read_b128 v[60:63], v11 offset:6400
    ds_read_b128 v[64:67], v11 offset:6656
    s_waitcnt lgkmcnt(9)
    ds_read_b128 v[68:71], v11 offset:9216
    ds_read_b128 v[72:75], v11 offset:9472
    ds_read_b128 v[76:79], v11 offset:9728
    v_max_f32 v96, v16, v20
    v_max3_f32 v96, v96, v24, v28
    v_sub_f32 v16, v16, v96
    v_sub_f32 v20, v20, v96
    v_sub_f32 v24, v24, v96
    v_sub_f32 v28, v28, v96
    v_exp_f32 v16, v16
    v_exp_f32 v20, v20
    v_exp_f32 v24, v24
    v_exp_f32 v28, v28
    v_mov_b32 v83, v10
    v_mov_b32 v87, v10
    v_mov_b32 v91, v10
    v_mov_b32 v95, v10
    v_mov_b32 v99, v10
    v_mul_f32 v97, v16, v17
    v_mul_f32 v98, v16, v18
    v_fmac_f32 v97, v20, v21
    v_fmac_f32 v98, v20, v22
    v_fmac_f32 v97, v24, v25
    v_fmac_f32 v98, v24, v26
    v_fmac_f32 v97, v28, v29
    v_fmac_f32 v98, v28, v30
    s_waitcnt lgkmcnt(9)
    v_fma_f32 v80, v32, v16, -v98
    v_fma_f32 v81, v33, v16, -v98
    v_fma_f32 v82, v34, v16, -v98
    v_fma_f32 v84, v35, v16, -v98
    v_fma_f32 v85, v36, v16, -v98
    v_fma_f32 v86, v37, v16, -v98
    v_fma_f32 v88, v38, v16, -v98
    v_fma_f32 v89, v39, v16, -v98
    v_fma_f32 v90, v40, v16, -v98
    v_fma_f32 v92, v41, v16, -v98
    v_fma_f32 v93, v42, v16, -v98
    v_fma_f32 v94, v43, v16, -v98
    s_waitcnt lgkmcnt(6)
    v_fmac_f32 v80, v44, v20
    v_fmac_f32 v81, v45, v20
    v_fmac_f32 v82, v46, v20
    v_fmac_f32 v84, v47, v20
    v_fmac_f32 v85, v48, v20
    v_fmac_f32 v86, v49, v20
    v_fmac_f32 v88, v50, v20
    v_fmac_f32 v89, v51, v20
    v_fmac_f32 v90, v52, v20
    v_fmac_f32 v92, v53, v20
    v_fmac_f32 v93, v54, v20
    v_fmac_f32 v94, v55, v20
    s_waitcnt lgkmcnt(3)
    v_fmac_f32 v80, v56, v24
    v_fmac_f32 v81, v57, v24
    v_fmac_f32 v82, v58, v24
    v_fmac_f32 v84, v59, v24
    v_fmac_f32 v85, v60, v24
    v_fmac_f32 v86, v61, v24
    v_fmac_f32 v88, v62, v24
    v_fmac_f32 v89, v63, v24
    v_fmac_f32 v90, v64, v24
    v_fmac_f32 v92, v65, v24
    v_fmac_f32 v93, v66, v24
    v_fmac_f32 v94, v67, v24
    s_waitcnt lgkmcnt(0)
    v_fmac_f32 v80, v68, v28
    v_fmac_f32 v81, v69, v28
    v_fmac_f32 v82, v70, v28
    v_fmac_f32 v84, v71, v28
    v_fmac_f32 v85, v72, v28
    v_fmac_f32 v86, v73, v28
    v_fmac_f32 v88, v74, v28
    v_fmac_f32 v89, v75, v28
    v_fmac_f32 v90, v76, v28
    v_fmac_f32 v92, v77, v28
    v_fmac_f32 v93, v78, v28
    v_fmac_f32 v94, v79, v28
    s_add_u32 s58, s68, 0
    s_add_u32 s59, s68, 4096
    buffer_store_dwordx4 v[80:83], v9, s[24:27], s58 offen offset:0 sc1
    buffer_store_dwordx4 v[84:87], v9, s[24:27], s58 offen offset:1024 sc1
    buffer_store_dwordx4 v[88:91], v9, s[24:27], s58 offen offset:2048 sc1
    buffer_store_dwordx4 v[92:95], v9, s[24:27], s58 offen offset:3072 sc1
    s_mov_b32 exec_lo, 0x00010001
    s_mov_b32 exec_hi, 0x00010001
    buffer_store_dwordx4 v[96:99], v14, s[24:27], s59 offen sc1
    s_mov_b64 exec, -1
    s_mov_b32 s70, 0
    s_waitcnt vmcnt(5)
    v_xor_b32 v13, v10, v163
    v_xor_b32 v11, v10, v167
    v_or_b32 v13, v13, v11
    v_xor_b32 v11, v10, v171
    v_or_b32 v13, v13, v11
    v_xor_b32 v11, v10, v175
    v_or_b32 v13, v13, v11
    v_xor_b32 v11, v10, v179
    v_or_b32 v13, v13, v11
    v_cmp_ne_u32 vcc, 0, v13
    s_nop 4
    s_cmp_eq_u64 vcc, 0
    s_cbranch_scc0 L_fo30
    v_max_f32 v11, v156, v176
    v_sub_f32 v16, v156, v11
    v_sub_f32 v17, v176, v11
    v_exp_f32 v16, v16
    v_exp_f32 v17, v17
    v_lshrrev_b32 v13, 1, v8
    v_mul_f32 v12, v16, v157
    v_fmac_f32 v12, v17, v177
    v_rcp_f32 v12, v12
    s_add_u32 s58, s63, 0
    s_mul_i32 s58, s58, 1536
    v_mul_f32 v16, v16, v12
    v_mul_f32 v17, v17, v12
    v_mul_f32 v32, v140, v16
    v_fmac_f32 v32, v160, v17
    v_mul_f32 v33, v141, v16
    v_fmac_f32 v33, v161, v17
    v_mul_f32 v34, v142, v16
    v_fmac_f32 v34, v162, v17
    v_mul_f32 v35, v144, v16
    v_fmac_f32 v35, v164, v17
    v_mul_f32 v36, v145, v16
    v_fmac_f32 v36, v165, v17
    v_mul_f32 v37, v146, v16
    v_fmac_f32 v37, v166, v17
    v_mul_f32 v38, v148, v16
    v_fmac_f32 v38, v168, v17
    v_mul_f32 v39, v149, v16
    v_fmac_f32 v39, v169, v17
    v_mul_f32 v40, v150, v16
    v_fmac_f32 v40, v170, v17
    v_mul_f32 v41, v152, v16
    v_fmac_f32 v41, v172, v17
    v_mul_f32 v42, v153, v16
    v_fmac_f32 v42, v173, v17
    v_mul_f32 v43, v154, v16
    v_fmac_f32 v43, v174, v17
    v_cvt_pk_bf16_f32 v44, v32, v33
    v_cvt_pk_bf16_f32 v45, v34, v35
    v_cvt_pk_bf16_f32 v46, v36, v37
    v_cvt_pk_bf16_f32 v47, v38, v39
    v_cvt_pk_bf16_f32 v48, v40, v41
    v_cvt_pk_bf16_f32 v49, v42, v43
    buffer_store_dwordx2 v[44:45], v13, s[48:51], s58 offen offset:0
    buffer_store_dwordx2 v[46:47], v13, s[48:51], s58 offen offset:128
    buffer_store_dwordx2 v[48:49], v13, s[48:51], s58 offen offset:256
    s_mov_b32 s70, 1
    s_waitcnt vmcnt(0)
    s_branch L_fo40
L_fo30:
    s_waitcnt vmcnt(0)
    s_add_u32 s58, s62, 4352
    s_add_u32 s59, s62, 8448
    buffer_load_dwordx4 v[176:179], v14, s[24:27], s59 offen sc1
    buffer_load_dwordx4 v[160:163], v9, s[24:27], s58 offen offset:0 sc1
    buffer_load_dwordx4 v[164:167], v9, s[24:27], s58 offen offset:1024 sc1
    buffer_load_dwordx4 v[168:171], v9, s[24:27], s58 offen offset:2048 sc1
    buffer_load_dwordx4 v[172:175], v9, s[24:27], s58 offen offset:3072 sc1
L_fo40:
    s_add_u32 s58, s68, 8704
    s_add_u32 s59, s68, 12800
    buffer_load_dwordx4 v[136:139], v14, s[24:27], s59 offen sc1
    buffer_load_dwordx4 v[120:123], v9, s[24:27], s58 offen offset:0 sc1
    buffer_load_dwordx4 v[124:127], v9, s[24:27], s58 offen offset:1024 sc1
    buffer_load_dwordx4 v[128:131], v9, s[24:27], s58 offen offset:2048 sc1
    buffer_load_dwordx4 v[132:135], v9, s[24:27], s58 offen offset:3072 sc1
    s_branch L_fo5
L_fo2:
    v_add_u32 v13, 142336, v14
    v_add_u32 v11, 142592, v8
    ds_read_b128 v[16:19], v13 offset:0
    ds_read_b128 v[20:23], v13 offset:64
    ds_read_b128 v[24:27], v13 offset:128
    ds_read_b128 v[28:31], v13 offset:192
    ds_read_b128 v[32:35], v11 offset:0
    ds_read_b128 v[36:39], v11 offset:256
    ds_read_b128 v[40:43], v11 offset:512
    ds_read_b128 v[44:47], v11 offset:3072
    ds_read_b128 v[48:51], v11 offset:3328
    ds_read_b128 v[52:55], v11 offset:3584
    ds_read_b128 v[56:59], v11 offset:6144
    ds_read_b128 v[60:63], v11 offset:6400
    ds_read_b128 v[64:67], v11 offset:6656
    s_waitcnt lgkmcnt(9)
    ds_read_b128 v[68:71], v11 offset:9216
    ds_read_b128 v[72:75], v11 offset:9472
    ds_read_b128 v[76:79], v11 offset:9728
    v_max_f32 v136, v16, v20
    v_max3_f32 v136, v136, v24, v28
    v_sub_f32 v16, v16, v136
    v_sub_f32 v20, v20, v136
    v_sub_f32 v24, v24, v136
    v_sub_f32 v28, v28, v136
    v_exp_f32 v16, v16
    v_exp_f32 v20, v20
    v_exp_f32 v24, v24
    v_exp_f32 v28, v28
    v_mov_b32 v123, v10
    v_mov_b32 v127, v10
    v_mov_b32 v131, v10
    v_mov_b32 v135, v10
    v_mov_b32 v139, v10
    v_mul_f32 v137, v16, v17
    v_mul_f32 v138, v16, v18
    v_fmac_f32 v137, v20, v21
    v_fmac_f32 v138, v20, v22
    v_fmac_f32 v137, v24, v25
    v_fmac_f32 v138, v24, v26
    v_fmac_f32 v137, v28, v29
    v_fmac_f32 v138, v28, v30
    s_waitcnt lgkmcnt(9)
    v_fma_f32 v120, v32, v16, -v138
    v_fma_f32 v121, v33, v16, -v138
    v_fma_f32 v122, v34, v16, -v138
    v_fma_f32 v124, v35, v16, -v138
    v_fma_f32 v125, v36, v16, -v138
    v_fma_f32 v126, v37, v16, -v138
    v_fma_f32 v128, v38, v16, -v138
    v_fma_f32 v129, v39, v16, -v138
    v_fma_f32 v130, v40, v16, -v138
    v_fma_f32 v132, v41, v16, -v138
    v_fma_f32 v133, v42, v16, -v138
    v_fma_f32 v134, v43, v16, -v138
    s_waitcnt lgkmcnt(6)
    v_fmac_f32 v120, v44, v20
    v_fmac_f32 v121, v45, v20
    v_fmac_f32 v122, v46, v20
    v_fmac_f32 v124, v47, v20
    v_fmac_f32 v125, v48, v20
    v_fmac_f32 v126, v49, v20
    v_fmac_f32 v128, v50, v20
    v_fmac_f32 v129, v51, v20
    v_fmac_f32 v130, v52, v20
    v_fmac_f32 v132, v53, v20
    v_fmac_f32 v133, v54, v20
    v_fmac_f32 v134, v55, v20
    s_waitcnt lgkmcnt(3)
    v_fmac_f32 v120, v56, v24
    v_fmac_f32 v121, v57, v24
    v_fmac_f32 v122, v58, v24
    v_fmac_f32 v124, v59, v24
    v_fmac_f32 v125, v60, v24
    v_fmac_f32 v126, v61, v24
    v_fmac_f32 v128, v62, v24
    v_fmac_f32 v129, v63, v24
    v_fmac_f32 v130, v64, v24
    v_fmac_f32 v132, v65, v24
    v_fmac_f32 v133, v66, v24
    v_fmac_f32 v134, v67, v24
    s_waitcnt lgkmcnt(0)
    v_fmac_f32 v120, v68, v28
    v_fmac_f32 v121, v69, v28
    v_fmac_f32 v122, v70, v28
    v_fmac_f32 v124, v71, v28
    v_fmac_f32 v125, v72, v28
    v_fmac_f32 v126, v73, v28
    v_fmac_f32 v128, v74, v28
    v_fmac_f32 v129, v75, v28
    v_fmac_f32 v130, v76, v28
    v_fmac_f32 v132, v77, v28
    v_fmac_f32 v133, v78, v28
    v_fmac_f32 v134, v79, v28
    s_add_u32 s58, s68, 8704
    s_add_u32 s59, s68, 12800
    buffer_store_dwordx4 v[120:123], v9, s[24:27], s58 offen offset:0 sc1
    buffer_store_dwordx4 v[124:127], v9, s[24:27], s58 offen offset:1024 sc1
    buffer_store_dwordx4 v[128:131], v9, s[24:27], s58 offen offset:2048 sc1
    buffer_store_dwordx4 v[132:135], v9, s[24:27], s58 offen offset:3072 sc1
    s_mov_b32 exec_lo, 0x00010001
    s_mov_b32 exec_hi, 0x00010001
    buffer_store_dwordx4 v[136:139], v14, s[24:27], s59 offen sc1
    s_mov_b64 exec, -1
    s_mov_b32 s70, 0
    s_waitcnt vmcnt(5)
    v_xor_b32 v13, v10, v163
    v_xor_b32 v11, v10, v167
    v_or_b32 v13, v13, v11
    v_xor_b32 v11, v10, v171
    v_or_b32 v13, v13, v11
    v_xor_b32 v11, v10, v175
    v_or_b32 v13, v13, v11
    v_xor_b32 v11, v10, v179
    v_or_b32 v13, v13, v11
    v_cmp_ne_u32 vcc, 0, v13
    s_nop 4
    s_cmp_eq_u64 vcc, 0
    s_cbranch_scc0 L_fo32
    v_max_f32 v11, v156, v176
    v_sub_f32 v16, v156, v11
    v_sub_f32 v17, v176, v11
    v_exp_f32 v16, v16
    v_exp_f32 v17, v17
    v_lshrrev_b32 v13, 1, v8
    v_mul_f32 v12, v16, v157
    v_fmac_f32 v12, v17, v177
    v_rcp_f32 v12, v12
    s_add_u32 s58, s63, 0
    s_mul_i32 s58, s58, 1536
    v_mul_f32 v16, v16, v12
    v_mul_f32 v17, v17, v12
    v_mul_f32 v32, v140, v16
    v_fmac_f32 v32, v160, v17
    v_mul_f32 v33, v141, v16
    v_fmac_f32 v33, v161, v17
    v_mul_f32 v34, v142, v16
    v_fmac_f32 v34, v162, v17
    v_mul_f32 v35, v144, v16
    v_fmac_f32 v35, v164, v17
    v_mul_f32 v36, v145, v16
    v_fmac_f32 v36, v165, v17
    v_mul_f32 v37, v146, v16
    v_fmac_f32 v37, v166, v17
    v_mul_f32 v38, v148, v16
    v_fmac_f32 v38, v168, v17
    v_mul_f32 v39, v149, v16
    v_fmac_f32 v39, v169, v17
    v_mul_f32 v40, v150, v16
    v_fmac_f32 v40, v170, v17
    v_mul_f32 v41, v152, v16
    v_fmac_f32 v41, v172, v17
    v_mul_f32 v42, v153, v16
    v_fmac_f32 v42, v173, v17
    v_mul_f32 v43, v154, v16
    v_fmac_f32 v43, v174, v17
    v_cvt_pk_bf16_f32 v44, v32, v33
    v_cvt_pk_bf16_f32 v45, v34, v35
    v_cvt_pk_bf16_f32 v46, v36, v37
    v_cvt_pk_bf16_f32 v47, v38, v39
    v_cvt_pk_bf16_f32 v48, v40, v41
    v_cvt_pk_bf16_f32 v49, v42, v43
    buffer_store_dwordx2 v[44:45], v13, s[48:51], s58 offen offset:0
    buffer_store_dwordx2 v[46:47], v13, s[48:51], s58 offen offset:128
    buffer_store_dwordx2 v[48:49], v13, s[48:51], s58 offen offset:256
    s_mov_b32 s70, 1
    s_waitcnt vmcnt(0)
    s_branch L_fo42
L_fo32:
    s_waitcnt vmcnt(0)
    s_add_u32 s58, s62, 4352
    s_add_u32 s59, s62, 8448
    buffer_load_dwordx4 v[176:179], v14, s[24:27], s59 offen sc1
    buffer_load_dwordx4 v[160:163], v9, s[24:27], s58 offen offset:0 sc1
    buffer_load_dwordx4 v[164:167], v9, s[24:27], s58 offen offset:1024 sc1
    buffer_load_dwordx4 v[168:171], v9, s[24:27], s58 offen offset:2048 sc1
    buffer_load_dwordx4 v[172:175], v9, s[24:27], s58 offen offset:3072 sc1
L_fo42:
    s_add_u32 s58, s68, 0
    s_add_u32 s59, s68, 4096
    buffer_load_dwordx4 v[96:99], v14, s[24:27], s59 offen sc1
    buffer_load_dwordx4 v[80:83], v9, s[24:27], s58 offen offset:0 sc1
    buffer_load_dwordx4 v[84:87], v9, s[24:27], s58 offen offset:1024 sc1
    buffer_load_dwordx4 v[88:91], v9, s[24:27], s58 offen offset:2048 sc1
    buffer_load_dwordx4 v[92:95], v9, s[24:27], s58 offen offset:3072 sc1
L_fo5:
    s_add_u32 s58, s68, 4352
    s_add_u32 s59, s68, 8448
    buffer_load_dwordx4 v[116:119], v14, s[24:27], s59 offen sc1
    buffer_load_dwordx4 v[100:103], v9, s[24:27], s58 offen offset:0 sc1
    buffer_load_dwordx4 v[104:107], v9, s[24:27], s58 offen offset:1024 sc1
    buffer_load_dwordx4 v[108:111], v9, s[24:27], s58 offen offset:2048 sc1
    buffer_load_dwordx4 v[112:115], v9, s[24:27], s58 offen offset:3072 sc1
    s_waitcnt vmcnt(0)
    v_xor_b32 v13, v10, v83
    v_xor_b32 v11, v10, v87
    v_or_b32 v13, v13, v11
    v_xor_b32 v11, v10, v91
    v_or_b32 v13, v13, v11
    v_xor_b32 v11, v10, v95
    v_or_b32 v13, v13, v11
    v_xor_b32 v11, v10, v99
    v_or_b32 v13, v13, v11
    v_xor_b32 v11, v10, v103
    v_or_b32 v13, v13, v11
    v_xor_b32 v11, v10, v107
    v_or_b32 v13, v13, v11
    v_xor_b32 v11, v10, v111
    v_or_b32 v13, v13, v11
    v_xor_b32 v11, v10, v115
    v_or_b32 v13, v13, v11
    v_xor_b32 v11, v10, v119
    v_or_b32 v13, v13, v11
    v_xor_b32 v11, v10, v123
    v_or_b32 v13, v13, v11
    v_xor_b32 v11, v10, v127
    v_or_b32 v13, v13, v11
    v_xor_b32 v11, v10, v131
    v_or_b32 v13, v13, v11
    v_xor_b32 v11, v10, v135
    v_or_b32 v13, v13, v11
    v_xor_b32 v11, v10, v139
    v_or_b32 v13, v13, v11
    v_cmp_ne_u32 vcc, 0, v13
    s_nop 4
    s_cmp_eq_u64 vcc, 0
    s_cbranch_scc0 L_fo6
    v_max3_f32 v11, v96, v116, v136
    v_sub_f32 v16, v96, v11
    v_sub_f32 v17, v116, v11
    v_sub_f32 v18, v136, v11
    v_exp_f32 v16, v16
    v_exp_f32 v17, v17
    v_exp_f32 v18, v18
    v_lshrrev_b32 v13, 1, v8
    v_mul_f32 v12, v16, v97
    v_fmac_f32 v12, v17, v117
    v_fmac_f32 v12, v18, v137
    v_rcp_f32 v12, v12
    s_add_u32 s58, s100, 171
    s_mul_i32 s58, s58, 1536
    v_mul_f32 v16, v16, v12
    v_mul_f32 v17, v17, v12
    v_mul_f32 v18, v18, v12
    v_mul_f32 v32, v80, v16
    v_fmac_f32 v32, v100, v17
    v_fmac_f32 v32, v120, v18
    v_mul_f32 v33, v81, v16
    v_fmac_f32 v33, v101, v17
    v_fmac_f32 v33, v121, v18
    v_mul_f32 v34, v82, v16
    v_fmac_f32 v34, v102, v17
    v_fmac_f32 v34, v122, v18
    v_mul_f32 v35, v84, v16
    v_fmac_f32 v35, v104, v17
    v_fmac_f32 v35, v124, v18
    v_mul_f32 v36, v85, v16
    v_fmac_f32 v36, v105, v17
    v_fmac_f32 v36, v125, v18
    v_mul_f32 v37, v86, v16
    v_fmac_f32 v37, v106, v17
    v_fmac_f32 v37, v126, v18
    v_mul_f32 v38, v88, v16
    v_fmac_f32 v38, v108, v17
    v_fmac_f32 v38, v128, v18
    v_mul_f32 v39, v89, v16
    v_fmac_f32 v39, v109, v17
    v_fmac_f32 v39, v129, v18
    v_mul_f32 v40, v90, v16
    v_fmac_f32 v40, v110, v17
    v_fmac_f32 v40, v130, v18
    v_mul_f32 v41, v92, v16
    v_fmac_f32 v41, v112, v17
    v_fmac_f32 v41, v132, v18
    v_mul_f32 v42, v93, v16
    v_fmac_f32 v42, v113, v17
    v_fmac_f32 v42, v133, v18
    v_mul_f32 v43, v94, v16
    v_fmac_f32 v43, v114, v17
    v_fmac_f32 v43, v134, v18
    v_cvt_pk_bf16_f32 v44, v32, v33
    v_cvt_pk_bf16_f32 v45, v34, v35
    v_cvt_pk_bf16_f32 v46, v36, v37
    v_cvt_pk_bf16_f32 v47, v38, v39
    v_cvt_pk_bf16_f32 v48, v40, v41
    v_cvt_pk_bf16_f32 v49, v42, v43
    buffer_store_dwordx2 v[44:45], v13, s[48:51], s58 offen offset:0
    buffer_store_dwordx2 v[46:47], v13, s[48:51], s58 offen offset:128
    buffer_store_dwordx2 v[48:49], v13, s[48:51], s58 offen offset:256
L_fo6:
    s_cmp_eq_u32 s70, 1
    s_cbranch_scc1 L_fin
    v_xor_b32 v13, v10, v163
    v_xor_b32 v11, v10, v167
    v_or_b32 v13, v13, v11
    v_xor_b32 v11, v10, v171
    v_or_b32 v13, v13, v11
    v_xor_b32 v11, v10, v175
    v_or_b32 v13, v13, v11
    v_xor_b32 v11, v10, v179
    v_or_b32 v13, v13, v11
    v_cmp_ne_u32 vcc, 0, v13
    s_nop 4
    s_cmp_eq_u64 vcc, 0
    s_cbranch_scc1 L_fo7
    s_add_u32 s58, s62, 0
    s_add_u32 s59, s62, 4096
    buffer_store_dwordx4 v[140:143], v9, s[24:27], s58 offen offset:0 sc1
    buffer_store_dwordx4 v[144:147], v9, s[24:27], s58 offen offset:1024 sc1
    buffer_store_dwordx4 v[148:151], v9, s[24:27], s58 offen offset:2048 sc1
    buffer_store_dwordx4 v[152:155], v9, s[24:27], s58 offen offset:3072 sc1
    s_mov_b32 exec_lo, 0x00010001
    s_mov_b32 exec_hi, 0x00010001
    buffer_store_dwordx4 v[156:159], v14, s[24:27], s59 offen sc1
    s_mov_b64 exec, -1
    s_waitcnt vmcnt(0)
    s_add_u32 s58, s62, 4352
    s_add_u32 s59, s62, 8448
    buffer_load_dwordx4 v[176:179], v14, s[24:27], s59 offen sc1
    buffer_load_dwordx4 v[160:163], v9, s[24:27], s58 offen offset:0 sc1
    buffer_load_dwordx4 v[164:167], v9, s[24:27], s58 offen offset:1024 sc1
    buffer_load_dwordx4 v[168:171], v9, s[24:27], s58 offen offset:2048 sc1
    buffer_load_dwordx4 v[172:175], v9, s[24:27], s58 offen offset:3072 sc1
    s_waitcnt vmcnt(0)
    v_xor_b32 v13, v10, v163
    v_xor_b32 v11, v10, v167
    v_or_b32 v13, v13, v11
    v_xor_b32 v11, v10, v171
    v_or_b32 v13, v13, v11
    v_xor_b32 v11, v10, v175
    v_or_b32 v13, v13, v11
    v_xor_b32 v11, v10, v179
    v_or_b32 v13, v13, v11
    v_cmp_ne_u32 vcc, 0, v13
    s_nop 4
    s_cmp_eq_u64 vcc, 0
    s_cbranch_scc0 L_fin
L_fo7:
    v_max_f32 v11, v156, v176
    v_sub_f32 v16, v156, v11
    v_sub_f32 v17, v176, v11
    v_exp_f32 v16, v16
    v_exp_f32 v17, v17
    v_lshrrev_b32 v13, 1, v8
    v_mul_f32 v12, v16, v157
    v_fmac_f32 v12, v17, v177
    v_rcp_f32 v12, v12
    s_add_u32 s58, s63, 0
    s_mul_i32 s58, s58, 1536
    v_mul_f32 v16, v16, v12
    v_mul_f32 v17, v17, v12
    v_mul_f32 v32, v140, v16
    v_fmac_f32 v32, v160, v17
    v_mul_f32 v33, v141, v16
    v_fmac_f32 v33, v161, v17
    v_mul_f32 v34, v142, v16
    v_fmac_f32 v34, v162, v17
    v_mul_f32 v35, v144, v16
    v_fmac_f32 v35, v164, v17
    v_mul_f32 v36, v145, v16
    v_fmac_f32 v36, v165, v17
    v_mul_f32 v37, v146, v16
    v_fmac_f32 v37, v166, v17
    v_mul_f32 v38, v148, v16
    v_fmac_f32 v38, v168, v17
    v_mul_f32 v39, v149, v16
    v_fmac_f32 v39, v169, v17
    v_mul_f32 v40, v150, v16
    v_fmac_f32 v40, v170, v17
    v_mul_f32 v41, v152, v16
    v_fmac_f32 v41, v172, v17
    v_mul_f32 v42, v153, v16
    v_fmac_f32 v42, v173, v17
    v_mul_f32 v43, v154, v16
    v_fmac_f32 v43, v174, v17
    v_cvt_pk_bf16_f32 v44, v32, v33
    v_cvt_pk_bf16_f32 v45, v34, v35
    v_cvt_pk_bf16_f32 v46, v36, v37
    v_cvt_pk_bf16_f32 v47, v38, v39
    v_cvt_pk_bf16_f32 v48, v40, v41
    v_cvt_pk_bf16_f32 v49, v42, v43
    buffer_store_dwordx2 v[44:45], v13, s[48:51], s58 offen offset:0
    buffer_store_dwordx2 v[46:47], v13, s[48:51], s58 offen offset:128
    buffer_store_dwordx2 v[48:49], v13, s[48:51], s58 offen offset:256
    s_branch L_fin
L_fmid:
    v_and_b32 v7, 1, v1
    v_mul_u32_u24 v7, 8704, v7
    v_add_u32 v7, 4108, v7
    s_movk_i32 s69, 41
L_fb4:
    s_barrier
    s_sub_u32 s69, s69, 1
    s_cmp_lg_u32 s69, 0
    s_cbranch_scc1 L_fb4
    v_add_u32 v13, 142336, v14
    v_add_u32 v11, 142592, v8
    ds_read_b128 v[16:19], v13 offset:0
    ds_read_b128 v[20:23], v13 offset:64
    ds_read_b128 v[24:27], v13 offset:128
    ds_read_b128 v[28:31], v13 offset:192
    ds_read_b128 v[32:35], v11 offset:0
    ds_read_b128 v[36:39], v11 offset:256
    ds_read_b128 v[40:43], v11 offset:512
    ds_read_b128 v[44:47], v11 offset:3072
    ds_read_b128 v[48:51], v11 offset:3328
    ds_read_b128 v[52:55], v11 offset:3584
    ds_read_b128 v[56:59], v11 offset:6144
    ds_read_b128 v[60:63], v11 offset:6400
    ds_read_b128 v[64:67], v11 offset:6656
    s_waitcnt lgkmcnt(9)
    ds_read_b128 v[68:71], v11 offset:9216
    ds_read_b128 v[72:75], v11 offset:9472
    ds_read_b128 v[76:79], v11 offset:9728
    v_max_f32 v156, v16, v20
    v_max3_f32 v156, v156, v24, v28
    v_sub_f32 v16, v16, v156
    v_sub_f32 v20, v20, v156
    v_sub_f32 v24, v24, v156
    v_sub_f32 v28, v28, v156
    v_exp_f32 v16, v16
    v_exp_f32 v20, v20
    v_exp_f32 v24, v24
    v_exp_f32 v28, v28
    v_mov_b32 v143, v10
    v_mov_b32 v147, v10
    v_mov_b32 v151, v10
    v_mov_b32 v155, v10
    v_mov_b32 v159, v10
    v_mul_f32 v157, v16, v17
    v_mul_f32 v158, v16, v18
    v_fmac_f32 v157, v20, v21
    v_fmac_f32 v158, v20, v22
    v_fmac_f32 v157, v24, v25
    v_fmac_f32 v158, v24, v26
    v_fmac_f32 v157, v28, v29
    v_fmac_f32 v158, v28, v30
    s_waitcnt lgkmcnt(9)
    v_fma_f32 v140, v32, v16, -v158
    v_fma_f32 v141, v33, v16, -v158
    v_fma_f32 v142, v34, v16, -v158
    v_fma_f32 v144, v35, v16, -v158
    v_fma_f32 v145, v36, v16, -v158
    v_fma_f32 v146, v37, v16, -v158
    v_fma_f32 v148, v38, v16, -v158
    v_fma_f32 v149, v39, v16, -v158
    v_fma_f32 v150, v40, v16, -v158
    v_fma_f32 v152, v41, v16, -v158
    v_fma_f32 v153, v42, v16, -v158
    v_fma_f32 v154, v43, v16, -v158
    s_waitcnt lgkmcnt(6)
    v_fmac_f32 v140, v44, v20
    v_fmac_f32 v141, v45, v20
    v_fmac_f32 v142, v46, v20
    v_fmac_f32 v144, v47, v20
    v_fmac_f32 v145, v48, v20
    v_fmac_f32 v146, v49, v20
    v_fmac_f32 v148, v50, v20
    v_fmac_f32 v149, v51, v20
    v_fmac_f32 v150, v52, v20
    v_fmac_f32 v152, v53, v20
    v_fmac_f32 v153, v54, v20
    v_fmac_f32 v154, v55, v20
    s_waitcnt lgkmcnt(3)
    v_fmac_f32 v140, v56, v24
    v_fmac_f32 v141, v57, v24
    v_fmac_f32 v142, v58, v24
    v_fmac_f32 v144, v59, v24
    v_fmac_f32 v145, v60, v24
    v_fmac_f32 v146, v61, v24
    v_fmac_f32 v148, v62, v24
    v_fmac_f32 v149, v63, v24
    v_fmac_f32 v150, v64, v24
    v_fmac_f32 v152, v65, v24
    v_fmac_f32 v153, v66, v24
    v_fmac_f32 v154, v67, v24
    s_waitcnt lgkmcnt(0)
    v_fmac_f32 v140, v68, v28
    v_fmac_f32 v141, v69, v28
    v_fmac_f32 v142, v70, v28
    v_fmac_f32 v144, v71, v28
    v_fmac_f32 v145, v72, v28
    v_fmac_f32 v146, v73, v28
    v_fmac_f32 v148, v74, v28
    v_fmac_f32 v149, v75, v28
    v_fmac_f32 v150, v76, v28
    v_fmac_f32 v152, v77, v28
    v_fmac_f32 v153, v78, v28
    v_fmac_f32 v154, v79, v28
    s_movk_i32 s69, 40
L_fb5:
    s_barrier
    s_sub_u32 s69, s69, 1
    s_cmp_lg_u32 s69, 0
    s_cbranch_scc1 L_fb5
    v_add_u32 v13, 142336, v14
    v_add_u32 v11, 142592, v8
    ds_read_b128 v[16:19], v13 offset:0
    ds_read_b128 v[20:23], v13 offset:64
    ds_read_b128 v[24:27], v13 offset:128
    ds_read_b128 v[28:31], v13 offset:192
    ds_read_b128 v[32:35], v11 offset:0
    ds_read_b128 v[36:39], v11 offset:256
    ds_read_b128 v[40:43], v11 offset:512
    ds_read_b128 v[44:47], v11 offset:3072
    ds_read_b128 v[48:51], v11 offset:3328
    ds_read_b128 v[52:55], v11 offset:3584
    ds_read_b128 v[56:59], v11 offset:6144
    ds_read_b128 v[60:63], v11 offset:6400
    ds_read_b128 v[64:67], v11 offset:6656
    s_waitcnt lgkmcnt(9)
    ds_read_b128 v[68:71], v11 offset:9216
    ds_read_b128 v[72:75], v11 offset:9472
    ds_read_b128 v[76:79], v11 offset:9728
    v_max_f32 v176, v16, v20
    v_max3_f32 v176, v176, v24, v28
    v_sub_f32 v16, v16, v176
    v_sub_f32 v20, v20, v176
    v_sub_f32 v24, v24, v176
    v_sub_f32 v28, v28, v176
    v_exp_f32 v16, v16
    v_exp_f32 v20, v20
    v_exp_f32 v24, v24
    v_exp_f32 v28, v28
    v_mov_b32 v163, v10
    v_mov_b32 v167, v10
    v_mov_b32 v171, v10
    v_mov_b32 v175, v10
    v_mov_b32 v179, v10
    v_mul_f32 v177, v16, v17
    v_mul_f32 v178, v16, v18
    v_fmac_f32 v177, v20, v21
    v_fmac_f32 v178, v20, v22
    v_fmac_f32 v177, v24, v25
    v_fmac_f32 v178, v24, v26
    v_fmac_f32 v177, v28, v29
    v_fmac_f32 v178, v28, v30
    s_waitcnt lgkmcnt(9)
    v_fma_f32 v160, v32, v16, -v178
    v_fma_f32 v161, v33, v16, -v178
    v_fma_f32 v162, v34, v16, -v178
    v_fma_f32 v164, v35, v16, -v178
    v_fma_f32 v165, v36, v16, -v178
    v_fma_f32 v166, v37, v16, -v178
    v_fma_f32 v168, v38, v16, -v178
    v_fma_f32 v169, v39, v16, -v178
    v_fma_f32 v170, v40, v16, -v178
    v_fma_f32 v172, v41, v16, -v178
    v_fma_f32 v173, v42, v16, -v178
    v_fma_f32 v174, v43, v16, -v178
    s_waitcnt lgkmcnt(6)
    v_fmac_f32 v160, v44, v20
    v_fmac_f32 v161, v45, v20
    v_fmac_f32 v162, v46, v20
    v_fmac_f32 v164, v47, v20
    v_fmac_f32 v165, v48, v20
    v_fmac_f32 v166, v49, v20
    v_fmac_f32 v168, v50, v20
    v_fmac_f32 v169, v51, v20
    v_fmac_f32 v170, v52, v20
    v_fmac_f32 v172, v53, v20
    v_fmac_f32 v173, v54, v20
    v_fmac_f32 v174, v55, v20
    s_waitcnt lgkmcnt(3)
    v_fmac_f32 v160, v56, v24
    v_fmac_f32 v161, v57, v24
    v_fmac_f32 v162, v58, v24
    v_fmac_f32 v164, v59, v24
    v_fmac_f32 v165, v60, v24
    v_fmac_f32 v166, v61, v24
    v_fmac_f32 v168, v62, v24
    v_fmac_f32 v169, v63, v24
    v_fmac_f32 v170, v64, v24
    v_fmac_f32 v172, v65, v24
    v_fmac_f32 v173, v66, v24
    v_fmac_f32 v174, v67, v24
    s_waitcnt lgkmcnt(0)
    v_fmac_f32 v160, v68, v28
    v_fmac_f32 v161, v69, v28
    v_fmac_f32 v162, v70, v28
    v_fmac_f32 v164, v71, v28
    v_fmac_f32 v165, v72, v28
    v_fmac_f32 v166, v73, v28
    v_fmac_f32 v168, v74, v28
    v_fmac_f32 v169, v75, v28
    v_fmac_f32 v170, v76, v28
    v_fmac_f32 v172, v77, v28
    v_fmac_f32 v173, v78, v28
    v_fmac_f32 v174, v79, v28
    s_movk_i32 s69, 46
L_fb6:
    s_barrier
    s_sub_u32 s69, s69, 1
    s_cmp_lg_u32 s69, 0
    s_cbranch_scc1 L_fb6
    s_add_u32 s58, s62, 4352
    s_add_u32 s59, s62, 8448
    buffer_store_dwordx4 v[140:143], v9, s[24:27], s58 offen offset:0 sc1
    buffer_store_dwordx4 v[144:147], v9, s[24:27], s58 offen offset:1024 sc1
    buffer_store_dwordx4 v[148:151], v9, s[24:27], s58 offen offset:2048 sc1
    buffer_store_dwordx4 v[152:155], v9, s[24:27], s58 offen offset:3072 sc1
    s_mov_b32 exec_lo, 0x00010001
    s_mov_b32 exec_hi, 0x00010001
    buffer_store_dwordx4 v[156:159], v14, s[24:27], s59 offen sc1
    s_mov_b64 exec, -1
    s_add_u32 s58, s62, 13056
    s_add_u32 s59, s62, 17152
    buffer_store_dwordx4 v[160:163], v9, s[24:27], s58 offen offset:0 sc1
    buffer_store_dwordx4 v[164:167], v9, s[24:27], s58 offen offset:1024 sc1
    buffer_store_dwordx4 v[168:171], v9, s[24:27], s58 offen offset:2048 sc1
    buffer_store_dwordx4 v[172:175], v9, s[24:27], s58 offen offset:3072 sc1
    s_mov_b32 exec_lo, 0x00010001
    s_mov_b32 exec_hi, 0x00010001
    buffer_store_dwordx4 v[176:179], v14, s[24:27], s59 offen sc1
    s_mov_b64 exec, -1
    s_barrier
    s_add_u32 s58, s68, 0
    s_add_u32 s59, s68, 4096
    buffer_load_dwordx4 v[96:99], v14, s[24:27], s59 offen sc1
    buffer_load_dwordx4 v[80:83], v9, s[24:27], s58 offen offset:0 sc1
    buffer_load_dwordx4 v[84:87], v9, s[24:27], s58 offen offset:1024 sc1
    buffer_load_dwordx4 v[88:91], v9, s[24:27], s58 offen offset:2048 sc1
    buffer_load_dwordx4 v[92:95], v9, s[24:27], s58 offen offset:3072 sc1
    s_add_u32 s58, s68, 8704
    s_add_u32 s59, s68, 12800
    buffer_load_dwordx4 v[136:139], v14, s[24:27], s59 offen sc1
    buffer_load_dwordx4 v[120:123], v9, s[24:27], s58 offen offset:0 sc1
    buffer_load_dwordx4 v[124:127], v9, s[24:27], s58 offen offset:1024 sc1
    buffer_load_dwordx4 v[128:131], v9, s[24:27], s58 offen offset:2048 sc1
    buffer_load_dwordx4 v[132:135], v9, s[24:27], s58 offen offset:3072 sc1
    s_barrier
    v_add_u32 v13, 142336, v14
    v_add_u32 v11, 142592, v8
    ds_read_b128 v[16:19], v13 offset:0
    ds_read_b128 v[20:23], v13 offset:64
    ds_read_b128 v[24:27], v13 offset:128
    ds_read_b128 v[28:31], v13 offset:192
    ds_read_b128 v[32:35], v11 offset:0
    ds_read_b128 v[36:39], v11 offset:256
    ds_read_b128 v[40:43], v11 offset:512
    ds_read_b128 v[44:47], v11 offset:3072
    ds_read_b128 v[48:51], v11 offset:3328
    ds_read_b128 v[52:55], v11 offset:3584
    ds_read_b128 v[56:59], v11 offset:6144
    ds_read_b128 v[60:63], v11 offset:6400
    ds_read_b128 v[64:67], v11 offset:6656
    s_waitcnt lgkmcnt(9)
    ds_read_b128 v[68:71], v11 offset:9216
    ds_read_b128 v[72:75], v11 offset:9472
    ds_read_b128 v[76:79], v11 offset:9728
    v_max_f32 v116, v16, v20
    v_max3_f32 v116, v116, v24, v28
    v_sub_f32 v16, v16, v116
    v_sub_f32 v20, v20, v116
    v_sub_f32 v24, v24, v116
    v_sub_f32 v28, v28, v116
    v_exp_f32 v16, v16
    v_exp_f32 v20, v20
    v_exp_f32 v24, v24
    v_exp_f32 v28, v28
    v_mov_b32 v103, v10
    v_mov_b32 v107, v10
    v_mov_b32 v111, v10
    v_mov_b32 v115, v10
    v_mov_b32 v119, v10
    v_mul_f32 v117, v16, v17
    v_mul_f32 v118, v16, v18
    v_fmac_f32 v117, v20, v21
    v_fmac_f32 v118, v20, v22
    v_fmac_f32 v117, v24, v25
    v_fmac_f32 v118, v24, v26
    v_fmac_f32 v117, v28, v29
    v_fmac_f32 v118, v28, v30
    s_waitcnt lgkmcnt(9)
    v_fma_f32 v100, v32, v16, -v118
    v_fma_f32 v101, v33, v16, -v118
    v_fma_f32 v102, v34, v16, -v118
    v_fma_f32 v104, v35, v16, -v118
    v_fma_f32 v105, v36, v16, -v118
    v_fma_f32 v106, v37, v16, -v118
    v_fma_f32 v108, v38, v16, -v118
    v_fma_f32 v109, v39, v16, -v118
    v_fma_f32 v110, v40, v16, -v118
    v_fma_f32 v112, v41, v16, -v118
    v_fma_f32 v113, v42, v16, -v118
    v_fma_f32 v114, v43, v16, -v118
    s_waitcnt lgkmcnt(6)
    v_fmac_f32 v100, v44, v20
    v_fmac_f32 v101, v45, v20
    v_fmac_f32 v102, v46, v20
    v_fmac_f32 v104, v47, v20
    v_fmac_f32 v105, v48, v20
    v_fmac_f32 v106, v49, v20
    v_fmac_f32 v108, v50, v20
    v_fmac_f32 v109, v51, v20
    v_fmac_f32 v110, v52, v20
    v_fmac_f32 v112, v53, v20
    v_fmac_f32 v113, v54, v20
    v_fmac_f32 v114, v55, v20
    s_waitcnt lgkmcnt(3)
    v_fmac_f32 v100, v56, v24
    v_fmac_f32 v101, v57, v24
    v_fmac_f32 v102, v58, v24
    v_fmac_f32 v104, v59, v24
    v_fmac_f32 v105, v60, v24
    v_fmac_f32 v106, v61, v24
    v_fmac_f32 v108, v62, v24
    v_fmac_f32 v109, v63, v24
    v_fmac_f32 v110, v64, v24
    v_fmac_f32 v112, v65, v24
    v_fmac_f32 v113, v66, v24
    v_fmac_f32 v114, v67, v24
    s_waitcnt lgkmcnt(0)
    v_fmac_f32 v100, v68, v28
    v_fmac_f32 v101, v69, v28
    v_fmac_f32 v102, v70, v28
    v_fmac_f32 v104, v71, v28
    v_fmac_f32 v105, v72, v28
    v_fmac_f32 v106, v73, v28
    v_fmac_f32 v108, v74, v28
    v_fmac_f32 v109, v75, v28
    v_fmac_f32 v110, v76, v28
    v_fmac_f32 v112, v77, v28
    v_fmac_f32 v113, v78, v28
    v_fmac_f32 v114, v79, v28
    s_waitcnt vmcnt(0)
    buffer_load_dword v15, v7, s[24:27], s62 offen sc1
    v_xor_b32 v13, v10, v83
    v_xor_b32 v11, v10, v87
    v_or_b32 v13, v13, v11
    v_xor_b32 v11, v10, v91
    v_or_b32 v13, v13, v11
    v_xor_b32 v11, v10, v95
    v_or_b32 v13, v13, v11
    v_xor_b32 v11, v10, v99
    v_or_b32 v13, v13, v11
    v_xor_b32 v11, v10, v123
    v_or_b32 v13, v13, v11
    v_xor_b32 v11, v10, v127
    v_or_b32 v13, v13, v11
    v_xor_b32 v11, v10, v131
    v_or_b32 v13, v13, v11
    v_xor_b32 v11, v10, v135
    v_or_b32 v13, v13, v11
    v_xor_b32 v11, v10, v139
    v_or_b32 v13, v13, v11
    v_cmp_ne_u32 vcc, 0, v13
    s_nop 4
    s_cmp_eq_u64 vcc, 0
    s_cbranch_scc1 L_fm1
    s_add_u32 s58, s68, 4352
    s_add_u32 s59, s68, 8448
    buffer_store_dwordx4 v[100:103], v9, s[24:27], s58 offen offset:0 sc1
    buffer_store_dwordx4 v[104:107], v9, s[24:27], s58 offen offset:1024 sc1
    buffer_store_dwordx4 v[108:111], v9, s[24:27], s58 offen offset:2048 sc1
    buffer_store_dwordx4 v[112:115], v9, s[24:27], s58 offen offset:3072 sc1
    s_mov_b32 exec_lo, 0x00010001
    s_mov_b32 exec_hi, 0x00010001
    buffer_store_dwordx4 v[116:119], v14, s[24:27], s59 offen sc1
    s_mov_b64 exec, -1
    s_waitcnt vmcnt(0)
    s_add_u32 s58, s68, 0
    s_add_u32 s59, s68, 4096
    buffer_load_dwordx4 v[96:99], v14, s[24:27], s59 offen sc1
    buffer_load_dwordx4 v[80:83], v9, s[24:27], s58 offen offset:0 sc1
    buffer_load_dwordx4 v[84:87], v9, s[24:27], s58 offen offset:1024 sc1
    buffer_load_dwordx4 v[88:91], v9, s[24:27], s58 offen offset:2048 sc1
    buffer_load_dwordx4 v[92:95], v9, s[24:27], s58 offen offset:3072 sc1
    s_add_u32 s58, s68, 8704
    s_add_u32 s59, s68, 12800
    buffer_load_dwordx4 v[136:139], v14, s[24:27], s59 offen sc1
    buffer_load_dwordx4 v[120:123], v9, s[24:27], s58 offen offset:0 sc1
    buffer_load_dwordx4 v[124:127], v9, s[24:27], s58 offen offset:1024 sc1
    buffer_load_dwordx4 v[128:131], v9, s[24:27], s58 offen offset:2048 sc1
    buffer_load_dwordx4 v[132:135], v9, s[24:27], s58 offen offset:3072 sc1
    s_waitcnt vmcnt(0)
    v_xor_b32 v13, v10, v83
    v_xor_b32 v11, v10, v87
    v_or_b32 v13, v13, v11
    v_xor_b32 v11, v10, v91
    v_or_b32 v13, v13, v11
    v_xor_b32 v11, v10, v95
    v_or_b32 v13, v13, v11
    v_xor_b32 v11, v10, v99
    v_or_b32 v13, v13, v11
    v_xor_b32 v11, v10, v123
    v_or_b32 v13, v13, v11
    v_xor_b32 v11, v10, v127
    v_or_b32 v13, v13, v11
    v_xor_b32 v11, v10, v131
    v_or_b32 v13, v13, v11
    v_xor_b32 v11, v10, v135
    v_or_b32 v13, v13, v11
    v_xor_b32 v11, v10, v139
    v_or_b32 v13, v13, v11
    v_cmp_ne_u32 vcc, 0, v13
    s_nop 4
    s_cmp_eq_u64 vcc, 0
    s_cbranch_scc0 L_fm2
L_fm1:
    v_max3_f32 v11, v96, v116, v136
    v_sub_f32 v16, v96, v11
    v_sub_f32 v17, v116, v11
    v_sub_f32 v18, v136, v11
    v_exp_f32 v16, v16
    v_exp_f32 v17, v17
    v_exp_f32 v18, v18
    v_lshrrev_b32 v13, 1, v8
    v_mul_f32 v12, v16, v97
    v_fmac_f32 v12, v17, v117
    v_fmac_f32 v12, v18, v137
    v_rcp_f32 v12, v12
    s_add_u32 s58, s100, 171
    s_mul_i32 s58, s58, 1536
    v_mul_f32 v16, v16, v12
    v_mul_f32 v17, v17, v12
    v_mul_f32 v18, v18, v12
    v_mul_f32 v32, v80, v16
    v_fmac_f32 v32, v100, v17
    v_fmac_f32 v32, v120, v18
    v_mul_f32 v33, v81, v16
    v_fmac_f32 v33, v101, v17
    v_fmac_f32 v33, v121, v18
    v_mul_f32 v34, v82, v16
    v_fmac_f32 v34, v102, v17
    v_fmac_f32 v34, v122, v18
    v_mul_f32 v35, v84, v16
    v_fmac_f32 v35, v104, v17
    v_fmac_f32 v35, v124, v18
    v_mul_f32 v36, v85, v16
    v_fmac_f32 v36, v105, v17
    v_fmac_f32 v36, v125, v18
    v_mul_f32 v37, v86, v16
    v_fmac_f32 v37, v106, v17
    v_fmac_f32 v37, v126, v18
    v_mul_f32 v38, v88, v16
    v_fmac_f32 v38, v108, v17
    v_fmac_f32 v38, v128, v18
    v_mul_f32 v39, v89, v16
    v_fmac_f32 v39, v109, v17
    v_fmac_f32 v39, v129, v18
    v_mul_f32 v40, v90, v16
    v_fmac_f32 v40, v110, v17
    v_fmac_f32 v40, v130, v18
    v_mul_f32 v41, v92, v16
    v_fmac_f32 v41, v112, v17
    v_fmac_f32 v41, v132, v18
    v_mul_f32 v42, v93, v16
    v_fmac_f32 v42, v113, v17
    v_fmac_f32 v42, v133, v18
    v_mul_f32 v43, v94, v16
    v_fmac_f32 v43, v114, v17
    v_fmac_f32 v43, v134, v18
    v_cvt_pk_bf16_f32 v44, v32, v33
    v_cvt_pk_bf16_f32 v45, v34, v35
    v_cvt_pk_bf16_f32 v46, v36, v37
    v_cvt_pk_bf16_f32 v47, v38, v39
    v_cvt_pk_bf16_f32 v48, v40, v41
    v_cvt_pk_bf16_f32 v49, v42, v43
    buffer_store_dwordx2 v[44:45], v13, s[48:51], s58 offen offset:0
    buffer_store_dwordx2 v[46:47], v13, s[48:51], s58 offen offset:128
    buffer_store_dwordx2 v[48:49], v13, s[48:51], s58 offen offset:256
    s_waitcnt vmcnt(3)
L_fm2:
    v_cmp_eq_u32 vcc, v15, v10
    s_nop 4
    s_and_b32 s70, vcc_lo, 3
    s_cbranch_scc0 L_fin
    s_bitcmp1_b32 s70, 0
    s_cbranch_scc0 L_fm30
    s_waitcnt vmcnt(0)
    s_add_u32 s58, s62, 0
    s_add_u32 s59, s62, 4096
    buffer_load_dwordx4 v[96:99], v14, s[24:27], s59 offen sc1
    buffer_load_dwordx4 v[80:83], v9, s[24:27], s58 offen offset:0 sc1
    buffer_load_dwordx4 v[84:87], v9, s[24:27], s58 offen offset:1024 sc1
    buffer_load_dwordx4 v[88:91], v9, s[24:27], s58 offen offset:2048 sc1
    buffer_load_dwordx4 v[92:95], v9, s[24:27], s58 offen offset:3072 sc1
    s_waitcnt vmcnt(0)
    v_xor_b32 v13, v10, v83
    v_xor_b32 v11, v10, v87
    v_or_b32 v13, v13, v11
    v_xor_b32 v11, v10, v91
    v_or_b32 v13, v13, v11
    v_xor_b32 v11, v10, v95
    v_or_b32 v13, v13, v11
    v_xor_b32 v11, v10, v99
    v_or_b32 v13, v13, v11
    v_cmp_ne_u32 vcc, 0, v13
    s_nop 4
    s_cmp_eq_u64 vcc, 0
    s_cbranch_scc0 L_fm30
    v_max_f32 v11, v96, v156
    v_sub_f32 v16, v96, v11
    v_sub_f32 v17, v156, v11
    v_exp_f32 v16, v16
    v_exp_f32 v17, v17
    v_lshrrev_b32 v13, 1, v8
    v_mul_f32 v12, v16, v97
    v_fmac_f32 v12, v17, v157
    v_rcp_f32 v12, v12
    s_add_u32 s58, s63, 0
    s_mul_i32 s58, s58, 1536
    v_mul_f32 v16, v16, v12
    v_mul_f32 v17, v17, v12
    v_mul_f32 v32, v80, v16
    v_fmac_f32 v32, v140, v17
    v_mul_f32 v33, v81, v16
    v_fmac_f32 v33, v141, v17
    v_mul_f32 v34, v82, v16
    v_fmac_f32 v34, v142, v17
    v_mul_f32 v35, v84, v16
    v_fmac_f32 v35, v144, v17
    v_mul_f32 v36, v85, v16
    v_fmac_f32 v36, v145, v17
    v_mul_f32 v37, v86, v16
    v_fmac_f32 v37, v146, v17
    v_mul_f32 v38, v88, v16
    v_fmac_f32 v38, v148, v17
    v_mul_f32 v39, v89, v16
    v_fmac_f32 v39, v149, v17
    v_mul_f32 v40, v90, v16
    v_fmac_f32 v40, v150, v17
    v_mul_f32 v41, v92, v16
    v_fmac_f32 v41, v152, v17
    v_mul_f32 v42, v93, v16
    v_fmac_f32 v42, v153, v17
    v_mul_f32 v43, v94, v16
    v_fmac_f32 v43, v154, v17
    v_cvt_pk_bf16_f32 v44, v32, v33
    v_cvt_pk_bf16_f32 v45, v34, v35
    v_cvt_pk_bf16_f32 v46, v36, v37
    v_cvt_pk_bf16_f32 v47, v38, v39
    v_cvt_pk_bf16_f32 v48, v40, v41
    v_cvt_pk_bf16_f32 v49, v42, v43
    buffer_store_dwordx2 v[44:45], v13, s[48:51], s58 offen offset:0
    buffer_store_dwordx2 v[46:47], v13, s[48:51], s58 offen offset:128
    buffer_store_dwordx2 v[48:49], v13, s[48:51], s58 offen offset:256
L_fm30:
    s_bitcmp1_b32 s70, 1
    s_cbranch_scc0 L_fm31
    s_waitcnt vmcnt(0)
    s_add_u32 s58, s62, 8704
    s_add_u32 s59, s62, 12800
    buffer_load_dwordx4 v[96:99], v14, s[24:27], s59 offen sc1
    buffer_load_dwordx4 v[80:83], v9, s[24:27], s58 offen offset:0 sc1
    buffer_load_dwordx4 v[84:87], v9, s[24:27], s58 offen offset:1024 sc1
    buffer_load_dwordx4 v[88:91], v9, s[24:27], s58 offen offset:2048 sc1
    buffer_load_dwordx4 v[92:95], v9, s[24:27], s58 offen offset:3072 sc1
    s_waitcnt vmcnt(0)
    v_xor_b32 v13, v10, v83
    v_xor_b32 v11, v10, v87
    v_or_b32 v13, v13, v11
    v_xor_b32 v11, v10, v91
    v_or_b32 v13, v13, v11
    v_xor_b32 v11, v10, v95
    v_or_b32 v13, v13, v11
    v_xor_b32 v11, v10, v99
    v_or_b32 v13, v13, v11
    v_cmp_ne_u32 vcc, 0, v13
    s_nop 4
    s_cmp_eq_u64 vcc, 0
    s_cbranch_scc0 L_fm31
    v_max_f32 v11, v96, v176
    v_sub_f32 v16, v96, v11
    v_sub_f32 v17, v176, v11
    v_exp_f32 v16, v16
    v_exp_f32 v17, v17
    v_lshrrev_b32 v13, 1, v8
    v_mul_f32 v12, v16, v97
    v_fmac_f32 v12, v17, v177
    v_rcp_f32 v12, v12
    s_add_u32 s58, s63, 1
    s_mul_i32 s58, s58, 1536
    v_mul_f32 v16, v16, v12
    v_mul_f32 v17, v17, v12
    v_mul_f32 v32, v80, v16
    v_fmac_f32 v32, v160, v17
    v_mul_f32 v33, v81, v16
    v_fmac_f32 v33, v161, v17
    v_mul_f32 v34, v82, v16
    v_fmac_f32 v34, v162, v17
    v_mul_f32 v35, v84, v16
    v_fmac_f32 v35, v164, v17
    v_mul_f32 v36, v85, v16
    v_fmac_f32 v36, v165, v17
    v_mul_f32 v37, v86, v16
    v_fmac_f32 v37, v166, v17
    v_mul_f32 v38, v88, v16
    v_fmac_f32 v38, v168, v17
    v_mul_f32 v39, v89, v16
    v_fmac_f32 v39, v169, v17
    v_mul_f32 v40, v90, v16
    v_fmac_f32 v40, v170, v17
    v_mul_f32 v41, v92, v16
    v_fmac_f32 v41, v172, v17
    v_mul_f32 v42, v93, v16
    v_fmac_f32 v42, v173, v17
    v_mul_f32 v43, v94, v16
    v_fmac_f32 v43, v174, v17
    v_cvt_pk_bf16_f32 v44, v32, v33
    v_cvt_pk_bf16_f32 v45, v34, v35
    v_cvt_pk_bf16_f32 v46, v36, v37
    v_cvt_pk_bf16_f32 v47, v38, v39
    v_cvt_pk_bf16_f32 v48, v40, v41
    v_cvt_pk_bf16_f32 v49, v42, v43
    buffer_store_dwordx2 v[44:45], v13, s[48:51], s58 offen offset:0
    buffer_store_dwordx2 v[46:47], v13, s[48:51], s58 offen offset:128
    buffer_store_dwordx2 v[48:49], v13, s[48:51], s58 offen offset:256
L_fm31:
    s_branch L_fin
L_fsolo:
    s_movk_i32 s69, 129
L_fb7:
    s_barrier
    s_sub_u32 s69, s69, 1
    s_cmp_lg_u32 s69, 0
    s_cbranch_scc1 L_fb7
    v_add_u32 v13, 142336, v14
    v_add_u32 v11, 142592, v8
    ds_read_b128 v[16:19], v13 offset:0
    ds_read_b128 v[20:23], v13 offset:64
    ds_read_b128 v[24:27], v13 offset:128
    ds_read_b128 v[28:31], v13 offset:192
    ds_read_b128 v[32:35], v11 offset:0
    ds_read_b128 v[36:39], v11 offset:256
    ds_read_b128 v[40:43], v11 offset:512
    ds_read_b128 v[44:47], v11 offset:3072
    ds_read_b128 v[48:51], v11 offset:3328
    ds_read_b128 v[52:55], v11 offset:3584
    ds_read_b128 v[56:59], v11 offset:6144
    ds_read_b128 v[60:63], v11 offset:6400
    ds_read_b128 v[64:67], v11 offset:6656
    s_waitcnt lgkmcnt(9)
    ds_read_b128 v[68:71], v11 offset:9216
    ds_read_b128 v[72:75], v11 offset:9472
    ds_read_b128 v[76:79], v11 offset:9728
    v_max_f32 v96, v16, v20
    v_max3_f32 v96, v96, v24, v28
    v_sub_f32 v16, v16, v96
    v_sub_f32 v20, v20, v96
    v_sub_f32 v24, v24, v96
    v_sub_f32 v28, v28, v96
    v_exp_f32 v16, v16
    v_exp_f32 v20, v20
    v_exp_f32 v24, v24
    v_exp_f32 v28, v28
    v_mov_b32 v83, v10
    v_mov_b32 v87, v10
    v_mov_b32 v91, v10
    v_mov_b32 v95, v10
    v_mov_b32 v99, v10
    v_mul_f32 v97, v16, v17
    v_mul_f32 v98, v16, v18
    v_fmac_f32 v97, v20, v21
    v_fmac_f32 v98, v20, v22
    v_fmac_f32 v97, v24, v25
    v_fmac_f32 v98, v24, v26
    v_fmac_f32 v97, v28, v29
    v_fmac_f32 v98, v28, v30
    s_waitcnt lgkmcnt(9)
    v_fma_f32 v80, v32, v16, -v98
    v_fma_f32 v81, v33, v16, -v98
    v_fma_f32 v82, v34, v16, -v98
    v_fma_f32 v84, v35, v16, -v98
    v_fma_f32 v85, v36, v16, -v98
    v_fma_f32 v86, v37, v16, -v98
    v_fma_f32 v88, v38, v16, -v98
    v_fma_f32 v89, v39, v16, -v98
    v_fma_f32 v90, v40, v16, -v98
    v_fma_f32 v92, v41, v16, -v98
    v_fma_f32 v93, v42, v16, -v98
    v_fma_f32 v94, v43, v16, -v98
    s_waitcnt lgkmcnt(6)
    v_fmac_f32 v80, v44, v20
    v_fmac_f32 v81, v45, v20
    v_fmac_f32 v82, v46, v20
    v_fmac_f32 v84, v47, v20
    v_fmac_f32 v85, v48, v20
    v_fmac_f32 v86, v49, v20
    v_fmac_f32 v88, v50, v20
    v_fmac_f32 v89, v51, v20
    v_fmac_f32 v90, v52, v20
    v_fmac_f32 v92, v53, v20
    v_fmac_f32 v93, v54, v20
    v_fmac_f32 v94, v55, v20
    s_waitcnt lgkmcnt(3)
    v_fmac_f32 v80, v56, v24
    v_fmac_f32 v81, v57, v24
    v_fmac_f32 v82, v58, v24
    v_fmac_f32 v84, v59, v24
    v_fmac_f32 v85, v60, v24
    v_fmac_f32 v86, v61, v24
    v_fmac_f32 v88, v62, v24
    v_fmac_f32 v89, v63, v24
    v_fmac_f32 v90, v64, v24
    v_fmac_f32 v92, v65, v24
    v_fmac_f32 v93, v66, v24
    v_fmac_f32 v94, v67, v24
    s_waitcnt lgkmcnt(0)
    v_fmac_f32 v80, v68, v28
    v_fmac_f32 v81, v69, v28
    v_fmac_f32 v82, v70, v28
    v_fmac_f32 v84, v71, v28
    v_fmac_f32 v85, v72, v28
    v_fmac_f32 v86, v73, v28
    v_fmac_f32 v88, v74, v28
    v_fmac_f32 v89, v75, v28
    v_fmac_f32 v90, v76, v28
    v_fmac_f32 v92, v77, v28
    v_fmac_f32 v93, v78, v28
    v_fmac_f32 v94, v79, v28
    v_max_f32 v11, v96, v96
    v_sub_f32 v16, v96, v11
    v_exp_f32 v16, v16
    v_lshrrev_b32 v13, 1, v8
    v_mul_f32 v12, v16, v97
    v_rcp_f32 v12, v12
    s_add_u32 s58, s63, 0
    s_mul_i32 s58, s58, 1536
    v_mul_f32 v16, v16, v12
    v_mul_f32 v32, v80, v16
    v_mul_f32 v33, v81, v16
    v_mul_f32 v34, v82, v16
    v_mul_f32 v35, v84, v16
    v_mul_f32 v36, v85, v16
    v_mul_f32 v37, v86, v16
    v_mul_f32 v38, v88, v16
    v_mul_f32 v39, v89, v16
    v_mul_f32 v40, v90, v16
    v_mul_f32 v41, v92, v16
    v_mul_f32 v42, v93, v16
    v_mul_f32 v43, v94, v16
    v_cvt_pk_bf16_f32 v44, v32, v33
    v_cvt_pk_bf16_f32 v45, v34, v35
    v_cvt_pk_bf16_f32 v46, v36, v37
    v_cvt_pk_bf16_f32 v47, v38, v39
    v_cvt_pk_bf16_f32 v48, v40, v41
    v_cvt_pk_bf16_f32 v49, v42, v43
    buffer_store_dwordx2 v[44:45], v13, s[48:51], s58 offen offset:0
    buffer_store_dwordx2 v[46:47], v13, s[48:51], s58 offen offset:128
    buffer_store_dwordx2 v[48:49], v13, s[48:51], s58 offen offset:256
L_fin:
L_end:
    s_endpgm
.section .rodata,"a"
.p2align 6
.amdhsa_kernel standalone__kv_cache_quant_int4_int2_kv_with_per_channel_or_per_token_scales__sampling_kernel
  .amdhsa_next_free_vgpr 224
  .amdhsa_next_free_sgpr 102
  .amdhsa_accum_offset 224
  .amdhsa_group_segment_fixed_size 0
  .amdhsa_kernarg_size 80
  .amdhsa_user_sgpr_count 2
  .amdhsa_user_sgpr_kernarg_segment_ptr 1
  .amdhsa_system_sgpr_workgroup_id_x 1
  .amdhsa_float_denorm_mode_32 3
.end_amdhsa_kernel
```

```asm
; @launch grid=(256,1,1) block=(448,1,1) lds=154944
.amdgcn_target "amdgcn-amd-amdhsa--gfx950"
.text
.globl standalone__kv_cache_quant_int4_int2_kv_with_per_channel_or_per_token_scales__sampling_kernel
.p2align 8
.type standalone__kv_cache_quant_int4_int2_kv_with_per_channel_or_per_token_scales__sampling_kernel,@function
standalone__kv_cache_quant_int4_int2_kv_with_per_channel_or_per_token_scales__sampling_kernel:
    s_cmp_ge_u32 s2, 256
    s_cbranch_scc1 L_end
    s_load_dwordx16 s[4:19], s[0:1], 0
    s_load_dwordx4 s[20:23], s[0:1], 64
    v_lshrrev_b32 v2, 6, v0
    v_and_b32 v1, 63, v0
    v_readfirstlane_b32 s56, v2
    s_mov_b32 s67, 768
    s_mul_i32 s100, s2, 43691
    s_lshr_b32 s100, s100, 17
    s_mul_i32 s101, s100, 3
    s_sub_u32 s101, s2, s101
    s_cmp_eq_u32 s2, 255
    s_cselect_b32 s73, 16, 11
    s_cmp_eq_u32 s101, 1
    s_cselect_b32 s3, 5, s73
    s_cselect_b32 s73, 10, s73
    s_mul_i32 s58, s101, 21
    s_add_u32 s58, s58, 1
    s_lshr_b32 s58, s58, 1
    s_lshl_b32 s59, s100, 5
    s_add_u32 s57, s58, s59
    s_mul_i32 s58, s101, 11
    s_lshr_b32 s58, s58, 1
    s_lshl_b32 s59, s100, 4
    s_add_u32 s58, s58, s59
    s_add_u32 s58, s58, 2736
    s_sub_u32 s58, s58, s73
    v_cmp_le_u32 vcc, s73, v1
    v_add_u32 v3, s57, v1
    v_add_u32 v4, s58, v1
    v_cndmask_b32 v152, v3, v4, vcc
    s_cmp_eq_u32 s56, 4
    s_cbranch_scc0 L_roles
    s_setprio 3
    v_add_u32 v17, 0, v1
    v_mul_u32_u24 v22, 1366, v17
    v_bfe_u32 v11, v22, 16, 1
    v_lshrrev_b32 v14, 17, v22
    v_mul_u32_u24 v22, 31488, v14
    v_lshl_add_u32 v17, v17, 4, v22
    v_mov_b32 v8, v17
    v_add_u32 v18, 64, v1
    v_mul_u32_u24 v22, 1366, v18
    v_bfe_u32 v12, v22, 16, 1
    v_lshrrev_b32 v15, 17, v22
    v_mul_u32_u24 v22, 31488, v15
    v_lshl_add_u32 v18, v18, 4, v22
    v_mov_b32 v9, v18
    v_add_u32 v19, 128, v1
    v_mul_u32_u24 v22, 1366, v19
    v_bfe_u32 v13, v22, 16, 1
    v_lshrrev_b32 v16, 17, v22
    v_mul_u32_u24 v22, 31488, v16
    v_lshl_add_u32 v19, v19, 4, v22
    v_mov_b32 v10, v19
    s_mov_b32 s68, 0
    s_mov_b32 m0, 0
    s_movk_i32 s71, 1024
    s_mul_i32 s57, s57, 196608
    s_mov_b32 s84, 0x400000
    s_mov_b32 s85, 0x800
    s_movk_i32 s86, 1536
    s_mov_b32 s70, 19
    s_mov_b32 s74, 0
    v_mov_b32 v20, 4864
    v_mov_b32 v21, 154880
    ds_write_b32 v21, v20
    s_waitcnt lgkmcnt(0)
    s_mov_b32 s24, s6
    s_and_b32 s25, s7, 0xffff
    s_mov_b32 s26, 805306368
    s_mov_b32 s27, 0x20000
L_lw16:
    s_waitcnt vmcnt(16)
L_lw17:
    s_waitcnt vmcnt(17)
L_lw18:
    s_waitcnt vmcnt(18)
L_lw19:
    s_waitcnt vmcnt(19)
L_lw20:
    s_waitcnt vmcnt(20)
L_lw21:
    s_waitcnt vmcnt(21)
    buffer_load_dwordx4 v17, s[24:27], s57 offen nt lds
    s_add_u32 m0, m0, s71
    s_add_u32 s68, s68, 1
    s_and_b32 s58, s68, 63
    s_cmp_ge_u32 s58, 43
    s_cselect_b32 s69, -768, 0
    buffer_load_dwordx4 v18, s[24:27], s57 offen nt lds
    s_add_u32 m0, m0, s71
    s_cmp_eq_u32 s58, 21
    s_cselect_b32 s62, 33024, 0
    v_mad_u32_u24 v17, v11, s62, v8
    s_bitcmp1_b64 s[84:85], s58
    s_cselect_b32 s63, 34560, s86
    buffer_load_dwordx4 v19, s[24:27], s57 offen nt lds
    s_add_u32 m0, m0, s71
    s_add_u32 s57, s57, s63
    v_mad_i32_i24 v22, v15, s69, v9
    v_mad_u32_u24 v18, v12, s62, v22
    v_mad_i32_i24 v22, v16, s69, v10
    v_mad_u32_u24 v19, v13, s62, v22
    s_and_b32 s59, s68, 7
    s_cbranch_scc0 L_lunit
L_lad:
    s_cmp_eq_u32 s70, 21
    s_cbranch_scc1 L_lw21
    s_cmp_eq_u32 s70, 20
    s_cbranch_scc1 L_lw20
    s_cmp_eq_u32 s70, 19
    s_cbranch_scc1 L_lw19
    s_cmp_eq_u32 s70, 18
    s_cbranch_scc1 L_lw18
    s_cmp_eq_u32 s70, 17
    s_cbranch_scc1 L_lw17
    s_branch L_lw16
L_lunit:
    s_waitcnt vmcnt(24)
    s_cmp_le_u32 s68, 16
    s_cbranch_scc1 L_lfirst
L_lbar:
    s_barrier
L_lnobar:
    s_waitcnt lgkmcnt(0)
    v_readfirstlane_b32 s59, v20
    ds_read_b32 v20, v21
    s_cmp_eq_u32 m0, 73728
    s_cselect_b32 m0, 0, m0
    s_and_b32 s74, s74, 255
    s_add_u32 s74, s74, s59
    s_lshr_b32 s70, s74, 8
    s_cmp_eq_u32 s58, 0
    s_cbranch_scc1 L_lblock
L_lsel:
    s_cmp_le_u32 s70, 21
    s_cbranch_scc1 L_lad
    s_cmp_le_u32 s70, 23
    s_cbranch_scc1 L_lad22
    s_branch L_lad24
L_lblock:
    s_bfe_u32 s58, s68, 262150
    v_readlane_b32 s57, v152, s58
    s_nop 3
    s_mul_i32 s57, s57, 196608
    s_cmp_eq_u32 s58, 0
    s_cbranch_scc0 L_lsel
    s_cmp_eq_u32 s68, 2048
    s_cbranch_scc1 L_ldone
    s_mov_b32 s24, s8
    s_and_b32 s25, s9, 0xffff
    s_branch L_lsel
L_lfirst:
    s_cmp_eq_u32 s68, 8
    s_cbranch_scc1 L_lnobar
    s_barrier
    s_branch L_lbar
L_ldone:
    s_waitcnt vmcnt(0)
    s_barrier
    s_endpgm
L_lw22:
    s_waitcnt vmcnt(22)
L_lw23:
    s_waitcnt vmcnt(23)
    buffer_load_dwordx4 v17, s[24:27], s57 offen nt lds
    s_add_u32 m0, m0, s71
    s_add_u32 s68, s68, 1
    s_and_b32 s58, s68, 63
    s_cmp_ge_u32 s58, 43
    s_cselect_b32 s69, -768, 0
    buffer_load_dwordx4 v18, s[24:27], s57 offen nt lds
    s_add_u32 m0, m0, s71
    s_cmp_eq_u32 s58, 21
    s_cselect_b32 s62, 33024, 0
    v_mad_u32_u24 v17, v11, s62, v8
    s_bitcmp1_b64 s[84:85], s58
    s_cselect_b32 s63, 34560, s86
    buffer_load_dwordx4 v19, s[24:27], s57 offen nt lds
    s_add_u32 m0, m0, s71
    s_add_u32 s57, s57, s63
    v_mad_i32_i24 v22, v15, s69, v9
    v_mad_u32_u24 v18, v12, s62, v22
    v_mad_i32_i24 v22, v16, s69, v10
    v_mad_u32_u24 v19, v13, s62, v22
    s_and_b32 s59, s68, 7
    s_cbranch_scc0 L_lunit
L_lad22:
    s_cmp_eq_u32 s70, 23
    s_cbranch_scc1 L_lw23
    s_branch L_lw22
L_lw24:
    s_waitcnt vmcnt(24)
L_lw25:
    s_waitcnt vmcnt(25)
    buffer_load_dwordx4 v17, s[24:27], s57 offen nt lds
    s_add_u32 m0, m0, s71
    s_add_u32 s68, s68, 1
    s_and_b32 s58, s68, 63
    s_cmp_ge_u32 s58, 43
    s_cselect_b32 s69, -768, 0
    buffer_load_dwordx4 v18, s[24:27], s57 offen nt lds
    s_add_u32 m0, m0, s71
    s_cmp_eq_u32 s58, 21
    s_cselect_b32 s62, 33024, 0
    v_mad_u32_u24 v17, v11, s62, v8
    s_bitcmp1_b64 s[84:85], s58
    s_cselect_b32 s63, 34560, s86
    buffer_load_dwordx4 v19, s[24:27], s57 offen nt lds
    s_add_u32 m0, m0, s71
    s_add_u32 s57, s57, s63
    v_mad_i32_i24 v22, v15, s69, v9
    v_mad_u32_u24 v18, v12, s62, v22
    v_mad_i32_i24 v22, v16, s69, v10
    v_mad_u32_u24 v19, v13, s62, v22
    s_and_b32 s59, s68, 7
    s_cbranch_scc0 L_lunit
L_lad24:
    s_cmp_eq_u32 s70, 25
    s_cbranch_scc1 L_lw25
    s_branch L_lw24
L_roles:
    s_cmp_lt_u32 s56, 4
    s_cbranch_scc1 L_consumer
    s_cmp_eq_u32 s56, 5
    s_cbranch_scc1 L_finisher
    s_sub_u32 s58, s2, 16
    s_cmp_lt_u32 s58, 8
    s_cbranch_scc0 L_pw
    s_getpc_b64 s[44:45]
L_pc:
    s_and_b32 s45, s45, 0xffff
    s_mov_b32 s46, L_end - L_pc
    s_mov_b32 s47, 0x20000
    v_lshlrev_b32 v9, 7, v1
    s_movk_i32 s58, 0
    buffer_load_dword v12, v9, s[44:47], s58 offen
    s_movk_i32 s58, 8192
    buffer_load_dword v13, v9, s[44:47], s58 offen
    s_movk_i32 s58, 16384
    buffer_load_dword v14, v9, s[44:47], s58 offen
    s_movk_i32 s58, 24576
    buffer_load_dword v15, v9, s[44:47], s58 offen
L_pw:
    s_waitcnt lgkmcnt(0)
    s_mov_b32 s52, s22
    s_and_b32 s53, s23, 0xffff
    s_mov_b32 s54, 16793888
    s_mov_b32 s55, 0x20000
    s_mov_b32 s71, 0
    s_add_u32 s98, s22, 16777216
    s_addc_u32 s99, s23, 0
    s_min_u32 s58, s2, 16
    s_lshr_b32 s61, 0x926d, s58
    s_and_b32 s61, s61, 1
    s_and_b32 s59, s2, 7
    s_mul_i32 s59, s59, 4
    s_add_u32 s59, s59, 16777216
    v_mov_b32 v8, s59
    v_mov_b32 v10, 154880
    s_mov_b32 s96, 0
    s_mov_b64 exec, 1
    s_barrier
    s_mov_b32 s63, 0
L_pace:
    s_barrier
    s_mov_b32 s62, s96
    s_memrealtime s[96:97]
    s_waitcnt lgkmcnt(0)
    s_cmp_eq_u32 s63, 0
    s_cbranch_scc1 L_pnext
    s_mov_b32 s58, 0
    s_sub_i32 s59, s84, s62
    s_add_i32 s60, s59, 5000
    s_cmp_lt_u32 s60, 10000
    s_cselect_b32 s59, s59, 200
    s_add_i32 s58, s58, s59
    s_sub_i32 s59, s85, s62
    s_add_i32 s60, s59, 5000
    s_cmp_lt_u32 s60, 10000
    s_cselect_b32 s59, s59, 200
    s_add_i32 s58, s58, s59
    s_sub_i32 s59, s86, s62
    s_add_i32 s60, s59, 5000
    s_cmp_lt_u32 s60, 10000
    s_cselect_b32 s59, s59, 200
    s_add_i32 s58, s58, s59
    s_sub_i32 s59, s87, s62
    s_add_i32 s60, s59, 5000
    s_cmp_lt_u32 s60, 10000
    s_cselect_b32 s59, s59, 200
    s_add_i32 s58, s58, s59
    s_sub_i32 s59, s88, s62
    s_add_i32 s60, s59, 5000
    s_cmp_lt_u32 s60, 10000
    s_cselect_b32 s59, s59, 200
    s_add_i32 s58, s58, s59
    s_sub_i32 s59, s89, s62
    s_add_i32 s60, s59, 5000
    s_cmp_lt_u32 s60, 10000
    s_cselect_b32 s59, s59, 200
    s_add_i32 s58, s58, s59
    s_sub_i32 s59, s90, s62
    s_add_i32 s60, s59, 5000
    s_cmp_lt_u32 s60, 10000
    s_cselect_b32 s59, s59, 200
    s_add_i32 s58, s58, s59
    s_sub_i32 s59, s91, s62
    s_add_i32 s60, s59, 5000
    s_cmp_lt_u32 s60, 10000
    s_cselect_b32 s59, s59, 200
    s_add_i32 s58, s58, s59
    s_min_u32 s59, s63, 12
    s_cmp_gt_i32 s58, 0
    s_cselect_b32 s63, s59, s63
    s_mul_i32 s58, s58, s63
    s_ashr_i32 s58, s58, 5
    s_sub_i32 s58, 4864, s58
    s_max_i32 s58, s58, 4096
    s_min_i32 s70, s58, 6400
    v_mov_b32 v9, s70
    ds_write_b32 v10, v9
L_pnext:
    s_and_b32 s58, s71, 768
    s_cselect_b32 s63, 0, 5
    s_cmp_ge_u32 s71, 14848
    s_cselect_b32 s63, 24, s63
    s_mul_i32 s58, s63, s61
    s_cmp_eq_u32 s58, 0
    s_cbranch_scc1 L_pnorep
    v_mov_b32 v11, s96
    buffer_store_dword v11, v8, s[52:55], s71 offen sc1
L_pnorep:
    s_barrier
    s_barrier
    s_barrier
    s_cmp_eq_u32 s63, 0
    s_cbranch_scc1 L_pnold
    s_load_dwordx8 s[84:91], s[98:99], s71
L_pnold:
    s_add_u32 s71, s71, 256
    s_cmp_lt_u32 s71, 16384
    s_cbranch_scc1 L_pace
    s_waitcnt lgkmcnt(0)
    s_mov_b64 exec, -1
    s_endpgm
L_consumer:
    v_lshrrev_b32 v3, 2, v1
    v_lshlrev_b32 v3, 3, v3
    v_and_b32 v4, 3, v1
    v_mul_u32_u24 v5, 384, v4
    v_add_u32 v15, v3, v5
    v_lshlrev_b32 v13, 4, v1
    s_mul_i32 s63, s56, 3072
    s_add_u32 s63, s63, 76800
    s_add_u32 s58, s56, 0
    v_readlane_b32 s84, v152, s58
    s_add_u32 s58, s56, 4
    v_readlane_b32 s85, v152, s58
    s_add_u32 s58, s56, 8
    v_readlane_b32 s86, v152, s58
    s_add_u32 s58, s56, 12
    v_readlane_b32 s87, v152, s58
    v_readlane_b32 s88, v152, 0
    s_min_u32 s58, s3, 15
    v_readlane_b32 s89, v152, s58
    v_readlane_b32 s90, v152, 15
    s_waitcnt lgkmcnt(0)
    s_mov_b32 s32, s12
    s_and_b32 s33, s13, 0xffff
    s_mov_b32 s34, 6291456
    s_mov_b32 s35, 0x20000
    s_mov_b32 s28, s10
    s_and_b32 s29, s11, 0xffff
    s_mov_b32 s30, 6291456
    s_mov_b32 s31, 0x20000
    s_mov_b32 exec_hi, 0xffff
    s_add_u32 m0, s63, 0
    s_mul_i32 s58, s84, 1536
    buffer_load_dwordx4 v13, s[32:35], s58 offen nt lds
    buffer_load_dwordx4 v13, s[32:35], s58 offen offset:768 nt lds
    s_add_u32 m0, m0, 1536
    s_nop 0
    buffer_load_dwordx4 v13, s[28:31], s58 offen nt lds
    buffer_load_dwordx4 v13, s[28:31], s58 offen offset:768 nt lds
    s_mov_b32 exec_hi, -1
    s_mov_b32 s44, s4
    s_and_b32 s45, s5, 0xffff
    s_mov_b32 s46, 393216
    s_mov_b32 s47, 0x20000
    s_lshr_b32 s58, s88, 4
    s_mul_i32 s58, s58, 1536
    buffer_load_dwordx2 v[156:157], v15, s[44:47], s58 offen offset:0 nt
    buffer_load_dwordx2 v[158:159], v15, s[44:47], s58 offen offset:128 nt
    buffer_load_dwordx2 v[160:161], v15, s[44:47], s58 offen offset:256 nt
    s_mov_b32 s64, 0x3fb8aa3b
    s_mov_b32 s65, 0x3d93cd3a
    s_mov_b32 s66, 0xffff0000
    v_bfe_u32 v36, v1, 2, 1
    v_lshl_add_u32 v36, v2, 2, v36
    v_bfe_u32 v37, v1, 3, 1
    v_lshrrev_b32 v38, 4, v1
    v_lshl_add_u32 v38, v38, 2, v4
    v_lshlrev_b32 v38, 3, v38
    v_add_u32 v38, 73728, v38
    s_movk_i32 s58, 384
    v_add_u32 v3, 0, v36
    v_cmp_le_u32 vcc, 43, v3
    v_add_u32 v5, 43, v3
    v_mov_b32 v6, 42
    v_cndmask_b32 v17, v3, v5, vcc
    v_cmp_le_u32 vcc, 86, v3
    v_add_u32 v5, 43, v17
    s_nop 0
    v_cndmask_b32 v17, v17, v5, vcc
    v_cndmask_b32 v6, 43, v6, vcc
    v_mad_u32_u24 v17, v6, v37, v17
    v_lshrrev_b32 v17, 6, v17
    v_mad_u32_u24 v17, v17, s58, v38
    v_add_u32 v3, 2, v36
    v_cmp_le_u32 vcc, 43, v3
    v_add_u32 v5, 43, v3
    v_mov_b32 v6, 42
    v_cndmask_b32 v18, v3, v5, vcc
    v_cmp_le_u32 vcc, 86, v3
    v_add_u32 v5, 43, v18
    s_nop 0
    v_cndmask_b32 v18, v18, v5, vcc
    v_cndmask_b32 v6, 43, v6, vcc
    v_mad_u32_u24 v18, v6, v37, v18
    v_lshrrev_b32 v18, 6, v18
    v_mad_u32_u24 v18, v18, s58, v38
    v_add_u32 v3, 16, v36
    v_cmp_le_u32 vcc, 43, v3
    v_add_u32 v5, 43, v3
    v_mov_b32 v6, 42
    v_cndmask_b32 v19, v3, v5, vcc
    v_cmp_le_u32 vcc, 86, v3
    v_add_u32 v5, 43, v19
    s_nop 0
    v_cndmask_b32 v19, v19, v5, vcc
    v_cndmask_b32 v6, 43, v6, vcc
    v_mad_u32_u24 v19, v6, v37, v19
    v_lshrrev_b32 v19, 6, v19
    v_mad_u32_u24 v19, v19, s58, v38
    v_add_u32 v3, 18, v36
    v_cmp_le_u32 vcc, 43, v3
    v_add_u32 v5, 43, v3
    v_mov_b32 v6, 42
    v_cndmask_b32 v20, v3, v5, vcc
    v_cmp_le_u32 vcc, 86, v3
    v_add_u32 v5, 43, v20
    s_nop 0
    v_cndmask_b32 v20, v20, v5, vcc
    v_cndmask_b32 v6, 43, v6, vcc
    v_mad_u32_u24 v20, v6, v37, v20
    v_lshrrev_b32 v20, 6, v20
    v_mad_u32_u24 v20, v20, s58, v38
    v_add_u32 v3, 32, v36
    v_cmp_le_u32 vcc, 43, v3
    v_add_u32 v5, 43, v3
    v_mov_b32 v6, 42
    v_cndmask_b32 v21, v3, v5, vcc
    v_cmp_le_u32 vcc, 86, v3
    v_add_u32 v5, 43, v21
    s_nop 0
    v_cndmask_b32 v21, v21, v5, vcc
    v_cndmask_b32 v6, 43, v6, vcc
    v_mad_u32_u24 v21, v6, v37, v21
    v_lshrrev_b32 v21, 6, v21
    v_mad_u32_u24 v21, v21, s58, v38
    v_add_u32 v3, 34, v36
    v_cmp_le_u32 vcc, 43, v3
    v_add_u32 v5, 43, v3
    v_mov_b32 v6, 42
    v_cndmask_b32 v22, v3, v5, vcc
    v_cmp_le_u32 vcc, 86, v3
    v_add_u32 v5, 43, v22
    s_nop 0
    v_cndmask_b32 v22, v22, v5, vcc
    v_cndmask_b32 v6, 43, v6, vcc
    v_mad_u32_u24 v22, v6, v37, v22
    v_lshrrev_b32 v22, 6, v22
    v_mad_u32_u24 v22, v22, s58, v38
    v_add_u32 v3, 48, v36
    v_cmp_le_u32 vcc, 43, v3
    v_add_u32 v5, 43, v3
    v_mov_b32 v6, 42
    v_cndmask_b32 v23, v3, v5, vcc
    v_cmp_le_u32 vcc, 86, v3
    v_add_u32 v5, 43, v23
    s_nop 0
    v_cndmask_b32 v23, v23, v5, vcc
    v_cndmask_b32 v6, 43, v6, vcc
    v_mad_u32_u24 v23, v6, v37, v23
    v_lshrrev_b32 v23, 6, v23
    v_mad_u32_u24 v23, v23, s58, v38
    v_add_u32 v3, 50, v36
    v_cmp_le_u32 vcc, 43, v3
    v_add_u32 v5, 43, v3
    v_mov_b32 v6, 42
    v_cndmask_b32 v24, v3, v5, vcc
    v_cmp_le_u32 vcc, 86, v3
    v_add_u32 v5, 43, v24
    s_nop 0
    v_cndmask_b32 v24, v24, v5, vcc
    v_cndmask_b32 v6, 43, v6, vcc
    v_mad_u32_u24 v24, v6, v37, v24
    v_lshrrev_b32 v24, 6, v24
    v_mad_u32_u24 v24, v24, s58, v38
    v_add_u32 v3, 64, v36
    v_cmp_le_u32 vcc, 43, v3
    v_add_u32 v5, 43, v3
    v_mov_b32 v6, 42
    v_cndmask_b32 v25, v3, v5, vcc
    v_cmp_le_u32 vcc, 86, v3
    v_add_u32 v5, 43, v25
    s_nop 0
    v_cndmask_b32 v25, v25, v5, vcc
    v_cndmask_b32 v6, 43, v6, vcc
    v_mad_u32_u24 v25, v6, v37, v25
    v_lshrrev_b32 v25, 6, v25
    v_mad_u32_u24 v25, v25, s58, v38
    v_add_u32 v3, 66, v36
    v_cmp_le_u32 vcc, 43, v3
    v_add_u32 v5, 43, v3
    v_mov_b32 v6, 42
    v_cndmask_b32 v26, v3, v5, vcc
    v_cmp_le_u32 vcc, 86, v3
    v_add_u32 v5, 43, v26
    s_nop 0
    v_cndmask_b32 v26, v26, v5, vcc
    v_cndmask_b32 v6, 43, v6, vcc
    v_mad_u32_u24 v26, v6, v37, v26
    v_lshrrev_b32 v26, 6, v26
    v_mad_u32_u24 v26, v26, s58, v38
    v_add_u32 v3, 80, v36
    v_cmp_le_u32 vcc, 43, v3
    v_add_u32 v5, 43, v3
    v_mov_b32 v6, 42
    v_cndmask_b32 v27, v3, v5, vcc
    v_cmp_le_u32 vcc, 86, v3
    v_add_u32 v5, 43, v27
    s_nop 0
    v_cndmask_b32 v27, v27, v5, vcc
    v_cndmask_b32 v6, 43, v6, vcc
    v_mad_u32_u24 v27, v6, v37, v27
    v_lshrrev_b32 v27, 6, v27
    v_mad_u32_u24 v27, v27, s58, v38
    v_add_u32 v3, 82, v36
    v_cmp_le_u32 vcc, 43, v3
    v_add_u32 v5, 43, v3
    v_mov_b32 v6, 42
    v_cndmask_b32 v28, v3, v5, vcc
    v_cmp_le_u32 vcc, 86, v3
    v_add_u32 v5, 43, v28
    s_nop 0
    v_cndmask_b32 v28, v28, v5, vcc
    v_cndmask_b32 v6, 43, v6, vcc
    v_mad_u32_u24 v28, v6, v37, v28
    v_lshrrev_b32 v28, 6, v28
    v_mad_u32_u24 v28, v28, s58, v38
    v_add_u32 v3, 96, v36
    v_cmp_le_u32 vcc, 43, v3
    v_add_u32 v5, 43, v3
    v_mov_b32 v6, 42
    v_cndmask_b32 v29, v3, v5, vcc
    v_cmp_le_u32 vcc, 86, v3
    v_add_u32 v5, 43, v29
    s_nop 0
    v_cndmask_b32 v29, v29, v5, vcc
    v_cndmask_b32 v6, 43, v6, vcc
    v_mad_u32_u24 v29, v6, v37, v29
    v_lshrrev_b32 v29, 6, v29
    v_mad_u32_u24 v29, v29, s58, v38
    v_add_u32 v3, 98, v36
    v_cmp_le_u32 vcc, 43, v3
    v_add_u32 v5, 43, v3
    v_mov_b32 v6, 42
    v_cndmask_b32 v30, v3, v5, vcc
    v_cmp_le_u32 vcc, 86, v3
    v_add_u32 v5, 43, v30
    s_nop 0
    v_cndmask_b32 v30, v30, v5, vcc
    v_cndmask_b32 v6, 43, v6, vcc
    v_mad_u32_u24 v30, v6, v37, v30
    v_lshrrev_b32 v30, 6, v30
    v_mad_u32_u24 v30, v30, s58, v38
    v_add_u32 v3, 112, v36
    v_cmp_le_u32 vcc, 43, v3
    v_add_u32 v5, 43, v3
    v_mov_b32 v6, 42
    v_cndmask_b32 v31, v3, v5, vcc
    v_cmp_le_u32 vcc, 86, v3
    v_add_u32 v5, 43, v31
    s_nop 0
    v_cndmask_b32 v31, v31, v5, vcc
    v_cndmask_b32 v6, 43, v6, vcc
    v_mad_u32_u24 v31, v6, v37, v31
    v_lshrrev_b32 v31, 6, v31
    v_mad_u32_u24 v31, v31, s58, v38
    v_add_u32 v3, 114, v36
    v_cmp_le_u32 vcc, 43, v3
    v_add_u32 v5, 43, v3
    v_mov_b32 v6, 42
    v_cndmask_b32 v32, v3, v5, vcc
    v_cmp_le_u32 vcc, 86, v3
    v_add_u32 v5, 43, v32
    s_nop 0
    v_cndmask_b32 v32, v32, v5, vcc
    v_cndmask_b32 v6, 43, v6, vcc
    v_mad_u32_u24 v32, v6, v37, v32
    v_lshrrev_b32 v32, 6, v32
    v_mad_u32_u24 v32, v32, s58, v38
    v_bfe_u32 v36, v1, 4, 1
    v_lshl_add_u32 v36, v2, 2, v36
    v_bfe_u32 v3, v1, 2, 2
    v_lshl_add_u32 v36, v3, 4, v36
    v_lshrrev_b32 v37, 5, v1
    s_mov_b32 s58, 125952
    v_add_u32 v3, 0, v36
    v_cmp_le_u32 vcc, 43, v3
    v_add_u32 v5, 43, v3
    v_mov_b32 v6, 42
    v_cndmask_b32 v7, v3, v5, vcc
    v_cmp_le_u32 vcc, 86, v3
    v_add_u32 v5, 43, v7
    s_nop 0
    v_cndmask_b32 v7, v7, v5, vcc
    v_cndmask_b32 v6, 43, v6, vcc
    v_mad_u32_u24 v7, v6, v37, v7
    v_lshl_add_u32 v7, v7, 1, s58
    v_add_u32 v3, 2, v36
    v_cmp_le_u32 vcc, 43, v3
    v_add_u32 v5, 43, v3
    v_mov_b32 v6, 42
    v_cndmask_b32 v8, v3, v5, vcc
    v_cmp_le_u32 vcc, 86, v3
    v_add_u32 v5, 43, v8
    s_nop 0
    v_cndmask_b32 v8, v8, v5, vcc
    v_cndmask_b32 v6, 43, v6, vcc
    v_mad_u32_u24 v8, v6, v37, v8
    v_lshl_add_u32 v8, v8, 1, s58
    v_add_u32 v3, 64, v36
    v_cmp_le_u32 vcc, 43, v3
    v_add_u32 v5, 43, v3
    v_mov_b32 v6, 42
    v_cndmask_b32 v9, v3, v5, vcc
    v_cmp_le_u32 vcc, 86, v3
    v_add_u32 v5, 43, v9
    s_nop 0
    v_cndmask_b32 v9, v9, v5, vcc
    v_cndmask_b32 v6, 43, v6, vcc
    v_mad_u32_u24 v9, v6, v37, v9
    v_lshl_add_u32 v9, v9, 1, s58
    v_add_u32 v3, 66, v36
    v_cmp_le_u32 vcc, 43, v3
    v_add_u32 v5, 43, v3
    v_mov_b32 v6, 42
    v_cndmask_b32 v10, v3, v5, vcc
    v_cmp_le_u32 vcc, 86, v3
    v_add_u32 v5, 43, v10
    s_nop 0
    v_cndmask_b32 v10, v10, v5, vcc
    v_cndmask_b32 v6, 43, v6, vcc
    v_mad_u32_u24 v10, v6, v37, v10
    v_lshl_add_u32 v10, v10, 1, s58
    v_lshlrev_b32 v11, 2, v1
    v_lshl_add_u32 v11, v2, 9, v11
    v_add_u32 v11, 73728, v11
    v_bfe_u32 v3, v1, 2, 2
    v_lshrrev_b32 v4, 4, v1
    v_and_b32 v5, 3, v1
    v_lshl_add_u32 v4, v4, 2, v5
    v_lshl_add_u32 v3, v2, 3, v3
    v_mul_u32_u24 v3, 768, v3
    v_lshl_add_u32 v12, v4, 4, v3
    v_mov_b32 v14, 0xff800000
    s_mov_b32 exec_hi, 0xffff
    s_add_u32 m0, s63, 12288
    s_mul_i32 s58, s85, 1536
    buffer_load_dwordx4 v13, s[32:35], s58 offen nt lds
    buffer_load_dwordx4 v13, s[32:35], s58 offen offset:768 nt lds
    s_add_u32 m0, m0, 1536
    s_nop 0
    buffer_load_dwordx4 v13, s[28:31], s58 offen nt lds
    buffer_load_dwordx4 v13, s[28:31], s58 offen offset:768 nt lds
    s_add_u32 m0, s63, 24576
    s_mul_i32 s58, s86, 1536
    buffer_load_dwordx4 v13, s[32:35], s58 offen nt lds
    buffer_load_dwordx4 v13, s[32:35], s58 offen offset:768 nt lds
    s_add_u32 m0, m0, 1536
    s_nop 0
    buffer_load_dwordx4 v13, s[28:31], s58 offen nt lds
    buffer_load_dwordx4 v13, s[28:31], s58 offen offset:768 nt lds
    s_add_u32 m0, s63, 36864
    s_mul_i32 s58, s87, 1536
    buffer_load_dwordx4 v13, s[32:35], s58 offen nt lds
    buffer_load_dwordx4 v13, s[32:35], s58 offen offset:768 nt lds
    s_add_u32 m0, m0, 1536
    s_nop 0
    buffer_load_dwordx4 v13, s[28:31], s58 offen nt lds
    buffer_load_dwordx4 v13, s[28:31], s58 offen offset:768 nt lds
    s_mov_b32 exec_hi, -1
    s_mov_b32 s36, s14
    s_and_b32 s37, s15, 0xffff
    s_mov_b32 s38, 2097152
    s_mov_b32 s39, 0x20000
    s_mov_b32 s40, s16
    s_and_b32 s41, s17, 0xffff
    s_mov_b32 s42, 2097152
    s_mov_b32 s43, 0x20000
    s_mov_b32 exec_hi, 0
    s_lshl_b32 s60, s56, 10
    s_add_u32 m0, s60, 125952
    s_lshl_b32 s58, s84, 9
    buffer_load_dwordx4 v13, s[36:39], s58 offen nt lds
    s_add_u32 m0, m0, 512
    s_nop 0
    buffer_load_dwordx4 v13, s[40:43], s58 offen nt lds
    s_add_u32 m0, s60, 130048
    s_lshl_b32 s58, s85, 9
    buffer_load_dwordx4 v13, s[36:39], s58 offen nt lds
    s_add_u32 m0, m0, 512
    s_nop 0
    buffer_load_dwordx4 v13, s[40:43], s58 offen nt lds
    s_add_u32 m0, s60, 134144
    s_lshl_b32 s58, s86, 9
    buffer_load_dwordx4 v13, s[36:39], s58 offen nt lds
    s_add_u32 m0, m0, 512
    s_nop 0
    buffer_load_dwordx4 v13, s[40:43], s58 offen nt lds
    s_add_u32 m0, s60, 138240
    s_lshl_b32 s58, s87, 9
    buffer_load_dwordx4 v13, s[36:39], s58 offen nt lds
    s_add_u32 m0, m0, 512
    s_nop 0
    buffer_load_dwordx4 v13, s[40:43], s58 offen nt lds
    s_mov_b32 exec_hi, -1
    s_lshr_b32 s58, s89, 4
    s_mul_i32 s58, s58, 1536
    buffer_load_dwordx2 v[162:163], v15, s[44:47], s58 offen offset:0 nt
    buffer_load_dwordx2 v[164:165], v15, s[44:47], s58 offen offset:128 nt
    buffer_load_dwordx2 v[166:167], v15, s[44:47], s58 offen offset:256 nt
    s_lshr_b32 s58, s90, 4
    s_mul_i32 s58, s58, 1536
    buffer_load_dwordx2 v[168:169], v15, s[44:47], s58 offen offset:0 nt
    buffer_load_dwordx2 v[170:171], v15, s[44:47], s58 offen offset:128 nt
    buffer_load_dwordx2 v[172:173], v15, s[44:47], s58 offen offset:256 nt
    s_mov_b32 s74, 0
    s_mov_b32 s61, 0
    s_mov_b32 s62, 0
    s_movk_i32 s63, 3072
    s_waitcnt vmcnt(26)
    s_barrier
    v_add_u32 v33, s63, v17
    v_add_u32 v34, s63, v18
    ds_read_b64 v[108:109], v33 offset:0
    ds_read_b64 v[110:111], v33 offset:1536
    ds_read_b64 v[112:113], v33 offset:128
    ds_read_b64 v[114:115], v33 offset:1664
    ds_read_b64 v[116:117], v33 offset:256
    ds_read_b64 v[118:119], v33 offset:1792
    ds_read_b64 v[120:121], v34 offset:0
    ds_read_b64 v[122:123], v34 offset:1536
    ds_read_b64 v[124:125], v34 offset:128
    ds_read_b64 v[126:127], v34 offset:1664
    ds_read_b64 v[128:129], v34 offset:256
    ds_read_b64 v[130:131], v34 offset:1792
    s_waitcnt lgkmcnt(0)
    v_lshlrev_b32 v60, 16, v108
    v_and_b32 v61, s66, v108
    v_lshlrev_b32 v62, 16, v109
    v_and_b32 v63, s66, v109
    v_lshlrev_b32 v84, 16, v110
    v_and_b32 v85, s66, v110
    v_lshlrev_b32 v86, 16, v111
    v_and_b32 v87, s66, v111
    v_lshlrev_b32 v64, 16, v112
    v_and_b32 v65, s66, v112
    v_lshlrev_b32 v66, 16, v113
    v_and_b32 v67, s66, v113
    v_lshlrev_b32 v88, 16, v114
    v_and_b32 v89, s66, v114
    v_lshlrev_b32 v90, 16, v115
    v_and_b32 v91, s66, v115
    v_lshlrev_b32 v68, 16, v116
    v_and_b32 v69, s66, v116
    v_lshlrev_b32 v70, 16, v117
    v_and_b32 v71, s66, v117
    v_lshlrev_b32 v92, 16, v118
    v_and_b32 v93, s66, v118
    v_lshlrev_b32 v94, 16, v119
    v_and_b32 v95, s66, v119
    v_lshlrev_b32 v72, 16, v120
    v_and_b32 v73, s66, v120
    v_lshlrev_b32 v74, 16, v121
    v_and_b32 v75, s66, v121
    v_lshlrev_b32 v96, 16, v122
    v_and_b32 v97, s66, v122
    v_lshlrev_b32 v98, 16, v123
    v_and_b32 v99, s66, v123
    v_lshlrev_b32 v76, 16, v124
    v_and_b32 v77, s66, v124
    v_lshlrev_b32 v78, 16, v125
    v_and_b32 v79, s66, v125
    v_lshlrev_b32 v100, 16, v126
    v_and_b32 v101, s66, v126
    v_lshlrev_b32 v102, 16, v127
    v_and_b32 v103, s66, v127
    v_lshlrev_b32 v80, 16, v128
    v_and_b32 v81, s66, v128
    v_lshlrev_b32 v82, 16, v129
    v_and_b32 v83, s66, v129
    v_lshlrev_b32 v104, 16, v130
    v_and_b32 v105, s66, v130
    v_lshlrev_b32 v106, 16, v131
    v_and_b32 v107, s66, v131
L_kblk:
    v_add_u32 v13, s62, v12
    s_add_u32 s62, s62, 24576
    s_cmp_eq_u32 s62, 73728
    s_cselect_b32 s62, 0, s62
    s_barrier
    ds_read_b128 v[36:39], v13 offset:0
    ds_read_b128 v[40:43], v13 offset:256
    ds_read_b128 v[44:47], v13 offset:512
    ds_read_b128 v[48:51], v13 offset:3072
    ds_read_b128 v[52:55], v13 offset:3328
    ds_read_b128 v[56:59], v13 offset:3584
    s_waitcnt lgkmcnt(3)
    v_cvt_f32_i32 v36, v36
    v_cvt_f32_i32 v37, v37
    v_cvt_f32_i32 v38, v38
    v_cvt_f32_i32 v39, v39
    v_cvt_f32_i32 v40, v40
    v_cvt_f32_i32 v41, v41
    v_cvt_f32_i32 v42, v42
    v_cvt_f32_i32 v43, v43
    v_cvt_f32_i32 v44, v44
    v_cvt_f32_i32 v45, v45
    v_cvt_f32_i32 v46, v46
    v_cvt_f32_i32 v47, v47
    v_sub_f32 v36, v36, v60
    v_sub_f32 v37, v37, v61
    v_sub_f32 v38, v38, v62
    v_sub_f32 v39, v39, v63
    v_sub_f32 v40, v40, v64
    v_sub_f32 v41, v41, v65
    v_sub_f32 v42, v42, v66
    v_sub_f32 v43, v43, v67
    v_sub_f32 v44, v44, v68
    v_sub_f32 v45, v45, v69
    v_sub_f32 v46, v46, v70
    v_sub_f32 v47, v47, v71
    v_cvt_pk_bf16_f32 v36, 0, v36
    v_cvt_pk_bf16_f32 v37, 0, v37
    v_cvt_pk_bf16_f32 v38, 0, v38
    v_cvt_pk_bf16_f32 v39, 0, v39
    v_cvt_pk_bf16_f32 v40, 0, v40
    v_cvt_pk_bf16_f32 v41, 0, v41
    v_cvt_pk_bf16_f32 v42, 0, v42
    v_cvt_pk_bf16_f32 v43, 0, v43
    v_cvt_pk_bf16_f32 v44, 0, v44
    v_cvt_pk_bf16_f32 v45, 0, v45
    v_cvt_pk_bf16_f32 v46, 0, v46
    v_cvt_pk_bf16_f32 v47, 0, v47
    v_mul_f32 v36, v36, v84
    v_mul_f32 v37, v37, v85
    v_mul_f32 v38, v38, v86
    v_mul_f32 v39, v39, v87
    v_mul_f32 v40, v40, v88
    v_mul_f32 v41, v41, v89
    v_mul_f32 v42, v42, v90
    v_mul_f32 v43, v43, v91
    v_mul_f32 v44, v44, v92
    v_mul_f32 v45, v45, v93
    v_mul_f32 v46, v46, v94
    v_mul_f32 v47, v47, v95
    v_cvt_pk_bf16_f32 v132, v36, v37
    v_cvt_pk_bf16_f32 v133, v38, v39
    v_cvt_pk_bf16_f32 v134, v40, v41
    v_cvt_pk_bf16_f32 v135, v42, v43
    v_cvt_pk_bf16_f32 v136, v44, v45
    v_cvt_pk_bf16_f32 v137, v46, v47
    v_mfma_f32_16x16x16_bf16 v[144:147], v[132:133], v[156:157], 0
    v_mfma_f32_16x16x16_bf16 v[144:147], v[134:135], v[158:159], v[144:147]
    v_mfma_f32_16x16x16_bf16 v[144:147], v[136:137], v[160:161], v[144:147]
    s_waitcnt lgkmcnt(0)
    v_cvt_f32_i32 v48, v48
    v_cvt_f32_i32 v49, v49
    v_cvt_f32_i32 v50, v50
    v_cvt_f32_i32 v51, v51
    v_cvt_f32_i32 v52, v52
    v_cvt_f32_i32 v53, v53
    v_cvt_f32_i32 v54, v54
    v_cvt_f32_i32 v55, v55
    v_cvt_f32_i32 v56, v56
    v_cvt_f32_i32 v57, v57
    v_cvt_f32_i32 v58, v58
    v_cvt_f32_i32 v59, v59
    v_sub_f32 v48, v48, v72
    v_sub_f32 v49, v49, v73
    v_sub_f32 v50, v50, v74
    v_sub_f32 v51, v51, v75
    v_sub_f32 v52, v52, v76
    v_sub_f32 v53, v53, v77
    v_sub_f32 v54, v54, v78
    v_sub_f32 v55, v55, v79
    v_sub_f32 v56, v56, v80
    v_sub_f32 v57, v57, v81
    v_sub_f32 v58, v58, v82
    v_sub_f32 v59, v59, v83
    v_cvt_pk_bf16_f32 v48, 0, v48
    v_cvt_pk_bf16_f32 v49, 0, v49
    v_cvt_pk_bf16_f32 v50, 0, v50
    v_cvt_pk_bf16_f32 v51, 0, v51
    v_cvt_pk_bf16_f32 v52, 0, v52
    v_cvt_pk_bf16_f32 v53, 0, v53
    v_cvt_pk_bf16_f32 v54, 0, v54
    v_cvt_pk_bf16_f32 v55, 0, v55
    v_cvt_pk_bf16_f32 v56, 0, v56
    v_cvt_pk_bf16_f32 v57, 0, v57
    v_cvt_pk_bf16_f32 v58, 0, v58
    v_cvt_pk_bf16_f32 v59, 0, v59
    v_mul_f32 v48, v48, v96
    v_mul_f32 v49, v49, v97
    v_mul_f32 v50, v50, v98
    v_mul_f32 v51, v51, v99
    v_mul_f32 v52, v52, v100
    v_mul_f32 v53, v53, v101
    v_mul_f32 v54, v54, v102
    v_mul_f32 v55, v55, v103
    v_mul_f32 v56, v56, v104
    v_mul_f32 v57, v57, v105
    v_mul_f32 v58, v58, v106
    v_mul_f32 v59, v59, v107
    v_cvt_pk_bf16_f32 v138, v48, v49
    v_cvt_pk_bf16_f32 v139, v50, v51
    v_add_f32_dpp v3, v145, v144 row_ror:12 row_mask:0xf bank_mask:0xf
    v_cvt_pk_bf16_f32 v140, v52, v53
    v_cvt_pk_bf16_f32 v141, v54, v55
    v_add_f32_dpp v3, v146, v3 row_ror:8 row_mask:0xf bank_mask:0xf
    v_cvt_pk_bf16_f32 v142, v56, v57
    v_cvt_pk_bf16_f32 v143, v58, v59
    v_add_f32_dpp v15, v147, v3 row_ror:4 row_mask:0xf bank_mask:0x1
    v_mfma_f32_16x16x16_bf16 v[148:151], v[138:139], v[156:157], 0
    v_mfma_f32_16x16x16_bf16 v[148:151], v[140:141], v[158:159], v[148:151]
    v_mfma_f32_16x16x16_bf16 v[148:151], v[142:143], v[160:161], v[148:151]
    v_add_u32 v33, s63, v19
    v_add_u32 v34, s63, v20
    ds_read_b64 v[108:109], v33 offset:0
    ds_read_b64 v[110:111], v33 offset:1536
    ds_read_b64 v[112:113], v33 offset:128
    ds_read_b64 v[114:115], v33 offset:1664
    ds_read_b64 v[116:117], v33 offset:256
    ds_read_b64 v[118:119], v33 offset:1792
    ds_read_b64 v[120:121], v34 offset:0
    v_add_f32_dpp v4, v149, v148 row_ror:12 row_mask:0xf bank_mask:0xf
    ds_read_b64 v[122:123], v34 offset:1536
    ds_read_b64 v[124:125], v34 offset:128
    v_add_f32_dpp v4, v150, v4 row_ror:8 row_mask:0xf bank_mask:0xf
    ds_read_b64 v[126:127], v34 offset:1664
    ds_read_b64 v[128:129], v34 offset:256
    ds_read_b64 v[130:131], v34 offset:1792
    v_add_f32_dpp v16, v151, v4 row_ror:4 row_mask:0xf bank_mask:0x1
    s_waitcnt lgkmcnt(0)
    v_lshlrev_b32 v60, 16, v108
    v_and_b32 v61, s66, v108
    v_lshlrev_b32 v62, 16, v109
    v_and_b32 v63, s66, v109
    v_lshlrev_b32 v84, 16, v110
    v_and_b32 v85, s66, v110
    v_lshlrev_b32 v86, 16, v111
    v_and_b32 v87, s66, v111
    v_lshlrev_b32 v64, 16, v112
    v_and_b32 v65, s66, v112
    v_lshlrev_b32 v66, 16, v113
    v_and_b32 v67, s66, v113
    v_lshlrev_b32 v88, 16, v114
    v_and_b32 v89, s66, v114
    v_lshlrev_b32 v90, 16, v115
    v_and_b32 v91, s66, v115
    v_lshlrev_b32 v68, 16, v116
    v_and_b32 v69, s66, v116
    v_lshlrev_b32 v70, 16, v117
    v_and_b32 v71, s66, v117
    v_lshlrev_b32 v92, 16, v118
    v_and_b32 v93, s66, v118
    v_lshlrev_b32 v94, 16, v119
    v_and_b32 v95, s66, v119
    v_lshlrev_b32 v72, 16, v120
    v_and_b32 v73, s66, v120
    v_lshlrev_b32 v74, 16, v121
    v_and_b32 v75, s66, v121
    v_lshlrev_b32 v96, 16, v122
    v_and_b32 v97, s66, v122
    v_lshlrev_b32 v98, 16, v123
    v_and_b32 v99, s66, v123
    v_lshlrev_b32 v76, 16, v124
    v_and_b32 v77, s66, v124
    v_lshlrev_b32 v78, 16, v125
    v_and_b32 v79, s66, v125
    v_lshlrev_b32 v100, 16, v126
    v_and_b32 v101, s66, v126
    v_lshlrev_b32 v102, 16, v127
    v_and_b32 v103, s66, v127
    v_lshlrev_b32 v80, 16, v128
    v_and_b32 v81, s66, v128
    v_lshlrev_b32 v82, 16, v129
    v_and_b32 v83, s66, v129
    v_lshlrev_b32 v104, 16, v130
    v_and_b32 v105, s66, v130
    v_lshlrev_b32 v106, 16, v131
    v_and_b32 v107, s66, v131
    v_add_u32 v13, s62, v12
    s_add_u32 s62, s62, 24576
    s_cmp_eq_u32 s62, 73728
    s_cselect_b32 s62, 0, s62
    s_barrier
    ds_read_b128 v[36:39], v13 offset:0
    ds_read_b128 v[40:43], v13 offset:256
    ds_read_b128 v[44:47], v13 offset:512
    ds_read_b128 v[48:51], v13 offset:3072
    ds_read_b128 v[52:55], v13 offset:3328
    ds_read_b128 v[56:59], v13 offset:3584
    s_waitcnt lgkmcnt(3)
    v_cvt_f32_i32 v36, v36
    v_cvt_f32_i32 v37, v37
    v_cvt_f32_i32 v38, v38
    v_cvt_f32_i32 v39, v39
    v_cvt_f32_i32 v40, v40
    v_cvt_f32_i32 v41, v41
    v_cvt_f32_i32 v42, v42
    v_cvt_f32_i32 v43, v43
    v_cvt_f32_i32 v44, v44
    v_cvt_f32_i32 v45, v45
    v_cvt_f32_i32 v46, v46
    v_cvt_f32_i32 v47, v47
    v_sub_f32 v36, v36, v60
    v_sub_f32 v37, v37, v61
    v_sub_f32 v38, v38, v62
    v_sub_f32 v39, v39, v63
    v_sub_f32 v40, v40, v64
    v_sub_f32 v41, v41, v65
    v_sub_f32 v42, v42, v66
    v_sub_f32 v43, v43, v67
    v_sub_f32 v44, v44, v68
    v_sub_f32 v45, v45, v69
    v_sub_f32 v46, v46, v70
    v_sub_f32 v47, v47, v71
    v_cvt_pk_bf16_f32 v36, 0, v36
    v_cvt_pk_bf16_f32 v37, 0, v37
    v_cvt_pk_bf16_f32 v38, 0, v38
    v_cvt_pk_bf16_f32 v39, 0, v39
    v_cvt_pk_bf16_f32 v40, 0, v40
    v_cvt_pk_bf16_f32 v41, 0, v41
    v_cvt_pk_bf16_f32 v42, 0, v42
    v_cvt_pk_bf16_f32 v43, 0, v43
    v_cvt_pk_bf16_f32 v44, 0, v44
    v_cvt_pk_bf16_f32 v45, 0, v45
    v_cvt_pk_bf16_f32 v46, 0, v46
    v_cvt_pk_bf16_f32 v47, 0, v47
    v_mul_f32 v36, v36, v84
    v_mul_f32 v37, v37, v85
    v_mul_f32 v38, v38, v86
    v_mul_f32 v39, v39, v87
    v_mul_f32 v40, v40, v88
    v_mul_f32 v41, v41, v89
    v_mul_f32 v42, v42, v90
    v_mul_f32 v43, v43, v91
    v_mul_f32 v44, v44, v92
    v_mul_f32 v45, v45, v93
    v_mul_f32 v46, v46, v94
    v_mul_f32 v47, v47, v95
    v_cvt_pk_bf16_f32 v132, v36, v37
    v_cvt_pk_bf16_f32 v133, v38, v39
    v_cvt_pk_bf16_f32 v134, v40, v41
    v_cvt_pk_bf16_f32 v135, v42, v43
    v_cvt_pk_bf16_f32 v136, v44, v45
    v_cvt_pk_bf16_f32 v137, v46, v47
    v_mfma_f32_16x16x16_bf16 v[144:147], v[132:133], v[156:157], 0
    v_mfma_f32_16x16x16_bf16 v[144:147], v[134:135], v[158:159], v[144:147]
    v_mfma_f32_16x16x16_bf16 v[144:147], v[136:137], v[160:161], v[144:147]
    s_waitcnt lgkmcnt(0)
    v_cvt_f32_i32 v48, v48
    v_cvt_f32_i32 v49, v49
    v_cvt_f32_i32 v50, v50
    v_cvt_f32_i32 v51, v51
    v_cvt_f32_i32 v52, v52
    v_cvt_f32_i32 v53, v53
    v_cvt_f32_i32 v54, v54
    v_cvt_f32_i32 v55, v55
    v_cvt_f32_i32 v56, v56
    v_cvt_f32_i32 v57, v57
    v_cvt_f32_i32 v58, v58
    v_cvt_f32_i32 v59, v59
    v_sub_f32 v48, v48, v72
    v_sub_f32 v49, v49, v73
    v_sub_f32 v50, v50, v74
    v_sub_f32 v51, v51, v75
    v_sub_f32 v52, v52, v76
    v_sub_f32 v53, v53, v77
    v_sub_f32 v54, v54, v78
    v_sub_f32 v55, v55, v79
    v_sub_f32 v56, v56, v80
    v_sub_f32 v57, v57, v81
    v_sub_f32 v58, v58, v82
    v_sub_f32 v59, v59, v83
    v_cvt_pk_bf16_f32 v48, 0, v48
    v_cvt_pk_bf16_f32 v49, 0, v49
    v_cvt_pk_bf16_f32 v50, 0, v50
    v_cvt_pk_bf16_f32 v51, 0, v51
    v_cvt_pk_bf16_f32 v52, 0, v52
    v_cvt_pk_bf16_f32 v53, 0, v53
    v_cvt_pk_bf16_f32 v54, 0, v54
    v_cvt_pk_bf16_f32 v55, 0, v55
    v_cvt_pk_bf16_f32 v56, 0, v56
    v_cvt_pk_bf16_f32 v57, 0, v57
    v_cvt_pk_bf16_f32 v58, 0, v58
    v_cvt_pk_bf16_f32 v59, 0, v59
    v_mul_f32 v48, v48, v96
    v_mul_f32 v49, v49, v97
    v_mul_f32 v50, v50, v98
    v_mul_f32 v51, v51, v99
    v_mul_f32 v52, v52, v100
    v_mul_f32 v53, v53, v101
    v_mul_f32 v54, v54, v102
    v_mul_f32 v55, v55, v103
    v_mul_f32 v56, v56, v104
    v_mul_f32 v57, v57, v105
    v_mul_f32 v58, v58, v106
    v_mul_f32 v59, v59, v107
    v_cvt_pk_bf16_f32 v138, v48, v49
    v_cvt_pk_bf16_f32 v139, v50, v51
    v_add_f32_dpp v3, v146, v145 row_ror:12 row_mask:0xf bank_mask:0xf
    v_cvt_pk_bf16_f32 v140, v52, v53
    v_cvt_pk_bf16_f32 v141, v54, v55
    v_add_f32_dpp v3, v147, v3 row_ror:8 row_mask:0xf bank_mask:0xf
    v_cvt_pk_bf16_f32 v142, v56, v57
    v_cvt_pk_bf16_f32 v143, v58, v59
    v_add_f32_dpp v15, v144, v3 row_ror:4 row_mask:0xf bank_mask:0x2
    v_mfma_f32_16x16x16_bf16 v[148:151], v[138:139], v[156:157], 0
    v_mfma_f32_16x16x16_bf16 v[148:151], v[140:141], v[158:159], v[148:151]
    v_mfma_f32_16x16x16_bf16 v[148:151], v[142:143], v[160:161], v[148:151]
    v_add_u32 v33, s63, v21
    v_add_u32 v34, s63, v22
    ds_read_b64 v[108:109], v33 offset:0
    ds_read_b64 v[110:111], v33 offset:1536
    ds_read_b64 v[112:113], v33 offset:128
    ds_read_b64 v[114:115], v33 offset:1664
    ds_read_b64 v[116:117], v33 offset:256
    ds_read_b64 v[118:119], v33 offset:1792
    ds_read_b64 v[120:121], v34 offset:0
    v_add_f32_dpp v4, v150, v149 row_ror:12 row_mask:0xf bank_mask:0xf
    ds_read_b64 v[122:123], v34 offset:1536
    ds_read_b64 v[124:125], v34 offset:128
    v_add_f32_dpp v4, v151, v4 row_ror:8 row_mask:0xf bank_mask:0xf
    ds_read_b64 v[126:127], v34 offset:1664
    ds_read_b64 v[128:129], v34 offset:256
    ds_read_b64 v[130:131], v34 offset:1792
    v_add_f32_dpp v16, v148, v4 row_ror:4 row_mask:0xf bank_mask:0x2
    s_waitcnt lgkmcnt(0)
    v_lshlrev_b32 v60, 16, v108
    v_and_b32 v61, s66, v108
    v_lshlrev_b32 v62, 16, v109
    v_and_b32 v63, s66, v109
    v_lshlrev_b32 v84, 16, v110
    v_and_b32 v85, s66, v110
    v_lshlrev_b32 v86, 16, v111
    v_and_b32 v87, s66, v111
    v_lshlrev_b32 v64, 16, v112
    v_and_b32 v65, s66, v112
    v_lshlrev_b32 v66, 16, v113
    v_and_b32 v67, s66, v113
    v_lshlrev_b32 v88, 16, v114
    v_and_b32 v89, s66, v114
    v_lshlrev_b32 v90, 16, v115
    v_and_b32 v91, s66, v115
    v_lshlrev_b32 v68, 16, v116
    v_and_b32 v69, s66, v116
    v_lshlrev_b32 v70, 16, v117
    v_and_b32 v71, s66, v117
    v_lshlrev_b32 v92, 16, v118
    v_and_b32 v93, s66, v118
    v_lshlrev_b32 v94, 16, v119
    v_and_b32 v95, s66, v119
    v_lshlrev_b32 v72, 16, v120
    v_and_b32 v73, s66, v120
    v_lshlrev_b32 v74, 16, v121
    v_and_b32 v75, s66, v121
    v_lshlrev_b32 v96, 16, v122
    v_and_b32 v97, s66, v122
    v_lshlrev_b32 v98, 16, v123
    v_and_b32 v99, s66, v123
    v_lshlrev_b32 v76, 16, v124
    v_and_b32 v77, s66, v124
    v_lshlrev_b32 v78, 16, v125
    v_and_b32 v79, s66, v125
    v_lshlrev_b32 v100, 16, v126
    v_and_b32 v101, s66, v126
    v_lshlrev_b32 v102, 16, v127
    v_and_b32 v103, s66, v127
    v_lshlrev_b32 v80, 16, v128
    v_and_b32 v81, s66, v128
    v_lshlrev_b32 v82, 16, v129
    v_and_b32 v83, s66, v129
    v_lshlrev_b32 v104, 16, v130
    v_and_b32 v105, s66, v130
    v_lshlrev_b32 v106, 16, v131
    v_and_b32 v107, s66, v131
    v_add_u32 v13, s62, v12
    s_add_u32 s62, s62, 24576
    s_cmp_eq_u32 s62, 73728
    s_cselect_b32 s62, 0, s62
    s_barrier
    ds_read_b128 v[36:39], v13 offset:0
    ds_read_b128 v[40:43], v13 offset:256
    ds_read_b128 v[44:47], v13 offset:512
    ds_read_b128 v[48:51], v13 offset:3072
    ds_read_b128 v[52:55], v13 offset:3328
    ds_read_b128 v[56:59], v13 offset:3584
    s_waitcnt lgkmcnt(3)
    v_cvt_f32_i32 v36, v36
    v_cvt_f32_i32 v37, v37
    v_cvt_f32_i32 v38, v38
    v_cvt_f32_i32 v39, v39
    v_cvt_f32_i32 v40, v40
    v_cvt_f32_i32 v41, v41
    v_cvt_f32_i32 v42, v42
    v_cvt_f32_i32 v43, v43
    v_cvt_f32_i32 v44, v44
    v_cvt_f32_i32 v45, v45
    v_cvt_f32_i32 v46, v46
    v_cvt_f32_i32 v47, v47
    v_sub_f32 v36, v36, v60
    v_sub_f32 v37, v37, v61
    v_sub_f32 v38, v38, v62
    v_sub_f32 v39, v39, v63
    v_sub_f32 v40, v40, v64
    v_sub_f32 v41, v41, v65
    v_sub_f32 v42, v42, v66
    v_sub_f32 v43, v43, v67
    v_sub_f32 v44, v44, v68
    v_sub_f32 v45, v45, v69
    v_sub_f32 v46, v46, v70
    v_sub_f32 v47, v47, v71
    v_cvt_pk_bf16_f32 v36, 0, v36
    v_cvt_pk_bf16_f32 v37, 0, v37
    v_cvt_pk_bf16_f32 v38, 0, v38
    v_cvt_pk_bf16_f32 v39, 0, v39
    v_cvt_pk_bf16_f32 v40, 0, v40
    v_cvt_pk_bf16_f32 v41, 0, v41
    v_cvt_pk_bf16_f32 v42, 0, v42
    v_cvt_pk_bf16_f32 v43, 0, v43
    v_cvt_pk_bf16_f32 v44, 0, v44
    v_cvt_pk_bf16_f32 v45, 0, v45
    v_cvt_pk_bf16_f32 v46, 0, v46
    v_cvt_pk_bf16_f32 v47, 0, v47
    v_mul_f32 v36, v36, v84
    v_mul_f32 v37, v37, v85
    v_mul_f32 v38, v38, v86
    v_mul_f32 v39, v39, v87
    v_mul_f32 v40, v40, v88
    v_mul_f32 v41, v41, v89
    v_mul_f32 v42, v42, v90
    v_mul_f32 v43, v43, v91
    v_mul_f32 v44, v44, v92
    v_mul_f32 v45, v45, v93
    v_mul_f32 v46, v46, v94
    v_mul_f32 v47, v47, v95
    v_cvt_pk_bf16_f32 v132, v36, v37
    v_cvt_pk_bf16_f32 v133, v38, v39
    v_cvt_pk_bf16_f32 v134, v40, v41
    v_cvt_pk_bf16_f32 v135, v42, v43
    v_cvt_pk_bf16_f32 v136, v44, v45
    v_cvt_pk_bf16_f32 v137, v46, v47
    v_mfma_f32_16x16x16_bf16 v[144:147], v[132:133], v[156:157], 0
    v_mfma_f32_16x16x16_bf16 v[144:147], v[134:135], v[158:159], v[144:147]
    v_mfma_f32_16x16x16_bf16 v[144:147], v[136:137], v[160:161], v[144:147]
    s_waitcnt lgkmcnt(0)
    v_cvt_f32_i32 v48, v48
    v_cvt_f32_i32 v49, v49
    v_cvt_f32_i32 v50, v50
    v_cvt_f32_i32 v51, v51
    v_cvt_f32_i32 v52, v52
    v_cvt_f32_i32 v53, v53
    v_cvt_f32_i32 v54, v54
    v_cvt_f32_i32 v55, v55
    v_cvt_f32_i32 v56, v56
    v_cvt_f32_i32 v57, v57
    v_cvt_f32_i32 v58, v58
    v_cvt_f32_i32 v59, v59
    v_sub_f32 v48, v48, v72
    v_sub_f32 v49, v49, v73
    v_sub_f32 v50, v50, v74
    v_sub_f32 v51, v51, v75
    v_sub_f32 v52, v52, v76
    v_sub_f32 v53, v53, v77
    v_sub_f32 v54, v54, v78
    v_sub_f32 v55, v55, v79
    v_sub_f32 v56, v56, v80
    v_sub_f32 v57, v57, v81
    v_sub_f32 v58, v58, v82
    v_sub_f32 v59, v59, v83
    v_cvt_pk_bf16_f32 v48, 0, v48
    v_cvt_pk_bf16_f32 v49, 0, v49
    v_cvt_pk_bf16_f32 v50, 0, v50
    v_cvt_pk_bf16_f32 v51, 0, v51
    v_cvt_pk_bf16_f32 v52, 0, v52
    v_cvt_pk_bf16_f32 v53, 0, v53
    v_cvt_pk_bf16_f32 v54, 0, v54
    v_cvt_pk_bf16_f32 v55, 0, v55
    v_cvt_pk_bf16_f32 v56, 0, v56
    v_cvt_pk_bf16_f32 v57, 0, v57
    v_cvt_pk_bf16_f32 v58, 0, v58
    v_cvt_pk_bf16_f32 v59, 0, v59
    v_mul_f32 v48, v48, v96
    v_mul_f32 v49, v49, v97
    v_mul_f32 v50, v50, v98
    v_mul_f32 v51, v51, v99
    v_mul_f32 v52, v52, v100
    v_mul_f32 v53, v53, v101
    v_mul_f32 v54, v54, v102
    v_mul_f32 v55, v55, v103
    v_mul_f32 v56, v56, v104
    v_mul_f32 v57, v57, v105
    v_mul_f32 v58, v58, v106
    v_mul_f32 v59, v59, v107
    v_cvt_pk_bf16_f32 v138, v48, v49
    v_cvt_pk_bf16_f32 v139, v50, v51
    v_add_f32_dpp v3, v147, v146 row_ror:12 row_mask:0xf bank_mask:0xf
    v_cvt_pk_bf16_f32 v140, v52, v53
    v_cvt_pk_bf16_f32 v141, v54, v55
    v_add_f32_dpp v3, v144, v3 row_ror:8 row_mask:0xf bank_mask:0xf
    v_cvt_pk_bf16_f32 v142, v56, v57
    v_cvt_pk_bf16_f32 v143, v58, v59
    v_add_f32_dpp v15, v145, v3 row_ror:4 row_mask:0xf bank_mask:0x4
    v_mfma_f32_16x16x16_bf16 v[148:151], v[138:139], v[156:157], 0
    v_mfma_f32_16x16x16_bf16 v[148:151], v[140:141], v[158:159], v[148:151]
    v_mfma_f32_16x16x16_bf16 v[148:151], v[142:143], v[160:161], v[148:151]
    v_add_u32 v33, s63, v23
    v_add_u32 v34, s63, v24
    ds_read_b64 v[108:109], v33 offset:0
    ds_read_b64 v[110:111], v33 offset:1536
    ds_read_b64 v[112:113], v33 offset:128
    ds_read_b64 v[114:115], v33 offset:1664
    ds_read_b64 v[116:117], v33 offset:256
    ds_read_b64 v[118:119], v33 offset:1792
    ds_read_b64 v[120:121], v34 offset:0
    v_add_f32_dpp v4, v151, v150 row_ror:12 row_mask:0xf bank_mask:0xf
    ds_read_b64 v[122:123], v34 offset:1536
    ds_read_b64 v[124:125], v34 offset:128
    v_add_f32_dpp v4, v148, v4 row_ror:8 row_mask:0xf bank_mask:0xf
    ds_read_b64 v[126:127], v34 offset:1664
    ds_read_b64 v[128:129], v34 offset:256
    ds_read_b64 v[130:131], v34 offset:1792
    v_add_f32_dpp v16, v149, v4 row_ror:4 row_mask:0xf bank_mask:0x4
    s_waitcnt lgkmcnt(0)
    v_lshlrev_b32 v60, 16, v108
    v_and_b32 v61, s66, v108
    v_lshlrev_b32 v62, 16, v109
    v_and_b32 v63, s66, v109
    v_lshlrev_b32 v84, 16, v110
    v_and_b32 v85, s66, v110
    v_lshlrev_b32 v86, 16, v111
    v_and_b32 v87, s66, v111
    v_lshlrev_b32 v64, 16, v112
    v_and_b32 v65, s66, v112
    v_lshlrev_b32 v66, 16, v113
    v_and_b32 v67, s66, v113
    v_lshlrev_b32 v88, 16, v114
    v_and_b32 v89, s66, v114
    v_lshlrev_b32 v90, 16, v115
    v_and_b32 v91, s66, v115
    v_lshlrev_b32 v68, 16, v116
    v_and_b32 v69, s66, v116
    v_lshlrev_b32 v70, 16, v117
    v_and_b32 v71, s66, v117
    v_lshlrev_b32 v92, 16, v118
    v_and_b32 v93, s66, v118
    v_lshlrev_b32 v94, 16, v119
    v_and_b32 v95, s66, v119
    v_lshlrev_b32 v72, 16, v120
    v_and_b32 v73, s66, v120
    v_lshlrev_b32 v74, 16, v121
    v_and_b32 v75, s66, v121
    v_lshlrev_b32 v96, 16, v122
    v_and_b32 v97, s66, v122
    v_lshlrev_b32 v98, 16, v123
    v_and_b32 v99, s66, v123
    v_lshlrev_b32 v76, 16, v124
    v_and_b32 v77, s66, v124
    v_lshlrev_b32 v78, 16, v125
    v_and_b32 v79, s66, v125
    v_lshlrev_b32 v100, 16, v126
    v_and_b32 v101, s66, v126
    v_lshlrev_b32 v102, 16, v127
    v_and_b32 v103, s66, v127
    v_lshlrev_b32 v80, 16, v128
    v_and_b32 v81, s66, v128
    v_lshlrev_b32 v82, 16, v129
    v_and_b32 v83, s66, v129
    v_lshlrev_b32 v104, 16, v130
    v_and_b32 v105, s66, v130
    v_lshlrev_b32 v106, 16, v131
    v_and_b32 v107, s66, v131
    v_add_u32 v13, s62, v12
    s_add_u32 s62, s62, 24576
    s_cmp_eq_u32 s62, 73728
    s_cselect_b32 s62, 0, s62
    s_barrier
    ds_read_b128 v[36:39], v13 offset:0
    ds_read_b128 v[40:43], v13 offset:256
    ds_read_b128 v[44:47], v13 offset:512
    ds_read_b128 v[48:51], v13 offset:3072
    ds_read_b128 v[52:55], v13 offset:3328
    ds_read_b128 v[56:59], v13 offset:3584
    s_waitcnt lgkmcnt(3)
    v_cvt_f32_i32 v36, v36
    v_cvt_f32_i32 v37, v37
    v_cvt_f32_i32 v38, v38
    v_cvt_f32_i32 v39, v39
    v_cvt_f32_i32 v40, v40
    v_cvt_f32_i32 v41, v41
    v_cvt_f32_i32 v42, v42
    v_cvt_f32_i32 v43, v43
    v_cvt_f32_i32 v44, v44
    v_cvt_f32_i32 v45, v45
    v_cvt_f32_i32 v46, v46
    v_cvt_f32_i32 v47, v47
    v_sub_f32 v36, v36, v60
    v_sub_f32 v37, v37, v61
    v_sub_f32 v38, v38, v62
    v_sub_f32 v39, v39, v63
    v_sub_f32 v40, v40, v64
    v_sub_f32 v41, v41, v65
    v_sub_f32 v42, v42, v66
    v_sub_f32 v43, v43, v67
    v_sub_f32 v44, v44, v68
    v_sub_f32 v45, v45, v69
    v_sub_f32 v46, v46, v70
    v_sub_f32 v47, v47, v71
    v_cvt_pk_bf16_f32 v36, 0, v36
    v_cvt_pk_bf16_f32 v37, 0, v37
    v_cvt_pk_bf16_f32 v38, 0, v38
    v_cvt_pk_bf16_f32 v39, 0, v39
    v_cvt_pk_bf16_f32 v40, 0, v40
    v_cvt_pk_bf16_f32 v41, 0, v41
    v_cvt_pk_bf16_f32 v42, 0, v42
    v_cvt_pk_bf16_f32 v43, 0, v43
    v_cvt_pk_bf16_f32 v44, 0, v44
    v_cvt_pk_bf16_f32 v45, 0, v45
    v_cvt_pk_bf16_f32 v46, 0, v46
    v_cvt_pk_bf16_f32 v47, 0, v47
    v_mul_f32 v36, v36, v84
    v_mul_f32 v37, v37, v85
    v_mul_f32 v38, v38, v86
    v_mul_f32 v39, v39, v87
    v_mul_f32 v40, v40, v88
    v_mul_f32 v41, v41, v89
    v_mul_f32 v42, v42, v90
    v_mul_f32 v43, v43, v91
    v_mul_f32 v44, v44, v92
    v_mul_f32 v45, v45, v93
    v_mul_f32 v46, v46, v94
    v_mul_f32 v47, v47, v95
    v_cvt_pk_bf16_f32 v132, v36, v37
    v_cvt_pk_bf16_f32 v133, v38, v39
    v_cvt_pk_bf16_f32 v134, v40, v41
    v_cvt_pk_bf16_f32 v135, v42, v43
    v_cvt_pk_bf16_f32 v136, v44, v45
    v_cvt_pk_bf16_f32 v137, v46, v47
    v_mfma_f32_16x16x16_bf16 v[144:147], v[132:133], v[156:157], 0
    v_mfma_f32_16x16x16_bf16 v[144:147], v[134:135], v[158:159], v[144:147]
    v_mfma_f32_16x16x16_bf16 v[144:147], v[136:137], v[160:161], v[144:147]
    s_waitcnt lgkmcnt(0)
    v_cvt_f32_i32 v48, v48
    v_cvt_f32_i32 v49, v49
    v_cvt_f32_i32 v50, v50
    v_cvt_f32_i32 v51, v51
    v_cvt_f32_i32 v52, v52
    v_cvt_f32_i32 v53, v53
    v_cvt_f32_i32 v54, v54
    v_cvt_f32_i32 v55, v55
    v_cvt_f32_i32 v56, v56
    v_cvt_f32_i32 v57, v57
    v_cvt_f32_i32 v58, v58
    v_cvt_f32_i32 v59, v59
    v_sub_f32 v48, v48, v72
    v_sub_f32 v49, v49, v73
    v_sub_f32 v50, v50, v74
    v_sub_f32 v51, v51, v75
    v_sub_f32 v52, v52, v76
    v_sub_f32 v53, v53, v77
    v_sub_f32 v54, v54, v78
    v_sub_f32 v55, v55, v79
    v_sub_f32 v56, v56, v80
    v_sub_f32 v57, v57, v81
    v_sub_f32 v58, v58, v82
    v_sub_f32 v59, v59, v83
    v_cvt_pk_bf16_f32 v48, 0, v48
    v_cvt_pk_bf16_f32 v49, 0, v49
    v_cvt_pk_bf16_f32 v50, 0, v50
    v_cvt_pk_bf16_f32 v51, 0, v51
    v_cvt_pk_bf16_f32 v52, 0, v52
    v_cvt_pk_bf16_f32 v53, 0, v53
    v_cvt_pk_bf16_f32 v54, 0, v54
    v_cvt_pk_bf16_f32 v55, 0, v55
    v_cvt_pk_bf16_f32 v56, 0, v56
    v_cvt_pk_bf16_f32 v57, 0, v57
    v_cvt_pk_bf16_f32 v58, 0, v58
    v_cvt_pk_bf16_f32 v59, 0, v59
    v_mul_f32 v48, v48, v96
    v_mul_f32 v49, v49, v97
    v_mul_f32 v50, v50, v98
    v_mul_f32 v51, v51, v99
    v_mul_f32 v52, v52, v100
    v_mul_f32 v53, v53, v101
    v_mul_f32 v54, v54, v102
    v_mul_f32 v55, v55, v103
    v_mul_f32 v56, v56, v104
    v_mul_f32 v57, v57, v105
    v_mul_f32 v58, v58, v106
    v_mul_f32 v59, v59, v107
    v_cvt_pk_bf16_f32 v138, v48, v49
    v_cvt_pk_bf16_f32 v139, v50, v51
    v_add_f32_dpp v3, v144, v147 row_ror:12 row_mask:0xf bank_mask:0xf
    v_cvt_pk_bf16_f32 v140, v52, v53
    v_cvt_pk_bf16_f32 v141, v54, v55
    v_add_f32_dpp v3, v145, v3 row_ror:8 row_mask:0xf bank_mask:0xf
    v_cvt_pk_bf16_f32 v142, v56, v57
    v_cvt_pk_bf16_f32 v143, v58, v59
    v_add_f32_dpp v15, v146, v3 row_ror:4 row_mask:0xf bank_mask:0x8
    v_mfma_f32_16x16x16_bf16 v[148:151], v[138:139], v[156:157], 0
    v_mfma_f32_16x16x16_bf16 v[148:151], v[140:141], v[158:159], v[148:151]
    v_mfma_f32_16x16x16_bf16 v[148:151], v[142:143], v[160:161], v[148:151]
    v_add_u32 v33, s63, v25
    v_add_u32 v34, s63, v26
    ds_read_b64 v[108:109], v33 offset:0
    ds_read_b64 v[110:111], v33 offset:1536
    ds_read_b64 v[112:113], v33 offset:128
    ds_read_b64 v[114:115], v33 offset:1664
    ds_read_b64 v[116:117], v33 offset:256
    ds_read_b64 v[118:119], v33 offset:1792
    ds_read_b64 v[120:121], v34 offset:0
    v_add_f32_dpp v4, v148, v151 row_ror:12 row_mask:0xf bank_mask:0xf
    ds_read_b64 v[122:123], v34 offset:1536
    ds_read_b64 v[124:125], v34 offset:128
    v_add_f32_dpp v4, v149, v4 row_ror:8 row_mask:0xf bank_mask:0xf
    ds_read_b64 v[126:127], v34 offset:1664
    ds_read_b64 v[128:129], v34 offset:256
    ds_read_b64 v[130:131], v34 offset:1792
    v_add_f32_dpp v16, v150, v4 row_ror:4 row_mask:0xf bank_mask:0x8
    v_cvt_pk_bf16_f32 v3, 0, v15
    v_cvt_pk_bf16_f32 v4, 0, v16
    v_mul_f32 v3, s65, v3
    v_mul_f32 v4, s65, v4
    v_cvt_pk_bf16_f32 v5, v3, v4
    v_max3_f32 v14, v14, v3, v4
    ds_write_b32 v11, v5 offset:0
    s_waitcnt lgkmcnt(0)
    v_lshlrev_b32 v60, 16, v108
    v_and_b32 v61, s66, v108
    v_lshlrev_b32 v62, 16, v109
    v_and_b32 v63, s66, v109
    v_lshlrev_b32 v84, 16, v110
    v_and_b32 v85, s66, v110
    v_lshlrev_b32 v86, 16, v111
    v_and_b32 v87, s66, v111
    v_lshlrev_b32 v64, 16, v112
    v_and_b32 v65, s66, v112
    v_lshlrev_b32 v66, 16, v113
    v_and_b32 v67, s66, v113
    v_lshlrev_b32 v88, 16, v114
    v_and_b32 v89, s66, v114
    v_lshlrev_b32 v90, 16, v115
    v_and_b32 v91, s66, v115
    v_lshlrev_b32 v68, 16, v116
    v_and_b32 v69, s66, v116
    v_lshlrev_b32 v70, 16, v117
    v_and_b32 v71, s66, v117
    v_lshlrev_b32 v92, 16, v118
    v_and_b32 v93, s66, v118
    v_lshlrev_b32 v94, 16, v119
    v_and_b32 v95, s66, v119
    v_lshlrev_b32 v72, 16, v120
    v_and_b32 v73, s66, v120
    v_lshlrev_b32 v74, 16, v121
    v_and_b32 v75, s66, v121
    v_lshlrev_b32 v96, 16, v122
    v_and_b32 v97, s66, v122
    v_lshlrev_b32 v98, 16, v123
    v_and_b32 v99, s66, v123
    v_lshlrev_b32 v76, 16, v124
    v_and_b32 v77, s66, v124
    v_lshlrev_b32 v78, 16, v125
    v_and_b32 v79, s66, v125
    v_lshlrev_b32 v100, 16, v126
    v_and_b32 v101, s66, v126
    v_lshlrev_b32 v102, 16, v127
    v_and_b32 v103, s66, v127
    v_lshlrev_b32 v80, 16, v128
    v_and_b32 v81, s66, v128
    v_lshlrev_b32 v82, 16, v129
    v_and_b32 v83, s66, v129
    v_lshlrev_b32 v104, 16, v130
    v_and_b32 v105, s66, v130
    v_lshlrev_b32 v106, 16, v131
    v_and_b32 v107, s66, v131
    s_waitcnt vmcnt(0)
    v_add_u32 v13, s62, v12
    s_add_u32 s62, s62, 24576
    s_cmp_eq_u32 s62, 73728
    s_cselect_b32 s62, 0, s62
    s_barrier
    ds_read_b128 v[36:39], v13 offset:0
    ds_read_b128 v[40:43], v13 offset:256
    ds_read_b128 v[44:47], v13 offset:512
    ds_read_b128 v[48:51], v13 offset:3072
    ds_read_b128 v[52:55], v13 offset:3328
    ds_read_b128 v[56:59], v13 offset:3584
    s_waitcnt lgkmcnt(3)
    v_cvt_f32_i32 v36, v36
    v_cvt_f32_i32 v37, v37
    v_cvt_f32_i32 v38, v38
    v_cvt_f32_i32 v39, v39
    v_cvt_f32_i32 v40, v40
    v_cvt_f32_i32 v41, v41
    v_cvt_f32_i32 v42, v42
    v_cvt_f32_i32 v43, v43
    v_cvt_f32_i32 v44, v44
    v_cvt_f32_i32 v45, v45
    v_cvt_f32_i32 v46, v46
    v_cvt_f32_i32 v47, v47
    v_sub_f32 v36, v36, v60
    v_sub_f32 v37, v37, v61
    v_sub_f32 v38, v38, v62
    v_sub_f32 v39, v39, v63
    v_sub_f32 v40, v40, v64
    v_sub_f32 v41, v41, v65
    v_sub_f32 v42, v42, v66
    v_sub_f32 v43, v43, v67
    v_sub_f32 v44, v44, v68
    v_sub_f32 v45, v45, v69
    v_sub_f32 v46, v46, v70
    v_sub_f32 v47, v47, v71
    v_cvt_pk_bf16_f32 v36, 0, v36
    v_cvt_pk_bf16_f32 v37, 0, v37
    v_cvt_pk_bf16_f32 v38, 0, v38
    v_cvt_pk_bf16_f32 v39, 0, v39
    v_cvt_pk_bf16_f32 v40, 0, v40
    v_cvt_pk_bf16_f32 v41, 0, v41
    v_cvt_pk_bf16_f32 v42, 0, v42
    v_cvt_pk_bf16_f32 v43, 0, v43
    v_cvt_pk_bf16_f32 v44, 0, v44
    v_cvt_pk_bf16_f32 v45, 0, v45
    v_cvt_pk_bf16_f32 v46, 0, v46
    v_cvt_pk_bf16_f32 v47, 0, v47
    v_mul_f32 v36, v36, v84
    v_mul_f32 v37, v37, v85
    v_mul_f32 v38, v38, v86
    v_mul_f32 v39, v39, v87
    v_mul_f32 v40, v40, v88
    v_mul_f32 v41, v41, v89
    v_mul_f32 v42, v42, v90
    v_mul_f32 v43, v43, v91
    v_mul_f32 v44, v44, v92
    v_mul_f32 v45, v45, v93
    v_mul_f32 v46, v46, v94
    v_mul_f32 v47, v47, v95
    v_cvt_pk_bf16_f32 v132, v36, v37
    v_cvt_pk_bf16_f32 v133, v38, v39
    v_cvt_pk_bf16_f32 v134, v40, v41
    v_cvt_pk_bf16_f32 v135, v42, v43
    v_cvt_pk_bf16_f32 v136, v44, v45
    v_cvt_pk_bf16_f32 v137, v46, v47
    v_mfma_f32_16x16x16_bf16 v[144:147], v[132:133], v[156:157], 0
    v_mfma_f32_16x16x16_bf16 v[144:147], v[134:135], v[158:159], v[144:147]
    v_mfma_f32_16x16x16_bf16 v[144:147], v[136:137], v[160:161], v[144:147]
    s_waitcnt lgkmcnt(0)
    v_cvt_f32_i32 v48, v48
    v_cvt_f32_i32 v49, v49
    v_cvt_f32_i32 v50, v50
    v_cvt_f32_i32 v51, v51
    v_cvt_f32_i32 v52, v52
    v_cvt_f32_i32 v53, v53
    v_cvt_f32_i32 v54, v54
    v_cvt_f32_i32 v55, v55
    v_cvt_f32_i32 v56, v56
    v_cvt_f32_i32 v57, v57
    v_cvt_f32_i32 v58, v58
    v_cvt_f32_i32 v59, v59
    v_sub_f32 v48, v48, v72
    v_sub_f32 v49, v49, v73
    v_sub_f32 v50, v50, v74
    v_sub_f32 v51, v51, v75
    v_sub_f32 v52, v52, v76
    v_sub_f32 v53, v53, v77
    v_sub_f32 v54, v54, v78
    v_sub_f32 v55, v55, v79
    v_sub_f32 v56, v56, v80
    v_sub_f32 v57, v57, v81
    v_sub_f32 v58, v58, v82
    v_sub_f32 v59, v59, v83
    v_cvt_pk_bf16_f32 v48, 0, v48
    v_cvt_pk_bf16_f32 v49, 0, v49
    v_cvt_pk_bf16_f32 v50, 0, v50
    v_cvt_pk_bf16_f32 v51, 0, v51
    v_cvt_pk_bf16_f32 v52, 0, v52
    v_cvt_pk_bf16_f32 v53, 0, v53
    v_cvt_pk_bf16_f32 v54, 0, v54
    v_cvt_pk_bf16_f32 v55, 0, v55
    v_cvt_pk_bf16_f32 v56, 0, v56
    v_cvt_pk_bf16_f32 v57, 0, v57
    v_cvt_pk_bf16_f32 v58, 0, v58
    v_cvt_pk_bf16_f32 v59, 0, v59
    v_mul_f32 v48, v48, v96
    v_mul_f32 v49, v49, v97
    v_mul_f32 v50, v50, v98
    v_mul_f32 v51, v51, v99
    v_mul_f32 v52, v52, v100
    v_mul_f32 v53, v53, v101
    v_mul_f32 v54, v54, v102
    v_mul_f32 v55, v55, v103
    v_mul_f32 v56, v56, v104
    v_mul_f32 v57, v57, v105
    v_mul_f32 v58, v58, v106
    v_mul_f32 v59, v59, v107
    v_cvt_pk_bf16_f32 v138, v48, v49
    v_cvt_pk_bf16_f32 v139, v50, v51
    v_add_f32_dpp v3, v145, v144 row_ror:12 row_mask:0xf bank_mask:0xf
    v_cvt_pk_bf16_f32 v140, v52, v53
    v_cvt_pk_bf16_f32 v141, v54, v55
    v_add_f32_dpp v3, v146, v3 row_ror:8 row_mask:0xf bank_mask:0xf
    v_cvt_pk_bf16_f32 v142, v56, v57
    v_cvt_pk_bf16_f32 v143, v58, v59
    v_add_f32_dpp v15, v147, v3 row_ror:4 row_mask:0xf bank_mask:0x1
    v_mfma_f32_16x16x16_bf16 v[148:151], v[138:139], v[156:157], 0
    v_mfma_f32_16x16x16_bf16 v[148:151], v[140:141], v[158:159], v[148:151]
    v_mfma_f32_16x16x16_bf16 v[148:151], v[142:143], v[160:161], v[148:151]
    v_add_u32 v33, s63, v27
    v_add_u32 v34, s63, v28
    ds_read_b64 v[108:109], v33 offset:0
    ds_read_b64 v[110:111], v33 offset:1536
    ds_read_b64 v[112:113], v33 offset:128
    ds_read_b64 v[114:115], v33 offset:1664
    ds_read_b64 v[116:117], v33 offset:256
    ds_read_b64 v[118:119], v33 offset:1792
    ds_read_b64 v[120:121], v34 offset:0
    v_add_f32_dpp v4, v149, v148 row_ror:12 row_mask:0xf bank_mask:0xf
    ds_read_b64 v[122:123], v34 offset:1536
    ds_read_b64 v[124:125], v34 offset:128
    v_add_f32_dpp v4, v150, v4 row_ror:8 row_mask:0xf bank_mask:0xf
    ds_read_b64 v[126:127], v34 offset:1664
    ds_read_b64 v[128:129], v34 offset:256
    ds_read_b64 v[130:131], v34 offset:1792
    v_add_f32_dpp v16, v151, v4 row_ror:4 row_mask:0xf bank_mask:0x1
    s_waitcnt lgkmcnt(0)
    v_lshlrev_b32 v60, 16, v108
    v_and_b32 v61, s66, v108
    v_lshlrev_b32 v62, 16, v109
    v_and_b32 v63, s66, v109
    v_lshlrev_b32 v84, 16, v110
    v_and_b32 v85, s66, v110
    v_lshlrev_b32 v86, 16, v111
    v_and_b32 v87, s66, v111
    v_lshlrev_b32 v64, 16, v112
    v_and_b32 v65, s66, v112
    v_lshlrev_b32 v66, 16, v113
    v_and_b32 v67, s66, v113
    v_lshlrev_b32 v88, 16, v114
    v_and_b32 v89, s66, v114
    v_lshlrev_b32 v90, 16, v115
    v_and_b32 v91, s66, v115
    v_lshlrev_b32 v68, 16, v116
    v_and_b32 v69, s66, v116
    v_lshlrev_b32 v70, 16, v117
    v_and_b32 v71, s66, v117
    v_lshlrev_b32 v92, 16, v118
    v_and_b32 v93, s66, v118
    v_lshlrev_b32 v94, 16, v119
    v_and_b32 v95, s66, v119
    v_lshlrev_b32 v72, 16, v120
    v_and_b32 v73, s66, v120
    v_lshlrev_b32 v74, 16, v121
    v_and_b32 v75, s66, v121
    v_lshlrev_b32 v96, 16, v122
    v_and_b32 v97, s66, v122
    v_lshlrev_b32 v98, 16, v123
    v_and_b32 v99, s66, v123
    v_lshlrev_b32 v76, 16, v124
    v_and_b32 v77, s66, v124
    v_lshlrev_b32 v78, 16, v125
    v_and_b32 v79, s66, v125
    v_lshlrev_b32 v100, 16, v126
    v_and_b32 v101, s66, v126
    v_lshlrev_b32 v102, 16, v127
    v_and_b32 v103, s66, v127
    v_lshlrev_b32 v80, 16, v128
    v_and_b32 v81, s66, v128
    v_lshlrev_b32 v82, 16, v129
    v_and_b32 v83, s66, v129
    v_lshlrev_b32 v104, 16, v130
    v_and_b32 v105, s66, v130
    v_lshlrev_b32 v106, 16, v131
    v_and_b32 v107, s66, v131
    v_add_u32 v13, s62, v12
    s_add_u32 s62, s62, 24576
    s_cmp_eq_u32 s62, 73728
    s_cselect_b32 s62, 0, s62
    s_barrier
    ds_read_b128 v[36:39], v13 offset:0
    ds_read_b128 v[40:43], v13 offset:256
    ds_read_b128 v[44:47], v13 offset:512
    ds_read_b128 v[48:51], v13 offset:3072
    ds_read_b128 v[52:55], v13 offset:3328
    ds_read_b128 v[56:59], v13 offset:3584
    s_waitcnt lgkmcnt(3)
    v_cvt_f32_i32 v36, v36
    v_cvt_f32_i32 v37, v37
    v_cvt_f32_i32 v38, v38
    v_cvt_f32_i32 v39, v39
    v_cvt_f32_i32 v40, v40
    v_cvt_f32_i32 v41, v41
    v_cvt_f32_i32 v42, v42
    v_cvt_f32_i32 v43, v43
    v_cvt_f32_i32 v44, v44
    v_cvt_f32_i32 v45, v45
    v_cvt_f32_i32 v46, v46
    v_cvt_f32_i32 v47, v47
    v_sub_f32 v36, v36, v60
    v_sub_f32 v37, v37, v61
    v_sub_f32 v38, v38, v62
    v_sub_f32 v39, v39, v63
    v_sub_f32 v40, v40, v64
    v_sub_f32 v41, v41, v65
    v_sub_f32 v42, v42, v66
    v_sub_f32 v43, v43, v67
    v_sub_f32 v44, v44, v68
    v_sub_f32 v45, v45, v69
    v_sub_f32 v46, v46, v70
    v_sub_f32 v47, v47, v71
    v_cvt_pk_bf16_f32 v36, 0, v36
    v_cvt_pk_bf16_f32 v37, 0, v37
    v_cvt_pk_bf16_f32 v38, 0, v38
    v_cvt_pk_bf16_f32 v39, 0, v39
    v_cvt_pk_bf16_f32 v40, 0, v40
    v_cvt_pk_bf16_f32 v41, 0, v41
    v_cvt_pk_bf16_f32 v42, 0, v42
    v_cvt_pk_bf16_f32 v43, 0, v43
    v_cvt_pk_bf16_f32 v44, 0, v44
    v_cvt_pk_bf16_f32 v45, 0, v45
    v_cvt_pk_bf16_f32 v46, 0, v46
    v_cvt_pk_bf16_f32 v47, 0, v47
    v_mul_f32 v36, v36, v84
    v_mul_f32 v37, v37, v85
    v_mul_f32 v38, v38, v86
    v_mul_f32 v39, v39, v87
    v_mul_f32 v40, v40, v88
    v_mul_f32 v41, v41, v89
    v_mul_f32 v42, v42, v90
    v_mul_f32 v43, v43, v91
    v_mul_f32 v44, v44, v92
    v_mul_f32 v45, v45, v93
    v_mul_f32 v46, v46, v94
    v_mul_f32 v47, v47, v95
    v_cvt_pk_bf16_f32 v132, v36, v37
    v_cvt_pk_bf16_f32 v133, v38, v39
    v_cvt_pk_bf16_f32 v134, v40, v41
    v_cvt_pk_bf16_f32 v135, v42, v43
    v_cvt_pk_bf16_f32 v136, v44, v45
    v_cvt_pk_bf16_f32 v137, v46, v47
    v_mfma_f32_16x16x16_bf16 v[144:147], v[132:133], v[156:157], 0
    v_mfma_f32_16x16x16_bf16 v[144:147], v[134:135], v[158:159], v[144:147]
    v_mfma_f32_16x16x16_bf16 v[144:147], v[136:137], v[160:161], v[144:147]
    s_waitcnt lgkmcnt(0)
    v_cvt_f32_i32 v48, v48
    v_cvt_f32_i32 v49, v49
    v_cvt_f32_i32 v50, v50
    v_cvt_f32_i32 v51, v51
    v_cvt_f32_i32 v52, v52
    v_cvt_f32_i32 v53, v53
    v_cvt_f32_i32 v54, v54
    v_cvt_f32_i32 v55, v55
    v_cvt_f32_i32 v56, v56
    v_cvt_f32_i32 v57, v57
    v_cvt_f32_i32 v58, v58
    v_cvt_f32_i32 v59, v59
    v_sub_f32 v48, v48, v72
    v_sub_f32 v49, v49, v73
    v_sub_f32 v50, v50, v74
    v_sub_f32 v51, v51, v75
    v_sub_f32 v52, v52, v76
    v_sub_f32 v53, v53, v77
    v_sub_f32 v54, v54, v78
    v_sub_f32 v55, v55, v79
    v_sub_f32 v56, v56, v80
    v_sub_f32 v57, v57, v81
    v_sub_f32 v58, v58, v82
    v_sub_f32 v59, v59, v83
    v_cvt_pk_bf16_f32 v48, 0, v48
    v_cvt_pk_bf16_f32 v49, 0, v49
    v_cvt_pk_bf16_f32 v50, 0, v50
    v_cvt_pk_bf16_f32 v51, 0, v51
    v_cvt_pk_bf16_f32 v52, 0, v52
    v_cvt_pk_bf16_f32 v53, 0, v53
    v_cvt_pk_bf16_f32 v54, 0, v54
    v_cvt_pk_bf16_f32 v55, 0, v55
    v_cvt_pk_bf16_f32 v56, 0, v56
    v_cvt_pk_bf16_f32 v57, 0, v57
    v_cvt_pk_bf16_f32 v58, 0, v58
    v_cvt_pk_bf16_f32 v59, 0, v59
    v_mul_f32 v48, v48, v96
    v_mul_f32 v49, v49, v97
    v_mul_f32 v50, v50, v98
    v_mul_f32 v51, v51, v99
    v_mul_f32 v52, v52, v100
    v_mul_f32 v53, v53, v101
    v_mul_f32 v54, v54, v102
    v_mul_f32 v55, v55, v103
    v_mul_f32 v56, v56, v104
    v_mul_f32 v57, v57, v105
    v_mul_f32 v58, v58, v106
    v_mul_f32 v59, v59, v107
    v_cvt_pk_bf16_f32 v138, v48, v49
    v_cvt_pk_bf16_f32 v139, v50, v51
    v_add_f32_dpp v3, v146, v145 row_ror:12 row_mask:0xf bank_mask:0xf
    v_cvt_pk_bf16_f32 v140, v52, v53
    v_cvt_pk_bf16_f32 v141, v54, v55
    v_add_f32_dpp v3, v147, v3 row_ror:8 row_mask:0xf bank_mask:0xf
    v_cvt_pk_bf16_f32 v142, v56, v57
    v_cvt_pk_bf16_f32 v143, v58, v59
    v_add_f32_dpp v15, v144, v3 row_ror:4 row_mask:0xf bank_mask:0x2
    v_mfma_f32_16x16x16_bf16 v[148:151], v[138:139], v[156:157], 0
    v_mfma_f32_16x16x16_bf16 v[148:151], v[140:141], v[158:159], v[148:151]
    v_mfma_f32_16x16x16_bf16 v[148:151], v[142:143], v[160:161], v[148:151]
    v_add_u32 v33, s63, v29
    v_add_u32 v34, s63, v30
    ds_read_b64 v[108:109], v33 offset:0
    ds_read_b64 v[110:111], v33 offset:1536
    ds_read_b64 v[112:113], v33 offset:128
    ds_read_b64 v[114:115], v33 offset:1664
    ds_read_b64 v[116:117], v33 offset:256
    ds_read_b64 v[118:119], v33 offset:1792
    ds_read_b64 v[120:121], v34 offset:0
    v_add_f32_dpp v4, v150, v149 row_ror:12 row_mask:0xf bank_mask:0xf
    ds_read_b64 v[122:123], v34 offset:1536
    ds_read_b64 v[124:125], v34 offset:128
    v_add_f32_dpp v4, v151, v4 row_ror:8 row_mask:0xf bank_mask:0xf
    ds_read_b64 v[126:127], v34 offset:1664
    ds_read_b64 v[128:129], v34 offset:256
    ds_read_b64 v[130:131], v34 offset:1792
    v_add_f32_dpp v16, v148, v4 row_ror:4 row_mask:0xf bank_mask:0x2
    s_waitcnt lgkmcnt(0)
    v_lshlrev_b32 v60, 16, v108
    v_and_b32 v61, s66, v108
    v_lshlrev_b32 v62, 16, v109
    v_and_b32 v63, s66, v109
    v_lshlrev_b32 v84, 16, v110
    v_and_b32 v85, s66, v110
    v_lshlrev_b32 v86, 16, v111
    v_and_b32 v87, s66, v111
    v_lshlrev_b32 v64, 16, v112
    v_and_b32 v65, s66, v112
    v_lshlrev_b32 v66, 16, v113
    v_and_b32 v67, s66, v113
    v_lshlrev_b32 v88, 16, v114
    v_and_b32 v89, s66, v114
    v_lshlrev_b32 v90, 16, v115
    v_and_b32 v91, s66, v115
    v_lshlrev_b32 v68, 16, v116
    v_and_b32 v69, s66, v116
    v_lshlrev_b32 v70, 16, v117
    v_and_b32 v71, s66, v117
    v_lshlrev_b32 v92, 16, v118
    v_and_b32 v93, s66, v118
    v_lshlrev_b32 v94, 16, v119
    v_and_b32 v95, s66, v119
    v_lshlrev_b32 v72, 16, v120
    v_and_b32 v73, s66, v120
    v_lshlrev_b32 v74, 16, v121
    v_and_b32 v75, s66, v121
    v_lshlrev_b32 v96, 16, v122
    v_and_b32 v97, s66, v122
    v_lshlrev_b32 v98, 16, v123
    v_and_b32 v99, s66, v123
    v_lshlrev_b32 v76, 16, v124
    v_and_b32 v77, s66, v124
    v_lshlrev_b32 v78, 16, v125
    v_and_b32 v79, s66, v125
    v_lshlrev_b32 v100, 16, v126
    v_and_b32 v101, s66, v126
    v_lshlrev_b32 v102, 16, v127
    v_and_b32 v103, s66, v127
    v_lshlrev_b32 v80, 16, v128
    v_and_b32 v81, s66, v128
    v_lshlrev_b32 v82, 16, v129
    v_and_b32 v83, s66, v129
    v_lshlrev_b32 v104, 16, v130
    v_and_b32 v105, s66, v130
    v_lshlrev_b32 v106, 16, v131
    v_and_b32 v107, s66, v131
    v_add_u32 v13, s62, v12
    s_add_u32 s62, s62, 24576
    s_cmp_eq_u32 s62, 73728
    s_cselect_b32 s62, 0, s62
    s_barrier
    ds_read_b128 v[36:39], v13 offset:0
    ds_read_b128 v[40:43], v13 offset:256
    ds_read_b128 v[44:47], v13 offset:512
    ds_read_b128 v[48:51], v13 offset:3072
    ds_read_b128 v[52:55], v13 offset:3328
    ds_read_b128 v[56:59], v13 offset:3584
    s_waitcnt lgkmcnt(3)
    v_cvt_f32_i32 v36, v36
    v_cvt_f32_i32 v37, v37
    v_cvt_f32_i32 v38, v38
    v_cvt_f32_i32 v39, v39
    v_cvt_f32_i32 v40, v40
    v_cvt_f32_i32 v41, v41
    v_cvt_f32_i32 v42, v42
    v_cvt_f32_i32 v43, v43
    v_cvt_f32_i32 v44, v44
    v_cvt_f32_i32 v45, v45
    v_cvt_f32_i32 v46, v46
    v_cvt_f32_i32 v47, v47
    v_sub_f32 v36, v36, v60
    v_sub_f32 v37, v37, v61
    v_sub_f32 v38, v38, v62
    v_sub_f32 v39, v39, v63
    v_sub_f32 v40, v40, v64
    v_sub_f32 v41, v41, v65
    v_sub_f32 v42, v42, v66
    v_sub_f32 v43, v43, v67
    v_sub_f32 v44, v44, v68
    v_sub_f32 v45, v45, v69
    v_sub_f32 v46, v46, v70
    v_sub_f32 v47, v47, v71
    v_cvt_pk_bf16_f32 v36, 0, v36
    v_cvt_pk_bf16_f32 v37, 0, v37
    v_cvt_pk_bf16_f32 v38, 0, v38
    v_cvt_pk_bf16_f32 v39, 0, v39
    v_cvt_pk_bf16_f32 v40, 0, v40
    v_cvt_pk_bf16_f32 v41, 0, v41
    v_cvt_pk_bf16_f32 v42, 0, v42
    v_cvt_pk_bf16_f32 v43, 0, v43
    v_cvt_pk_bf16_f32 v44, 0, v44
    v_cvt_pk_bf16_f32 v45, 0, v45
    v_cvt_pk_bf16_f32 v46, 0, v46
    v_cvt_pk_bf16_f32 v47, 0, v47
    v_mul_f32 v36, v36, v84
    v_mul_f32 v37, v37, v85
    v_mul_f32 v38, v38, v86
    v_mul_f32 v39, v39, v87
    v_mul_f32 v40, v40, v88
    v_mul_f32 v41, v41, v89
    v_mul_f32 v42, v42, v90
    v_mul_f32 v43, v43, v91
    v_mul_f32 v44, v44, v92
    v_mul_f32 v45, v45, v93
    v_mul_f32 v46, v46, v94
    v_mul_f32 v47, v47, v95
    v_cvt_pk_bf16_f32 v132, v36, v37
    v_cvt_pk_bf16_f32 v133, v38, v39
    v_cvt_pk_bf16_f32 v134, v40, v41
    v_cvt_pk_bf16_f32 v135, v42, v43
    v_cvt_pk_bf16_f32 v136, v44, v45
    v_cvt_pk_bf16_f32 v137, v46, v47
    v_mfma_f32_16x16x16_bf16 v[144:147], v[132:133], v[156:157], 0
    v_mfma_f32_16x16x16_bf16 v[144:147], v[134:135], v[158:159], v[144:147]
    v_mfma_f32_16x16x16_bf16 v[144:147], v[136:137], v[160:161], v[144:147]
    s_waitcnt lgkmcnt(0)
    v_cvt_f32_i32 v48, v48
    v_cvt_f32_i32 v49, v49
    v_cvt_f32_i32 v50, v50
    v_cvt_f32_i32 v51, v51
    v_cvt_f32_i32 v52, v52
    v_cvt_f32_i32 v53, v53
    v_cvt_f32_i32 v54, v54
    v_cvt_f32_i32 v55, v55
    v_cvt_f32_i32 v56, v56
    v_cvt_f32_i32 v57, v57
    v_cvt_f32_i32 v58, v58
    v_cvt_f32_i32 v59, v59
    v_sub_f32 v48, v48, v72
    v_sub_f32 v49, v49, v73
    v_sub_f32 v50, v50, v74
    v_sub_f32 v51, v51, v75
    v_sub_f32 v52, v52, v76
    v_sub_f32 v53, v53, v77
    v_sub_f32 v54, v54, v78
    v_sub_f32 v55, v55, v79
    v_sub_f32 v56, v56, v80
    v_sub_f32 v57, v57, v81
    v_sub_f32 v58, v58, v82
    v_sub_f32 v59, v59, v83
    v_cvt_pk_bf16_f32 v48, 0, v48
    v_cvt_pk_bf16_f32 v49, 0, v49
    v_cvt_pk_bf16_f32 v50, 0, v50
    v_cvt_pk_bf16_f32 v51, 0, v51
    v_cvt_pk_bf16_f32 v52, 0, v52
    v_cvt_pk_bf16_f32 v53, 0, v53
    v_cvt_pk_bf16_f32 v54, 0, v54
    v_cvt_pk_bf16_f32 v55, 0, v55
    v_cvt_pk_bf16_f32 v56, 0, v56
    v_cvt_pk_bf16_f32 v57, 0, v57
    v_cvt_pk_bf16_f32 v58, 0, v58
    v_cvt_pk_bf16_f32 v59, 0, v59
    v_mul_f32 v48, v48, v96
    v_mul_f32 v49, v49, v97
    v_mul_f32 v50, v50, v98
    v_mul_f32 v51, v51, v99
    v_mul_f32 v52, v52, v100
    v_mul_f32 v53, v53, v101
    v_mul_f32 v54, v54, v102
    v_mul_f32 v55, v55, v103
    v_mul_f32 v56, v56, v104
    v_mul_f32 v57, v57, v105
    v_mul_f32 v58, v58, v106
    v_mul_f32 v59, v59, v107
    v_cvt_pk_bf16_f32 v138, v48, v49
    v_cvt_pk_bf16_f32 v139, v50, v51
    v_add_f32_dpp v3, v147, v146 row_ror:12 row_mask:0xf bank_mask:0xf
    v_cvt_pk_bf16_f32 v140, v52, v53
    v_cvt_pk_bf16_f32 v141, v54, v55
    v_add_f32_dpp v3, v144, v3 row_ror:8 row_mask:0xf bank_mask:0xf
    v_cvt_pk_bf16_f32 v142, v56, v57
    v_cvt_pk_bf16_f32 v143, v58, v59
    v_add_f32_dpp v15, v145, v3 row_ror:4 row_mask:0xf bank_mask:0x4
    v_mfma_f32_16x16x16_bf16 v[148:151], v[138:139], v[156:157], 0
    v_mfma_f32_16x16x16_bf16 v[148:151], v[140:141], v[158:159], v[148:151]
    v_mfma_f32_16x16x16_bf16 v[148:151], v[142:143], v[160:161], v[148:151]
    v_add_u32 v33, s63, v31
    v_add_u32 v34, s63, v32
    ds_read_b64 v[108:109], v33 offset:0
    ds_read_b64 v[110:111], v33 offset:1536
    ds_read_b64 v[112:113], v33 offset:128
    ds_read_b64 v[114:115], v33 offset:1664
    ds_read_b64 v[116:117], v33 offset:256
    ds_read_b64 v[118:119], v33 offset:1792
    ds_read_b64 v[120:121], v34 offset:0
    v_add_f32_dpp v4, v151, v150 row_ror:12 row_mask:0xf bank_mask:0xf
    ds_read_b64 v[122:123], v34 offset:1536
    ds_read_b64 v[124:125], v34 offset:128
    v_add_f32_dpp v4, v148, v4 row_ror:8 row_mask:0xf bank_mask:0xf
    ds_read_b64 v[126:127], v34 offset:1664
    ds_read_b64 v[128:129], v34 offset:256
    ds_read_b64 v[130:131], v34 offset:1792
    v_add_f32_dpp v16, v149, v4 row_ror:4 row_mask:0xf bank_mask:0x4
    s_waitcnt lgkmcnt(0)
    v_lshlrev_b32 v60, 16, v108
    v_and_b32 v61, s66, v108
    v_lshlrev_b32 v62, 16, v109
    v_and_b32 v63, s66, v109
    v_lshlrev_b32 v84, 16, v110
    v_and_b32 v85, s66, v110
    v_lshlrev_b32 v86, 16, v111
    v_and_b32 v87, s66, v111
    v_lshlrev_b32 v64, 16, v112
    v_and_b32 v65, s66, v112
    v_lshlrev_b32 v66, 16, v113
    v_and_b32 v67, s66, v113
    v_lshlrev_b32 v88, 16, v114
    v_and_b32 v89, s66, v114
    v_lshlrev_b32 v90, 16, v115
    v_and_b32 v91, s66, v115
    v_lshlrev_b32 v68, 16, v116
    v_and_b32 v69, s66, v116
    v_lshlrev_b32 v70, 16, v117
    v_and_b32 v71, s66, v117
    v_lshlrev_b32 v92, 16, v118
    v_and_b32 v93, s66, v118
    v_lshlrev_b32 v94, 16, v119
    v_and_b32 v95, s66, v119
    v_lshlrev_b32 v72, 16, v120
    v_and_b32 v73, s66, v120
    v_lshlrev_b32 v74, 16, v121
    v_and_b32 v75, s66, v121
    v_lshlrev_b32 v96, 16, v122
    v_and_b32 v97, s66, v122
    v_lshlrev_b32 v98, 16, v123
    v_and_b32 v99, s66, v123
    v_lshlrev_b32 v76, 16, v124
    v_and_b32 v77, s66, v124
    v_lshlrev_b32 v78, 16, v125
    v_and_b32 v79, s66, v125
    v_lshlrev_b32 v100, 16, v126
    v_and_b32 v101, s66, v126
    v_lshlrev_b32 v102, 16, v127
    v_and_b32 v103, s66, v127
    v_lshlrev_b32 v80, 16, v128
    v_and_b32 v81, s66, v128
    v_lshlrev_b32 v82, 16, v129
    v_and_b32 v83, s66, v129
    v_lshlrev_b32 v104, 16, v130
    v_and_b32 v105, s66, v130
    v_lshlrev_b32 v106, 16, v131
    v_and_b32 v107, s66, v131
    v_add_u32 v13, s62, v12
    s_add_u32 s62, s62, 24576
    s_cmp_eq_u32 s62, 73728
    s_cselect_b32 s62, 0, s62
    s_barrier
    ds_read_b128 v[36:39], v13 offset:0
    ds_read_b128 v[40:43], v13 offset:256
    ds_read_b128 v[44:47], v13 offset:512
    ds_read_b128 v[48:51], v13 offset:3072
    ds_read_b128 v[52:55], v13 offset:3328
    ds_read_b128 v[56:59], v13 offset:3584
    s_waitcnt lgkmcnt(3)
    v_cvt_f32_i32 v36, v36
    v_cvt_f32_i32 v37, v37
    v_cvt_f32_i32 v38, v38
    v_cvt_f32_i32 v39, v39
    v_cvt_f32_i32 v40, v40
    v_cvt_f32_i32 v41, v41
    v_cvt_f32_i32 v42, v42
    v_cvt_f32_i32 v43, v43
    v_cvt_f32_i32 v44, v44
    v_cvt_f32_i32 v45, v45
    v_cvt_f32_i32 v46, v46
    v_cvt_f32_i32 v47, v47
    v_sub_f32 v36, v36, v60
    v_sub_f32 v37, v37, v61
    v_sub_f32 v38, v38, v62
    v_sub_f32 v39, v39, v63
    v_sub_f32 v40, v40, v64
    v_sub_f32 v41, v41, v65
    v_sub_f32 v42, v42, v66
    v_sub_f32 v43, v43, v67
    v_sub_f32 v44, v44, v68
    v_sub_f32 v45, v45, v69
    v_sub_f32 v46, v46, v70
    v_sub_f32 v47, v47, v71
    v_cvt_pk_bf16_f32 v36, 0, v36
    v_cvt_pk_bf16_f32 v37, 0, v37
    v_cvt_pk_bf16_f32 v38, 0, v38
    v_cvt_pk_bf16_f32 v39, 0, v39
    v_cvt_pk_bf16_f32 v40, 0, v40
    v_cvt_pk_bf16_f32 v41, 0, v41
    v_cvt_pk_bf16_f32 v42, 0, v42
    v_cvt_pk_bf16_f32 v43, 0, v43
    v_cvt_pk_bf16_f32 v44, 0, v44
    v_cvt_pk_bf16_f32 v45, 0, v45
    v_cvt_pk_bf16_f32 v46, 0, v46
    v_cvt_pk_bf16_f32 v47, 0, v47
    v_mul_f32 v36, v36, v84
    v_mul_f32 v37, v37, v85
    v_mul_f32 v38, v38, v86
    v_mul_f32 v39, v39, v87
    v_mul_f32 v40, v40, v88
    v_mul_f32 v41, v41, v89
    v_mul_f32 v42, v42, v90
    v_mul_f32 v43, v43, v91
    v_mul_f32 v44, v44, v92
    v_mul_f32 v45, v45, v93
    v_mul_f32 v46, v46, v94
    v_mul_f32 v47, v47, v95
    v_cvt_pk_bf16_f32 v132, v36, v37
    v_cvt_pk_bf16_f32 v133, v38, v39
    v_cvt_pk_bf16_f32 v134, v40, v41
    v_cvt_pk_bf16_f32 v135, v42, v43
    v_cvt_pk_bf16_f32 v136, v44, v45
    v_cvt_pk_bf16_f32 v137, v46, v47
    v_mfma_f32_16x16x16_bf16 v[144:147], v[132:133], v[156:157], 0
    v_mfma_f32_16x16x16_bf16 v[144:147], v[134:135], v[158:159], v[144:147]
    v_mfma_f32_16x16x16_bf16 v[144:147], v[136:137], v[160:161], v[144:147]
    s_waitcnt lgkmcnt(0)
    v_cvt_f32_i32 v48, v48
    v_cvt_f32_i32 v49, v49
    v_cvt_f32_i32 v50, v50
    v_cvt_f32_i32 v51, v51
    v_cvt_f32_i32 v52, v52
    v_cvt_f32_i32 v53, v53
    v_cvt_f32_i32 v54, v54
    v_cvt_f32_i32 v55, v55
    v_cvt_f32_i32 v56, v56
    v_cvt_f32_i32 v57, v57
    v_cvt_f32_i32 v58, v58
    v_cvt_f32_i32 v59, v59
    v_sub_f32 v48, v48, v72
    v_sub_f32 v49, v49, v73
    v_sub_f32 v50, v50, v74
    v_sub_f32 v51, v51, v75
    v_sub_f32 v52, v52, v76
    v_sub_f32 v53, v53, v77
    v_sub_f32 v54, v54, v78
    v_sub_f32 v55, v55, v79
    v_sub_f32 v56, v56, v80
    v_sub_f32 v57, v57, v81
    v_sub_f32 v58, v58, v82
    v_sub_f32 v59, v59, v83
    v_cvt_pk_bf16_f32 v48, 0, v48
    v_cvt_pk_bf16_f32 v49, 0, v49
    v_cvt_pk_bf16_f32 v50, 0, v50
    v_cvt_pk_bf16_f32 v51, 0, v51
    v_cvt_pk_bf16_f32 v52, 0, v52
    v_cvt_pk_bf16_f32 v53, 0, v53
    v_cvt_pk_bf16_f32 v54, 0, v54
    v_cvt_pk_bf16_f32 v55, 0, v55
    v_cvt_pk_bf16_f32 v56, 0, v56
    v_cvt_pk_bf16_f32 v57, 0, v57
    v_cvt_pk_bf16_f32 v58, 0, v58
    v_cvt_pk_bf16_f32 v59, 0, v59
    v_mul_f32 v48, v48, v96
    v_mul_f32 v49, v49, v97
    v_mul_f32 v50, v50, v98
    v_mul_f32 v51, v51, v99
    v_mul_f32 v52, v52, v100
    v_mul_f32 v53, v53, v101
    v_mul_f32 v54, v54, v102
    v_mul_f32 v55, v55, v103
    v_mul_f32 v56, v56, v104
    v_mul_f32 v57, v57, v105
    v_mul_f32 v58, v58, v106
    v_mul_f32 v59, v59, v107
    v_cvt_pk_bf16_f32 v138, v48, v49
    v_cvt_pk_bf16_f32 v139, v50, v51
    v_add_f32_dpp v3, v144, v147 row_ror:12 row_mask:0xf bank_mask:0xf
    v_cvt_pk_bf16_f32 v140, v52, v53
    v_cvt_pk_bf16_f32 v141, v54, v55
    v_add_f32_dpp v3, v145, v3 row_ror:8 row_mask:0xf bank_mask:0xf
    v_cvt_pk_bf16_f32 v142, v56, v57
    v_cvt_pk_bf16_f32 v143, v58, v59
    v_add_f32_dpp v15, v146, v3 row_ror:4 row_mask:0xf bank_mask:0x8
    v_mfma_f32_16x16x16_bf16 v[148:151], v[138:139], v[156:157], 0
    v_mfma_f32_16x16x16_bf16 v[148:151], v[140:141], v[158:159], v[148:151]
    v_mfma_f32_16x16x16_bf16 v[148:151], v[142:143], v[160:161], v[148:151]
    s_add_u32 s63, s63, 3072
    v_add_u32 v33, s63, v17
    v_add_u32 v34, s63, v18
    ds_read_b64 v[108:109], v33 offset:0
    ds_read_b64 v[110:111], v33 offset:1536
    ds_read_b64 v[112:113], v33 offset:128
    ds_read_b64 v[114:115], v33 offset:1664
    ds_read_b64 v[116:117], v33 offset:256
    ds_read_b64 v[118:119], v33 offset:1792
    ds_read_b64 v[120:121], v34 offset:0
    v_add_f32_dpp v4, v148, v151 row_ror:12 row_mask:0xf bank_mask:0xf
    ds_read_b64 v[122:123], v34 offset:1536
    ds_read_b64 v[124:125], v34 offset:128
    v_add_f32_dpp v4, v149, v4 row_ror:8 row_mask:0xf bank_mask:0xf
    ds_read_b64 v[126:127], v34 offset:1664
    ds_read_b64 v[128:129], v34 offset:256
    ds_read_b64 v[130:131], v34 offset:1792
    v_add_f32_dpp v16, v150, v4 row_ror:4 row_mask:0xf bank_mask:0x8
    v_cvt_pk_bf16_f32 v3, 0, v15
    v_cvt_pk_bf16_f32 v4, 0, v16
    v_mul_f32 v3, s65, v3
    v_mul_f32 v4, s65, v4
    v_cvt_pk_bf16_f32 v5, v3, v4
    v_max3_f32 v14, v14, v3, v4
    ds_write_b32 v11, v5 offset:256
    s_waitcnt lgkmcnt(0)
    v_lshlrev_b32 v60, 16, v108
    v_and_b32 v61, s66, v108
    v_lshlrev_b32 v62, 16, v109
    v_and_b32 v63, s66, v109
    v_lshlrev_b32 v84, 16, v110
    v_and_b32 v85, s66, v110
    v_lshlrev_b32 v86, 16, v111
    v_and_b32 v87, s66, v111
    v_lshlrev_b32 v64, 16, v112
    v_and_b32 v65, s66, v112
    v_lshlrev_b32 v66, 16, v113
    v_and_b32 v67, s66, v113
    v_lshlrev_b32 v88, 16, v114
    v_and_b32 v89, s66, v114
    v_lshlrev_b32 v90, 16, v115
    v_and_b32 v91, s66, v115
    v_lshlrev_b32 v68, 16, v116
    v_and_b32 v69, s66, v116
    v_lshlrev_b32 v70, 16, v117
    v_and_b32 v71, s66, v117
    v_lshlrev_b32 v92, 16, v118
    v_and_b32 v93, s66, v118
    v_lshlrev_b32 v94, 16, v119
    v_and_b32 v95, s66, v119
    v_lshlrev_b32 v72, 16, v120
    v_and_b32 v73, s66, v120
    v_lshlrev_b32 v74, 16, v121
    v_and_b32 v75, s66, v121
    v_lshlrev_b32 v96, 16, v122
    v_and_b32 v97, s66, v122
    v_lshlrev_b32 v98, 16, v123
    v_and_b32 v99, s66, v123
    v_lshlrev_b32 v76, 16, v124
    v_and_b32 v77, s66, v124
    v_lshlrev_b32 v78, 16, v125
    v_and_b32 v79, s66, v125
    v_lshlrev_b32 v100, 16, v126
    v_and_b32 v101, s66, v126
    v_lshlrev_b32 v102, 16, v127
    v_and_b32 v103, s66, v127
    v_lshlrev_b32 v80, 16, v128
    v_and_b32 v81, s66, v128
    v_lshlrev_b32 v82, 16, v129
    v_and_b32 v83, s66, v129
    v_lshlrev_b32 v104, 16, v130
    v_and_b32 v105, s66, v130
    v_lshlrev_b32 v106, 16, v131
    v_and_b32 v107, s66, v131
    v_add_u32 v11, 3072, v11
    s_add_u32 s61, s61, 1
    s_cmp_eq_u32 s61, s3
    s_cbranch_scc1 L_kblk_end
    s_cmp_eq_u32 s61, s73
    s_cbranch_scc1 L_kblk_end
    s_cmp_lt_u32 s61, 16
    s_cbranch_scc1 L_kblk
L_kblk_end:
    s_cmp_eq_u32 s74, 0
    s_cselect_b64 vcc, -1, 0
    v_cndmask_b32 v153, v153, v14, vcc
    s_cmp_eq_u32 s74, 1
    s_cselect_b64 vcc, -1, 0
    v_cndmask_b32 v154, v154, v14, vcc
    s_cmp_eq_u32 s74, 2
    s_cselect_b64 vcc, -1, 0
    v_cndmask_b32 v155, v155, v14, vcc
    s_add_u32 s74, s74, 1
    v_mov_b32 v156, v162
    v_mov_b32 v157, v163
    v_mov_b32 v158, v164
    v_mov_b32 v159, v165
    v_mov_b32 v160, v166
    v_mov_b32 v161, v167
    v_mov_b32 v162, v168
    v_mov_b32 v163, v169
    v_mov_b32 v164, v170
    v_mov_b32 v165, v171
    v_mov_b32 v166, v172
    v_mov_b32 v167, v173
    v_mov_b32 v14, 0xff800000
    s_cmp_lt_u32 s61, 16
    s_cbranch_scc1 L_kblk
    v_lshrrev_b32 v3, 4, v1
    v_and_b32 v4, 15, v1
    v_lshl_add_u32 v3, v2, 3, v3
    v_mul_u32_u24 v3, 768, v3
    v_lshl_add_u32 v12, v4, 4, v3
    v_subrev_u32 v11, 49152, v11
    s_mov_b32 s63, 0
    v_add_u32 v211, s63, v7
    v_add_u32 v212, s63, v8
    ds_read_b32 v210, v11 offset:0
    ds_read_u16 v213, v211 offset:512
    ds_read_u16 v214, v212 offset:512
    ds_read_u16 v211, v211
    ds_read_u16 v212, v212
    v_mov_b32 v204, 0
    v_mov_b32 v205, 0
    v_mov_b32 v206, 0
    v_mov_b32 v207, 0
    s_mov_b32 s61, 0
L_vround:
    v_mov_b32 v14, v153
    v_mov_b32 v153, v154
    v_mov_b32 v154, v155
    v_mov_b32 v156, 0
    v_mov_b32 v157, 0
    v_mov_b32 v158, 0
    v_mov_b32 v159, 0
    v_mov_b32 v160, 0
    v_mov_b32 v161, 0
    v_mov_b32 v162, 0
    v_mov_b32 v163, 0
    v_mov_b32 v164, 0
    v_mov_b32 v165, 0
    v_mov_b32 v166, 0
    v_mov_b32 v167, 0
    v_mov_b32 v168, 0
    v_mov_b32 v169, 0
    v_mov_b32 v170, 0
    v_mov_b32 v171, 0
    v_mov_b32 v172, 0
    v_mov_b32 v173, 0
    v_mov_b32 v174, 0
    v_mov_b32 v175, 0
    v_mov_b32 v176, 0
    v_mov_b32 v177, 0
    v_mov_b32 v178, 0
    v_mov_b32 v179, 0
    v_mov_b32 v180, 0
    v_mov_b32 v181, 0
    v_mov_b32 v182, 0
    v_mov_b32 v183, 0
    v_mov_b32 v184, 0
    v_mov_b32 v185, 0
    v_mov_b32 v186, 0
    v_mov_b32 v187, 0
    v_mov_b32 v188, 0
    v_mov_b32 v189, 0
    v_mov_b32 v190, 0
    v_mov_b32 v191, 0
    v_mov_b32 v192, 0
    v_mov_b32 v193, 0
    v_mov_b32 v194, 0
    v_mov_b32 v195, 0
    v_mov_b32 v196, 0
    v_mov_b32 v197, 0
    v_mov_b32 v198, 0
    v_mov_b32 v199, 0
    v_mov_b32 v200, 0
    v_mov_b32 v201, 0
    v_mov_b32 v202, 0
    v_mov_b32 v203, 0
    v_mov_b32 v208, 0
    v_mov_b32 v209, 0
    s_nop 1
    v_max_f32_dpp v14, v14, v14 row_ror:4 row_mask:0xf bank_mask:0xf
    s_nop 1
    v_max_f32_dpp v14, v14, v14 row_ror:8 row_mask:0xf bank_mask:0xf
    v_mov_b32 v3, v14
    s_nop 1
    v_permlane16_swap_b32 v14, v3
    v_max_f32 v14, v14, v3
    v_mov_b32 v3, v14
    s_nop 1
    v_permlane32_swap_b32 v14, v3
    v_max_f32 v14, v14, v3
    v_cvt_pk_bf16_f32 v14, 0, v14
    v_mul_f32 v14, s64, v14
L_vblk:
    v_add_u32 v13, s62, v12
    s_add_u32 s62, s62, 24576
    s_cmp_eq_u32 s62, 73728
    s_cselect_b32 s62, 0, s62
    s_barrier
    ds_read_b128 v[36:39], v13 offset:0
    ds_read_b128 v[40:43], v13 offset:256
    ds_read_b128 v[44:47], v13 offset:512
    ds_read_b128 v[48:51], v13 offset:3072
    ds_read_b128 v[52:55], v13 offset:3328
    ds_read_b128 v[56:59], v13 offset:3584
    s_waitcnt lgkmcnt(6)
    v_lshlrev_b32 v215, 16, v210
    v_and_b32 v216, s66, v210
    v_fma_f32 v215, v215, s64, -v14
    v_fma_f32 v216, v216, s64, -v14
    v_exp_f32 v215, v215
    v_exp_f32 v216, v216
    v_lshlrev_b32 v217, 16, v211
    v_lshlrev_b32 v218, 16, v212
    v_mul_f32 v217, v215, v217
    v_mul_f32 v218, v216, v218
    v_add_f32 v208, v208, v215
    v_cvt_pk_bf16_f32 v217, v217, v218
    v_add_f32 v208, v208, v216
    v_lshlrev_b32 v219, 16, v213
    v_lshlrev_b32 v220, 16, v214
    v_lshlrev_b32 v215, 16, v217
    v_and_b32 v216, s66, v217
    v_fmac_f32 v209, v215, v219
    v_fmac_f32 v209, v216, v220
    v_mov_b32_dpp v204, v217 quad_perm:[0,1,2,3] row_mask:0xf bank_mask:0x1
    v_mov_b32_dpp v205, v217 quad_perm:[0,1,2,3] row_mask:0xf bank_mask:0x2
    v_mov_b32_dpp v206, v217 quad_perm:[0,1,2,3] row_mask:0xf bank_mask:0x4
    v_mov_b32_dpp v207, v217 quad_perm:[0,1,2,3] row_mask:0xf bank_mask:0x8
    s_waitcnt lgkmcnt(3)
    v_cvt_f32_i32 v36, v36
    v_cvt_f32_i32 v37, v37
    v_cvt_f32_i32 v38, v38
    v_cvt_f32_i32 v39, v39
    v_cvt_f32_i32 v40, v40
    v_cvt_f32_i32 v41, v41
    v_cvt_f32_i32 v42, v42
    v_cvt_f32_i32 v43, v43
    v_cvt_f32_i32 v44, v44
    v_cvt_f32_i32 v45, v45
    v_cvt_f32_i32 v46, v46
    v_cvt_f32_i32 v47, v47
    s_waitcnt lgkmcnt(0)
    v_cvt_f32_i32 v48, v48
    v_cvt_f32_i32 v49, v49
    v_cvt_f32_i32 v50, v50
    v_cvt_f32_i32 v51, v51
    v_cvt_f32_i32 v52, v52
    v_cvt_f32_i32 v53, v53
    v_cvt_f32_i32 v54, v54
    v_cvt_f32_i32 v55, v55
    v_cvt_f32_i32 v56, v56
    v_cvt_f32_i32 v57, v57
    v_cvt_f32_i32 v58, v58
    v_cvt_f32_i32 v59, v59
    v_cvt_pk_bf16_f32 v60, v36, v48
    v_cvt_pk_bf16_f32 v64, v37, v49
    v_cvt_pk_bf16_f32 v68, v38, v50
    v_cvt_pk_bf16_f32 v72, v39, v51
    v_cvt_pk_bf16_f32 v76, v40, v52
    v_cvt_pk_bf16_f32 v80, v41, v53
    v_cvt_pk_bf16_f32 v84, v42, v54
    v_cvt_pk_bf16_f32 v88, v43, v55
    v_cvt_pk_bf16_f32 v92, v44, v56
    v_cvt_pk_bf16_f32 v96, v45, v57
    v_cvt_pk_bf16_f32 v100, v46, v58
    v_cvt_pk_bf16_f32 v104, v47, v59
    v_add_u32 v211, s63, v9
    v_add_u32 v212, s63, v10
    ds_read_b32 v210, v11 offset:256
    ds_read_u16 v213, v211 offset:512
    ds_read_u16 v214, v212 offset:512
    ds_read_u16 v211, v211
    ds_read_u16 v212, v212
    v_add_u32 v13, s62, v12
    s_add_u32 s62, s62, 24576
    s_cmp_eq_u32 s62, 73728
    s_cselect_b32 s62, 0, s62
    s_barrier
    ds_read_b128 v[36:39], v13 offset:0
    ds_read_b128 v[40:43], v13 offset:256
    ds_read_b128 v[44:47], v13 offset:512
    ds_read_b128 v[48:51], v13 offset:3072
    ds_read_b128 v[52:55], v13 offset:3328
    ds_read_b128 v[56:59], v13 offset:3584
    s_waitcnt lgkmcnt(3)
    v_cvt_f32_i32 v36, v36
    v_cvt_f32_i32 v37, v37
    v_cvt_f32_i32 v38, v38
    v_cvt_f32_i32 v39, v39
    v_cvt_f32_i32 v40, v40
    v_cvt_f32_i32 v41, v41
    v_cvt_f32_i32 v42, v42
    v_cvt_f32_i32 v43, v43
    v_cvt_f32_i32 v44, v44
    v_cvt_f32_i32 v45, v45
    v_cvt_f32_i32 v46, v46
    v_cvt_f32_i32 v47, v47
    s_waitcnt lgkmcnt(0)
    v_cvt_f32_i32 v48, v48
    v_cvt_f32_i32 v49, v49
    v_cvt_f32_i32 v50, v50
    v_cvt_f32_i32 v51, v51
    v_cvt_f32_i32 v52, v52
    v_cvt_f32_i32 v53, v53
    v_cvt_f32_i32 v54, v54
    v_cvt_f32_i32 v55, v55
    v_cvt_f32_i32 v56, v56
    v_cvt_f32_i32 v57, v57
    v_cvt_f32_i32 v58, v58
    v_cvt_f32_i32 v59, v59
    v_cvt_pk_bf16_f32 v61, v36, v48
    v_cvt_pk_bf16_f32 v65, v37, v49
    v_cvt_pk_bf16_f32 v69, v38, v50
    v_cvt_pk_bf16_f32 v73, v39, v51
    v_cvt_pk_bf16_f32 v77, v40, v52
    v_cvt_pk_bf16_f32 v81, v41, v53
    v_cvt_pk_bf16_f32 v85, v42, v54
    v_cvt_pk_bf16_f32 v89, v43, v55
    v_cvt_pk_bf16_f32 v93, v44, v56
    v_cvt_pk_bf16_f32 v97, v45, v57
    v_cvt_pk_bf16_f32 v101, v46, v58
    v_cvt_pk_bf16_f32 v105, v47, v59
    v_add_u32 v13, s62, v12
    s_add_u32 s62, s62, 24576
    s_cmp_eq_u32 s62, 73728
    s_cselect_b32 s62, 0, s62
    s_barrier
    ds_read_b128 v[36:39], v13 offset:0
    ds_read_b128 v[40:43], v13 offset:256
    ds_read_b128 v[44:47], v13 offset:512
    ds_read_b128 v[48:51], v13 offset:3072
    ds_read_b128 v[52:55], v13 offset:3328
    ds_read_b128 v[56:59], v13 offset:3584
    s_waitcnt lgkmcnt(3)
    v_cvt_f32_i32 v36, v36
    v_cvt_f32_i32 v37, v37
    v_cvt_f32_i32 v38, v38
    v_cvt_f32_i32 v39, v39
    v_cvt_f32_i32 v40, v40
    v_cvt_f32_i32 v41, v41
    v_cvt_f32_i32 v42, v42
    v_cvt_f32_i32 v43, v43
    v_cvt_f32_i32 v44, v44
    v_cvt_f32_i32 v45, v45
    v_cvt_f32_i32 v46, v46
    v_cvt_f32_i32 v47, v47
    s_waitcnt lgkmcnt(0)
    v_cvt_f32_i32 v48, v48
    v_cvt_f32_i32 v49, v49
    v_cvt_f32_i32 v50, v50
    v_cvt_f32_i32 v51, v51
    v_cvt_f32_i32 v52, v52
    v_cvt_f32_i32 v53, v53
    v_cvt_f32_i32 v54, v54
    v_cvt_f32_i32 v55, v55
    v_cvt_f32_i32 v56, v56
    v_cvt_f32_i32 v57, v57
    v_cvt_f32_i32 v58, v58
    v_cvt_f32_i32 v59, v59
    v_cvt_pk_bf16_f32 v62, v36, v48
    v_cvt_pk_bf16_f32 v66, v37, v49
    v_cvt_pk_bf16_f32 v70, v38, v50
    v_cvt_pk_bf16_f32 v74, v39, v51
    v_cvt_pk_bf16_f32 v78, v40, v52
    v_cvt_pk_bf16_f32 v82, v41, v53
    v_cvt_pk_bf16_f32 v86, v42, v54
    v_cvt_pk_bf16_f32 v90, v43, v55
    v_cvt_pk_bf16_f32 v94, v44, v56
    v_cvt_pk_bf16_f32 v98, v45, v57
    v_cvt_pk_bf16_f32 v102, v46, v58
    v_cvt_pk_bf16_f32 v106, v47, v59
    v_add_u32 v13, s62, v12
    s_add_u32 s62, s62, 24576
    s_cmp_eq_u32 s62, 73728
    s_cselect_b32 s62, 0, s62
    s_barrier
    ds_read_b128 v[36:39], v13 offset:0
    ds_read_b128 v[40:43], v13 offset:256
    ds_read_b128 v[44:47], v13 offset:512
    ds_read_b128 v[48:51], v13 offset:3072
    ds_read_b128 v[52:55], v13 offset:3328
    ds_read_b128 v[56:59], v13 offset:3584
    s_waitcnt lgkmcnt(3)
    v_cvt_f32_i32 v36, v36
    v_cvt_f32_i32 v37, v37
    v_cvt_f32_i32 v38, v38
    v_cvt_f32_i32 v39, v39
    v_cvt_f32_i32 v40, v40
    v_cvt_f32_i32 v41, v41
    v_cvt_f32_i32 v42, v42
    v_cvt_f32_i32 v43, v43
    v_cvt_f32_i32 v44, v44
    v_cvt_f32_i32 v45, v45
    v_cvt_f32_i32 v46, v46
    v_cvt_f32_i32 v47, v47
    s_waitcnt lgkmcnt(0)
    v_cvt_f32_i32 v48, v48
    v_cvt_f32_i32 v49, v49
    v_cvt_f32_i32 v50, v50
    v_cvt_f32_i32 v51, v51
    v_cvt_f32_i32 v52, v52
    v_cvt_f32_i32 v53, v53
    v_cvt_f32_i32 v54, v54
    v_cvt_f32_i32 v55, v55
    v_cvt_f32_i32 v56, v56
    v_cvt_f32_i32 v57, v57
    v_cvt_f32_i32 v58, v58
    v_cvt_f32_i32 v59, v59
    v_cvt_pk_bf16_f32 v63, v36, v48
    v_cvt_pk_bf16_f32 v67, v37, v49
    v_cvt_pk_bf16_f32 v71, v38, v50
    v_cvt_pk_bf16_f32 v75, v39, v51
    v_cvt_pk_bf16_f32 v79, v40, v52
    v_cvt_pk_bf16_f32 v83, v41, v53
    v_cvt_pk_bf16_f32 v87, v42, v54
    v_cvt_pk_bf16_f32 v91, v43, v55
    v_cvt_pk_bf16_f32 v95, v44, v56
    v_cvt_pk_bf16_f32 v99, v45, v57
    v_cvt_pk_bf16_f32 v103, v46, v58
    v_cvt_pk_bf16_f32 v107, v47, v59
    v_mfma_f32_16x16x32_bf16 v[156:159], v[204:207], v[60:63], v[156:159]
    v_mfma_f32_16x16x32_bf16 v[160:163], v[204:207], v[64:67], v[160:163]
    v_mfma_f32_16x16x32_bf16 v[164:167], v[204:207], v[68:71], v[164:167]
    v_mfma_f32_16x16x32_bf16 v[168:171], v[204:207], v[72:75], v[168:171]
    v_mfma_f32_16x16x32_bf16 v[172:175], v[204:207], v[76:79], v[172:175]
    v_mfma_f32_16x16x32_bf16 v[176:179], v[204:207], v[80:83], v[176:179]
    v_mfma_f32_16x16x32_bf16 v[180:183], v[204:207], v[84:87], v[180:183]
    v_mfma_f32_16x16x32_bf16 v[184:187], v[204:207], v[88:91], v[184:187]
    v_mfma_f32_16x16x32_bf16 v[188:191], v[204:207], v[92:95], v[188:191]
    v_mfma_f32_16x16x32_bf16 v[192:195], v[204:207], v[96:99], v[192:195]
    v_mfma_f32_16x16x32_bf16 v[196:199], v[204:207], v[100:103], v[196:199]
    v_mfma_f32_16x16x32_bf16 v[200:203], v[204:207], v[104:107], v[200:203]
    v_add_u32 v13, s62, v12
    s_add_u32 s62, s62, 24576
    s_cmp_eq_u32 s62, 73728
    s_cselect_b32 s62, 0, s62
    s_barrier
    ds_read_b128 v[36:39], v13 offset:0
    ds_read_b128 v[40:43], v13 offset:256
    ds_read_b128 v[44:47], v13 offset:512
    ds_read_b128 v[48:51], v13 offset:3072
    ds_read_b128 v[52:55], v13 offset:3328
    ds_read_b128 v[56:59], v13 offset:3584
    s_waitcnt lgkmcnt(6)
    v_lshlrev_b32 v215, 16, v210
    v_and_b32 v216, s66, v210
    v_fma_f32 v215, v215, s64, -v14
    v_fma_f32 v216, v216, s64, -v14
    v_exp_f32 v215, v215
    v_exp_f32 v216, v216
    v_lshlrev_b32 v217, 16, v211
    v_lshlrev_b32 v218, 16, v212
    v_mul_f32 v217, v215, v217
    v_mul_f32 v218, v216, v218
    v_add_f32 v208, v208, v215
    v_cvt_pk_bf16_f32 v217, v217, v218
    v_add_f32 v208, v208, v216
    v_lshlrev_b32 v219, 16, v213
    v_lshlrev_b32 v220, 16, v214
    v_lshlrev_b32 v215, 16, v217
    v_and_b32 v216, s66, v217
    v_fmac_f32 v209, v215, v219
    v_fmac_f32 v209, v216, v220
    v_mov_b32_dpp v204, v217 quad_perm:[0,1,2,3] row_mask:0xf bank_mask:0x1
    v_mov_b32_dpp v205, v217 quad_perm:[0,1,2,3] row_mask:0xf bank_mask:0x2
    v_mov_b32_dpp v206, v217 quad_perm:[0,1,2,3] row_mask:0xf bank_mask:0x4
    v_mov_b32_dpp v207, v217 quad_perm:[0,1,2,3] row_mask:0xf bank_mask:0x8
    s_waitcnt lgkmcnt(3)
    v_cvt_f32_i32 v36, v36
    v_cvt_f32_i32 v37, v37
    v_cvt_f32_i32 v38, v38
    v_cvt_f32_i32 v39, v39
    v_cvt_f32_i32 v40, v40
    v_cvt_f32_i32 v41, v41
    v_cvt_f32_i32 v42, v42
    v_cvt_f32_i32 v43, v43
    v_cvt_f32_i32 v44, v44
    v_cvt_f32_i32 v45, v45
    v_cvt_f32_i32 v46, v46
    v_cvt_f32_i32 v47, v47
    s_waitcnt lgkmcnt(0)
    v_cvt_f32_i32 v48, v48
    v_cvt_f32_i32 v49, v49
    v_cvt_f32_i32 v50, v50
    v_cvt_f32_i32 v51, v51
    v_cvt_f32_i32 v52, v52
    v_cvt_f32_i32 v53, v53
    v_cvt_f32_i32 v54, v54
    v_cvt_f32_i32 v55, v55
    v_cvt_f32_i32 v56, v56
    v_cvt_f32_i32 v57, v57
    v_cvt_f32_i32 v58, v58
    v_cvt_f32_i32 v59, v59
    v_cvt_pk_bf16_f32 v60, v36, v48
    v_cvt_pk_bf16_f32 v64, v37, v49
    v_cvt_pk_bf16_f32 v68, v38, v50
    v_cvt_pk_bf16_f32 v72, v39, v51
    v_cvt_pk_bf16_f32 v76, v40, v52
    v_cvt_pk_bf16_f32 v80, v41, v53
    v_cvt_pk_bf16_f32 v84, v42, v54
    v_cvt_pk_bf16_f32 v88, v43, v55
    v_cvt_pk_bf16_f32 v92, v44, v56
    v_cvt_pk_bf16_f32 v96, v45, v57
    v_cvt_pk_bf16_f32 v100, v46, v58
    v_cvt_pk_bf16_f32 v104, v47, v59
    v_add_u32 v11, 3072, v11
    s_add_u32 s63, s63, 1024
    v_add_u32 v211, s63, v7
    v_add_u32 v212, s63, v8
    ds_read_b32 v210, v11 offset:0
    ds_read_u16 v213, v211 offset:512
    ds_read_u16 v214, v212 offset:512
    ds_read_u16 v211, v211
    ds_read_u16 v212, v212
    v_add_u32 v13, s62, v12
    s_add_u32 s62, s62, 24576
    s_cmp_eq_u32 s62, 73728
    s_cselect_b32 s62, 0, s62
    s_barrier
    ds_read_b128 v[36:39], v13 offset:0
    ds_read_b128 v[40:43], v13 offset:256
    ds_read_b128 v[44:47], v13 offset:512
    ds_read_b128 v[48:51], v13 offset:3072
    ds_read_b128 v[52:55], v13 offset:3328
    ds_read_b128 v[56:59], v13 offset:3584
    s_waitcnt lgkmcnt(3)
    v_cvt_f32_i32 v36, v36
    v_cvt_f32_i32 v37, v37
    v_cvt_f32_i32 v38, v38
    v_cvt_f32_i32 v39, v39
    v_cvt_f32_i32 v40, v40
    v_cvt_f32_i32 v41, v41
    v_cvt_f32_i32 v42, v42
    v_cvt_f32_i32 v43, v43
    v_cvt_f32_i32 v44, v44
    v_cvt_f32_i32 v45, v45
    v_cvt_f32_i32 v46, v46
    v_cvt_f32_i32 v47, v47
    s_waitcnt lgkmcnt(0)
    v_cvt_f32_i32 v48, v48
    v_cvt_f32_i32 v49, v49
    v_cvt_f32_i32 v50, v50
    v_cvt_f32_i32 v51, v51
    v_cvt_f32_i32 v52, v52
    v_cvt_f32_i32 v53, v53
    v_cvt_f32_i32 v54, v54
    v_cvt_f32_i32 v55, v55
    v_cvt_f32_i32 v56, v56
    v_cvt_f32_i32 v57, v57
    v_cvt_f32_i32 v58, v58
    v_cvt_f32_i32 v59, v59
    v_cvt_pk_bf16_f32 v61, v36, v48
    v_cvt_pk_bf16_f32 v65, v37, v49
    v_cvt_pk_bf16_f32 v69, v38, v50
    v_cvt_pk_bf16_f32 v73, v39, v51
    v_cvt_pk_bf16_f32 v77, v40, v52
    v_cvt_pk_bf16_f32 v81, v41, v53
    v_cvt_pk_bf16_f32 v85, v42, v54
    v_cvt_pk_bf16_f32 v89, v43, v55
    v_cvt_pk_bf16_f32 v93, v44, v56
    v_cvt_pk_bf16_f32 v97, v45, v57
    v_cvt_pk_bf16_f32 v101, v46, v58
    v_cvt_pk_bf16_f32 v105, v47, v59
    v_add_u32 v13, s62, v12
    s_add_u32 s62, s62, 24576
    s_cmp_eq_u32 s62, 73728
    s_cselect_b32 s62, 0, s62
    s_barrier
    ds_read_b128 v[36:39], v13 offset:0
    ds_read_b128 v[40:43], v13 offset:256
    ds_read_b128 v[44:47], v13 offset:512
    ds_read_b128 v[48:51], v13 offset:3072
    ds_read_b128 v[52:55], v13 offset:3328
    ds_read_b128 v[56:59], v13 offset:3584
    s_waitcnt lgkmcnt(3)
    v_cvt_f32_i32 v36, v36
    v_cvt_f32_i32 v37, v37
    v_cvt_f32_i32 v38, v38
    v_cvt_f32_i32 v39, v39
    v_cvt_f32_i32 v40, v40
    v_cvt_f32_i32 v41, v41
    v_cvt_f32_i32 v42, v42
    v_cvt_f32_i32 v43, v43
    v_cvt_f32_i32 v44, v44
    v_cvt_f32_i32 v45, v45
    v_cvt_f32_i32 v46, v46
    v_cvt_f32_i32 v47, v47
    s_waitcnt lgkmcnt(0)
    v_cvt_f32_i32 v48, v48
    v_cvt_f32_i32 v49, v49
    v_cvt_f32_i32 v50, v50
    v_cvt_f32_i32 v51, v51
    v_cvt_f32_i32 v52, v52
    v_cvt_f32_i32 v53, v53
    v_cvt_f32_i32 v54, v54
    v_cvt_f32_i32 v55, v55
    v_cvt_f32_i32 v56, v56
    v_cvt_f32_i32 v57, v57
    v_cvt_f32_i32 v58, v58
    v_cvt_f32_i32 v59, v59
    v_cvt_pk_bf16_f32 v62, v36, v48
    v_cvt_pk_bf16_f32 v66, v37, v49
    v_cvt_pk_bf16_f32 v70, v38, v50
    v_cvt_pk_bf16_f32 v74, v39, v51
    v_cvt_pk_bf16_f32 v78, v40, v52
    v_cvt_pk_bf16_f32 v82, v41, v53
    v_cvt_pk_bf16_f32 v86, v42, v54
    v_cvt_pk_bf16_f32 v90, v43, v55
    v_cvt_pk_bf16_f32 v94, v44, v56
    v_cvt_pk_bf16_f32 v98, v45, v57
    v_cvt_pk_bf16_f32 v102, v46, v58
    v_cvt_pk_bf16_f32 v106, v47, v59
    v_add_u32 v13, s62, v12
    s_add_u32 s62, s62, 24576
    s_cmp_eq_u32 s62, 73728
    s_cselect_b32 s62, 0, s62
    s_barrier
    ds_read_b128 v[36:39], v13 offset:0
    ds_read_b128 v[40:43], v13 offset:256
    ds_read_b128 v[44:47], v13 offset:512
    ds_read_b128 v[48:51], v13 offset:3072
    ds_read_b128 v[52:55], v13 offset:3328
    ds_read_b128 v[56:59], v13 offset:3584
    s_waitcnt lgkmcnt(3)
    v_cvt_f32_i32 v36, v36
    v_cvt_f32_i32 v37, v37
    v_cvt_f32_i32 v38, v38
    v_cvt_f32_i32 v39, v39
    v_cvt_f32_i32 v40, v40
    v_cvt_f32_i32 v41, v41
    v_cvt_f32_i32 v42, v42
    v_cvt_f32_i32 v43, v43
    v_cvt_f32_i32 v44, v44
    v_cvt_f32_i32 v45, v45
    v_cvt_f32_i32 v46, v46
    v_cvt_f32_i32 v47, v47
    s_waitcnt lgkmcnt(0)
    v_cvt_f32_i32 v48, v48
    v_cvt_f32_i32 v49, v49
    v_cvt_f32_i32 v50, v50
    v_cvt_f32_i32 v51, v51
    v_cvt_f32_i32 v52, v52
    v_cvt_f32_i32 v53, v53
    v_cvt_f32_i32 v54, v54
    v_cvt_f32_i32 v55, v55
    v_cvt_f32_i32 v56, v56
    v_cvt_f32_i32 v57, v57
    v_cvt_f32_i32 v58, v58
    v_cvt_f32_i32 v59, v59
    v_cvt_pk_bf16_f32 v63, v36, v48
    v_cvt_pk_bf16_f32 v67, v37, v49
    v_cvt_pk_bf16_f32 v71, v38, v50
    v_cvt_pk_bf16_f32 v75, v39, v51
    v_cvt_pk_bf16_f32 v79, v40, v52
    v_cvt_pk_bf16_f32 v83, v41, v53
    v_cvt_pk_bf16_f32 v87, v42, v54
    v_cvt_pk_bf16_f32 v91, v43, v55
    v_cvt_pk_bf16_f32 v95, v44, v56
    v_cvt_pk_bf16_f32 v99, v45, v57
    v_cvt_pk_bf16_f32 v103, v46, v58
    v_cvt_pk_bf16_f32 v107, v47, v59
    v_mfma_f32_16x16x32_bf16 v[156:159], v[204:207], v[60:63], v[156:159]
    v_mfma_f32_16x16x32_bf16 v[160:163], v[204:207], v[64:67], v[160:163]
    v_mfma_f32_16x16x32_bf16 v[164:167], v[204:207], v[68:71], v[164:167]
    v_mfma_f32_16x16x32_bf16 v[168:171], v[204:207], v[72:75], v[168:171]
    v_mfma_f32_16x16x32_bf16 v[172:175], v[204:207], v[76:79], v[172:175]
    v_mfma_f32_16x16x32_bf16 v[176:179], v[204:207], v[80:83], v[176:179]
    v_mfma_f32_16x16x32_bf16 v[180:183], v[204:207], v[84:87], v[180:183]
    v_mfma_f32_16x16x32_bf16 v[184:187], v[204:207], v[88:91], v[184:187]
    v_mfma_f32_16x16x32_bf16 v[188:191], v[204:207], v[92:95], v[188:191]
    v_mfma_f32_16x16x32_bf16 v[192:195], v[204:207], v[96:99], v[192:195]
    v_mfma_f32_16x16x32_bf16 v[196:199], v[204:207], v[100:103], v[196:199]
    v_mfma_f32_16x16x32_bf16 v[200:203], v[204:207], v[104:107], v[200:203]
    s_add_u32 s61, s61, 1
    s_cmp_eq_u32 s61, s3
    s_cbranch_scc1 L_vblk_end
    s_cmp_eq_u32 s61, s73
    s_cbranch_scc1 L_vblk_end
    s_cmp_lt_u32 s61, 16
    s_cbranch_scc1 L_vblk
L_vblk_end:
    s_nop 1
    v_add_f32_dpp v208, v208, v208 row_ror:4 row_mask:0xf bank_mask:0xf
    s_nop 1
    v_add_f32_dpp v208, v208, v208 row_ror:8 row_mask:0xf bank_mask:0xf
    v_mov_b32 v3, v208
    s_nop 1
    v_permlane16_swap_b32 v208, v3
    v_add_f32 v208, v208, v3
    v_mov_b32 v3, v208
    s_nop 1
    v_permlane32_swap_b32 v208, v3
    v_add_f32 v208, v208, v3
    s_nop 1
    v_add_f32_dpp v209, v209, v209 row_ror:4 row_mask:0xf bank_mask:0xf
    s_nop 1
    v_add_f32_dpp v209, v209, v209 row_ror:8 row_mask:0xf bank_mask:0xf
    v_mov_b32 v3, v209
    s_nop 1
    v_permlane16_swap_b32 v209, v3
    v_add_f32 v209, v209, v3
    v_mov_b32 v3, v209
    s_nop 1
    v_permlane32_swap_b32 v209, v3
    v_add_f32 v209, v209, v3
    v_mov_b32 v36, v14
    v_mov_b32 v37, v208
    v_mov_b32 v38, v209
    v_mov_b32 v39, 0
    v_and_b32 v4, 3, v1
    v_lshl_add_u32 v4, v2, 2, v4
    v_lshlrev_b32 v4, 4, v4
    v_add_u32 v4, 142336, v4
    ds_write_b128 v4, v[36:39]
    v_permlane32_swap_b32 v156, v158
    v_permlane32_swap_b32 v157, v159
    v_permlane32_swap_b32 v160, v162
    v_permlane32_swap_b32 v161, v163
    v_permlane32_swap_b32 v164, v166
    v_permlane32_swap_b32 v165, v167
    v_permlane32_swap_b32 v168, v170
    v_permlane32_swap_b32 v169, v171
    v_permlane32_swap_b32 v172, v174
    v_permlane32_swap_b32 v173, v175
    v_permlane32_swap_b32 v176, v178
    v_permlane32_swap_b32 v177, v179
    v_permlane32_swap_b32 v180, v182
    v_permlane32_swap_b32 v181, v183
    v_permlane32_swap_b32 v184, v186
    v_permlane32_swap_b32 v185, v187
    v_permlane32_swap_b32 v188, v190
    v_permlane32_swap_b32 v189, v191
    v_permlane32_swap_b32 v192, v194
    v_permlane32_swap_b32 v193, v195
    v_permlane32_swap_b32 v196, v198
    v_permlane32_swap_b32 v197, v199
    v_permlane32_swap_b32 v200, v202
    v_permlane32_swap_b32 v201, v203
    v_add_f32 v156, v156, v158
    v_add_f32 v157, v157, v159
    v_add_f32 v160, v160, v162
    v_add_f32 v161, v161, v163
    v_add_f32 v164, v164, v166
    v_add_f32 v165, v165, v167
    v_add_f32 v168, v168, v170
    v_add_f32 v169, v169, v171
    v_add_f32 v172, v172, v174
    v_add_f32 v173, v173, v175
    v_add_f32 v176, v176, v178
    v_add_f32 v177, v177, v179
    v_add_f32 v180, v180, v182
    v_add_f32 v181, v181, v183
    v_add_f32 v184, v184, v186
    v_add_f32 v185, v185, v187
    v_add_f32 v188, v188, v190
    v_add_f32 v189, v189, v191
    v_add_f32 v192, v192, v194
    v_add_f32 v193, v193, v195
    v_add_f32 v196, v196, v198
    v_add_f32 v197, v197, v199
    v_add_f32 v200, v200, v202
    v_add_f32 v201, v201, v203
    s_nop 1
    v_permlane16_swap_b32 v156, v157
    v_permlane16_swap_b32 v160, v161
    v_permlane16_swap_b32 v164, v165
    v_permlane16_swap_b32 v168, v169
    v_permlane16_swap_b32 v172, v173
    v_permlane16_swap_b32 v176, v177
    v_permlane16_swap_b32 v180, v181
    v_permlane16_swap_b32 v184, v185
    v_permlane16_swap_b32 v188, v189
    v_permlane16_swap_b32 v192, v193
    v_permlane16_swap_b32 v196, v197
    v_permlane16_swap_b32 v200, v201
    v_add_f32 v40, v156, v157
    v_add_f32 v41, v160, v161
    v_add_f32 v42, v164, v165
    v_add_f32 v43, v168, v169
    v_add_f32 v44, v172, v173
    v_add_f32 v45, v176, v177
    v_add_f32 v46, v180, v181
    v_add_f32 v47, v184, v185
    v_add_f32 v48, v188, v189
    v_add_f32 v49, v192, v193
    v_add_f32 v50, v196, v197
    v_add_f32 v51, v200, v201
    v_lshrrev_b32 v3, 4, v1
    v_mul_u32_u24 v3, 768, v3
    v_and_b32 v4, 15, v1
    v_lshl_add_u32 v3, v4, 4, v3
    v_mul_u32_u24 v4, 3072, v2
    s_mov_b32 s58, 142592
    v_add3_u32 v4, v4, v3, s58
    ds_write_b128 v4, v[40:43] offset:0
    ds_write_b128 v4, v[44:47] offset:256
    ds_write_b128 v4, v[48:51] offset:512
    s_waitcnt lgkmcnt(0)
    s_cmp_lt_u32 s61, 16
    s_cbranch_scc1 L_vround
    s_barrier
    s_branch L_fin
L_finisher:
    v_lshrrev_b32 v8, 4, v1
    v_mul_u32_u24 v8, 768, v8
    v_and_b32 v13, 15, v1
    v_lshl_add_u32 v8, v13, 4, v8
    v_lshlrev_b32 v9, 4, v1
    v_and_b32 v14, 48, v1
    s_memrealtime s[96:97]
    s_waitcnt lgkmcnt(0)
    s_mov_b32 s48, s18
    s_and_b32 s49, s19, 0xffff
    s_mov_b32 s50, 393216
    s_mov_b32 s51, 0x20000
    s_mov_b32 s52, s20
    s_and_b32 s53, s21, 0xffff
    s_mov_b32 s54, 256
    s_mov_b32 s55, 0x20000
    s_mov_b32 s24, s22
    s_and_b32 s25, s23, 0xffff
    s_mov_b32 s26, 2611200
    s_mov_b32 s27, 0x20000
    s_cmp_eq_u32 s2, 0
    s_cbranch_scc0 L_fk
    s_or_b32 s71, s96, 1
    v_mov_b32 v16, s71
    v_mov_b32 v17, 0
    s_mov_b64 exec, 1
    buffer_atomic_cmpswap v[16:17], v9, s[52:55], 0 offen sc0 sc1
    s_mov_b64 exec, -1
    s_waitcnt vmcnt(0)
    v_readfirstlane_b32 s58, v16
    s_nop 3
    s_cmp_eq_u32 s58, 0
    s_cselect_b32 s71, s71, s58
L_fk:
    s_movk_i32 s69, 128
L_fb1:
    s_barrier
    s_sub_u32 s69, s69, 1
    s_cmp_lg_u32 s69, 0
    s_cbranch_scc1 L_fb1
    s_load_dword s71, s[20:21], 0
    s_barrier
    s_waitcnt lgkmcnt(0)
    s_cmp_eq_u32 s71, 0
    s_cbranch_scc0 L_ftag
    s_or_b32 s71, s96, 1
    v_mov_b32 v16, s71
    v_mov_b32 v17, 0
    s_mov_b64 exec, 1
    buffer_atomic_cmpswap v[16:17], v9, s[52:55], 0 offen sc0 sc1
    s_mov_b64 exec, -1
    s_waitcnt vmcnt(0)
    v_readfirstlane_b32 s58, v16
    s_nop 3
    s_cmp_eq_u32 s58, 0
    s_cselect_b32 s71, s71, s58
L_ftag:
    v_mov_b32 v10, s71
    s_mul_i32 s68, s100, 13056
    s_lshr_b32 s63, s101, 1
    s_lshl_b32 s58, s100, 1
    s_add_u32 s63, s63, s58
    s_mul_i32 s62, s63, 8704
    s_add_u32 s62, s62, 1114112
    s_cmp_eq_u32 s2, 255
    s_cbranch_scc1 L_fsolo
    s_cmp_eq_u32 s101, 1
    s_cbranch_scc1 L_fmid
    s_movk_i32 s69, 89
L_fb2:
    s_barrier
    s_sub_u32 s69, s69, 1
    s_cmp_lg_u32 s69, 0
    s_cbranch_scc1 L_fb2
    v_add_u32 v13, 142336, v14
    v_add_u32 v11, 142592, v8
    ds_read_b128 v[16:19], v13 offset:0
    ds_read_b128 v[20:23], v13 offset:64
    ds_read_b128 v[24:27], v13 offset:128
    ds_read_b128 v[28:31], v13 offset:192
    ds_read_b128 v[32:35], v11 offset:0
    ds_read_b128 v[36:39], v11 offset:256
    ds_read_b128 v[40:43], v11 offset:512
    ds_read_b128 v[44:47], v11 offset:3072
    ds_read_b128 v[48:51], v11 offset:3328
    ds_read_b128 v[52:55], v11 offset:3584
    ds_read_b128 v[56:59], v11 offset:6144
    ds_read_b128 v[60:63], v11 offset:6400
    ds_read_b128 v[64:67], v11 offset:6656
    s_waitcnt lgkmcnt(9)
    ds_read_b128 v[68:71], v11 offset:9216
    ds_read_b128 v[72:75], v11 offset:9472
    ds_read_b128 v[76:79], v11 offset:9728
    v_max_f32 v156, v16, v20
    v_max3_f32 v156, v156, v24, v28
    v_sub_f32 v16, v16, v156
    v_sub_f32 v20, v20, v156
    v_sub_f32 v24, v24, v156
    v_sub_f32 v28, v28, v156
    v_exp_f32 v16, v16
    v_exp_f32 v20, v20
    v_exp_f32 v24, v24
    v_exp_f32 v28, v28
    v_mov_b32 v143, v10
    v_mov_b32 v147, v10
    v_mov_b32 v151, v10
    v_mov_b32 v155, v10
    v_mov_b32 v159, v10
    v_mul_f32 v157, v16, v17
    v_mul_f32 v158, v16, v18
    v_fmac_f32 v157, v20, v21
    v_fmac_f32 v158, v20, v22
    v_fmac_f32 v157, v24, v25
    v_fmac_f32 v158, v24, v26
    v_fmac_f32 v157, v28, v29
    v_fmac_f32 v158, v28, v30
    s_waitcnt lgkmcnt(9)
    v_fma_f32 v140, v32, v16, -v158
    v_fma_f32 v141, v33, v16, -v158
    v_fma_f32 v142, v34, v16, -v158
    v_fma_f32 v144, v35, v16, -v158
    v_fma_f32 v145, v36, v16, -v158
    v_fma_f32 v146, v37, v16, -v158
    v_fma_f32 v148, v38, v16, -v158
    v_fma_f32 v149, v39, v16, -v158
    v_fma_f32 v150, v40, v16, -v158
    v_fma_f32 v152, v41, v16, -v158
    v_fma_f32 v153, v42, v16, -v158
    v_fma_f32 v154, v43, v16, -v158
    s_waitcnt lgkmcnt(6)
    v_fmac_f32 v140, v44, v20
    v_fmac_f32 v141, v45, v20
    v_fmac_f32 v142, v46, v20
    v_fmac_f32 v144, v47, v20
    v_fmac_f32 v145, v48, v20
    v_fmac_f32 v146, v49, v20
    v_fmac_f32 v148, v50, v20
    v_fmac_f32 v149, v51, v20
    v_fmac_f32 v150, v52, v20
    v_fmac_f32 v152, v53, v20
    v_fmac_f32 v153, v54, v20
    v_fmac_f32 v154, v55, v20
    s_waitcnt lgkmcnt(3)
    v_fmac_f32 v140, v56, v24
    v_fmac_f32 v141, v57, v24
    v_fmac_f32 v142, v58, v24
    v_fmac_f32 v144, v59, v24
    v_fmac_f32 v145, v60, v24
    v_fmac_f32 v146, v61, v24
    v_fmac_f32 v148, v62, v24
    v_fmac_f32 v149, v63, v24
    v_fmac_f32 v150, v64, v24
    v_fmac_f32 v152, v65, v24
    v_fmac_f32 v153, v66, v24
    v_fmac_f32 v154, v67, v24
    s_waitcnt lgkmcnt(0)
    v_fmac_f32 v140, v68, v28
    v_fmac_f32 v141, v69, v28
    v_fmac_f32 v142, v70, v28
    v_fmac_f32 v144, v71, v28
    v_fmac_f32 v145, v72, v28
    v_fmac_f32 v146, v73, v28
    v_fmac_f32 v148, v74, v28
    v_fmac_f32 v149, v75, v28
    v_fmac_f32 v150, v76, v28
    v_fmac_f32 v152, v77, v28
    v_fmac_f32 v153, v78, v28
    v_fmac_f32 v154, v79, v28
    s_movk_i32 s69, 39
L_fb3:
    s_barrier
    s_sub_u32 s69, s69, 1
    s_cmp_lg_u32 s69, 0
    s_cbranch_scc1 L_fb3
    s_add_u32 s58, s62, 4352
    s_add_u32 s59, s62, 8448
    buffer_load_dwordx4 v[176:179], v14, s[24:27], s59 offen sc1
    buffer_load_dwordx4 v[160:163], v9, s[24:27], s58 offen offset:0 sc1
    buffer_load_dwordx4 v[164:167], v9, s[24:27], s58 offen offset:1024 sc1
    buffer_load_dwordx4 v[168:171], v9, s[24:27], s58 offen offset:2048 sc1
    buffer_load_dwordx4 v[172:175], v9, s[24:27], s58 offen offset:3072 sc1
    s_barrier
    s_cmp_eq_u32 s101, 2
    s_cbranch_scc1 L_fo2
    v_add_u32 v13, 142336, v14
    v_add_u32 v11, 142592, v8
    ds_read_b128 v[16:19], v13 offset:0
    ds_read_b128 v[20:23], v13 offset:64
    ds_read_b128 v[24:27], v13 offset:128
    ds_read_b128 v[28:31], v13 offset:192
    ds_read_b128 v[32:35], v11 offset:0
    ds_read_b128 v[36:39], v11 offset:256
    ds_read_b128 v[40:43], v11 offset:512
    ds_read_b128 v[44:47], v11 offset:3072
    ds_read_b128 v[48:51], v11 offset:3328
    ds_read_b128 v[52:55], v11 offset:3584
    ds_read_b128 v[56:59], v11 offset:6144
    ds_read_b128 v[60:63], v11 offset:6400
    ds_read_b128 v[64:67], v11 offset:6656
    s_waitcnt lgkmcnt(9)
    ds_read_b128 v[68:71], v11 offset:9216
    ds_read_b128 v[72:75], v11 offset:9472
    ds_read_b128 v[76:79], v11 offset:9728
    v_max_f32 v96, v16, v20
    v_max3_f32 v96, v96, v24, v28
    v_sub_f32 v16, v16, v96
    v_sub_f32 v20, v20, v96
    v_sub_f32 v24, v24, v96
    v_sub_f32 v28, v28, v96
    v_exp_f32 v16, v16
    v_exp_f32 v20, v20
    v_exp_f32 v24, v24
    v_exp_f32 v28, v28
    v_mov_b32 v83, v10
    v_mov_b32 v87, v10
    v_mov_b32 v91, v10
    v_mov_b32 v95, v10
    v_mov_b32 v99, v10
    v_mul_f32 v97, v16, v17
    v_mul_f32 v98, v16, v18
    v_fmac_f32 v97, v20, v21
    v_fmac_f32 v98, v20, v22
    v_fmac_f32 v97, v24, v25
    v_fmac_f32 v98, v24, v26
    v_fmac_f32 v97, v28, v29
    v_fmac_f32 v98, v28, v30
    s_waitcnt lgkmcnt(9)
    v_fma_f32 v80, v32, v16, -v98
    v_fma_f32 v81, v33, v16, -v98
    v_fma_f32 v82, v34, v16, -v98
    v_fma_f32 v84, v35, v16, -v98
    v_fma_f32 v85, v36, v16, -v98
    v_fma_f32 v86, v37, v16, -v98
    v_fma_f32 v88, v38, v16, -v98
    v_fma_f32 v89, v39, v16, -v98
    v_fma_f32 v90, v40, v16, -v98
    v_fma_f32 v92, v41, v16, -v98
    v_fma_f32 v93, v42, v16, -v98
    v_fma_f32 v94, v43, v16, -v98
    s_waitcnt lgkmcnt(6)
    v_fmac_f32 v80, v44, v20
    v_fmac_f32 v81, v45, v20
    v_fmac_f32 v82, v46, v20
    v_fmac_f32 v84, v47, v20
    v_fmac_f32 v85, v48, v20
    v_fmac_f32 v86, v49, v20
    v_fmac_f32 v88, v50, v20
    v_fmac_f32 v89, v51, v20
    v_fmac_f32 v90, v52, v20
    v_fmac_f32 v92, v53, v20
    v_fmac_f32 v93, v54, v20
    v_fmac_f32 v94, v55, v20
    s_waitcnt lgkmcnt(3)
    v_fmac_f32 v80, v56, v24
    v_fmac_f32 v81, v57, v24
    v_fmac_f32 v82, v58, v24
    v_fmac_f32 v84, v59, v24
    v_fmac_f32 v85, v60, v24
    v_fmac_f32 v86, v61, v24
    v_fmac_f32 v88, v62, v24
    v_fmac_f32 v89, v63, v24
    v_fmac_f32 v90, v64, v24
    v_fmac_f32 v92, v65, v24
    v_fmac_f32 v93, v66, v24
    v_fmac_f32 v94, v67, v24
    s_waitcnt lgkmcnt(0)
    v_fmac_f32 v80, v68, v28
    v_fmac_f32 v81, v69, v28
    v_fmac_f32 v82, v70, v28
    v_fmac_f32 v84, v71, v28
    v_fmac_f32 v85, v72, v28
    v_fmac_f32 v86, v73, v28
    v_fmac_f32 v88, v74, v28
    v_fmac_f32 v89, v75, v28
    v_fmac_f32 v90, v76, v28
    v_fmac_f32 v92, v77, v28
    v_fmac_f32 v93, v78, v28
    v_fmac_f32 v94, v79, v28
    s_add_u32 s58, s68, 0
    s_add_u32 s59, s68, 4096
    buffer_store_dwordx4 v[80:83], v9, s[24:27], s58 offen offset:0 sc1
    buffer_store_dwordx4 v[84:87], v9, s[24:27], s58 offen offset:1024 sc1
    buffer_store_dwordx4 v[88:91], v9, s[24:27], s58 offen offset:2048 sc1
    buffer_store_dwordx4 v[92:95], v9, s[24:27], s58 offen offset:3072 sc1
    s_mov_b32 exec_lo, 0x00010001
    s_mov_b32 exec_hi, 0x00010001
    buffer_store_dwordx4 v[96:99], v14, s[24:27], s59 offen sc1
    s_mov_b64 exec, -1
    s_mov_b32 s70, 0
    s_waitcnt vmcnt(5)
    v_xor_b32 v13, v10, v163
    v_xor_b32 v11, v10, v167
    v_or_b32 v13, v13, v11
    v_xor_b32 v11, v10, v171
    v_or_b32 v13, v13, v11
    v_xor_b32 v11, v10, v175
    v_or_b32 v13, v13, v11
    v_xor_b32 v11, v10, v179
    v_or_b32 v13, v13, v11
    v_cmp_ne_u32 vcc, 0, v13
    s_nop 4
    s_cmp_eq_u64 vcc, 0
    s_cbranch_scc0 L_fo30
    v_max_f32 v11, v156, v176
    v_sub_f32 v16, v156, v11
    v_sub_f32 v17, v176, v11
    v_exp_f32 v16, v16
    v_exp_f32 v17, v17
    v_lshrrev_b32 v13, 1, v8
    v_mul_f32 v12, v16, v157
    v_fmac_f32 v12, v17, v177
    v_rcp_f32 v12, v12
    s_add_u32 s58, s63, 0
    s_mul_i32 s58, s58, 1536
    v_mul_f32 v16, v16, v12
    v_mul_f32 v17, v17, v12
    v_mul_f32 v32, v140, v16
    v_fmac_f32 v32, v160, v17
    v_mul_f32 v33, v141, v16
    v_fmac_f32 v33, v161, v17
    v_mul_f32 v34, v142, v16
    v_fmac_f32 v34, v162, v17
    v_mul_f32 v35, v144, v16
    v_fmac_f32 v35, v164, v17
    v_mul_f32 v36, v145, v16
    v_fmac_f32 v36, v165, v17
    v_mul_f32 v37, v146, v16
    v_fmac_f32 v37, v166, v17
    v_mul_f32 v38, v148, v16
    v_fmac_f32 v38, v168, v17
    v_mul_f32 v39, v149, v16
    v_fmac_f32 v39, v169, v17
    v_mul_f32 v40, v150, v16
    v_fmac_f32 v40, v170, v17
    v_mul_f32 v41, v152, v16
    v_fmac_f32 v41, v172, v17
    v_mul_f32 v42, v153, v16
    v_fmac_f32 v42, v173, v17
    v_mul_f32 v43, v154, v16
    v_fmac_f32 v43, v174, v17
    v_cvt_pk_bf16_f32 v44, v32, v33
    v_cvt_pk_bf16_f32 v45, v34, v35
    v_cvt_pk_bf16_f32 v46, v36, v37
    v_cvt_pk_bf16_f32 v47, v38, v39
    v_cvt_pk_bf16_f32 v48, v40, v41
    v_cvt_pk_bf16_f32 v49, v42, v43
    buffer_store_dwordx2 v[44:45], v13, s[48:51], s58 offen offset:0
    buffer_store_dwordx2 v[46:47], v13, s[48:51], s58 offen offset:128
    buffer_store_dwordx2 v[48:49], v13, s[48:51], s58 offen offset:256
    s_mov_b32 s70, 1
    s_waitcnt vmcnt(0)
    s_branch L_fo40
L_fo30:
    s_waitcnt vmcnt(0)
    s_add_u32 s58, s62, 4352
    s_add_u32 s59, s62, 8448
    buffer_load_dwordx4 v[176:179], v14, s[24:27], s59 offen sc1
    buffer_load_dwordx4 v[160:163], v9, s[24:27], s58 offen offset:0 sc1
    buffer_load_dwordx4 v[164:167], v9, s[24:27], s58 offen offset:1024 sc1
    buffer_load_dwordx4 v[168:171], v9, s[24:27], s58 offen offset:2048 sc1
    buffer_load_dwordx4 v[172:175], v9, s[24:27], s58 offen offset:3072 sc1
L_fo40:
    s_add_u32 s58, s68, 8704
    s_add_u32 s59, s68, 12800
    buffer_load_dwordx4 v[136:139], v14, s[24:27], s59 offen sc1
    buffer_load_dwordx4 v[120:123], v9, s[24:27], s58 offen offset:0 sc1
    buffer_load_dwordx4 v[124:127], v9, s[24:27], s58 offen offset:1024 sc1
    buffer_load_dwordx4 v[128:131], v9, s[24:27], s58 offen offset:2048 sc1
    buffer_load_dwordx4 v[132:135], v9, s[24:27], s58 offen offset:3072 sc1
    s_branch L_fo5
L_fo2:
    v_add_u32 v13, 142336, v14
    v_add_u32 v11, 142592, v8
    ds_read_b128 v[16:19], v13 offset:0
    ds_read_b128 v[20:23], v13 offset:64
    ds_read_b128 v[24:27], v13 offset:128
    ds_read_b128 v[28:31], v13 offset:192
    ds_read_b128 v[32:35], v11 offset:0
    ds_read_b128 v[36:39], v11 offset:256
    ds_read_b128 v[40:43], v11 offset:512
    ds_read_b128 v[44:47], v11 offset:3072
    ds_read_b128 v[48:51], v11 offset:3328
    ds_read_b128 v[52:55], v11 offset:3584
    ds_read_b128 v[56:59], v11 offset:6144
    ds_read_b128 v[60:63], v11 offset:6400
    ds_read_b128 v[64:67], v11 offset:6656
    s_waitcnt lgkmcnt(9)
    ds_read_b128 v[68:71], v11 offset:9216
    ds_read_b128 v[72:75], v11 offset:9472
    ds_read_b128 v[76:79], v11 offset:9728
    v_max_f32 v136, v16, v20
    v_max3_f32 v136, v136, v24, v28
    v_sub_f32 v16, v16, v136
    v_sub_f32 v20, v20, v136
    v_sub_f32 v24, v24, v136
    v_sub_f32 v28, v28, v136
    v_exp_f32 v16, v16
    v_exp_f32 v20, v20
    v_exp_f32 v24, v24
    v_exp_f32 v28, v28
    v_mov_b32 v123, v10
    v_mov_b32 v127, v10
    v_mov_b32 v131, v10
    v_mov_b32 v135, v10
    v_mov_b32 v139, v10
    v_mul_f32 v137, v16, v17
    v_mul_f32 v138, v16, v18
    v_fmac_f32 v137, v20, v21
    v_fmac_f32 v138, v20, v22
    v_fmac_f32 v137, v24, v25
    v_fmac_f32 v138, v24, v26
    v_fmac_f32 v137, v28, v29
    v_fmac_f32 v138, v28, v30
    s_waitcnt lgkmcnt(9)
    v_fma_f32 v120, v32, v16, -v138
    v_fma_f32 v121, v33, v16, -v138
    v_fma_f32 v122, v34, v16, -v138
    v_fma_f32 v124, v35, v16, -v138
    v_fma_f32 v125, v36, v16, -v138
    v_fma_f32 v126, v37, v16, -v138
    v_fma_f32 v128, v38, v16, -v138
    v_fma_f32 v129, v39, v16, -v138
    v_fma_f32 v130, v40, v16, -v138
    v_fma_f32 v132, v41, v16, -v138
    v_fma_f32 v133, v42, v16, -v138
    v_fma_f32 v134, v43, v16, -v138
    s_waitcnt lgkmcnt(6)
    v_fmac_f32 v120, v44, v20
    v_fmac_f32 v121, v45, v20
    v_fmac_f32 v122, v46, v20
    v_fmac_f32 v124, v47, v20
    v_fmac_f32 v125, v48, v20
    v_fmac_f32 v126, v49, v20
    v_fmac_f32 v128, v50, v20
    v_fmac_f32 v129, v51, v20
    v_fmac_f32 v130, v52, v20
    v_fmac_f32 v132, v53, v20
    v_fmac_f32 v133, v54, v20
    v_fmac_f32 v134, v55, v20
    s_waitcnt lgkmcnt(3)
    v_fmac_f32 v120, v56, v24
    v_fmac_f32 v121, v57, v24
    v_fmac_f32 v122, v58, v24
    v_fmac_f32 v124, v59, v24
    v_fmac_f32 v125, v60, v24
    v_fmac_f32 v126, v61, v24
    v_fmac_f32 v128, v62, v24
    v_fmac_f32 v129, v63, v24
    v_fmac_f32 v130, v64, v24
    v_fmac_f32 v132, v65, v24
    v_fmac_f32 v133, v66, v24
    v_fmac_f32 v134, v67, v24
    s_waitcnt lgkmcnt(0)
    v_fmac_f32 v120, v68, v28
    v_fmac_f32 v121, v69, v28
    v_fmac_f32 v122, v70, v28
    v_fmac_f32 v124, v71, v28
    v_fmac_f32 v125, v72, v28
    v_fmac_f32 v126, v73, v28
    v_fmac_f32 v128, v74, v28
    v_fmac_f32 v129, v75, v28
    v_fmac_f32 v130, v76, v28
    v_fmac_f32 v132, v77, v28
    v_fmac_f32 v133, v78, v28
    v_fmac_f32 v134, v79, v28
    s_add_u32 s58, s68, 8704
    s_add_u32 s59, s68, 12800
    buffer_store_dwordx4 v[120:123], v9, s[24:27], s58 offen offset:0 sc1
    buffer_store_dwordx4 v[124:127], v9, s[24:27], s58 offen offset:1024 sc1
    buffer_store_dwordx4 v[128:131], v9, s[24:27], s58 offen offset:2048 sc1
    buffer_store_dwordx4 v[132:135], v9, s[24:27], s58 offen offset:3072 sc1
    s_mov_b32 exec_lo, 0x00010001
    s_mov_b32 exec_hi, 0x00010001
    buffer_store_dwordx4 v[136:139], v14, s[24:27], s59 offen sc1
    s_mov_b64 exec, -1
    s_mov_b32 s70, 0
    s_waitcnt vmcnt(5)
    v_xor_b32 v13, v10, v163
    v_xor_b32 v11, v10, v167
    v_or_b32 v13, v13, v11
    v_xor_b32 v11, v10, v171
    v_or_b32 v13, v13, v11
    v_xor_b32 v11, v10, v175
    v_or_b32 v13, v13, v11
    v_xor_b32 v11, v10, v179
    v_or_b32 v13, v13, v11
    v_cmp_ne_u32 vcc, 0, v13
    s_nop 4
    s_cmp_eq_u64 vcc, 0
    s_cbranch_scc0 L_fo32
    v_max_f32 v11, v156, v176
    v_sub_f32 v16, v156, v11
    v_sub_f32 v17, v176, v11
    v_exp_f32 v16, v16
    v_exp_f32 v17, v17
    v_lshrrev_b32 v13, 1, v8
    v_mul_f32 v12, v16, v157
    v_fmac_f32 v12, v17, v177
    v_rcp_f32 v12, v12
    s_add_u32 s58, s63, 0
    s_mul_i32 s58, s58, 1536
    v_mul_f32 v16, v16, v12
    v_mul_f32 v17, v17, v12
    v_mul_f32 v32, v140, v16
    v_fmac_f32 v32, v160, v17
    v_mul_f32 v33, v141, v16
    v_fmac_f32 v33, v161, v17
    v_mul_f32 v34, v142, v16
    v_fmac_f32 v34, v162, v17
    v_mul_f32 v35, v144, v16
    v_fmac_f32 v35, v164, v17
    v_mul_f32 v36, v145, v16
    v_fmac_f32 v36, v165, v17
    v_mul_f32 v37, v146, v16
    v_fmac_f32 v37, v166, v17
    v_mul_f32 v38, v148, v16
    v_fmac_f32 v38, v168, v17
    v_mul_f32 v39, v149, v16
    v_fmac_f32 v39, v169, v17
    v_mul_f32 v40, v150, v16
    v_fmac_f32 v40, v170, v17
    v_mul_f32 v41, v152, v16
    v_fmac_f32 v41, v172, v17
    v_mul_f32 v42, v153, v16
    v_fmac_f32 v42, v173, v17
    v_mul_f32 v43, v154, v16
    v_fmac_f32 v43, v174, v17
    v_cvt_pk_bf16_f32 v44, v32, v33
    v_cvt_pk_bf16_f32 v45, v34, v35
    v_cvt_pk_bf16_f32 v46, v36, v37
    v_cvt_pk_bf16_f32 v47, v38, v39
    v_cvt_pk_bf16_f32 v48, v40, v41
    v_cvt_pk_bf16_f32 v49, v42, v43
    buffer_store_dwordx2 v[44:45], v13, s[48:51], s58 offen offset:0
    buffer_store_dwordx2 v[46:47], v13, s[48:51], s58 offen offset:128
    buffer_store_dwordx2 v[48:49], v13, s[48:51], s58 offen offset:256
    s_mov_b32 s70, 1
    s_waitcnt vmcnt(0)
    s_branch L_fo42
L_fo32:
    s_waitcnt vmcnt(0)
    s_add_u32 s58, s62, 4352
    s_add_u32 s59, s62, 8448
    buffer_load_dwordx4 v[176:179], v14, s[24:27], s59 offen sc1
    buffer_load_dwordx4 v[160:163], v9, s[24:27], s58 offen offset:0 sc1
    buffer_load_dwordx4 v[164:167], v9, s[24:27], s58 offen offset:1024 sc1
    buffer_load_dwordx4 v[168:171], v9, s[24:27], s58 offen offset:2048 sc1
    buffer_load_dwordx4 v[172:175], v9, s[24:27], s58 offen offset:3072 sc1
L_fo42:
    s_add_u32 s58, s68, 0
    s_add_u32 s59, s68, 4096
    buffer_load_dwordx4 v[96:99], v14, s[24:27], s59 offen sc1
    buffer_load_dwordx4 v[80:83], v9, s[24:27], s58 offen offset:0 sc1
    buffer_load_dwordx4 v[84:87], v9, s[24:27], s58 offen offset:1024 sc1
    buffer_load_dwordx4 v[88:91], v9, s[24:27], s58 offen offset:2048 sc1
    buffer_load_dwordx4 v[92:95], v9, s[24:27], s58 offen offset:3072 sc1
L_fo5:
    s_add_u32 s58, s68, 4352
    s_add_u32 s59, s68, 8448
    buffer_load_dwordx4 v[116:119], v14, s[24:27], s59 offen sc1
    buffer_load_dwordx4 v[100:103], v9, s[24:27], s58 offen offset:0 sc1
    buffer_load_dwordx4 v[104:107], v9, s[24:27], s58 offen offset:1024 sc1
    buffer_load_dwordx4 v[108:111], v9, s[24:27], s58 offen offset:2048 sc1
    buffer_load_dwordx4 v[112:115], v9, s[24:27], s58 offen offset:3072 sc1
    s_waitcnt vmcnt(0)
    v_xor_b32 v13, v10, v83
    v_xor_b32 v11, v10, v87
    v_or_b32 v13, v13, v11
    v_xor_b32 v11, v10, v91
    v_or_b32 v13, v13, v11
    v_xor_b32 v11, v10, v95
    v_or_b32 v13, v13, v11
    v_xor_b32 v11, v10, v99
    v_or_b32 v13, v13, v11
    v_xor_b32 v11, v10, v103
    v_or_b32 v13, v13, v11
    v_xor_b32 v11, v10, v107
    v_or_b32 v13, v13, v11
    v_xor_b32 v11, v10, v111
    v_or_b32 v13, v13, v11
    v_xor_b32 v11, v10, v115
    v_or_b32 v13, v13, v11
    v_xor_b32 v11, v10, v119
    v_or_b32 v13, v13, v11
    v_xor_b32 v11, v10, v123
    v_or_b32 v13, v13, v11
    v_xor_b32 v11, v10, v127
    v_or_b32 v13, v13, v11
    v_xor_b32 v11, v10, v131
    v_or_b32 v13, v13, v11
    v_xor_b32 v11, v10, v135
    v_or_b32 v13, v13, v11
    v_xor_b32 v11, v10, v139
    v_or_b32 v13, v13, v11
    v_cmp_ne_u32 vcc, 0, v13
    s_nop 4
    s_cmp_eq_u64 vcc, 0
    s_cbranch_scc0 L_fo6
    v_max3_f32 v11, v96, v116, v136
    v_sub_f32 v16, v96, v11
    v_sub_f32 v17, v116, v11
    v_sub_f32 v18, v136, v11
    v_exp_f32 v16, v16
    v_exp_f32 v17, v17
    v_exp_f32 v18, v18
    v_lshrrev_b32 v13, 1, v8
    v_mul_f32 v12, v16, v97
    v_fmac_f32 v12, v17, v117
    v_fmac_f32 v12, v18, v137
    v_rcp_f32 v12, v12
    s_add_u32 s58, s100, 171
    s_mul_i32 s58, s58, 1536
    v_mul_f32 v16, v16, v12
    v_mul_f32 v17, v17, v12
    v_mul_f32 v18, v18, v12
    v_mul_f32 v32, v80, v16
    v_fmac_f32 v32, v100, v17
    v_fmac_f32 v32, v120, v18
    v_mul_f32 v33, v81, v16
    v_fmac_f32 v33, v101, v17
    v_fmac_f32 v33, v121, v18
    v_mul_f32 v34, v82, v16
    v_fmac_f32 v34, v102, v17
    v_fmac_f32 v34, v122, v18
    v_mul_f32 v35, v84, v16
    v_fmac_f32 v35, v104, v17
    v_fmac_f32 v35, v124, v18
    v_mul_f32 v36, v85, v16
    v_fmac_f32 v36, v105, v17
    v_fmac_f32 v36, v125, v18
    v_mul_f32 v37, v86, v16
    v_fmac_f32 v37, v106, v17
    v_fmac_f32 v37, v126, v18
    v_mul_f32 v38, v88, v16
    v_fmac_f32 v38, v108, v17
    v_fmac_f32 v38, v128, v18
    v_mul_f32 v39, v89, v16
    v_fmac_f32 v39, v109, v17
    v_fmac_f32 v39, v129, v18
    v_mul_f32 v40, v90, v16
    v_fmac_f32 v40, v110, v17
    v_fmac_f32 v40, v130, v18
    v_mul_f32 v41, v92, v16
    v_fmac_f32 v41, v112, v17
    v_fmac_f32 v41, v132, v18
    v_mul_f32 v42, v93, v16
    v_fmac_f32 v42, v113, v17
    v_fmac_f32 v42, v133, v18
    v_mul_f32 v43, v94, v16
    v_fmac_f32 v43, v114, v17
    v_fmac_f32 v43, v134, v18
    v_cvt_pk_bf16_f32 v44, v32, v33
    v_cvt_pk_bf16_f32 v45, v34, v35
    v_cvt_pk_bf16_f32 v46, v36, v37
    v_cvt_pk_bf16_f32 v47, v38, v39
    v_cvt_pk_bf16_f32 v48, v40, v41
    v_cvt_pk_bf16_f32 v49, v42, v43
    buffer_store_dwordx2 v[44:45], v13, s[48:51], s58 offen offset:0
    buffer_store_dwordx2 v[46:47], v13, s[48:51], s58 offen offset:128
    buffer_store_dwordx2 v[48:49], v13, s[48:51], s58 offen offset:256
L_fo6:
    s_cmp_eq_u32 s70, 1
    s_cbranch_scc1 L_fin
    v_xor_b32 v13, v10, v163
    v_xor_b32 v11, v10, v167
    v_or_b32 v13, v13, v11
    v_xor_b32 v11, v10, v171
    v_or_b32 v13, v13, v11
    v_xor_b32 v11, v10, v175
    v_or_b32 v13, v13, v11
    v_xor_b32 v11, v10, v179
    v_or_b32 v13, v13, v11
    v_cmp_ne_u32 vcc, 0, v13
    s_nop 4
    s_cmp_eq_u64 vcc, 0
    s_cbranch_scc1 L_fo7
    s_add_u32 s58, s62, 0
    s_add_u32 s59, s62, 4096
    buffer_store_dwordx4 v[140:143], v9, s[24:27], s58 offen offset:0 sc1
    buffer_store_dwordx4 v[144:147], v9, s[24:27], s58 offen offset:1024 sc1
    buffer_store_dwordx4 v[148:151], v9, s[24:27], s58 offen offset:2048 sc1
    buffer_store_dwordx4 v[152:155], v9, s[24:27], s58 offen offset:3072 sc1
    s_mov_b32 exec_lo, 0x00010001
    s_mov_b32 exec_hi, 0x00010001
    buffer_store_dwordx4 v[156:159], v14, s[24:27], s59 offen sc1
    s_mov_b64 exec, -1
    s_waitcnt vmcnt(0)
    s_add_u32 s58, s62, 4352
    s_add_u32 s59, s62, 8448
    buffer_load_dwordx4 v[176:179], v14, s[24:27], s59 offen sc1
    buffer_load_dwordx4 v[160:163], v9, s[24:27], s58 offen offset:0 sc1
    buffer_load_dwordx4 v[164:167], v9, s[24:27], s58 offen offset:1024 sc1
    buffer_load_dwordx4 v[168:171], v9, s[24:27], s58 offen offset:2048 sc1
    buffer_load_dwordx4 v[172:175], v9, s[24:27], s58 offen offset:3072 sc1
    s_waitcnt vmcnt(0)
    v_xor_b32 v13, v10, v163
    v_xor_b32 v11, v10, v167
    v_or_b32 v13, v13, v11
    v_xor_b32 v11, v10, v171
    v_or_b32 v13, v13, v11
    v_xor_b32 v11, v10, v175
    v_or_b32 v13, v13, v11
    v_xor_b32 v11, v10, v179
    v_or_b32 v13, v13, v11
    v_cmp_ne_u32 vcc, 0, v13
    s_nop 4
    s_cmp_eq_u64 vcc, 0
    s_cbranch_scc0 L_fin
L_fo7:
    v_max_f32 v11, v156, v176
    v_sub_f32 v16, v156, v11
    v_sub_f32 v17, v176, v11
    v_exp_f32 v16, v16
    v_exp_f32 v17, v17
    v_lshrrev_b32 v13, 1, v8
    v_mul_f32 v12, v16, v157
    v_fmac_f32 v12, v17, v177
    v_rcp_f32 v12, v12
    s_add_u32 s58, s63, 0
    s_mul_i32 s58, s58, 1536
    v_mul_f32 v16, v16, v12
    v_mul_f32 v17, v17, v12
    v_mul_f32 v32, v140, v16
    v_fmac_f32 v32, v160, v17
    v_mul_f32 v33, v141, v16
    v_fmac_f32 v33, v161, v17
    v_mul_f32 v34, v142, v16
    v_fmac_f32 v34, v162, v17
    v_mul_f32 v35, v144, v16
    v_fmac_f32 v35, v164, v17
    v_mul_f32 v36, v145, v16
    v_fmac_f32 v36, v165, v17
    v_mul_f32 v37, v146, v16
    v_fmac_f32 v37, v166, v17
    v_mul_f32 v38, v148, v16
    v_fmac_f32 v38, v168, v17
    v_mul_f32 v39, v149, v16
    v_fmac_f32 v39, v169, v17
    v_mul_f32 v40, v150, v16
    v_fmac_f32 v40, v170, v17
    v_mul_f32 v41, v152, v16
    v_fmac_f32 v41, v172, v17
    v_mul_f32 v42, v153, v16
    v_fmac_f32 v42, v173, v17
    v_mul_f32 v43, v154, v16
    v_fmac_f32 v43, v174, v17
    v_cvt_pk_bf16_f32 v44, v32, v33
    v_cvt_pk_bf16_f32 v45, v34, v35
    v_cvt_pk_bf16_f32 v46, v36, v37
    v_cvt_pk_bf16_f32 v47, v38, v39
    v_cvt_pk_bf16_f32 v48, v40, v41
    v_cvt_pk_bf16_f32 v49, v42, v43
    buffer_store_dwordx2 v[44:45], v13, s[48:51], s58 offen offset:0
    buffer_store_dwordx2 v[46:47], v13, s[48:51], s58 offen offset:128
    buffer_store_dwordx2 v[48:49], v13, s[48:51], s58 offen offset:256
    s_branch L_fin
L_fmid:
    v_and_b32 v7, 1, v1
    v_mul_u32_u24 v7, 8704, v7
    v_add_u32 v7, 4108, v7
    s_movk_i32 s69, 41
L_fb4:
    s_barrier
    s_sub_u32 s69, s69, 1
    s_cmp_lg_u32 s69, 0
    s_cbranch_scc1 L_fb4
    v_add_u32 v13, 142336, v14
    v_add_u32 v11, 142592, v8
    ds_read_b128 v[16:19], v13 offset:0
    ds_read_b128 v[20:23], v13 offset:64
    ds_read_b128 v[24:27], v13 offset:128
    ds_read_b128 v[28:31], v13 offset:192
    ds_read_b128 v[32:35], v11 offset:0
    ds_read_b128 v[36:39], v11 offset:256
    ds_read_b128 v[40:43], v11 offset:512
    ds_read_b128 v[44:47], v11 offset:3072
    ds_read_b128 v[48:51], v11 offset:3328
    ds_read_b128 v[52:55], v11 offset:3584
    ds_read_b128 v[56:59], v11 offset:6144
    ds_read_b128 v[60:63], v11 offset:6400
    ds_read_b128 v[64:67], v11 offset:6656
    s_waitcnt lgkmcnt(9)
    ds_read_b128 v[68:71], v11 offset:9216
    ds_read_b128 v[72:75], v11 offset:9472
    ds_read_b128 v[76:79], v11 offset:9728
    v_max_f32 v156, v16, v20
    v_max3_f32 v156, v156, v24, v28
    v_sub_f32 v16, v16, v156
    v_sub_f32 v20, v20, v156
    v_sub_f32 v24, v24, v156
    v_sub_f32 v28, v28, v156
    v_exp_f32 v16, v16
    v_exp_f32 v20, v20
    v_exp_f32 v24, v24
    v_exp_f32 v28, v28
    v_mov_b32 v143, v10
    v_mov_b32 v147, v10
    v_mov_b32 v151, v10
    v_mov_b32 v155, v10
    v_mov_b32 v159, v10
    v_mul_f32 v157, v16, v17
    v_mul_f32 v158, v16, v18
    v_fmac_f32 v157, v20, v21
    v_fmac_f32 v158, v20, v22
    v_fmac_f32 v157, v24, v25
    v_fmac_f32 v158, v24, v26
    v_fmac_f32 v157, v28, v29
    v_fmac_f32 v158, v28, v30
    s_waitcnt lgkmcnt(9)
    v_fma_f32 v140, v32, v16, -v158
    v_fma_f32 v141, v33, v16, -v158
    v_fma_f32 v142, v34, v16, -v158
    v_fma_f32 v144, v35, v16, -v158
    v_fma_f32 v145, v36, v16, -v158
    v_fma_f32 v146, v37, v16, -v158
    v_fma_f32 v148, v38, v16, -v158
    v_fma_f32 v149, v39, v16, -v158
    v_fma_f32 v150, v40, v16, -v158
    v_fma_f32 v152, v41, v16, -v158
    v_fma_f32 v153, v42, v16, -v158
    v_fma_f32 v154, v43, v16, -v158
    s_waitcnt lgkmcnt(6)
    v_fmac_f32 v140, v44, v20
    v_fmac_f32 v141, v45, v20
    v_fmac_f32 v142, v46, v20
    v_fmac_f32 v144, v47, v20
    v_fmac_f32 v145, v48, v20
    v_fmac_f32 v146, v49, v20
    v_fmac_f32 v148, v50, v20
    v_fmac_f32 v149, v51, v20
    v_fmac_f32 v150, v52, v20
    v_fmac_f32 v152, v53, v20
    v_fmac_f32 v153, v54, v20
    v_fmac_f32 v154, v55, v20
    s_waitcnt lgkmcnt(3)
    v_fmac_f32 v140, v56, v24
    v_fmac_f32 v141, v57, v24
    v_fmac_f32 v142, v58, v24
    v_fmac_f32 v144, v59, v24
    v_fmac_f32 v145, v60, v24
    v_fmac_f32 v146, v61, v24
    v_fmac_f32 v148, v62, v24
    v_fmac_f32 v149, v63, v24
    v_fmac_f32 v150, v64, v24
    v_fmac_f32 v152, v65, v24
    v_fmac_f32 v153, v66, v24
    v_fmac_f32 v154, v67, v24
    s_waitcnt lgkmcnt(0)
    v_fmac_f32 v140, v68, v28
    v_fmac_f32 v141, v69, v28
    v_fmac_f32 v142, v70, v28
    v_fmac_f32 v144, v71, v28
    v_fmac_f32 v145, v72, v28
    v_fmac_f32 v146, v73, v28
    v_fmac_f32 v148, v74, v28
    v_fmac_f32 v149, v75, v28
    v_fmac_f32 v150, v76, v28
    v_fmac_f32 v152, v77, v28
    v_fmac_f32 v153, v78, v28
    v_fmac_f32 v154, v79, v28
    s_movk_i32 s69, 40
L_fb5:
    s_barrier
    s_sub_u32 s69, s69, 1
    s_cmp_lg_u32 s69, 0
    s_cbranch_scc1 L_fb5
    v_add_u32 v13, 142336, v14
    v_add_u32 v11, 142592, v8
    ds_read_b128 v[16:19], v13 offset:0
    ds_read_b128 v[20:23], v13 offset:64
    ds_read_b128 v[24:27], v13 offset:128
    ds_read_b128 v[28:31], v13 offset:192
    ds_read_b128 v[32:35], v11 offset:0
    ds_read_b128 v[36:39], v11 offset:256
    ds_read_b128 v[40:43], v11 offset:512
    ds_read_b128 v[44:47], v11 offset:3072
    ds_read_b128 v[48:51], v11 offset:3328
    ds_read_b128 v[52:55], v11 offset:3584
    ds_read_b128 v[56:59], v11 offset:6144
    ds_read_b128 v[60:63], v11 offset:6400
    ds_read_b128 v[64:67], v11 offset:6656
    s_waitcnt lgkmcnt(9)
    ds_read_b128 v[68:71], v11 offset:9216
    ds_read_b128 v[72:75], v11 offset:9472
    ds_read_b128 v[76:79], v11 offset:9728
    v_max_f32 v176, v16, v20
    v_max3_f32 v176, v176, v24, v28
    v_sub_f32 v16, v16, v176
    v_sub_f32 v20, v20, v176
    v_sub_f32 v24, v24, v176
    v_sub_f32 v28, v28, v176
    v_exp_f32 v16, v16
    v_exp_f32 v20, v20
    v_exp_f32 v24, v24
    v_exp_f32 v28, v28
    v_mov_b32 v163, v10
    v_mov_b32 v167, v10
    v_mov_b32 v171, v10
    v_mov_b32 v175, v10
    v_mov_b32 v179, v10
    v_mul_f32 v177, v16, v17
    v_mul_f32 v178, v16, v18
    v_fmac_f32 v177, v20, v21
    v_fmac_f32 v178, v20, v22
    v_fmac_f32 v177, v24, v25
    v_fmac_f32 v178, v24, v26
    v_fmac_f32 v177, v28, v29
    v_fmac_f32 v178, v28, v30
    s_waitcnt lgkmcnt(9)
    v_fma_f32 v160, v32, v16, -v178
    v_fma_f32 v161, v33, v16, -v178
    v_fma_f32 v162, v34, v16, -v178
    v_fma_f32 v164, v35, v16, -v178
    v_fma_f32 v165, v36, v16, -v178
    v_fma_f32 v166, v37, v16, -v178
    v_fma_f32 v168, v38, v16, -v178
    v_fma_f32 v169, v39, v16, -v178
    v_fma_f32 v170, v40, v16, -v178
    v_fma_f32 v172, v41, v16, -v178
    v_fma_f32 v173, v42, v16, -v178
    v_fma_f32 v174, v43, v16, -v178
    s_waitcnt lgkmcnt(6)
    v_fmac_f32 v160, v44, v20
    v_fmac_f32 v161, v45, v20
    v_fmac_f32 v162, v46, v20
    v_fmac_f32 v164, v47, v20
    v_fmac_f32 v165, v48, v20
    v_fmac_f32 v166, v49, v20
    v_fmac_f32 v168, v50, v20
    v_fmac_f32 v169, v51, v20
    v_fmac_f32 v170, v52, v20
    v_fmac_f32 v172, v53, v20
    v_fmac_f32 v173, v54, v20
    v_fmac_f32 v174, v55, v20
    s_waitcnt lgkmcnt(3)
    v_fmac_f32 v160, v56, v24
    v_fmac_f32 v161, v57, v24
    v_fmac_f32 v162, v58, v24
    v_fmac_f32 v164, v59, v24
    v_fmac_f32 v165, v60, v24
    v_fmac_f32 v166, v61, v24
    v_fmac_f32 v168, v62, v24
    v_fmac_f32 v169, v63, v24
    v_fmac_f32 v170, v64, v24
    v_fmac_f32 v172, v65, v24
    v_fmac_f32 v173, v66, v24
    v_fmac_f32 v174, v67, v24
    s_waitcnt lgkmcnt(0)
    v_fmac_f32 v160, v68, v28
    v_fmac_f32 v161, v69, v28
    v_fmac_f32 v162, v70, v28
    v_fmac_f32 v164, v71, v28
    v_fmac_f32 v165, v72, v28
    v_fmac_f32 v166, v73, v28
    v_fmac_f32 v168, v74, v28
    v_fmac_f32 v169, v75, v28
    v_fmac_f32 v170, v76, v28
    v_fmac_f32 v172, v77, v28
    v_fmac_f32 v173, v78, v28
    v_fmac_f32 v174, v79, v28
    s_movk_i32 s69, 46
L_fb6:
    s_barrier
    s_sub_u32 s69, s69, 1
    s_cmp_lg_u32 s69, 0
    s_cbranch_scc1 L_fb6
    s_add_u32 s58, s62, 4352
    s_add_u32 s59, s62, 8448
    buffer_store_dwordx4 v[140:143], v9, s[24:27], s58 offen offset:0 sc1
    buffer_store_dwordx4 v[144:147], v9, s[24:27], s58 offen offset:1024 sc1
    buffer_store_dwordx4 v[148:151], v9, s[24:27], s58 offen offset:2048 sc1
    buffer_store_dwordx4 v[152:155], v9, s[24:27], s58 offen offset:3072 sc1
    s_mov_b32 exec_lo, 0x00010001
    s_mov_b32 exec_hi, 0x00010001
    buffer_store_dwordx4 v[156:159], v14, s[24:27], s59 offen sc1
    s_mov_b64 exec, -1
    s_add_u32 s58, s62, 13056
    s_add_u32 s59, s62, 17152
    buffer_store_dwordx4 v[160:163], v9, s[24:27], s58 offen offset:0 sc1
    buffer_store_dwordx4 v[164:167], v9, s[24:27], s58 offen offset:1024 sc1
    buffer_store_dwordx4 v[168:171], v9, s[24:27], s58 offen offset:2048 sc1
    buffer_store_dwordx4 v[172:175], v9, s[24:27], s58 offen offset:3072 sc1
    s_mov_b32 exec_lo, 0x00010001
    s_mov_b32 exec_hi, 0x00010001
    buffer_store_dwordx4 v[176:179], v14, s[24:27], s59 offen sc1
    s_mov_b64 exec, -1
    s_barrier
    s_add_u32 s58, s68, 0
    s_add_u32 s59, s68, 4096
    buffer_load_dwordx4 v[96:99], v14, s[24:27], s59 offen sc1
    buffer_load_dwordx4 v[80:83], v9, s[24:27], s58 offen offset:0 sc1
    buffer_load_dwordx4 v[84:87], v9, s[24:27], s58 offen offset:1024 sc1
    buffer_load_dwordx4 v[88:91], v9, s[24:27], s58 offen offset:2048 sc1
    buffer_load_dwordx4 v[92:95], v9, s[24:27], s58 offen offset:3072 sc1
    s_add_u32 s58, s68, 8704
    s_add_u32 s59, s68, 12800
    buffer_load_dwordx4 v[136:139], v14, s[24:27], s59 offen sc1
    buffer_load_dwordx4 v[120:123], v9, s[24:27], s58 offen offset:0 sc1
    buffer_load_dwordx4 v[124:127], v9, s[24:27], s58 offen offset:1024 sc1
    buffer_load_dwordx4 v[128:131], v9, s[24:27], s58 offen offset:2048 sc1
    buffer_load_dwordx4 v[132:135], v9, s[24:27], s58 offen offset:3072 sc1
    s_barrier
    v_add_u32 v13, 142336, v14
    v_add_u32 v11, 142592, v8
    ds_read_b128 v[16:19], v13 offset:0
    ds_read_b128 v[20:23], v13 offset:64
    ds_read_b128 v[24:27], v13 offset:128
    ds_read_b128 v[28:31], v13 offset:192
    ds_read_b128 v[32:35], v11 offset:0
    ds_read_b128 v[36:39], v11 offset:256
    ds_read_b128 v[40:43], v11 offset:512
    ds_read_b128 v[44:47], v11 offset:3072
    ds_read_b128 v[48:51], v11 offset:3328
    ds_read_b128 v[52:55], v11 offset:3584
    ds_read_b128 v[56:59], v11 offset:6144
    ds_read_b128 v[60:63], v11 offset:6400
    ds_read_b128 v[64:67], v11 offset:6656
    s_waitcnt lgkmcnt(9)
    ds_read_b128 v[68:71], v11 offset:9216
    ds_read_b128 v[72:75], v11 offset:9472
    ds_read_b128 v[76:79], v11 offset:9728
    v_max_f32 v116, v16, v20
    v_max3_f32 v116, v116, v24, v28
    v_sub_f32 v16, v16, v116
    v_sub_f32 v20, v20, v116
    v_sub_f32 v24, v24, v116
    v_sub_f32 v28, v28, v116
    v_exp_f32 v16, v16
    v_exp_f32 v20, v20
    v_exp_f32 v24, v24
    v_exp_f32 v28, v28
    v_mov_b32 v103, v10
    v_mov_b32 v107, v10
    v_mov_b32 v111, v10
    v_mov_b32 v115, v10
    v_mov_b32 v119, v10
    v_mul_f32 v117, v16, v17
    v_mul_f32 v118, v16, v18
    v_fmac_f32 v117, v20, v21
    v_fmac_f32 v118, v20, v22
    v_fmac_f32 v117, v24, v25
    v_fmac_f32 v118, v24, v26
    v_fmac_f32 v117, v28, v29
    v_fmac_f32 v118, v28, v30
    s_waitcnt lgkmcnt(9)
    v_fma_f32 v100, v32, v16, -v118
    v_fma_f32 v101, v33, v16, -v118
    v_fma_f32 v102, v34, v16, -v118
    v_fma_f32 v104, v35, v16, -v118
    v_fma_f32 v105, v36, v16, -v118
    v_fma_f32 v106, v37, v16, -v118
    v_fma_f32 v108, v38, v16, -v118
    v_fma_f32 v109, v39, v16, -v118
    v_fma_f32 v110, v40, v16, -v118
    v_fma_f32 v112, v41, v16, -v118
    v_fma_f32 v113, v42, v16, -v118
    v_fma_f32 v114, v43, v16, -v118
    s_waitcnt lgkmcnt(6)
    v_fmac_f32 v100, v44, v20
    v_fmac_f32 v101, v45, v20
    v_fmac_f32 v102, v46, v20
    v_fmac_f32 v104, v47, v20
    v_fmac_f32 v105, v48, v20
    v_fmac_f32 v106, v49, v20
    v_fmac_f32 v108, v50, v20
    v_fmac_f32 v109, v51, v20
    v_fmac_f32 v110, v52, v20
    v_fmac_f32 v112, v53, v20
    v_fmac_f32 v113, v54, v20
    v_fmac_f32 v114, v55, v20
    s_waitcnt lgkmcnt(3)
    v_fmac_f32 v100, v56, v24
    v_fmac_f32 v101, v57, v24
    v_fmac_f32 v102, v58, v24
    v_fmac_f32 v104, v59, v24
    v_fmac_f32 v105, v60, v24
    v_fmac_f32 v106, v61, v24
    v_fmac_f32 v108, v62, v24
    v_fmac_f32 v109, v63, v24
    v_fmac_f32 v110, v64, v24
    v_fmac_f32 v112, v65, v24
    v_fmac_f32 v113, v66, v24
    v_fmac_f32 v114, v67, v24
    s_waitcnt lgkmcnt(0)
    v_fmac_f32 v100, v68, v28
    v_fmac_f32 v101, v69, v28
    v_fmac_f32 v102, v70, v28
    v_fmac_f32 v104, v71, v28
    v_fmac_f32 v105, v72, v28
    v_fmac_f32 v106, v73, v28
    v_fmac_f32 v108, v74, v28
    v_fmac_f32 v109, v75, v28
    v_fmac_f32 v110, v76, v28
    v_fmac_f32 v112, v77, v28
    v_fmac_f32 v113, v78, v28
    v_fmac_f32 v114, v79, v28
    s_waitcnt vmcnt(0)
    buffer_load_dword v15, v7, s[24:27], s62 offen sc1
    v_xor_b32 v13, v10, v83
    v_xor_b32 v11, v10, v87
    v_or_b32 v13, v13, v11
    v_xor_b32 v11, v10, v91
    v_or_b32 v13, v13, v11
    v_xor_b32 v11, v10, v95
    v_or_b32 v13, v13, v11
    v_xor_b32 v11, v10, v99
    v_or_b32 v13, v13, v11
    v_xor_b32 v11, v10, v123
    v_or_b32 v13, v13, v11
    v_xor_b32 v11, v10, v127
    v_or_b32 v13, v13, v11
    v_xor_b32 v11, v10, v131
    v_or_b32 v13, v13, v11
    v_xor_b32 v11, v10, v135
    v_or_b32 v13, v13, v11
    v_xor_b32 v11, v10, v139
    v_or_b32 v13, v13, v11
    v_cmp_ne_u32 vcc, 0, v13
    s_nop 4
    s_cmp_eq_u64 vcc, 0
    s_cbranch_scc1 L_fm1
    s_add_u32 s58, s68, 4352
    s_add_u32 s59, s68, 8448
    buffer_store_dwordx4 v[100:103], v9, s[24:27], s58 offen offset:0 sc1
    buffer_store_dwordx4 v[104:107], v9, s[24:27], s58 offen offset:1024 sc1
    buffer_store_dwordx4 v[108:111], v9, s[24:27], s58 offen offset:2048 sc1
    buffer_store_dwordx4 v[112:115], v9, s[24:27], s58 offen offset:3072 sc1
    s_mov_b32 exec_lo, 0x00010001
    s_mov_b32 exec_hi, 0x00010001
    buffer_store_dwordx4 v[116:119], v14, s[24:27], s59 offen sc1
    s_mov_b64 exec, -1
    s_waitcnt vmcnt(0)
    s_add_u32 s58, s68, 0
    s_add_u32 s59, s68, 4096
    buffer_load_dwordx4 v[96:99], v14, s[24:27], s59 offen sc1
    buffer_load_dwordx4 v[80:83], v9, s[24:27], s58 offen offset:0 sc1
    buffer_load_dwordx4 v[84:87], v9, s[24:27], s58 offen offset:1024 sc1
    buffer_load_dwordx4 v[88:91], v9, s[24:27], s58 offen offset:2048 sc1
    buffer_load_dwordx4 v[92:95], v9, s[24:27], s58 offen offset:3072 sc1
    s_add_u32 s58, s68, 8704
    s_add_u32 s59, s68, 12800
    buffer_load_dwordx4 v[136:139], v14, s[24:27], s59 offen sc1
    buffer_load_dwordx4 v[120:123], v9, s[24:27], s58 offen offset:0 sc1
    buffer_load_dwordx4 v[124:127], v9, s[24:27], s58 offen offset:1024 sc1
    buffer_load_dwordx4 v[128:131], v9, s[24:27], s58 offen offset:2048 sc1
    buffer_load_dwordx4 v[132:135], v9, s[24:27], s58 offen offset:3072 sc1
    s_waitcnt vmcnt(0)
    v_xor_b32 v13, v10, v83
    v_xor_b32 v11, v10, v87
    v_or_b32 v13, v13, v11
    v_xor_b32 v11, v10, v91
    v_or_b32 v13, v13, v11
    v_xor_b32 v11, v10, v95
    v_or_b32 v13, v13, v11
    v_xor_b32 v11, v10, v99
    v_or_b32 v13, v13, v11
    v_xor_b32 v11, v10, v123
    v_or_b32 v13, v13, v11
    v_xor_b32 v11, v10, v127
    v_or_b32 v13, v13, v11
    v_xor_b32 v11, v10, v131
    v_or_b32 v13, v13, v11
    v_xor_b32 v11, v10, v135
    v_or_b32 v13, v13, v11
    v_xor_b32 v11, v10, v139
    v_or_b32 v13, v13, v11
    v_cmp_ne_u32 vcc, 0, v13
    s_nop 4
    s_cmp_eq_u64 vcc, 0
    s_cbranch_scc0 L_fm2
L_fm1:
    v_max3_f32 v11, v96, v116, v136
    v_sub_f32 v16, v96, v11
    v_sub_f32 v17, v116, v11
    v_sub_f32 v18, v136, v11
    v_exp_f32 v16, v16
    v_exp_f32 v17, v17
    v_exp_f32 v18, v18
    v_lshrrev_b32 v13, 1, v8
    v_mul_f32 v12, v16, v97
    v_fmac_f32 v12, v17, v117
    v_fmac_f32 v12, v18, v137
    v_rcp_f32 v12, v12
    s_add_u32 s58, s100, 171
    s_mul_i32 s58, s58, 1536
    v_mul_f32 v16, v16, v12
    v_mul_f32 v17, v17, v12
    v_mul_f32 v18, v18, v12
    v_mul_f32 v32, v80, v16
    v_fmac_f32 v32, v100, v17
    v_fmac_f32 v32, v120, v18
    v_mul_f32 v33, v81, v16
    v_fmac_f32 v33, v101, v17
    v_fmac_f32 v33, v121, v18
    v_mul_f32 v34, v82, v16
    v_fmac_f32 v34, v102, v17
    v_fmac_f32 v34, v122, v18
    v_mul_f32 v35, v84, v16
    v_fmac_f32 v35, v104, v17
    v_fmac_f32 v35, v124, v18
    v_mul_f32 v36, v85, v16
    v_fmac_f32 v36, v105, v17
    v_fmac_f32 v36, v125, v18
    v_mul_f32 v37, v86, v16
    v_fmac_f32 v37, v106, v17
    v_fmac_f32 v37, v126, v18
    v_mul_f32 v38, v88, v16
    v_fmac_f32 v38, v108, v17
    v_fmac_f32 v38, v128, v18
    v_mul_f32 v39, v89, v16
    v_fmac_f32 v39, v109, v17
    v_fmac_f32 v39, v129, v18
    v_mul_f32 v40, v90, v16
    v_fmac_f32 v40, v110, v17
    v_fmac_f32 v40, v130, v18
    v_mul_f32 v41, v92, v16
    v_fmac_f32 v41, v112, v17
    v_fmac_f32 v41, v132, v18
    v_mul_f32 v42, v93, v16
    v_fmac_f32 v42, v113, v17
    v_fmac_f32 v42, v133, v18
    v_mul_f32 v43, v94, v16
    v_fmac_f32 v43, v114, v17
    v_fmac_f32 v43, v134, v18
    v_cvt_pk_bf16_f32 v44, v32, v33
    v_cvt_pk_bf16_f32 v45, v34, v35
    v_cvt_pk_bf16_f32 v46, v36, v37
    v_cvt_pk_bf16_f32 v47, v38, v39
    v_cvt_pk_bf16_f32 v48, v40, v41
    v_cvt_pk_bf16_f32 v49, v42, v43
    buffer_store_dwordx2 v[44:45], v13, s[48:51], s58 offen offset:0
    buffer_store_dwordx2 v[46:47], v13, s[48:51], s58 offen offset:128
    buffer_store_dwordx2 v[48:49], v13, s[48:51], s58 offen offset:256
    s_waitcnt vmcnt(3)
L_fm2:
    v_cmp_eq_u32 vcc, v15, v10
    s_nop 4
    s_and_b32 s70, vcc_lo, 3
    s_cbranch_scc0 L_fin
    s_bitcmp1_b32 s70, 0
    s_cbranch_scc0 L_fm30
    s_waitcnt vmcnt(0)
    s_add_u32 s58, s62, 0
    s_add_u32 s59, s62, 4096
    buffer_load_dwordx4 v[96:99], v14, s[24:27], s59 offen sc1
    buffer_load_dwordx4 v[80:83], v9, s[24:27], s58 offen offset:0 sc1
    buffer_load_dwordx4 v[84:87], v9, s[24:27], s58 offen offset:1024 sc1
    buffer_load_dwordx4 v[88:91], v9, s[24:27], s58 offen offset:2048 sc1
    buffer_load_dwordx4 v[92:95], v9, s[24:27], s58 offen offset:3072 sc1
    s_waitcnt vmcnt(0)
    v_xor_b32 v13, v10, v83
    v_xor_b32 v11, v10, v87
    v_or_b32 v13, v13, v11
    v_xor_b32 v11, v10, v91
    v_or_b32 v13, v13, v11
    v_xor_b32 v11, v10, v95
    v_or_b32 v13, v13, v11
    v_xor_b32 v11, v10, v99
    v_or_b32 v13, v13, v11
    v_cmp_ne_u32 vcc, 0, v13
    s_nop 4
    s_cmp_eq_u64 vcc, 0
    s_cbranch_scc0 L_fm30
    v_max_f32 v11, v96, v156
    v_sub_f32 v16, v96, v11
    v_sub_f32 v17, v156, v11
    v_exp_f32 v16, v16
    v_exp_f32 v17, v17
    v_lshrrev_b32 v13, 1, v8
    v_mul_f32 v12, v16, v97
    v_fmac_f32 v12, v17, v157
    v_rcp_f32 v12, v12
    s_add_u32 s58, s63, 0
    s_mul_i32 s58, s58, 1536
    v_mul_f32 v16, v16, v12
    v_mul_f32 v17, v17, v12
    v_mul_f32 v32, v80, v16
    v_fmac_f32 v32, v140, v17
    v_mul_f32 v33, v81, v16
    v_fmac_f32 v33, v141, v17
    v_mul_f32 v34, v82, v16
    v_fmac_f32 v34, v142, v17
    v_mul_f32 v35, v84, v16
    v_fmac_f32 v35, v144, v17
    v_mul_f32 v36, v85, v16
    v_fmac_f32 v36, v145, v17
    v_mul_f32 v37, v86, v16
    v_fmac_f32 v37, v146, v17
    v_mul_f32 v38, v88, v16
    v_fmac_f32 v38, v148, v17
    v_mul_f32 v39, v89, v16
    v_fmac_f32 v39, v149, v17
    v_mul_f32 v40, v90, v16
    v_fmac_f32 v40, v150, v17
    v_mul_f32 v41, v92, v16
    v_fmac_f32 v41, v152, v17
    v_mul_f32 v42, v93, v16
    v_fmac_f32 v42, v153, v17
    v_mul_f32 v43, v94, v16
    v_fmac_f32 v43, v154, v17
    v_cvt_pk_bf16_f32 v44, v32, v33
    v_cvt_pk_bf16_f32 v45, v34, v35
    v_cvt_pk_bf16_f32 v46, v36, v37
    v_cvt_pk_bf16_f32 v47, v38, v39
    v_cvt_pk_bf16_f32 v48, v40, v41
    v_cvt_pk_bf16_f32 v49, v42, v43
    buffer_store_dwordx2 v[44:45], v13, s[48:51], s58 offen offset:0
    buffer_store_dwordx2 v[46:47], v13, s[48:51], s58 offen offset:128
    buffer_store_dwordx2 v[48:49], v13, s[48:51], s58 offen offset:256
L_fm30:
    s_bitcmp1_b32 s70, 1
    s_cbranch_scc0 L_fm31
    s_waitcnt vmcnt(0)
    s_add_u32 s58, s62, 8704
    s_add_u32 s59, s62, 12800
    buffer_load_dwordx4 v[96:99], v14, s[24:27], s59 offen sc1
    buffer_load_dwordx4 v[80:83], v9, s[24:27], s58 offen offset:0 sc1
    buffer_load_dwordx4 v[84:87], v9, s[24:27], s58 offen offset:1024 sc1
    buffer_load_dwordx4 v[88:91], v9, s[24:27], s58 offen offset:2048 sc1
    buffer_load_dwordx4 v[92:95], v9, s[24:27], s58 offen offset:3072 sc1
    s_waitcnt vmcnt(0)
    v_xor_b32 v13, v10, v83
    v_xor_b32 v11, v10, v87
    v_or_b32 v13, v13, v11
    v_xor_b32 v11, v10, v91
    v_or_b32 v13, v13, v11
    v_xor_b32 v11, v10, v95
    v_or_b32 v13, v13, v11
    v_xor_b32 v11, v10, v99
    v_or_b32 v13, v13, v11
    v_cmp_ne_u32 vcc, 0, v13
    s_nop 4
    s_cmp_eq_u64 vcc, 0
    s_cbranch_scc0 L_fm31
    v_max_f32 v11, v96, v176
    v_sub_f32 v16, v96, v11
    v_sub_f32 v17, v176, v11
    v_exp_f32 v16, v16
    v_exp_f32 v17, v17
    v_lshrrev_b32 v13, 1, v8
    v_mul_f32 v12, v16, v97
    v_fmac_f32 v12, v17, v177
    v_rcp_f32 v12, v12
    s_add_u32 s58, s63, 1
    s_mul_i32 s58, s58, 1536
    v_mul_f32 v16, v16, v12
    v_mul_f32 v17, v17, v12
    v_mul_f32 v32, v80, v16
    v_fmac_f32 v32, v160, v17
    v_mul_f32 v33, v81, v16
    v_fmac_f32 v33, v161, v17
    v_mul_f32 v34, v82, v16
    v_fmac_f32 v34, v162, v17
    v_mul_f32 v35, v84, v16
    v_fmac_f32 v35, v164, v17
    v_mul_f32 v36, v85, v16
    v_fmac_f32 v36, v165, v17
    v_mul_f32 v37, v86, v16
    v_fmac_f32 v37, v166, v17
    v_mul_f32 v38, v88, v16
    v_fmac_f32 v38, v168, v17
    v_mul_f32 v39, v89, v16
    v_fmac_f32 v39, v169, v17
    v_mul_f32 v40, v90, v16
    v_fmac_f32 v40, v170, v17
    v_mul_f32 v41, v92, v16
    v_fmac_f32 v41, v172, v17
    v_mul_f32 v42, v93, v16
    v_fmac_f32 v42, v173, v17
    v_mul_f32 v43, v94, v16
    v_fmac_f32 v43, v174, v17
    v_cvt_pk_bf16_f32 v44, v32, v33
    v_cvt_pk_bf16_f32 v45, v34, v35
    v_cvt_pk_bf16_f32 v46, v36, v37
    v_cvt_pk_bf16_f32 v47, v38, v39
    v_cvt_pk_bf16_f32 v48, v40, v41
    v_cvt_pk_bf16_f32 v49, v42, v43
    buffer_store_dwordx2 v[44:45], v13, s[48:51], s58 offen offset:0
    buffer_store_dwordx2 v[46:47], v13, s[48:51], s58 offen offset:128
    buffer_store_dwordx2 v[48:49], v13, s[48:51], s58 offen offset:256
L_fm31:
    s_branch L_fin
L_fsolo:
    s_movk_i32 s69, 129
L_fb7:
    s_barrier
    s_sub_u32 s69, s69, 1
    s_cmp_lg_u32 s69, 0
    s_cbranch_scc1 L_fb7
    v_add_u32 v13, 142336, v14
    v_add_u32 v11, 142592, v8
    ds_read_b128 v[16:19], v13 offset:0
    ds_read_b128 v[20:23], v13 offset:64
    ds_read_b128 v[24:27], v13 offset:128
    ds_read_b128 v[28:31], v13 offset:192
    ds_read_b128 v[32:35], v11 offset:0
    ds_read_b128 v[36:39], v11 offset:256
    ds_read_b128 v[40:43], v11 offset:512
    ds_read_b128 v[44:47], v11 offset:3072
    ds_read_b128 v[48:51], v11 offset:3328
    ds_read_b128 v[52:55], v11 offset:3584
    ds_read_b128 v[56:59], v11 offset:6144
    ds_read_b128 v[60:63], v11 offset:6400
    ds_read_b128 v[64:67], v11 offset:6656
    s_waitcnt lgkmcnt(9)
    ds_read_b128 v[68:71], v11 offset:9216
    ds_read_b128 v[72:75], v11 offset:9472
    ds_read_b128 v[76:79], v11 offset:9728
    v_max_f32 v96, v16, v20
    v_max3_f32 v96, v96, v24, v28
    v_sub_f32 v16, v16, v96
    v_sub_f32 v20, v20, v96
    v_sub_f32 v24, v24, v96
    v_sub_f32 v28, v28, v96
    v_exp_f32 v16, v16
    v_exp_f32 v20, v20
    v_exp_f32 v24, v24
    v_exp_f32 v28, v28
    v_mov_b32 v83, v10
    v_mov_b32 v87, v10
    v_mov_b32 v91, v10
    v_mov_b32 v95, v10
    v_mov_b32 v99, v10
    v_mul_f32 v97, v16, v17
    v_mul_f32 v98, v16, v18
    v_fmac_f32 v97, v20, v21
    v_fmac_f32 v98, v20, v22
    v_fmac_f32 v97, v24, v25
    v_fmac_f32 v98, v24, v26
    v_fmac_f32 v97, v28, v29
    v_fmac_f32 v98, v28, v30
    s_waitcnt lgkmcnt(9)
    v_fma_f32 v80, v32, v16, -v98
    v_fma_f32 v81, v33, v16, -v98
    v_fma_f32 v82, v34, v16, -v98
    v_fma_f32 v84, v35, v16, -v98
    v_fma_f32 v85, v36, v16, -v98
    v_fma_f32 v86, v37, v16, -v98
    v_fma_f32 v88, v38, v16, -v98
    v_fma_f32 v89, v39, v16, -v98
    v_fma_f32 v90, v40, v16, -v98
    v_fma_f32 v92, v41, v16, -v98
    v_fma_f32 v93, v42, v16, -v98
    v_fma_f32 v94, v43, v16, -v98
    s_waitcnt lgkmcnt(6)
    v_fmac_f32 v80, v44, v20
    v_fmac_f32 v81, v45, v20
    v_fmac_f32 v82, v46, v20
    v_fmac_f32 v84, v47, v20
    v_fmac_f32 v85, v48, v20
    v_fmac_f32 v86, v49, v20
    v_fmac_f32 v88, v50, v20
    v_fmac_f32 v89, v51, v20
    v_fmac_f32 v90, v52, v20
    v_fmac_f32 v92, v53, v20
    v_fmac_f32 v93, v54, v20
    v_fmac_f32 v94, v55, v20
    s_waitcnt lgkmcnt(3)
    v_fmac_f32 v80, v56, v24
    v_fmac_f32 v81, v57, v24
    v_fmac_f32 v82, v58, v24
    v_fmac_f32 v84, v59, v24
    v_fmac_f32 v85, v60, v24
    v_fmac_f32 v86, v61, v24
    v_fmac_f32 v88, v62, v24
    v_fmac_f32 v89, v63, v24
    v_fmac_f32 v90, v64, v24
    v_fmac_f32 v92, v65, v24
    v_fmac_f32 v93, v66, v24
    v_fmac_f32 v94, v67, v24
    s_waitcnt lgkmcnt(0)
    v_fmac_f32 v80, v68, v28
    v_fmac_f32 v81, v69, v28
    v_fmac_f32 v82, v70, v28
    v_fmac_f32 v84, v71, v28
    v_fmac_f32 v85, v72, v28
    v_fmac_f32 v86, v73, v28
    v_fmac_f32 v88, v74, v28
    v_fmac_f32 v89, v75, v28
    v_fmac_f32 v90, v76, v28
    v_fmac_f32 v92, v77, v28
    v_fmac_f32 v93, v78, v28
    v_fmac_f32 v94, v79, v28
    v_max_f32 v11, v96, v96
    v_sub_f32 v16, v96, v11
    v_exp_f32 v16, v16
    v_lshrrev_b32 v13, 1, v8
    v_mul_f32 v12, v16, v97
    v_rcp_f32 v12, v12
    s_add_u32 s58, s63, 0
    s_mul_i32 s58, s58, 1536
    v_mul_f32 v16, v16, v12
    v_mul_f32 v32, v80, v16
    v_mul_f32 v33, v81, v16
    v_mul_f32 v34, v82, v16
    v_mul_f32 v35, v84, v16
    v_mul_f32 v36, v85, v16
    v_mul_f32 v37, v86, v16
    v_mul_f32 v38, v88, v16
    v_mul_f32 v39, v89, v16
    v_mul_f32 v40, v90, v16
    v_mul_f32 v41, v92, v16
    v_mul_f32 v42, v93, v16
    v_mul_f32 v43, v94, v16
    v_cvt_pk_bf16_f32 v44, v32, v33
    v_cvt_pk_bf16_f32 v45, v34, v35
    v_cvt_pk_bf16_f32 v46, v36, v37
    v_cvt_pk_bf16_f32 v47, v38, v39
    v_cvt_pk_bf16_f32 v48, v40, v41
    v_cvt_pk_bf16_f32 v49, v42, v43
    buffer_store_dwordx2 v[44:45], v13, s[48:51], s58 offen offset:0
    buffer_store_dwordx2 v[46:47], v13, s[48:51], s58 offen offset:128
    buffer_store_dwordx2 v[48:49], v13, s[48:51], s58 offen offset:256
L_fin:
L_end:
    s_endpgm
.section .rodata,"a"
.p2align 6
.amdhsa_kernel standalone__kv_cache_quant_int4_int2_kv_with_per_channel_or_per_token_scales__sampling_kernel
  .amdhsa_next_free_vgpr 224
  .amdhsa_next_free_sgpr 102
  .amdhsa_accum_offset 224
  .amdhsa_group_segment_fixed_size 0
  .amdhsa_kernarg_size 80
  .amdhsa_user_sgpr_count 2
  .amdhsa_user_sgpr_kernarg_segment_ptr 1
  .amdhsa_system_sgpr_workgroup_id_x 1
  .amdhsa_float_denorm_mode_32 3
.end_amdhsa_kernel
```

```asm
; @launch grid=(256,1,1) block=(448,1,1) lds=154944
.amdgcn_target "amdgcn-amd-amdhsa--gfx950"
.text
.globl standalone__kv_cache_quant_int4_int2_kv_with_per_channel_or_per_token_scales__sampling_kernel
.p2align 8
.type standalone__kv_cache_quant_int4_int2_kv_with_per_channel_or_per_token_scales__sampling_kernel,@function
standalone__kv_cache_quant_int4_int2_kv_with_per_channel_or_per_token_scales__sampling_kernel:
    s_cmp_ge_u32 s2, 256
    s_cbranch_scc1 L_end
    s_load_dwordx16 s[4:19], s[0:1], 0
    s_load_dwordx4 s[20:23], s[0:1], 64
    v_lshrrev_b32 v2, 6, v0
    v_and_b32 v1, 63, v0
    v_readfirstlane_b32 s56, v2
    s_mov_b32 s67, 768
    s_mul_i32 s100, s2, 43691
    s_lshr_b32 s100, s100, 17
    s_mul_i32 s101, s100, 3
    s_sub_u32 s101, s2, s101
    s_cmp_eq_u32 s2, 255
    s_cselect_b32 s73, 16, 11
    s_cmp_eq_u32 s101, 1
    s_cselect_b32 s3, 5, s73
    s_cselect_b32 s73, 10, s73
    s_mul_i32 s58, s101, 21
    s_add_u32 s58, s58, 1
    s_lshr_b32 s58, s58, 1
    s_lshl_b32 s59, s100, 5
    s_add_u32 s57, s58, s59
    s_mul_i32 s58, s101, 11
    s_lshr_b32 s58, s58, 1
    s_lshl_b32 s59, s100, 4
    s_add_u32 s58, s58, s59
    s_add_u32 s58, s58, 2736
    s_sub_u32 s58, s58, s73
    v_cmp_le_u32 vcc, s73, v1
    v_add_u32 v3, s57, v1
    v_add_u32 v4, s58, v1
    v_cndmask_b32 v152, v3, v4, vcc
    s_cmp_eq_u32 s56, 4
    s_cbranch_scc0 L_roles
    s_setprio 3
    v_add_u32 v17, 0, v1
    v_mul_u32_u24 v22, 1366, v17
    v_bfe_u32 v11, v22, 16, 1
    v_lshrrev_b32 v14, 17, v22
    v_mul_u32_u24 v22, 31488, v14
    v_lshl_add_u32 v17, v17, 4, v22
    v_mov_b32 v8, v17
    v_add_u32 v18, 64, v1
    v_mul_u32_u24 v22, 1366, v18
    v_bfe_u32 v12, v22, 16, 1
    v_lshrrev_b32 v15, 17, v22
    v_mul_u32_u24 v22, 31488, v15
    v_lshl_add_u32 v18, v18, 4, v22
    v_mov_b32 v9, v18
    v_add_u32 v19, 128, v1
    v_mul_u32_u24 v22, 1366, v19
    v_bfe_u32 v13, v22, 16, 1
    v_lshrrev_b32 v16, 17, v22
    v_mul_u32_u24 v22, 31488, v16
    v_lshl_add_u32 v19, v19, 4, v22
    v_mov_b32 v10, v19
    s_mov_b32 s68, 0
    s_mov_b32 m0, 0
    s_movk_i32 s71, 1024
    s_mul_i32 s57, s57, 196608
    s_mov_b32 s84, 0x400000
    s_mov_b32 s85, 0x800
    s_movk_i32 s86, 1536
    s_mov_b32 s70, 18
    s_mov_b32 s74, 0
    v_mov_b32 v20, 4710
    v_mov_b32 v21, 154880
    ds_write_b32 v21, v20
    s_waitcnt lgkmcnt(0)
    s_mov_b32 s24, s6
    s_and_b32 s25, s7, 0xffff
    s_mov_b32 s26, 805306368
    s_mov_b32 s27, 0x20000
L_lw16:
    s_waitcnt vmcnt(16)
L_lw17:
    s_waitcnt vmcnt(17)
L_lw18:
    s_waitcnt vmcnt(18)
L_lw19:
    s_waitcnt vmcnt(19)
L_lw20:
    s_waitcnt vmcnt(20)
    buffer_load_dwordx4 v17, s[24:27], s57 offen nt lds
    s_add_u32 m0, m0, s71
    s_add_u32 s68, s68, 1
    s_and_b32 s58, s68, 63
    s_cmp_ge_u32 s58, 43
    s_cselect_b32 s69, -768, 0
    buffer_load_dwordx4 v18, s[24:27], s57 offen nt lds
    s_add_u32 m0, m0, s71
    s_cmp_eq_u32 s58, 21
    s_cselect_b32 s62, 33024, 0
    v_mad_u32_u24 v17, v11, s62, v8
    s_bitcmp1_b64 s[84:85], s58
    s_cselect_b32 s63, 34560, s86
    buffer_load_dwordx4 v19, s[24:27], s57 offen nt lds
    s_add_u32 m0, m0, s71
    s_add_u32 s57, s57, s63
    v_mad_i32_i24 v22, v15, s69, v9
    v_mad_u32_u24 v18, v12, s62, v22
    v_mad_i32_i24 v22, v16, s69, v10
    v_mad_u32_u24 v19, v13, s62, v22
    s_and_b32 s59, s68, 7
    s_cbranch_scc0 L_lunit
L_lad:
    s_cmp_eq_u32 s70, 20
    s_cbranch_scc1 L_lw20
    s_cmp_eq_u32 s70, 19
    s_cbranch_scc1 L_lw19
    s_cmp_eq_u32 s70, 18
    s_cbranch_scc1 L_lw18
    s_cmp_eq_u32 s70, 17
    s_cbranch_scc1 L_lw17
    s_branch L_lw16
L_lunit:
    s_waitcnt vmcnt(24)
    s_cmp_le_u32 s68, 16
    s_cbranch_scc1 L_lfirst
L_lbar:
    s_barrier
L_lnobar:
    s_waitcnt lgkmcnt(0)
    v_readfirstlane_b32 s59, v20
    ds_read_b32 v20, v21
    s_cmp_eq_u32 m0, 73728
    s_cselect_b32 m0, 0, m0
    s_and_b32 s74, s74, 255
    s_add_u32 s74, s74, s59
    s_lshr_b32 s70, s74, 8
    s_cmp_eq_u32 s58, 0
    s_cbranch_scc1 L_lblock
L_lsel:
    s_cmp_le_u32 s70, 20
    s_cbranch_scc1 L_lad
    s_cmp_le_u32 s70, 22
    s_cbranch_scc1 L_lad21
    s_cmp_le_u32 s70, 24
    s_cbranch_scc1 L_lad23
    s_branch L_lad25
L_lblock:
    s_bfe_u32 s58, s68, 262150
    v_readlane_b32 s57, v152, s58
    s_nop 3
    s_mul_i32 s57, s57, 196608
    s_cmp_eq_u32 s58, 0
    s_cbranch_scc0 L_lsel
    s_cmp_eq_u32 s68, 2048
    s_cbranch_scc1 L_ldone
    s_mov_b32 s24, s8
    s_and_b32 s25, s9, 0xffff
    s_branch L_lsel
L_lfirst:
    s_cmp_eq_u32 s68, 8
    s_cbranch_scc1 L_lnobar
    s_barrier
    s_branch L_lbar
L_ldone:
    s_waitcnt vmcnt(0)
    s_barrier
    s_endpgm
L_lw21:
    s_waitcnt vmcnt(21)
L_lw22:
    s_waitcnt vmcnt(22)
    buffer_load_dwordx4 v17, s[24:27], s57 offen nt lds
    s_add_u32 m0, m0, s71
    s_add_u32 s68, s68, 1
    s_and_b32 s58, s68, 63
    s_cmp_ge_u32 s58, 43
    s_cselect_b32 s69, -768, 0
    buffer_load_dwordx4 v18, s[24:27], s57 offen nt lds
    s_add_u32 m0, m0, s71
    s_cmp_eq_u32 s58, 21
    s_cselect_b32 s62, 33024, 0
    v_mad_u32_u24 v17, v11, s62, v8
    s_bitcmp1_b64 s[84:85], s58
    s_cselect_b32 s63, 34560, s86
    buffer_load_dwordx4 v19, s[24:27], s57 offen nt lds
    s_add_u32 m0, m0, s71
    s_add_u32 s57, s57, s63
    v_mad_i32_i24 v22, v15, s69, v9
    v_mad_u32_u24 v18, v12, s62, v22
    v_mad_i32_i24 v22, v16, s69, v10
    v_mad_u32_u24 v19, v13, s62, v22
    s_and_b32 s59, s68, 7
    s_cbranch_scc0 L_lunit
L_lad21:
    s_cmp_eq_u32 s70, 22
    s_cbranch_scc1 L_lw22
    s_branch L_lw21
L_lw23:
    s_waitcnt vmcnt(23)
L_lw24:
    s_waitcnt vmcnt(24)
    buffer_load_dwordx4 v17, s[24:27], s57 offen nt lds
    s_add_u32 m0, m0, s71
    s_add_u32 s68, s68, 1
    s_and_b32 s58, s68, 63
    s_cmp_ge_u32 s58, 43
    s_cselect_b32 s69, -768, 0
    buffer_load_dwordx4 v18, s[24:27], s57 offen nt lds
    s_add_u32 m0, m0, s71
    s_cmp_eq_u32 s58, 21
    s_cselect_b32 s62, 33024, 0
    v_mad_u32_u24 v17, v11, s62, v8
    s_bitcmp1_b64 s[84:85], s58
    s_cselect_b32 s63, 34560, s86
    buffer_load_dwordx4 v19, s[24:27], s57 offen nt lds
    s_add_u32 m0, m0, s71
    s_add_u32 s57, s57, s63
    v_mad_i32_i24 v22, v15, s69, v9
    v_mad_u32_u24 v18, v12, s62, v22
    v_mad_i32_i24 v22, v16, s69, v10
    v_mad_u32_u24 v19, v13, s62, v22
    s_and_b32 s59, s68, 7
    s_cbranch_scc0 L_lunit
L_lad23:
    s_cmp_eq_u32 s70, 24
    s_cbranch_scc1 L_lw24
    s_branch L_lw23
L_lw25:
    s_waitcnt vmcnt(25)
    buffer_load_dwordx4 v17, s[24:27], s57 offen nt lds
    s_add_u32 m0, m0, s71
    s_add_u32 s68, s68, 1
    s_and_b32 s58, s68, 63
    s_cmp_ge_u32 s58, 43
    s_cselect_b32 s69, -768, 0
    buffer_load_dwordx4 v18, s[24:27], s57 offen nt lds
    s_add_u32 m0, m0, s71
    s_cmp_eq_u32 s58, 21
    s_cselect_b32 s62, 33024, 0
    v_mad_u32_u24 v17, v11, s62, v8
    s_bitcmp1_b64 s[84:85], s58
    s_cselect_b32 s63, 34560, s86
    buffer_load_dwordx4 v19, s[24:27], s57 offen nt lds
    s_add_u32 m0, m0, s71
    s_add_u32 s57, s57, s63
    v_mad_i32_i24 v22, v15, s69, v9
    v_mad_u32_u24 v18, v12, s62, v22
    v_mad_i32_i24 v22, v16, s69, v10
    v_mad_u32_u24 v19, v13, s62, v22
    s_and_b32 s59, s68, 7
    s_cbranch_scc0 L_lunit
L_lad25:
    s_branch L_lw25
L_roles:
    s_cmp_lt_u32 s56, 4
    s_cbranch_scc1 L_consumer
    s_cmp_eq_u32 s56, 5
    s_cbranch_scc1 L_finisher
    s_sub_u32 s58, s2, 16
    s_cmp_lt_u32 s58, 8
    s_cbranch_scc0 L_pw
    s_getpc_b64 s[44:45]
L_pc:
    s_and_b32 s45, s45, 0xffff
    s_mov_b32 s46, L_end - L_pc
    s_mov_b32 s47, 0x20000
    v_lshlrev_b32 v9, 7, v1
    s_movk_i32 s58, 0
    buffer_load_dword v12, v9, s[44:47], s58 offen
    s_movk_i32 s58, 8192
    buffer_load_dword v13, v9, s[44:47], s58 offen
    s_movk_i32 s58, 16384
    buffer_load_dword v14, v9, s[44:47], s58 offen
    s_movk_i32 s58, 24576
    buffer_load_dword v15, v9, s[44:47], s58 offen
L_pw:
    s_waitcnt lgkmcnt(0)
    s_mov_b32 s52, s22
    s_and_b32 s53, s23, 0xffff
    s_mov_b32 s54, 16793888
    s_mov_b32 s55, 0x20000
    s_mov_b32 s71, 0
    s_add_u32 s98, s22, 16777216
    s_addc_u32 s99, s23, 0
    s_min_u32 s58, s2, 16
    s_lshr_b32 s61, 0x926d, s58
    s_and_b32 s61, s61, 1
    s_and_b32 s59, s2, 7
    s_mul_i32 s59, s59, 4
    s_add_u32 s59, s59, 16777216
    v_mov_b32 v8, s59
    v_mov_b32 v10, 154880
    s_mov_b32 s96, 0
    s_mov_b64 exec, 1
    s_barrier
    s_mov_b32 s63, 0
L_pace:
    s_barrier
    s_mov_b32 s62, s96
    s_memrealtime s[96:97]
    s_waitcnt lgkmcnt(0)
    s_cmp_eq_u32 s63, 0
    s_cbranch_scc1 L_pnext
    s_mov_b32 s58, 0
    s_sub_i32 s59, s84, s62
    s_add_i32 s60, s59, 5000
    s_cmp_lt_u32 s60, 10000
    s_cselect_b32 s59, s59, 200
    s_add_i32 s58, s58, s59
    s_sub_i32 s59, s85, s62
    s_add_i32 s60, s59, 5000
    s_cmp_lt_u32 s60, 10000
    s_cselect_b32 s59, s59, 200
    s_add_i32 s58, s58, s59
    s_sub_i32 s59, s86, s62
    s_add_i32 s60, s59, 5000
    s_cmp_lt_u32 s60, 10000
    s_cselect_b32 s59, s59, 200
    s_add_i32 s58, s58, s59
    s_sub_i32 s59, s87, s62
    s_add_i32 s60, s59, 5000
    s_cmp_lt_u32 s60, 10000
    s_cselect_b32 s59, s59, 200
    s_add_i32 s58, s58, s59
    s_sub_i32 s59, s88, s62
    s_add_i32 s60, s59, 5000
    s_cmp_lt_u32 s60, 10000
    s_cselect_b32 s59, s59, 200
    s_add_i32 s58, s58, s59
    s_sub_i32 s59, s89, s62
    s_add_i32 s60, s59, 5000
    s_cmp_lt_u32 s60, 10000
    s_cselect_b32 s59, s59, 200
    s_add_i32 s58, s58, s59
    s_sub_i32 s59, s90, s62
    s_add_i32 s60, s59, 5000
    s_cmp_lt_u32 s60, 10000
    s_cselect_b32 s59, s59, 200
    s_add_i32 s58, s58, s59
    s_sub_i32 s59, s91, s62
    s_add_i32 s60, s59, 5000
    s_cmp_lt_u32 s60, 10000
    s_cselect_b32 s59, s59, 200
    s_add_i32 s58, s58, s59
    s_min_u32 s59, s63, 12
    s_cmp_gt_i32 s58, 0
    s_cselect_b32 s63, s59, s63
    s_mul_i32 s58, s58, s63
    s_ashr_i32 s58, s58, 5
    s_sub_i32 s58, 4710, s58
    s_max_i32 s58, s58, 4096
    s_min_i32 s70, s58, 6400
    v_mov_b32 v9, s70
    ds_write_b32 v10, v9
L_pnext:
    s_and_b32 s58, s71, 768
    s_cselect_b32 s63, 0, 5
    s_cmp_ge_u32 s71, 14848
    s_cselect_b32 s63, 24, s63
    s_mul_i32 s58, s63, s61
    s_cmp_eq_u32 s58, 0
    s_cbranch_scc1 L_pnorep
    v_mov_b32 v11, s96
    buffer_store_dword v11, v8, s[52:55], s71 offen sc1
L_pnorep:
    s_barrier
    s_barrier
    s_barrier
    s_cmp_eq_u32 s63, 0
    s_cbranch_scc1 L_pnold
    s_load_dwordx8 s[84:91], s[98:99], s71
L_pnold:
    s_add_u32 s71, s71, 256
    s_cmp_lt_u32 s71, 16384
    s_cbranch_scc1 L_pace
    s_waitcnt lgkmcnt(0)
    s_mov_b64 exec, -1
    s_endpgm
L_consumer:
    v_lshrrev_b32 v3, 2, v1
    v_lshlrev_b32 v3, 3, v3
    v_and_b32 v4, 3, v1
    v_mul_u32_u24 v5, 384, v4
    v_add_u32 v15, v3, v5
    v_lshlrev_b32 v13, 4, v1
    s_mul_i32 s63, s56, 3072
    s_add_u32 s63, s63, 76800
    s_add_u32 s58, s56, 0
    v_readlane_b32 s84, v152, s58
    s_add_u32 s58, s56, 4
    v_readlane_b32 s85, v152, s58
    s_add_u32 s58, s56, 8
    v_readlane_b32 s86, v152, s58
    s_add_u32 s58, s56, 12
    v_readlane_b32 s87, v152, s58
    v_readlane_b32 s88, v152, 0
    s_min_u32 s58, s3, 15
    v_readlane_b32 s89, v152, s58
    v_readlane_b32 s90, v152, 15
    s_waitcnt lgkmcnt(0)
    s_mov_b32 s32, s12
    s_and_b32 s33, s13, 0xffff
    s_mov_b32 s34, 6291456
    s_mov_b32 s35, 0x20000
    s_mov_b32 s28, s10
    s_and_b32 s29, s11, 0xffff
    s_mov_b32 s30, 6291456
    s_mov_b32 s31, 0x20000
    s_mov_b32 exec_hi, 0xffff
    s_add_u32 m0, s63, 0
    s_mul_i32 s58, s84, 1536
    buffer_load_dwordx4 v13, s[32:35], s58 offen nt lds
    buffer_load_dwordx4 v13, s[32:35], s58 offen offset:768 nt lds
    s_add_u32 m0, m0, 1536
    s_nop 0
    buffer_load_dwordx4 v13, s[28:31], s58 offen nt lds
    buffer_load_dwordx4 v13, s[28:31], s58 offen offset:768 nt lds
    s_mov_b32 exec_hi, -1
    s_mov_b32 s44, s4
    s_and_b32 s45, s5, 0xffff
    s_mov_b32 s46, 393216
    s_mov_b32 s47, 0x20000
    s_lshr_b32 s58, s88, 4
    s_mul_i32 s58, s58, 1536
    buffer_load_dwordx2 v[156:157], v15, s[44:47], s58 offen offset:0 nt
    buffer_load_dwordx2 v[158:159], v15, s[44:47], s58 offen offset:128 nt
    buffer_load_dwordx2 v[160:161], v15, s[44:47], s58 offen offset:256 nt
    s_mov_b32 s64, 0x3fb8aa3b
    s_mov_b32 s65, 0x3d93cd3a
    s_mov_b32 s66, 0xffff0000
    v_bfe_u32 v36, v1, 2, 1
    v_lshl_add_u32 v36, v2, 2, v36
    v_bfe_u32 v37, v1, 3, 1
    v_lshrrev_b32 v38, 4, v1
    v_lshl_add_u32 v38, v38, 2, v4
    v_lshlrev_b32 v38, 3, v38
    v_add_u32 v38, 73728, v38
    s_movk_i32 s58, 384
    v_add_u32 v3, 0, v36
    v_cmp_le_u32 vcc, 43, v3
    v_add_u32 v5, 43, v3
    v_mov_b32 v6, 42
    v_cndmask_b32 v17, v3, v5, vcc
    v_cmp_le_u32 vcc, 86, v3
    v_add_u32 v5, 43, v17
    s_nop 0
    v_cndmask_b32 v17, v17, v5, vcc
    v_cndmask_b32 v6, 43, v6, vcc
    v_mad_u32_u24 v17, v6, v37, v17
    v_lshrrev_b32 v17, 6, v17
    v_mad_u32_u24 v17, v17, s58, v38
    v_add_u32 v3, 2, v36
    v_cmp_le_u32 vcc, 43, v3
    v_add_u32 v5, 43, v3
    v_mov_b32 v6, 42
    v_cndmask_b32 v18, v3, v5, vcc
    v_cmp_le_u32 vcc, 86, v3
    v_add_u32 v5, 43, v18
    s_nop 0
    v_cndmask_b32 v18, v18, v5, vcc
    v_cndmask_b32 v6, 43, v6, vcc
    v_mad_u32_u24 v18, v6, v37, v18
    v_lshrrev_b32 v18, 6, v18
    v_mad_u32_u24 v18, v18, s58, v38
    v_add_u32 v3, 16, v36
    v_cmp_le_u32 vcc, 43, v3
    v_add_u32 v5, 43, v3
    v_mov_b32 v6, 42
    v_cndmask_b32 v19, v3, v5, vcc
    v_cmp_le_u32 vcc, 86, v3
    v_add_u32 v5, 43, v19
    s_nop 0
    v_cndmask_b32 v19, v19, v5, vcc
    v_cndmask_b32 v6, 43, v6, vcc
    v_mad_u32_u24 v19, v6, v37, v19
    v_lshrrev_b32 v19, 6, v19
    v_mad_u32_u24 v19, v19, s58, v38
    v_add_u32 v3, 18, v36
    v_cmp_le_u32 vcc, 43, v3
    v_add_u32 v5, 43, v3
    v_mov_b32 v6, 42
    v_cndmask_b32 v20, v3, v5, vcc
    v_cmp_le_u32 vcc, 86, v3
    v_add_u32 v5, 43, v20
    s_nop 0
    v_cndmask_b32 v20, v20, v5, vcc
    v_cndmask_b32 v6, 43, v6, vcc
    v_mad_u32_u24 v20, v6, v37, v20
    v_lshrrev_b32 v20, 6, v20
    v_mad_u32_u24 v20, v20, s58, v38
    v_add_u32 v3, 32, v36
    v_cmp_le_u32 vcc, 43, v3
    v_add_u32 v5, 43, v3
    v_mov_b32 v6, 42
    v_cndmask_b32 v21, v3, v5, vcc
    v_cmp_le_u32 vcc, 86, v3
    v_add_u32 v5, 43, v21
    s_nop 0
    v_cndmask_b32 v21, v21, v5, vcc
    v_cndmask_b32 v6, 43, v6, vcc
    v_mad_u32_u24 v21, v6, v37, v21
    v_lshrrev_b32 v21, 6, v21
    v_mad_u32_u24 v21, v21, s58, v38
    v_add_u32 v3, 34, v36
    v_cmp_le_u32 vcc, 43, v3
    v_add_u32 v5, 43, v3
    v_mov_b32 v6, 42
    v_cndmask_b32 v22, v3, v5, vcc
    v_cmp_le_u32 vcc, 86, v3
    v_add_u32 v5, 43, v22
    s_nop 0
    v_cndmask_b32 v22, v22, v5, vcc
    v_cndmask_b32 v6, 43, v6, vcc
    v_mad_u32_u24 v22, v6, v37, v22
    v_lshrrev_b32 v22, 6, v22
    v_mad_u32_u24 v22, v22, s58, v38
    v_add_u32 v3, 48, v36
    v_cmp_le_u32 vcc, 43, v3
    v_add_u32 v5, 43, v3
    v_mov_b32 v6, 42
    v_cndmask_b32 v23, v3, v5, vcc
    v_cmp_le_u32 vcc, 86, v3
    v_add_u32 v5, 43, v23
    s_nop 0
    v_cndmask_b32 v23, v23, v5, vcc
    v_cndmask_b32 v6, 43, v6, vcc
    v_mad_u32_u24 v23, v6, v37, v23
    v_lshrrev_b32 v23, 6, v23
    v_mad_u32_u24 v23, v23, s58, v38
    v_add_u32 v3, 50, v36
    v_cmp_le_u32 vcc, 43, v3
    v_add_u32 v5, 43, v3
    v_mov_b32 v6, 42
    v_cndmask_b32 v24, v3, v5, vcc
    v_cmp_le_u32 vcc, 86, v3
    v_add_u32 v5, 43, v24
    s_nop 0
    v_cndmask_b32 v24, v24, v5, vcc
    v_cndmask_b32 v6, 43, v6, vcc
    v_mad_u32_u24 v24, v6, v37, v24
    v_lshrrev_b32 v24, 6, v24
    v_mad_u32_u24 v24, v24, s58, v38
    v_add_u32 v3, 64, v36
    v_cmp_le_u32 vcc, 43, v3
    v_add_u32 v5, 43, v3
    v_mov_b32 v6, 42
    v_cndmask_b32 v25, v3, v5, vcc
    v_cmp_le_u32 vcc, 86, v3
    v_add_u32 v5, 43, v25
    s_nop 0
    v_cndmask_b32 v25, v25, v5, vcc
    v_cndmask_b32 v6, 43, v6, vcc
    v_mad_u32_u24 v25, v6, v37, v25
    v_lshrrev_b32 v25, 6, v25
    v_mad_u32_u24 v25, v25, s58, v38
    v_add_u32 v3, 66, v36
    v_cmp_le_u32 vcc, 43, v3
    v_add_u32 v5, 43, v3
    v_mov_b32 v6, 42
    v_cndmask_b32 v26, v3, v5, vcc
    v_cmp_le_u32 vcc, 86, v3
    v_add_u32 v5, 43, v26
    s_nop 0
    v_cndmask_b32 v26, v26, v5, vcc
    v_cndmask_b32 v6, 43, v6, vcc
    v_mad_u32_u24 v26, v6, v37, v26
    v_lshrrev_b32 v26, 6, v26
    v_mad_u32_u24 v26, v26, s58, v38
    v_add_u32 v3, 80, v36
    v_cmp_le_u32 vcc, 43, v3
    v_add_u32 v5, 43, v3
    v_mov_b32 v6, 42
    v_cndmask_b32 v27, v3, v5, vcc
    v_cmp_le_u32 vcc, 86, v3
    v_add_u32 v5, 43, v27
    s_nop 0
    v_cndmask_b32 v27, v27, v5, vcc
    v_cndmask_b32 v6, 43, v6, vcc
    v_mad_u32_u24 v27, v6, v37, v27
    v_lshrrev_b32 v27, 6, v27
    v_mad_u32_u24 v27, v27, s58, v38
    v_add_u32 v3, 82, v36
    v_cmp_le_u32 vcc, 43, v3
    v_add_u32 v5, 43, v3
    v_mov_b32 v6, 42
    v_cndmask_b32 v28, v3, v5, vcc
    v_cmp_le_u32 vcc, 86, v3
    v_add_u32 v5, 43, v28
    s_nop 0
    v_cndmask_b32 v28, v28, v5, vcc
    v_cndmask_b32 v6, 43, v6, vcc
    v_mad_u32_u24 v28, v6, v37, v28
    v_lshrrev_b32 v28, 6, v28
    v_mad_u32_u24 v28, v28, s58, v38
    v_add_u32 v3, 96, v36
    v_cmp_le_u32 vcc, 43, v3
    v_add_u32 v5, 43, v3
    v_mov_b32 v6, 42
    v_cndmask_b32 v29, v3, v5, vcc
    v_cmp_le_u32 vcc, 86, v3
    v_add_u32 v5, 43, v29
    s_nop 0
    v_cndmask_b32 v29, v29, v5, vcc
    v_cndmask_b32 v6, 43, v6, vcc
    v_mad_u32_u24 v29, v6, v37, v29
    v_lshrrev_b32 v29, 6, v29
    v_mad_u32_u24 v29, v29, s58, v38
    v_add_u32 v3, 98, v36
    v_cmp_le_u32 vcc, 43, v3
    v_add_u32 v5, 43, v3
    v_mov_b32 v6, 42
    v_cndmask_b32 v30, v3, v5, vcc
    v_cmp_le_u32 vcc, 86, v3
    v_add_u32 v5, 43, v30
    s_nop 0
    v_cndmask_b32 v30, v30, v5, vcc
    v_cndmask_b32 v6, 43, v6, vcc
    v_mad_u32_u24 v30, v6, v37, v30
    v_lshrrev_b32 v30, 6, v30
    v_mad_u32_u24 v30, v30, s58, v38
    v_add_u32 v3, 112, v36
    v_cmp_le_u32 vcc, 43, v3
    v_add_u32 v5, 43, v3
    v_mov_b32 v6, 42
    v_cndmask_b32 v31, v3, v5, vcc
    v_cmp_le_u32 vcc, 86, v3
    v_add_u32 v5, 43, v31
    s_nop 0
    v_cndmask_b32 v31, v31, v5, vcc
    v_cndmask_b32 v6, 43, v6, vcc
    v_mad_u32_u24 v31, v6, v37, v31
    v_lshrrev_b32 v31, 6, v31
    v_mad_u32_u24 v31, v31, s58, v38
    v_add_u32 v3, 114, v36
    v_cmp_le_u32 vcc, 43, v3
    v_add_u32 v5, 43, v3
    v_mov_b32 v6, 42
    v_cndmask_b32 v32, v3, v5, vcc
    v_cmp_le_u32 vcc, 86, v3
    v_add_u32 v5, 43, v32
    s_nop 0
    v_cndmask_b32 v32, v32, v5, vcc
    v_cndmask_b32 v6, 43, v6, vcc
    v_mad_u32_u24 v32, v6, v37, v32
    v_lshrrev_b32 v32, 6, v32
    v_mad_u32_u24 v32, v32, s58, v38
    v_bfe_u32 v36, v1, 4, 1
    v_lshl_add_u32 v36, v2, 2, v36
    v_bfe_u32 v3, v1, 2, 2
    v_lshl_add_u32 v36, v3, 4, v36
    v_lshrrev_b32 v37, 5, v1
    s_mov_b32 s58, 125952
    v_add_u32 v3, 0, v36
    v_cmp_le_u32 vcc, 43, v3
    v_add_u32 v5, 43, v3
    v_mov_b32 v6, 42
    v_cndmask_b32 v7, v3, v5, vcc
    v_cmp_le_u32 vcc, 86, v3
    v_add_u32 v5, 43, v7
    s_nop 0
    v_cndmask_b32 v7, v7, v5, vcc
    v_cndmask_b32 v6, 43, v6, vcc
    v_mad_u32_u24 v7, v6, v37, v7
    v_lshl_add_u32 v7, v7, 1, s58
    v_add_u32 v3, 2, v36
    v_cmp_le_u32 vcc, 43, v3
    v_add_u32 v5, 43, v3
    v_mov_b32 v6, 42
    v_cndmask_b32 v8, v3, v5, vcc
    v_cmp_le_u32 vcc, 86, v3
    v_add_u32 v5, 43, v8
    s_nop 0
    v_cndmask_b32 v8, v8, v5, vcc
    v_cndmask_b32 v6, 43, v6, vcc
    v_mad_u32_u24 v8, v6, v37, v8
    v_lshl_add_u32 v8, v8, 1, s58
    v_add_u32 v3, 64, v36
    v_cmp_le_u32 vcc, 43, v3
    v_add_u32 v5, 43, v3
    v_mov_b32 v6, 42
    v_cndmask_b32 v9, v3, v5, vcc
    v_cmp_le_u32 vcc, 86, v3
    v_add_u32 v5, 43, v9
    s_nop 0
    v_cndmask_b32 v9, v9, v5, vcc
    v_cndmask_b32 v6, 43, v6, vcc
    v_mad_u32_u24 v9, v6, v37, v9
    v_lshl_add_u32 v9, v9, 1, s58
    v_add_u32 v3, 66, v36
    v_cmp_le_u32 vcc, 43, v3
    v_add_u32 v5, 43, v3
    v_mov_b32 v6, 42
    v_cndmask_b32 v10, v3, v5, vcc
    v_cmp_le_u32 vcc, 86, v3
    v_add_u32 v5, 43, v10
    s_nop 0
    v_cndmask_b32 v10, v10, v5, vcc
    v_cndmask_b32 v6, 43, v6, vcc
    v_mad_u32_u24 v10, v6, v37, v10
    v_lshl_add_u32 v10, v10, 1, s58
    v_lshlrev_b32 v11, 2, v1
    v_lshl_add_u32 v11, v2, 9, v11
    v_add_u32 v11, 73728, v11
    v_bfe_u32 v3, v1, 2, 2
    v_lshrrev_b32 v4, 4, v1
    v_and_b32 v5, 3, v1
    v_lshl_add_u32 v4, v4, 2, v5
    v_lshl_add_u32 v3, v2, 3, v3
    v_mul_u32_u24 v3, 768, v3
    v_lshl_add_u32 v12, v4, 4, v3
    v_mov_b32 v14, 0xff800000
    s_mov_b32 exec_hi, 0xffff
    s_add_u32 m0, s63, 12288
    s_mul_i32 s58, s85, 1536
    buffer_load_dwordx4 v13, s[32:35], s58 offen nt lds
    buffer_load_dwordx4 v13, s[32:35], s58 offen offset:768 nt lds
    s_add_u32 m0, m0, 1536
    s_nop 0
    buffer_load_dwordx4 v13, s[28:31], s58 offen nt lds
    buffer_load_dwordx4 v13, s[28:31], s58 offen offset:768 nt lds
    s_add_u32 m0, s63, 24576
    s_mul_i32 s58, s86, 1536
    buffer_load_dwordx4 v13, s[32:35], s58 offen nt lds
    buffer_load_dwordx4 v13, s[32:35], s58 offen offset:768 nt lds
    s_add_u32 m0, m0, 1536
    s_nop 0
    buffer_load_dwordx4 v13, s[28:31], s58 offen nt lds
    buffer_load_dwordx4 v13, s[28:31], s58 offen offset:768 nt lds
    s_add_u32 m0, s63, 36864
    s_mul_i32 s58, s87, 1536
    buffer_load_dwordx4 v13, s[32:35], s58 offen nt lds
    buffer_load_dwordx4 v13, s[32:35], s58 offen offset:768 nt lds
    s_add_u32 m0, m0, 1536
    s_nop 0
    buffer_load_dwordx4 v13, s[28:31], s58 offen nt lds
    buffer_load_dwordx4 v13, s[28:31], s58 offen offset:768 nt lds
    s_mov_b32 exec_hi, -1
    s_mov_b32 s36, s14
    s_and_b32 s37, s15, 0xffff
    s_mov_b32 s38, 2097152
    s_mov_b32 s39, 0x20000
    s_mov_b32 s40, s16
    s_and_b32 s41, s17, 0xffff
    s_mov_b32 s42, 2097152
    s_mov_b32 s43, 0x20000
    s_mov_b32 exec_hi, 0
    s_lshl_b32 s60, s56, 10
    s_add_u32 m0, s60, 125952
    s_lshl_b32 s58, s84, 9
    buffer_load_dwordx4 v13, s[36:39], s58 offen nt lds
    s_add_u32 m0, m0, 512
    s_nop 0
    buffer_load_dwordx4 v13, s[40:43], s58 offen nt lds
    s_add_u32 m0, s60, 130048
    s_lshl_b32 s58, s85, 9
    buffer_load_dwordx4 v13, s[36:39], s58 offen nt lds
    s_add_u32 m0, m0, 512
    s_nop 0
    buffer_load_dwordx4 v13, s[40:43], s58 offen nt lds
    s_add_u32 m0, s60, 134144
    s_lshl_b32 s58, s86, 9
    buffer_load_dwordx4 v13, s[36:39], s58 offen nt lds
    s_add_u32 m0, m0, 512
    s_nop 0
    buffer_load_dwordx4 v13, s[40:43], s58 offen nt lds
    s_add_u32 m0, s60, 138240
    s_lshl_b32 s58, s87, 9
    buffer_load_dwordx4 v13, s[36:39], s58 offen nt lds
    s_add_u32 m0, m0, 512
    s_nop 0
    buffer_load_dwordx4 v13, s[40:43], s58 offen nt lds
    s_mov_b32 exec_hi, -1
    s_lshr_b32 s58, s89, 4
    s_mul_i32 s58, s58, 1536
    buffer_load_dwordx2 v[162:163], v15, s[44:47], s58 offen offset:0 nt
    buffer_load_dwordx2 v[164:165], v15, s[44:47], s58 offen offset:128 nt
    buffer_load_dwordx2 v[166:167], v15, s[44:47], s58 offen offset:256 nt
    s_lshr_b32 s58, s90, 4
    s_mul_i32 s58, s58, 1536
    buffer_load_dwordx2 v[168:169], v15, s[44:47], s58 offen offset:0 nt
    buffer_load_dwordx2 v[170:171], v15, s[44:47], s58 offen offset:128 nt
    buffer_load_dwordx2 v[172:173], v15, s[44:47], s58 offen offset:256 nt
    s_mov_b32 s74, 0
    s_mov_b32 s61, 0
    s_mov_b32 s62, 0
    s_movk_i32 s63, 3072
    s_waitcnt vmcnt(26)
    s_barrier
    v_add_u32 v33, s63, v17
    v_add_u32 v34, s63, v18
    ds_read_b64 v[108:109], v33 offset:0
    ds_read_b64 v[110:111], v33 offset:1536
    ds_read_b64 v[112:113], v33 offset:128
    ds_read_b64 v[114:115], v33 offset:1664
    ds_read_b64 v[116:117], v33 offset:256
    ds_read_b64 v[118:119], v33 offset:1792
    ds_read_b64 v[120:121], v34 offset:0
    ds_read_b64 v[122:123], v34 offset:1536
    ds_read_b64 v[124:125], v34 offset:128
    ds_read_b64 v[126:127], v34 offset:1664
    ds_read_b64 v[128:129], v34 offset:256
    ds_read_b64 v[130:131], v34 offset:1792
    s_waitcnt lgkmcnt(0)
    v_lshlrev_b32 v60, 16, v108
    v_and_b32 v61, s66, v108
    v_lshlrev_b32 v62, 16, v109
    v_and_b32 v63, s66, v109
    v_lshlrev_b32 v84, 16, v110
    v_and_b32 v85, s66, v110
    v_lshlrev_b32 v86, 16, v111
    v_and_b32 v87, s66, v111
    v_lshlrev_b32 v64, 16, v112
    v_and_b32 v65, s66, v112
    v_lshlrev_b32 v66, 16, v113
    v_and_b32 v67, s66, v113
    v_lshlrev_b32 v88, 16, v114
    v_and_b32 v89, s66, v114
    v_lshlrev_b32 v90, 16, v115
    v_and_b32 v91, s66, v115
    v_lshlrev_b32 v68, 16, v116
    v_and_b32 v69, s66, v116
    v_lshlrev_b32 v70, 16, v117
    v_and_b32 v71, s66, v117
    v_lshlrev_b32 v92, 16, v118
    v_and_b32 v93, s66, v118
    v_lshlrev_b32 v94, 16, v119
    v_and_b32 v95, s66, v119
    v_lshlrev_b32 v72, 16, v120
    v_and_b32 v73, s66, v120
    v_lshlrev_b32 v74, 16, v121
    v_and_b32 v75, s66, v121
    v_lshlrev_b32 v96, 16, v122
    v_and_b32 v97, s66, v122
    v_lshlrev_b32 v98, 16, v123
    v_and_b32 v99, s66, v123
    v_lshlrev_b32 v76, 16, v124
    v_and_b32 v77, s66, v124
    v_lshlrev_b32 v78, 16, v125
    v_and_b32 v79, s66, v125
    v_lshlrev_b32 v100, 16, v126
    v_and_b32 v101, s66, v126
    v_lshlrev_b32 v102, 16, v127
    v_and_b32 v103, s66, v127
    v_lshlrev_b32 v80, 16, v128
    v_and_b32 v81, s66, v128
    v_lshlrev_b32 v82, 16, v129
    v_and_b32 v83, s66, v129
    v_lshlrev_b32 v104, 16, v130
    v_and_b32 v105, s66, v130
    v_lshlrev_b32 v106, 16, v131
    v_and_b32 v107, s66, v131
L_kblk:
    v_add_u32 v13, s62, v12
    s_add_u32 s62, s62, 24576
    s_cmp_eq_u32 s62, 73728
    s_cselect_b32 s62, 0, s62
    s_barrier
    ds_read_b128 v[36:39], v13 offset:0
    ds_read_b128 v[40:43], v13 offset:256
    ds_read_b128 v[44:47], v13 offset:512
    ds_read_b128 v[48:51], v13 offset:3072
    ds_read_b128 v[52:55], v13 offset:3328
    ds_read_b128 v[56:59], v13 offset:3584
    s_waitcnt lgkmcnt(3)
    v_cvt_f32_i32 v36, v36
    v_cvt_f32_i32 v37, v37
    v_cvt_f32_i32 v38, v38
    v_cvt_f32_i32 v39, v39
    v_cvt_f32_i32 v40, v40
    v_cvt_f32_i32 v41, v41
    v_cvt_f32_i32 v42, v42
    v_cvt_f32_i32 v43, v43
    v_cvt_f32_i32 v44, v44
    v_cvt_f32_i32 v45, v45
    v_cvt_f32_i32 v46, v46
    v_cvt_f32_i32 v47, v47
    v_sub_f32 v36, v36, v60
    v_sub_f32 v37, v37, v61
    v_sub_f32 v38, v38, v62
    v_sub_f32 v39, v39, v63
    v_sub_f32 v40, v40, v64
    v_sub_f32 v41, v41, v65
    v_sub_f32 v42, v42, v66
    v_sub_f32 v43, v43, v67
    v_sub_f32 v44, v44, v68
    v_sub_f32 v45, v45, v69
    v_sub_f32 v46, v46, v70
    v_sub_f32 v47, v47, v71
    v_cvt_pk_bf16_f32 v36, 0, v36
    v_cvt_pk_bf16_f32 v37, 0, v37
    v_cvt_pk_bf16_f32 v38, 0, v38
    v_cvt_pk_bf16_f32 v39, 0, v39
    v_cvt_pk_bf16_f32 v40, 0, v40
    v_cvt_pk_bf16_f32 v41, 0, v41
    v_cvt_pk_bf16_f32 v42, 0, v42
    v_cvt_pk_bf16_f32 v43, 0, v43
    v_cvt_pk_bf16_f32 v44, 0, v44
    v_cvt_pk_bf16_f32 v45, 0, v45
    v_cvt_pk_bf16_f32 v46, 0, v46
    v_cvt_pk_bf16_f32 v47, 0, v47
    v_mul_f32 v36, v36, v84
    v_mul_f32 v37, v37, v85
    v_mul_f32 v38, v38, v86
    v_mul_f32 v39, v39, v87
    v_mul_f32 v40, v40, v88
    v_mul_f32 v41, v41, v89
    v_mul_f32 v42, v42, v90
    v_mul_f32 v43, v43, v91
    v_mul_f32 v44, v44, v92
    v_mul_f32 v45, v45, v93
    v_mul_f32 v46, v46, v94
    v_mul_f32 v47, v47, v95
    v_cvt_pk_bf16_f32 v132, v36, v37
    v_cvt_pk_bf16_f32 v133, v38, v39
    v_cvt_pk_bf16_f32 v134, v40, v41
    v_cvt_pk_bf16_f32 v135, v42, v43
    v_cvt_pk_bf16_f32 v136, v44, v45
    v_cvt_pk_bf16_f32 v137, v46, v47
    v_mfma_f32_16x16x16_bf16 v[144:147], v[132:133], v[156:157], 0
    v_mfma_f32_16x16x16_bf16 v[144:147], v[134:135], v[158:159], v[144:147]
    v_mfma_f32_16x16x16_bf16 v[144:147], v[136:137], v[160:161], v[144:147]
    s_waitcnt lgkmcnt(0)
    v_cvt_f32_i32 v48, v48
    v_cvt_f32_i32 v49, v49
    v_cvt_f32_i32 v50, v50
    v_cvt_f32_i32 v51, v51
    v_cvt_f32_i32 v52, v52
    v_cvt_f32_i32 v53, v53
    v_cvt_f32_i32 v54, v54
    v_cvt_f32_i32 v55, v55
    v_cvt_f32_i32 v56, v56
    v_cvt_f32_i32 v57, v57
    v_cvt_f32_i32 v58, v58
    v_cvt_f32_i32 v59, v59
    v_sub_f32 v48, v48, v72
    v_sub_f32 v49, v49, v73
    v_sub_f32 v50, v50, v74
    v_sub_f32 v51, v51, v75
    v_sub_f32 v52, v52, v76
    v_sub_f32 v53, v53, v77
    v_sub_f32 v54, v54, v78
    v_sub_f32 v55, v55, v79
    v_sub_f32 v56, v56, v80
    v_sub_f32 v57, v57, v81
    v_sub_f32 v58, v58, v82
    v_sub_f32 v59, v59, v83
    v_cvt_pk_bf16_f32 v48, 0, v48
    v_cvt_pk_bf16_f32 v49, 0, v49
    v_cvt_pk_bf16_f32 v50, 0, v50
    v_cvt_pk_bf16_f32 v51, 0, v51
    v_cvt_pk_bf16_f32 v52, 0, v52
    v_cvt_pk_bf16_f32 v53, 0, v53
    v_cvt_pk_bf16_f32 v54, 0, v54
    v_cvt_pk_bf16_f32 v55, 0, v55
    v_cvt_pk_bf16_f32 v56, 0, v56
    v_cvt_pk_bf16_f32 v57, 0, v57
    v_cvt_pk_bf16_f32 v58, 0, v58
    v_cvt_pk_bf16_f32 v59, 0, v59
    v_mul_f32 v48, v48, v96
    v_mul_f32 v49, v49, v97
    v_mul_f32 v50, v50, v98
    v_mul_f32 v51, v51, v99
    v_mul_f32 v52, v52, v100
    v_mul_f32 v53, v53, v101
    v_mul_f32 v54, v54, v102
    v_mul_f32 v55, v55, v103
    v_mul_f32 v56, v56, v104
    v_mul_f32 v57, v57, v105
    v_mul_f32 v58, v58, v106
    v_mul_f32 v59, v59, v107
    v_cvt_pk_bf16_f32 v138, v48, v49
    v_cvt_pk_bf16_f32 v139, v50, v51
    v_add_f32_dpp v3, v145, v144 row_ror:12 row_mask:0xf bank_mask:0xf
    v_cvt_pk_bf16_f32 v140, v52, v53
    v_cvt_pk_bf16_f32 v141, v54, v55
    v_add_f32_dpp v3, v146, v3 row_ror:8 row_mask:0xf bank_mask:0xf
    v_cvt_pk_bf16_f32 v142, v56, v57
    v_cvt_pk_bf16_f32 v143, v58, v59
    v_add_f32_dpp v15, v147, v3 row_ror:4 row_mask:0xf bank_mask:0x1
    v_mfma_f32_16x16x16_bf16 v[148:151], v[138:139], v[156:157], 0
    v_mfma_f32_16x16x16_bf16 v[148:151], v[140:141], v[158:159], v[148:151]
    v_mfma_f32_16x16x16_bf16 v[148:151], v[142:143], v[160:161], v[148:151]
    v_add_u32 v33, s63, v19
    v_add_u32 v34, s63, v20
    ds_read_b64 v[108:109], v33 offset:0
    ds_read_b64 v[110:111], v33 offset:1536
    ds_read_b64 v[112:113], v33 offset:128
    ds_read_b64 v[114:115], v33 offset:1664
    ds_read_b64 v[116:117], v33 offset:256
    ds_read_b64 v[118:119], v33 offset:1792
    ds_read_b64 v[120:121], v34 offset:0
    v_add_f32_dpp v4, v149, v148 row_ror:12 row_mask:0xf bank_mask:0xf
    ds_read_b64 v[122:123], v34 offset:1536
    ds_read_b64 v[124:125], v34 offset:128
    v_add_f32_dpp v4, v150, v4 row_ror:8 row_mask:0xf bank_mask:0xf
    ds_read_b64 v[126:127], v34 offset:1664
    ds_read_b64 v[128:129], v34 offset:256
    ds_read_b64 v[130:131], v34 offset:1792
    v_add_f32_dpp v16, v151, v4 row_ror:4 row_mask:0xf bank_mask:0x1
    s_waitcnt lgkmcnt(0)
    v_lshlrev_b32 v60, 16, v108
    v_and_b32 v61, s66, v108
    v_lshlrev_b32 v62, 16, v109
    v_and_b32 v63, s66, v109
    v_lshlrev_b32 v84, 16, v110
    v_and_b32 v85, s66, v110
    v_lshlrev_b32 v86, 16, v111
    v_and_b32 v87, s66, v111
    v_lshlrev_b32 v64, 16, v112
    v_and_b32 v65, s66, v112
    v_lshlrev_b32 v66, 16, v113
    v_and_b32 v67, s66, v113
    v_lshlrev_b32 v88, 16, v114
    v_and_b32 v89, s66, v114
    v_lshlrev_b32 v90, 16, v115
    v_and_b32 v91, s66, v115
    v_lshlrev_b32 v68, 16, v116
    v_and_b32 v69, s66, v116
    v_lshlrev_b32 v70, 16, v117
    v_and_b32 v71, s66, v117
    v_lshlrev_b32 v92, 16, v118
    v_and_b32 v93, s66, v118
    v_lshlrev_b32 v94, 16, v119
    v_and_b32 v95, s66, v119
    v_lshlrev_b32 v72, 16, v120
    v_and_b32 v73, s66, v120
    v_lshlrev_b32 v74, 16, v121
    v_and_b32 v75, s66, v121
    v_lshlrev_b32 v96, 16, v122
    v_and_b32 v97, s66, v122
    v_lshlrev_b32 v98, 16, v123
    v_and_b32 v99, s66, v123
    v_lshlrev_b32 v76, 16, v124
    v_and_b32 v77, s66, v124
    v_lshlrev_b32 v78, 16, v125
    v_and_b32 v79, s66, v125
    v_lshlrev_b32 v100, 16, v126
    v_and_b32 v101, s66, v126
    v_lshlrev_b32 v102, 16, v127
    v_and_b32 v103, s66, v127
    v_lshlrev_b32 v80, 16, v128
    v_and_b32 v81, s66, v128
    v_lshlrev_b32 v82, 16, v129
    v_and_b32 v83, s66, v129
    v_lshlrev_b32 v104, 16, v130
    v_and_b32 v105, s66, v130
    v_lshlrev_b32 v106, 16, v131
    v_and_b32 v107, s66, v131
    v_add_u32 v13, s62, v12
    s_add_u32 s62, s62, 24576
    s_cmp_eq_u32 s62, 73728
    s_cselect_b32 s62, 0, s62
    s_barrier
    ds_read_b128 v[36:39], v13 offset:0
    ds_read_b128 v[40:43], v13 offset:256
    ds_read_b128 v[44:47], v13 offset:512
    ds_read_b128 v[48:51], v13 offset:3072
    ds_read_b128 v[52:55], v13 offset:3328
    ds_read_b128 v[56:59], v13 offset:3584
    s_waitcnt lgkmcnt(3)
    v_cvt_f32_i32 v36, v36
    v_cvt_f32_i32 v37, v37
    v_cvt_f32_i32 v38, v38
    v_cvt_f32_i32 v39, v39
    v_cvt_f32_i32 v40, v40
    v_cvt_f32_i32 v41, v41
    v_cvt_f32_i32 v42, v42
    v_cvt_f32_i32 v43, v43
    v_cvt_f32_i32 v44, v44
    v_cvt_f32_i32 v45, v45
    v_cvt_f32_i32 v46, v46
    v_cvt_f32_i32 v47, v47
    v_sub_f32 v36, v36, v60
    v_sub_f32 v37, v37, v61
    v_sub_f32 v38, v38, v62
    v_sub_f32 v39, v39, v63
    v_sub_f32 v40, v40, v64
    v_sub_f32 v41, v41, v65
    v_sub_f32 v42, v42, v66
    v_sub_f32 v43, v43, v67
    v_sub_f32 v44, v44, v68
    v_sub_f32 v45, v45, v69
    v_sub_f32 v46, v46, v70
    v_sub_f32 v47, v47, v71
    v_cvt_pk_bf16_f32 v36, 0, v36
    v_cvt_pk_bf16_f32 v37, 0, v37
    v_cvt_pk_bf16_f32 v38, 0, v38
    v_cvt_pk_bf16_f32 v39, 0, v39
    v_cvt_pk_bf16_f32 v40, 0, v40
    v_cvt_pk_bf16_f32 v41, 0, v41
    v_cvt_pk_bf16_f32 v42, 0, v42
    v_cvt_pk_bf16_f32 v43, 0, v43
    v_cvt_pk_bf16_f32 v44, 0, v44
    v_cvt_pk_bf16_f32 v45, 0, v45
    v_cvt_pk_bf16_f32 v46, 0, v46
    v_cvt_pk_bf16_f32 v47, 0, v47
    v_mul_f32 v36, v36, v84
    v_mul_f32 v37, v37, v85
    v_mul_f32 v38, v38, v86
    v_mul_f32 v39, v39, v87
    v_mul_f32 v40, v40, v88
    v_mul_f32 v41, v41, v89
    v_mul_f32 v42, v42, v90
    v_mul_f32 v43, v43, v91
    v_mul_f32 v44, v44, v92
    v_mul_f32 v45, v45, v93
    v_mul_f32 v46, v46, v94
    v_mul_f32 v47, v47, v95
    v_cvt_pk_bf16_f32 v132, v36, v37
    v_cvt_pk_bf16_f32 v133, v38, v39
    v_cvt_pk_bf16_f32 v134, v40, v41
    v_cvt_pk_bf16_f32 v135, v42, v43
    v_cvt_pk_bf16_f32 v136, v44, v45
    v_cvt_pk_bf16_f32 v137, v46, v47
    v_mfma_f32_16x16x16_bf16 v[144:147], v[132:133], v[156:157], 0
    v_mfma_f32_16x16x16_bf16 v[144:147], v[134:135], v[158:159], v[144:147]
    v_mfma_f32_16x16x16_bf16 v[144:147], v[136:137], v[160:161], v[144:147]
    s_waitcnt lgkmcnt(0)
    v_cvt_f32_i32 v48, v48
    v_cvt_f32_i32 v49, v49
    v_cvt_f32_i32 v50, v50
    v_cvt_f32_i32 v51, v51
    v_cvt_f32_i32 v52, v52
    v_cvt_f32_i32 v53, v53
    v_cvt_f32_i32 v54, v54
    v_cvt_f32_i32 v55, v55
    v_cvt_f32_i32 v56, v56
    v_cvt_f32_i32 v57, v57
    v_cvt_f32_i32 v58, v58
    v_cvt_f32_i32 v59, v59
    v_sub_f32 v48, v48, v72
    v_sub_f32 v49, v49, v73
    v_sub_f32 v50, v50, v74
    v_sub_f32 v51, v51, v75
    v_sub_f32 v52, v52, v76
    v_sub_f32 v53, v53, v77
    v_sub_f32 v54, v54, v78
    v_sub_f32 v55, v55, v79
    v_sub_f32 v56, v56, v80
    v_sub_f32 v57, v57, v81
    v_sub_f32 v58, v58, v82
    v_sub_f32 v59, v59, v83
    v_cvt_pk_bf16_f32 v48, 0, v48
    v_cvt_pk_bf16_f32 v49, 0, v49
    v_cvt_pk_bf16_f32 v50, 0, v50
    v_cvt_pk_bf16_f32 v51, 0, v51
    v_cvt_pk_bf16_f32 v52, 0, v52
    v_cvt_pk_bf16_f32 v53, 0, v53
    v_cvt_pk_bf16_f32 v54, 0, v54
    v_cvt_pk_bf16_f32 v55, 0, v55
    v_cvt_pk_bf16_f32 v56, 0, v56
    v_cvt_pk_bf16_f32 v57, 0, v57
    v_cvt_pk_bf16_f32 v58, 0, v58
    v_cvt_pk_bf16_f32 v59, 0, v59
    v_mul_f32 v48, v48, v96
    v_mul_f32 v49, v49, v97
    v_mul_f32 v50, v50, v98
    v_mul_f32 v51, v51, v99
    v_mul_f32 v52, v52, v100
    v_mul_f32 v53, v53, v101
    v_mul_f32 v54, v54, v102
    v_mul_f32 v55, v55, v103
    v_mul_f32 v56, v56, v104
    v_mul_f32 v57, v57, v105
    v_mul_f32 v58, v58, v106
    v_mul_f32 v59, v59, v107
    v_cvt_pk_bf16_f32 v138, v48, v49
    v_cvt_pk_bf16_f32 v139, v50, v51
    v_add_f32_dpp v3, v146, v145 row_ror:12 row_mask:0xf bank_mask:0xf
    v_cvt_pk_bf16_f32 v140, v52, v53
    v_cvt_pk_bf16_f32 v141, v54, v55
    v_add_f32_dpp v3, v147, v3 row_ror:8 row_mask:0xf bank_mask:0xf
    v_cvt_pk_bf16_f32 v142, v56, v57
    v_cvt_pk_bf16_f32 v143, v58, v59
    v_add_f32_dpp v15, v144, v3 row_ror:4 row_mask:0xf bank_mask:0x2
    v_mfma_f32_16x16x16_bf16 v[148:151], v[138:139], v[156:157], 0
    v_mfma_f32_16x16x16_bf16 v[148:151], v[140:141], v[158:159], v[148:151]
    v_mfma_f32_16x16x16_bf16 v[148:151], v[142:143], v[160:161], v[148:151]
    v_add_u32 v33, s63, v21
    v_add_u32 v34, s63, v22
    ds_read_b64 v[108:109], v33 offset:0
    ds_read_b64 v[110:111], v33 offset:1536
    ds_read_b64 v[112:113], v33 offset:128
    ds_read_b64 v[114:115], v33 offset:1664
    ds_read_b64 v[116:117], v33 offset:256
    ds_read_b64 v[118:119], v33 offset:1792
    ds_read_b64 v[120:121], v34 offset:0
    v_add_f32_dpp v4, v150, v149 row_ror:12 row_mask:0xf bank_mask:0xf
    ds_read_b64 v[122:123], v34 offset:1536
    ds_read_b64 v[124:125], v34 offset:128
    v_add_f32_dpp v4, v151, v4 row_ror:8 row_mask:0xf bank_mask:0xf
    ds_read_b64 v[126:127], v34 offset:1664
    ds_read_b64 v[128:129], v34 offset:256
    ds_read_b64 v[130:131], v34 offset:1792
    v_add_f32_dpp v16, v148, v4 row_ror:4 row_mask:0xf bank_mask:0x2
    s_waitcnt lgkmcnt(0)
    v_lshlrev_b32 v60, 16, v108
    v_and_b32 v61, s66, v108
    v_lshlrev_b32 v62, 16, v109
    v_and_b32 v63, s66, v109
    v_lshlrev_b32 v84, 16, v110
    v_and_b32 v85, s66, v110
    v_lshlrev_b32 v86, 16, v111
    v_and_b32 v87, s66, v111
    v_lshlrev_b32 v64, 16, v112
    v_and_b32 v65, s66, v112
    v_lshlrev_b32 v66, 16, v113
    v_and_b32 v67, s66, v113
    v_lshlrev_b32 v88, 16, v114
    v_and_b32 v89, s66, v114
    v_lshlrev_b32 v90, 16, v115
    v_and_b32 v91, s66, v115
    v_lshlrev_b32 v68, 16, v116
    v_and_b32 v69, s66, v116
    v_lshlrev_b32 v70, 16, v117
    v_and_b32 v71, s66, v117
    v_lshlrev_b32 v92, 16, v118
    v_and_b32 v93, s66, v118
    v_lshlrev_b32 v94, 16, v119
    v_and_b32 v95, s66, v119
    v_lshlrev_b32 v72, 16, v120
    v_and_b32 v73, s66, v120
    v_lshlrev_b32 v74, 16, v121
    v_and_b32 v75, s66, v121
    v_lshlrev_b32 v96, 16, v122
    v_and_b32 v97, s66, v122
    v_lshlrev_b32 v98, 16, v123
    v_and_b32 v99, s66, v123
    v_lshlrev_b32 v76, 16, v124
    v_and_b32 v77, s66, v124
    v_lshlrev_b32 v78, 16, v125
    v_and_b32 v79, s66, v125
    v_lshlrev_b32 v100, 16, v126
    v_and_b32 v101, s66, v126
    v_lshlrev_b32 v102, 16, v127
    v_and_b32 v103, s66, v127
    v_lshlrev_b32 v80, 16, v128
    v_and_b32 v81, s66, v128
    v_lshlrev_b32 v82, 16, v129
    v_and_b32 v83, s66, v129
    v_lshlrev_b32 v104, 16, v130
    v_and_b32 v105, s66, v130
    v_lshlrev_b32 v106, 16, v131
    v_and_b32 v107, s66, v131
    v_add_u32 v13, s62, v12
    s_add_u32 s62, s62, 24576
    s_cmp_eq_u32 s62, 73728
    s_cselect_b32 s62, 0, s62
    s_barrier
    ds_read_b128 v[36:39], v13 offset:0
    ds_read_b128 v[40:43], v13 offset:256
    ds_read_b128 v[44:47], v13 offset:512
    ds_read_b128 v[48:51], v13 offset:3072
    ds_read_b128 v[52:55], v13 offset:3328
    ds_read_b128 v[56:59], v13 offset:3584
    s_waitcnt lgkmcnt(3)
    v_cvt_f32_i32 v36, v36
    v_cvt_f32_i32 v37, v37
    v_cvt_f32_i32 v38, v38
    v_cvt_f32_i32 v39, v39
    v_cvt_f32_i32 v40, v40
    v_cvt_f32_i32 v41, v41
    v_cvt_f32_i32 v42, v42
    v_cvt_f32_i32 v43, v43
    v_cvt_f32_i32 v44, v44
    v_cvt_f32_i32 v45, v45
    v_cvt_f32_i32 v46, v46
    v_cvt_f32_i32 v47, v47
    v_sub_f32 v36, v36, v60
    v_sub_f32 v37, v37, v61
    v_sub_f32 v38, v38, v62
    v_sub_f32 v39, v39, v63
    v_sub_f32 v40, v40, v64
    v_sub_f32 v41, v41, v65
    v_sub_f32 v42, v42, v66
    v_sub_f32 v43, v43, v67
    v_sub_f32 v44, v44, v68
    v_sub_f32 v45, v45, v69
    v_sub_f32 v46, v46, v70
    v_sub_f32 v47, v47, v71
    v_cvt_pk_bf16_f32 v36, 0, v36
    v_cvt_pk_bf16_f32 v37, 0, v37
    v_cvt_pk_bf16_f32 v38, 0, v38
    v_cvt_pk_bf16_f32 v39, 0, v39
    v_cvt_pk_bf16_f32 v40, 0, v40
    v_cvt_pk_bf16_f32 v41, 0, v41
    v_cvt_pk_bf16_f32 v42, 0, v42
    v_cvt_pk_bf16_f32 v43, 0, v43
    v_cvt_pk_bf16_f32 v44, 0, v44
    v_cvt_pk_bf16_f32 v45, 0, v45
    v_cvt_pk_bf16_f32 v46, 0, v46
    v_cvt_pk_bf16_f32 v47, 0, v47
    v_mul_f32 v36, v36, v84
    v_mul_f32 v37, v37, v85
    v_mul_f32 v38, v38, v86
    v_mul_f32 v39, v39, v87
    v_mul_f32 v40, v40, v88
    v_mul_f32 v41, v41, v89
    v_mul_f32 v42, v42, v90
    v_mul_f32 v43, v43, v91
    v_mul_f32 v44, v44, v92
    v_mul_f32 v45, v45, v93
    v_mul_f32 v46, v46, v94
    v_mul_f32 v47, v47, v95
    v_cvt_pk_bf16_f32 v132, v36, v37
    v_cvt_pk_bf16_f32 v133, v38, v39
    v_cvt_pk_bf16_f32 v134, v40, v41
    v_cvt_pk_bf16_f32 v135, v42, v43
    v_cvt_pk_bf16_f32 v136, v44, v45
    v_cvt_pk_bf16_f32 v137, v46, v47
    v_mfma_f32_16x16x16_bf16 v[144:147], v[132:133], v[156:157], 0
    v_mfma_f32_16x16x16_bf16 v[144:147], v[134:135], v[158:159], v[144:147]
    v_mfma_f32_16x16x16_bf16 v[144:147], v[136:137], v[160:161], v[144:147]
    s_waitcnt lgkmcnt(0)
    v_cvt_f32_i32 v48, v48
    v_cvt_f32_i32 v49, v49
    v_cvt_f32_i32 v50, v50
    v_cvt_f32_i32 v51, v51
    v_cvt_f32_i32 v52, v52
    v_cvt_f32_i32 v53, v53
    v_cvt_f32_i32 v54, v54
    v_cvt_f32_i32 v55, v55
    v_cvt_f32_i32 v56, v56
    v_cvt_f32_i32 v57, v57
    v_cvt_f32_i32 v58, v58
    v_cvt_f32_i32 v59, v59
    v_sub_f32 v48, v48, v72
    v_sub_f32 v49, v49, v73
    v_sub_f32 v50, v50, v74
    v_sub_f32 v51, v51, v75
    v_sub_f32 v52, v52, v76
    v_sub_f32 v53, v53, v77
    v_sub_f32 v54, v54, v78
    v_sub_f32 v55, v55, v79
    v_sub_f32 v56, v56, v80
    v_sub_f32 v57, v57, v81
    v_sub_f32 v58, v58, v82
    v_sub_f32 v59, v59, v83
    v_cvt_pk_bf16_f32 v48, 0, v48
    v_cvt_pk_bf16_f32 v49, 0, v49
    v_cvt_pk_bf16_f32 v50, 0, v50
    v_cvt_pk_bf16_f32 v51, 0, v51
    v_cvt_pk_bf16_f32 v52, 0, v52
    v_cvt_pk_bf16_f32 v53, 0, v53
    v_cvt_pk_bf16_f32 v54, 0, v54
    v_cvt_pk_bf16_f32 v55, 0, v55
    v_cvt_pk_bf16_f32 v56, 0, v56
    v_cvt_pk_bf16_f32 v57, 0, v57
    v_cvt_pk_bf16_f32 v58, 0, v58
    v_cvt_pk_bf16_f32 v59, 0, v59
    v_mul_f32 v48, v48, v96
    v_mul_f32 v49, v49, v97
    v_mul_f32 v50, v50, v98
    v_mul_f32 v51, v51, v99
    v_mul_f32 v52, v52, v100
    v_mul_f32 v53, v53, v101
    v_mul_f32 v54, v54, v102
    v_mul_f32 v55, v55, v103
    v_mul_f32 v56, v56, v104
    v_mul_f32 v57, v57, v105
    v_mul_f32 v58, v58, v106
    v_mul_f32 v59, v59, v107
    v_cvt_pk_bf16_f32 v138, v48, v49
    v_cvt_pk_bf16_f32 v139, v50, v51
    v_add_f32_dpp v3, v147, v146 row_ror:12 row_mask:0xf bank_mask:0xf
    v_cvt_pk_bf16_f32 v140, v52, v53
    v_cvt_pk_bf16_f32 v141, v54, v55
    v_add_f32_dpp v3, v144, v3 row_ror:8 row_mask:0xf bank_mask:0xf
    v_cvt_pk_bf16_f32 v142, v56, v57
    v_cvt_pk_bf16_f32 v143, v58, v59
    v_add_f32_dpp v15, v145, v3 row_ror:4 row_mask:0xf bank_mask:0x4
    v_mfma_f32_16x16x16_bf16 v[148:151], v[138:139], v[156:157], 0
    v_mfma_f32_16x16x16_bf16 v[148:151], v[140:141], v[158:159], v[148:151]
    v_mfma_f32_16x16x16_bf16 v[148:151], v[142:143], v[160:161], v[148:151]
    v_add_u32 v33, s63, v23
    v_add_u32 v34, s63, v24
    ds_read_b64 v[108:109], v33 offset:0
    ds_read_b64 v[110:111], v33 offset:1536
    ds_read_b64 v[112:113], v33 offset:128
    ds_read_b64 v[114:115], v33 offset:1664
    ds_read_b64 v[116:117], v33 offset:256
    ds_read_b64 v[118:119], v33 offset:1792
    ds_read_b64 v[120:121], v34 offset:0
    v_add_f32_dpp v4, v151, v150 row_ror:12 row_mask:0xf bank_mask:0xf
    ds_read_b64 v[122:123], v34 offset:1536
    ds_read_b64 v[124:125], v34 offset:128
    v_add_f32_dpp v4, v148, v4 row_ror:8 row_mask:0xf bank_mask:0xf
    ds_read_b64 v[126:127], v34 offset:1664
    ds_read_b64 v[128:129], v34 offset:256
    ds_read_b64 v[130:131], v34 offset:1792
    v_add_f32_dpp v16, v149, v4 row_ror:4 row_mask:0xf bank_mask:0x4
    s_waitcnt lgkmcnt(0)
    v_lshlrev_b32 v60, 16, v108
    v_and_b32 v61, s66, v108
    v_lshlrev_b32 v62, 16, v109
    v_and_b32 v63, s66, v109
    v_lshlrev_b32 v84, 16, v110
    v_and_b32 v85, s66, v110
    v_lshlrev_b32 v86, 16, v111
    v_and_b32 v87, s66, v111
    v_lshlrev_b32 v64, 16, v112
    v_and_b32 v65, s66, v112
    v_lshlrev_b32 v66, 16, v113
    v_and_b32 v67, s66, v113
    v_lshlrev_b32 v88, 16, v114
    v_and_b32 v89, s66, v114
    v_lshlrev_b32 v90, 16, v115
    v_and_b32 v91, s66, v115
    v_lshlrev_b32 v68, 16, v116
    v_and_b32 v69, s66, v116
    v_lshlrev_b32 v70, 16, v117
    v_and_b32 v71, s66, v117
    v_lshlrev_b32 v92, 16, v118
    v_and_b32 v93, s66, v118
    v_lshlrev_b32 v94, 16, v119
    v_and_b32 v95, s66, v119
    v_lshlrev_b32 v72, 16, v120
    v_and_b32 v73, s66, v120
    v_lshlrev_b32 v74, 16, v121
    v_and_b32 v75, s66, v121
    v_lshlrev_b32 v96, 16, v122
    v_and_b32 v97, s66, v122
    v_lshlrev_b32 v98, 16, v123
    v_and_b32 v99, s66, v123
    v_lshlrev_b32 v76, 16, v124
    v_and_b32 v77, s66, v124
    v_lshlrev_b32 v78, 16, v125
    v_and_b32 v79, s66, v125
    v_lshlrev_b32 v100, 16, v126
    v_and_b32 v101, s66, v126
    v_lshlrev_b32 v102, 16, v127
    v_and_b32 v103, s66, v127
    v_lshlrev_b32 v80, 16, v128
    v_and_b32 v81, s66, v128
    v_lshlrev_b32 v82, 16, v129
    v_and_b32 v83, s66, v129
    v_lshlrev_b32 v104, 16, v130
    v_and_b32 v105, s66, v130
    v_lshlrev_b32 v106, 16, v131
    v_and_b32 v107, s66, v131
    v_add_u32 v13, s62, v12
    s_add_u32 s62, s62, 24576
    s_cmp_eq_u32 s62, 73728
    s_cselect_b32 s62, 0, s62
    s_barrier
    ds_read_b128 v[36:39], v13 offset:0
    ds_read_b128 v[40:43], v13 offset:256
    ds_read_b128 v[44:47], v13 offset:512
    ds_read_b128 v[48:51], v13 offset:3072
    ds_read_b128 v[52:55], v13 offset:3328
    ds_read_b128 v[56:59], v13 offset:3584
    s_waitcnt lgkmcnt(3)
    v_cvt_f32_i32 v36, v36
    v_cvt_f32_i32 v37, v37
    v_cvt_f32_i32 v38, v38
    v_cvt_f32_i32 v39, v39
    v_cvt_f32_i32 v40, v40
    v_cvt_f32_i32 v41, v41
    v_cvt_f32_i32 v42, v42
    v_cvt_f32_i32 v43, v43
    v_cvt_f32_i32 v44, v44
    v_cvt_f32_i32 v45, v45
    v_cvt_f32_i32 v46, v46
    v_cvt_f32_i32 v47, v47
    v_sub_f32 v36, v36, v60
    v_sub_f32 v37, v37, v61
    v_sub_f32 v38, v38, v62
    v_sub_f32 v39, v39, v63
    v_sub_f32 v40, v40, v64
    v_sub_f32 v41, v41, v65
    v_sub_f32 v42, v42, v66
    v_sub_f32 v43, v43, v67
    v_sub_f32 v44, v44, v68
    v_sub_f32 v45, v45, v69
    v_sub_f32 v46, v46, v70
    v_sub_f32 v47, v47, v71
    v_cvt_pk_bf16_f32 v36, 0, v36
    v_cvt_pk_bf16_f32 v37, 0, v37
    v_cvt_pk_bf16_f32 v38, 0, v38
    v_cvt_pk_bf16_f32 v39, 0, v39
    v_cvt_pk_bf16_f32 v40, 0, v40
    v_cvt_pk_bf16_f32 v41, 0, v41
    v_cvt_pk_bf16_f32 v42, 0, v42
    v_cvt_pk_bf16_f32 v43, 0, v43
    v_cvt_pk_bf16_f32 v44, 0, v44
    v_cvt_pk_bf16_f32 v45, 0, v45
    v_cvt_pk_bf16_f32 v46, 0, v46
    v_cvt_pk_bf16_f32 v47, 0, v47
    v_mul_f32 v36, v36, v84
    v_mul_f32 v37, v37, v85
    v_mul_f32 v38, v38, v86
    v_mul_f32 v39, v39, v87
    v_mul_f32 v40, v40, v88
    v_mul_f32 v41, v41, v89
    v_mul_f32 v42, v42, v90
    v_mul_f32 v43, v43, v91
    v_mul_f32 v44, v44, v92
    v_mul_f32 v45, v45, v93
    v_mul_f32 v46, v46, v94
    v_mul_f32 v47, v47, v95
    v_cvt_pk_bf16_f32 v132, v36, v37
    v_cvt_pk_bf16_f32 v133, v38, v39
    v_cvt_pk_bf16_f32 v134, v40, v41
    v_cvt_pk_bf16_f32 v135, v42, v43
    v_cvt_pk_bf16_f32 v136, v44, v45
    v_cvt_pk_bf16_f32 v137, v46, v47
    v_mfma_f32_16x16x16_bf16 v[144:147], v[132:133], v[156:157], 0
    v_mfma_f32_16x16x16_bf16 v[144:147], v[134:135], v[158:159], v[144:147]
    v_mfma_f32_16x16x16_bf16 v[144:147], v[136:137], v[160:161], v[144:147]
    s_waitcnt lgkmcnt(0)
    v_cvt_f32_i32 v48, v48
    v_cvt_f32_i32 v49, v49
    v_cvt_f32_i32 v50, v50
    v_cvt_f32_i32 v51, v51
    v_cvt_f32_i32 v52, v52
    v_cvt_f32_i32 v53, v53
    v_cvt_f32_i32 v54, v54
    v_cvt_f32_i32 v55, v55
    v_cvt_f32_i32 v56, v56
    v_cvt_f32_i32 v57, v57
    v_cvt_f32_i32 v58, v58
    v_cvt_f32_i32 v59, v59
    v_sub_f32 v48, v48, v72
    v_sub_f32 v49, v49, v73
    v_sub_f32 v50, v50, v74
    v_sub_f32 v51, v51, v75
    v_sub_f32 v52, v52, v76
    v_sub_f32 v53, v53, v77
    v_sub_f32 v54, v54, v78
    v_sub_f32 v55, v55, v79
    v_sub_f32 v56, v56, v80
    v_sub_f32 v57, v57, v81
    v_sub_f32 v58, v58, v82
    v_sub_f32 v59, v59, v83
    v_cvt_pk_bf16_f32 v48, 0, v48
    v_cvt_pk_bf16_f32 v49, 0, v49
    v_cvt_pk_bf16_f32 v50, 0, v50
    v_cvt_pk_bf16_f32 v51, 0, v51
    v_cvt_pk_bf16_f32 v52, 0, v52
    v_cvt_pk_bf16_f32 v53, 0, v53
    v_cvt_pk_bf16_f32 v54, 0, v54
    v_cvt_pk_bf16_f32 v55, 0, v55
    v_cvt_pk_bf16_f32 v56, 0, v56
    v_cvt_pk_bf16_f32 v57, 0, v57
    v_cvt_pk_bf16_f32 v58, 0, v58
    v_cvt_pk_bf16_f32 v59, 0, v59
    v_mul_f32 v48, v48, v96
    v_mul_f32 v49, v49, v97
    v_mul_f32 v50, v50, v98
    v_mul_f32 v51, v51, v99
    v_mul_f32 v52, v52, v100
    v_mul_f32 v53, v53, v101
    v_mul_f32 v54, v54, v102
    v_mul_f32 v55, v55, v103
    v_mul_f32 v56, v56, v104
    v_mul_f32 v57, v57, v105
    v_mul_f32 v58, v58, v106
    v_mul_f32 v59, v59, v107
    v_cvt_pk_bf16_f32 v138, v48, v49
    v_cvt_pk_bf16_f32 v139, v50, v51
    v_add_f32_dpp v3, v144, v147 row_ror:12 row_mask:0xf bank_mask:0xf
    v_cvt_pk_bf16_f32 v140, v52, v53
    v_cvt_pk_bf16_f32 v141, v54, v55
    v_add_f32_dpp v3, v145, v3 row_ror:8 row_mask:0xf bank_mask:0xf
    v_cvt_pk_bf16_f32 v142, v56, v57
    v_cvt_pk_bf16_f32 v143, v58, v59
    v_add_f32_dpp v15, v146, v3 row_ror:4 row_mask:0xf bank_mask:0x8
    v_mfma_f32_16x16x16_bf16 v[148:151], v[138:139], v[156:157], 0
    v_mfma_f32_16x16x16_bf16 v[148:151], v[140:141], v[158:159], v[148:151]
    v_mfma_f32_16x16x16_bf16 v[148:151], v[142:143], v[160:161], v[148:151]
    v_add_u32 v33, s63, v25
    v_add_u32 v34, s63, v26
    ds_read_b64 v[108:109], v33 offset:0
    ds_read_b64 v[110:111], v33 offset:1536
    ds_read_b64 v[112:113], v33 offset:128
    ds_read_b64 v[114:115], v33 offset:1664
    ds_read_b64 v[116:117], v33 offset:256
    ds_read_b64 v[118:119], v33 offset:1792
    ds_read_b64 v[120:121], v34 offset:0
    v_add_f32_dpp v4, v148, v151 row_ror:12 row_mask:0xf bank_mask:0xf
    ds_read_b64 v[122:123], v34 offset:1536
    ds_read_b64 v[124:125], v34 offset:128
    v_add_f32_dpp v4, v149, v4 row_ror:8 row_mask:0xf bank_mask:0xf
    ds_read_b64 v[126:127], v34 offset:1664
    ds_read_b64 v[128:129], v34 offset:256
    ds_read_b64 v[130:131], v34 offset:1792
    v_add_f32_dpp v16, v150, v4 row_ror:4 row_mask:0xf bank_mask:0x8
    v_cvt_pk_bf16_f32 v3, 0, v15
    v_cvt_pk_bf16_f32 v4, 0, v16
    v_mul_f32 v3, s65, v3
    v_mul_f32 v4, s65, v4
    v_cvt_pk_bf16_f32 v5, v3, v4
    v_max3_f32 v14, v14, v3, v4
    ds_write_b32 v11, v5 offset:0
    s_waitcnt lgkmcnt(0)
    v_lshlrev_b32 v60, 16, v108
    v_and_b32 v61, s66, v108
    v_lshlrev_b32 v62, 16, v109
    v_and_b32 v63, s66, v109
    v_lshlrev_b32 v84, 16, v110
    v_and_b32 v85, s66, v110
    v_lshlrev_b32 v86, 16, v111
    v_and_b32 v87, s66, v111
    v_lshlrev_b32 v64, 16, v112
    v_and_b32 v65, s66, v112
    v_lshlrev_b32 v66, 16, v113
    v_and_b32 v67, s66, v113
    v_lshlrev_b32 v88, 16, v114
    v_and_b32 v89, s66, v114
    v_lshlrev_b32 v90, 16, v115
    v_and_b32 v91, s66, v115
    v_lshlrev_b32 v68, 16, v116
    v_and_b32 v69, s66, v116
    v_lshlrev_b32 v70, 16, v117
    v_and_b32 v71, s66, v117
    v_lshlrev_b32 v92, 16, v118
    v_and_b32 v93, s66, v118
    v_lshlrev_b32 v94, 16, v119
    v_and_b32 v95, s66, v119
    v_lshlrev_b32 v72, 16, v120
    v_and_b32 v73, s66, v120
    v_lshlrev_b32 v74, 16, v121
    v_and_b32 v75, s66, v121
    v_lshlrev_b32 v96, 16, v122
    v_and_b32 v97, s66, v122
    v_lshlrev_b32 v98, 16, v123
    v_and_b32 v99, s66, v123
    v_lshlrev_b32 v76, 16, v124
    v_and_b32 v77, s66, v124
    v_lshlrev_b32 v78, 16, v125
    v_and_b32 v79, s66, v125
    v_lshlrev_b32 v100, 16, v126
    v_and_b32 v101, s66, v126
    v_lshlrev_b32 v102, 16, v127
    v_and_b32 v103, s66, v127
    v_lshlrev_b32 v80, 16, v128
    v_and_b32 v81, s66, v128
    v_lshlrev_b32 v82, 16, v129
    v_and_b32 v83, s66, v129
    v_lshlrev_b32 v104, 16, v130
    v_and_b32 v105, s66, v130
    v_lshlrev_b32 v106, 16, v131
    v_and_b32 v107, s66, v131
    s_waitcnt vmcnt(0)
    v_add_u32 v13, s62, v12
    s_add_u32 s62, s62, 24576
    s_cmp_eq_u32 s62, 73728
    s_cselect_b32 s62, 0, s62
    s_barrier
    ds_read_b128 v[36:39], v13 offset:0
    ds_read_b128 v[40:43], v13 offset:256
    ds_read_b128 v[44:47], v13 offset:512
    ds_read_b128 v[48:51], v13 offset:3072
    ds_read_b128 v[52:55], v13 offset:3328
    ds_read_b128 v[56:59], v13 offset:3584
    s_waitcnt lgkmcnt(3)
    v_cvt_f32_i32 v36, v36
    v_cvt_f32_i32 v37, v37
    v_cvt_f32_i32 v38, v38
    v_cvt_f32_i32 v39, v39
    v_cvt_f32_i32 v40, v40
    v_cvt_f32_i32 v41, v41
    v_cvt_f32_i32 v42, v42
    v_cvt_f32_i32 v43, v43
    v_cvt_f32_i32 v44, v44
    v_cvt_f32_i32 v45, v45
    v_cvt_f32_i32 v46, v46
    v_cvt_f32_i32 v47, v47
    v_sub_f32 v36, v36, v60
    v_sub_f32 v37, v37, v61
    v_sub_f32 v38, v38, v62
    v_sub_f32 v39, v39, v63
    v_sub_f32 v40, v40, v64
    v_sub_f32 v41, v41, v65
    v_sub_f32 v42, v42, v66
    v_sub_f32 v43, v43, v67
    v_sub_f32 v44, v44, v68
    v_sub_f32 v45, v45, v69
    v_sub_f32 v46, v46, v70
    v_sub_f32 v47, v47, v71
    v_cvt_pk_bf16_f32 v36, 0, v36
    v_cvt_pk_bf16_f32 v37, 0, v37
    v_cvt_pk_bf16_f32 v38, 0, v38
    v_cvt_pk_bf16_f32 v39, 0, v39
    v_cvt_pk_bf16_f32 v40, 0, v40
    v_cvt_pk_bf16_f32 v41, 0, v41
    v_cvt_pk_bf16_f32 v42, 0, v42
    v_cvt_pk_bf16_f32 v43, 0, v43
    v_cvt_pk_bf16_f32 v44, 0, v44
    v_cvt_pk_bf16_f32 v45, 0, v45
    v_cvt_pk_bf16_f32 v46, 0, v46
    v_cvt_pk_bf16_f32 v47, 0, v47
    v_mul_f32 v36, v36, v84
    v_mul_f32 v37, v37, v85
    v_mul_f32 v38, v38, v86
    v_mul_f32 v39, v39, v87
    v_mul_f32 v40, v40, v88
    v_mul_f32 v41, v41, v89
    v_mul_f32 v42, v42, v90
    v_mul_f32 v43, v43, v91
    v_mul_f32 v44, v44, v92
    v_mul_f32 v45, v45, v93
    v_mul_f32 v46, v46, v94
    v_mul_f32 v47, v47, v95
    v_cvt_pk_bf16_f32 v132, v36, v37
    v_cvt_pk_bf16_f32 v133, v38, v39
    v_cvt_pk_bf16_f32 v134, v40, v41
    v_cvt_pk_bf16_f32 v135, v42, v43
    v_cvt_pk_bf16_f32 v136, v44, v45
    v_cvt_pk_bf16_f32 v137, v46, v47
    v_mfma_f32_16x16x16_bf16 v[144:147], v[132:133], v[156:157], 0
    v_mfma_f32_16x16x16_bf16 v[144:147], v[134:135], v[158:159], v[144:147]
    v_mfma_f32_16x16x16_bf16 v[144:147], v[136:137], v[160:161], v[144:147]
    s_waitcnt lgkmcnt(0)
    v_cvt_f32_i32 v48, v48
    v_cvt_f32_i32 v49, v49
    v_cvt_f32_i32 v50, v50
    v_cvt_f32_i32 v51, v51
    v_cvt_f32_i32 v52, v52
    v_cvt_f32_i32 v53, v53
    v_cvt_f32_i32 v54, v54
    v_cvt_f32_i32 v55, v55
    v_cvt_f32_i32 v56, v56
    v_cvt_f32_i32 v57, v57
    v_cvt_f32_i32 v58, v58
    v_cvt_f32_i32 v59, v59
    v_sub_f32 v48, v48, v72
    v_sub_f32 v49, v49, v73
    v_sub_f32 v50, v50, v74
    v_sub_f32 v51, v51, v75
    v_sub_f32 v52, v52, v76
    v_sub_f32 v53, v53, v77
    v_sub_f32 v54, v54, v78
    v_sub_f32 v55, v55, v79
    v_sub_f32 v56, v56, v80
    v_sub_f32 v57, v57, v81
    v_sub_f32 v58, v58, v82
    v_sub_f32 v59, v59, v83
    v_cvt_pk_bf16_f32 v48, 0, v48
    v_cvt_pk_bf16_f32 v49, 0, v49
    v_cvt_pk_bf16_f32 v50, 0, v50
    v_cvt_pk_bf16_f32 v51, 0, v51
    v_cvt_pk_bf16_f32 v52, 0, v52
    v_cvt_pk_bf16_f32 v53, 0, v53
    v_cvt_pk_bf16_f32 v54, 0, v54
    v_cvt_pk_bf16_f32 v55, 0, v55
    v_cvt_pk_bf16_f32 v56, 0, v56
    v_cvt_pk_bf16_f32 v57, 0, v57
    v_cvt_pk_bf16_f32 v58, 0, v58
    v_cvt_pk_bf16_f32 v59, 0, v59
    v_mul_f32 v48, v48, v96
    v_mul_f32 v49, v49, v97
    v_mul_f32 v50, v50, v98
    v_mul_f32 v51, v51, v99
    v_mul_f32 v52, v52, v100
    v_mul_f32 v53, v53, v101
    v_mul_f32 v54, v54, v102
    v_mul_f32 v55, v55, v103
    v_mul_f32 v56, v56, v104
    v_mul_f32 v57, v57, v105
    v_mul_f32 v58, v58, v106
    v_mul_f32 v59, v59, v107
    v_cvt_pk_bf16_f32 v138, v48, v49
    v_cvt_pk_bf16_f32 v139, v50, v51
    v_add_f32_dpp v3, v145, v144 row_ror:12 row_mask:0xf bank_mask:0xf
    v_cvt_pk_bf16_f32 v140, v52, v53
    v_cvt_pk_bf16_f32 v141, v54, v55
    v_add_f32_dpp v3, v146, v3 row_ror:8 row_mask:0xf bank_mask:0xf
    v_cvt_pk_bf16_f32 v142, v56, v57
    v_cvt_pk_bf16_f32 v143, v58, v59
    v_add_f32_dpp v15, v147, v3 row_ror:4 row_mask:0xf bank_mask:0x1
    v_mfma_f32_16x16x16_bf16 v[148:151], v[138:139], v[156:157], 0
    v_mfma_f32_16x16x16_bf16 v[148:151], v[140:141], v[158:159], v[148:151]
    v_mfma_f32_16x16x16_bf16 v[148:151], v[142:143], v[160:161], v[148:151]
    v_add_u32 v33, s63, v27
    v_add_u32 v34, s63, v28
    ds_read_b64 v[108:109], v33 offset:0
    ds_read_b64 v[110:111], v33 offset:1536
    ds_read_b64 v[112:113], v33 offset:128
    ds_read_b64 v[114:115], v33 offset:1664
    ds_read_b64 v[116:117], v33 offset:256
    ds_read_b64 v[118:119], v33 offset:1792
    ds_read_b64 v[120:121], v34 offset:0
    v_add_f32_dpp v4, v149, v148 row_ror:12 row_mask:0xf bank_mask:0xf
    ds_read_b64 v[122:123], v34 offset:1536
    ds_read_b64 v[124:125], v34 offset:128
    v_add_f32_dpp v4, v150, v4 row_ror:8 row_mask:0xf bank_mask:0xf
    ds_read_b64 v[126:127], v34 offset:1664
    ds_read_b64 v[128:129], v34 offset:256
    ds_read_b64 v[130:131], v34 offset:1792
    v_add_f32_dpp v16, v151, v4 row_ror:4 row_mask:0xf bank_mask:0x1
    s_waitcnt lgkmcnt(0)
    v_lshlrev_b32 v60, 16, v108
    v_and_b32 v61, s66, v108
    v_lshlrev_b32 v62, 16, v109
    v_and_b32 v63, s66, v109
    v_lshlrev_b32 v84, 16, v110
    v_and_b32 v85, s66, v110
    v_lshlrev_b32 v86, 16, v111
    v_and_b32 v87, s66, v111
    v_lshlrev_b32 v64, 16, v112
    v_and_b32 v65, s66, v112
    v_lshlrev_b32 v66, 16, v113
    v_and_b32 v67, s66, v113
    v_lshlrev_b32 v88, 16, v114
    v_and_b32 v89, s66, v114
    v_lshlrev_b32 v90, 16, v115
    v_and_b32 v91, s66, v115
    v_lshlrev_b32 v68, 16, v116
    v_and_b32 v69, s66, v116
    v_lshlrev_b32 v70, 16, v117
    v_and_b32 v71, s66, v117
    v_lshlrev_b32 v92, 16, v118
    v_and_b32 v93, s66, v118
    v_lshlrev_b32 v94, 16, v119
    v_and_b32 v95, s66, v119
    v_lshlrev_b32 v72, 16, v120
    v_and_b32 v73, s66, v120
    v_lshlrev_b32 v74, 16, v121
    v_and_b32 v75, s66, v121
    v_lshlrev_b32 v96, 16, v122
    v_and_b32 v97, s66, v122
    v_lshlrev_b32 v98, 16, v123
    v_and_b32 v99, s66, v123
    v_lshlrev_b32 v76, 16, v124
    v_and_b32 v77, s66, v124
    v_lshlrev_b32 v78, 16, v125
    v_and_b32 v79, s66, v125
    v_lshlrev_b32 v100, 16, v126
    v_and_b32 v101, s66, v126
    v_lshlrev_b32 v102, 16, v127
    v_and_b32 v103, s66, v127
    v_lshlrev_b32 v80, 16, v128
    v_and_b32 v81, s66, v128
    v_lshlrev_b32 v82, 16, v129
    v_and_b32 v83, s66, v129
    v_lshlrev_b32 v104, 16, v130
    v_and_b32 v105, s66, v130
    v_lshlrev_b32 v106, 16, v131
    v_and_b32 v107, s66, v131
    v_add_u32 v13, s62, v12
    s_add_u32 s62, s62, 24576
    s_cmp_eq_u32 s62, 73728
    s_cselect_b32 s62, 0, s62
    s_barrier
    ds_read_b128 v[36:39], v13 offset:0
    ds_read_b128 v[40:43], v13 offset:256
    ds_read_b128 v[44:47], v13 offset:512
    ds_read_b128 v[48:51], v13 offset:3072
    ds_read_b128 v[52:55], v13 offset:3328
    ds_read_b128 v[56:59], v13 offset:3584
    s_waitcnt lgkmcnt(3)
    v_cvt_f32_i32 v36, v36
    v_cvt_f32_i32 v37, v37
    v_cvt_f32_i32 v38, v38
    v_cvt_f32_i32 v39, v39
    v_cvt_f32_i32 v40, v40
    v_cvt_f32_i32 v41, v41
    v_cvt_f32_i32 v42, v42
    v_cvt_f32_i32 v43, v43
    v_cvt_f32_i32 v44, v44
    v_cvt_f32_i32 v45, v45
    v_cvt_f32_i32 v46, v46
    v_cvt_f32_i32 v47, v47
    v_sub_f32 v36, v36, v60
    v_sub_f32 v37, v37, v61
    v_sub_f32 v38, v38, v62
    v_sub_f32 v39, v39, v63
    v_sub_f32 v40, v40, v64
    v_sub_f32 v41, v41, v65
    v_sub_f32 v42, v42, v66
    v_sub_f32 v43, v43, v67
    v_sub_f32 v44, v44, v68
    v_sub_f32 v45, v45, v69
    v_sub_f32 v46, v46, v70
    v_sub_f32 v47, v47, v71
    v_cvt_pk_bf16_f32 v36, 0, v36
    v_cvt_pk_bf16_f32 v37, 0, v37
    v_cvt_pk_bf16_f32 v38, 0, v38
    v_cvt_pk_bf16_f32 v39, 0, v39
    v_cvt_pk_bf16_f32 v40, 0, v40
    v_cvt_pk_bf16_f32 v41, 0, v41
    v_cvt_pk_bf16_f32 v42, 0, v42
    v_cvt_pk_bf16_f32 v43, 0, v43
    v_cvt_pk_bf16_f32 v44, 0, v44
    v_cvt_pk_bf16_f32 v45, 0, v45
    v_cvt_pk_bf16_f32 v46, 0, v46
    v_cvt_pk_bf16_f32 v47, 0, v47
    v_mul_f32 v36, v36, v84
    v_mul_f32 v37, v37, v85
    v_mul_f32 v38, v38, v86
    v_mul_f32 v39, v39, v87
    v_mul_f32 v40, v40, v88
    v_mul_f32 v41, v41, v89
    v_mul_f32 v42, v42, v90
    v_mul_f32 v43, v43, v91
    v_mul_f32 v44, v44, v92
    v_mul_f32 v45, v45, v93
    v_mul_f32 v46, v46, v94
    v_mul_f32 v47, v47, v95
    v_cvt_pk_bf16_f32 v132, v36, v37
    v_cvt_pk_bf16_f32 v133, v38, v39
    v_cvt_pk_bf16_f32 v134, v40, v41
    v_cvt_pk_bf16_f32 v135, v42, v43
    v_cvt_pk_bf16_f32 v136, v44, v45
    v_cvt_pk_bf16_f32 v137, v46, v47
    v_mfma_f32_16x16x16_bf16 v[144:147], v[132:133], v[156:157], 0
    v_mfma_f32_16x16x16_bf16 v[144:147], v[134:135], v[158:159], v[144:147]
    v_mfma_f32_16x16x16_bf16 v[144:147], v[136:137], v[160:161], v[144:147]
    s_waitcnt lgkmcnt(0)
    v_cvt_f32_i32 v48, v48
    v_cvt_f32_i32 v49, v49
    v_cvt_f32_i32 v50, v50
    v_cvt_f32_i32 v51, v51
    v_cvt_f32_i32 v52, v52
    v_cvt_f32_i32 v53, v53
    v_cvt_f32_i32 v54, v54
    v_cvt_f32_i32 v55, v55
    v_cvt_f32_i32 v56, v56
    v_cvt_f32_i32 v57, v57
    v_cvt_f32_i32 v58, v58
    v_cvt_f32_i32 v59, v59
    v_sub_f32 v48, v48, v72
    v_sub_f32 v49, v49, v73
    v_sub_f32 v50, v50, v74
    v_sub_f32 v51, v51, v75
    v_sub_f32 v52, v52, v76
    v_sub_f32 v53, v53, v77
    v_sub_f32 v54, v54, v78
    v_sub_f32 v55, v55, v79
    v_sub_f32 v56, v56, v80
    v_sub_f32 v57, v57, v81
    v_sub_f32 v58, v58, v82
    v_sub_f32 v59, v59, v83
    v_cvt_pk_bf16_f32 v48, 0, v48
    v_cvt_pk_bf16_f32 v49, 0, v49
    v_cvt_pk_bf16_f32 v50, 0, v50
    v_cvt_pk_bf16_f32 v51, 0, v51
    v_cvt_pk_bf16_f32 v52, 0, v52
    v_cvt_pk_bf16_f32 v53, 0, v53
    v_cvt_pk_bf16_f32 v54, 0, v54
    v_cvt_pk_bf16_f32 v55, 0, v55
    v_cvt_pk_bf16_f32 v56, 0, v56
    v_cvt_pk_bf16_f32 v57, 0, v57
    v_cvt_pk_bf16_f32 v58, 0, v58
    v_cvt_pk_bf16_f32 v59, 0, v59
    v_mul_f32 v48, v48, v96
    v_mul_f32 v49, v49, v97
    v_mul_f32 v50, v50, v98
    v_mul_f32 v51, v51, v99
    v_mul_f32 v52, v52, v100
    v_mul_f32 v53, v53, v101
    v_mul_f32 v54, v54, v102
    v_mul_f32 v55, v55, v103
    v_mul_f32 v56, v56, v104
    v_mul_f32 v57, v57, v105
    v_mul_f32 v58, v58, v106
    v_mul_f32 v59, v59, v107
    v_cvt_pk_bf16_f32 v138, v48, v49
    v_cvt_pk_bf16_f32 v139, v50, v51
    v_add_f32_dpp v3, v146, v145 row_ror:12 row_mask:0xf bank_mask:0xf
    v_cvt_pk_bf16_f32 v140, v52, v53
    v_cvt_pk_bf16_f32 v141, v54, v55
    v_add_f32_dpp v3, v147, v3 row_ror:8 row_mask:0xf bank_mask:0xf
    v_cvt_pk_bf16_f32 v142, v56, v57
    v_cvt_pk_bf16_f32 v143, v58, v59
    v_add_f32_dpp v15, v144, v3 row_ror:4 row_mask:0xf bank_mask:0x2
    v_mfma_f32_16x16x16_bf16 v[148:151], v[138:139], v[156:157], 0
    v_mfma_f32_16x16x16_bf16 v[148:151], v[140:141], v[158:159], v[148:151]
    v_mfma_f32_16x16x16_bf16 v[148:151], v[142:143], v[160:161], v[148:151]
    v_add_u32 v33, s63, v29
    v_add_u32 v34, s63, v30
    ds_read_b64 v[108:109], v33 offset:0
    ds_read_b64 v[110:111], v33 offset:1536
    ds_read_b64 v[112:113], v33 offset:128
    ds_read_b64 v[114:115], v33 offset:1664
    ds_read_b64 v[116:117], v33 offset:256
    ds_read_b64 v[118:119], v33 offset:1792
    ds_read_b64 v[120:121], v34 offset:0
    v_add_f32_dpp v4, v150, v149 row_ror:12 row_mask:0xf bank_mask:0xf
    ds_read_b64 v[122:123], v34 offset:1536
    ds_read_b64 v[124:125], v34 offset:128
    v_add_f32_dpp v4, v151, v4 row_ror:8 row_mask:0xf bank_mask:0xf
    ds_read_b64 v[126:127], v34 offset:1664
    ds_read_b64 v[128:129], v34 offset:256
    ds_read_b64 v[130:131], v34 offset:1792
    v_add_f32_dpp v16, v148, v4 row_ror:4 row_mask:0xf bank_mask:0x2
    s_waitcnt lgkmcnt(0)
    v_lshlrev_b32 v60, 16, v108
    v_and_b32 v61, s66, v108
    v_lshlrev_b32 v62, 16, v109
    v_and_b32 v63, s66, v109
    v_lshlrev_b32 v84, 16, v110
    v_and_b32 v85, s66, v110
    v_lshlrev_b32 v86, 16, v111
    v_and_b32 v87, s66, v111
    v_lshlrev_b32 v64, 16, v112
    v_and_b32 v65, s66, v112
    v_lshlrev_b32 v66, 16, v113
    v_and_b32 v67, s66, v113
    v_lshlrev_b32 v88, 16, v114
    v_and_b32 v89, s66, v114
    v_lshlrev_b32 v90, 16, v115
    v_and_b32 v91, s66, v115
    v_lshlrev_b32 v68, 16, v116
    v_and_b32 v69, s66, v116
    v_lshlrev_b32 v70, 16, v117
    v_and_b32 v71, s66, v117
    v_lshlrev_b32 v92, 16, v118
    v_and_b32 v93, s66, v118
    v_lshlrev_b32 v94, 16, v119
    v_and_b32 v95, s66, v119
    v_lshlrev_b32 v72, 16, v120
    v_and_b32 v73, s66, v120
    v_lshlrev_b32 v74, 16, v121
    v_and_b32 v75, s66, v121
    v_lshlrev_b32 v96, 16, v122
    v_and_b32 v97, s66, v122
    v_lshlrev_b32 v98, 16, v123
    v_and_b32 v99, s66, v123
    v_lshlrev_b32 v76, 16, v124
    v_and_b32 v77, s66, v124
    v_lshlrev_b32 v78, 16, v125
    v_and_b32 v79, s66, v125
    v_lshlrev_b32 v100, 16, v126
    v_and_b32 v101, s66, v126
    v_lshlrev_b32 v102, 16, v127
    v_and_b32 v103, s66, v127
    v_lshlrev_b32 v80, 16, v128
    v_and_b32 v81, s66, v128
    v_lshlrev_b32 v82, 16, v129
    v_and_b32 v83, s66, v129
    v_lshlrev_b32 v104, 16, v130
    v_and_b32 v105, s66, v130
    v_lshlrev_b32 v106, 16, v131
    v_and_b32 v107, s66, v131
    v_add_u32 v13, s62, v12
    s_add_u32 s62, s62, 24576
    s_cmp_eq_u32 s62, 73728
    s_cselect_b32 s62, 0, s62
    s_barrier
    ds_read_b128 v[36:39], v13 offset:0
    ds_read_b128 v[40:43], v13 offset:256
    ds_read_b128 v[44:47], v13 offset:512
    ds_read_b128 v[48:51], v13 offset:3072
    ds_read_b128 v[52:55], v13 offset:3328
    ds_read_b128 v[56:59], v13 offset:3584
    s_waitcnt lgkmcnt(3)
    v_cvt_f32_i32 v36, v36
    v_cvt_f32_i32 v37, v37
    v_cvt_f32_i32 v38, v38
    v_cvt_f32_i32 v39, v39
    v_cvt_f32_i32 v40, v40
    v_cvt_f32_i32 v41, v41
    v_cvt_f32_i32 v42, v42
    v_cvt_f32_i32 v43, v43
    v_cvt_f32_i32 v44, v44
    v_cvt_f32_i32 v45, v45
    v_cvt_f32_i32 v46, v46
    v_cvt_f32_i32 v47, v47
    v_sub_f32 v36, v36, v60
    v_sub_f32 v37, v37, v61
    v_sub_f32 v38, v38, v62
    v_sub_f32 v39, v39, v63
    v_sub_f32 v40, v40, v64
    v_sub_f32 v41, v41, v65
    v_sub_f32 v42, v42, v66
    v_sub_f32 v43, v43, v67
    v_sub_f32 v44, v44, v68
    v_sub_f32 v45, v45, v69
    v_sub_f32 v46, v46, v70
    v_sub_f32 v47, v47, v71
    v_cvt_pk_bf16_f32 v36, 0, v36
    v_cvt_pk_bf16_f32 v37, 0, v37
    v_cvt_pk_bf16_f32 v38, 0, v38
    v_cvt_pk_bf16_f32 v39, 0, v39
    v_cvt_pk_bf16_f32 v40, 0, v40
    v_cvt_pk_bf16_f32 v41, 0, v41
    v_cvt_pk_bf16_f32 v42, 0, v42
    v_cvt_pk_bf16_f32 v43, 0, v43
    v_cvt_pk_bf16_f32 v44, 0, v44
    v_cvt_pk_bf16_f32 v45, 0, v45
    v_cvt_pk_bf16_f32 v46, 0, v46
    v_cvt_pk_bf16_f32 v47, 0, v47
    v_mul_f32 v36, v36, v84
    v_mul_f32 v37, v37, v85
    v_mul_f32 v38, v38, v86
    v_mul_f32 v39, v39, v87
    v_mul_f32 v40, v40, v88
    v_mul_f32 v41, v41, v89
    v_mul_f32 v42, v42, v90
    v_mul_f32 v43, v43, v91
    v_mul_f32 v44, v44, v92
    v_mul_f32 v45, v45, v93
    v_mul_f32 v46, v46, v94
    v_mul_f32 v47, v47, v95
    v_cvt_pk_bf16_f32 v132, v36, v37
    v_cvt_pk_bf16_f32 v133, v38, v39
    v_cvt_pk_bf16_f32 v134, v40, v41
    v_cvt_pk_bf16_f32 v135, v42, v43
    v_cvt_pk_bf16_f32 v136, v44, v45
    v_cvt_pk_bf16_f32 v137, v46, v47
    v_mfma_f32_16x16x16_bf16 v[144:147], v[132:133], v[156:157], 0
    v_mfma_f32_16x16x16_bf16 v[144:147], v[134:135], v[158:159], v[144:147]
    v_mfma_f32_16x16x16_bf16 v[144:147], v[136:137], v[160:161], v[144:147]
    s_waitcnt lgkmcnt(0)
    v_cvt_f32_i32 v48, v48
    v_cvt_f32_i32 v49, v49
    v_cvt_f32_i32 v50, v50
    v_cvt_f32_i32 v51, v51
    v_cvt_f32_i32 v52, v52
    v_cvt_f32_i32 v53, v53
    v_cvt_f32_i32 v54, v54
    v_cvt_f32_i32 v55, v55
    v_cvt_f32_i32 v56, v56
    v_cvt_f32_i32 v57, v57
    v_cvt_f32_i32 v58, v58
    v_cvt_f32_i32 v59, v59
    v_sub_f32 v48, v48, v72
    v_sub_f32 v49, v49, v73
    v_sub_f32 v50, v50, v74
    v_sub_f32 v51, v51, v75
    v_sub_f32 v52, v52, v76
    v_sub_f32 v53, v53, v77
    v_sub_f32 v54, v54, v78
    v_sub_f32 v55, v55, v79
    v_sub_f32 v56, v56, v80
    v_sub_f32 v57, v57, v81
    v_sub_f32 v58, v58, v82
    v_sub_f32 v59, v59, v83
    v_cvt_pk_bf16_f32 v48, 0, v48
    v_cvt_pk_bf16_f32 v49, 0, v49
    v_cvt_pk_bf16_f32 v50, 0, v50
    v_cvt_pk_bf16_f32 v51, 0, v51
    v_cvt_pk_bf16_f32 v52, 0, v52
    v_cvt_pk_bf16_f32 v53, 0, v53
    v_cvt_pk_bf16_f32 v54, 0, v54
    v_cvt_pk_bf16_f32 v55, 0, v55
    v_cvt_pk_bf16_f32 v56, 0, v56
    v_cvt_pk_bf16_f32 v57, 0, v57
    v_cvt_pk_bf16_f32 v58, 0, v58
    v_cvt_pk_bf16_f32 v59, 0, v59
    v_mul_f32 v48, v48, v96
    v_mul_f32 v49, v49, v97
    v_mul_f32 v50, v50, v98
    v_mul_f32 v51, v51, v99
    v_mul_f32 v52, v52, v100
    v_mul_f32 v53, v53, v101
    v_mul_f32 v54, v54, v102
    v_mul_f32 v55, v55, v103
    v_mul_f32 v56, v56, v104
    v_mul_f32 v57, v57, v105
    v_mul_f32 v58, v58, v106
    v_mul_f32 v59, v59, v107
    v_cvt_pk_bf16_f32 v138, v48, v49
    v_cvt_pk_bf16_f32 v139, v50, v51
    v_add_f32_dpp v3, v147, v146 row_ror:12 row_mask:0xf bank_mask:0xf
    v_cvt_pk_bf16_f32 v140, v52, v53
    v_cvt_pk_bf16_f32 v141, v54, v55
    v_add_f32_dpp v3, v144, v3 row_ror:8 row_mask:0xf bank_mask:0xf
    v_cvt_pk_bf16_f32 v142, v56, v57
    v_cvt_pk_bf16_f32 v143, v58, v59
    v_add_f32_dpp v15, v145, v3 row_ror:4 row_mask:0xf bank_mask:0x4
    v_mfma_f32_16x16x16_bf16 v[148:151], v[138:139], v[156:157], 0
    v_mfma_f32_16x16x16_bf16 v[148:151], v[140:141], v[158:159], v[148:151]
    v_mfma_f32_16x16x16_bf16 v[148:151], v[142:143], v[160:161], v[148:151]
    v_add_u32 v33, s63, v31
    v_add_u32 v34, s63, v32
    ds_read_b64 v[108:109], v33 offset:0
    ds_read_b64 v[110:111], v33 offset:1536
    ds_read_b64 v[112:113], v33 offset:128
    ds_read_b64 v[114:115], v33 offset:1664
    ds_read_b64 v[116:117], v33 offset:256
    ds_read_b64 v[118:119], v33 offset:1792
    ds_read_b64 v[120:121], v34 offset:0
    v_add_f32_dpp v4, v151, v150 row_ror:12 row_mask:0xf bank_mask:0xf
    ds_read_b64 v[122:123], v34 offset:1536
    ds_read_b64 v[124:125], v34 offset:128
    v_add_f32_dpp v4, v148, v4 row_ror:8 row_mask:0xf bank_mask:0xf
    ds_read_b64 v[126:127], v34 offset:1664
    ds_read_b64 v[128:129], v34 offset:256
    ds_read_b64 v[130:131], v34 offset:1792
    v_add_f32_dpp v16, v149, v4 row_ror:4 row_mask:0xf bank_mask:0x4
    s_waitcnt lgkmcnt(0)
    v_lshlrev_b32 v60, 16, v108
    v_and_b32 v61, s66, v108
    v_lshlrev_b32 v62, 16, v109
    v_and_b32 v63, s66, v109
    v_lshlrev_b32 v84, 16, v110
    v_and_b32 v85, s66, v110
    v_lshlrev_b32 v86, 16, v111
    v_and_b32 v87, s66, v111
    v_lshlrev_b32 v64, 16, v112
    v_and_b32 v65, s66, v112
    v_lshlrev_b32 v66, 16, v113
    v_and_b32 v67, s66, v113
    v_lshlrev_b32 v88, 16, v114
    v_and_b32 v89, s66, v114
    v_lshlrev_b32 v90, 16, v115
    v_and_b32 v91, s66, v115
    v_lshlrev_b32 v68, 16, v116
    v_and_b32 v69, s66, v116
    v_lshlrev_b32 v70, 16, v117
    v_and_b32 v71, s66, v117
    v_lshlrev_b32 v92, 16, v118
    v_and_b32 v93, s66, v118
    v_lshlrev_b32 v94, 16, v119
    v_and_b32 v95, s66, v119
    v_lshlrev_b32 v72, 16, v120
    v_and_b32 v73, s66, v120
    v_lshlrev_b32 v74, 16, v121
    v_and_b32 v75, s66, v121
    v_lshlrev_b32 v96, 16, v122
    v_and_b32 v97, s66, v122
    v_lshlrev_b32 v98, 16, v123
    v_and_b32 v99, s66, v123
    v_lshlrev_b32 v76, 16, v124
    v_and_b32 v77, s66, v124
    v_lshlrev_b32 v78, 16, v125
    v_and_b32 v79, s66, v125
    v_lshlrev_b32 v100, 16, v126
    v_and_b32 v101, s66, v126
    v_lshlrev_b32 v102, 16, v127
    v_and_b32 v103, s66, v127
    v_lshlrev_b32 v80, 16, v128
    v_and_b32 v81, s66, v128
    v_lshlrev_b32 v82, 16, v129
    v_and_b32 v83, s66, v129
    v_lshlrev_b32 v104, 16, v130
    v_and_b32 v105, s66, v130
    v_lshlrev_b32 v106, 16, v131
    v_and_b32 v107, s66, v131
    v_add_u32 v13, s62, v12
    s_add_u32 s62, s62, 24576
    s_cmp_eq_u32 s62, 73728
    s_cselect_b32 s62, 0, s62
    s_barrier
    ds_read_b128 v[36:39], v13 offset:0
    ds_read_b128 v[40:43], v13 offset:256
    ds_read_b128 v[44:47], v13 offset:512
    ds_read_b128 v[48:51], v13 offset:3072
    ds_read_b128 v[52:55], v13 offset:3328
    ds_read_b128 v[56:59], v13 offset:3584
    s_waitcnt lgkmcnt(3)
    v_cvt_f32_i32 v36, v36
    v_cvt_f32_i32 v37, v37
    v_cvt_f32_i32 v38, v38
    v_cvt_f32_i32 v39, v39
    v_cvt_f32_i32 v40, v40
    v_cvt_f32_i32 v41, v41
    v_cvt_f32_i32 v42, v42
    v_cvt_f32_i32 v43, v43
    v_cvt_f32_i32 v44, v44
    v_cvt_f32_i32 v45, v45
    v_cvt_f32_i32 v46, v46
    v_cvt_f32_i32 v47, v47
    v_sub_f32 v36, v36, v60
    v_sub_f32 v37, v37, v61
    v_sub_f32 v38, v38, v62
    v_sub_f32 v39, v39, v63
    v_sub_f32 v40, v40, v64
    v_sub_f32 v41, v41, v65
    v_sub_f32 v42, v42, v66
    v_sub_f32 v43, v43, v67
    v_sub_f32 v44, v44, v68
    v_sub_f32 v45, v45, v69
    v_sub_f32 v46, v46, v70
    v_sub_f32 v47, v47, v71
    v_cvt_pk_bf16_f32 v36, 0, v36
    v_cvt_pk_bf16_f32 v37, 0, v37
    v_cvt_pk_bf16_f32 v38, 0, v38
    v_cvt_pk_bf16_f32 v39, 0, v39
    v_cvt_pk_bf16_f32 v40, 0, v40
    v_cvt_pk_bf16_f32 v41, 0, v41
    v_cvt_pk_bf16_f32 v42, 0, v42
    v_cvt_pk_bf16_f32 v43, 0, v43
    v_cvt_pk_bf16_f32 v44, 0, v44
    v_cvt_pk_bf16_f32 v45, 0, v45
    v_cvt_pk_bf16_f32 v46, 0, v46
    v_cvt_pk_bf16_f32 v47, 0, v47
    v_mul_f32 v36, v36, v84
    v_mul_f32 v37, v37, v85
    v_mul_f32 v38, v38, v86
    v_mul_f32 v39, v39, v87
    v_mul_f32 v40, v40, v88
    v_mul_f32 v41, v41, v89
    v_mul_f32 v42, v42, v90
    v_mul_f32 v43, v43, v91
    v_mul_f32 v44, v44, v92
    v_mul_f32 v45, v45, v93
    v_mul_f32 v46, v46, v94
    v_mul_f32 v47, v47, v95
    v_cvt_pk_bf16_f32 v132, v36, v37
    v_cvt_pk_bf16_f32 v133, v38, v39
    v_cvt_pk_bf16_f32 v134, v40, v41
    v_cvt_pk_bf16_f32 v135, v42, v43
    v_cvt_pk_bf16_f32 v136, v44, v45
    v_cvt_pk_bf16_f32 v137, v46, v47
    v_mfma_f32_16x16x16_bf16 v[144:147], v[132:133], v[156:157], 0
    v_mfma_f32_16x16x16_bf16 v[144:147], v[134:135], v[158:159], v[144:147]
    v_mfma_f32_16x16x16_bf16 v[144:147], v[136:137], v[160:161], v[144:147]
    s_waitcnt lgkmcnt(0)
    v_cvt_f32_i32 v48, v48
    v_cvt_f32_i32 v49, v49
    v_cvt_f32_i32 v50, v50
    v_cvt_f32_i32 v51, v51
    v_cvt_f32_i32 v52, v52
    v_cvt_f32_i32 v53, v53
    v_cvt_f32_i32 v54, v54
    v_cvt_f32_i32 v55, v55
    v_cvt_f32_i32 v56, v56
    v_cvt_f32_i32 v57, v57
    v_cvt_f32_i32 v58, v58
    v_cvt_f32_i32 v59, v59
    v_sub_f32 v48, v48, v72
    v_sub_f32 v49, v49, v73
    v_sub_f32 v50, v50, v74
    v_sub_f32 v51, v51, v75
    v_sub_f32 v52, v52, v76
    v_sub_f32 v53, v53, v77
    v_sub_f32 v54, v54, v78
    v_sub_f32 v55, v55, v79
    v_sub_f32 v56, v56, v80
    v_sub_f32 v57, v57, v81
    v_sub_f32 v58, v58, v82
    v_sub_f32 v59, v59, v83
    v_cvt_pk_bf16_f32 v48, 0, v48
    v_cvt_pk_bf16_f32 v49, 0, v49
    v_cvt_pk_bf16_f32 v50, 0, v50
    v_cvt_pk_bf16_f32 v51, 0, v51
    v_cvt_pk_bf16_f32 v52, 0, v52
    v_cvt_pk_bf16_f32 v53, 0, v53
    v_cvt_pk_bf16_f32 v54, 0, v54
    v_cvt_pk_bf16_f32 v55, 0, v55
    v_cvt_pk_bf16_f32 v56, 0, v56
    v_cvt_pk_bf16_f32 v57, 0, v57
    v_cvt_pk_bf16_f32 v58, 0, v58
    v_cvt_pk_bf16_f32 v59, 0, v59
    v_mul_f32 v48, v48, v96
    v_mul_f32 v49, v49, v97
    v_mul_f32 v50, v50, v98
    v_mul_f32 v51, v51, v99
    v_mul_f32 v52, v52, v100
    v_mul_f32 v53, v53, v101
    v_mul_f32 v54, v54, v102
    v_mul_f32 v55, v55, v103
    v_mul_f32 v56, v56, v104
    v_mul_f32 v57, v57, v105
    v_mul_f32 v58, v58, v106
    v_mul_f32 v59, v59, v107
    v_cvt_pk_bf16_f32 v138, v48, v49
    v_cvt_pk_bf16_f32 v139, v50, v51
    v_add_f32_dpp v3, v144, v147 row_ror:12 row_mask:0xf bank_mask:0xf
    v_cvt_pk_bf16_f32 v140, v52, v53
    v_cvt_pk_bf16_f32 v141, v54, v55
    v_add_f32_dpp v3, v145, v3 row_ror:8 row_mask:0xf bank_mask:0xf
    v_cvt_pk_bf16_f32 v142, v56, v57
    v_cvt_pk_bf16_f32 v143, v58, v59
    v_add_f32_dpp v15, v146, v3 row_ror:4 row_mask:0xf bank_mask:0x8
    v_mfma_f32_16x16x16_bf16 v[148:151], v[138:139], v[156:157], 0
    v_mfma_f32_16x16x16_bf16 v[148:151], v[140:141], v[158:159], v[148:151]
    v_mfma_f32_16x16x16_bf16 v[148:151], v[142:143], v[160:161], v[148:151]
    s_add_u32 s63, s63, 3072
    v_add_u32 v33, s63, v17
    v_add_u32 v34, s63, v18
    ds_read_b64 v[108:109], v33 offset:0
    ds_read_b64 v[110:111], v33 offset:1536
    ds_read_b64 v[112:113], v33 offset:128
    ds_read_b64 v[114:115], v33 offset:1664
    ds_read_b64 v[116:117], v33 offset:256
    ds_read_b64 v[118:119], v33 offset:1792
    ds_read_b64 v[120:121], v34 offset:0
    v_add_f32_dpp v4, v148, v151 row_ror:12 row_mask:0xf bank_mask:0xf
    ds_read_b64 v[122:123], v34 offset:1536
    ds_read_b64 v[124:125], v34 offset:128
    v_add_f32_dpp v4, v149, v4 row_ror:8 row_mask:0xf bank_mask:0xf
    ds_read_b64 v[126:127], v34 offset:1664
    ds_read_b64 v[128:129], v34 offset:256
    ds_read_b64 v[130:131], v34 offset:1792
    v_add_f32_dpp v16, v150, v4 row_ror:4 row_mask:0xf bank_mask:0x8
    v_cvt_pk_bf16_f32 v3, 0, v15
    v_cvt_pk_bf16_f32 v4, 0, v16
    v_mul_f32 v3, s65, v3
    v_mul_f32 v4, s65, v4
    v_cvt_pk_bf16_f32 v5, v3, v4
    v_max3_f32 v14, v14, v3, v4
    ds_write_b32 v11, v5 offset:256
    s_waitcnt lgkmcnt(0)
    v_lshlrev_b32 v60, 16, v108
    v_and_b32 v61, s66, v108
    v_lshlrev_b32 v62, 16, v109
    v_and_b32 v63, s66, v109
    v_lshlrev_b32 v84, 16, v110
    v_and_b32 v85, s66, v110
    v_lshlrev_b32 v86, 16, v111
    v_and_b32 v87, s66, v111
    v_lshlrev_b32 v64, 16, v112
    v_and_b32 v65, s66, v112
    v_lshlrev_b32 v66, 16, v113
    v_and_b32 v67, s66, v113
    v_lshlrev_b32 v88, 16, v114
    v_and_b32 v89, s66, v114
    v_lshlrev_b32 v90, 16, v115
    v_and_b32 v91, s66, v115
    v_lshlrev_b32 v68, 16, v116
    v_and_b32 v69, s66, v116
    v_lshlrev_b32 v70, 16, v117
    v_and_b32 v71, s66, v117
    v_lshlrev_b32 v92, 16, v118
    v_and_b32 v93, s66, v118
    v_lshlrev_b32 v94, 16, v119
    v_and_b32 v95, s66, v119
    v_lshlrev_b32 v72, 16, v120
    v_and_b32 v73, s66, v120
    v_lshlrev_b32 v74, 16, v121
    v_and_b32 v75, s66, v121
    v_lshlrev_b32 v96, 16, v122
    v_and_b32 v97, s66, v122
    v_lshlrev_b32 v98, 16, v123
    v_and_b32 v99, s66, v123
    v_lshlrev_b32 v76, 16, v124
    v_and_b32 v77, s66, v124
    v_lshlrev_b32 v78, 16, v125
    v_and_b32 v79, s66, v125
    v_lshlrev_b32 v100, 16, v126
    v_and_b32 v101, s66, v126
    v_lshlrev_b32 v102, 16, v127
    v_and_b32 v103, s66, v127
    v_lshlrev_b32 v80, 16, v128
    v_and_b32 v81, s66, v128
    v_lshlrev_b32 v82, 16, v129
    v_and_b32 v83, s66, v129
    v_lshlrev_b32 v104, 16, v130
    v_and_b32 v105, s66, v130
    v_lshlrev_b32 v106, 16, v131
    v_and_b32 v107, s66, v131
    v_add_u32 v11, 3072, v11
    s_add_u32 s61, s61, 1
    s_cmp_eq_u32 s61, s3
    s_cbranch_scc1 L_kblk_end
    s_cmp_eq_u32 s61, s73
    s_cbranch_scc1 L_kblk_end
    s_cmp_lt_u32 s61, 16
    s_cbranch_scc1 L_kblk
L_kblk_end:
    s_cmp_eq_u32 s74, 0
    s_cselect_b64 vcc, -1, 0
    v_cndmask_b32 v153, v153, v14, vcc
    s_cmp_eq_u32 s74, 1
    s_cselect_b64 vcc, -1, 0
    v_cndmask_b32 v154, v154, v14, vcc
    s_cmp_eq_u32 s74, 2
    s_cselect_b64 vcc, -1, 0
    v_cndmask_b32 v155, v155, v14, vcc
    s_add_u32 s74, s74, 1
    v_mov_b32 v156, v162
    v_mov_b32 v157, v163
    v_mov_b32 v158, v164
    v_mov_b32 v159, v165
    v_mov_b32 v160, v166
    v_mov_b32 v161, v167
    v_mov_b32 v162, v168
    v_mov_b32 v163, v169
    v_mov_b32 v164, v170
    v_mov_b32 v165, v171
    v_mov_b32 v166, v172
    v_mov_b32 v167, v173
    v_mov_b32 v14, 0xff800000
    s_cmp_lt_u32 s61, 16
    s_cbranch_scc1 L_kblk
    v_lshrrev_b32 v3, 4, v1
    v_and_b32 v4, 15, v1
    v_lshl_add_u32 v3, v2, 3, v3
    v_mul_u32_u24 v3, 768, v3
    v_lshl_add_u32 v12, v4, 4, v3
    v_subrev_u32 v11, 49152, v11
    s_mov_b32 s63, 0
    v_add_u32 v211, s63, v7
    v_add_u32 v212, s63, v8
    ds_read_b32 v210, v11 offset:0
    ds_read_u16 v213, v211 offset:512
    ds_read_u16 v214, v212 offset:512
    ds_read_u16 v211, v211
    ds_read_u16 v212, v212
    v_mov_b32 v204, 0
    v_mov_b32 v205, 0
    v_mov_b32 v206, 0
    v_mov_b32 v207, 0
    s_mov_b32 s61, 0
L_vround:
    v_mov_b32 v14, v153
    v_mov_b32 v153, v154
    v_mov_b32 v154, v155
    v_mov_b32 v156, 0
    v_mov_b32 v157, 0
    v_mov_b32 v158, 0
    v_mov_b32 v159, 0
    v_mov_b32 v160, 0
    v_mov_b32 v161, 0
    v_mov_b32 v162, 0
    v_mov_b32 v163, 0
    v_mov_b32 v164, 0
    v_mov_b32 v165, 0
    v_mov_b32 v166, 0
    v_mov_b32 v167, 0
    v_mov_b32 v168, 0
    v_mov_b32 v169, 0
    v_mov_b32 v170, 0
    v_mov_b32 v171, 0
    v_mov_b32 v172, 0
    v_mov_b32 v173, 0
    v_mov_b32 v174, 0
    v_mov_b32 v175, 0
    v_mov_b32 v176, 0
    v_mov_b32 v177, 0
    v_mov_b32 v178, 0
    v_mov_b32 v179, 0
    v_mov_b32 v180, 0
    v_mov_b32 v181, 0
    v_mov_b32 v182, 0
    v_mov_b32 v183, 0
    v_mov_b32 v184, 0
    v_mov_b32 v185, 0
    v_mov_b32 v186, 0
    v_mov_b32 v187, 0
    v_mov_b32 v188, 0
    v_mov_b32 v189, 0
    v_mov_b32 v190, 0
    v_mov_b32 v191, 0
    v_mov_b32 v192, 0
    v_mov_b32 v193, 0
    v_mov_b32 v194, 0
    v_mov_b32 v195, 0
    v_mov_b32 v196, 0
    v_mov_b32 v197, 0
    v_mov_b32 v198, 0
    v_mov_b32 v199, 0
    v_mov_b32 v200, 0
    v_mov_b32 v201, 0
    v_mov_b32 v202, 0
    v_mov_b32 v203, 0
    v_mov_b32 v208, 0
    v_mov_b32 v209, 0
    s_nop 1
    v_max_f32_dpp v14, v14, v14 row_ror:4 row_mask:0xf bank_mask:0xf
    s_nop 1
    v_max_f32_dpp v14, v14, v14 row_ror:8 row_mask:0xf bank_mask:0xf
    v_mov_b32 v3, v14
    s_nop 1
    v_permlane16_swap_b32 v14, v3
    v_max_f32 v14, v14, v3
    v_mov_b32 v3, v14
    s_nop 1
    v_permlane32_swap_b32 v14, v3
    v_max_f32 v14, v14, v3
    v_cvt_pk_bf16_f32 v14, 0, v14
    v_mul_f32 v14, s64, v14
L_vblk:
    v_add_u32 v13, s62, v12
    s_add_u32 s62, s62, 24576
    s_cmp_eq_u32 s62, 73728
    s_cselect_b32 s62, 0, s62
    s_barrier
    ds_read_b128 v[36:39], v13 offset:0
    ds_read_b128 v[40:43], v13 offset:256
    ds_read_b128 v[44:47], v13 offset:512
    ds_read_b128 v[48:51], v13 offset:3072
    ds_read_b128 v[52:55], v13 offset:3328
    ds_read_b128 v[56:59], v13 offset:3584
    s_waitcnt lgkmcnt(6)
    v_lshlrev_b32 v215, 16, v210
    v_and_b32 v216, s66, v210
    v_fma_f32 v215, v215, s64, -v14
    v_fma_f32 v216, v216, s64, -v14
    v_exp_f32 v215, v215
    v_exp_f32 v216, v216
    v_lshlrev_b32 v217, 16, v211
    v_lshlrev_b32 v218, 16, v212
    v_mul_f32 v217, v215, v217
    v_mul_f32 v218, v216, v218
    v_add_f32 v208, v208, v215
    v_cvt_pk_bf16_f32 v217, v217, v218
    v_add_f32 v208, v208, v216
    v_lshlrev_b32 v219, 16, v213
    v_lshlrev_b32 v220, 16, v214
    v_lshlrev_b32 v215, 16, v217
    v_and_b32 v216, s66, v217
    v_fmac_f32 v209, v215, v219
    v_fmac_f32 v209, v216, v220
    v_mov_b32_dpp v204, v217 quad_perm:[0,1,2,3] row_mask:0xf bank_mask:0x1
    v_mov_b32_dpp v205, v217 quad_perm:[0,1,2,3] row_mask:0xf bank_mask:0x2
    v_mov_b32_dpp v206, v217 quad_perm:[0,1,2,3] row_mask:0xf bank_mask:0x4
    v_mov_b32_dpp v207, v217 quad_perm:[0,1,2,3] row_mask:0xf bank_mask:0x8
    s_waitcnt lgkmcnt(3)
    v_cvt_f32_i32 v36, v36
    v_cvt_f32_i32 v37, v37
    v_cvt_f32_i32 v38, v38
    v_cvt_f32_i32 v39, v39
    v_cvt_f32_i32 v40, v40
    v_cvt_f32_i32 v41, v41
    v_cvt_f32_i32 v42, v42
    v_cvt_f32_i32 v43, v43
    v_cvt_f32_i32 v44, v44
    v_cvt_f32_i32 v45, v45
    v_cvt_f32_i32 v46, v46
    v_cvt_f32_i32 v47, v47
    s_waitcnt lgkmcnt(0)
    v_cvt_f32_i32 v48, v48
    v_cvt_f32_i32 v49, v49
    v_cvt_f32_i32 v50, v50
    v_cvt_f32_i32 v51, v51
    v_cvt_f32_i32 v52, v52
    v_cvt_f32_i32 v53, v53
    v_cvt_f32_i32 v54, v54
    v_cvt_f32_i32 v55, v55
    v_cvt_f32_i32 v56, v56
    v_cvt_f32_i32 v57, v57
    v_cvt_f32_i32 v58, v58
    v_cvt_f32_i32 v59, v59
    v_cvt_pk_bf16_f32 v60, v36, v48
    v_cvt_pk_bf16_f32 v64, v37, v49
    v_cvt_pk_bf16_f32 v68, v38, v50
    v_cvt_pk_bf16_f32 v72, v39, v51
    v_cvt_pk_bf16_f32 v76, v40, v52
    v_cvt_pk_bf16_f32 v80, v41, v53
    v_cvt_pk_bf16_f32 v84, v42, v54
    v_cvt_pk_bf16_f32 v88, v43, v55
    v_cvt_pk_bf16_f32 v92, v44, v56
    v_cvt_pk_bf16_f32 v96, v45, v57
    v_cvt_pk_bf16_f32 v100, v46, v58
    v_cvt_pk_bf16_f32 v104, v47, v59
    v_add_u32 v211, s63, v9
    v_add_u32 v212, s63, v10
    ds_read_b32 v210, v11 offset:256
    ds_read_u16 v213, v211 offset:512
    ds_read_u16 v214, v212 offset:512
    ds_read_u16 v211, v211
    ds_read_u16 v212, v212
    v_add_u32 v13, s62, v12
    s_add_u32 s62, s62, 24576
    s_cmp_eq_u32 s62, 73728
    s_cselect_b32 s62, 0, s62
    s_barrier
    ds_read_b128 v[36:39], v13 offset:0
    ds_read_b128 v[40:43], v13 offset:256
    ds_read_b128 v[44:47], v13 offset:512
    ds_read_b128 v[48:51], v13 offset:3072
    ds_read_b128 v[52:55], v13 offset:3328
    ds_read_b128 v[56:59], v13 offset:3584
    s_waitcnt lgkmcnt(3)
    v_cvt_f32_i32 v36, v36
    v_cvt_f32_i32 v37, v37
    v_cvt_f32_i32 v38, v38
    v_cvt_f32_i32 v39, v39
    v_cvt_f32_i32 v40, v40
    v_cvt_f32_i32 v41, v41
    v_cvt_f32_i32 v42, v42
    v_cvt_f32_i32 v43, v43
    v_cvt_f32_i32 v44, v44
    v_cvt_f32_i32 v45, v45
    v_cvt_f32_i32 v46, v46
    v_cvt_f32_i32 v47, v47
    s_waitcnt lgkmcnt(0)
    v_cvt_f32_i32 v48, v48
    v_cvt_f32_i32 v49, v49
    v_cvt_f32_i32 v50, v50
    v_cvt_f32_i32 v51, v51
    v_cvt_f32_i32 v52, v52
    v_cvt_f32_i32 v53, v53
    v_cvt_f32_i32 v54, v54
    v_cvt_f32_i32 v55, v55
    v_cvt_f32_i32 v56, v56
    v_cvt_f32_i32 v57, v57
    v_cvt_f32_i32 v58, v58
    v_cvt_f32_i32 v59, v59
    v_cvt_pk_bf16_f32 v61, v36, v48
    v_cvt_pk_bf16_f32 v65, v37, v49
    v_cvt_pk_bf16_f32 v69, v38, v50
    v_cvt_pk_bf16_f32 v73, v39, v51
    v_cvt_pk_bf16_f32 v77, v40, v52
    v_cvt_pk_bf16_f32 v81, v41, v53
    v_cvt_pk_bf16_f32 v85, v42, v54
    v_cvt_pk_bf16_f32 v89, v43, v55
    v_cvt_pk_bf16_f32 v93, v44, v56
    v_cvt_pk_bf16_f32 v97, v45, v57
    v_cvt_pk_bf16_f32 v101, v46, v58
    v_cvt_pk_bf16_f32 v105, v47, v59
    v_add_u32 v13, s62, v12
    s_add_u32 s62, s62, 24576
    s_cmp_eq_u32 s62, 73728
    s_cselect_b32 s62, 0, s62
    s_barrier
    ds_read_b128 v[36:39], v13 offset:0
    ds_read_b128 v[40:43], v13 offset:256
    ds_read_b128 v[44:47], v13 offset:512
    ds_read_b128 v[48:51], v13 offset:3072
    ds_read_b128 v[52:55], v13 offset:3328
    ds_read_b128 v[56:59], v13 offset:3584
    s_waitcnt lgkmcnt(3)
    v_cvt_f32_i32 v36, v36
    v_cvt_f32_i32 v37, v37
    v_cvt_f32_i32 v38, v38
    v_cvt_f32_i32 v39, v39
    v_cvt_f32_i32 v40, v40
    v_cvt_f32_i32 v41, v41
    v_cvt_f32_i32 v42, v42
    v_cvt_f32_i32 v43, v43
    v_cvt_f32_i32 v44, v44
    v_cvt_f32_i32 v45, v45
    v_cvt_f32_i32 v46, v46
    v_cvt_f32_i32 v47, v47
    s_waitcnt lgkmcnt(0)
    v_cvt_f32_i32 v48, v48
    v_cvt_f32_i32 v49, v49
    v_cvt_f32_i32 v50, v50
    v_cvt_f32_i32 v51, v51
    v_cvt_f32_i32 v52, v52
    v_cvt_f32_i32 v53, v53
    v_cvt_f32_i32 v54, v54
    v_cvt_f32_i32 v55, v55
    v_cvt_f32_i32 v56, v56
    v_cvt_f32_i32 v57, v57
    v_cvt_f32_i32 v58, v58
    v_cvt_f32_i32 v59, v59
    v_cvt_pk_bf16_f32 v62, v36, v48
    v_cvt_pk_bf16_f32 v66, v37, v49
    v_cvt_pk_bf16_f32 v70, v38, v50
    v_cvt_pk_bf16_f32 v74, v39, v51
    v_cvt_pk_bf16_f32 v78, v40, v52
    v_cvt_pk_bf16_f32 v82, v41, v53
    v_cvt_pk_bf16_f32 v86, v42, v54
    v_cvt_pk_bf16_f32 v90, v43, v55
    v_cvt_pk_bf16_f32 v94, v44, v56
    v_cvt_pk_bf16_f32 v98, v45, v57
    v_cvt_pk_bf16_f32 v102, v46, v58
    v_cvt_pk_bf16_f32 v106, v47, v59
    v_add_u32 v13, s62, v12
    s_add_u32 s62, s62, 24576
    s_cmp_eq_u32 s62, 73728
    s_cselect_b32 s62, 0, s62
    s_barrier
    ds_read_b128 v[36:39], v13 offset:0
    ds_read_b128 v[40:43], v13 offset:256
    ds_read_b128 v[44:47], v13 offset:512
    ds_read_b128 v[48:51], v13 offset:3072
    ds_read_b128 v[52:55], v13 offset:3328
    ds_read_b128 v[56:59], v13 offset:3584
    s_waitcnt lgkmcnt(3)
    v_cvt_f32_i32 v36, v36
    v_cvt_f32_i32 v37, v37
    v_cvt_f32_i32 v38, v38
    v_cvt_f32_i32 v39, v39
    v_cvt_f32_i32 v40, v40
    v_cvt_f32_i32 v41, v41
    v_cvt_f32_i32 v42, v42
    v_cvt_f32_i32 v43, v43
    v_cvt_f32_i32 v44, v44
    v_cvt_f32_i32 v45, v45
    v_cvt_f32_i32 v46, v46
    v_cvt_f32_i32 v47, v47
    s_waitcnt lgkmcnt(0)
    v_cvt_f32_i32 v48, v48
    v_cvt_f32_i32 v49, v49
    v_cvt_f32_i32 v50, v50
    v_cvt_f32_i32 v51, v51
    v_cvt_f32_i32 v52, v52
    v_cvt_f32_i32 v53, v53
    v_cvt_f32_i32 v54, v54
    v_cvt_f32_i32 v55, v55
    v_cvt_f32_i32 v56, v56
    v_cvt_f32_i32 v57, v57
    v_cvt_f32_i32 v58, v58
    v_cvt_f32_i32 v59, v59
    v_cvt_pk_bf16_f32 v63, v36, v48
    v_cvt_pk_bf16_f32 v67, v37, v49
    v_cvt_pk_bf16_f32 v71, v38, v50
    v_cvt_pk_bf16_f32 v75, v39, v51
    v_cvt_pk_bf16_f32 v79, v40, v52
    v_cvt_pk_bf16_f32 v83, v41, v53
    v_cvt_pk_bf16_f32 v87, v42, v54
    v_cvt_pk_bf16_f32 v91, v43, v55
    v_cvt_pk_bf16_f32 v95, v44, v56
    v_cvt_pk_bf16_f32 v99, v45, v57
    v_cvt_pk_bf16_f32 v103, v46, v58
    v_cvt_pk_bf16_f32 v107, v47, v59
    v_mfma_f32_16x16x32_bf16 v[156:159], v[204:207], v[60:63], v[156:159]
    v_mfma_f32_16x16x32_bf16 v[160:163], v[204:207], v[64:67], v[160:163]
    v_mfma_f32_16x16x32_bf16 v[164:167], v[204:207], v[68:71], v[164:167]
    v_mfma_f32_16x16x32_bf16 v[168:171], v[204:207], v[72:75], v[168:171]
    v_mfma_f32_16x16x32_bf16 v[172:175], v[204:207], v[76:79], v[172:175]
    v_mfma_f32_16x16x32_bf16 v[176:179], v[204:207], v[80:83], v[176:179]
    v_mfma_f32_16x16x32_bf16 v[180:183], v[204:207], v[84:87], v[180:183]
    v_mfma_f32_16x16x32_bf16 v[184:187], v[204:207], v[88:91], v[184:187]
    v_mfma_f32_16x16x32_bf16 v[188:191], v[204:207], v[92:95], v[188:191]
    v_mfma_f32_16x16x32_bf16 v[192:195], v[204:207], v[96:99], v[192:195]
    v_mfma_f32_16x16x32_bf16 v[196:199], v[204:207], v[100:103], v[196:199]
    v_mfma_f32_16x16x32_bf16 v[200:203], v[204:207], v[104:107], v[200:203]
    v_add_u32 v13, s62, v12
    s_add_u32 s62, s62, 24576
    s_cmp_eq_u32 s62, 73728
    s_cselect_b32 s62, 0, s62
    s_barrier
    ds_read_b128 v[36:39], v13 offset:0
    ds_read_b128 v[40:43], v13 offset:256
    ds_read_b128 v[44:47], v13 offset:512
    ds_read_b128 v[48:51], v13 offset:3072
    ds_read_b128 v[52:55], v13 offset:3328
    ds_read_b128 v[56:59], v13 offset:3584
    s_waitcnt lgkmcnt(6)
    v_lshlrev_b32 v215, 16, v210
    v_and_b32 v216, s66, v210
    v_fma_f32 v215, v215, s64, -v14
    v_fma_f32 v216, v216, s64, -v14
    v_exp_f32 v215, v215
    v_exp_f32 v216, v216
    v_lshlrev_b32 v217, 16, v211
    v_lshlrev_b32 v218, 16, v212
    v_mul_f32 v217, v215, v217
    v_mul_f32 v218, v216, v218
    v_add_f32 v208, v208, v215
    v_cvt_pk_bf16_f32 v217, v217, v218
    v_add_f32 v208, v208, v216
    v_lshlrev_b32 v219, 16, v213
    v_lshlrev_b32 v220, 16, v214
    v_lshlrev_b32 v215, 16, v217
    v_and_b32 v216, s66, v217
    v_fmac_f32 v209, v215, v219
    v_fmac_f32 v209, v216, v220
    v_mov_b32_dpp v204, v217 quad_perm:[0,1,2,3] row_mask:0xf bank_mask:0x1
    v_mov_b32_dpp v205, v217 quad_perm:[0,1,2,3] row_mask:0xf bank_mask:0x2
    v_mov_b32_dpp v206, v217 quad_perm:[0,1,2,3] row_mask:0xf bank_mask:0x4
    v_mov_b32_dpp v207, v217 quad_perm:[0,1,2,3] row_mask:0xf bank_mask:0x8
    s_waitcnt lgkmcnt(3)
    v_cvt_f32_i32 v36, v36
    v_cvt_f32_i32 v37, v37
    v_cvt_f32_i32 v38, v38
    v_cvt_f32_i32 v39, v39
    v_cvt_f32_i32 v40, v40
    v_cvt_f32_i32 v41, v41
    v_cvt_f32_i32 v42, v42
    v_cvt_f32_i32 v43, v43
    v_cvt_f32_i32 v44, v44
    v_cvt_f32_i32 v45, v45
    v_cvt_f32_i32 v46, v46
    v_cvt_f32_i32 v47, v47
    s_waitcnt lgkmcnt(0)
    v_cvt_f32_i32 v48, v48
    v_cvt_f32_i32 v49, v49
    v_cvt_f32_i32 v50, v50
    v_cvt_f32_i32 v51, v51
    v_cvt_f32_i32 v52, v52
    v_cvt_f32_i32 v53, v53
    v_cvt_f32_i32 v54, v54
    v_cvt_f32_i32 v55, v55
    v_cvt_f32_i32 v56, v56
    v_cvt_f32_i32 v57, v57
    v_cvt_f32_i32 v58, v58
    v_cvt_f32_i32 v59, v59
    v_cvt_pk_bf16_f32 v60, v36, v48
    v_cvt_pk_bf16_f32 v64, v37, v49
    v_cvt_pk_bf16_f32 v68, v38, v50
    v_cvt_pk_bf16_f32 v72, v39, v51
    v_cvt_pk_bf16_f32 v76, v40, v52
    v_cvt_pk_bf16_f32 v80, v41, v53
    v_cvt_pk_bf16_f32 v84, v42, v54
    v_cvt_pk_bf16_f32 v88, v43, v55
    v_cvt_pk_bf16_f32 v92, v44, v56
    v_cvt_pk_bf16_f32 v96, v45, v57
    v_cvt_pk_bf16_f32 v100, v46, v58
    v_cvt_pk_bf16_f32 v104, v47, v59
    v_add_u32 v11, 3072, v11
    s_add_u32 s63, s63, 1024
    v_add_u32 v211, s63, v7
    v_add_u32 v212, s63, v8
    ds_read_b32 v210, v11 offset:0
    ds_read_u16 v213, v211 offset:512
    ds_read_u16 v214, v212 offset:512
    ds_read_u16 v211, v211
    ds_read_u16 v212, v212
    v_add_u32 v13, s62, v12
    s_add_u32 s62, s62, 24576
    s_cmp_eq_u32 s62, 73728
    s_cselect_b32 s62, 0, s62
    s_barrier
    ds_read_b128 v[36:39], v13 offset:0
    ds_read_b128 v[40:43], v13 offset:256
    ds_read_b128 v[44:47], v13 offset:512
    ds_read_b128 v[48:51], v13 offset:3072
    ds_read_b128 v[52:55], v13 offset:3328
    ds_read_b128 v[56:59], v13 offset:3584
    s_waitcnt lgkmcnt(3)
    v_cvt_f32_i32 v36, v36
    v_cvt_f32_i32 v37, v37
    v_cvt_f32_i32 v38, v38
    v_cvt_f32_i32 v39, v39
    v_cvt_f32_i32 v40, v40
    v_cvt_f32_i32 v41, v41
    v_cvt_f32_i32 v42, v42
    v_cvt_f32_i32 v43, v43
    v_cvt_f32_i32 v44, v44
    v_cvt_f32_i32 v45, v45
    v_cvt_f32_i32 v46, v46
    v_cvt_f32_i32 v47, v47
    s_waitcnt lgkmcnt(0)
    v_cvt_f32_i32 v48, v48
    v_cvt_f32_i32 v49, v49
    v_cvt_f32_i32 v50, v50
    v_cvt_f32_i32 v51, v51
    v_cvt_f32_i32 v52, v52
    v_cvt_f32_i32 v53, v53
    v_cvt_f32_i32 v54, v54
    v_cvt_f32_i32 v55, v55
    v_cvt_f32_i32 v56, v56
    v_cvt_f32_i32 v57, v57
    v_cvt_f32_i32 v58, v58
    v_cvt_f32_i32 v59, v59
    v_cvt_pk_bf16_f32 v61, v36, v48
    v_cvt_pk_bf16_f32 v65, v37, v49
    v_cvt_pk_bf16_f32 v69, v38, v50
    v_cvt_pk_bf16_f32 v73, v39, v51
    v_cvt_pk_bf16_f32 v77, v40, v52
    v_cvt_pk_bf16_f32 v81, v41, v53
    v_cvt_pk_bf16_f32 v85, v42, v54
    v_cvt_pk_bf16_f32 v89, v43, v55
    v_cvt_pk_bf16_f32 v93, v44, v56
    v_cvt_pk_bf16_f32 v97, v45, v57
    v_cvt_pk_bf16_f32 v101, v46, v58
    v_cvt_pk_bf16_f32 v105, v47, v59
    v_add_u32 v13, s62, v12
    s_add_u32 s62, s62, 24576
    s_cmp_eq_u32 s62, 73728
    s_cselect_b32 s62, 0, s62
    s_barrier
    ds_read_b128 v[36:39], v13 offset:0
    ds_read_b128 v[40:43], v13 offset:256
    ds_read_b128 v[44:47], v13 offset:512
    ds_read_b128 v[48:51], v13 offset:3072
    ds_read_b128 v[52:55], v13 offset:3328
    ds_read_b128 v[56:59], v13 offset:3584
    s_waitcnt lgkmcnt(3)
    v_cvt_f32_i32 v36, v36
    v_cvt_f32_i32 v37, v37
    v_cvt_f32_i32 v38, v38
    v_cvt_f32_i32 v39, v39
    v_cvt_f32_i32 v40, v40
    v_cvt_f32_i32 v41, v41
    v_cvt_f32_i32 v42, v42
    v_cvt_f32_i32 v43, v43
    v_cvt_f32_i32 v44, v44
    v_cvt_f32_i32 v45, v45
    v_cvt_f32_i32 v46, v46
    v_cvt_f32_i32 v47, v47
    s_waitcnt lgkmcnt(0)
    v_cvt_f32_i32 v48, v48
    v_cvt_f32_i32 v49, v49
    v_cvt_f32_i32 v50, v50
    v_cvt_f32_i32 v51, v51
    v_cvt_f32_i32 v52, v52
    v_cvt_f32_i32 v53, v53
    v_cvt_f32_i32 v54, v54
    v_cvt_f32_i32 v55, v55
    v_cvt_f32_i32 v56, v56
    v_cvt_f32_i32 v57, v57
    v_cvt_f32_i32 v58, v58
    v_cvt_f32_i32 v59, v59
    v_cvt_pk_bf16_f32 v62, v36, v48
    v_cvt_pk_bf16_f32 v66, v37, v49
    v_cvt_pk_bf16_f32 v70, v38, v50
    v_cvt_pk_bf16_f32 v74, v39, v51
    v_cvt_pk_bf16_f32 v78, v40, v52
    v_cvt_pk_bf16_f32 v82, v41, v53
    v_cvt_pk_bf16_f32 v86, v42, v54
    v_cvt_pk_bf16_f32 v90, v43, v55
    v_cvt_pk_bf16_f32 v94, v44, v56
    v_cvt_pk_bf16_f32 v98, v45, v57
    v_cvt_pk_bf16_f32 v102, v46, v58
    v_cvt_pk_bf16_f32 v106, v47, v59
    v_add_u32 v13, s62, v12
    s_add_u32 s62, s62, 24576
    s_cmp_eq_u32 s62, 73728
    s_cselect_b32 s62, 0, s62
    s_barrier
    ds_read_b128 v[36:39], v13 offset:0
    ds_read_b128 v[40:43], v13 offset:256
    ds_read_b128 v[44:47], v13 offset:512
    ds_read_b128 v[48:51], v13 offset:3072
    ds_read_b128 v[52:55], v13 offset:3328
    ds_read_b128 v[56:59], v13 offset:3584
    s_waitcnt lgkmcnt(3)
    v_cvt_f32_i32 v36, v36
    v_cvt_f32_i32 v37, v37
    v_cvt_f32_i32 v38, v38
    v_cvt_f32_i32 v39, v39
    v_cvt_f32_i32 v40, v40
    v_cvt_f32_i32 v41, v41
    v_cvt_f32_i32 v42, v42
    v_cvt_f32_i32 v43, v43
    v_cvt_f32_i32 v44, v44
    v_cvt_f32_i32 v45, v45
    v_cvt_f32_i32 v46, v46
    v_cvt_f32_i32 v47, v47
    s_waitcnt lgkmcnt(0)
    v_cvt_f32_i32 v48, v48
    v_cvt_f32_i32 v49, v49
    v_cvt_f32_i32 v50, v50
    v_cvt_f32_i32 v51, v51
    v_cvt_f32_i32 v52, v52
    v_cvt_f32_i32 v53, v53
    v_cvt_f32_i32 v54, v54
    v_cvt_f32_i32 v55, v55
    v_cvt_f32_i32 v56, v56
    v_cvt_f32_i32 v57, v57
    v_cvt_f32_i32 v58, v58
    v_cvt_f32_i32 v59, v59
    v_cvt_pk_bf16_f32 v63, v36, v48
    v_cvt_pk_bf16_f32 v67, v37, v49
    v_cvt_pk_bf16_f32 v71, v38, v50
    v_cvt_pk_bf16_f32 v75, v39, v51
    v_cvt_pk_bf16_f32 v79, v40, v52
    v_cvt_pk_bf16_f32 v83, v41, v53
    v_cvt_pk_bf16_f32 v87, v42, v54
    v_cvt_pk_bf16_f32 v91, v43, v55
    v_cvt_pk_bf16_f32 v95, v44, v56
    v_cvt_pk_bf16_f32 v99, v45, v57
    v_cvt_pk_bf16_f32 v103, v46, v58
    v_cvt_pk_bf16_f32 v107, v47, v59
    v_mfma_f32_16x16x32_bf16 v[156:159], v[204:207], v[60:63], v[156:159]
    v_mfma_f32_16x16x32_bf16 v[160:163], v[204:207], v[64:67], v[160:163]
    v_mfma_f32_16x16x32_bf16 v[164:167], v[204:207], v[68:71], v[164:167]
    v_mfma_f32_16x16x32_bf16 v[168:171], v[204:207], v[72:75], v[168:171]
    v_mfma_f32_16x16x32_bf16 v[172:175], v[204:207], v[76:79], v[172:175]
    v_mfma_f32_16x16x32_bf16 v[176:179], v[204:207], v[80:83], v[176:179]
    v_mfma_f32_16x16x32_bf16 v[180:183], v[204:207], v[84:87], v[180:183]
    v_mfma_f32_16x16x32_bf16 v[184:187], v[204:207], v[88:91], v[184:187]
    v_mfma_f32_16x16x32_bf16 v[188:191], v[204:207], v[92:95], v[188:191]
    v_mfma_f32_16x16x32_bf16 v[192:195], v[204:207], v[96:99], v[192:195]
    v_mfma_f32_16x16x32_bf16 v[196:199], v[204:207], v[100:103], v[196:199]
    v_mfma_f32_16x16x32_bf16 v[200:203], v[204:207], v[104:107], v[200:203]
    s_add_u32 s61, s61, 1
    s_cmp_eq_u32 s61, s3
    s_cbranch_scc1 L_vblk_end
    s_cmp_eq_u32 s61, s73
    s_cbranch_scc1 L_vblk_end
    s_cmp_lt_u32 s61, 16
    s_cbranch_scc1 L_vblk
L_vblk_end:
    s_nop 1
    v_add_f32_dpp v208, v208, v208 row_ror:4 row_mask:0xf bank_mask:0xf
    s_nop 1
    v_add_f32_dpp v208, v208, v208 row_ror:8 row_mask:0xf bank_mask:0xf
    v_mov_b32 v3, v208
    s_nop 1
    v_permlane16_swap_b32 v208, v3
    v_add_f32 v208, v208, v3
    v_mov_b32 v3, v208
    s_nop 1
    v_permlane32_swap_b32 v208, v3
    v_add_f32 v208, v208, v3
    s_nop 1
    v_add_f32_dpp v209, v209, v209 row_ror:4 row_mask:0xf bank_mask:0xf
    s_nop 1
    v_add_f32_dpp v209, v209, v209 row_ror:8 row_mask:0xf bank_mask:0xf
    v_mov_b32 v3, v209
    s_nop 1
    v_permlane16_swap_b32 v209, v3
    v_add_f32 v209, v209, v3
    v_mov_b32 v3, v209
    s_nop 1
    v_permlane32_swap_b32 v209, v3
    v_add_f32 v209, v209, v3
    v_mov_b32 v36, v14
    v_mov_b32 v37, v208
    v_mov_b32 v38, v209
    v_mov_b32 v39, 0
    v_and_b32 v4, 3, v1
    v_lshl_add_u32 v4, v2, 2, v4
    v_lshlrev_b32 v4, 4, v4
    v_add_u32 v4, 142336, v4
    ds_write_b128 v4, v[36:39]
    v_permlane32_swap_b32 v156, v158
    v_permlane32_swap_b32 v157, v159
    v_permlane32_swap_b32 v160, v162
    v_permlane32_swap_b32 v161, v163
    v_permlane32_swap_b32 v164, v166
    v_permlane32_swap_b32 v165, v167
    v_permlane32_swap_b32 v168, v170
    v_permlane32_swap_b32 v169, v171
    v_permlane32_swap_b32 v172, v174
    v_permlane32_swap_b32 v173, v175
    v_permlane32_swap_b32 v176, v178
    v_permlane32_swap_b32 v177, v179
    v_permlane32_swap_b32 v180, v182
    v_permlane32_swap_b32 v181, v183
    v_permlane32_swap_b32 v184, v186
    v_permlane32_swap_b32 v185, v187
    v_permlane32_swap_b32 v188, v190
    v_permlane32_swap_b32 v189, v191
    v_permlane32_swap_b32 v192, v194
    v_permlane32_swap_b32 v193, v195
    v_permlane32_swap_b32 v196, v198
    v_permlane32_swap_b32 v197, v199
    v_permlane32_swap_b32 v200, v202
    v_permlane32_swap_b32 v201, v203
    v_add_f32 v156, v156, v158
    v_add_f32 v157, v157, v159
    v_add_f32 v160, v160, v162
    v_add_f32 v161, v161, v163
    v_add_f32 v164, v164, v166
    v_add_f32 v165, v165, v167
    v_add_f32 v168, v168, v170
    v_add_f32 v169, v169, v171
    v_add_f32 v172, v172, v174
    v_add_f32 v173, v173, v175
    v_add_f32 v176, v176, v178
    v_add_f32 v177, v177, v179
    v_add_f32 v180, v180, v182
    v_add_f32 v181, v181, v183
    v_add_f32 v184, v184, v186
    v_add_f32 v185, v185, v187
    v_add_f32 v188, v188, v190
    v_add_f32 v189, v189, v191
    v_add_f32 v192, v192, v194
    v_add_f32 v193, v193, v195
    v_add_f32 v196, v196, v198
    v_add_f32 v197, v197, v199
    v_add_f32 v200, v200, v202
    v_add_f32 v201, v201, v203
    s_nop 1
    v_permlane16_swap_b32 v156, v157
    v_permlane16_swap_b32 v160, v161
    v_permlane16_swap_b32 v164, v165
    v_permlane16_swap_b32 v168, v169
    v_permlane16_swap_b32 v172, v173
    v_permlane16_swap_b32 v176, v177
    v_permlane16_swap_b32 v180, v181
    v_permlane16_swap_b32 v184, v185
    v_permlane16_swap_b32 v188, v189
    v_permlane16_swap_b32 v192, v193
    v_permlane16_swap_b32 v196, v197
    v_permlane16_swap_b32 v200, v201
    v_add_f32 v40, v156, v157
    v_add_f32 v41, v160, v161
    v_add_f32 v42, v164, v165
    v_add_f32 v43, v168, v169
    v_add_f32 v44, v172, v173
    v_add_f32 v45, v176, v177
    v_add_f32 v46, v180, v181
    v_add_f32 v47, v184, v185
    v_add_f32 v48, v188, v189
    v_add_f32 v49, v192, v193
    v_add_f32 v50, v196, v197
    v_add_f32 v51, v200, v201
    v_lshrrev_b32 v3, 4, v1
    v_mul_u32_u24 v3, 768, v3
    v_and_b32 v4, 15, v1
    v_lshl_add_u32 v3, v4, 4, v3
    v_mul_u32_u24 v4, 3072, v2
    s_mov_b32 s58, 142592
    v_add3_u32 v4, v4, v3, s58
    ds_write_b128 v4, v[40:43] offset:0
    ds_write_b128 v4, v[44:47] offset:256
    ds_write_b128 v4, v[48:51] offset:512
    s_waitcnt lgkmcnt(0)
    s_cmp_lt_u32 s61, 16
    s_cbranch_scc1 L_vround
    s_barrier
    s_branch L_fin
L_finisher:
    v_lshrrev_b32 v8, 4, v1
    v_mul_u32_u24 v8, 768, v8
    v_and_b32 v13, 15, v1
    v_lshl_add_u32 v8, v13, 4, v8
    v_lshlrev_b32 v9, 4, v1
    v_and_b32 v14, 48, v1
    s_memrealtime s[96:97]
    s_waitcnt lgkmcnt(0)
    s_mov_b32 s48, s18
    s_and_b32 s49, s19, 0xffff
    s_mov_b32 s50, 393216
    s_mov_b32 s51, 0x20000
    s_mov_b32 s52, s20
    s_and_b32 s53, s21, 0xffff
    s_mov_b32 s54, 256
    s_mov_b32 s55, 0x20000
    s_mov_b32 s24, s22
    s_and_b32 s25, s23, 0xffff
    s_mov_b32 s26, 2611200
    s_mov_b32 s27, 0x20000
    s_cmp_eq_u32 s2, 0
    s_cbranch_scc0 L_fk
    s_or_b32 s71, s96, 1
    v_mov_b32 v16, s71
    v_mov_b32 v17, 0
    s_mov_b64 exec, 1
    buffer_atomic_cmpswap v[16:17], v9, s[52:55], 0 offen sc0 sc1
    s_mov_b64 exec, -1
    s_waitcnt vmcnt(0)
    v_readfirstlane_b32 s58, v16
    s_nop 3
    s_cmp_eq_u32 s58, 0
    s_cselect_b32 s71, s71, s58
L_fk:
    s_movk_i32 s69, 128
L_fb1:
    s_barrier
    s_sub_u32 s69, s69, 1
    s_cmp_lg_u32 s69, 0
    s_cbranch_scc1 L_fb1
    s_load_dword s71, s[20:21], 0
    s_barrier
    s_waitcnt lgkmcnt(0)
    s_cmp_eq_u32 s71, 0
    s_cbranch_scc0 L_ftag
    s_or_b32 s71, s96, 1
    v_mov_b32 v16, s71
    v_mov_b32 v17, 0
    s_mov_b64 exec, 1
    buffer_atomic_cmpswap v[16:17], v9, s[52:55], 0 offen sc0 sc1
    s_mov_b64 exec, -1
    s_waitcnt vmcnt(0)
    v_readfirstlane_b32 s58, v16
    s_nop 3
    s_cmp_eq_u32 s58, 0
    s_cselect_b32 s71, s71, s58
L_ftag:
    v_mov_b32 v10, s71
    s_mul_i32 s68, s100, 13056
    s_lshr_b32 s63, s101, 1
    s_lshl_b32 s58, s100, 1
    s_add_u32 s63, s63, s58
    s_mul_i32 s62, s63, 8704
    s_add_u32 s62, s62, 1114112
    s_cmp_eq_u32 s2, 255
    s_cbranch_scc1 L_fsolo
    s_cmp_eq_u32 s101, 1
    s_cbranch_scc1 L_fmid
    s_movk_i32 s69, 89
L_fb2:
    s_barrier
    s_sub_u32 s69, s69, 1
    s_cmp_lg_u32 s69, 0
    s_cbranch_scc1 L_fb2
    v_add_u32 v13, 142336, v14
    v_add_u32 v11, 142592, v8
    ds_read_b128 v[16:19], v13 offset:0
    ds_read_b128 v[20:23], v13 offset:64
    ds_read_b128 v[24:27], v13 offset:128
    ds_read_b128 v[28:31], v13 offset:192
    ds_read_b128 v[32:35], v11 offset:0
    ds_read_b128 v[36:39], v11 offset:256
    ds_read_b128 v[40:43], v11 offset:512
    ds_read_b128 v[44:47], v11 offset:3072
    ds_read_b128 v[48:51], v11 offset:3328
    ds_read_b128 v[52:55], v11 offset:3584
    ds_read_b128 v[56:59], v11 offset:6144
    ds_read_b128 v[60:63], v11 offset:6400
    ds_read_b128 v[64:67], v11 offset:6656
    s_waitcnt lgkmcnt(9)
    ds_read_b128 v[68:71], v11 offset:9216
    ds_read_b128 v[72:75], v11 offset:9472
    ds_read_b128 v[76:79], v11 offset:9728
    v_max_f32 v156, v16, v20
    v_max3_f32 v156, v156, v24, v28
    v_sub_f32 v16, v16, v156
    v_sub_f32 v20, v20, v156
    v_sub_f32 v24, v24, v156
    v_sub_f32 v28, v28, v156
    v_exp_f32 v16, v16
    v_exp_f32 v20, v20
    v_exp_f32 v24, v24
    v_exp_f32 v28, v28
    v_mov_b32 v143, v10
    v_mov_b32 v147, v10
    v_mov_b32 v151, v10
    v_mov_b32 v155, v10
    v_mov_b32 v159, v10
    v_mul_f32 v157, v16, v17
    v_mul_f32 v158, v16, v18
    v_fmac_f32 v157, v20, v21
    v_fmac_f32 v158, v20, v22
    v_fmac_f32 v157, v24, v25
    v_fmac_f32 v158, v24, v26
    v_fmac_f32 v157, v28, v29
    v_fmac_f32 v158, v28, v30
    s_waitcnt lgkmcnt(9)
    v_fma_f32 v140, v32, v16, -v158
    v_fma_f32 v141, v33, v16, -v158
    v_fma_f32 v142, v34, v16, -v158
    v_fma_f32 v144, v35, v16, -v158
    v_fma_f32 v145, v36, v16, -v158
    v_fma_f32 v146, v37, v16, -v158
    v_fma_f32 v148, v38, v16, -v158
    v_fma_f32 v149, v39, v16, -v158
    v_fma_f32 v150, v40, v16, -v158
    v_fma_f32 v152, v41, v16, -v158
    v_fma_f32 v153, v42, v16, -v158
    v_fma_f32 v154, v43, v16, -v158
    s_waitcnt lgkmcnt(6)
    v_fmac_f32 v140, v44, v20
    v_fmac_f32 v141, v45, v20
    v_fmac_f32 v142, v46, v20
    v_fmac_f32 v144, v47, v20
    v_fmac_f32 v145, v48, v20
    v_fmac_f32 v146, v49, v20
    v_fmac_f32 v148, v50, v20
    v_fmac_f32 v149, v51, v20
    v_fmac_f32 v150, v52, v20
    v_fmac_f32 v152, v53, v20
    v_fmac_f32 v153, v54, v20
    v_fmac_f32 v154, v55, v20
    s_waitcnt lgkmcnt(3)
    v_fmac_f32 v140, v56, v24
    v_fmac_f32 v141, v57, v24
    v_fmac_f32 v142, v58, v24
    v_fmac_f32 v144, v59, v24
    v_fmac_f32 v145, v60, v24
    v_fmac_f32 v146, v61, v24
    v_fmac_f32 v148, v62, v24
    v_fmac_f32 v149, v63, v24
    v_fmac_f32 v150, v64, v24
    v_fmac_f32 v152, v65, v24
    v_fmac_f32 v153, v66, v24
    v_fmac_f32 v154, v67, v24
    s_waitcnt lgkmcnt(0)
    v_fmac_f32 v140, v68, v28
    v_fmac_f32 v141, v69, v28
    v_fmac_f32 v142, v70, v28
    v_fmac_f32 v144, v71, v28
    v_fmac_f32 v145, v72, v28
    v_fmac_f32 v146, v73, v28
    v_fmac_f32 v148, v74, v28
    v_fmac_f32 v149, v75, v28
    v_fmac_f32 v150, v76, v28
    v_fmac_f32 v152, v77, v28
    v_fmac_f32 v153, v78, v28
    v_fmac_f32 v154, v79, v28
    s_movk_i32 s69, 39
L_fb3:
    s_barrier
    s_sub_u32 s69, s69, 1
    s_cmp_lg_u32 s69, 0
    s_cbranch_scc1 L_fb3
    s_add_u32 s58, s62, 4352
    s_add_u32 s59, s62, 8448
    buffer_load_dwordx4 v[176:179], v14, s[24:27], s59 offen sc1
    buffer_load_dwordx4 v[160:163], v9, s[24:27], s58 offen offset:0 sc1
    buffer_load_dwordx4 v[164:167], v9, s[24:27], s58 offen offset:1024 sc1
    buffer_load_dwordx4 v[168:171], v9, s[24:27], s58 offen offset:2048 sc1
    buffer_load_dwordx4 v[172:175], v9, s[24:27], s58 offen offset:3072 sc1
    s_barrier
    s_cmp_eq_u32 s101, 2
    s_cbranch_scc1 L_fo2
    v_add_u32 v13, 142336, v14
    v_add_u32 v11, 142592, v8
    ds_read_b128 v[16:19], v13 offset:0
    ds_read_b128 v[20:23], v13 offset:64
    ds_read_b128 v[24:27], v13 offset:128
    ds_read_b128 v[28:31], v13 offset:192
    ds_read_b128 v[32:35], v11 offset:0
    ds_read_b128 v[36:39], v11 offset:256
    ds_read_b128 v[40:43], v11 offset:512
    ds_read_b128 v[44:47], v11 offset:3072
    ds_read_b128 v[48:51], v11 offset:3328
    ds_read_b128 v[52:55], v11 offset:3584
    ds_read_b128 v[56:59], v11 offset:6144
    ds_read_b128 v[60:63], v11 offset:6400
    ds_read_b128 v[64:67], v11 offset:6656
    s_waitcnt lgkmcnt(9)
    ds_read_b128 v[68:71], v11 offset:9216
    ds_read_b128 v[72:75], v11 offset:9472
    ds_read_b128 v[76:79], v11 offset:9728
    v_max_f32 v96, v16, v20
    v_max3_f32 v96, v96, v24, v28
    v_sub_f32 v16, v16, v96
    v_sub_f32 v20, v20, v96
    v_sub_f32 v24, v24, v96
    v_sub_f32 v28, v28, v96
    v_exp_f32 v16, v16
    v_exp_f32 v20, v20
    v_exp_f32 v24, v24
    v_exp_f32 v28, v28
    v_mov_b32 v83, v10
    v_mov_b32 v87, v10
    v_mov_b32 v91, v10
    v_mov_b32 v95, v10
    v_mov_b32 v99, v10
    v_mul_f32 v97, v16, v17
    v_mul_f32 v98, v16, v18
    v_fmac_f32 v97, v20, v21
    v_fmac_f32 v98, v20, v22
    v_fmac_f32 v97, v24, v25
    v_fmac_f32 v98, v24, v26
    v_fmac_f32 v97, v28, v29
    v_fmac_f32 v98, v28, v30
    s_waitcnt lgkmcnt(9)
    v_fma_f32 v80, v32, v16, -v98
    v_fma_f32 v81, v33, v16, -v98
    v_fma_f32 v82, v34, v16, -v98
    v_fma_f32 v84, v35, v16, -v98
    v_fma_f32 v85, v36, v16, -v98
    v_fma_f32 v86, v37, v16, -v98
    v_fma_f32 v88, v38, v16, -v98
    v_fma_f32 v89, v39, v16, -v98
    v_fma_f32 v90, v40, v16, -v98
    v_fma_f32 v92, v41, v16, -v98
    v_fma_f32 v93, v42, v16, -v98
    v_fma_f32 v94, v43, v16, -v98
    s_waitcnt lgkmcnt(6)
    v_fmac_f32 v80, v44, v20
    v_fmac_f32 v81, v45, v20
    v_fmac_f32 v82, v46, v20
    v_fmac_f32 v84, v47, v20
    v_fmac_f32 v85, v48, v20
    v_fmac_f32 v86, v49, v20
    v_fmac_f32 v88, v50, v20
    v_fmac_f32 v89, v51, v20
    v_fmac_f32 v90, v52, v20
    v_fmac_f32 v92, v53, v20
    v_fmac_f32 v93, v54, v20
    v_fmac_f32 v94, v55, v20
    s_waitcnt lgkmcnt(3)
    v_fmac_f32 v80, v56, v24
    v_fmac_f32 v81, v57, v24
    v_fmac_f32 v82, v58, v24
    v_fmac_f32 v84, v59, v24
    v_fmac_f32 v85, v60, v24
    v_fmac_f32 v86, v61, v24
    v_fmac_f32 v88, v62, v24
    v_fmac_f32 v89, v63, v24
    v_fmac_f32 v90, v64, v24
    v_fmac_f32 v92, v65, v24
    v_fmac_f32 v93, v66, v24
    v_fmac_f32 v94, v67, v24
    s_waitcnt lgkmcnt(0)
    v_fmac_f32 v80, v68, v28
    v_fmac_f32 v81, v69, v28
    v_fmac_f32 v82, v70, v28
    v_fmac_f32 v84, v71, v28
    v_fmac_f32 v85, v72, v28
    v_fmac_f32 v86, v73, v28
    v_fmac_f32 v88, v74, v28
    v_fmac_f32 v89, v75, v28
    v_fmac_f32 v90, v76, v28
    v_fmac_f32 v92, v77, v28
    v_fmac_f32 v93, v78, v28
    v_fmac_f32 v94, v79, v28
    s_add_u32 s58, s68, 0
    s_add_u32 s59, s68, 4096
    buffer_store_dwordx4 v[80:83], v9, s[24:27], s58 offen offset:0 sc1
    buffer_store_dwordx4 v[84:87], v9, s[24:27], s58 offen offset:1024 sc1
    buffer_store_dwordx4 v[88:91], v9, s[24:27], s58 offen offset:2048 sc1
    buffer_store_dwordx4 v[92:95], v9, s[24:27], s58 offen offset:3072 sc1
    s_mov_b32 exec_lo, 0x00010001
    s_mov_b32 exec_hi, 0x00010001
    buffer_store_dwordx4 v[96:99], v14, s[24:27], s59 offen sc1
    s_mov_b64 exec, -1
    s_mov_b32 s70, 0
    s_waitcnt vmcnt(5)
    v_xor_b32 v13, v10, v163
    v_xor_b32 v11, v10, v167
    v_or_b32 v13, v13, v11
    v_xor_b32 v11, v10, v171
    v_or_b32 v13, v13, v11
    v_xor_b32 v11, v10, v175
    v_or_b32 v13, v13, v11
    v_xor_b32 v11, v10, v179
    v_or_b32 v13, v13, v11
    v_cmp_ne_u32 vcc, 0, v13
    s_nop 4
    s_cmp_eq_u64 vcc, 0
    s_cbranch_scc0 L_fo30
    v_max_f32 v11, v156, v176
    v_sub_f32 v16, v156, v11
    v_sub_f32 v17, v176, v11
    v_exp_f32 v16, v16
    v_exp_f32 v17, v17
    v_lshrrev_b32 v13, 1, v8
    v_mul_f32 v12, v16, v157
    v_fmac_f32 v12, v17, v177
    v_rcp_f32 v12, v12
    s_add_u32 s58, s63, 0
    s_mul_i32 s58, s58, 1536
    v_mul_f32 v16, v16, v12
    v_mul_f32 v17, v17, v12
    v_mul_f32 v32, v140, v16
    v_fmac_f32 v32, v160, v17
    v_mul_f32 v33, v141, v16
    v_fmac_f32 v33, v161, v17
    v_mul_f32 v34, v142, v16
    v_fmac_f32 v34, v162, v17
    v_mul_f32 v35, v144, v16
    v_fmac_f32 v35, v164, v17
    v_mul_f32 v36, v145, v16
    v_fmac_f32 v36, v165, v17
    v_mul_f32 v37, v146, v16
    v_fmac_f32 v37, v166, v17
    v_mul_f32 v38, v148, v16
    v_fmac_f32 v38, v168, v17
    v_mul_f32 v39, v149, v16
    v_fmac_f32 v39, v169, v17
    v_mul_f32 v40, v150, v16
    v_fmac_f32 v40, v170, v17
    v_mul_f32 v41, v152, v16
    v_fmac_f32 v41, v172, v17
    v_mul_f32 v42, v153, v16
    v_fmac_f32 v42, v173, v17
    v_mul_f32 v43, v154, v16
    v_fmac_f32 v43, v174, v17
    v_cvt_pk_bf16_f32 v44, v32, v33
    v_cvt_pk_bf16_f32 v45, v34, v35
    v_cvt_pk_bf16_f32 v46, v36, v37
    v_cvt_pk_bf16_f32 v47, v38, v39
    v_cvt_pk_bf16_f32 v48, v40, v41
    v_cvt_pk_bf16_f32 v49, v42, v43
    buffer_store_dwordx2 v[44:45], v13, s[48:51], s58 offen offset:0
    buffer_store_dwordx2 v[46:47], v13, s[48:51], s58 offen offset:128
    buffer_store_dwordx2 v[48:49], v13, s[48:51], s58 offen offset:256
    s_mov_b32 s70, 1
    s_waitcnt vmcnt(0)
    s_branch L_fo40
L_fo30:
    s_waitcnt vmcnt(0)
    s_add_u32 s58, s62, 4352
    s_add_u32 s59, s62, 8448
    buffer_load_dwordx4 v[176:179], v14, s[24:27], s59 offen sc1
    buffer_load_dwordx4 v[160:163], v9, s[24:27], s58 offen offset:0 sc1
    buffer_load_dwordx4 v[164:167], v9, s[24:27], s58 offen offset:1024 sc1
    buffer_load_dwordx4 v[168:171], v9, s[24:27], s58 offen offset:2048 sc1
    buffer_load_dwordx4 v[172:175], v9, s[24:27], s58 offen offset:3072 sc1
L_fo40:
    s_add_u32 s58, s68, 8704
    s_add_u32 s59, s68, 12800
    buffer_load_dwordx4 v[136:139], v14, s[24:27], s59 offen sc1
    buffer_load_dwordx4 v[120:123], v9, s[24:27], s58 offen offset:0 sc1
    buffer_load_dwordx4 v[124:127], v9, s[24:27], s58 offen offset:1024 sc1
    buffer_load_dwordx4 v[128:131], v9, s[24:27], s58 offen offset:2048 sc1
    buffer_load_dwordx4 v[132:135], v9, s[24:27], s58 offen offset:3072 sc1
    s_branch L_fo5
L_fo2:
    v_add_u32 v13, 142336, v14
    v_add_u32 v11, 142592, v8
    ds_read_b128 v[16:19], v13 offset:0
    ds_read_b128 v[20:23], v13 offset:64
    ds_read_b128 v[24:27], v13 offset:128
    ds_read_b128 v[28:31], v13 offset:192
    ds_read_b128 v[32:35], v11 offset:0
    ds_read_b128 v[36:39], v11 offset:256
    ds_read_b128 v[40:43], v11 offset:512
    ds_read_b128 v[44:47], v11 offset:3072
    ds_read_b128 v[48:51], v11 offset:3328
    ds_read_b128 v[52:55], v11 offset:3584
    ds_read_b128 v[56:59], v11 offset:6144
    ds_read_b128 v[60:63], v11 offset:6400
    ds_read_b128 v[64:67], v11 offset:6656
    s_waitcnt lgkmcnt(9)
    ds_read_b128 v[68:71], v11 offset:9216
    ds_read_b128 v[72:75], v11 offset:9472
    ds_read_b128 v[76:79], v11 offset:9728
    v_max_f32 v136, v16, v20
    v_max3_f32 v136, v136, v24, v28
    v_sub_f32 v16, v16, v136
    v_sub_f32 v20, v20, v136
    v_sub_f32 v24, v24, v136
    v_sub_f32 v28, v28, v136
    v_exp_f32 v16, v16
    v_exp_f32 v20, v20
    v_exp_f32 v24, v24
    v_exp_f32 v28, v28
    v_mov_b32 v123, v10
    v_mov_b32 v127, v10
    v_mov_b32 v131, v10
    v_mov_b32 v135, v10
    v_mov_b32 v139, v10
    v_mul_f32 v137, v16, v17
    v_mul_f32 v138, v16, v18
    v_fmac_f32 v137, v20, v21
    v_fmac_f32 v138, v20, v22
    v_fmac_f32 v137, v24, v25
    v_fmac_f32 v138, v24, v26
    v_fmac_f32 v137, v28, v29
    v_fmac_f32 v138, v28, v30
    s_waitcnt lgkmcnt(9)
    v_fma_f32 v120, v32, v16, -v138
    v_fma_f32 v121, v33, v16, -v138
    v_fma_f32 v122, v34, v16, -v138
    v_fma_f32 v124, v35, v16, -v138
    v_fma_f32 v125, v36, v16, -v138
    v_fma_f32 v126, v37, v16, -v138
    v_fma_f32 v128, v38, v16, -v138
    v_fma_f32 v129, v39, v16, -v138
    v_fma_f32 v130, v40, v16, -v138
    v_fma_f32 v132, v41, v16, -v138
    v_fma_f32 v133, v42, v16, -v138
    v_fma_f32 v134, v43, v16, -v138
    s_waitcnt lgkmcnt(6)
    v_fmac_f32 v120, v44, v20
    v_fmac_f32 v121, v45, v20
    v_fmac_f32 v122, v46, v20
    v_fmac_f32 v124, v47, v20
    v_fmac_f32 v125, v48, v20
    v_fmac_f32 v126, v49, v20
    v_fmac_f32 v128, v50, v20
    v_fmac_f32 v129, v51, v20
    v_fmac_f32 v130, v52, v20
    v_fmac_f32 v132, v53, v20
    v_fmac_f32 v133, v54, v20
    v_fmac_f32 v134, v55, v20
    s_waitcnt lgkmcnt(3)
    v_fmac_f32 v120, v56, v24
    v_fmac_f32 v121, v57, v24
    v_fmac_f32 v122, v58, v24
    v_fmac_f32 v124, v59, v24
    v_fmac_f32 v125, v60, v24
    v_fmac_f32 v126, v61, v24
    v_fmac_f32 v128, v62, v24
    v_fmac_f32 v129, v63, v24
    v_fmac_f32 v130, v64, v24
    v_fmac_f32 v132, v65, v24
    v_fmac_f32 v133, v66, v24
    v_fmac_f32 v134, v67, v24
    s_waitcnt lgkmcnt(0)
    v_fmac_f32 v120, v68, v28
    v_fmac_f32 v121, v69, v28
    v_fmac_f32 v122, v70, v28
    v_fmac_f32 v124, v71, v28
    v_fmac_f32 v125, v72, v28
    v_fmac_f32 v126, v73, v28
    v_fmac_f32 v128, v74, v28
    v_fmac_f32 v129, v75, v28
    v_fmac_f32 v130, v76, v28
    v_fmac_f32 v132, v77, v28
    v_fmac_f32 v133, v78, v28
    v_fmac_f32 v134, v79, v28
    s_add_u32 s58, s68, 8704
    s_add_u32 s59, s68, 12800
    buffer_store_dwordx4 v[120:123], v9, s[24:27], s58 offen offset:0 sc1
    buffer_store_dwordx4 v[124:127], v9, s[24:27], s58 offen offset:1024 sc1
    buffer_store_dwordx4 v[128:131], v9, s[24:27], s58 offen offset:2048 sc1
    buffer_store_dwordx4 v[132:135], v9, s[24:27], s58 offen offset:3072 sc1
    s_mov_b32 exec_lo, 0x00010001
    s_mov_b32 exec_hi, 0x00010001
    buffer_store_dwordx4 v[136:139], v14, s[24:27], s59 offen sc1
    s_mov_b64 exec, -1
    s_mov_b32 s70, 0
    s_waitcnt vmcnt(5)
    v_xor_b32 v13, v10, v163
    v_xor_b32 v11, v10, v167
    v_or_b32 v13, v13, v11
    v_xor_b32 v11, v10, v171
    v_or_b32 v13, v13, v11
    v_xor_b32 v11, v10, v175
    v_or_b32 v13, v13, v11
    v_xor_b32 v11, v10, v179
    v_or_b32 v13, v13, v11
    v_cmp_ne_u32 vcc, 0, v13
    s_nop 4
    s_cmp_eq_u64 vcc, 0
    s_cbranch_scc0 L_fo32
    v_max_f32 v11, v156, v176
    v_sub_f32 v16, v156, v11
    v_sub_f32 v17, v176, v11
    v_exp_f32 v16, v16
    v_exp_f32 v17, v17
    v_lshrrev_b32 v13, 1, v8
    v_mul_f32 v12, v16, v157
    v_fmac_f32 v12, v17, v177
    v_rcp_f32 v12, v12
    s_add_u32 s58, s63, 0
    s_mul_i32 s58, s58, 1536
    v_mul_f32 v16, v16, v12
    v_mul_f32 v17, v17, v12
    v_mul_f32 v32, v140, v16
    v_fmac_f32 v32, v160, v17
    v_mul_f32 v33, v141, v16
    v_fmac_f32 v33, v161, v17
    v_mul_f32 v34, v142, v16
    v_fmac_f32 v34, v162, v17
    v_mul_f32 v35, v144, v16
    v_fmac_f32 v35, v164, v17
    v_mul_f32 v36, v145, v16
    v_fmac_f32 v36, v165, v17
    v_mul_f32 v37, v146, v16
    v_fmac_f32 v37, v166, v17
    v_mul_f32 v38, v148, v16
    v_fmac_f32 v38, v168, v17
    v_mul_f32 v39, v149, v16
    v_fmac_f32 v39, v169, v17
    v_mul_f32 v40, v150, v16
    v_fmac_f32 v40, v170, v17
    v_mul_f32 v41, v152, v16
    v_fmac_f32 v41, v172, v17
    v_mul_f32 v42, v153, v16
    v_fmac_f32 v42, v173, v17
    v_mul_f32 v43, v154, v16
    v_fmac_f32 v43, v174, v17
    v_cvt_pk_bf16_f32 v44, v32, v33
    v_cvt_pk_bf16_f32 v45, v34, v35
    v_cvt_pk_bf16_f32 v46, v36, v37
    v_cvt_pk_bf16_f32 v47, v38, v39
    v_cvt_pk_bf16_f32 v48, v40, v41
    v_cvt_pk_bf16_f32 v49, v42, v43
    buffer_store_dwordx2 v[44:45], v13, s[48:51], s58 offen offset:0
    buffer_store_dwordx2 v[46:47], v13, s[48:51], s58 offen offset:128
    buffer_store_dwordx2 v[48:49], v13, s[48:51], s58 offen offset:256
    s_mov_b32 s70, 1
    s_waitcnt vmcnt(0)
    s_branch L_fo42
L_fo32:
    s_waitcnt vmcnt(0)
    s_add_u32 s58, s62, 4352
    s_add_u32 s59, s62, 8448
    buffer_load_dwordx4 v[176:179], v14, s[24:27], s59 offen sc1
    buffer_load_dwordx4 v[160:163], v9, s[24:27], s58 offen offset:0 sc1
    buffer_load_dwordx4 v[164:167], v9, s[24:27], s58 offen offset:1024 sc1
    buffer_load_dwordx4 v[168:171], v9, s[24:27], s58 offen offset:2048 sc1
    buffer_load_dwordx4 v[172:175], v9, s[24:27], s58 offen offset:3072 sc1
L_fo42:
    s_add_u32 s58, s68, 0
    s_add_u32 s59, s68, 4096
    buffer_load_dwordx4 v[96:99], v14, s[24:27], s59 offen sc1
    buffer_load_dwordx4 v[80:83], v9, s[24:27], s58 offen offset:0 sc1
    buffer_load_dwordx4 v[84:87], v9, s[24:27], s58 offen offset:1024 sc1
    buffer_load_dwordx4 v[88:91], v9, s[24:27], s58 offen offset:2048 sc1
    buffer_load_dwordx4 v[92:95], v9, s[24:27], s58 offen offset:3072 sc1
L_fo5:
    s_add_u32 s58, s68, 4352
    s_add_u32 s59, s68, 8448
    buffer_load_dwordx4 v[116:119], v14, s[24:27], s59 offen sc1
    buffer_load_dwordx4 v[100:103], v9, s[24:27], s58 offen offset:0 sc1
    buffer_load_dwordx4 v[104:107], v9, s[24:27], s58 offen offset:1024 sc1
    buffer_load_dwordx4 v[108:111], v9, s[24:27], s58 offen offset:2048 sc1
    buffer_load_dwordx4 v[112:115], v9, s[24:27], s58 offen offset:3072 sc1
    s_waitcnt vmcnt(0)
    v_xor_b32 v13, v10, v83
    v_xor_b32 v11, v10, v87
    v_or_b32 v13, v13, v11
    v_xor_b32 v11, v10, v91
    v_or_b32 v13, v13, v11
    v_xor_b32 v11, v10, v95
    v_or_b32 v13, v13, v11
    v_xor_b32 v11, v10, v99
    v_or_b32 v13, v13, v11
    v_xor_b32 v11, v10, v103
    v_or_b32 v13, v13, v11
    v_xor_b32 v11, v10, v107
    v_or_b32 v13, v13, v11
    v_xor_b32 v11, v10, v111
    v_or_b32 v13, v13, v11
    v_xor_b32 v11, v10, v115
    v_or_b32 v13, v13, v11
    v_xor_b32 v11, v10, v119
    v_or_b32 v13, v13, v11
    v_xor_b32 v11, v10, v123
    v_or_b32 v13, v13, v11
    v_xor_b32 v11, v10, v127
    v_or_b32 v13, v13, v11
    v_xor_b32 v11, v10, v131
    v_or_b32 v13, v13, v11
    v_xor_b32 v11, v10, v135
    v_or_b32 v13, v13, v11
    v_xor_b32 v11, v10, v139
    v_or_b32 v13, v13, v11
    v_cmp_ne_u32 vcc, 0, v13
    s_nop 4
    s_cmp_eq_u64 vcc, 0
    s_cbranch_scc0 L_fo6
    v_max3_f32 v11, v96, v116, v136
    v_sub_f32 v16, v96, v11
    v_sub_f32 v17, v116, v11
    v_sub_f32 v18, v136, v11
    v_exp_f32 v16, v16
    v_exp_f32 v17, v17
    v_exp_f32 v18, v18
    v_lshrrev_b32 v13, 1, v8
    v_mul_f32 v12, v16, v97
    v_fmac_f32 v12, v17, v117
    v_fmac_f32 v12, v18, v137
    v_rcp_f32 v12, v12
    s_add_u32 s58, s100, 171
    s_mul_i32 s58, s58, 1536
    v_mul_f32 v16, v16, v12
    v_mul_f32 v17, v17, v12
    v_mul_f32 v18, v18, v12
    v_mul_f32 v32, v80, v16
    v_fmac_f32 v32, v100, v17
    v_fmac_f32 v32, v120, v18
    v_mul_f32 v33, v81, v16
    v_fmac_f32 v33, v101, v17
    v_fmac_f32 v33, v121, v18
    v_mul_f32 v34, v82, v16
    v_fmac_f32 v34, v102, v17
    v_fmac_f32 v34, v122, v18
    v_mul_f32 v35, v84, v16
    v_fmac_f32 v35, v104, v17
    v_fmac_f32 v35, v124, v18
    v_mul_f32 v36, v85, v16
    v_fmac_f32 v36, v105, v17
    v_fmac_f32 v36, v125, v18
    v_mul_f32 v37, v86, v16
    v_fmac_f32 v37, v106, v17
    v_fmac_f32 v37, v126, v18
    v_mul_f32 v38, v88, v16
    v_fmac_f32 v38, v108, v17
    v_fmac_f32 v38, v128, v18
    v_mul_f32 v39, v89, v16
    v_fmac_f32 v39, v109, v17
    v_fmac_f32 v39, v129, v18
    v_mul_f32 v40, v90, v16
    v_fmac_f32 v40, v110, v17
    v_fmac_f32 v40, v130, v18
    v_mul_f32 v41, v92, v16
    v_fmac_f32 v41, v112, v17
    v_fmac_f32 v41, v132, v18
    v_mul_f32 v42, v93, v16
    v_fmac_f32 v42, v113, v17
    v_fmac_f32 v42, v133, v18
    v_mul_f32 v43, v94, v16
    v_fmac_f32 v43, v114, v17
    v_fmac_f32 v43, v134, v18
    v_cvt_pk_bf16_f32 v44, v32, v33
    v_cvt_pk_bf16_f32 v45, v34, v35
    v_cvt_pk_bf16_f32 v46, v36, v37
    v_cvt_pk_bf16_f32 v47, v38, v39
    v_cvt_pk_bf16_f32 v48, v40, v41
    v_cvt_pk_bf16_f32 v49, v42, v43
    buffer_store_dwordx2 v[44:45], v13, s[48:51], s58 offen offset:0
    buffer_store_dwordx2 v[46:47], v13, s[48:51], s58 offen offset:128
    buffer_store_dwordx2 v[48:49], v13, s[48:51], s58 offen offset:256
L_fo6:
    s_cmp_eq_u32 s70, 1
    s_cbranch_scc1 L_fin
    v_xor_b32 v13, v10, v163
    v_xor_b32 v11, v10, v167
    v_or_b32 v13, v13, v11
    v_xor_b32 v11, v10, v171
    v_or_b32 v13, v13, v11
    v_xor_b32 v11, v10, v175
    v_or_b32 v13, v13, v11
    v_xor_b32 v11, v10, v179
    v_or_b32 v13, v13, v11
    v_cmp_ne_u32 vcc, 0, v13
    s_nop 4
    s_cmp_eq_u64 vcc, 0
    s_cbranch_scc1 L_fo7
    s_add_u32 s58, s62, 0
    s_add_u32 s59, s62, 4096
    buffer_store_dwordx4 v[140:143], v9, s[24:27], s58 offen offset:0 sc1
    buffer_store_dwordx4 v[144:147], v9, s[24:27], s58 offen offset:1024 sc1
    buffer_store_dwordx4 v[148:151], v9, s[24:27], s58 offen offset:2048 sc1
    buffer_store_dwordx4 v[152:155], v9, s[24:27], s58 offen offset:3072 sc1
    s_mov_b32 exec_lo, 0x00010001
    s_mov_b32 exec_hi, 0x00010001
    buffer_store_dwordx4 v[156:159], v14, s[24:27], s59 offen sc1
    s_mov_b64 exec, -1
    s_waitcnt vmcnt(0)
    s_add_u32 s58, s62, 4352
    s_add_u32 s59, s62, 8448
    buffer_load_dwordx4 v[176:179], v14, s[24:27], s59 offen sc1
    buffer_load_dwordx4 v[160:163], v9, s[24:27], s58 offen offset:0 sc1
    buffer_load_dwordx4 v[164:167], v9, s[24:27], s58 offen offset:1024 sc1
    buffer_load_dwordx4 v[168:171], v9, s[24:27], s58 offen offset:2048 sc1
    buffer_load_dwordx4 v[172:175], v9, s[24:27], s58 offen offset:3072 sc1
    s_waitcnt vmcnt(0)
    v_xor_b32 v13, v10, v163
    v_xor_b32 v11, v10, v167
    v_or_b32 v13, v13, v11
    v_xor_b32 v11, v10, v171
    v_or_b32 v13, v13, v11
    v_xor_b32 v11, v10, v175
    v_or_b32 v13, v13, v11
    v_xor_b32 v11, v10, v179
    v_or_b32 v13, v13, v11
    v_cmp_ne_u32 vcc, 0, v13
    s_nop 4
    s_cmp_eq_u64 vcc, 0
    s_cbranch_scc0 L_fin
L_fo7:
    v_max_f32 v11, v156, v176
    v_sub_f32 v16, v156, v11
    v_sub_f32 v17, v176, v11
    v_exp_f32 v16, v16
    v_exp_f32 v17, v17
    v_lshrrev_b32 v13, 1, v8
    v_mul_f32 v12, v16, v157
    v_fmac_f32 v12, v17, v177
    v_rcp_f32 v12, v12
    s_add_u32 s58, s63, 0
    s_mul_i32 s58, s58, 1536
    v_mul_f32 v16, v16, v12
    v_mul_f32 v17, v17, v12
    v_mul_f32 v32, v140, v16
    v_fmac_f32 v32, v160, v17
    v_mul_f32 v33, v141, v16
    v_fmac_f32 v33, v161, v17
    v_mul_f32 v34, v142, v16
    v_fmac_f32 v34, v162, v17
    v_mul_f32 v35, v144, v16
    v_fmac_f32 v35, v164, v17
    v_mul_f32 v36, v145, v16
    v_fmac_f32 v36, v165, v17
    v_mul_f32 v37, v146, v16
    v_fmac_f32 v37, v166, v17
    v_mul_f32 v38, v148, v16
    v_fmac_f32 v38, v168, v17
    v_mul_f32 v39, v149, v16
    v_fmac_f32 v39, v169, v17
    v_mul_f32 v40, v150, v16
    v_fmac_f32 v40, v170, v17
    v_mul_f32 v41, v152, v16
    v_fmac_f32 v41, v172, v17
    v_mul_f32 v42, v153, v16
    v_fmac_f32 v42, v173, v17
    v_mul_f32 v43, v154, v16
    v_fmac_f32 v43, v174, v17
    v_cvt_pk_bf16_f32 v44, v32, v33
    v_cvt_pk_bf16_f32 v45, v34, v35
    v_cvt_pk_bf16_f32 v46, v36, v37
    v_cvt_pk_bf16_f32 v47, v38, v39
    v_cvt_pk_bf16_f32 v48, v40, v41
    v_cvt_pk_bf16_f32 v49, v42, v43
    buffer_store_dwordx2 v[44:45], v13, s[48:51], s58 offen offset:0
    buffer_store_dwordx2 v[46:47], v13, s[48:51], s58 offen offset:128
    buffer_store_dwordx2 v[48:49], v13, s[48:51], s58 offen offset:256
    s_branch L_fin
L_fmid:
    v_and_b32 v7, 1, v1
    v_mul_u32_u24 v7, 8704, v7
    v_add_u32 v7, 4108, v7
    s_movk_i32 s69, 41
L_fb4:
    s_barrier
    s_sub_u32 s69, s69, 1
    s_cmp_lg_u32 s69, 0
    s_cbranch_scc1 L_fb4
    v_add_u32 v13, 142336, v14
    v_add_u32 v11, 142592, v8
    ds_read_b128 v[16:19], v13 offset:0
    ds_read_b128 v[20:23], v13 offset:64
    ds_read_b128 v[24:27], v13 offset:128
    ds_read_b128 v[28:31], v13 offset:192
    ds_read_b128 v[32:35], v11 offset:0
    ds_read_b128 v[36:39], v11 offset:256
    ds_read_b128 v[40:43], v11 offset:512
    ds_read_b128 v[44:47], v11 offset:3072
    ds_read_b128 v[48:51], v11 offset:3328
    ds_read_b128 v[52:55], v11 offset:3584
    ds_read_b128 v[56:59], v11 offset:6144
    ds_read_b128 v[60:63], v11 offset:6400
    ds_read_b128 v[64:67], v11 offset:6656
    s_waitcnt lgkmcnt(9)
    ds_read_b128 v[68:71], v11 offset:9216
    ds_read_b128 v[72:75], v11 offset:9472
    ds_read_b128 v[76:79], v11 offset:9728
    v_max_f32 v156, v16, v20
    v_max3_f32 v156, v156, v24, v28
    v_sub_f32 v16, v16, v156
    v_sub_f32 v20, v20, v156
    v_sub_f32 v24, v24, v156
    v_sub_f32 v28, v28, v156
    v_exp_f32 v16, v16
    v_exp_f32 v20, v20
    v_exp_f32 v24, v24
    v_exp_f32 v28, v28
    v_mov_b32 v143, v10
    v_mov_b32 v147, v10
    v_mov_b32 v151, v10
    v_mov_b32 v155, v10
    v_mov_b32 v159, v10
    v_mul_f32 v157, v16, v17
    v_mul_f32 v158, v16, v18
    v_fmac_f32 v157, v20, v21
    v_fmac_f32 v158, v20, v22
    v_fmac_f32 v157, v24, v25
    v_fmac_f32 v158, v24, v26
    v_fmac_f32 v157, v28, v29
    v_fmac_f32 v158, v28, v30
    s_waitcnt lgkmcnt(9)
    v_fma_f32 v140, v32, v16, -v158
    v_fma_f32 v141, v33, v16, -v158
    v_fma_f32 v142, v34, v16, -v158
    v_fma_f32 v144, v35, v16, -v158
    v_fma_f32 v145, v36, v16, -v158
    v_fma_f32 v146, v37, v16, -v158
    v_fma_f32 v148, v38, v16, -v158
    v_fma_f32 v149, v39, v16, -v158
    v_fma_f32 v150, v40, v16, -v158
    v_fma_f32 v152, v41, v16, -v158
    v_fma_f32 v153, v42, v16, -v158
    v_fma_f32 v154, v43, v16, -v158
    s_waitcnt lgkmcnt(6)
    v_fmac_f32 v140, v44, v20
    v_fmac_f32 v141, v45, v20
    v_fmac_f32 v142, v46, v20
    v_fmac_f32 v144, v47, v20
    v_fmac_f32 v145, v48, v20
    v_fmac_f32 v146, v49, v20
    v_fmac_f32 v148, v50, v20
    v_fmac_f32 v149, v51, v20
    v_fmac_f32 v150, v52, v20
    v_fmac_f32 v152, v53, v20
    v_fmac_f32 v153, v54, v20
    v_fmac_f32 v154, v55, v20
    s_waitcnt lgkmcnt(3)
    v_fmac_f32 v140, v56, v24
    v_fmac_f32 v141, v57, v24
    v_fmac_f32 v142, v58, v24
    v_fmac_f32 v144, v59, v24
    v_fmac_f32 v145, v60, v24
    v_fmac_f32 v146, v61, v24
    v_fmac_f32 v148, v62, v24
    v_fmac_f32 v149, v63, v24
    v_fmac_f32 v150, v64, v24
    v_fmac_f32 v152, v65, v24
    v_fmac_f32 v153, v66, v24
    v_fmac_f32 v154, v67, v24
    s_waitcnt lgkmcnt(0)
    v_fmac_f32 v140, v68, v28
    v_fmac_f32 v141, v69, v28
    v_fmac_f32 v142, v70, v28
    v_fmac_f32 v144, v71, v28
    v_fmac_f32 v145, v72, v28
    v_fmac_f32 v146, v73, v28
    v_fmac_f32 v148, v74, v28
    v_fmac_f32 v149, v75, v28
    v_fmac_f32 v150, v76, v28
    v_fmac_f32 v152, v77, v28
    v_fmac_f32 v153, v78, v28
    v_fmac_f32 v154, v79, v28
    s_movk_i32 s69, 40
L_fb5:
    s_barrier
    s_sub_u32 s69, s69, 1
    s_cmp_lg_u32 s69, 0
    s_cbranch_scc1 L_fb5
    v_add_u32 v13, 142336, v14
    v_add_u32 v11, 142592, v8
    ds_read_b128 v[16:19], v13 offset:0
    ds_read_b128 v[20:23], v13 offset:64
    ds_read_b128 v[24:27], v13 offset:128
    ds_read_b128 v[28:31], v13 offset:192
    ds_read_b128 v[32:35], v11 offset:0
    ds_read_b128 v[36:39], v11 offset:256
    ds_read_b128 v[40:43], v11 offset:512
    ds_read_b128 v[44:47], v11 offset:3072
    ds_read_b128 v[48:51], v11 offset:3328
    ds_read_b128 v[52:55], v11 offset:3584
    ds_read_b128 v[56:59], v11 offset:6144
    ds_read_b128 v[60:63], v11 offset:6400
    ds_read_b128 v[64:67], v11 offset:6656
    s_waitcnt lgkmcnt(9)
    ds_read_b128 v[68:71], v11 offset:9216
    ds_read_b128 v[72:75], v11 offset:9472
    ds_read_b128 v[76:79], v11 offset:9728
    v_max_f32 v176, v16, v20
    v_max3_f32 v176, v176, v24, v28
    v_sub_f32 v16, v16, v176
    v_sub_f32 v20, v20, v176
    v_sub_f32 v24, v24, v176
    v_sub_f32 v28, v28, v176
    v_exp_f32 v16, v16
    v_exp_f32 v20, v20
    v_exp_f32 v24, v24
    v_exp_f32 v28, v28
    v_mov_b32 v163, v10
    v_mov_b32 v167, v10
    v_mov_b32 v171, v10
    v_mov_b32 v175, v10
    v_mov_b32 v179, v10
    v_mul_f32 v177, v16, v17
    v_mul_f32 v178, v16, v18
    v_fmac_f32 v177, v20, v21
    v_fmac_f32 v178, v20, v22
    v_fmac_f32 v177, v24, v25
    v_fmac_f32 v178, v24, v26
    v_fmac_f32 v177, v28, v29
    v_fmac_f32 v178, v28, v30
    s_waitcnt lgkmcnt(9)
    v_fma_f32 v160, v32, v16, -v178
    v_fma_f32 v161, v33, v16, -v178
    v_fma_f32 v162, v34, v16, -v178
    v_fma_f32 v164, v35, v16, -v178
    v_fma_f32 v165, v36, v16, -v178
    v_fma_f32 v166, v37, v16, -v178
    v_fma_f32 v168, v38, v16, -v178
    v_fma_f32 v169, v39, v16, -v178
    v_fma_f32 v170, v40, v16, -v178
    v_fma_f32 v172, v41, v16, -v178
    v_fma_f32 v173, v42, v16, -v178
    v_fma_f32 v174, v43, v16, -v178
    s_waitcnt lgkmcnt(6)
    v_fmac_f32 v160, v44, v20
    v_fmac_f32 v161, v45, v20
    v_fmac_f32 v162, v46, v20
    v_fmac_f32 v164, v47, v20
    v_fmac_f32 v165, v48, v20
    v_fmac_f32 v166, v49, v20
    v_fmac_f32 v168, v50, v20
    v_fmac_f32 v169, v51, v20
    v_fmac_f32 v170, v52, v20
    v_fmac_f32 v172, v53, v20
    v_fmac_f32 v173, v54, v20
    v_fmac_f32 v174, v55, v20
    s_waitcnt lgkmcnt(3)
    v_fmac_f32 v160, v56, v24
    v_fmac_f32 v161, v57, v24
    v_fmac_f32 v162, v58, v24
    v_fmac_f32 v164, v59, v24
    v_fmac_f32 v165, v60, v24
    v_fmac_f32 v166, v61, v24
    v_fmac_f32 v168, v62, v24
    v_fmac_f32 v169, v63, v24
    v_fmac_f32 v170, v64, v24
    v_fmac_f32 v172, v65, v24
    v_fmac_f32 v173, v66, v24
    v_fmac_f32 v174, v67, v24
    s_waitcnt lgkmcnt(0)
    v_fmac_f32 v160, v68, v28
    v_fmac_f32 v161, v69, v28
    v_fmac_f32 v162, v70, v28
    v_fmac_f32 v164, v71, v28
    v_fmac_f32 v165, v72, v28
    v_fmac_f32 v166, v73, v28
    v_fmac_f32 v168, v74, v28
    v_fmac_f32 v169, v75, v28
    v_fmac_f32 v170, v76, v28
    v_fmac_f32 v172, v77, v28
    v_fmac_f32 v173, v78, v28
    v_fmac_f32 v174, v79, v28
    s_movk_i32 s69, 46
L_fb6:
    s_barrier
    s_sub_u32 s69, s69, 1
    s_cmp_lg_u32 s69, 0
    s_cbranch_scc1 L_fb6
    s_add_u32 s58, s62, 4352
    s_add_u32 s59, s62, 8448
    buffer_store_dwordx4 v[140:143], v9, s[24:27], s58 offen offset:0 sc1
    buffer_store_dwordx4 v[144:147], v9, s[24:27], s58 offen offset:1024 sc1
    buffer_store_dwordx4 v[148:151], v9, s[24:27], s58 offen offset:2048 sc1
    buffer_store_dwordx4 v[152:155], v9, s[24:27], s58 offen offset:3072 sc1
    s_mov_b32 exec_lo, 0x00010001
    s_mov_b32 exec_hi, 0x00010001
    buffer_store_dwordx4 v[156:159], v14, s[24:27], s59 offen sc1
    s_mov_b64 exec, -1
    s_add_u32 s58, s62, 13056
    s_add_u32 s59, s62, 17152
    buffer_store_dwordx4 v[160:163], v9, s[24:27], s58 offen offset:0 sc1
    buffer_store_dwordx4 v[164:167], v9, s[24:27], s58 offen offset:1024 sc1
    buffer_store_dwordx4 v[168:171], v9, s[24:27], s58 offen offset:2048 sc1
    buffer_store_dwordx4 v[172:175], v9, s[24:27], s58 offen offset:3072 sc1
    s_mov_b32 exec_lo, 0x00010001
    s_mov_b32 exec_hi, 0x00010001
    buffer_store_dwordx4 v[176:179], v14, s[24:27], s59 offen sc1
    s_mov_b64 exec, -1
    s_barrier
    s_add_u32 s58, s68, 0
    s_add_u32 s59, s68, 4096
    buffer_load_dwordx4 v[96:99], v14, s[24:27], s59 offen sc1
    buffer_load_dwordx4 v[80:83], v9, s[24:27], s58 offen offset:0 sc1
    buffer_load_dwordx4 v[84:87], v9, s[24:27], s58 offen offset:1024 sc1
    buffer_load_dwordx4 v[88:91], v9, s[24:27], s58 offen offset:2048 sc1
    buffer_load_dwordx4 v[92:95], v9, s[24:27], s58 offen offset:3072 sc1
    s_add_u32 s58, s68, 8704
    s_add_u32 s59, s68, 12800
    buffer_load_dwordx4 v[136:139], v14, s[24:27], s59 offen sc1
    buffer_load_dwordx4 v[120:123], v9, s[24:27], s58 offen offset:0 sc1
    buffer_load_dwordx4 v[124:127], v9, s[24:27], s58 offen offset:1024 sc1
    buffer_load_dwordx4 v[128:131], v9, s[24:27], s58 offen offset:2048 sc1
    buffer_load_dwordx4 v[132:135], v9, s[24:27], s58 offen offset:3072 sc1
    s_barrier
    v_add_u32 v13, 142336, v14
    v_add_u32 v11, 142592, v8
    ds_read_b128 v[16:19], v13 offset:0
    ds_read_b128 v[20:23], v13 offset:64
    ds_read_b128 v[24:27], v13 offset:128
    ds_read_b128 v[28:31], v13 offset:192
    ds_read_b128 v[32:35], v11 offset:0
    ds_read_b128 v[36:39], v11 offset:256
    ds_read_b128 v[40:43], v11 offset:512
    ds_read_b128 v[44:47], v11 offset:3072
    ds_read_b128 v[48:51], v11 offset:3328
    ds_read_b128 v[52:55], v11 offset:3584
    ds_read_b128 v[56:59], v11 offset:6144
    ds_read_b128 v[60:63], v11 offset:6400
    ds_read_b128 v[64:67], v11 offset:6656
    s_waitcnt lgkmcnt(9)
    ds_read_b128 v[68:71], v11 offset:9216
    ds_read_b128 v[72:75], v11 offset:9472
    ds_read_b128 v[76:79], v11 offset:9728
    v_max_f32 v116, v16, v20
    v_max3_f32 v116, v116, v24, v28
    v_sub_f32 v16, v16, v116
    v_sub_f32 v20, v20, v116
    v_sub_f32 v24, v24, v116
    v_sub_f32 v28, v28, v116
    v_exp_f32 v16, v16
    v_exp_f32 v20, v20
    v_exp_f32 v24, v24
    v_exp_f32 v28, v28
    v_mov_b32 v103, v10
    v_mov_b32 v107, v10
    v_mov_b32 v111, v10
    v_mov_b32 v115, v10
    v_mov_b32 v119, v10
    v_mul_f32 v117, v16, v17
    v_mul_f32 v118, v16, v18
    v_fmac_f32 v117, v20, v21
    v_fmac_f32 v118, v20, v22
    v_fmac_f32 v117, v24, v25
    v_fmac_f32 v118, v24, v26
    v_fmac_f32 v117, v28, v29
    v_fmac_f32 v118, v28, v30
    s_waitcnt lgkmcnt(9)
    v_fma_f32 v100, v32, v16, -v118
    v_fma_f32 v101, v33, v16, -v118
    v_fma_f32 v102, v34, v16, -v118
    v_fma_f32 v104, v35, v16, -v118
    v_fma_f32 v105, v36, v16, -v118
    v_fma_f32 v106, v37, v16, -v118
    v_fma_f32 v108, v38, v16, -v118
    v_fma_f32 v109, v39, v16, -v118
    v_fma_f32 v110, v40, v16, -v118
    v_fma_f32 v112, v41, v16, -v118
    v_fma_f32 v113, v42, v16, -v118
    v_fma_f32 v114, v43, v16, -v118
    s_waitcnt lgkmcnt(6)
    v_fmac_f32 v100, v44, v20
    v_fmac_f32 v101, v45, v20
    v_fmac_f32 v102, v46, v20
    v_fmac_f32 v104, v47, v20
    v_fmac_f32 v105, v48, v20
    v_fmac_f32 v106, v49, v20
    v_fmac_f32 v108, v50, v20
    v_fmac_f32 v109, v51, v20
    v_fmac_f32 v110, v52, v20
    v_fmac_f32 v112, v53, v20
    v_fmac_f32 v113, v54, v20
    v_fmac_f32 v114, v55, v20
    s_waitcnt lgkmcnt(3)
    v_fmac_f32 v100, v56, v24
    v_fmac_f32 v101, v57, v24
    v_fmac_f32 v102, v58, v24
    v_fmac_f32 v104, v59, v24
    v_fmac_f32 v105, v60, v24
    v_fmac_f32 v106, v61, v24
    v_fmac_f32 v108, v62, v24
    v_fmac_f32 v109, v63, v24
    v_fmac_f32 v110, v64, v24
    v_fmac_f32 v112, v65, v24
    v_fmac_f32 v113, v66, v24
    v_fmac_f32 v114, v67, v24
    s_waitcnt lgkmcnt(0)
    v_fmac_f32 v100, v68, v28
    v_fmac_f32 v101, v69, v28
    v_fmac_f32 v102, v70, v28
    v_fmac_f32 v104, v71, v28
    v_fmac_f32 v105, v72, v28
    v_fmac_f32 v106, v73, v28
    v_fmac_f32 v108, v74, v28
    v_fmac_f32 v109, v75, v28
    v_fmac_f32 v110, v76, v28
    v_fmac_f32 v112, v77, v28
    v_fmac_f32 v113, v78, v28
    v_fmac_f32 v114, v79, v28
    s_waitcnt vmcnt(0)
    buffer_load_dword v15, v7, s[24:27], s62 offen sc1
    v_xor_b32 v13, v10, v83
    v_xor_b32 v11, v10, v87
    v_or_b32 v13, v13, v11
    v_xor_b32 v11, v10, v91
    v_or_b32 v13, v13, v11
    v_xor_b32 v11, v10, v95
    v_or_b32 v13, v13, v11
    v_xor_b32 v11, v10, v99
    v_or_b32 v13, v13, v11
    v_xor_b32 v11, v10, v123
    v_or_b32 v13, v13, v11
    v_xor_b32 v11, v10, v127
    v_or_b32 v13, v13, v11
    v_xor_b32 v11, v10, v131
    v_or_b32 v13, v13, v11
    v_xor_b32 v11, v10, v135
    v_or_b32 v13, v13, v11
    v_xor_b32 v11, v10, v139
    v_or_b32 v13, v13, v11
    v_cmp_ne_u32 vcc, 0, v13
    s_nop 4
    s_cmp_eq_u64 vcc, 0
    s_cbranch_scc1 L_fm1
    s_add_u32 s58, s68, 4352
    s_add_u32 s59, s68, 8448
    buffer_store_dwordx4 v[100:103], v9, s[24:27], s58 offen offset:0 sc1
    buffer_store_dwordx4 v[104:107], v9, s[24:27], s58 offen offset:1024 sc1
    buffer_store_dwordx4 v[108:111], v9, s[24:27], s58 offen offset:2048 sc1
    buffer_store_dwordx4 v[112:115], v9, s[24:27], s58 offen offset:3072 sc1
    s_mov_b32 exec_lo, 0x00010001
    s_mov_b32 exec_hi, 0x00010001
    buffer_store_dwordx4 v[116:119], v14, s[24:27], s59 offen sc1
    s_mov_b64 exec, -1
    s_waitcnt vmcnt(0)
    s_add_u32 s58, s68, 0
    s_add_u32 s59, s68, 4096
    buffer_load_dwordx4 v[96:99], v14, s[24:27], s59 offen sc1
    buffer_load_dwordx4 v[80:83], v9, s[24:27], s58 offen offset:0 sc1
    buffer_load_dwordx4 v[84:87], v9, s[24:27], s58 offen offset:1024 sc1
    buffer_load_dwordx4 v[88:91], v9, s[24:27], s58 offen offset:2048 sc1
    buffer_load_dwordx4 v[92:95], v9, s[24:27], s58 offen offset:3072 sc1
    s_add_u32 s58, s68, 8704
    s_add_u32 s59, s68, 12800
    buffer_load_dwordx4 v[136:139], v14, s[24:27], s59 offen sc1
    buffer_load_dwordx4 v[120:123], v9, s[24:27], s58 offen offset:0 sc1
    buffer_load_dwordx4 v[124:127], v9, s[24:27], s58 offen offset:1024 sc1
    buffer_load_dwordx4 v[128:131], v9, s[24:27], s58 offen offset:2048 sc1
    buffer_load_dwordx4 v[132:135], v9, s[24:27], s58 offen offset:3072 sc1
    s_waitcnt vmcnt(0)
    v_xor_b32 v13, v10, v83
    v_xor_b32 v11, v10, v87
    v_or_b32 v13, v13, v11
    v_xor_b32 v11, v10, v91
    v_or_b32 v13, v13, v11
    v_xor_b32 v11, v10, v95
    v_or_b32 v13, v13, v11
    v_xor_b32 v11, v10, v99
    v_or_b32 v13, v13, v11
    v_xor_b32 v11, v10, v123
    v_or_b32 v13, v13, v11
    v_xor_b32 v11, v10, v127
    v_or_b32 v13, v13, v11
    v_xor_b32 v11, v10, v131
    v_or_b32 v13, v13, v11
    v_xor_b32 v11, v10, v135
    v_or_b32 v13, v13, v11
    v_xor_b32 v11, v10, v139
    v_or_b32 v13, v13, v11
    v_cmp_ne_u32 vcc, 0, v13
    s_nop 4
    s_cmp_eq_u64 vcc, 0
    s_cbranch_scc0 L_fm2
L_fm1:
    v_max3_f32 v11, v96, v116, v136
    v_sub_f32 v16, v96, v11
    v_sub_f32 v17, v116, v11
    v_sub_f32 v18, v136, v11
    v_exp_f32 v16, v16
    v_exp_f32 v17, v17
    v_exp_f32 v18, v18
    v_lshrrev_b32 v13, 1, v8
    v_mul_f32 v12, v16, v97
    v_fmac_f32 v12, v17, v117
    v_fmac_f32 v12, v18, v137
    v_rcp_f32 v12, v12
    s_add_u32 s58, s100, 171
    s_mul_i32 s58, s58, 1536
    v_mul_f32 v16, v16, v12
    v_mul_f32 v17, v17, v12
    v_mul_f32 v18, v18, v12
    v_mul_f32 v32, v80, v16
    v_fmac_f32 v32, v100, v17
    v_fmac_f32 v32, v120, v18
    v_mul_f32 v33, v81, v16
    v_fmac_f32 v33, v101, v17
    v_fmac_f32 v33, v121, v18
    v_mul_f32 v34, v82, v16
    v_fmac_f32 v34, v102, v17
    v_fmac_f32 v34, v122, v18
    v_mul_f32 v35, v84, v16
    v_fmac_f32 v35, v104, v17
    v_fmac_f32 v35, v124, v18
    v_mul_f32 v36, v85, v16
    v_fmac_f32 v36, v105, v17
    v_fmac_f32 v36, v125, v18
    v_mul_f32 v37, v86, v16
    v_fmac_f32 v37, v106, v17
    v_fmac_f32 v37, v126, v18
    v_mul_f32 v38, v88, v16
    v_fmac_f32 v38, v108, v17
    v_fmac_f32 v38, v128, v18
    v_mul_f32 v39, v89, v16
    v_fmac_f32 v39, v109, v17
    v_fmac_f32 v39, v129, v18
    v_mul_f32 v40, v90, v16
    v_fmac_f32 v40, v110, v17
    v_fmac_f32 v40, v130, v18
    v_mul_f32 v41, v92, v16
    v_fmac_f32 v41, v112, v17
    v_fmac_f32 v41, v132, v18
    v_mul_f32 v42, v93, v16
    v_fmac_f32 v42, v113, v17
    v_fmac_f32 v42, v133, v18
    v_mul_f32 v43, v94, v16
    v_fmac_f32 v43, v114, v17
    v_fmac_f32 v43, v134, v18
    v_cvt_pk_bf16_f32 v44, v32, v33
    v_cvt_pk_bf16_f32 v45, v34, v35
    v_cvt_pk_bf16_f32 v46, v36, v37
    v_cvt_pk_bf16_f32 v47, v38, v39
    v_cvt_pk_bf16_f32 v48, v40, v41
    v_cvt_pk_bf16_f32 v49, v42, v43
    buffer_store_dwordx2 v[44:45], v13, s[48:51], s58 offen offset:0
    buffer_store_dwordx2 v[46:47], v13, s[48:51], s58 offen offset:128
    buffer_store_dwordx2 v[48:49], v13, s[48:51], s58 offen offset:256
    s_waitcnt vmcnt(3)
L_fm2:
    v_cmp_eq_u32 vcc, v15, v10
    s_nop 4
    s_and_b32 s70, vcc_lo, 3
    s_cbranch_scc0 L_fin
    s_bitcmp1_b32 s70, 0
    s_cbranch_scc0 L_fm30
    s_waitcnt vmcnt(0)
    s_add_u32 s58, s62, 0
    s_add_u32 s59, s62, 4096
    buffer_load_dwordx4 v[96:99], v14, s[24:27], s59 offen sc1
    buffer_load_dwordx4 v[80:83], v9, s[24:27], s58 offen offset:0 sc1
    buffer_load_dwordx4 v[84:87], v9, s[24:27], s58 offen offset:1024 sc1
    buffer_load_dwordx4 v[88:91], v9, s[24:27], s58 offen offset:2048 sc1
    buffer_load_dwordx4 v[92:95], v9, s[24:27], s58 offen offset:3072 sc1
    s_waitcnt vmcnt(0)
    v_xor_b32 v13, v10, v83
    v_xor_b32 v11, v10, v87
    v_or_b32 v13, v13, v11
    v_xor_b32 v11, v10, v91
    v_or_b32 v13, v13, v11
    v_xor_b32 v11, v10, v95
    v_or_b32 v13, v13, v11
    v_xor_b32 v11, v10, v99
    v_or_b32 v13, v13, v11
    v_cmp_ne_u32 vcc, 0, v13
    s_nop 4
    s_cmp_eq_u64 vcc, 0
    s_cbranch_scc0 L_fm30
    v_max_f32 v11, v96, v156
    v_sub_f32 v16, v96, v11
    v_sub_f32 v17, v156, v11
    v_exp_f32 v16, v16
    v_exp_f32 v17, v17
    v_lshrrev_b32 v13, 1, v8
    v_mul_f32 v12, v16, v97
    v_fmac_f32 v12, v17, v157
    v_rcp_f32 v12, v12
    s_add_u32 s58, s63, 0
    s_mul_i32 s58, s58, 1536
    v_mul_f32 v16, v16, v12
    v_mul_f32 v17, v17, v12
    v_mul_f32 v32, v80, v16
    v_fmac_f32 v32, v140, v17
    v_mul_f32 v33, v81, v16
    v_fmac_f32 v33, v141, v17
    v_mul_f32 v34, v82, v16
    v_fmac_f32 v34, v142, v17
    v_mul_f32 v35, v84, v16
    v_fmac_f32 v35, v144, v17
    v_mul_f32 v36, v85, v16
    v_fmac_f32 v36, v145, v17
    v_mul_f32 v37, v86, v16
    v_fmac_f32 v37, v146, v17
    v_mul_f32 v38, v88, v16
    v_fmac_f32 v38, v148, v17
    v_mul_f32 v39, v89, v16
    v_fmac_f32 v39, v149, v17
    v_mul_f32 v40, v90, v16
    v_fmac_f32 v40, v150, v17
    v_mul_f32 v41, v92, v16
    v_fmac_f32 v41, v152, v17
    v_mul_f32 v42, v93, v16
    v_fmac_f32 v42, v153, v17
    v_mul_f32 v43, v94, v16
    v_fmac_f32 v43, v154, v17
    v_cvt_pk_bf16_f32 v44, v32, v33
    v_cvt_pk_bf16_f32 v45, v34, v35
    v_cvt_pk_bf16_f32 v46, v36, v37
    v_cvt_pk_bf16_f32 v47, v38, v39
    v_cvt_pk_bf16_f32 v48, v40, v41
    v_cvt_pk_bf16_f32 v49, v42, v43
    buffer_store_dwordx2 v[44:45], v13, s[48:51], s58 offen offset:0
    buffer_store_dwordx2 v[46:47], v13, s[48:51], s58 offen offset:128
    buffer_store_dwordx2 v[48:49], v13, s[48:51], s58 offen offset:256
L_fm30:
    s_bitcmp1_b32 s70, 1
    s_cbranch_scc0 L_fm31
    s_waitcnt vmcnt(0)
    s_add_u32 s58, s62, 8704
    s_add_u32 s59, s62, 12800
    buffer_load_dwordx4 v[96:99], v14, s[24:27], s59 offen sc1
    buffer_load_dwordx4 v[80:83], v9, s[24:27], s58 offen offset:0 sc1
    buffer_load_dwordx4 v[84:87], v9, s[24:27], s58 offen offset:1024 sc1
    buffer_load_dwordx4 v[88:91], v9, s[24:27], s58 offen offset:2048 sc1
    buffer_load_dwordx4 v[92:95], v9, s[24:27], s58 offen offset:3072 sc1
    s_waitcnt vmcnt(0)
    v_xor_b32 v13, v10, v83
    v_xor_b32 v11, v10, v87
    v_or_b32 v13, v13, v11
    v_xor_b32 v11, v10, v91
    v_or_b32 v13, v13, v11
    v_xor_b32 v11, v10, v95
    v_or_b32 v13, v13, v11
    v_xor_b32 v11, v10, v99
    v_or_b32 v13, v13, v11
    v_cmp_ne_u32 vcc, 0, v13
    s_nop 4
    s_cmp_eq_u64 vcc, 0
    s_cbranch_scc0 L_fm31
    v_max_f32 v11, v96, v176
    v_sub_f32 v16, v96, v11
    v_sub_f32 v17, v176, v11
    v_exp_f32 v16, v16
    v_exp_f32 v17, v17
    v_lshrrev_b32 v13, 1, v8
    v_mul_f32 v12, v16, v97
    v_fmac_f32 v12, v17, v177
    v_rcp_f32 v12, v12
    s_add_u32 s58, s63, 1
    s_mul_i32 s58, s58, 1536
    v_mul_f32 v16, v16, v12
    v_mul_f32 v17, v17, v12
    v_mul_f32 v32, v80, v16
    v_fmac_f32 v32, v160, v17
    v_mul_f32 v33, v81, v16
    v_fmac_f32 v33, v161, v17
    v_mul_f32 v34, v82, v16
    v_fmac_f32 v34, v162, v17
    v_mul_f32 v35, v84, v16
    v_fmac_f32 v35, v164, v17
    v_mul_f32 v36, v85, v16
    v_fmac_f32 v36, v165, v17
    v_mul_f32 v37, v86, v16
    v_fmac_f32 v37, v166, v17
    v_mul_f32 v38, v88, v16
    v_fmac_f32 v38, v168, v17
    v_mul_f32 v39, v89, v16
    v_fmac_f32 v39, v169, v17
    v_mul_f32 v40, v90, v16
    v_fmac_f32 v40, v170, v17
    v_mul_f32 v41, v92, v16
    v_fmac_f32 v41, v172, v17
    v_mul_f32 v42, v93, v16
    v_fmac_f32 v42, v173, v17
    v_mul_f32 v43, v94, v16
    v_fmac_f32 v43, v174, v17
    v_cvt_pk_bf16_f32 v44, v32, v33
    v_cvt_pk_bf16_f32 v45, v34, v35
    v_cvt_pk_bf16_f32 v46, v36, v37
    v_cvt_pk_bf16_f32 v47, v38, v39
    v_cvt_pk_bf16_f32 v48, v40, v41
    v_cvt_pk_bf16_f32 v49, v42, v43
    buffer_store_dwordx2 v[44:45], v13, s[48:51], s58 offen offset:0
    buffer_store_dwordx2 v[46:47], v13, s[48:51], s58 offen offset:128
    buffer_store_dwordx2 v[48:49], v13, s[48:51], s58 offen offset:256
L_fm31:
    s_branch L_fin
L_fsolo:
    s_movk_i32 s69, 129
L_fb7:
    s_barrier
    s_sub_u32 s69, s69, 1
    s_cmp_lg_u32 s69, 0
    s_cbranch_scc1 L_fb7
    v_add_u32 v13, 142336, v14
    v_add_u32 v11, 142592, v8
    ds_read_b128 v[16:19], v13 offset:0
    ds_read_b128 v[20:23], v13 offset:64
    ds_read_b128 v[24:27], v13 offset:128
    ds_read_b128 v[28:31], v13 offset:192
    ds_read_b128 v[32:35], v11 offset:0
    ds_read_b128 v[36:39], v11 offset:256
    ds_read_b128 v[40:43], v11 offset:512
    ds_read_b128 v[44:47], v11 offset:3072
    ds_read_b128 v[48:51], v11 offset:3328
    ds_read_b128 v[52:55], v11 offset:3584
    ds_read_b128 v[56:59], v11 offset:6144
    ds_read_b128 v[60:63], v11 offset:6400
    ds_read_b128 v[64:67], v11 offset:6656
    s_waitcnt lgkmcnt(9)
    ds_read_b128 v[68:71], v11 offset:9216
    ds_read_b128 v[72:75], v11 offset:9472
    ds_read_b128 v[76:79], v11 offset:9728
    v_max_f32 v96, v16, v20
    v_max3_f32 v96, v96, v24, v28
    v_sub_f32 v16, v16, v96
    v_sub_f32 v20, v20, v96
    v_sub_f32 v24, v24, v96
    v_sub_f32 v28, v28, v96
    v_exp_f32 v16, v16
    v_exp_f32 v20, v20
    v_exp_f32 v24, v24
    v_exp_f32 v28, v28
    v_mov_b32 v83, v10
    v_mov_b32 v87, v10
    v_mov_b32 v91, v10
    v_mov_b32 v95, v10
    v_mov_b32 v99, v10
    v_mul_f32 v97, v16, v17
    v_mul_f32 v98, v16, v18
    v_fmac_f32 v97, v20, v21
    v_fmac_f32 v98, v20, v22
    v_fmac_f32 v97, v24, v25
    v_fmac_f32 v98, v24, v26
    v_fmac_f32 v97, v28, v29
    v_fmac_f32 v98, v28, v30
    s_waitcnt lgkmcnt(9)
    v_fma_f32 v80, v32, v16, -v98
    v_fma_f32 v81, v33, v16, -v98
    v_fma_f32 v82, v34, v16, -v98
    v_fma_f32 v84, v35, v16, -v98
    v_fma_f32 v85, v36, v16, -v98
    v_fma_f32 v86, v37, v16, -v98
    v_fma_f32 v88, v38, v16, -v98
    v_fma_f32 v89, v39, v16, -v98
    v_fma_f32 v90, v40, v16, -v98
    v_fma_f32 v92, v41, v16, -v98
    v_fma_f32 v93, v42, v16, -v98
    v_fma_f32 v94, v43, v16, -v98
    s_waitcnt lgkmcnt(6)
    v_fmac_f32 v80, v44, v20
    v_fmac_f32 v81, v45, v20
    v_fmac_f32 v82, v46, v20
    v_fmac_f32 v84, v47, v20
    v_fmac_f32 v85, v48, v20
    v_fmac_f32 v86, v49, v20
    v_fmac_f32 v88, v50, v20
    v_fmac_f32 v89, v51, v20
    v_fmac_f32 v90, v52, v20
    v_fmac_f32 v92, v53, v20
    v_fmac_f32 v93, v54, v20
    v_fmac_f32 v94, v55, v20
    s_waitcnt lgkmcnt(3)
    v_fmac_f32 v80, v56, v24
    v_fmac_f32 v81, v57, v24
    v_fmac_f32 v82, v58, v24
    v_fmac_f32 v84, v59, v24
    v_fmac_f32 v85, v60, v24
    v_fmac_f32 v86, v61, v24
    v_fmac_f32 v88, v62, v24
    v_fmac_f32 v89, v63, v24
    v_fmac_f32 v90, v64, v24
    v_fmac_f32 v92, v65, v24
    v_fmac_f32 v93, v66, v24
    v_fmac_f32 v94, v67, v24
    s_waitcnt lgkmcnt(0)
    v_fmac_f32 v80, v68, v28
    v_fmac_f32 v81, v69, v28
    v_fmac_f32 v82, v70, v28
    v_fmac_f32 v84, v71, v28
    v_fmac_f32 v85, v72, v28
    v_fmac_f32 v86, v73, v28
    v_fmac_f32 v88, v74, v28
    v_fmac_f32 v89, v75, v28
    v_fmac_f32 v90, v76, v28
    v_fmac_f32 v92, v77, v28
    v_fmac_f32 v93, v78, v28
    v_fmac_f32 v94, v79, v28
    v_max_f32 v11, v96, v96
    v_sub_f32 v16, v96, v11
    v_exp_f32 v16, v16
    v_lshrrev_b32 v13, 1, v8
    v_mul_f32 v12, v16, v97
    v_rcp_f32 v12, v12
    s_add_u32 s58, s63, 0
    s_mul_i32 s58, s58, 1536
    v_mul_f32 v16, v16, v12
    v_mul_f32 v32, v80, v16
    v_mul_f32 v33, v81, v16
    v_mul_f32 v34, v82, v16
    v_mul_f32 v35, v84, v16
    v_mul_f32 v36, v85, v16
    v_mul_f32 v37, v86, v16
    v_mul_f32 v38, v88, v16
    v_mul_f32 v39, v89, v16
    v_mul_f32 v40, v90, v16
    v_mul_f32 v41, v92, v16
    v_mul_f32 v42, v93, v16
    v_mul_f32 v43, v94, v16
    v_cvt_pk_bf16_f32 v44, v32, v33
    v_cvt_pk_bf16_f32 v45, v34, v35
    v_cvt_pk_bf16_f32 v46, v36, v37
    v_cvt_pk_bf16_f32 v47, v38, v39
    v_cvt_pk_bf16_f32 v48, v40, v41
    v_cvt_pk_bf16_f32 v49, v42, v43
    buffer_store_dwordx2 v[44:45], v13, s[48:51], s58 offen offset:0
    buffer_store_dwordx2 v[46:47], v13, s[48:51], s58 offen offset:128
    buffer_store_dwordx2 v[48:49], v13, s[48:51], s58 offen offset:256
L_fin:
L_end:
    s_endpgm
.section .rodata,"a"
.p2align 6
.amdhsa_kernel standalone__kv_cache_quant_int4_int2_kv_with_per_channel_or_per_token_scales__sampling_kernel
  .amdhsa_next_free_vgpr 224
  .amdhsa_next_free_sgpr 102
  .amdhsa_accum_offset 224
  .amdhsa_group_segment_fixed_size 0
  .amdhsa_kernarg_size 80
  .amdhsa_user_sgpr_count 2
  .amdhsa_user_sgpr_kernarg_segment_ptr 1
  .amdhsa_system_sgpr_workgroup_id_x 1
  .amdhsa_float_denorm_mode_32 3
.end_amdhsa_kernel
```

```asm
; @launch grid=(256,1,1) block=(448,1,1) lds=155136
.amdgcn_target "amdgcn-amd-amdhsa--gfx950"
.text
.globl standalone__kv_cache_quant_int4_int2_kv_with_per_channel_or_per_token_scales__sampling_kernel
.p2align 8
.type standalone__kv_cache_quant_int4_int2_kv_with_per_channel_or_per_token_scales__sampling_kernel,@function
standalone__kv_cache_quant_int4_int2_kv_with_per_channel_or_per_token_scales__sampling_kernel:
    s_cmp_ge_u32 s2, 256
    s_cbranch_scc1 L_end
    s_load_dwordx16 s[4:19], s[0:1], 0
    s_load_dwordx4 s[20:23], s[0:1], 64
    v_lshrrev_b32 v2, 6, v0
    v_and_b32 v1, 63, v0
    v_readfirstlane_b32 s56, v2
    s_mov_b32 s67, 768
    s_mul_i32 s100, s2, 43691
    s_lshr_b32 s100, s100, 17
    s_mul_i32 s101, s100, 3
    s_sub_u32 s101, s2, s101
    s_cmp_eq_u32 s2, 255
    s_cselect_b32 s73, 16, 11
    s_cmp_eq_u32 s101, 1
    s_cselect_b32 s3, 5, s73
    s_cselect_b32 s73, 10, s73
    s_mul_i32 s58, s101, 21
    s_add_u32 s58, s58, 1
    s_lshr_b32 s58, s58, 1
    s_lshl_b32 s59, s100, 5
    s_add_u32 s57, s58, s59
    s_mul_i32 s58, s101, 11
    s_lshr_b32 s58, s58, 1
    s_lshl_b32 s59, s100, 4
    s_add_u32 s58, s58, s59
    s_add_u32 s58, s58, 2736
    s_sub_u32 s58, s58, s73
    v_cmp_le_u32 vcc, s73, v1
    v_add_u32 v3, s57, v1
    v_add_u32 v4, s58, v1
    v_cndmask_b32 v152, v3, v4, vcc
    s_cmp_eq_u32 s56, 4
    s_cbranch_scc0 L_roles
    s_setprio 3
    v_add_u32 v17, 0, v1
    v_mul_u32_u24 v22, 1366, v17
    v_bfe_u32 v11, v22, 16, 1
    v_lshrrev_b32 v14, 17, v22
    v_mul_u32_u24 v22, 31488, v14
    v_lshl_add_u32 v17, v17, 4, v22
    v_mov_b32 v8, v17
    v_add_u32 v18, 64, v1
    v_mul_u32_u24 v22, 1366, v18
    v_bfe_u32 v12, v22, 16, 1
    v_lshrrev_b32 v15, 17, v22
    v_mul_u32_u24 v22, 31488, v15
    v_lshl_add_u32 v18, v18, 4, v22
    v_mov_b32 v9, v18
    v_add_u32 v19, 128, v1
    v_mul_u32_u24 v22, 1366, v19
    v_bfe_u32 v13, v22, 16, 1
    v_lshrrev_b32 v16, 17, v22
    v_mul_u32_u24 v22, 31488, v16
    v_lshl_add_u32 v19, v19, 4, v22
    v_mov_b32 v10, v19
    s_mov_b32 s68, 0
    s_mov_b32 m0, 0
    s_movk_i32 s71, 1024
    s_mul_i32 s57, s57, 196608
    s_mov_b32 s84, 0x400000
    s_mov_b32 s85, 0x800
    s_movk_i32 s86, 1536
    s_mov_b32 s70, 18
    s_mov_b32 s74, 0
    v_mov_b32 v20, 4710
    v_mov_b32 v21, 154880
    ds_write_b32 v21, v20
    s_waitcnt lgkmcnt(0)
    s_mov_b32 s24, s6
    s_and_b32 s25, s7, 0xffff
    s_mov_b32 s26, 805306368
    s_mov_b32 s27, 0x20000
L_lw16:
    s_waitcnt vmcnt(16)
L_lw17:
    s_waitcnt vmcnt(17)
L_lw18:
    s_waitcnt vmcnt(18)
L_lw19:
    s_waitcnt vmcnt(19)
L_lw20:
    s_waitcnt vmcnt(20)
    buffer_load_dwordx4 v17, s[24:27], s57 offen nt lds
    s_add_u32 m0, m0, s71
    s_add_u32 s68, s68, 1
    s_and_b32 s58, s68, 63
    s_cmp_ge_u32 s58, 43
    s_cselect_b32 s69, -768, 0
    buffer_load_dwordx4 v18, s[24:27], s57 offen nt lds
    s_add_u32 m0, m0, s71
    s_cmp_eq_u32 s58, 21
    s_cselect_b32 s62, 33024, 0
    v_mad_u32_u24 v17, v11, s62, v8
    s_bitcmp1_b64 s[84:85], s58
    s_cselect_b32 s63, 34560, s86
    buffer_load_dwordx4 v19, s[24:27], s57 offen nt lds
    s_add_u32 m0, m0, s71
    s_add_u32 s57, s57, s63
    v_mad_i32_i24 v22, v15, s69, v9
    v_mad_u32_u24 v18, v12, s62, v22
    v_mad_i32_i24 v22, v16, s69, v10
    v_mad_u32_u24 v19, v13, s62, v22
    s_and_b32 s59, s68, 7
    s_cbranch_scc0 L_lunit
L_lad:
    s_cmp_eq_u32 s70, 20
    s_cbranch_scc1 L_lw20
    s_cmp_eq_u32 s70, 19
    s_cbranch_scc1 L_lw19
    s_cmp_eq_u32 s70, 18
    s_cbranch_scc1 L_lw18
    s_cmp_eq_u32 s70, 17
    s_cbranch_scc1 L_lw17
    s_branch L_lw16
L_lunit:
    s_waitcnt vmcnt(24)
    s_cmp_le_u32 s68, 16
    s_cbranch_scc1 L_lfirst
L_lbar:
    s_barrier
L_lnobar:
    s_waitcnt lgkmcnt(0)
    v_readfirstlane_b32 s59, v20
    ds_read_b32 v20, v21
    s_cmp_eq_u32 m0, 73728
    s_cselect_b32 m0, 0, m0
    s_and_b32 s74, s74, 255
    s_add_u32 s74, s74, s59
    s_lshr_b32 s70, s74, 8
    s_cmp_eq_u32 s58, 0
    s_cbranch_scc1 L_lblock
L_lsel:
    s_cmp_le_u32 s70, 20
    s_cbranch_scc1 L_lad
    s_cmp_le_u32 s70, 22
    s_cbranch_scc1 L_lad21
    s_cmp_le_u32 s70, 24
    s_cbranch_scc1 L_lad23
    s_branch L_lad25
L_lblock:
    s_bfe_u32 s58, s68, 262150
    v_readlane_b32 s57, v152, s58
    s_nop 3
    s_mul_i32 s57, s57, 196608
    s_cmp_eq_u32 s58, 0
    s_cbranch_scc0 L_lsel
    s_cmp_eq_u32 s68, 2048
    s_cbranch_scc1 L_ldone
    s_mov_b32 s24, s8
    s_and_b32 s25, s9, 0xffff
    s_branch L_lsel
L_lfirst:
    s_cmp_eq_u32 s68, 8
    s_cbranch_scc1 L_lnobar
    s_barrier
    s_branch L_lbar
L_ldone:
    s_waitcnt vmcnt(0)
    s_barrier
    s_endpgm
L_lw21:
    s_waitcnt vmcnt(21)
L_lw22:
    s_waitcnt vmcnt(22)
    buffer_load_dwordx4 v17, s[24:27], s57 offen nt lds
    s_add_u32 m0, m0, s71
    s_add_u32 s68, s68, 1
    s_and_b32 s58, s68, 63
    s_cmp_ge_u32 s58, 43
    s_cselect_b32 s69, -768, 0
    buffer_load_dwordx4 v18, s[24:27], s57 offen nt lds
    s_add_u32 m0, m0, s71
    s_cmp_eq_u32 s58, 21
    s_cselect_b32 s62, 33024, 0
    v_mad_u32_u24 v17, v11, s62, v8
    s_bitcmp1_b64 s[84:85], s58
    s_cselect_b32 s63, 34560, s86
    buffer_load_dwordx4 v19, s[24:27], s57 offen nt lds
    s_add_u32 m0, m0, s71
    s_add_u32 s57, s57, s63
    v_mad_i32_i24 v22, v15, s69, v9
    v_mad_u32_u24 v18, v12, s62, v22
    v_mad_i32_i24 v22, v16, s69, v10
    v_mad_u32_u24 v19, v13, s62, v22
    s_and_b32 s59, s68, 7
    s_cbranch_scc0 L_lunit
L_lad21:
    s_cmp_eq_u32 s70, 22
    s_cbranch_scc1 L_lw22
    s_branch L_lw21
L_lw23:
    s_waitcnt vmcnt(23)
L_lw24:
    s_waitcnt vmcnt(24)
    buffer_load_dwordx4 v17, s[24:27], s57 offen nt lds
    s_add_u32 m0, m0, s71
    s_add_u32 s68, s68, 1
    s_and_b32 s58, s68, 63
    s_cmp_ge_u32 s58, 43
    s_cselect_b32 s69, -768, 0
    buffer_load_dwordx4 v18, s[24:27], s57 offen nt lds
    s_add_u32 m0, m0, s71
    s_cmp_eq_u32 s58, 21
    s_cselect_b32 s62, 33024, 0
    v_mad_u32_u24 v17, v11, s62, v8
    s_bitcmp1_b64 s[84:85], s58
    s_cselect_b32 s63, 34560, s86
    buffer_load_dwordx4 v19, s[24:27], s57 offen nt lds
    s_add_u32 m0, m0, s71
    s_add_u32 s57, s57, s63
    v_mad_i32_i24 v22, v15, s69, v9
    v_mad_u32_u24 v18, v12, s62, v22
    v_mad_i32_i24 v22, v16, s69, v10
    v_mad_u32_u24 v19, v13, s62, v22
    s_and_b32 s59, s68, 7
    s_cbranch_scc0 L_lunit
L_lad23:
    s_cmp_eq_u32 s70, 24
    s_cbranch_scc1 L_lw24
    s_branch L_lw23
L_lw25:
    s_waitcnt vmcnt(25)
    buffer_load_dwordx4 v17, s[24:27], s57 offen nt lds
    s_add_u32 m0, m0, s71
    s_add_u32 s68, s68, 1
    s_and_b32 s58, s68, 63
    s_cmp_ge_u32 s58, 43
    s_cselect_b32 s69, -768, 0
    buffer_load_dwordx4 v18, s[24:27], s57 offen nt lds
    s_add_u32 m0, m0, s71
    s_cmp_eq_u32 s58, 21
    s_cselect_b32 s62, 33024, 0
    v_mad_u32_u24 v17, v11, s62, v8
    s_bitcmp1_b64 s[84:85], s58
    s_cselect_b32 s63, 34560, s86
    buffer_load_dwordx4 v19, s[24:27], s57 offen nt lds
    s_add_u32 m0, m0, s71
    s_add_u32 s57, s57, s63
    v_mad_i32_i24 v22, v15, s69, v9
    v_mad_u32_u24 v18, v12, s62, v22
    v_mad_i32_i24 v22, v16, s69, v10
    v_mad_u32_u24 v19, v13, s62, v22
    s_and_b32 s59, s68, 7
    s_cbranch_scc0 L_lunit
L_lad25:
    s_branch L_lw25
L_roles:
    s_cmp_lt_u32 s56, 4
    s_cbranch_scc1 L_consumer
    s_cmp_eq_u32 s56, 5
    s_cbranch_scc1 L_finisher
    s_sub_u32 s58, s2, 16
    s_cmp_lt_u32 s58, 8
    s_cbranch_scc0 L_pw
    s_getpc_b64 s[44:45]
L_pc:
    s_and_b32 s45, s45, 0xffff
    s_mov_b32 s46, L_end - L_pc
    s_mov_b32 s47, 0x20000
    v_lshlrev_b32 v9, 7, v1
    s_movk_i32 s58, 0
    buffer_load_dword v12, v9, s[44:47], s58 offen
    s_movk_i32 s58, 8192
    buffer_load_dword v13, v9, s[44:47], s58 offen
    s_movk_i32 s58, 16384
    buffer_load_dword v14, v9, s[44:47], s58 offen
    s_movk_i32 s58, 24576
    buffer_load_dword v15, v9, s[44:47], s58 offen
L_pw:
    s_waitcnt lgkmcnt(0)
    s_mov_b32 s52, s22
    s_and_b32 s53, s23, 0xffff
    s_mov_b32 s54, 16793888
    s_mov_b32 s55, 0x20000
    s_mov_b32 s71, 0
    s_add_u32 s98, s22, 16777216
    s_addc_u32 s99, s23, 0
    s_min_u32 s58, s2, 16
    s_lshr_b32 s61, 0x926d, s58
    s_and_b32 s61, s61, 1
    s_and_b32 s59, s2, 7
    s_mul_i32 s59, s59, 4
    s_add_u32 s59, s59, 16777216
    v_mov_b32 v8, s59
    v_mov_b32 v10, 154880
    s_mov_b32 s96, 0
    s_mov_b64 exec, 1
    s_barrier
    s_mov_b32 s63, 0
L_pace:
    s_barrier
    s_mov_b32 s62, s96
    s_memrealtime s[96:97]
    s_waitcnt lgkmcnt(0)
    s_cmp_eq_u32 s63, 0
    s_cbranch_scc1 L_pnext
    s_mov_b32 s58, 0
    s_sub_i32 s59, s84, s62
    s_add_i32 s60, s59, 5000
    s_cmp_lt_u32 s60, 10000
    s_cselect_b32 s59, s59, 200
    s_add_i32 s58, s58, s59
    s_sub_i32 s59, s85, s62
    s_add_i32 s60, s59, 5000
    s_cmp_lt_u32 s60, 10000
    s_cselect_b32 s59, s59, 200
    s_add_i32 s58, s58, s59
    s_sub_i32 s59, s86, s62
    s_add_i32 s60, s59, 5000
    s_cmp_lt_u32 s60, 10000
    s_cselect_b32 s59, s59, 200
    s_add_i32 s58, s58, s59
    s_sub_i32 s59, s87, s62
    s_add_i32 s60, s59, 5000
    s_cmp_lt_u32 s60, 10000
    s_cselect_b32 s59, s59, 200
    s_add_i32 s58, s58, s59
    s_sub_i32 s59, s88, s62
    s_add_i32 s60, s59, 5000
    s_cmp_lt_u32 s60, 10000
    s_cselect_b32 s59, s59, 200
    s_add_i32 s58, s58, s59
    s_sub_i32 s59, s89, s62
    s_add_i32 s60, s59, 5000
    s_cmp_lt_u32 s60, 10000
    s_cselect_b32 s59, s59, 200
    s_add_i32 s58, s58, s59
    s_sub_i32 s59, s90, s62
    s_add_i32 s60, s59, 5000
    s_cmp_lt_u32 s60, 10000
    s_cselect_b32 s59, s59, 200
    s_add_i32 s58, s58, s59
    s_sub_i32 s59, s91, s62
    s_add_i32 s60, s59, 5000
    s_cmp_lt_u32 s60, 10000
    s_cselect_b32 s59, s59, 200
    s_add_i32 s58, s58, s59
    s_min_u32 s59, s63, 12
    s_cmp_gt_i32 s58, 0
    s_cselect_b32 s63, s59, s63
    s_mul_i32 s58, s58, s63
    s_ashr_i32 s58, s58, 5
    s_sub_i32 s58, 4710, s58
    s_max_i32 s58, s58, 4096
    s_min_i32 s70, s58, 6400
    v_mov_b32 v9, s70
    ds_write_b32 v10, v9
L_pnext:
    s_and_b32 s58, s71, 768
    s_cselect_b32 s63, 0, 5
    s_cmp_ge_u32 s71, 14848
    s_cselect_b32 s63, 24, s63
    s_mul_i32 s58, s63, s61
    s_cmp_eq_u32 s58, 0
    s_cbranch_scc1 L_pnorep
    v_mov_b32 v11, s96
    buffer_store_dword v11, v8, s[52:55], s71 offen sc1
L_pnorep:
    s_barrier
    s_barrier
    s_barrier
    s_cmp_eq_u32 s63, 0
    s_cbranch_scc1 L_pnold
    s_load_dwordx8 s[84:91], s[98:99], s71
L_pnold:
    s_add_u32 s71, s71, 256
    s_cmp_lt_u32 s71, 16384
    s_cbranch_scc1 L_pace
    s_waitcnt lgkmcnt(0)
    s_mov_b64 exec, -1
    s_endpgm
L_consumer:
    v_lshrrev_b32 v3, 2, v1
    v_lshlrev_b32 v3, 3, v3
    v_and_b32 v4, 3, v1
    v_mul_u32_u24 v5, 384, v4
    v_add_u32 v15, v3, v5
    v_lshlrev_b32 v13, 4, v1
    s_mul_i32 s63, s56, 3072
    s_add_u32 s63, s63, 76800
    s_add_u32 s58, s56, 0
    v_readlane_b32 s84, v152, s58
    s_add_u32 s58, s56, 4
    v_readlane_b32 s85, v152, s58
    s_add_u32 s58, s56, 8
    v_readlane_b32 s86, v152, s58
    s_add_u32 s58, s56, 12
    v_readlane_b32 s87, v152, s58
    v_readlane_b32 s88, v152, 0
    s_min_u32 s58, s3, 15
    v_readlane_b32 s89, v152, s58
    v_readlane_b32 s90, v152, 15
    s_waitcnt lgkmcnt(0)
    s_mov_b32 s32, s12
    s_and_b32 s33, s13, 0xffff
    s_mov_b32 s34, 6291456
    s_mov_b32 s35, 0x20000
    s_mov_b32 s28, s10
    s_and_b32 s29, s11, 0xffff
    s_mov_b32 s30, 6291456
    s_mov_b32 s31, 0x20000
    s_mov_b32 exec_hi, 0xffff
    s_add_u32 m0, s63, 0
    s_mul_i32 s58, s84, 1536
    buffer_load_dwordx4 v13, s[32:35], s58 offen nt lds
    buffer_load_dwordx4 v13, s[32:35], s58 offen offset:768 nt lds
    s_add_u32 m0, m0, 1536
    s_nop 0
    buffer_load_dwordx4 v13, s[28:31], s58 offen nt lds
    buffer_load_dwordx4 v13, s[28:31], s58 offen offset:768 nt lds
    s_mov_b32 exec_hi, -1
    s_mov_b32 s44, s4
    s_and_b32 s45, s5, 0xffff
    s_mov_b32 s46, 393216
    s_mov_b32 s47, 0x20000
    s_lshr_b32 s58, s88, 4
    s_mul_i32 s58, s58, 1536
    buffer_load_dwordx2 v[160:161], v15, s[44:47], s58 offen offset:0 nt
    buffer_load_dwordx2 v[162:163], v15, s[44:47], s58 offen offset:128 nt
    buffer_load_dwordx2 v[164:165], v15, s[44:47], s58 offen offset:256 nt
    s_mov_b32 s64, 0x3fb8aa3b
    s_mov_b32 s65, 0x3d93cd3a
    s_mov_b32 s66, 0xffff0000
    v_bfe_u32 v36, v1, 2, 1
    v_lshl_add_u32 v36, v2, 2, v36
    v_bfe_u32 v37, v1, 3, 1
    v_lshrrev_b32 v38, 4, v1
    v_lshl_add_u32 v38, v38, 2, v4
    v_lshlrev_b32 v38, 3, v38
    v_add_u32 v38, 73728, v38
    s_movk_i32 s58, 384
    v_add_u32 v3, 0, v36
    v_cmp_le_u32 vcc, 43, v3
    v_add_u32 v5, 43, v3
    v_mov_b32 v6, 42
    v_cndmask_b32 v17, v3, v5, vcc
    v_cmp_le_u32 vcc, 86, v3
    v_add_u32 v5, 43, v17
    s_nop 0
    v_cndmask_b32 v17, v17, v5, vcc
    v_cndmask_b32 v6, 43, v6, vcc
    v_mad_u32_u24 v17, v6, v37, v17
    v_lshrrev_b32 v17, 6, v17
    v_mad_u32_u24 v17, v17, s58, v38
    v_add_u32 v3, 2, v36
    v_cmp_le_u32 vcc, 43, v3
    v_add_u32 v5, 43, v3
    v_mov_b32 v6, 42
    v_cndmask_b32 v18, v3, v5, vcc
    v_cmp_le_u32 vcc, 86, v3
    v_add_u32 v5, 43, v18
    s_nop 0
    v_cndmask_b32 v18, v18, v5, vcc
    v_cndmask_b32 v6, 43, v6, vcc
    v_mad_u32_u24 v18, v6, v37, v18
    v_lshrrev_b32 v18, 6, v18
    v_mad_u32_u24 v18, v18, s58, v38
    v_add_u32 v3, 16, v36
    v_cmp_le_u32 vcc, 43, v3
    v_add_u32 v5, 43, v3
    v_mov_b32 v6, 42
    v_cndmask_b32 v19, v3, v5, vcc
    v_cmp_le_u32 vcc, 86, v3
    v_add_u32 v5, 43, v19
    s_nop 0
    v_cndmask_b32 v19, v19, v5, vcc
    v_cndmask_b32 v6, 43, v6, vcc
    v_mad_u32_u24 v19, v6, v37, v19
    v_lshrrev_b32 v19, 6, v19
    v_mad_u32_u24 v19, v19, s58, v38
    v_add_u32 v3, 18, v36
    v_cmp_le_u32 vcc, 43, v3
    v_add_u32 v5, 43, v3
    v_mov_b32 v6, 42
    v_cndmask_b32 v20, v3, v5, vcc
    v_cmp_le_u32 vcc, 86, v3
    v_add_u32 v5, 43, v20
    s_nop 0
    v_cndmask_b32 v20, v20, v5, vcc
    v_cndmask_b32 v6, 43, v6, vcc
    v_mad_u32_u24 v20, v6, v37, v20
    v_lshrrev_b32 v20, 6, v20
    v_mad_u32_u24 v20, v20, s58, v38
    v_add_u32 v3, 32, v36
    v_cmp_le_u32 vcc, 43, v3
    v_add_u32 v5, 43, v3
    v_mov_b32 v6, 42
    v_cndmask_b32 v21, v3, v5, vcc
    v_cmp_le_u32 vcc, 86, v3
    v_add_u32 v5, 43, v21
    s_nop 0
    v_cndmask_b32 v21, v21, v5, vcc
    v_cndmask_b32 v6, 43, v6, vcc
    v_mad_u32_u24 v21, v6, v37, v21
    v_lshrrev_b32 v21, 6, v21
    v_mad_u32_u24 v21, v21, s58, v38
    v_add_u32 v3, 34, v36
    v_cmp_le_u32 vcc, 43, v3
    v_add_u32 v5, 43, v3
    v_mov_b32 v6, 42
    v_cndmask_b32 v22, v3, v5, vcc
    v_cmp_le_u32 vcc, 86, v3
    v_add_u32 v5, 43, v22
    s_nop 0
    v_cndmask_b32 v22, v22, v5, vcc
    v_cndmask_b32 v6, 43, v6, vcc
    v_mad_u32_u24 v22, v6, v37, v22
    v_lshrrev_b32 v22, 6, v22
    v_mad_u32_u24 v22, v22, s58, v38
    v_add_u32 v3, 48, v36
    v_cmp_le_u32 vcc, 43, v3
    v_add_u32 v5, 43, v3
    v_mov_b32 v6, 42
    v_cndmask_b32 v23, v3, v5, vcc
    v_cmp_le_u32 vcc, 86, v3
    v_add_u32 v5, 43, v23
    s_nop 0
    v_cndmask_b32 v23, v23, v5, vcc
    v_cndmask_b32 v6, 43, v6, vcc
    v_mad_u32_u24 v23, v6, v37, v23
    v_lshrrev_b32 v23, 6, v23
    v_mad_u32_u24 v23, v23, s58, v38
    v_add_u32 v3, 50, v36
    v_cmp_le_u32 vcc, 43, v3
    v_add_u32 v5, 43, v3
    v_mov_b32 v6, 42
    v_cndmask_b32 v24, v3, v5, vcc
    v_cmp_le_u32 vcc, 86, v3
    v_add_u32 v5, 43, v24
    s_nop 0
    v_cndmask_b32 v24, v24, v5, vcc
    v_cndmask_b32 v6, 43, v6, vcc
    v_mad_u32_u24 v24, v6, v37, v24
    v_lshrrev_b32 v24, 6, v24
    v_mad_u32_u24 v24, v24, s58, v38
    v_add_u32 v3, 64, v36
    v_cmp_le_u32 vcc, 43, v3
    v_add_u32 v5, 43, v3
    v_mov_b32 v6, 42
    v_cndmask_b32 v25, v3, v5, vcc
    v_cmp_le_u32 vcc, 86, v3
    v_add_u32 v5, 43, v25
    s_nop 0
    v_cndmask_b32 v25, v25, v5, vcc
    v_cndmask_b32 v6, 43, v6, vcc
    v_mad_u32_u24 v25, v6, v37, v25
    v_lshrrev_b32 v25, 6, v25
    v_mad_u32_u24 v25, v25, s58, v38
    v_add_u32 v3, 66, v36
    v_cmp_le_u32 vcc, 43, v3
    v_add_u32 v5, 43, v3
    v_mov_b32 v6, 42
    v_cndmask_b32 v26, v3, v5, vcc
    v_cmp_le_u32 vcc, 86, v3
    v_add_u32 v5, 43, v26
    s_nop 0
    v_cndmask_b32 v26, v26, v5, vcc
    v_cndmask_b32 v6, 43, v6, vcc
    v_mad_u32_u24 v26, v6, v37, v26
    v_lshrrev_b32 v26, 6, v26
    v_mad_u32_u24 v26, v26, s58, v38
    v_add_u32 v3, 80, v36
    v_cmp_le_u32 vcc, 43, v3
    v_add_u32 v5, 43, v3
    v_mov_b32 v6, 42
    v_cndmask_b32 v27, v3, v5, vcc
    v_cmp_le_u32 vcc, 86, v3
    v_add_u32 v5, 43, v27
    s_nop 0
    v_cndmask_b32 v27, v27, v5, vcc
    v_cndmask_b32 v6, 43, v6, vcc
    v_mad_u32_u24 v27, v6, v37, v27
    v_lshrrev_b32 v27, 6, v27
    v_mad_u32_u24 v27, v27, s58, v38
    v_add_u32 v3, 82, v36
    v_cmp_le_u32 vcc, 43, v3
    v_add_u32 v5, 43, v3
    v_mov_b32 v6, 42
    v_cndmask_b32 v28, v3, v5, vcc
    v_cmp_le_u32 vcc, 86, v3
    v_add_u32 v5, 43, v28
    s_nop 0
    v_cndmask_b32 v28, v28, v5, vcc
    v_cndmask_b32 v6, 43, v6, vcc
    v_mad_u32_u24 v28, v6, v37, v28
    v_lshrrev_b32 v28, 6, v28
    v_mad_u32_u24 v28, v28, s58, v38
    v_add_u32 v3, 96, v36
    v_cmp_le_u32 vcc, 43, v3
    v_add_u32 v5, 43, v3
    v_mov_b32 v6, 42
    v_cndmask_b32 v29, v3, v5, vcc
    v_cmp_le_u32 vcc, 86, v3
    v_add_u32 v5, 43, v29
    s_nop 0
    v_cndmask_b32 v29, v29, v5, vcc
    v_cndmask_b32 v6, 43, v6, vcc
    v_mad_u32_u24 v29, v6, v37, v29
    v_lshrrev_b32 v29, 6, v29
    v_mad_u32_u24 v29, v29, s58, v38
    v_add_u32 v3, 98, v36
    v_cmp_le_u32 vcc, 43, v3
    v_add_u32 v5, 43, v3
    v_mov_b32 v6, 42
    v_cndmask_b32 v30, v3, v5, vcc
    v_cmp_le_u32 vcc, 86, v3
    v_add_u32 v5, 43, v30
    s_nop 0
    v_cndmask_b32 v30, v30, v5, vcc
    v_cndmask_b32 v6, 43, v6, vcc
    v_mad_u32_u24 v30, v6, v37, v30
    v_lshrrev_b32 v30, 6, v30
    v_mad_u32_u24 v30, v30, s58, v38
    v_add_u32 v3, 112, v36
    v_cmp_le_u32 vcc, 43, v3
    v_add_u32 v5, 43, v3
    v_mov_b32 v6, 42
    v_cndmask_b32 v31, v3, v5, vcc
    v_cmp_le_u32 vcc, 86, v3
    v_add_u32 v5, 43, v31
    s_nop 0
    v_cndmask_b32 v31, v31, v5, vcc
    v_cndmask_b32 v6, 43, v6, vcc
    v_mad_u32_u24 v31, v6, v37, v31
    v_lshrrev_b32 v31, 6, v31
    v_mad_u32_u24 v31, v31, s58, v38
    v_add_u32 v3, 114, v36
    v_cmp_le_u32 vcc, 43, v3
    v_add_u32 v5, 43, v3
    v_mov_b32 v6, 42
    v_cndmask_b32 v32, v3, v5, vcc
    v_cmp_le_u32 vcc, 86, v3
    v_add_u32 v5, 43, v32
    s_nop 0
    v_cndmask_b32 v32, v32, v5, vcc
    v_cndmask_b32 v6, 43, v6, vcc
    v_mad_u32_u24 v32, v6, v37, v32
    v_lshrrev_b32 v32, 6, v32
    v_mad_u32_u24 v32, v32, s58, v38
    v_bfe_u32 v36, v1, 4, 1
    v_lshl_add_u32 v36, v2, 2, v36
    v_bfe_u32 v3, v1, 2, 2
    v_lshl_add_u32 v36, v3, 4, v36
    v_lshrrev_b32 v37, 5, v1
    s_mov_b32 s58, 125952
    v_add_u32 v3, 0, v36
    v_cmp_le_u32 vcc, 43, v3
    v_add_u32 v5, 43, v3
    v_mov_b32 v6, 42
    v_cndmask_b32 v7, v3, v5, vcc
    v_cmp_le_u32 vcc, 86, v3
    v_add_u32 v5, 43, v7
    s_nop 0
    v_cndmask_b32 v7, v7, v5, vcc
    v_cndmask_b32 v6, 43, v6, vcc
    v_mad_u32_u24 v7, v6, v37, v7
    v_lshl_add_u32 v7, v7, 1, s58
    v_add_u32 v3, 2, v36
    v_cmp_le_u32 vcc, 43, v3
    v_add_u32 v5, 43, v3
    v_mov_b32 v6, 42
    v_cndmask_b32 v8, v3, v5, vcc
    v_cmp_le_u32 vcc, 86, v3
    v_add_u32 v5, 43, v8
    s_nop 0
    v_cndmask_b32 v8, v8, v5, vcc
    v_cndmask_b32 v6, 43, v6, vcc
    v_mad_u32_u24 v8, v6, v37, v8
    v_lshl_add_u32 v8, v8, 1, s58
    v_add_u32 v3, 64, v36
    v_cmp_le_u32 vcc, 43, v3
    v_add_u32 v5, 43, v3
    v_mov_b32 v6, 42
    v_cndmask_b32 v9, v3, v5, vcc
    v_cmp_le_u32 vcc, 86, v3
    v_add_u32 v5, 43, v9
    s_nop 0
    v_cndmask_b32 v9, v9, v5, vcc
    v_cndmask_b32 v6, 43, v6, vcc
    v_mad_u32_u24 v9, v6, v37, v9
    v_lshl_add_u32 v9, v9, 1, s58
    v_add_u32 v3, 66, v36
    v_cmp_le_u32 vcc, 43, v3
    v_add_u32 v5, 43, v3
    v_mov_b32 v6, 42
    v_cndmask_b32 v10, v3, v5, vcc
    v_cmp_le_u32 vcc, 86, v3
    v_add_u32 v5, 43, v10
    s_nop 0
    v_cndmask_b32 v10, v10, v5, vcc
    v_cndmask_b32 v6, 43, v6, vcc
    v_mad_u32_u24 v10, v6, v37, v10
    v_lshl_add_u32 v10, v10, 1, s58
    v_lshlrev_b32 v11, 2, v1
    v_lshl_add_u32 v11, v2, 9, v11
    v_add_u32 v11, 73728, v11
    v_bfe_u32 v3, v1, 2, 2
    v_lshrrev_b32 v4, 4, v1
    v_and_b32 v5, 3, v1
    v_lshl_add_u32 v4, v4, 2, v5
    v_lshl_add_u32 v3, v2, 3, v3
    v_mul_u32_u24 v3, 768, v3
    v_lshl_add_u32 v12, v4, 4, v3
    v_and_b32 v3, 3, v1
    v_lshl_add_u32 v153, v3, 2, v2
    v_lshlrev_b32 v153, 2, v153
    v_add_u32 v153, 154944, v153
    v_mov_b32 v14, 0xff800000
    s_mov_b32 exec_hi, 0xffff
    s_add_u32 m0, s63, 12288
    s_mul_i32 s58, s85, 1536
    buffer_load_dwordx4 v13, s[32:35], s58 offen nt lds
    buffer_load_dwordx4 v13, s[32:35], s58 offen offset:768 nt lds
    s_add_u32 m0, m0, 1536
    s_nop 0
    buffer_load_dwordx4 v13, s[28:31], s58 offen nt lds
    buffer_load_dwordx4 v13, s[28:31], s58 offen offset:768 nt lds
    s_add_u32 m0, s63, 24576
    s_mul_i32 s58, s86, 1536
    buffer_load_dwordx4 v13, s[32:35], s58 offen nt lds
    buffer_load_dwordx4 v13, s[32:35], s58 offen offset:768 nt lds
    s_add_u32 m0, m0, 1536
    s_nop 0
    buffer_load_dwordx4 v13, s[28:31], s58 offen nt lds
    buffer_load_dwordx4 v13, s[28:31], s58 offen offset:768 nt lds
    s_add_u32 m0, s63, 36864
    s_mul_i32 s58, s87, 1536
    buffer_load_dwordx4 v13, s[32:35], s58 offen nt lds
    buffer_load_dwordx4 v13, s[32:35], s58 offen offset:768 nt lds
    s_add_u32 m0, m0, 1536
    s_nop 0
    buffer_load_dwordx4 v13, s[28:31], s58 offen nt lds
    buffer_load_dwordx4 v13, s[28:31], s58 offen offset:768 nt lds
    s_mov_b32 exec_hi, -1
    s_mov_b32 s36, s14
    s_and_b32 s37, s15, 0xffff
    s_mov_b32 s38, 2097152
    s_mov_b32 s39, 0x20000
    s_mov_b32 s40, s16
    s_and_b32 s41, s17, 0xffff
    s_mov_b32 s42, 2097152
    s_mov_b32 s43, 0x20000
    s_mov_b32 exec_hi, 0
    s_lshl_b32 s60, s56, 10
    s_add_u32 m0, s60, 125952
    s_lshl_b32 s58, s84, 9
    buffer_load_dwordx4 v13, s[36:39], s58 offen nt lds
    s_add_u32 m0, m0, 512
    s_nop 0
    buffer_load_dwordx4 v13, s[40:43], s58 offen nt lds
    s_add_u32 m0, s60, 130048
    s_lshl_b32 s58, s85, 9
    buffer_load_dwordx4 v13, s[36:39], s58 offen nt lds
    s_add_u32 m0, m0, 512
    s_nop 0
    buffer_load_dwordx4 v13, s[40:43], s58 offen nt lds
    s_add_u32 m0, s60, 134144
    s_lshl_b32 s58, s86, 9
    buffer_load_dwordx4 v13, s[36:39], s58 offen nt lds
    s_add_u32 m0, m0, 512
    s_nop 0
    buffer_load_dwordx4 v13, s[40:43], s58 offen nt lds
    s_add_u32 m0, s60, 138240
    s_lshl_b32 s58, s87, 9
    buffer_load_dwordx4 v13, s[36:39], s58 offen nt lds
    s_add_u32 m0, m0, 512
    s_nop 0
    buffer_load_dwordx4 v13, s[40:43], s58 offen nt lds
    s_mov_b32 exec_hi, -1
    s_lshr_b32 s58, s89, 4
    s_mul_i32 s58, s58, 1536
    buffer_load_dwordx2 v[166:167], v15, s[44:47], s58 offen offset:0 nt
    buffer_load_dwordx2 v[168:169], v15, s[44:47], s58 offen offset:128 nt
    buffer_load_dwordx2 v[170:171], v15, s[44:47], s58 offen offset:256 nt
    s_lshr_b32 s58, s90, 4
    s_mul_i32 s58, s58, 1536
    buffer_load_dwordx2 v[172:173], v15, s[44:47], s58 offen offset:0 nt
    buffer_load_dwordx2 v[174:175], v15, s[44:47], s58 offen offset:128 nt
    buffer_load_dwordx2 v[176:177], v15, s[44:47], s58 offen offset:256 nt
    s_mov_b32 s61, 0
    s_mov_b32 s62, 0
    s_movk_i32 s63, 3072
    s_waitcnt vmcnt(26)
    s_barrier
    v_add_u32 v33, s63, v17
    v_add_u32 v34, s63, v18
    ds_read_b64 v[108:109], v33 offset:0
    ds_read_b64 v[110:111], v33 offset:1536
    ds_read_b64 v[112:113], v33 offset:128
    ds_read_b64 v[114:115], v33 offset:1664
    ds_read_b64 v[116:117], v33 offset:256
    ds_read_b64 v[118:119], v33 offset:1792
    ds_read_b64 v[120:121], v34 offset:0
    ds_read_b64 v[122:123], v34 offset:1536
    ds_read_b64 v[124:125], v34 offset:128
    ds_read_b64 v[126:127], v34 offset:1664
    ds_read_b64 v[128:129], v34 offset:256
    ds_read_b64 v[130:131], v34 offset:1792
    s_waitcnt lgkmcnt(0)
    v_lshlrev_b32 v60, 16, v108
    v_and_b32 v61, s66, v108
    v_lshlrev_b32 v62, 16, v109
    v_and_b32 v63, s66, v109
    v_lshlrev_b32 v84, 16, v110
    v_and_b32 v85, s66, v110
    v_lshlrev_b32 v86, 16, v111
    v_and_b32 v87, s66, v111
    v_lshlrev_b32 v64, 16, v112
    v_and_b32 v65, s66, v112
    v_lshlrev_b32 v66, 16, v113
    v_and_b32 v67, s66, v113
    v_lshlrev_b32 v88, 16, v114
    v_and_b32 v89, s66, v114
    v_lshlrev_b32 v90, 16, v115
    v_and_b32 v91, s66, v115
    v_lshlrev_b32 v68, 16, v116
    v_and_b32 v69, s66, v116
    v_lshlrev_b32 v70, 16, v117
    v_and_b32 v71, s66, v117
    v_lshlrev_b32 v92, 16, v118
    v_and_b32 v93, s66, v118
    v_lshlrev_b32 v94, 16, v119
    v_and_b32 v95, s66, v119
    v_lshlrev_b32 v72, 16, v120
    v_and_b32 v73, s66, v120
    v_lshlrev_b32 v74, 16, v121
    v_and_b32 v75, s66, v121
    v_lshlrev_b32 v96, 16, v122
    v_and_b32 v97, s66, v122
    v_lshlrev_b32 v98, 16, v123
    v_and_b32 v99, s66, v123
    v_lshlrev_b32 v76, 16, v124
    v_and_b32 v77, s66, v124
    v_lshlrev_b32 v78, 16, v125
    v_and_b32 v79, s66, v125
    v_lshlrev_b32 v100, 16, v126
    v_and_b32 v101, s66, v126
    v_lshlrev_b32 v102, 16, v127
    v_and_b32 v103, s66, v127
    v_lshlrev_b32 v80, 16, v128
    v_and_b32 v81, s66, v128
    v_lshlrev_b32 v82, 16, v129
    v_and_b32 v83, s66, v129
    v_lshlrev_b32 v104, 16, v130
    v_and_b32 v105, s66, v130
    v_lshlrev_b32 v106, 16, v131
    v_and_b32 v107, s66, v131
L_kblk:
    v_add_u32 v13, s62, v12
    s_add_u32 s62, s62, 24576
    s_cmp_eq_u32 s62, 73728
    s_cselect_b32 s62, 0, s62
    s_barrier
    ds_read_b128 v[36:39], v13 offset:0
    ds_read_b128 v[40:43], v13 offset:256
    ds_read_b128 v[44:47], v13 offset:512
    ds_read_b128 v[48:51], v13 offset:3072
    ds_read_b128 v[52:55], v13 offset:3328
    ds_read_b128 v[56:59], v13 offset:3584
    s_waitcnt lgkmcnt(3)
    v_cvt_f32_i32 v36, v36
    v_cvt_f32_i32 v37, v37
    v_cvt_f32_i32 v38, v38
    v_cvt_f32_i32 v39, v39
    v_cvt_f32_i32 v40, v40
    v_cvt_f32_i32 v41, v41
    v_cvt_f32_i32 v42, v42
    v_cvt_f32_i32 v43, v43
    v_cvt_f32_i32 v44, v44
    v_cvt_f32_i32 v45, v45
    v_cvt_f32_i32 v46, v46
    v_cvt_f32_i32 v47, v47
    v_sub_f32 v36, v36, v60
    v_sub_f32 v37, v37, v61
    v_sub_f32 v38, v38, v62
    v_sub_f32 v39, v39, v63
    v_sub_f32 v40, v40, v64
    v_sub_f32 v41, v41, v65
    v_sub_f32 v42, v42, v66
    v_sub_f32 v43, v43, v67
    v_sub_f32 v44, v44, v68
    v_sub_f32 v45, v45, v69
    v_sub_f32 v46, v46, v70
    v_sub_f32 v47, v47, v71
    v_cvt_pk_bf16_f32 v36, 0, v36
    v_cvt_pk_bf16_f32 v37, 0, v37
    v_cvt_pk_bf16_f32 v38, 0, v38
    v_cvt_pk_bf16_f32 v39, 0, v39
    v_cvt_pk_bf16_f32 v40, 0, v40
    v_cvt_pk_bf16_f32 v41, 0, v41
    v_cvt_pk_bf16_f32 v42, 0, v42
    v_cvt_pk_bf16_f32 v43, 0, v43
    v_cvt_pk_bf16_f32 v44, 0, v44
    v_cvt_pk_bf16_f32 v45, 0, v45
    v_cvt_pk_bf16_f32 v46, 0, v46
    v_cvt_pk_bf16_f32 v47, 0, v47
    v_mul_f32 v36, v36, v84
    v_mul_f32 v37, v37, v85
    v_mul_f32 v38, v38, v86
    v_mul_f32 v39, v39, v87
    v_mul_f32 v40, v40, v88
    v_mul_f32 v41, v41, v89
    v_mul_f32 v42, v42, v90
    v_mul_f32 v43, v43, v91
    v_mul_f32 v44, v44, v92
    v_mul_f32 v45, v45, v93
    v_mul_f32 v46, v46, v94
    v_mul_f32 v47, v47, v95
    v_cvt_pk_bf16_f32 v132, v36, v37
    v_cvt_pk_bf16_f32 v133, v38, v39
    v_cvt_pk_bf16_f32 v134, v40, v41
    v_cvt_pk_bf16_f32 v135, v42, v43
    v_cvt_pk_bf16_f32 v136, v44, v45
    v_cvt_pk_bf16_f32 v137, v46, v47
    v_mfma_f32_16x16x16_bf16 v[144:147], v[132:133], v[160:161], 0
    v_mfma_f32_16x16x16_bf16 v[144:147], v[134:135], v[162:163], v[144:147]
    v_mfma_f32_16x16x16_bf16 v[144:147], v[136:137], v[164:165], v[144:147]
    s_waitcnt lgkmcnt(0)
    v_cvt_f32_i32 v48, v48
    v_cvt_f32_i32 v49, v49
    v_cvt_f32_i32 v50, v50
    v_cvt_f32_i32 v51, v51
    v_cvt_f32_i32 v52, v52
    v_cvt_f32_i32 v53, v53
    v_cvt_f32_i32 v54, v54
    v_cvt_f32_i32 v55, v55
    v_cvt_f32_i32 v56, v56
    v_cvt_f32_i32 v57, v57
    v_cvt_f32_i32 v58, v58
    v_cvt_f32_i32 v59, v59
    v_sub_f32 v48, v48, v72
    v_sub_f32 v49, v49, v73
    v_sub_f32 v50, v50, v74
    v_sub_f32 v51, v51, v75
    v_sub_f32 v52, v52, v76
    v_sub_f32 v53, v53, v77
    v_sub_f32 v54, v54, v78
    v_sub_f32 v55, v55, v79
    v_sub_f32 v56, v56, v80
    v_sub_f32 v57, v57, v81
    v_sub_f32 v58, v58, v82
    v_sub_f32 v59, v59, v83
    v_cvt_pk_bf16_f32 v48, 0, v48
    v_cvt_pk_bf16_f32 v49, 0, v49
    v_cvt_pk_bf16_f32 v50, 0, v50
    v_cvt_pk_bf16_f32 v51, 0, v51
    v_cvt_pk_bf16_f32 v52, 0, v52
    v_cvt_pk_bf16_f32 v53, 0, v53
    v_cvt_pk_bf16_f32 v54, 0, v54
    v_cvt_pk_bf16_f32 v55, 0, v55
    v_cvt_pk_bf16_f32 v56, 0, v56
    v_cvt_pk_bf16_f32 v57, 0, v57
    v_cvt_pk_bf16_f32 v58, 0, v58
    v_cvt_pk_bf16_f32 v59, 0, v59
    v_mul_f32 v48, v48, v96
    v_mul_f32 v49, v49, v97
    v_mul_f32 v50, v50, v98
    v_mul_f32 v51, v51, v99
    v_mul_f32 v52, v52, v100
    v_mul_f32 v53, v53, v101
    v_mul_f32 v54, v54, v102
    v_mul_f32 v55, v55, v103
    v_mul_f32 v56, v56, v104
    v_mul_f32 v57, v57, v105
    v_mul_f32 v58, v58, v106
    v_mul_f32 v59, v59, v107
    v_cvt_pk_bf16_f32 v138, v48, v49
    v_cvt_pk_bf16_f32 v139, v50, v51
    v_add_f32_dpp v3, v145, v144 row_ror:12 row_mask:0xf bank_mask:0xf
    v_cvt_pk_bf16_f32 v140, v52, v53
    v_cvt_pk_bf16_f32 v141, v54, v55
    v_add_f32_dpp v3, v146, v3 row_ror:8 row_mask:0xf bank_mask:0xf
    v_cvt_pk_bf16_f32 v142, v56, v57
    v_cvt_pk_bf16_f32 v143, v58, v59
    v_add_f32_dpp v15, v147, v3 row_ror:4 row_mask:0xf bank_mask:0x1
    v_mfma_f32_16x16x16_bf16 v[148:151], v[138:139], v[160:161], 0
    v_mfma_f32_16x16x16_bf16 v[148:151], v[140:141], v[162:163], v[148:151]
    v_mfma_f32_16x16x16_bf16 v[148:151], v[142:143], v[164:165], v[148:151]
    v_add_u32 v33, s63, v19
    v_add_u32 v34, s63, v20
    ds_read_b64 v[108:109], v33 offset:0
    ds_read_b64 v[110:111], v33 offset:1536
    ds_read_b64 v[112:113], v33 offset:128
    ds_read_b64 v[114:115], v33 offset:1664
    ds_read_b64 v[116:117], v33 offset:256
    ds_read_b64 v[118:119], v33 offset:1792
    ds_read_b64 v[120:121], v34 offset:0
    v_add_f32_dpp v4, v149, v148 row_ror:12 row_mask:0xf bank_mask:0xf
    ds_read_b64 v[122:123], v34 offset:1536
    ds_read_b64 v[124:125], v34 offset:128
    v_add_f32_dpp v4, v150, v4 row_ror:8 row_mask:0xf bank_mask:0xf
    ds_read_b64 v[126:127], v34 offset:1664
    ds_read_b64 v[128:129], v34 offset:256
    ds_read_b64 v[130:131], v34 offset:1792
    v_add_f32_dpp v16, v151, v4 row_ror:4 row_mask:0xf bank_mask:0x1
    s_waitcnt lgkmcnt(0)
    v_lshlrev_b32 v60, 16, v108
    v_and_b32 v61, s66, v108
    v_lshlrev_b32 v62, 16, v109
    v_and_b32 v63, s66, v109
    v_lshlrev_b32 v84, 16, v110
    v_and_b32 v85, s66, v110
    v_lshlrev_b32 v86, 16, v111
    v_and_b32 v87, s66, v111
    v_lshlrev_b32 v64, 16, v112
    v_and_b32 v65, s66, v112
    v_lshlrev_b32 v66, 16, v113
    v_and_b32 v67, s66, v113
    v_lshlrev_b32 v88, 16, v114
    v_and_b32 v89, s66, v114
    v_lshlrev_b32 v90, 16, v115
    v_and_b32 v91, s66, v115
    v_lshlrev_b32 v68, 16, v116
    v_and_b32 v69, s66, v116
    v_lshlrev_b32 v70, 16, v117
    v_and_b32 v71, s66, v117
    v_lshlrev_b32 v92, 16, v118
    v_and_b32 v93, s66, v118
    v_lshlrev_b32 v94, 16, v119
    v_and_b32 v95, s66, v119
    v_lshlrev_b32 v72, 16, v120
    v_and_b32 v73, s66, v120
    v_lshlrev_b32 v74, 16, v121
    v_and_b32 v75, s66, v121
    v_lshlrev_b32 v96, 16, v122
    v_and_b32 v97, s66, v122
    v_lshlrev_b32 v98, 16, v123
    v_and_b32 v99, s66, v123
    v_lshlrev_b32 v76, 16, v124
    v_and_b32 v77, s66, v124
    v_lshlrev_b32 v78, 16, v125
    v_and_b32 v79, s66, v125
    v_lshlrev_b32 v100, 16, v126
    v_and_b32 v101, s66, v126
    v_lshlrev_b32 v102, 16, v127
    v_and_b32 v103, s66, v127
    v_lshlrev_b32 v80, 16, v128
    v_and_b32 v81, s66, v128
    v_lshlrev_b32 v82, 16, v129
    v_and_b32 v83, s66, v129
    v_lshlrev_b32 v104, 16, v130
    v_and_b32 v105, s66, v130
    v_lshlrev_b32 v106, 16, v131
    v_and_b32 v107, s66, v131
    v_add_u32 v13, s62, v12
    s_add_u32 s62, s62, 24576
    s_cmp_eq_u32 s62, 73728
    s_cselect_b32 s62, 0, s62
    s_barrier
    ds_read_b128 v[36:39], v13 offset:0
    ds_read_b128 v[40:43], v13 offset:256
    ds_read_b128 v[44:47], v13 offset:512
    ds_read_b128 v[48:51], v13 offset:3072
    ds_read_b128 v[52:55], v13 offset:3328
    ds_read_b128 v[56:59], v13 offset:3584
    s_waitcnt lgkmcnt(3)
    v_cvt_f32_i32 v36, v36
    v_cvt_f32_i32 v37, v37
    v_cvt_f32_i32 v38, v38
    v_cvt_f32_i32 v39, v39
    v_cvt_f32_i32 v40, v40
    v_cvt_f32_i32 v41, v41
    v_cvt_f32_i32 v42, v42
    v_cvt_f32_i32 v43, v43
    v_cvt_f32_i32 v44, v44
    v_cvt_f32_i32 v45, v45
    v_cvt_f32_i32 v46, v46
    v_cvt_f32_i32 v47, v47
    v_sub_f32 v36, v36, v60
    v_sub_f32 v37, v37, v61
    v_sub_f32 v38, v38, v62
    v_sub_f32 v39, v39, v63
    v_sub_f32 v40, v40, v64
    v_sub_f32 v41, v41, v65
    v_sub_f32 v42, v42, v66
    v_sub_f32 v43, v43, v67
    v_sub_f32 v44, v44, v68
    v_sub_f32 v45, v45, v69
    v_sub_f32 v46, v46, v70
    v_sub_f32 v47, v47, v71
    v_cvt_pk_bf16_f32 v36, 0, v36
    v_cvt_pk_bf16_f32 v37, 0, v37
    v_cvt_pk_bf16_f32 v38, 0, v38
    v_cvt_pk_bf16_f32 v39, 0, v39
    v_cvt_pk_bf16_f32 v40, 0, v40
    v_cvt_pk_bf16_f32 v41, 0, v41
    v_cvt_pk_bf16_f32 v42, 0, v42
    v_cvt_pk_bf16_f32 v43, 0, v43
    v_cvt_pk_bf16_f32 v44, 0, v44
    v_cvt_pk_bf16_f32 v45, 0, v45
    v_cvt_pk_bf16_f32 v46, 0, v46
    v_cvt_pk_bf16_f32 v47, 0, v47
    v_mul_f32 v36, v36, v84
    v_mul_f32 v37, v37, v85
    v_mul_f32 v38, v38, v86
    v_mul_f32 v39, v39, v87
    v_mul_f32 v40, v40, v88
    v_mul_f32 v41, v41, v89
    v_mul_f32 v42, v42, v90
    v_mul_f32 v43, v43, v91
    v_mul_f32 v44, v44, v92
    v_mul_f32 v45, v45, v93
    v_mul_f32 v46, v46, v94
    v_mul_f32 v47, v47, v95
    v_cvt_pk_bf16_f32 v132, v36, v37
    v_cvt_pk_bf16_f32 v133, v38, v39
    v_cvt_pk_bf16_f32 v134, v40, v41
    v_cvt_pk_bf16_f32 v135, v42, v43
    v_cvt_pk_bf16_f32 v136, v44, v45
    v_cvt_pk_bf16_f32 v137, v46, v47
    v_mfma_f32_16x16x16_bf16 v[144:147], v[132:133], v[160:161], 0
    v_mfma_f32_16x16x16_bf16 v[144:147], v[134:135], v[162:163], v[144:147]
    v_mfma_f32_16x16x16_bf16 v[144:147], v[136:137], v[164:165], v[144:147]
    s_waitcnt lgkmcnt(0)
    v_cvt_f32_i32 v48, v48
    v_cvt_f32_i32 v49, v49
    v_cvt_f32_i32 v50, v50
    v_cvt_f32_i32 v51, v51
    v_cvt_f32_i32 v52, v52
    v_cvt_f32_i32 v53, v53
    v_cvt_f32_i32 v54, v54
    v_cvt_f32_i32 v55, v55
    v_cvt_f32_i32 v56, v56
    v_cvt_f32_i32 v57, v57
    v_cvt_f32_i32 v58, v58
    v_cvt_f32_i32 v59, v59
    v_sub_f32 v48, v48, v72
    v_sub_f32 v49, v49, v73
    v_sub_f32 v50, v50, v74
    v_sub_f32 v51, v51, v75
    v_sub_f32 v52, v52, v76
    v_sub_f32 v53, v53, v77
    v_sub_f32 v54, v54, v78
    v_sub_f32 v55, v55, v79
    v_sub_f32 v56, v56, v80
    v_sub_f32 v57, v57, v81
    v_sub_f32 v58, v58, v82
    v_sub_f32 v59, v59, v83
    v_cvt_pk_bf16_f32 v48, 0, v48
    v_cvt_pk_bf16_f32 v49, 0, v49
    v_cvt_pk_bf16_f32 v50, 0, v50
    v_cvt_pk_bf16_f32 v51, 0, v51
    v_cvt_pk_bf16_f32 v52, 0, v52
    v_cvt_pk_bf16_f32 v53, 0, v53
    v_cvt_pk_bf16_f32 v54, 0, v54
    v_cvt_pk_bf16_f32 v55, 0, v55
    v_cvt_pk_bf16_f32 v56, 0, v56
    v_cvt_pk_bf16_f32 v57, 0, v57
    v_cvt_pk_bf16_f32 v58, 0, v58
    v_cvt_pk_bf16_f32 v59, 0, v59
    v_mul_f32 v48, v48, v96
    v_mul_f32 v49, v49, v97
    v_mul_f32 v50, v50, v98
    v_mul_f32 v51, v51, v99
    v_mul_f32 v52, v52, v100
    v_mul_f32 v53, v53, v101
    v_mul_f32 v54, v54, v102
    v_mul_f32 v55, v55, v103
    v_mul_f32 v56, v56, v104
    v_mul_f32 v57, v57, v105
    v_mul_f32 v58, v58, v106
    v_mul_f32 v59, v59, v107
    v_cvt_pk_bf16_f32 v138, v48, v49
    v_cvt_pk_bf16_f32 v139, v50, v51
    v_add_f32_dpp v3, v146, v145 row_ror:12 row_mask:0xf bank_mask:0xf
    v_cvt_pk_bf16_f32 v140, v52, v53
    v_cvt_pk_bf16_f32 v141, v54, v55
    v_add_f32_dpp v3, v147, v3 row_ror:8 row_mask:0xf bank_mask:0xf
    v_cvt_pk_bf16_f32 v142, v56, v57
    v_cvt_pk_bf16_f32 v143, v58, v59
    v_add_f32_dpp v15, v144, v3 row_ror:4 row_mask:0xf bank_mask:0x2
    v_mfma_f32_16x16x16_bf16 v[148:151], v[138:139], v[160:161], 0
    v_mfma_f32_16x16x16_bf16 v[148:151], v[140:141], v[162:163], v[148:151]
    v_mfma_f32_16x16x16_bf16 v[148:151], v[142:143], v[164:165], v[148:151]
    v_add_u32 v33, s63, v21
    v_add_u32 v34, s63, v22
    ds_read_b64 v[108:109], v33 offset:0
    ds_read_b64 v[110:111], v33 offset:1536
    ds_read_b64 v[112:113], v33 offset:128
    ds_read_b64 v[114:115], v33 offset:1664
    ds_read_b64 v[116:117], v33 offset:256
    ds_read_b64 v[118:119], v33 offset:1792
    ds_read_b64 v[120:121], v34 offset:0
    v_add_f32_dpp v4, v150, v149 row_ror:12 row_mask:0xf bank_mask:0xf
    ds_read_b64 v[122:123], v34 offset:1536
    ds_read_b64 v[124:125], v34 offset:128
    v_add_f32_dpp v4, v151, v4 row_ror:8 row_mask:0xf bank_mask:0xf
    ds_read_b64 v[126:127], v34 offset:1664
    ds_read_b64 v[128:129], v34 offset:256
    ds_read_b64 v[130:131], v34 offset:1792
    v_add_f32_dpp v16, v148, v4 row_ror:4 row_mask:0xf bank_mask:0x2
    s_waitcnt lgkmcnt(0)
    v_lshlrev_b32 v60, 16, v108
    v_and_b32 v61, s66, v108
    v_lshlrev_b32 v62, 16, v109
    v_and_b32 v63, s66, v109
    v_lshlrev_b32 v84, 16, v110
    v_and_b32 v85, s66, v110
    v_lshlrev_b32 v86, 16, v111
    v_and_b32 v87, s66, v111
    v_lshlrev_b32 v64, 16, v112
    v_and_b32 v65, s66, v112
    v_lshlrev_b32 v66, 16, v113
    v_and_b32 v67, s66, v113
    v_lshlrev_b32 v88, 16, v114
    v_and_b32 v89, s66, v114
    v_lshlrev_b32 v90, 16, v115
    v_and_b32 v91, s66, v115
    v_lshlrev_b32 v68, 16, v116
    v_and_b32 v69, s66, v116
    v_lshlrev_b32 v70, 16, v117
    v_and_b32 v71, s66, v117
    v_lshlrev_b32 v92, 16, v118
    v_and_b32 v93, s66, v118
    v_lshlrev_b32 v94, 16, v119
    v_and_b32 v95, s66, v119
    v_lshlrev_b32 v72, 16, v120
    v_and_b32 v73, s66, v120
    v_lshlrev_b32 v74, 16, v121
    v_and_b32 v75, s66, v121
    v_lshlrev_b32 v96, 16, v122
    v_and_b32 v97, s66, v122
    v_lshlrev_b32 v98, 16, v123
    v_and_b32 v99, s66, v123
    v_lshlrev_b32 v76, 16, v124
    v_and_b32 v77, s66, v124
    v_lshlrev_b32 v78, 16, v125
    v_and_b32 v79, s66, v125
    v_lshlrev_b32 v100, 16, v126
    v_and_b32 v101, s66, v126
    v_lshlrev_b32 v102, 16, v127
    v_and_b32 v103, s66, v127
    v_lshlrev_b32 v80, 16, v128
    v_and_b32 v81, s66, v128
    v_lshlrev_b32 v82, 16, v129
    v_and_b32 v83, s66, v129
    v_lshlrev_b32 v104, 16, v130
    v_and_b32 v105, s66, v130
    v_lshlrev_b32 v106, 16, v131
    v_and_b32 v107, s66, v131
    v_add_u32 v13, s62, v12
    s_add_u32 s62, s62, 24576
    s_cmp_eq_u32 s62, 73728
    s_cselect_b32 s62, 0, s62
    s_barrier
    ds_read_b128 v[36:39], v13 offset:0
    ds_read_b128 v[40:43], v13 offset:256
    ds_read_b128 v[44:47], v13 offset:512
    ds_read_b128 v[48:51], v13 offset:3072
    ds_read_b128 v[52:55], v13 offset:3328
    ds_read_b128 v[56:59], v13 offset:3584
    s_waitcnt lgkmcnt(3)
    v_cvt_f32_i32 v36, v36
    v_cvt_f32_i32 v37, v37
    v_cvt_f32_i32 v38, v38
    v_cvt_f32_i32 v39, v39
    v_cvt_f32_i32 v40, v40
    v_cvt_f32_i32 v41, v41
    v_cvt_f32_i32 v42, v42
    v_cvt_f32_i32 v43, v43
    v_cvt_f32_i32 v44, v44
    v_cvt_f32_i32 v45, v45
    v_cvt_f32_i32 v46, v46
    v_cvt_f32_i32 v47, v47
    v_sub_f32 v36, v36, v60
    v_sub_f32 v37, v37, v61
    v_sub_f32 v38, v38, v62
    v_sub_f32 v39, v39, v63
    v_sub_f32 v40, v40, v64
    v_sub_f32 v41, v41, v65
    v_sub_f32 v42, v42, v66
    v_sub_f32 v43, v43, v67
    v_sub_f32 v44, v44, v68
    v_sub_f32 v45, v45, v69
    v_sub_f32 v46, v46, v70
    v_sub_f32 v47, v47, v71
    v_cvt_pk_bf16_f32 v36, 0, v36
    v_cvt_pk_bf16_f32 v37, 0, v37
    v_cvt_pk_bf16_f32 v38, 0, v38
    v_cvt_pk_bf16_f32 v39, 0, v39
    v_cvt_pk_bf16_f32 v40, 0, v40
    v_cvt_pk_bf16_f32 v41, 0, v41
    v_cvt_pk_bf16_f32 v42, 0, v42
    v_cvt_pk_bf16_f32 v43, 0, v43
    v_cvt_pk_bf16_f32 v44, 0, v44
    v_cvt_pk_bf16_f32 v45, 0, v45
    v_cvt_pk_bf16_f32 v46, 0, v46
    v_cvt_pk_bf16_f32 v47, 0, v47
    v_mul_f32 v36, v36, v84
    v_mul_f32 v37, v37, v85
    v_mul_f32 v38, v38, v86
    v_mul_f32 v39, v39, v87
    v_mul_f32 v40, v40, v88
    v_mul_f32 v41, v41, v89
    v_mul_f32 v42, v42, v90
    v_mul_f32 v43, v43, v91
    v_mul_f32 v44, v44, v92
    v_mul_f32 v45, v45, v93
    v_mul_f32 v46, v46, v94
    v_mul_f32 v47, v47, v95
    v_cvt_pk_bf16_f32 v132, v36, v37
    v_cvt_pk_bf16_f32 v133, v38, v39
    v_cvt_pk_bf16_f32 v134, v40, v41
    v_cvt_pk_bf16_f32 v135, v42, v43
    v_cvt_pk_bf16_f32 v136, v44, v45
    v_cvt_pk_bf16_f32 v137, v46, v47
    v_mfma_f32_16x16x16_bf16 v[144:147], v[132:133], v[160:161], 0
    v_mfma_f32_16x16x16_bf16 v[144:147], v[134:135], v[162:163], v[144:147]
    v_mfma_f32_16x16x16_bf16 v[144:147], v[136:137], v[164:165], v[144:147]
    s_waitcnt lgkmcnt(0)
    v_cvt_f32_i32 v48, v48
    v_cvt_f32_i32 v49, v49
    v_cvt_f32_i32 v50, v50
    v_cvt_f32_i32 v51, v51
    v_cvt_f32_i32 v52, v52
    v_cvt_f32_i32 v53, v53
    v_cvt_f32_i32 v54, v54
    v_cvt_f32_i32 v55, v55
    v_cvt_f32_i32 v56, v56
    v_cvt_f32_i32 v57, v57
    v_cvt_f32_i32 v58, v58
    v_cvt_f32_i32 v59, v59
    v_sub_f32 v48, v48, v72
    v_sub_f32 v49, v49, v73
    v_sub_f32 v50, v50, v74
    v_sub_f32 v51, v51, v75
    v_sub_f32 v52, v52, v76
    v_sub_f32 v53, v53, v77
    v_sub_f32 v54, v54, v78
    v_sub_f32 v55, v55, v79
    v_sub_f32 v56, v56, v80
    v_sub_f32 v57, v57, v81
    v_sub_f32 v58, v58, v82
    v_sub_f32 v59, v59, v83
    v_cvt_pk_bf16_f32 v48, 0, v48
    v_cvt_pk_bf16_f32 v49, 0, v49
    v_cvt_pk_bf16_f32 v50, 0, v50
    v_cvt_pk_bf16_f32 v51, 0, v51
    v_cvt_pk_bf16_f32 v52, 0, v52
    v_cvt_pk_bf16_f32 v53, 0, v53
    v_cvt_pk_bf16_f32 v54, 0, v54
    v_cvt_pk_bf16_f32 v55, 0, v55
    v_cvt_pk_bf16_f32 v56, 0, v56
    v_cvt_pk_bf16_f32 v57, 0, v57
    v_cvt_pk_bf16_f32 v58, 0, v58
    v_cvt_pk_bf16_f32 v59, 0, v59
    v_mul_f32 v48, v48, v96
    v_mul_f32 v49, v49, v97
    v_mul_f32 v50, v50, v98
    v_mul_f32 v51, v51, v99
    v_mul_f32 v52, v52, v100
    v_mul_f32 v53, v53, v101
    v_mul_f32 v54, v54, v102
    v_mul_f32 v55, v55, v103
    v_mul_f32 v56, v56, v104
    v_mul_f32 v57, v57, v105
    v_mul_f32 v58, v58, v106
    v_mul_f32 v59, v59, v107
    v_cvt_pk_bf16_f32 v138, v48, v49
    v_cvt_pk_bf16_f32 v139, v50, v51
    v_add_f32_dpp v3, v147, v146 row_ror:12 row_mask:0xf bank_mask:0xf
    v_cvt_pk_bf16_f32 v140, v52, v53
    v_cvt_pk_bf16_f32 v141, v54, v55
    v_add_f32_dpp v3, v144, v3 row_ror:8 row_mask:0xf bank_mask:0xf
    v_cvt_pk_bf16_f32 v142, v56, v57
    v_cvt_pk_bf16_f32 v143, v58, v59
    v_add_f32_dpp v15, v145, v3 row_ror:4 row_mask:0xf bank_mask:0x4
    v_mfma_f32_16x16x16_bf16 v[148:151], v[138:139], v[160:161], 0
    v_mfma_f32_16x16x16_bf16 v[148:151], v[140:141], v[162:163], v[148:151]
    v_mfma_f32_16x16x16_bf16 v[148:151], v[142:143], v[164:165], v[148:151]
    v_add_u32 v33, s63, v23
    v_add_u32 v34, s63, v24
    ds_read_b64 v[108:109], v33 offset:0
    ds_read_b64 v[110:111], v33 offset:1536
    ds_read_b64 v[112:113], v33 offset:128
    ds_read_b64 v[114:115], v33 offset:1664
    ds_read_b64 v[116:117], v33 offset:256
    ds_read_b64 v[118:119], v33 offset:1792
    ds_read_b64 v[120:121], v34 offset:0
    v_add_f32_dpp v4, v151, v150 row_ror:12 row_mask:0xf bank_mask:0xf
    ds_read_b64 v[122:123], v34 offset:1536
    ds_read_b64 v[124:125], v34 offset:128
    v_add_f32_dpp v4, v148, v4 row_ror:8 row_mask:0xf bank_mask:0xf
    ds_read_b64 v[126:127], v34 offset:1664
    ds_read_b64 v[128:129], v34 offset:256
    ds_read_b64 v[130:131], v34 offset:1792
    v_add_f32_dpp v16, v149, v4 row_ror:4 row_mask:0xf bank_mask:0x4
    s_waitcnt lgkmcnt(0)
    v_lshlrev_b32 v60, 16, v108
    v_and_b32 v61, s66, v108
    v_lshlrev_b32 v62, 16, v109
    v_and_b32 v63, s66, v109
    v_lshlrev_b32 v84, 16, v110
    v_and_b32 v85, s66, v110
    v_lshlrev_b32 v86, 16, v111
    v_and_b32 v87, s66, v111
    v_lshlrev_b32 v64, 16, v112
    v_and_b32 v65, s66, v112
    v_lshlrev_b32 v66, 16, v113
    v_and_b32 v67, s66, v113
    v_lshlrev_b32 v88, 16, v114
    v_and_b32 v89, s66, v114
    v_lshlrev_b32 v90, 16, v115
    v_and_b32 v91, s66, v115
    v_lshlrev_b32 v68, 16, v116
    v_and_b32 v69, s66, v116
    v_lshlrev_b32 v70, 16, v117
    v_and_b32 v71, s66, v117
    v_lshlrev_b32 v92, 16, v118
    v_and_b32 v93, s66, v118
    v_lshlrev_b32 v94, 16, v119
    v_and_b32 v95, s66, v119
    v_lshlrev_b32 v72, 16, v120
    v_and_b32 v73, s66, v120
    v_lshlrev_b32 v74, 16, v121
    v_and_b32 v75, s66, v121
    v_lshlrev_b32 v96, 16, v122
    v_and_b32 v97, s66, v122
    v_lshlrev_b32 v98, 16, v123
    v_and_b32 v99, s66, v123
    v_lshlrev_b32 v76, 16, v124
    v_and_b32 v77, s66, v124
    v_lshlrev_b32 v78, 16, v125
    v_and_b32 v79, s66, v125
    v_lshlrev_b32 v100, 16, v126
    v_and_b32 v101, s66, v126
    v_lshlrev_b32 v102, 16, v127
    v_and_b32 v103, s66, v127
    v_lshlrev_b32 v80, 16, v128
    v_and_b32 v81, s66, v128
    v_lshlrev_b32 v82, 16, v129
    v_and_b32 v83, s66, v129
    v_lshlrev_b32 v104, 16, v130
    v_and_b32 v105, s66, v130
    v_lshlrev_b32 v106, 16, v131
    v_and_b32 v107, s66, v131
    v_add_u32 v13, s62, v12
    s_add_u32 s62, s62, 24576
    s_cmp_eq_u32 s62, 73728
    s_cselect_b32 s62, 0, s62
    s_barrier
    ds_read_b128 v[36:39], v13 offset:0
    ds_read_b128 v[40:43], v13 offset:256
    ds_read_b128 v[44:47], v13 offset:512
    ds_read_b128 v[48:51], v13 offset:3072
    ds_read_b128 v[52:55], v13 offset:3328
    ds_read_b128 v[56:59], v13 offset:3584
    s_waitcnt lgkmcnt(3)
    v_cvt_f32_i32 v36, v36
    v_cvt_f32_i32 v37, v37
    v_cvt_f32_i32 v38, v38
    v_cvt_f32_i32 v39, v39
    v_cvt_f32_i32 v40, v40
    v_cvt_f32_i32 v41, v41
    v_cvt_f32_i32 v42, v42
    v_cvt_f32_i32 v43, v43
    v_cvt_f32_i32 v44, v44
    v_cvt_f32_i32 v45, v45
    v_cvt_f32_i32 v46, v46
    v_cvt_f32_i32 v47, v47
    v_sub_f32 v36, v36, v60
    v_sub_f32 v37, v37, v61
    v_sub_f32 v38, v38, v62
    v_sub_f32 v39, v39, v63
    v_sub_f32 v40, v40, v64
    v_sub_f32 v41, v41, v65
    v_sub_f32 v42, v42, v66
    v_sub_f32 v43, v43, v67
    v_sub_f32 v44, v44, v68
    v_sub_f32 v45, v45, v69
    v_sub_f32 v46, v46, v70
    v_sub_f32 v47, v47, v71
    v_cvt_pk_bf16_f32 v36, 0, v36
    v_cvt_pk_bf16_f32 v37, 0, v37
    v_cvt_pk_bf16_f32 v38, 0, v38
    v_cvt_pk_bf16_f32 v39, 0, v39
    v_cvt_pk_bf16_f32 v40, 0, v40
    v_cvt_pk_bf16_f32 v41, 0, v41
    v_cvt_pk_bf16_f32 v42, 0, v42
    v_cvt_pk_bf16_f32 v43, 0, v43
    v_cvt_pk_bf16_f32 v44, 0, v44
    v_cvt_pk_bf16_f32 v45, 0, v45
    v_cvt_pk_bf16_f32 v46, 0, v46
    v_cvt_pk_bf16_f32 v47, 0, v47
    v_mul_f32 v36, v36, v84
    v_mul_f32 v37, v37, v85
    v_mul_f32 v38, v38, v86
    v_mul_f32 v39, v39, v87
    v_mul_f32 v40, v40, v88
    v_mul_f32 v41, v41, v89
    v_mul_f32 v42, v42, v90
    v_mul_f32 v43, v43, v91
    v_mul_f32 v44, v44, v92
    v_mul_f32 v45, v45, v93
    v_mul_f32 v46, v46, v94
    v_mul_f32 v47, v47, v95
    v_cvt_pk_bf16_f32 v132, v36, v37
    v_cvt_pk_bf16_f32 v133, v38, v39
    v_cvt_pk_bf16_f32 v134, v40, v41
    v_cvt_pk_bf16_f32 v135, v42, v43
    v_cvt_pk_bf16_f32 v136, v44, v45
    v_cvt_pk_bf16_f32 v137, v46, v47
    v_mfma_f32_16x16x16_bf16 v[144:147], v[132:133], v[160:161], 0
    v_mfma_f32_16x16x16_bf16 v[144:147], v[134:135], v[162:163], v[144:147]
    v_mfma_f32_16x16x16_bf16 v[144:147], v[136:137], v[164:165], v[144:147]
    s_waitcnt lgkmcnt(0)
    v_cvt_f32_i32 v48, v48
    v_cvt_f32_i32 v49, v49
    v_cvt_f32_i32 v50, v50
    v_cvt_f32_i32 v51, v51
    v_cvt_f32_i32 v52, v52
    v_cvt_f32_i32 v53, v53
    v_cvt_f32_i32 v54, v54
    v_cvt_f32_i32 v55, v55
    v_cvt_f32_i32 v56, v56
    v_cvt_f32_i32 v57, v57
    v_cvt_f32_i32 v58, v58
    v_cvt_f32_i32 v59, v59
    v_sub_f32 v48, v48, v72
    v_sub_f32 v49, v49, v73
    v_sub_f32 v50, v50, v74
    v_sub_f32 v51, v51, v75
    v_sub_f32 v52, v52, v76
    v_sub_f32 v53, v53, v77
    v_sub_f32 v54, v54, v78
    v_sub_f32 v55, v55, v79
    v_sub_f32 v56, v56, v80
    v_sub_f32 v57, v57, v81
    v_sub_f32 v58, v58, v82
    v_sub_f32 v59, v59, v83
    v_cvt_pk_bf16_f32 v48, 0, v48
    v_cvt_pk_bf16_f32 v49, 0, v49
    v_cvt_pk_bf16_f32 v50, 0, v50
    v_cvt_pk_bf16_f32 v51, 0, v51
    v_cvt_pk_bf16_f32 v52, 0, v52
    v_cvt_pk_bf16_f32 v53, 0, v53
    v_cvt_pk_bf16_f32 v54, 0, v54
    v_cvt_pk_bf16_f32 v55, 0, v55
    v_cvt_pk_bf16_f32 v56, 0, v56
    v_cvt_pk_bf16_f32 v57, 0, v57
    v_cvt_pk_bf16_f32 v58, 0, v58
    v_cvt_pk_bf16_f32 v59, 0, v59
    v_mul_f32 v48, v48, v96
    v_mul_f32 v49, v49, v97
    v_mul_f32 v50, v50, v98
    v_mul_f32 v51, v51, v99
    v_mul_f32 v52, v52, v100
    v_mul_f32 v53, v53, v101
    v_mul_f32 v54, v54, v102
    v_mul_f32 v55, v55, v103
    v_mul_f32 v56, v56, v104
    v_mul_f32 v57, v57, v105
    v_mul_f32 v58, v58, v106
    v_mul_f32 v59, v59, v107
    v_cvt_pk_bf16_f32 v138, v48, v49
    v_cvt_pk_bf16_f32 v139, v50, v51
    v_add_f32_dpp v3, v144, v147 row_ror:12 row_mask:0xf bank_mask:0xf
    v_cvt_pk_bf16_f32 v140, v52, v53
    v_cvt_pk_bf16_f32 v141, v54, v55
    v_add_f32_dpp v3, v145, v3 row_ror:8 row_mask:0xf bank_mask:0xf
    v_cvt_pk_bf16_f32 v142, v56, v57
    v_cvt_pk_bf16_f32 v143, v58, v59
    v_add_f32_dpp v15, v146, v3 row_ror:4 row_mask:0xf bank_mask:0x8
    v_mfma_f32_16x16x16_bf16 v[148:151], v[138:139], v[160:161], 0
    v_mfma_f32_16x16x16_bf16 v[148:151], v[140:141], v[162:163], v[148:151]
    v_mfma_f32_16x16x16_bf16 v[148:151], v[142:143], v[164:165], v[148:151]
    v_add_u32 v33, s63, v25
    v_add_u32 v34, s63, v26
    ds_read_b64 v[108:109], v33 offset:0
    ds_read_b64 v[110:111], v33 offset:1536
    ds_read_b64 v[112:113], v33 offset:128
    ds_read_b64 v[114:115], v33 offset:1664
    ds_read_b64 v[116:117], v33 offset:256
    ds_read_b64 v[118:119], v33 offset:1792
    ds_read_b64 v[120:121], v34 offset:0
    v_add_f32_dpp v4, v148, v151 row_ror:12 row_mask:0xf bank_mask:0xf
    ds_read_b64 v[122:123], v34 offset:1536
    ds_read_b64 v[124:125], v34 offset:128
    v_add_f32_dpp v4, v149, v4 row_ror:8 row_mask:0xf bank_mask:0xf
    ds_read_b64 v[126:127], v34 offset:1664
    ds_read_b64 v[128:129], v34 offset:256
    ds_read_b64 v[130:131], v34 offset:1792
    v_add_f32_dpp v16, v150, v4 row_ror:4 row_mask:0xf bank_mask:0x8
    v_cvt_pk_bf16_f32 v3, 0, v15
    v_cvt_pk_bf16_f32 v4, 0, v16
    v_mul_f32 v3, s65, v3
    v_mul_f32 v4, s65, v4
    v_cvt_pk_bf16_f32 v5, v3, v4
    v_max3_f32 v14, v14, v3, v4
    ds_write_b32 v11, v5 offset:0
    s_waitcnt lgkmcnt(0)
    v_lshlrev_b32 v60, 16, v108
    v_and_b32 v61, s66, v108
    v_lshlrev_b32 v62, 16, v109
    v_and_b32 v63, s66, v109
    v_lshlrev_b32 v84, 16, v110
    v_and_b32 v85, s66, v110
    v_lshlrev_b32 v86, 16, v111
    v_and_b32 v87, s66, v111
    v_lshlrev_b32 v64, 16, v112
    v_and_b32 v65, s66, v112
    v_lshlrev_b32 v66, 16, v113
    v_and_b32 v67, s66, v113
    v_lshlrev_b32 v88, 16, v114
    v_and_b32 v89, s66, v114
    v_lshlrev_b32 v90, 16, v115
    v_and_b32 v91, s66, v115
    v_lshlrev_b32 v68, 16, v116
    v_and_b32 v69, s66, v116
    v_lshlrev_b32 v70, 16, v117
    v_and_b32 v71, s66, v117
    v_lshlrev_b32 v92, 16, v118
    v_and_b32 v93, s66, v118
    v_lshlrev_b32 v94, 16, v119
    v_and_b32 v95, s66, v119
    v_lshlrev_b32 v72, 16, v120
    v_and_b32 v73, s66, v120
    v_lshlrev_b32 v74, 16, v121
    v_and_b32 v75, s66, v121
    v_lshlrev_b32 v96, 16, v122
    v_and_b32 v97, s66, v122
    v_lshlrev_b32 v98, 16, v123
    v_and_b32 v99, s66, v123
    v_lshlrev_b32 v76, 16, v124
    v_and_b32 v77, s66, v124
    v_lshlrev_b32 v78, 16, v125
    v_and_b32 v79, s66, v125
    v_lshlrev_b32 v100, 16, v126
    v_and_b32 v101, s66, v126
    v_lshlrev_b32 v102, 16, v127
    v_and_b32 v103, s66, v127
    v_lshlrev_b32 v80, 16, v128
    v_and_b32 v81, s66, v128
    v_lshlrev_b32 v82, 16, v129
    v_and_b32 v83, s66, v129
    v_lshlrev_b32 v104, 16, v130
    v_and_b32 v105, s66, v130
    v_lshlrev_b32 v106, 16, v131
    v_and_b32 v107, s66, v131
    s_waitcnt vmcnt(0)
    v_add_u32 v13, s62, v12
    s_add_u32 s62, s62, 24576
    s_cmp_eq_u32 s62, 73728
    s_cselect_b32 s62, 0, s62
    s_barrier
    ds_read_b128 v[36:39], v13 offset:0
    ds_read_b128 v[40:43], v13 offset:256
    ds_read_b128 v[44:47], v13 offset:512
    ds_read_b128 v[48:51], v13 offset:3072
    ds_read_b128 v[52:55], v13 offset:3328
    ds_read_b128 v[56:59], v13 offset:3584
    s_waitcnt lgkmcnt(3)
    v_cvt_f32_i32 v36, v36
    v_cvt_f32_i32 v37, v37
    v_cvt_f32_i32 v38, v38
    v_cvt_f32_i32 v39, v39
    v_cvt_f32_i32 v40, v40
    v_cvt_f32_i32 v41, v41
    v_cvt_f32_i32 v42, v42
    v_cvt_f32_i32 v43, v43
    v_cvt_f32_i32 v44, v44
    v_cvt_f32_i32 v45, v45
    v_cvt_f32_i32 v46, v46
    v_cvt_f32_i32 v47, v47
    v_sub_f32 v36, v36, v60
    v_sub_f32 v37, v37, v61
    v_sub_f32 v38, v38, v62
    v_sub_f32 v39, v39, v63
    v_sub_f32 v40, v40, v64
    v_sub_f32 v41, v41, v65
    v_sub_f32 v42, v42, v66
    v_sub_f32 v43, v43, v67
    v_sub_f32 v44, v44, v68
    v_sub_f32 v45, v45, v69
    v_sub_f32 v46, v46, v70
    v_sub_f32 v47, v47, v71
    v_cvt_pk_bf16_f32 v36, 0, v36
    v_cvt_pk_bf16_f32 v37, 0, v37
    v_cvt_pk_bf16_f32 v38, 0, v38
    v_cvt_pk_bf16_f32 v39, 0, v39
    v_cvt_pk_bf16_f32 v40, 0, v40
    v_cvt_pk_bf16_f32 v41, 0, v41
    v_cvt_pk_bf16_f32 v42, 0, v42
    v_cvt_pk_bf16_f32 v43, 0, v43
    v_cvt_pk_bf16_f32 v44, 0, v44
    v_cvt_pk_bf16_f32 v45, 0, v45
    v_cvt_pk_bf16_f32 v46, 0, v46
    v_cvt_pk_bf16_f32 v47, 0, v47
    v_mul_f32 v36, v36, v84
    v_mul_f32 v37, v37, v85
    v_mul_f32 v38, v38, v86
    v_mul_f32 v39, v39, v87
    v_mul_f32 v40, v40, v88
    v_mul_f32 v41, v41, v89
    v_mul_f32 v42, v42, v90
    v_mul_f32 v43, v43, v91
    v_mul_f32 v44, v44, v92
    v_mul_f32 v45, v45, v93
    v_mul_f32 v46, v46, v94
    v_mul_f32 v47, v47, v95
    v_cvt_pk_bf16_f32 v132, v36, v37
    v_cvt_pk_bf16_f32 v133, v38, v39
    v_cvt_pk_bf16_f32 v134, v40, v41
    v_cvt_pk_bf16_f32 v135, v42, v43
    v_cvt_pk_bf16_f32 v136, v44, v45
    v_cvt_pk_bf16_f32 v137, v46, v47
    v_mfma_f32_16x16x16_bf16 v[144:147], v[132:133], v[160:161], 0
    v_mfma_f32_16x16x16_bf16 v[144:147], v[134:135], v[162:163], v[144:147]
    v_mfma_f32_16x16x16_bf16 v[144:147], v[136:137], v[164:165], v[144:147]
    s_waitcnt lgkmcnt(0)
    v_cvt_f32_i32 v48, v48
    v_cvt_f32_i32 v49, v49
    v_cvt_f32_i32 v50, v50
    v_cvt_f32_i32 v51, v51
    v_cvt_f32_i32 v52, v52
    v_cvt_f32_i32 v53, v53
    v_cvt_f32_i32 v54, v54
    v_cvt_f32_i32 v55, v55
    v_cvt_f32_i32 v56, v56
    v_cvt_f32_i32 v57, v57
    v_cvt_f32_i32 v58, v58
    v_cvt_f32_i32 v59, v59
    v_sub_f32 v48, v48, v72
    v_sub_f32 v49, v49, v73
    v_sub_f32 v50, v50, v74
    v_sub_f32 v51, v51, v75
    v_sub_f32 v52, v52, v76
    v_sub_f32 v53, v53, v77
    v_sub_f32 v54, v54, v78
    v_sub_f32 v55, v55, v79
    v_sub_f32 v56, v56, v80
    v_sub_f32 v57, v57, v81
    v_sub_f32 v58, v58, v82
    v_sub_f32 v59, v59, v83
    v_cvt_pk_bf16_f32 v48, 0, v48
    v_cvt_pk_bf16_f32 v49, 0, v49
    v_cvt_pk_bf16_f32 v50, 0, v50
    v_cvt_pk_bf16_f32 v51, 0, v51
    v_cvt_pk_bf16_f32 v52, 0, v52
    v_cvt_pk_bf16_f32 v53, 0, v53
    v_cvt_pk_bf16_f32 v54, 0, v54
    v_cvt_pk_bf16_f32 v55, 0, v55
    v_cvt_pk_bf16_f32 v56, 0, v56
    v_cvt_pk_bf16_f32 v57, 0, v57
    v_cvt_pk_bf16_f32 v58, 0, v58
    v_cvt_pk_bf16_f32 v59, 0, v59
    v_mul_f32 v48, v48, v96
    v_mul_f32 v49, v49, v97
    v_mul_f32 v50, v50, v98
    v_mul_f32 v51, v51, v99
    v_mul_f32 v52, v52, v100
    v_mul_f32 v53, v53, v101
    v_mul_f32 v54, v54, v102
    v_mul_f32 v55, v55, v103
    v_mul_f32 v56, v56, v104
    v_mul_f32 v57, v57, v105
    v_mul_f32 v58, v58, v106
    v_mul_f32 v59, v59, v107
    v_cvt_pk_bf16_f32 v138, v48, v49
    v_cvt_pk_bf16_f32 v139, v50, v51
    v_add_f32_dpp v3, v145, v144 row_ror:12 row_mask:0xf bank_mask:0xf
    v_cvt_pk_bf16_f32 v140, v52, v53
    v_cvt_pk_bf16_f32 v141, v54, v55
    v_add_f32_dpp v3, v146, v3 row_ror:8 row_mask:0xf bank_mask:0xf
    v_cvt_pk_bf16_f32 v142, v56, v57
    v_cvt_pk_bf16_f32 v143, v58, v59
    v_add_f32_dpp v15, v147, v3 row_ror:4 row_mask:0xf bank_mask:0x1
    v_mfma_f32_16x16x16_bf16 v[148:151], v[138:139], v[160:161], 0
    v_mfma_f32_16x16x16_bf16 v[148:151], v[140:141], v[162:163], v[148:151]
    v_mfma_f32_16x16x16_bf16 v[148:151], v[142:143], v[164:165], v[148:151]
    v_add_u32 v33, s63, v27
    v_add_u32 v34, s63, v28
    ds_read_b64 v[108:109], v33 offset:0
    ds_read_b64 v[110:111], v33 offset:1536
    ds_read_b64 v[112:113], v33 offset:128
    ds_read_b64 v[114:115], v33 offset:1664
    ds_read_b64 v[116:117], v33 offset:256
    ds_read_b64 v[118:119], v33 offset:1792
    ds_read_b64 v[120:121], v34 offset:0
    v_add_f32_dpp v4, v149, v148 row_ror:12 row_mask:0xf bank_mask:0xf
    ds_read_b64 v[122:123], v34 offset:1536
    ds_read_b64 v[124:125], v34 offset:128
    v_add_f32_dpp v4, v150, v4 row_ror:8 row_mask:0xf bank_mask:0xf
    ds_read_b64 v[126:127], v34 offset:1664
    ds_read_b64 v[128:129], v34 offset:256
    ds_read_b64 v[130:131], v34 offset:1792
    v_add_f32_dpp v16, v151, v4 row_ror:4 row_mask:0xf bank_mask:0x1
    s_waitcnt lgkmcnt(0)
    v_lshlrev_b32 v60, 16, v108
    v_and_b32 v61, s66, v108
    v_lshlrev_b32 v62, 16, v109
    v_and_b32 v63, s66, v109
    v_lshlrev_b32 v84, 16, v110
    v_and_b32 v85, s66, v110
    v_lshlrev_b32 v86, 16, v111
    v_and_b32 v87, s66, v111
    v_lshlrev_b32 v64, 16, v112
    v_and_b32 v65, s66, v112
    v_lshlrev_b32 v66, 16, v113
    v_and_b32 v67, s66, v113
    v_lshlrev_b32 v88, 16, v114
    v_and_b32 v89, s66, v114
    v_lshlrev_b32 v90, 16, v115
    v_and_b32 v91, s66, v115
    v_lshlrev_b32 v68, 16, v116
    v_and_b32 v69, s66, v116
    v_lshlrev_b32 v70, 16, v117
    v_and_b32 v71, s66, v117
    v_lshlrev_b32 v92, 16, v118
    v_and_b32 v93, s66, v118
    v_lshlrev_b32 v94, 16, v119
    v_and_b32 v95, s66, v119
    v_lshlrev_b32 v72, 16, v120
    v_and_b32 v73, s66, v120
    v_lshlrev_b32 v74, 16, v121
    v_and_b32 v75, s66, v121
    v_lshlrev_b32 v96, 16, v122
    v_and_b32 v97, s66, v122
    v_lshlrev_b32 v98, 16, v123
    v_and_b32 v99, s66, v123
    v_lshlrev_b32 v76, 16, v124
    v_and_b32 v77, s66, v124
    v_lshlrev_b32 v78, 16, v125
    v_and_b32 v79, s66, v125
    v_lshlrev_b32 v100, 16, v126
    v_and_b32 v101, s66, v126
    v_lshlrev_b32 v102, 16, v127
    v_and_b32 v103, s66, v127
    v_lshlrev_b32 v80, 16, v128
    v_and_b32 v81, s66, v128
    v_lshlrev_b32 v82, 16, v129
    v_and_b32 v83, s66, v129
    v_lshlrev_b32 v104, 16, v130
    v_and_b32 v105, s66, v130
    v_lshlrev_b32 v106, 16, v131
    v_and_b32 v107, s66, v131
    v_add_u32 v13, s62, v12
    s_add_u32 s62, s62, 24576
    s_cmp_eq_u32 s62, 73728
    s_cselect_b32 s62, 0, s62
    s_barrier
    ds_read_b128 v[36:39], v13 offset:0
    ds_read_b128 v[40:43], v13 offset:256
    ds_read_b128 v[44:47], v13 offset:512
    ds_read_b128 v[48:51], v13 offset:3072
    ds_read_b128 v[52:55], v13 offset:3328
    ds_read_b128 v[56:59], v13 offset:3584
    s_waitcnt lgkmcnt(3)
    v_cvt_f32_i32 v36, v36
    v_cvt_f32_i32 v37, v37
    v_cvt_f32_i32 v38, v38
    v_cvt_f32_i32 v39, v39
    v_cvt_f32_i32 v40, v40
    v_cvt_f32_i32 v41, v41
    v_cvt_f32_i32 v42, v42
    v_cvt_f32_i32 v43, v43
    v_cvt_f32_i32 v44, v44
    v_cvt_f32_i32 v45, v45
    v_cvt_f32_i32 v46, v46
    v_cvt_f32_i32 v47, v47
    v_sub_f32 v36, v36, v60
    v_sub_f32 v37, v37, v61
    v_sub_f32 v38, v38, v62
    v_sub_f32 v39, v39, v63
    v_sub_f32 v40, v40, v64
    v_sub_f32 v41, v41, v65
    v_sub_f32 v42, v42, v66
    v_sub_f32 v43, v43, v67
    v_sub_f32 v44, v44, v68
    v_sub_f32 v45, v45, v69
    v_sub_f32 v46, v46, v70
    v_sub_f32 v47, v47, v71
    v_cvt_pk_bf16_f32 v36, 0, v36
    v_cvt_pk_bf16_f32 v37, 0, v37
    v_cvt_pk_bf16_f32 v38, 0, v38
    v_cvt_pk_bf16_f32 v39, 0, v39
    v_cvt_pk_bf16_f32 v40, 0, v40
    v_cvt_pk_bf16_f32 v41, 0, v41
    v_cvt_pk_bf16_f32 v42, 0, v42
    v_cvt_pk_bf16_f32 v43, 0, v43
    v_cvt_pk_bf16_f32 v44, 0, v44
    v_cvt_pk_bf16_f32 v45, 0, v45
    v_cvt_pk_bf16_f32 v46, 0, v46
    v_cvt_pk_bf16_f32 v47, 0, v47
    v_mul_f32 v36, v36, v84
    v_mul_f32 v37, v37, v85
    v_mul_f32 v38, v38, v86
    v_mul_f32 v39, v39, v87
    v_mul_f32 v40, v40, v88
    v_mul_f32 v41, v41, v89
    v_mul_f32 v42, v42, v90
    v_mul_f32 v43, v43, v91
    v_mul_f32 v44, v44, v92
    v_mul_f32 v45, v45, v93
    v_mul_f32 v46, v46, v94
    v_mul_f32 v47, v47, v95
    v_cvt_pk_bf16_f32 v132, v36, v37
    v_cvt_pk_bf16_f32 v133, v38, v39
    v_cvt_pk_bf16_f32 v134, v40, v41
    v_cvt_pk_bf16_f32 v135, v42, v43
    v_cvt_pk_bf16_f32 v136, v44, v45
    v_cvt_pk_bf16_f32 v137, v46, v47
    v_mfma_f32_16x16x16_bf16 v[144:147], v[132:133], v[160:161], 0
    v_mfma_f32_16x16x16_bf16 v[144:147], v[134:135], v[162:163], v[144:147]
    v_mfma_f32_16x16x16_bf16 v[144:147], v[136:137], v[164:165], v[144:147]
    s_waitcnt lgkmcnt(0)
    v_cvt_f32_i32 v48, v48
    v_cvt_f32_i32 v49, v49
    v_cvt_f32_i32 v50, v50
    v_cvt_f32_i32 v51, v51
    v_cvt_f32_i32 v52, v52
    v_cvt_f32_i32 v53, v53
    v_cvt_f32_i32 v54, v54
    v_cvt_f32_i32 v55, v55
    v_cvt_f32_i32 v56, v56
    v_cvt_f32_i32 v57, v57
    v_cvt_f32_i32 v58, v58
    v_cvt_f32_i32 v59, v59
    v_sub_f32 v48, v48, v72
    v_sub_f32 v49, v49, v73
    v_sub_f32 v50, v50, v74
    v_sub_f32 v51, v51, v75
    v_sub_f32 v52, v52, v76
    v_sub_f32 v53, v53, v77
    v_sub_f32 v54, v54, v78
    v_sub_f32 v55, v55, v79
    v_sub_f32 v56, v56, v80
    v_sub_f32 v57, v57, v81
    v_sub_f32 v58, v58, v82
    v_sub_f32 v59, v59, v83
    v_cvt_pk_bf16_f32 v48, 0, v48
    v_cvt_pk_bf16_f32 v49, 0, v49
    v_cvt_pk_bf16_f32 v50, 0, v50
    v_cvt_pk_bf16_f32 v51, 0, v51
    v_cvt_pk_bf16_f32 v52, 0, v52
    v_cvt_pk_bf16_f32 v53, 0, v53
    v_cvt_pk_bf16_f32 v54, 0, v54
    v_cvt_pk_bf16_f32 v55, 0, v55
    v_cvt_pk_bf16_f32 v56, 0, v56
    v_cvt_pk_bf16_f32 v57, 0, v57
    v_cvt_pk_bf16_f32 v58, 0, v58
    v_cvt_pk_bf16_f32 v59, 0, v59
    v_mul_f32 v48, v48, v96
    v_mul_f32 v49, v49, v97
    v_mul_f32 v50, v50, v98
    v_mul_f32 v51, v51, v99
    v_mul_f32 v52, v52, v100
    v_mul_f32 v53, v53, v101
    v_mul_f32 v54, v54, v102
    v_mul_f32 v55, v55, v103
    v_mul_f32 v56, v56, v104
    v_mul_f32 v57, v57, v105
    v_mul_f32 v58, v58, v106
    v_mul_f32 v59, v59, v107
    v_cvt_pk_bf16_f32 v138, v48, v49
    v_cvt_pk_bf16_f32 v139, v50, v51
    v_add_f32_dpp v3, v146, v145 row_ror:12 row_mask:0xf bank_mask:0xf
    v_cvt_pk_bf16_f32 v140, v52, v53
    v_cvt_pk_bf16_f32 v141, v54, v55
    v_add_f32_dpp v3, v147, v3 row_ror:8 row_mask:0xf bank_mask:0xf
    v_cvt_pk_bf16_f32 v142, v56, v57
    v_cvt_pk_bf16_f32 v143, v58, v59
    v_add_f32_dpp v15, v144, v3 row_ror:4 row_mask:0xf bank_mask:0x2
    v_mfma_f32_16x16x16_bf16 v[148:151], v[138:139], v[160:161], 0
    v_mfma_f32_16x16x16_bf16 v[148:151], v[140:141], v[162:163], v[148:151]
    v_mfma_f32_16x16x16_bf16 v[148:151], v[142:143], v[164:165], v[148:151]
    v_add_u32 v33, s63, v29
    v_add_u32 v34, s63, v30
    ds_read_b64 v[108:109], v33 offset:0
    ds_read_b64 v[110:111], v33 offset:1536
    ds_read_b64 v[112:113], v33 offset:128
    ds_read_b64 v[114:115], v33 offset:1664
    ds_read_b64 v[116:117], v33 offset:256
    ds_read_b64 v[118:119], v33 offset:1792
    ds_read_b64 v[120:121], v34 offset:0
    v_add_f32_dpp v4, v150, v149 row_ror:12 row_mask:0xf bank_mask:0xf
    ds_read_b64 v[122:123], v34 offset:1536
    ds_read_b64 v[124:125], v34 offset:128
    v_add_f32_dpp v4, v151, v4 row_ror:8 row_mask:0xf bank_mask:0xf
    ds_read_b64 v[126:127], v34 offset:1664
    ds_read_b64 v[128:129], v34 offset:256
    ds_read_b64 v[130:131], v34 offset:1792
    v_add_f32_dpp v16, v148, v4 row_ror:4 row_mask:0xf bank_mask:0x2
    s_waitcnt lgkmcnt(0)
    v_lshlrev_b32 v60, 16, v108
    v_and_b32 v61, s66, v108
    v_lshlrev_b32 v62, 16, v109
    v_and_b32 v63, s66, v109
    v_lshlrev_b32 v84, 16, v110
    v_and_b32 v85, s66, v110
    v_lshlrev_b32 v86, 16, v111
    v_and_b32 v87, s66, v111
    v_lshlrev_b32 v64, 16, v112
    v_and_b32 v65, s66, v112
    v_lshlrev_b32 v66, 16, v113
    v_and_b32 v67, s66, v113
    v_lshlrev_b32 v88, 16, v114
    v_and_b32 v89, s66, v114
    v_lshlrev_b32 v90, 16, v115
    v_and_b32 v91, s66, v115
    v_lshlrev_b32 v68, 16, v116
    v_and_b32 v69, s66, v116
    v_lshlrev_b32 v70, 16, v117
    v_and_b32 v71, s66, v117
    v_lshlrev_b32 v92, 16, v118
    v_and_b32 v93, s66, v118
    v_lshlrev_b32 v94, 16, v119
    v_and_b32 v95, s66, v119
    v_lshlrev_b32 v72, 16, v120
    v_and_b32 v73, s66, v120
    v_lshlrev_b32 v74, 16, v121
    v_and_b32 v75, s66, v121
    v_lshlrev_b32 v96, 16, v122
    v_and_b32 v97, s66, v122
    v_lshlrev_b32 v98, 16, v123
    v_and_b32 v99, s66, v123
    v_lshlrev_b32 v76, 16, v124
    v_and_b32 v77, s66, v124
    v_lshlrev_b32 v78, 16, v125
    v_and_b32 v79, s66, v125
    v_lshlrev_b32 v100, 16, v126
    v_and_b32 v101, s66, v126
    v_lshlrev_b32 v102, 16, v127
    v_and_b32 v103, s66, v127
    v_lshlrev_b32 v80, 16, v128
    v_and_b32 v81, s66, v128
    v_lshlrev_b32 v82, 16, v129
    v_and_b32 v83, s66, v129
    v_lshlrev_b32 v104, 16, v130
    v_and_b32 v105, s66, v130
    v_lshlrev_b32 v106, 16, v131
    v_and_b32 v107, s66, v131
    v_add_u32 v13, s62, v12
    s_add_u32 s62, s62, 24576
    s_cmp_eq_u32 s62, 73728
    s_cselect_b32 s62, 0, s62
    s_barrier
    ds_read_b128 v[36:39], v13 offset:0
    ds_read_b128 v[40:43], v13 offset:256
    ds_read_b128 v[44:47], v13 offset:512
    ds_read_b128 v[48:51], v13 offset:3072
    ds_read_b128 v[52:55], v13 offset:3328
    ds_read_b128 v[56:59], v13 offset:3584
    s_waitcnt lgkmcnt(3)
    v_cvt_f32_i32 v36, v36
    v_cvt_f32_i32 v37, v37
    v_cvt_f32_i32 v38, v38
    v_cvt_f32_i32 v39, v39
    v_cvt_f32_i32 v40, v40
    v_cvt_f32_i32 v41, v41
    v_cvt_f32_i32 v42, v42
    v_cvt_f32_i32 v43, v43
    v_cvt_f32_i32 v44, v44
    v_cvt_f32_i32 v45, v45
    v_cvt_f32_i32 v46, v46
    v_cvt_f32_i32 v47, v47
    v_sub_f32 v36, v36, v60
    v_sub_f32 v37, v37, v61
    v_sub_f32 v38, v38, v62
    v_sub_f32 v39, v39, v63
    v_sub_f32 v40, v40, v64
    v_sub_f32 v41, v41, v65
    v_sub_f32 v42, v42, v66
    v_sub_f32 v43, v43, v67
    v_sub_f32 v44, v44, v68
    v_sub_f32 v45, v45, v69
    v_sub_f32 v46, v46, v70
    v_sub_f32 v47, v47, v71
    v_cvt_pk_bf16_f32 v36, 0, v36
    v_cvt_pk_bf16_f32 v37, 0, v37
    v_cvt_pk_bf16_f32 v38, 0, v38
    v_cvt_pk_bf16_f32 v39, 0, v39
    v_cvt_pk_bf16_f32 v40, 0, v40
    v_cvt_pk_bf16_f32 v41, 0, v41
    v_cvt_pk_bf16_f32 v42, 0, v42
    v_cvt_pk_bf16_f32 v43, 0, v43
    v_cvt_pk_bf16_f32 v44, 0, v44
    v_cvt_pk_bf16_f32 v45, 0, v45
    v_cvt_pk_bf16_f32 v46, 0, v46
    v_cvt_pk_bf16_f32 v47, 0, v47
    v_mul_f32 v36, v36, v84
    v_mul_f32 v37, v37, v85
    v_mul_f32 v38, v38, v86
    v_mul_f32 v39, v39, v87
    v_mul_f32 v40, v40, v88
    v_mul_f32 v41, v41, v89
    v_mul_f32 v42, v42, v90
    v_mul_f32 v43, v43, v91
    v_mul_f32 v44, v44, v92
    v_mul_f32 v45, v45, v93
    v_mul_f32 v46, v46, v94
    v_mul_f32 v47, v47, v95
    v_cvt_pk_bf16_f32 v132, v36, v37
    v_cvt_pk_bf16_f32 v133, v38, v39
    v_cvt_pk_bf16_f32 v134, v40, v41
    v_cvt_pk_bf16_f32 v135, v42, v43
    v_cvt_pk_bf16_f32 v136, v44, v45
    v_cvt_pk_bf16_f32 v137, v46, v47
    v_mfma_f32_16x16x16_bf16 v[144:147], v[132:133], v[160:161], 0
    v_mfma_f32_16x16x16_bf16 v[144:147], v[134:135], v[162:163], v[144:147]
    v_mfma_f32_16x16x16_bf16 v[144:147], v[136:137], v[164:165], v[144:147]
    s_waitcnt lgkmcnt(0)
    v_cvt_f32_i32 v48, v48
    v_cvt_f32_i32 v49, v49
    v_cvt_f32_i32 v50, v50
    v_cvt_f32_i32 v51, v51
    v_cvt_f32_i32 v52, v52
    v_cvt_f32_i32 v53, v53
    v_cvt_f32_i32 v54, v54
    v_cvt_f32_i32 v55, v55
    v_cvt_f32_i32 v56, v56
    v_cvt_f32_i32 v57, v57
    v_cvt_f32_i32 v58, v58
    v_cvt_f32_i32 v59, v59
    v_sub_f32 v48, v48, v72
    v_sub_f32 v49, v49, v73
    v_sub_f32 v50, v50, v74
    v_sub_f32 v51, v51, v75
    v_sub_f32 v52, v52, v76
    v_sub_f32 v53, v53, v77
    v_sub_f32 v54, v54, v78
    v_sub_f32 v55, v55, v79
    v_sub_f32 v56, v56, v80
    v_sub_f32 v57, v57, v81
    v_sub_f32 v58, v58, v82
    v_sub_f32 v59, v59, v83
    v_cvt_pk_bf16_f32 v48, 0, v48
    v_cvt_pk_bf16_f32 v49, 0, v49
    v_cvt_pk_bf16_f32 v50, 0, v50
    v_cvt_pk_bf16_f32 v51, 0, v51
    v_cvt_pk_bf16_f32 v52, 0, v52
    v_cvt_pk_bf16_f32 v53, 0, v53
    v_cvt_pk_bf16_f32 v54, 0, v54
    v_cvt_pk_bf16_f32 v55, 0, v55
    v_cvt_pk_bf16_f32 v56, 0, v56
    v_cvt_pk_bf16_f32 v57, 0, v57
    v_cvt_pk_bf16_f32 v58, 0, v58
    v_cvt_pk_bf16_f32 v59, 0, v59
    v_mul_f32 v48, v48, v96
    v_mul_f32 v49, v49, v97
    v_mul_f32 v50, v50, v98
    v_mul_f32 v51, v51, v99
    v_mul_f32 v52, v52, v100
    v_mul_f32 v53, v53, v101
    v_mul_f32 v54, v54, v102
    v_mul_f32 v55, v55, v103
    v_mul_f32 v56, v56, v104
    v_mul_f32 v57, v57, v105
    v_mul_f32 v58, v58, v106
    v_mul_f32 v59, v59, v107
    v_cvt_pk_bf16_f32 v138, v48, v49
    v_cvt_pk_bf16_f32 v139, v50, v51
    v_add_f32_dpp v3, v147, v146 row_ror:12 row_mask:0xf bank_mask:0xf
    v_cvt_pk_bf16_f32 v140, v52, v53
    v_cvt_pk_bf16_f32 v141, v54, v55
    v_add_f32_dpp v3, v144, v3 row_ror:8 row_mask:0xf bank_mask:0xf
    v_cvt_pk_bf16_f32 v142, v56, v57
    v_cvt_pk_bf16_f32 v143, v58, v59
    v_add_f32_dpp v15, v145, v3 row_ror:4 row_mask:0xf bank_mask:0x4
    v_mfma_f32_16x16x16_bf16 v[148:151], v[138:139], v[160:161], 0
    v_mfma_f32_16x16x16_bf16 v[148:151], v[140:141], v[162:163], v[148:151]
    v_mfma_f32_16x16x16_bf16 v[148:151], v[142:143], v[164:165], v[148:151]
    v_add_u32 v33, s63, v31
    v_add_u32 v34, s63, v32
    ds_read_b64 v[108:109], v33 offset:0
    ds_read_b64 v[110:111], v33 offset:1536
    ds_read_b64 v[112:113], v33 offset:128
    ds_read_b64 v[114:115], v33 offset:1664
    ds_read_b64 v[116:117], v33 offset:256
    ds_read_b64 v[118:119], v33 offset:1792
    ds_read_b64 v[120:121], v34 offset:0
    v_add_f32_dpp v4, v151, v150 row_ror:12 row_mask:0xf bank_mask:0xf
    ds_read_b64 v[122:123], v34 offset:1536
    ds_read_b64 v[124:125], v34 offset:128
    v_add_f32_dpp v4, v148, v4 row_ror:8 row_mask:0xf bank_mask:0xf
    ds_read_b64 v[126:127], v34 offset:1664
    ds_read_b64 v[128:129], v34 offset:256
    ds_read_b64 v[130:131], v34 offset:1792
    v_add_f32_dpp v16, v149, v4 row_ror:4 row_mask:0xf bank_mask:0x4
    s_waitcnt lgkmcnt(0)
    v_lshlrev_b32 v60, 16, v108
    v_and_b32 v61, s66, v108
    v_lshlrev_b32 v62, 16, v109
    v_and_b32 v63, s66, v109
    v_lshlrev_b32 v84, 16, v110
    v_and_b32 v85, s66, v110
    v_lshlrev_b32 v86, 16, v111
    v_and_b32 v87, s66, v111
    v_lshlrev_b32 v64, 16, v112
    v_and_b32 v65, s66, v112
    v_lshlrev_b32 v66, 16, v113
    v_and_b32 v67, s66, v113
    v_lshlrev_b32 v88, 16, v114
    v_and_b32 v89, s66, v114
    v_lshlrev_b32 v90, 16, v115
    v_and_b32 v91, s66, v115
    v_lshlrev_b32 v68, 16, v116
    v_and_b32 v69, s66, v116
    v_lshlrev_b32 v70, 16, v117
    v_and_b32 v71, s66, v117
    v_lshlrev_b32 v92, 16, v118
    v_and_b32 v93, s66, v118
    v_lshlrev_b32 v94, 16, v119
    v_and_b32 v95, s66, v119
    v_lshlrev_b32 v72, 16, v120
    v_and_b32 v73, s66, v120
    v_lshlrev_b32 v74, 16, v121
    v_and_b32 v75, s66, v121
    v_lshlrev_b32 v96, 16, v122
    v_and_b32 v97, s66, v122
    v_lshlrev_b32 v98, 16, v123
    v_and_b32 v99, s66, v123
    v_lshlrev_b32 v76, 16, v124
    v_and_b32 v77, s66, v124
    v_lshlrev_b32 v78, 16, v125
    v_and_b32 v79, s66, v125
    v_lshlrev_b32 v100, 16, v126
    v_and_b32 v101, s66, v126
    v_lshlrev_b32 v102, 16, v127
    v_and_b32 v103, s66, v127
    v_lshlrev_b32 v80, 16, v128
    v_and_b32 v81, s66, v128
    v_lshlrev_b32 v82, 16, v129
    v_and_b32 v83, s66, v129
    v_lshlrev_b32 v104, 16, v130
    v_and_b32 v105, s66, v130
    v_lshlrev_b32 v106, 16, v131
    v_and_b32 v107, s66, v131
    v_add_u32 v13, s62, v12
    s_add_u32 s62, s62, 24576
    s_cmp_eq_u32 s62, 73728
    s_cselect_b32 s62, 0, s62
    s_barrier
    ds_read_b128 v[36:39], v13 offset:0
    ds_read_b128 v[40:43], v13 offset:256
    ds_read_b128 v[44:47], v13 offset:512
    ds_read_b128 v[48:51], v13 offset:3072
    ds_read_b128 v[52:55], v13 offset:3328
    ds_read_b128 v[56:59], v13 offset:3584
    s_waitcnt lgkmcnt(3)
    v_cvt_f32_i32 v36, v36
    v_cvt_f32_i32 v37, v37
    v_cvt_f32_i32 v38, v38
    v_cvt_f32_i32 v39, v39
    v_cvt_f32_i32 v40, v40
    v_cvt_f32_i32 v41, v41
    v_cvt_f32_i32 v42, v42
    v_cvt_f32_i32 v43, v43
    v_cvt_f32_i32 v44, v44
    v_cvt_f32_i32 v45, v45
    v_cvt_f32_i32 v46, v46
    v_cvt_f32_i32 v47, v47
    v_sub_f32 v36, v36, v60
    v_sub_f32 v37, v37, v61
    v_sub_f32 v38, v38, v62
    v_sub_f32 v39, v39, v63
    v_sub_f32 v40, v40, v64
    v_sub_f32 v41, v41, v65
    v_sub_f32 v42, v42, v66
    v_sub_f32 v43, v43, v67
    v_sub_f32 v44, v44, v68
    v_sub_f32 v45, v45, v69
    v_sub_f32 v46, v46, v70
    v_sub_f32 v47, v47, v71
    v_cvt_pk_bf16_f32 v36, 0, v36
    v_cvt_pk_bf16_f32 v37, 0, v37
    v_cvt_pk_bf16_f32 v38, 0, v38
    v_cvt_pk_bf16_f32 v39, 0, v39
    v_cvt_pk_bf16_f32 v40, 0, v40
    v_cvt_pk_bf16_f32 v41, 0, v41
    v_cvt_pk_bf16_f32 v42, 0, v42
    v_cvt_pk_bf16_f32 v43, 0, v43
    v_cvt_pk_bf16_f32 v44, 0, v44
    v_cvt_pk_bf16_f32 v45, 0, v45
    v_cvt_pk_bf16_f32 v46, 0, v46
    v_cvt_pk_bf16_f32 v47, 0, v47
    v_mul_f32 v36, v36, v84
    v_mul_f32 v37, v37, v85
    v_mul_f32 v38, v38, v86
    v_mul_f32 v39, v39, v87
    v_mul_f32 v40, v40, v88
    v_mul_f32 v41, v41, v89
    v_mul_f32 v42, v42, v90
    v_mul_f32 v43, v43, v91
    v_mul_f32 v44, v44, v92
    v_mul_f32 v45, v45, v93
    v_mul_f32 v46, v46, v94
    v_mul_f32 v47, v47, v95
    v_cvt_pk_bf16_f32 v132, v36, v37
    v_cvt_pk_bf16_f32 v133, v38, v39
    v_cvt_pk_bf16_f32 v134, v40, v41
    v_cvt_pk_bf16_f32 v135, v42, v43
    v_cvt_pk_bf16_f32 v136, v44, v45
    v_cvt_pk_bf16_f32 v137, v46, v47
    v_mfma_f32_16x16x16_bf16 v[144:147], v[132:133], v[160:161], 0
    v_mfma_f32_16x16x16_bf16 v[144:147], v[134:135], v[162:163], v[144:147]
    v_mfma_f32_16x16x16_bf16 v[144:147], v[136:137], v[164:165], v[144:147]
    s_waitcnt lgkmcnt(0)
    v_cvt_f32_i32 v48, v48
    v_cvt_f32_i32 v49, v49
    v_cvt_f32_i32 v50, v50
    v_cvt_f32_i32 v51, v51
    v_cvt_f32_i32 v52, v52
    v_cvt_f32_i32 v53, v53
    v_cvt_f32_i32 v54, v54
    v_cvt_f32_i32 v55, v55
    v_cvt_f32_i32 v56, v56
    v_cvt_f32_i32 v57, v57
    v_cvt_f32_i32 v58, v58
    v_cvt_f32_i32 v59, v59
    v_sub_f32 v48, v48, v72
    v_sub_f32 v49, v49, v73
    v_sub_f32 v50, v50, v74
    v_sub_f32 v51, v51, v75
    v_sub_f32 v52, v52, v76
    v_sub_f32 v53, v53, v77
    v_sub_f32 v54, v54, v78
    v_sub_f32 v55, v55, v79
    v_sub_f32 v56, v56, v80
    v_sub_f32 v57, v57, v81
    v_sub_f32 v58, v58, v82
    v_sub_f32 v59, v59, v83
    v_cvt_pk_bf16_f32 v48, 0, v48
    v_cvt_pk_bf16_f32 v49, 0, v49
    v_cvt_pk_bf16_f32 v50, 0, v50
    v_cvt_pk_bf16_f32 v51, 0, v51
    v_cvt_pk_bf16_f32 v52, 0, v52
    v_cvt_pk_bf16_f32 v53, 0, v53
    v_cvt_pk_bf16_f32 v54, 0, v54
    v_cvt_pk_bf16_f32 v55, 0, v55
    v_cvt_pk_bf16_f32 v56, 0, v56
    v_cvt_pk_bf16_f32 v57, 0, v57
    v_cvt_pk_bf16_f32 v58, 0, v58
    v_cvt_pk_bf16_f32 v59, 0, v59
    v_mul_f32 v48, v48, v96
    v_mul_f32 v49, v49, v97
    v_mul_f32 v50, v50, v98
    v_mul_f32 v51, v51, v99
    v_mul_f32 v52, v52, v100
    v_mul_f32 v53, v53, v101
    v_mul_f32 v54, v54, v102
    v_mul_f32 v55, v55, v103
    v_mul_f32 v56, v56, v104
    v_mul_f32 v57, v57, v105
    v_mul_f32 v58, v58, v106
    v_mul_f32 v59, v59, v107
    v_cvt_pk_bf16_f32 v138, v48, v49
    v_cvt_pk_bf16_f32 v139, v50, v51
    v_add_f32_dpp v3, v144, v147 row_ror:12 row_mask:0xf bank_mask:0xf
    v_cvt_pk_bf16_f32 v140, v52, v53
    v_cvt_pk_bf16_f32 v141, v54, v55
    v_add_f32_dpp v3, v145, v3 row_ror:8 row_mask:0xf bank_mask:0xf
    v_cvt_pk_bf16_f32 v142, v56, v57
    v_cvt_pk_bf16_f32 v143, v58, v59
    v_add_f32_dpp v15, v146, v3 row_ror:4 row_mask:0xf bank_mask:0x8
    v_mfma_f32_16x16x16_bf16 v[148:151], v[138:139], v[160:161], 0
    v_mfma_f32_16x16x16_bf16 v[148:151], v[140:141], v[162:163], v[148:151]
    v_mfma_f32_16x16x16_bf16 v[148:151], v[142:143], v[164:165], v[148:151]
    s_add_u32 s63, s63, 3072
    v_add_u32 v33, s63, v17
    v_add_u32 v34, s63, v18
    ds_read_b64 v[108:109], v33 offset:0
    ds_read_b64 v[110:111], v33 offset:1536
    ds_read_b64 v[112:113], v33 offset:128
    ds_read_b64 v[114:115], v33 offset:1664
    ds_read_b64 v[116:117], v33 offset:256
    ds_read_b64 v[118:119], v33 offset:1792
    ds_read_b64 v[120:121], v34 offset:0
    v_add_f32_dpp v4, v148, v151 row_ror:12 row_mask:0xf bank_mask:0xf
    ds_read_b64 v[122:123], v34 offset:1536
    ds_read_b64 v[124:125], v34 offset:128
    v_add_f32_dpp v4, v149, v4 row_ror:8 row_mask:0xf bank_mask:0xf
    ds_read_b64 v[126:127], v34 offset:1664
    ds_read_b64 v[128:129], v34 offset:256
    ds_read_b64 v[130:131], v34 offset:1792
    v_add_f32_dpp v16, v150, v4 row_ror:4 row_mask:0xf bank_mask:0x8
    v_cvt_pk_bf16_f32 v3, 0, v15
    v_cvt_pk_bf16_f32 v4, 0, v16
    v_mul_f32 v3, s65, v3
    v_mul_f32 v4, s65, v4
    v_cvt_pk_bf16_f32 v5, v3, v4
    v_max3_f32 v14, v14, v3, v4
    ds_write_b32 v11, v5 offset:256
    s_waitcnt lgkmcnt(0)
    v_lshlrev_b32 v60, 16, v108
    v_and_b32 v61, s66, v108
    v_lshlrev_b32 v62, 16, v109
    v_and_b32 v63, s66, v109
    v_lshlrev_b32 v84, 16, v110
    v_and_b32 v85, s66, v110
    v_lshlrev_b32 v86, 16, v111
    v_and_b32 v87, s66, v111
    v_lshlrev_b32 v64, 16, v112
    v_and_b32 v65, s66, v112
    v_lshlrev_b32 v66, 16, v113
    v_and_b32 v67, s66, v113
    v_lshlrev_b32 v88, 16, v114
    v_and_b32 v89, s66, v114
    v_lshlrev_b32 v90, 16, v115
    v_and_b32 v91, s66, v115
    v_lshlrev_b32 v68, 16, v116
    v_and_b32 v69, s66, v116
    v_lshlrev_b32 v70, 16, v117
    v_and_b32 v71, s66, v117
    v_lshlrev_b32 v92, 16, v118
    v_and_b32 v93, s66, v118
    v_lshlrev_b32 v94, 16, v119
    v_and_b32 v95, s66, v119
    v_lshlrev_b32 v72, 16, v120
    v_and_b32 v73, s66, v120
    v_lshlrev_b32 v74, 16, v121
    v_and_b32 v75, s66, v121
    v_lshlrev_b32 v96, 16, v122
    v_and_b32 v97, s66, v122
    v_lshlrev_b32 v98, 16, v123
    v_and_b32 v99, s66, v123
    v_lshlrev_b32 v76, 16, v124
    v_and_b32 v77, s66, v124
    v_lshlrev_b32 v78, 16, v125
    v_and_b32 v79, s66, v125
    v_lshlrev_b32 v100, 16, v126
    v_and_b32 v101, s66, v126
    v_lshlrev_b32 v102, 16, v127
    v_and_b32 v103, s66, v127
    v_lshlrev_b32 v80, 16, v128
    v_and_b32 v81, s66, v128
    v_lshlrev_b32 v82, 16, v129
    v_and_b32 v83, s66, v129
    v_lshlrev_b32 v104, 16, v130
    v_and_b32 v105, s66, v130
    v_lshlrev_b32 v106, 16, v131
    v_and_b32 v107, s66, v131
    v_add_u32 v11, 3072, v11
    s_add_u32 s61, s61, 1
    s_cmp_eq_u32 s61, s3
    s_cbranch_scc1 L_kblk_end
    s_cmp_eq_u32 s61, s73
    s_cbranch_scc1 L_kblk_end
    s_cmp_lt_u32 s61, 16
    s_cbranch_scc1 L_kblk
L_kblk_end:
    s_nop 1
    v_max_f32_dpp v14, v14, v14 row_ror:4 row_mask:0xf bank_mask:0xf
    s_nop 1
    v_max_f32_dpp v14, v14, v14 row_ror:8 row_mask:0xf bank_mask:0xf
    v_mov_b32 v3, v14
    s_nop 1
    v_permlane16_swap_b32 v14, v3
    v_max_f32 v14, v14, v3
    v_mov_b32 v3, v14
    s_nop 1
    v_permlane32_swap_b32 v14, v3
    v_max_f32 v14, v14, v3
    v_cvt_pk_bf16_f32 v14, 0, v14
    v_mul_f32 v14, s64, v14
    ds_write_b32 v153, v14
    v_add_u32 v153, 64, v153
    v_mov_b32 v160, v166
    v_mov_b32 v161, v167
    v_mov_b32 v162, v168
    v_mov_b32 v163, v169
    v_mov_b32 v164, v170
    v_mov_b32 v165, v171
    v_mov_b32 v166, v172
    v_mov_b32 v167, v173
    v_mov_b32 v168, v174
    v_mov_b32 v169, v175
    v_mov_b32 v170, v176
    v_mov_b32 v171, v177
    v_mov_b32 v14, 0xff800000
    s_waitcnt lgkmcnt(0)
    s_cmp_lt_u32 s61, 16
    s_cbranch_scc1 L_kblk
    v_lshrrev_b32 v3, 4, v1
    v_and_b32 v4, 15, v1
    v_lshl_add_u32 v3, v2, 3, v3
    v_mul_u32_u24 v3, 768, v3
    v_lshl_add_u32 v12, v4, 4, v3
    v_subrev_u32 v11, 49152, v11
    s_mov_b32 s63, 0
    v_add_u32 v211, s63, v7
    v_add_u32 v212, s63, v8
    ds_read_b32 v210, v11 offset:0
    ds_read_u16 v213, v211 offset:512
    ds_read_u16 v214, v212 offset:512
    ds_read_u16 v211, v211
    ds_read_u16 v212, v212
    v_mov_b32 v184, 0
    v_mov_b32 v185, 0
    v_mov_b32 v186, 0
    v_mov_b32 v187, 0
    v_mov_b32 v188, 0
    v_mov_b32 v189, 0
    v_mov_b32 v190, 0
    v_mov_b32 v191, 0
    v_mov_b32 v192, 0
    v_mov_b32 v193, 0
    v_mov_b32 v194, 0
    v_mov_b32 v195, 0
    v_mov_b32 v196, 0
    v_mov_b32 v197, 0
    v_mov_b32 v198, 0
    v_mov_b32 v199, 0
    s_mov_b32 s61, 0
    v_and_b32 v3, 3, v1
    v_lshlrev_b32 v20, 4, v3
    v_add_u32 v153, 154944, v20
    v_add_u32 v18, 142336, v20
    v_lshl_add_u32 v155, v2, 6, v18
    v_lshl_add_u32 v20, v2, 6, v20
    v_add_u32 v20, 3072, v20
    v_mul_u32_u24 v154, 3072, v2
    v_lshl_add_u32 v154, v1, 4, v154
    v_add_u32 v154, 142592, v154
    v_lshlrev_b32 v4, 10, v2
    v_lshl_add_u32 v19, v1, 4, v4
    v_lshl_add_u32 v17, v1, 2, v4
    v_add_u32 v17, 142592, v17
    v_mul_u32_u24 v21, 384, v3
    v_lshrrev_b32 v4, 2, v1
    v_lshl_add_u32 v21, v4, 3, v21
    v_lshl_add_u32 v21, v2, 7, v21
    s_mov_b32 s48, s18
    s_and_b32 s49, s19, 0xffff
    s_mov_b32 s50, 393216
    s_mov_b32 s51, 0x20000
    s_mov_b32 s24, s22
    s_and_b32 s25, s23, 0xffff
    s_mov_b32 s26, 848640
    s_mov_b32 s27, 0x20000
    s_mul_i32 s68, s100, 9984
    s_mul_i32 s71, s2, 3328
    s_add_u32 s69, s68, 3328
    s_add_u32 s70, s68, 6656
    s_add_u32 s57, s100, 171
    s_cmp_eq_u32 s2, 255
    s_cselect_b32 s57, 170, s57
    s_mul_i32 s57, s57, 1536
    s_mov_b32 s84, 0x7060500
    s_mov_b32 s85, 0x7060501
    s_mov_b32 s86, 0x7060502
    s_mov_b32 s87, 0x7060503
    s_mov_b32 s88, 0x0c0c0400
    s_mov_b32 s89, 0x04000c0c
    s_mov_b32 s90, 0xffffff00
L_vround:
    v_mov_b32 v160, 0
    v_mov_b32 v161, 0
    v_mov_b32 v162, 0
    v_mov_b32 v163, 0
    v_mov_b32 v164, 0
    v_mov_b32 v165, 0
    v_mov_b32 v166, 0
    v_mov_b32 v167, 0
    v_mov_b32 v168, 0
    v_mov_b32 v169, 0
    v_mov_b32 v170, 0
    v_mov_b32 v171, 0
    v_mov_b32 v208, 0
    v_mov_b32 v209, 0
L_vblk:
    s_add_u32 s61, s61, 1
    s_cmp_eq_u32 s61, s3
    s_cselect_b32 s74, 1, 0
    s_cmp_eq_u32 s61, s73
    s_cselect_b32 s74, 1, s74
    s_cmp_eq_u32 s61, 16
    s_cselect_b32 s74, 1, s74
    v_add_u32 v13, s62, v12
    s_add_u32 s62, s62, 24576
    s_cmp_eq_u32 s62, 73728
    s_cselect_b32 s62, 0, s62
    s_barrier
    ds_read_b128 v[156:159], v153
    ds_read_b128 v[36:39], v13 offset:0
    ds_read_b128 v[48:51], v13 offset:3072
    ds_read_b128 v[40:43], v13 offset:256
    ds_read_b128 v[52:55], v13 offset:3328
    ds_read_b128 v[44:47], v13 offset:512
    ds_read_b128 v[56:59], v13 offset:3584
    s_waitcnt lgkmcnt(6)
    v_max_f32 v14, v156, v157
    v_max3_f32 v14, v14, v158, v159
    s_waitcnt lgkmcnt(6)
    v_lshlrev_b32 v215, 16, v210
    v_and_b32 v216, s66, v210
    v_fma_f32 v215, v215, s64, -v14
    v_fma_f32 v216, v216, s64, -v14
    v_exp_f32 v215, v215
    v_exp_f32 v216, v216
    v_lshlrev_b32 v217, 16, v211
    v_lshlrev_b32 v218, 16, v212
    v_mul_f32 v217, v215, v217
    v_mul_f32 v218, v216, v218
    v_add_f32 v208, v208, v215
    v_cvt_pk_bf16_f32 v217, v217, v218
    v_add_f32 v208, v208, v216
    v_lshlrev_b32 v219, 16, v213
    v_lshlrev_b32 v220, 16, v214
    v_lshlrev_b32 v215, 16, v217
    v_and_b32 v216, s66, v217
    v_fmac_f32 v209, v215, v219
    v_fmac_f32 v209, v216, v220
    v_mov_b32_dpp v184, v217 quad_perm:[0,1,2,3] row_mask:0xf bank_mask:0x1
    v_mov_b32_dpp v185, v217 row_ror:12 row_mask:0xf bank_mask:0x1
    v_mov_b32_dpp v186, v217 row_ror:8 row_mask:0xf bank_mask:0x1
    v_mov_b32_dpp v187, v217 row_ror:4 row_mask:0xf bank_mask:0x1
    v_mov_b32_dpp v188, v217 row_ror:4 row_mask:0xf bank_mask:0x2
    v_mov_b32_dpp v189, v217 quad_perm:[0,1,2,3] row_mask:0xf bank_mask:0x2
    v_mov_b32_dpp v190, v217 row_ror:12 row_mask:0xf bank_mask:0x2
    v_mov_b32_dpp v191, v217 row_ror:8 row_mask:0xf bank_mask:0x2
    v_mov_b32_dpp v192, v217 row_ror:8 row_mask:0xf bank_mask:0x4
    v_mov_b32_dpp v193, v217 row_ror:4 row_mask:0xf bank_mask:0x4
    v_mov_b32_dpp v194, v217 quad_perm:[0,1,2,3] row_mask:0xf bank_mask:0x4
    v_mov_b32_dpp v195, v217 row_ror:12 row_mask:0xf bank_mask:0x4
    v_mov_b32_dpp v196, v217 row_ror:12 row_mask:0xf bank_mask:0x8
    v_mov_b32_dpp v197, v217 row_ror:8 row_mask:0xf bank_mask:0x8
    v_mov_b32_dpp v198, v217 row_ror:4 row_mask:0xf bank_mask:0x8
    v_mov_b32_dpp v199, v217 quad_perm:[0,1,2,3] row_mask:0xf bank_mask:0x8
    s_waitcnt lgkmcnt(4)
    v_cvt_f32_i32 v36, v36
    v_cvt_f32_i32 v37, v37
    v_cvt_f32_i32 v38, v38
    v_cvt_f32_i32 v39, v39
    v_cvt_f32_i32 v48, v48
    v_cvt_f32_i32 v49, v49
    v_cvt_f32_i32 v50, v50
    v_cvt_f32_i32 v51, v51
    v_cvt_pk_bf16_f32 v60, v36, v48
    v_cvt_pk_bf16_f32 v64, v37, v49
    v_cvt_pk_bf16_f32 v68, v38, v50
    v_cvt_pk_bf16_f32 v72, v39, v51
    s_waitcnt lgkmcnt(2)
    v_cvt_f32_i32 v40, v40
    v_cvt_f32_i32 v41, v41
    v_cvt_f32_i32 v42, v42
    v_cvt_f32_i32 v43, v43
    v_cvt_f32_i32 v52, v52
    v_cvt_f32_i32 v53, v53
    v_cvt_f32_i32 v54, v54
    v_cvt_f32_i32 v55, v55
    v_cvt_pk_bf16_f32 v76, v40, v52
    v_cvt_pk_bf16_f32 v80, v41, v53
    v_cvt_pk_bf16_f32 v84, v42, v54
    v_cvt_pk_bf16_f32 v88, v43, v55
    s_waitcnt lgkmcnt(0)
    v_cvt_f32_i32 v44, v44
    v_cvt_f32_i32 v45, v45
    v_cvt_f32_i32 v46, v46
    v_cvt_f32_i32 v47, v47
    v_cvt_f32_i32 v56, v56
    v_cvt_f32_i32 v57, v57
    v_cvt_f32_i32 v58, v58
    v_cvt_f32_i32 v59, v59
    v_cvt_pk_bf16_f32 v92, v44, v56
    v_cvt_pk_bf16_f32 v96, v45, v57
    v_cvt_pk_bf16_f32 v100, v46, v58
    v_cvt_pk_bf16_f32 v104, v47, v59
    v_add_u32 v211, s63, v9
    v_add_u32 v212, s63, v10
    ds_read_b32 v210, v11 offset:256
    ds_read_u16 v213, v211 offset:512
    ds_read_u16 v214, v212 offset:512
    ds_read_u16 v211, v211
    ds_read_u16 v212, v212
    v_add_u32 v13, s62, v12
    s_add_u32 s62, s62, 24576
    s_cmp_eq_u32 s62, 73728
    s_cselect_b32 s62, 0, s62
    s_barrier
    ds_read_b128 v[36:39], v13 offset:0
    ds_read_b128 v[48:51], v13 offset:3072
    ds_read_b128 v[40:43], v13 offset:256
    ds_read_b128 v[52:55], v13 offset:3328
    ds_read_b128 v[44:47], v13 offset:512
    ds_read_b128 v[56:59], v13 offset:3584
    s_waitcnt lgkmcnt(4)
    v_cvt_f32_i32 v36, v36
    v_cvt_f32_i32 v37, v37
    v_cvt_f32_i32 v38, v38
    v_cvt_f32_i32 v39, v39
    v_cvt_f32_i32 v48, v48
    v_cvt_f32_i32 v49, v49
    v_cvt_f32_i32 v50, v50
    v_cvt_f32_i32 v51, v51
    v_cvt_pk_bf16_f32 v61, v36, v48
    v_cvt_pk_bf16_f32 v65, v37, v49
    v_cvt_pk_bf16_f32 v69, v38, v50
    v_cvt_pk_bf16_f32 v73, v39, v51
    s_waitcnt lgkmcnt(2)
    v_cvt_f32_i32 v40, v40
    v_cvt_f32_i32 v41, v41
    v_cvt_f32_i32 v42, v42
    v_cvt_f32_i32 v43, v43
    v_cvt_f32_i32 v52, v52
    v_cvt_f32_i32 v53, v53
    v_cvt_f32_i32 v54, v54
    v_cvt_f32_i32 v55, v55
    v_cvt_pk_bf16_f32 v77, v40, v52
    v_cvt_pk_bf16_f32 v81, v41, v53
    v_cvt_pk_bf16_f32 v85, v42, v54
    v_cvt_pk_bf16_f32 v89, v43, v55
    s_waitcnt lgkmcnt(0)
    v_cvt_f32_i32 v44, v44
    v_cvt_f32_i32 v45, v45
    v_cvt_f32_i32 v46, v46
    v_cvt_f32_i32 v47, v47
    v_cvt_f32_i32 v56, v56
    v_cvt_f32_i32 v57, v57
    v_cvt_f32_i32 v58, v58
    v_cvt_f32_i32 v59, v59
    v_cvt_pk_bf16_f32 v93, v44, v56
    v_cvt_pk_bf16_f32 v97, v45, v57
    v_cvt_pk_bf16_f32 v101, v46, v58
    v_cvt_pk_bf16_f32 v105, v47, v59
    v_add_u32 v13, s62, v12
    s_add_u32 s62, s62, 24576
    s_cmp_eq_u32 s62, 73728
    s_cselect_b32 s62, 0, s62
    s_barrier
    ds_read_b128 v[36:39], v13 offset:0
    ds_read_b128 v[48:51], v13 offset:3072
    ds_read_b128 v[40:43], v13 offset:256
    ds_read_b128 v[52:55], v13 offset:3328
    ds_read_b128 v[44:47], v13 offset:512
    ds_read_b128 v[56:59], v13 offset:3584
    s_waitcnt lgkmcnt(4)
    v_cvt_f32_i32 v36, v36
    v_cvt_f32_i32 v37, v37
    v_cvt_f32_i32 v38, v38
    v_cvt_f32_i32 v39, v39
    v_cvt_f32_i32 v48, v48
    v_cvt_f32_i32 v49, v49
    v_cvt_f32_i32 v50, v50
    v_cvt_f32_i32 v51, v51
    v_cvt_pk_bf16_f32 v62, v36, v48
    v_cvt_pk_bf16_f32 v66, v37, v49
    v_cvt_pk_bf16_f32 v70, v38, v50
    v_cvt_pk_bf16_f32 v74, v39, v51
    s_waitcnt lgkmcnt(2)
    v_cvt_f32_i32 v40, v40
    v_cvt_f32_i32 v41, v41
    v_cvt_f32_i32 v42, v42
    v_cvt_f32_i32 v43, v43
    v_cvt_f32_i32 v52, v52
    v_cvt_f32_i32 v53, v53
    v_cvt_f32_i32 v54, v54
    v_cvt_f32_i32 v55, v55
    v_cvt_pk_bf16_f32 v78, v40, v52
    v_cvt_pk_bf16_f32 v82, v41, v53
    v_cvt_pk_bf16_f32 v86, v42, v54
    v_cvt_pk_bf16_f32 v90, v43, v55
    s_waitcnt lgkmcnt(0)
    v_cvt_f32_i32 v44, v44
    v_cvt_f32_i32 v45, v45
    v_cvt_f32_i32 v46, v46
    v_cvt_f32_i32 v47, v47
    v_cvt_f32_i32 v56, v56
    v_cvt_f32_i32 v57, v57
    v_cvt_f32_i32 v58, v58
    v_cvt_f32_i32 v59, v59
    v_cvt_pk_bf16_f32 v94, v44, v56
    v_cvt_pk_bf16_f32 v98, v45, v57
    v_cvt_pk_bf16_f32 v102, v46, v58
    v_cvt_pk_bf16_f32 v106, v47, v59
    v_add_u32 v13, s62, v12
    s_add_u32 s62, s62, 24576
    s_cmp_eq_u32 s62, 73728
    s_cselect_b32 s62, 0, s62
    s_barrier
    ds_read_b128 v[36:39], v13 offset:0
    ds_read_b128 v[48:51], v13 offset:3072
    ds_read_b128 v[40:43], v13 offset:256
    ds_read_b128 v[52:55], v13 offset:3328
    ds_read_b128 v[44:47], v13 offset:512
    ds_read_b128 v[56:59], v13 offset:3584
    s_waitcnt lgkmcnt(4)
    v_cvt_f32_i32 v36, v36
    v_cvt_f32_i32 v37, v37
    v_cvt_f32_i32 v38, v38
    v_cvt_f32_i32 v39, v39
    v_cvt_f32_i32 v48, v48
    v_cvt_f32_i32 v49, v49
    v_cvt_f32_i32 v50, v50
    v_cvt_f32_i32 v51, v51
    v_cvt_pk_bf16_f32 v63, v36, v48
    v_cvt_pk_bf16_f32 v67, v37, v49
    v_cvt_pk_bf16_f32 v71, v38, v50
    v_cvt_pk_bf16_f32 v75, v39, v51
    s_waitcnt lgkmcnt(2)
    v_cvt_f32_i32 v40, v40
    v_cvt_f32_i32 v41, v41
    v_cvt_f32_i32 v42, v42
    v_mfma_f32_16x16x32_bf16 v[160:163], v[184:187], v[60:63], v[160:163]
    v_cvt_f32_i32 v43, v43
    v_cvt_f32_i32 v52, v52
    v_cvt_f32_i32 v53, v53
    v_mfma_f32_16x16x32_bf16 v[160:163], v[188:191], v[64:67], v[160:163]
    v_cvt_f32_i32 v54, v54
    v_cvt_f32_i32 v55, v55
    v_cvt_pk_bf16_f32 v79, v40, v52
    v_mfma_f32_16x16x32_bf16 v[160:163], v[192:195], v[68:71], v[160:163]
    v_cvt_pk_bf16_f32 v83, v41, v53
    v_cvt_pk_bf16_f32 v87, v42, v54
    v_cvt_pk_bf16_f32 v91, v43, v55
    v_mfma_f32_16x16x32_bf16 v[160:163], v[196:199], v[72:75], v[160:163]
    s_waitcnt lgkmcnt(0)
    v_cvt_f32_i32 v44, v44
    v_cvt_f32_i32 v45, v45
    v_cvt_f32_i32 v46, v46
    v_mfma_f32_16x16x32_bf16 v[164:167], v[184:187], v[76:79], v[164:167]
    v_cvt_f32_i32 v47, v47
    v_cvt_f32_i32 v56, v56
    v_cvt_f32_i32 v57, v57
    v_mfma_f32_16x16x32_bf16 v[164:167], v[188:191], v[80:83], v[164:167]
    v_cvt_f32_i32 v58, v58
    v_cvt_f32_i32 v59, v59
    v_cvt_pk_bf16_f32 v95, v44, v56
    v_mfma_f32_16x16x32_bf16 v[164:167], v[192:195], v[84:87], v[164:167]
    v_cvt_pk_bf16_f32 v99, v45, v57
    v_cvt_pk_bf16_f32 v103, v46, v58
    v_cvt_pk_bf16_f32 v107, v47, v59
    v_mfma_f32_16x16x32_bf16 v[164:167], v[196:199], v[88:91], v[164:167]
    v_mfma_f32_16x16x32_bf16 v[168:171], v[184:187], v[92:95], v[168:171]
    v_mfma_f32_16x16x32_bf16 v[168:171], v[188:191], v[96:99], v[168:171]
    v_mfma_f32_16x16x32_bf16 v[168:171], v[192:195], v[100:103], v[168:171]
    v_mfma_f32_16x16x32_bf16 v[168:171], v[196:199], v[104:107], v[168:171]
    v_add_u32 v13, s62, v12
    s_add_u32 s62, s62, 24576
    s_cmp_eq_u32 s62, 73728
    s_cselect_b32 s62, 0, s62
    s_barrier
    ds_read_b128 v[36:39], v13 offset:0
    ds_read_b128 v[48:51], v13 offset:3072
    ds_read_b128 v[40:43], v13 offset:256
    ds_read_b128 v[52:55], v13 offset:3328
    ds_read_b128 v[44:47], v13 offset:512
    ds_read_b128 v[56:59], v13 offset:3584
    s_waitcnt lgkmcnt(6)
    v_lshlrev_b32 v215, 16, v210
    v_and_b32 v216, s66, v210
    v_fma_f32 v215, v215, s64, -v14
    v_fma_f32 v216, v216, s64, -v14
    v_exp_f32 v215, v215
    v_exp_f32 v216, v216
    v_lshlrev_b32 v217, 16, v211
    v_lshlrev_b32 v218, 16, v212
    v_mul_f32 v217, v215, v217
    v_mul_f32 v218, v216, v218
    v_add_f32 v208, v208, v215
    v_cvt_pk_bf16_f32 v217, v217, v218
    v_add_f32 v208, v208, v216
    v_lshlrev_b32 v219, 16, v213
    v_lshlrev_b32 v220, 16, v214
    v_lshlrev_b32 v215, 16, v217
    v_and_b32 v216, s66, v217
    v_fmac_f32 v209, v215, v219
    v_fmac_f32 v209, v216, v220
    v_mov_b32_dpp v184, v217 quad_perm:[0,1,2,3] row_mask:0xf bank_mask:0x1
    v_mov_b32_dpp v185, v217 row_ror:12 row_mask:0xf bank_mask:0x1
    v_mov_b32_dpp v186, v217 row_ror:8 row_mask:0xf bank_mask:0x1
    v_mov_b32_dpp v187, v217 row_ror:4 row_mask:0xf bank_mask:0x1
    v_mov_b32_dpp v188, v217 row_ror:4 row_mask:0xf bank_mask:0x2
    v_mov_b32_dpp v189, v217 quad_perm:[0,1,2,3] row_mask:0xf bank_mask:0x2
    v_mov_b32_dpp v190, v217 row_ror:12 row_mask:0xf bank_mask:0x2
    v_mov_b32_dpp v191, v217 row_ror:8 row_mask:0xf bank_mask:0x2
    v_mov_b32_dpp v192, v217 row_ror:8 row_mask:0xf bank_mask:0x4
    v_mov_b32_dpp v193, v217 row_ror:4 row_mask:0xf bank_mask:0x4
    v_mov_b32_dpp v194, v217 quad_perm:[0,1,2,3] row_mask:0xf bank_mask:0x4
    v_mov_b32_dpp v195, v217 row_ror:12 row_mask:0xf bank_mask:0x4
    v_mov_b32_dpp v196, v217 row_ror:12 row_mask:0xf bank_mask:0x8
    v_mov_b32_dpp v197, v217 row_ror:8 row_mask:0xf bank_mask:0x8
    v_mov_b32_dpp v198, v217 row_ror:4 row_mask:0xf bank_mask:0x8
    v_mov_b32_dpp v199, v217 quad_perm:[0,1,2,3] row_mask:0xf bank_mask:0x8
    s_waitcnt lgkmcnt(4)
    v_cvt_f32_i32 v36, v36
    v_cvt_f32_i32 v37, v37
    v_cvt_f32_i32 v38, v38
    v_cvt_f32_i32 v39, v39
    v_cvt_f32_i32 v48, v48
    v_cvt_f32_i32 v49, v49
    v_cvt_f32_i32 v50, v50
    v_cvt_f32_i32 v51, v51
    v_cvt_pk_bf16_f32 v60, v36, v48
    v_cvt_pk_bf16_f32 v64, v37, v49
    v_cvt_pk_bf16_f32 v68, v38, v50
    v_cvt_pk_bf16_f32 v72, v39, v51
    s_waitcnt lgkmcnt(2)
    v_cvt_f32_i32 v40, v40
    v_cvt_f32_i32 v41, v41
    v_cvt_f32_i32 v42, v42
    v_cvt_f32_i32 v43, v43
    v_cvt_f32_i32 v52, v52
    v_cvt_f32_i32 v53, v53
    v_cvt_f32_i32 v54, v54
    v_cvt_f32_i32 v55, v55
    v_cvt_pk_bf16_f32 v76, v40, v52
    v_cvt_pk_bf16_f32 v80, v41, v53
    v_cvt_pk_bf16_f32 v84, v42, v54
    v_cvt_pk_bf16_f32 v88, v43, v55
    s_waitcnt lgkmcnt(0)
    v_cvt_f32_i32 v44, v44
    v_cvt_f32_i32 v45, v45
    v_cvt_f32_i32 v46, v46
    v_cvt_f32_i32 v47, v47
    v_cvt_f32_i32 v56, v56
    v_cvt_f32_i32 v57, v57
    v_cvt_f32_i32 v58, v58
    v_cvt_f32_i32 v59, v59
    v_cvt_pk_bf16_f32 v92, v44, v56
    v_cvt_pk_bf16_f32 v96, v45, v57
    v_cvt_pk_bf16_f32 v100, v46, v58
    v_cvt_pk_bf16_f32 v104, v47, v59
    v_add_u32 v11, 3072, v11
    s_add_u32 s63, s63, 1024
    v_add_u32 v211, s63, v7
    v_add_u32 v212, s63, v8
    ds_read_b32 v210, v11 offset:0
    ds_read_u16 v213, v211 offset:512
    ds_read_u16 v214, v212 offset:512
    ds_read_u16 v211, v211
    ds_read_u16 v212, v212
    v_add_u32 v13, s62, v12
    s_add_u32 s62, s62, 24576
    s_cmp_eq_u32 s62, 73728
    s_cselect_b32 s62, 0, s62
    s_barrier
    ds_read_b128 v[36:39], v13 offset:0
    ds_read_b128 v[48:51], v13 offset:3072
    ds_read_b128 v[40:43], v13 offset:256
    ds_read_b128 v[52:55], v13 offset:3328
    ds_read_b128 v[44:47], v13 offset:512
    ds_read_b128 v[56:59], v13 offset:3584
    s_waitcnt lgkmcnt(4)
    v_cvt_f32_i32 v36, v36
    v_cvt_f32_i32 v37, v37
    v_cvt_f32_i32 v38, v38
    v_cvt_f32_i32 v39, v39
    v_cvt_f32_i32 v48, v48
    v_cvt_f32_i32 v49, v49
    v_cvt_f32_i32 v50, v50
    v_cvt_f32_i32 v51, v51
    v_cvt_pk_bf16_f32 v61, v36, v48
    v_cvt_pk_bf16_f32 v65, v37, v49
    v_cvt_pk_bf16_f32 v69, v38, v50
    v_cvt_pk_bf16_f32 v73, v39, v51
    s_waitcnt lgkmcnt(2)
    v_cvt_f32_i32 v40, v40
    v_cvt_f32_i32 v41, v41
    v_cvt_f32_i32 v42, v42
    v_cvt_f32_i32 v43, v43
    v_cvt_f32_i32 v52, v52
    v_cvt_f32_i32 v53, v53
    v_cvt_f32_i32 v54, v54
    v_cvt_f32_i32 v55, v55
    v_cvt_pk_bf16_f32 v77, v40, v52
    v_cvt_pk_bf16_f32 v81, v41, v53
    v_cvt_pk_bf16_f32 v85, v42, v54
    v_cvt_pk_bf16_f32 v89, v43, v55
    s_waitcnt lgkmcnt(0)
    v_cvt_f32_i32 v44, v44
    v_cvt_f32_i32 v45, v45
    v_cvt_f32_i32 v46, v46
    v_cvt_f32_i32 v47, v47
    v_cvt_f32_i32 v56, v56
    v_cvt_f32_i32 v57, v57
    v_cvt_f32_i32 v58, v58
    v_cvt_f32_i32 v59, v59
    v_cvt_pk_bf16_f32 v93, v44, v56
    v_cvt_pk_bf16_f32 v97, v45, v57
    v_cvt_pk_bf16_f32 v101, v46, v58
    v_cvt_pk_bf16_f32 v105, v47, v59
    s_cmp_eq_u32 s74, 0
    s_cbranch_scc1 L_vnostat
    v_mov_b32 v22, 154884
    ds_read_b32 v22, v22
    s_nop 1
    v_add_f32_dpp v208, v208, v208 row_ror:4 row_mask:0xf bank_mask:0xf
    s_nop 1
    v_add_f32_dpp v208, v208, v208 row_ror:8 row_mask:0xf bank_mask:0xf
    v_mov_b32 v3, v208
    s_nop 1
    v_permlane16_swap_b32 v208, v3
    v_add_f32 v208, v208, v3
    v_mov_b32 v3, v208
    s_nop 1
    v_permlane32_swap_b32 v208, v3
    v_add_f32 v208, v208, v3
    s_nop 1
    v_add_f32_dpp v209, v209, v209 row_ror:4 row_mask:0xf bank_mask:0xf
    s_nop 1
    v_add_f32_dpp v209, v209, v209 row_ror:8 row_mask:0xf bank_mask:0xf
    v_mov_b32 v3, v209
    s_nop 1
    v_permlane16_swap_b32 v209, v3
    v_add_f32 v209, v209, v3
    v_mov_b32 v3, v209
    s_nop 1
    v_permlane32_swap_b32 v209, v3
    v_add_f32 v209, v209, v3
    v_mov_b32 v156, v14
    v_mov_b32 v157, v208
    v_mov_b32 v158, v209
    ds_write_b128 v155, v[156:159]
    v_add_u32 v153, 64, v153
L_vnostat:
    v_add_u32 v13, s62, v12
    s_add_u32 s62, s62, 24576
    s_cmp_eq_u32 s62, 73728
    s_cselect_b32 s62, 0, s62
    s_barrier
    ds_read_b128 v[36:39], v13 offset:0
    ds_read_b128 v[48:51], v13 offset:3072
    ds_read_b128 v[40:43], v13 offset:256
    ds_read_b128 v[52:55], v13 offset:3328
    ds_read_b128 v[44:47], v13 offset:512
    ds_read_b128 v[56:59], v13 offset:3584
    s_waitcnt lgkmcnt(4)
    v_cvt_f32_i32 v36, v36
    v_cvt_f32_i32 v37, v37
    v_cvt_f32_i32 v38, v38
    v_cvt_f32_i32 v39, v39
    v_cvt_f32_i32 v48, v48
    v_cvt_f32_i32 v49, v49
    v_cvt_f32_i32 v50, v50
    v_cvt_f32_i32 v51, v51
    v_cvt_pk_bf16_f32 v62, v36, v48
    v_cvt_pk_bf16_f32 v66, v37, v49
    v_cvt_pk_bf16_f32 v70, v38, v50
    v_cvt_pk_bf16_f32 v74, v39, v51
    s_waitcnt lgkmcnt(2)
    v_cvt_f32_i32 v40, v40
    v_cvt_f32_i32 v41, v41
    v_cvt_f32_i32 v42, v42
    v_cvt_f32_i32 v43, v43
    v_cvt_f32_i32 v52, v52
    v_cvt_f32_i32 v53, v53
    v_cvt_f32_i32 v54, v54
    v_cvt_f32_i32 v55, v55
    v_cvt_pk_bf16_f32 v78, v40, v52
    v_cvt_pk_bf16_f32 v82, v41, v53
    v_cvt_pk_bf16_f32 v86, v42, v54
    v_cvt_pk_bf16_f32 v90, v43, v55
    s_waitcnt lgkmcnt(0)
    v_cvt_f32_i32 v44, v44
    v_cvt_f32_i32 v45, v45
    v_cvt_f32_i32 v46, v46
    v_cvt_f32_i32 v47, v47
    v_cvt_f32_i32 v56, v56
    v_cvt_f32_i32 v57, v57
    v_cvt_f32_i32 v58, v58
    v_cvt_f32_i32 v59, v59
    v_cvt_pk_bf16_f32 v94, v44, v56
    v_cvt_pk_bf16_f32 v98, v45, v57
    v_cvt_pk_bf16_f32 v102, v46, v58
    v_cvt_pk_bf16_f32 v106, v47, v59
    v_add_u32 v13, s62, v12
    s_add_u32 s62, s62, 24576
    s_cmp_eq_u32 s62, 73728
    s_cselect_b32 s62, 0, s62
    s_barrier
    ds_read_b128 v[36:39], v13 offset:0
    ds_read_b128 v[48:51], v13 offset:3072
    ds_read_b128 v[40:43], v13 offset:256
    ds_read_b128 v[52:55], v13 offset:3328
    ds_read_b128 v[44:47], v13 offset:512
    ds_read_b128 v[56:59], v13 offset:3584
    s_waitcnt lgkmcnt(4)
    v_cvt_f32_i32 v36, v36
    v_cvt_f32_i32 v37, v37
    v_cvt_f32_i32 v38, v38
    v_cvt_f32_i32 v39, v39
    v_cvt_f32_i32 v48, v48
    v_cvt_f32_i32 v49, v49
    v_cvt_f32_i32 v50, v50
    v_cvt_f32_i32 v51, v51
    v_cvt_pk_bf16_f32 v63, v36, v48
    v_cvt_pk_bf16_f32 v67, v37, v49
    v_cvt_pk_bf16_f32 v71, v38, v50
    v_cvt_pk_bf16_f32 v75, v39, v51
    s_waitcnt lgkmcnt(2)
    v_cvt_f32_i32 v40, v40
    v_cvt_f32_i32 v41, v41
    v_cvt_f32_i32 v42, v42
    v_mfma_f32_16x16x32_bf16 v[160:163], v[184:187], v[60:63], v[160:163]
    v_cvt_f32_i32 v43, v43
    v_cvt_f32_i32 v52, v52
    v_cvt_f32_i32 v53, v53
    v_mfma_f32_16x16x32_bf16 v[160:163], v[188:191], v[64:67], v[160:163]
    v_cvt_f32_i32 v54, v54
    v_cvt_f32_i32 v55, v55
    v_cvt_pk_bf16_f32 v79, v40, v52
    v_mfma_f32_16x16x32_bf16 v[160:163], v[192:195], v[68:71], v[160:163]
    v_cvt_pk_bf16_f32 v83, v41, v53
    v_cvt_pk_bf16_f32 v87, v42, v54
    v_cvt_pk_bf16_f32 v91, v43, v55
    v_mfma_f32_16x16x32_bf16 v[160:163], v[196:199], v[72:75], v[160:163]
    s_waitcnt lgkmcnt(0)
    v_cvt_f32_i32 v44, v44
    v_cvt_f32_i32 v45, v45
    v_cvt_f32_i32 v46, v46
    v_mfma_f32_16x16x32_bf16 v[164:167], v[184:187], v[76:79], v[164:167]
    v_cvt_f32_i32 v47, v47
    v_cvt_f32_i32 v56, v56
    v_cvt_f32_i32 v57, v57
    v_mfma_f32_16x16x32_bf16 v[164:167], v[188:191], v[80:83], v[164:167]
    v_cvt_f32_i32 v58, v58
    v_cvt_f32_i32 v59, v59
    v_cvt_pk_bf16_f32 v95, v44, v56
    v_mfma_f32_16x16x32_bf16 v[164:167], v[192:195], v[84:87], v[164:167]
    v_cvt_pk_bf16_f32 v99, v45, v57
    v_cvt_pk_bf16_f32 v103, v46, v58
    v_cvt_pk_bf16_f32 v107, v47, v59
    v_mfma_f32_16x16x32_bf16 v[164:167], v[196:199], v[88:91], v[164:167]
    v_mfma_f32_16x16x32_bf16 v[168:171], v[184:187], v[92:95], v[168:171]
    v_mfma_f32_16x16x32_bf16 v[168:171], v[188:191], v[96:99], v[168:171]
    v_mfma_f32_16x16x32_bf16 v[168:171], v[192:195], v[100:103], v[168:171]
    v_mfma_f32_16x16x32_bf16 v[168:171], v[196:199], v[104:107], v[168:171]
    s_cmp_eq_u32 s74, 0
    s_cbranch_scc1 L_vblk
    ds_write_b128 v154, v[160:163]
    s_nop 0
    ds_write_b128 v154, v[164:167] offset:1024
    s_cmp_lt_u32 s61, 16
    s_nop 1
    ds_write_b128 v154, v[168:171] offset:2048
    s_waitcnt lgkmcnt(0)
    s_cbranch_scc1 L_vround
    s_barrier
    s_cmp_eq_u32 s56, 3
    s_cbranch_scc1 L_fin
    ds_read_b128 v[36:39], v18 offset:0
    ds_read_b128 v[40:43], v18 offset:64
    ds_read_b128 v[44:47], v18 offset:128
    ds_read_b128 v[48:51], v18 offset:192
    ds_read2st64_b32 v[60:61], v17 offset0:0 offset1:1
    ds_read2st64_b32 v[62:63], v17 offset0:2 offset1:3
    ds_read2st64_b32 v[64:65], v17 offset0:12 offset1:13
    ds_read2st64_b32 v[66:67], v17 offset0:14 offset1:15
    ds_read2st64_b32 v[68:69], v17 offset0:24 offset1:25
    ds_read2st64_b32 v[70:71], v17 offset0:26 offset1:27
    ds_read2st64_b32 v[72:73], v17 offset0:36 offset1:37
    ds_read2st64_b32 v[74:75], v17 offset0:38 offset1:39
    s_cmp_eq_u32 s101, 0
    s_cbranch_scc0 L_rp10
    buffer_load_dwordx4 v[172:175], v20, s[24:27], s69 offen sc1
    buffer_load_dwordx4 v[180:183], v20, s[24:27], s70 offen sc1
    buffer_load_dwordx4 v[168:171], v19, s[24:27], s69 offen sc1
    buffer_load_dwordx4 v[176:179], v19, s[24:27], s70 offen sc1
    s_branch L_rp12
L_rp10:
    s_cmp_eq_u32 s101, 1
    s_cbranch_scc0 L_rp11
    buffer_load_dwordx4 v[164:167], v20, s[24:27], s68 offen sc1
    buffer_load_dwordx4 v[180:183], v20, s[24:27], s70 offen sc1
    buffer_load_dwordx4 v[160:163], v19, s[24:27], s68 offen sc1
    buffer_load_dwordx4 v[176:179], v19, s[24:27], s70 offen sc1
    s_branch L_rp12
L_rp11:
    buffer_load_dwordx4 v[164:167], v20, s[24:27], s68 offen sc1
    buffer_load_dwordx4 v[172:175], v20, s[24:27], s69 offen sc1
    buffer_load_dwordx4 v[160:163], v19, s[24:27], s68 offen sc1
    buffer_load_dwordx4 v[168:171], v19, s[24:27], s69 offen sc1
L_rp12:
    s_waitcnt lgkmcnt(8)
    v_add_f32 v37, v37, v41
    v_add_f32 v45, v45, v49
    v_add_f32 v38, v38, v42
    v_add_f32 v46, v46, v50
    v_add_f32 v37, v37, v45
    v_add_f32 v38, v38, v46
    v_mov_b32 v39, v22
    s_waitcnt lgkmcnt(4)
    v_add_f32 v60, v60, v64
    v_add_f32 v61, v61, v65
    v_add_f32 v62, v62, v66
    v_add_f32 v63, v63, v67
    s_waitcnt lgkmcnt(0)
    v_add_f32 v68, v68, v72
    v_add_f32 v69, v69, v73
    v_add_f32 v70, v70, v74
    v_add_f32 v71, v71, v75
    v_add_f32 v60, v60, v68
    v_add_f32 v61, v61, v69
    v_add_f32 v62, v62, v70
    v_add_f32 v63, v63, v71
    v_sub_f32 v60, v60, v38
    v_sub_f32 v61, v61, v38
    v_sub_f32 v62, v62, v38
    v_sub_f32 v63, v63, v38
    s_cmp_eq_u32 s2, 255
    s_cbranch_scc1 L_rsolo
    v_perm_b32 v60, v60, v22, s84
    v_perm_b32 v61, v61, v22, s85
    v_perm_b32 v62, v62, v22, s86
    v_perm_b32 v63, v63, v22, s87
    buffer_store_dwordx4 v[60:63], v19, s[24:27], s71 offen sc1
    s_mov_b64 exec, 15
    buffer_store_dwordx4 v[36:39], v20, s[24:27], s71 offen sc1
    s_mov_b64 exec, -1
    s_cmp_eq_u32 s101, 0
    s_cbranch_scc0 L_rp20
    v_mov_b32 v160, v60
    v_mov_b32 v164, v36
    v_mov_b32 v161, v61
    v_mov_b32 v165, v37
    v_mov_b32 v162, v62
    v_mov_b32 v166, v38
    v_mov_b32 v163, v63
    v_mov_b32 v167, v39
    s_branch L_rp22
L_rp20:
    s_cmp_eq_u32 s101, 1
    s_cbranch_scc0 L_rp21
    v_mov_b32 v168, v60
    v_mov_b32 v172, v36
    v_mov_b32 v169, v61
    v_mov_b32 v173, v37
    v_mov_b32 v170, v62
    v_mov_b32 v174, v38
    v_mov_b32 v171, v63
    v_mov_b32 v175, v39
    s_branch L_rp22
L_rp21:
    v_mov_b32 v176, v60
    v_mov_b32 v180, v36
    v_mov_b32 v177, v61
    v_mov_b32 v181, v37
    v_mov_b32 v178, v62
    v_mov_b32 v182, v38
    v_mov_b32 v179, v63
    v_mov_b32 v183, v39
L_rp22:
    s_waitcnt vmcnt(4)
    v_xor_b32 v40, v167, v22
    v_xor_b32 v41, v175, v22
    v_xor_b32 v42, v183, v22
    v_or3_b32 v4, v40, v41, v42
    s_waitcnt vmcnt(2)
    v_perm_b32 v5, v161, v160, s88
    v_perm_b32 v6, v163, v162, s89
    v_bitop3_b32 v5, v5, v6, v22 bitop3:0x56
    v_or_b32 v4, v4, v5
    v_perm_b32 v5, v169, v168, s88
    v_perm_b32 v6, v171, v170, s89
    v_bitop3_b32 v5, v5, v6, v22 bitop3:0x56
    v_or_b32 v4, v4, v5
    v_perm_b32 v5, v177, v176, s88
    v_perm_b32 v6, v179, v178, s89
    v_bitop3_b32 v5, v5, v6, v22 bitop3:0x56
    v_or_b32 v4, v4, v5
    v_cmp_eq_u32 vcc, 0, v4
    s_nop 4
    s_cmp_eq_u64 vcc, -1
    s_cbranch_scc1 L_rmerge
    s_waitcnt vmcnt(0)
    s_cmp_eq_u32 s101, 0
    s_cbranch_scc0 L_rp30
    buffer_load_dwordx4 v[172:175], v20, s[24:27], s69 offen sc1
    buffer_load_dwordx4 v[180:183], v20, s[24:27], s70 offen sc1
    buffer_load_dwordx4 v[168:171], v19, s[24:27], s69 offen sc1
    buffer_load_dwordx4 v[176:179], v19, s[24:27], s70 offen sc1
    s_branch L_rp32
L_rp30:
    s_cmp_eq_u32 s101, 1
    s_cbranch_scc0 L_rp31
    buffer_load_dwordx4 v[164:167], v20, s[24:27], s68 offen sc1
    buffer_load_dwordx4 v[180:183], v20, s[24:27], s70 offen sc1
    buffer_load_dwordx4 v[160:163], v19, s[24:27], s68 offen sc1
    buffer_load_dwordx4 v[176:179], v19, s[24:27], s70 offen sc1
    s_branch L_rp32
L_rp31:
    buffer_load_dwordx4 v[164:167], v20, s[24:27], s68 offen sc1
    buffer_load_dwordx4 v[172:175], v20, s[24:27], s69 offen sc1
    buffer_load_dwordx4 v[160:163], v19, s[24:27], s68 offen sc1
    buffer_load_dwordx4 v[168:171], v19, s[24:27], s69 offen sc1
L_rp32:
    s_waitcnt vmcnt(2)
    v_xor_b32 v40, v167, v22
    v_xor_b32 v41, v175, v22
    v_xor_b32 v42, v183, v22
    v_or3_b32 v4, v40, v41, v42
    s_waitcnt vmcnt(0)
    v_perm_b32 v5, v161, v160, s88
    v_perm_b32 v6, v163, v162, s89
    v_bitop3_b32 v5, v5, v6, v22 bitop3:0x56
    v_or_b32 v4, v4, v5
    v_perm_b32 v5, v169, v168, s88
    v_perm_b32 v6, v171, v170, s89
    v_bitop3_b32 v5, v5, v6, v22 bitop3:0x56
    v_or_b32 v4, v4, v5
    v_perm_b32 v5, v177, v176, s88
    v_perm_b32 v6, v179, v178, s89
    v_bitop3_b32 v5, v5, v6, v22 bitop3:0x56
    v_or_b32 v4, v4, v5
    v_cmp_eq_u32 vcc, 0, v4
L_rmerge:
    v_max3_f32 v3, v164, v172, v180
    v_sub_f32 v164, v164, v3
    v_sub_f32 v172, v172, v3
    v_sub_f32 v180, v180, v3
    v_exp_f32 v164, v164
    v_exp_f32 v172, v172
    v_exp_f32 v180, v180
    s_and_b64 exec, exec, vcc
    s_cbranch_execz L_fin
    v_and_b32 v160, s90, v160
    v_and_b32 v161, s90, v161
    v_and_b32 v162, s90, v162
    v_and_b32 v163, s90, v163
    v_and_b32 v168, s90, v168
    v_and_b32 v169, s90, v169
    v_and_b32 v170, s90, v170
    v_and_b32 v171, s90, v171
    v_and_b32 v176, s90, v176
    v_and_b32 v177, s90, v177
    v_and_b32 v178, s90, v178
    v_and_b32 v179, s90, v179
    v_mul_f32 v37, v164, v165
    v_fmac_f32 v37, v172, v173
    v_fmac_f32 v37, v180, v181
    v_mul_f32 v60, v160, v164
    v_fmac_f32 v60, v168, v172
    v_fmac_f32 v60, v176, v180
    v_mul_f32 v61, v161, v164
    v_fmac_f32 v61, v169, v172
    v_fmac_f32 v61, v177, v180
    v_mul_f32 v62, v162, v164
    v_fmac_f32 v62, v170, v172
    v_fmac_f32 v62, v178, v180
    v_mul_f32 v63, v163, v164
    v_fmac_f32 v63, v171, v172
    v_fmac_f32 v63, v179, v180
L_rsolo:
    v_rcp_f32 v37, v37
    s_nop 0
    v_mul_f32 v60, v60, v37
    v_mul_f32 v61, v61, v37
    v_mul_f32 v62, v62, v37
    v_mul_f32 v63, v63, v37
    v_cvt_pk_bf16_f32 v64, v60, v61
    v_cvt_pk_bf16_f32 v65, v62, v63
    buffer_store_dwordx2 v[64:65], v21, s[48:51], s57 offen
    s_branch L_fin
L_finisher:
    v_and_b32 v14, 3, v1
    v_mul_u32_u24 v8, 384, v14
    v_lshrrev_b32 v13, 2, v1
    v_lshl_add_u32 v8, v13, 3, v8
    v_lshlrev_b32 v9, 4, v1
    v_lshlrev_b32 v14, 4, v14
    s_memrealtime s[96:97]
    s_waitcnt lgkmcnt(0)
    s_mov_b32 s48, s18
    s_and_b32 s49, s19, 0xffff
    s_mov_b32 s50, 393216
    s_mov_b32 s51, 0x20000
    s_mov_b32 s52, s20
    s_and_b32 s53, s21, 0xffff
    s_mov_b32 s54, 256
    s_mov_b32 s55, 0x20000
    s_mov_b32 s24, s22
    s_and_b32 s25, s23, 0xffff
    s_mov_b32 s26, 2528256
    s_mov_b32 s27, 0x20000
    s_cmp_eq_u32 s2, 0
    s_cbranch_scc0 L_fk
    s_or_b32 s71, s96, 1
    v_mov_b32 v16, s71
    v_mov_b32 v17, 0
    s_mov_b64 exec, 1
    buffer_atomic_cmpswap v[16:17], v9, s[52:55], 0 offen sc0 sc1
    s_mov_b64 exec, -1
    s_waitcnt vmcnt(0)
    v_readfirstlane_b32 s58, v16
    s_nop 3
    s_cmp_eq_u32 s58, 0
    s_cselect_b32 s71, s71, s58
L_fk:
    s_movk_i32 s69, 128
L_fb1:
    s_barrier
    s_sub_u32 s69, s69, 1
    s_cmp_lg_u32 s69, 0
    s_cbranch_scc1 L_fb1
    s_load_dword s71, s[20:21], 0
    s_barrier
    s_waitcnt lgkmcnt(0)
    s_cmp_eq_u32 s71, 0
    s_cbranch_scc0 L_ftag
    s_or_b32 s71, s96, 1
    v_mov_b32 v16, s71
    v_mov_b32 v17, 0
    s_mov_b64 exec, 1
    buffer_atomic_cmpswap v[16:17], v9, s[52:55], 0 offen sc0 sc1
    s_mov_b64 exec, -1
    s_waitcnt vmcnt(0)
    v_readfirstlane_b32 s58, v16
    s_nop 3
    s_cmp_eq_u32 s58, 0
    s_cselect_b32 s71, s71, s58
L_ftag:
    v_mov_b32 v10, s71
    v_mov_b32 v13, 154884
    ds_write_b32 v13, v10
    s_lshr_b32 s63, s101, 1
    s_lshl_b32 s58, s100, 1
    s_add_u32 s63, s63, s58
    s_mul_i32 s62, s63, 8704
    s_add_u32 s62, s62, 1048576
    s_waitcnt lgkmcnt(0)
    s_cmp_eq_u32 s2, 255
    s_cbranch_scc1 L_fin
    s_cmp_eq_u32 s101, 1
    s_cbranch_scc1 L_fmid
    s_movk_i32 s69, 89
L_fb2:
    s_barrier
    s_sub_u32 s69, s69, 1
    s_cmp_lg_u32 s69, 0
    s_cbranch_scc1 L_fb2
    v_add_u32 v13, 142336, v14
    v_lshlrev_b32 v11, 2, v1
    v_add_u32 v11, 142592, v11
    ds_read_b128 v[16:19], v13 offset:0
    ds_read_b128 v[20:23], v13 offset:64
    ds_read_b128 v[24:27], v13 offset:128
    ds_read_b128 v[28:31], v13 offset:192
    ds_read2st64_b32 v[32:33], v11 offset0:0 offset1:1
    ds_read2st64_b32 v[34:35], v11 offset0:2 offset1:3
    ds_read2st64_b32 v[36:37], v11 offset0:4 offset1:5
    ds_read2st64_b32 v[38:39], v11 offset0:6 offset1:7
    ds_read2st64_b32 v[40:41], v11 offset0:8 offset1:9
    ds_read2st64_b32 v[42:43], v11 offset0:10 offset1:11
    ds_read2st64_b32 v[44:45], v11 offset0:12 offset1:13
    ds_read2st64_b32 v[46:47], v11 offset0:14 offset1:15
    s_waitcnt lgkmcnt(4)
    ds_read2st64_b32 v[48:49], v11 offset0:16 offset1:17
    ds_read2st64_b32 v[50:51], v11 offset0:18 offset1:19
    ds_read2st64_b32 v[52:53], v11 offset0:20 offset1:21
    ds_read2st64_b32 v[54:55], v11 offset0:22 offset1:23
    ds_read2st64_b32 v[56:57], v11 offset0:24 offset1:25
    ds_read2st64_b32 v[58:59], v11 offset0:26 offset1:27
    ds_read2st64_b32 v[60:61], v11 offset0:28 offset1:29
    ds_read2st64_b32 v[62:63], v11 offset0:30 offset1:31
    s_waitcnt lgkmcnt(4)
    ds_read2st64_b32 v[64:65], v11 offset0:32 offset1:33
    ds_read2st64_b32 v[66:67], v11 offset0:34 offset1:35
    ds_read2st64_b32 v[68:69], v11 offset0:36 offset1:37
    ds_read2st64_b32 v[70:71], v11 offset0:38 offset1:39
    ds_read2st64_b32 v[72:73], v11 offset0:40 offset1:41
    ds_read2st64_b32 v[74:75], v11 offset0:42 offset1:43
    ds_read2st64_b32 v[76:77], v11 offset0:44 offset1:45
    ds_read2st64_b32 v[78:79], v11 offset0:46 offset1:47
    v_mov_b32 v83, v10
    v_mov_b32 v87, v10
    v_mov_b32 v91, v10
    v_mov_b32 v95, v10
    v_mov_b32 v99, v10
    v_mov_b32 v96, v16
    v_add_f32 v17, v17, v21
    v_add_f32 v25, v25, v29
    v_add_f32 v97, v17, v25
    v_add_f32 v18, v18, v22
    v_add_f32 v26, v26, v30
    v_add_f32 v98, v18, v26
    s_waitcnt lgkmcnt(0)
    v_add_f32 v32, v32, v44
    v_add_f32 v56, v56, v68
    v_add_f32 v32, v32, v56
    v_sub_f32 v80, v32, v98
    v_add_f32 v33, v33, v45
    v_add_f32 v57, v57, v69
    v_add_f32 v33, v33, v57
    v_sub_f32 v81, v33, v98
    v_add_f32 v34, v34, v46
    v_add_f32 v58, v58, v70
    v_add_f32 v34, v34, v58
    v_sub_f32 v82, v34, v98
    v_add_f32 v35, v35, v47
    v_add_f32 v59, v59, v71
    v_add_f32 v35, v35, v59
    v_sub_f32 v84, v35, v98
    v_add_f32 v36, v36, v48
    v_add_f32 v60, v60, v72
    v_add_f32 v36, v36, v60
    v_sub_f32 v85, v36, v98
    v_add_f32 v37, v37, v49
    v_add_f32 v61, v61, v73
    v_add_f32 v37, v37, v61
    v_sub_f32 v86, v37, v98
    v_add_f32 v38, v38, v50
    v_add_f32 v62, v62, v74
    v_add_f32 v38, v38, v62
    v_sub_f32 v88, v38, v98
    v_add_f32 v39, v39, v51
    v_add_f32 v63, v63, v75
    v_add_f32 v39, v39, v63
    v_sub_f32 v89, v39, v98
    v_add_f32 v40, v40, v52
    v_add_f32 v64, v64, v76
    v_add_f32 v40, v40, v64
    v_sub_f32 v90, v40, v98
    v_add_f32 v41, v41, v53
    v_add_f32 v65, v65, v77
    v_add_f32 v41, v41, v65
    v_sub_f32 v92, v41, v98
    v_add_f32 v42, v42, v54
    v_add_f32 v66, v66, v78
    v_add_f32 v42, v42, v66
    v_sub_f32 v93, v42, v98
    v_add_f32 v43, v43, v55
    v_add_f32 v67, v67, v79
    v_add_f32 v43, v43, v67
    v_sub_f32 v94, v43, v98
    s_movk_i32 s69, 39
L_fb3:
    s_barrier
    s_sub_u32 s69, s69, 1
    s_cmp_lg_u32 s69, 0
    s_cbranch_scc1 L_fb3
    s_barrier
    s_mov_b32 s69, 2
L_fo5:
    s_add_u32 s58, s62, 4352
    s_add_u32 s59, s62, 8448
    buffer_load_dwordx4 v[116:119], v14, s[24:27], s59 offen sc1
    buffer_load_dwordx4 v[100:103], v9, s[24:27], s58 offen offset:0 sc1
    buffer_load_dwordx4 v[104:107], v9, s[24:27], s58 offen offset:1024 sc1
    buffer_load_dwordx4 v[108:111], v9, s[24:27], s58 offen offset:2048 sc1
    buffer_load_dwordx4 v[112:115], v9, s[24:27], s58 offen offset:3072 sc1
    s_waitcnt vmcnt(0)
    v_xor_b32 v13, v10, v103
    v_xor_b32 v11, v10, v107
    v_or_b32 v13, v13, v11
    v_xor_b32 v11, v10, v111
    v_or_b32 v13, v13, v11
    v_xor_b32 v11, v10, v115
    v_or_b32 v13, v13, v11
    v_xor_b32 v11, v10, v119
    v_or_b32 v13, v13, v11
    v_cmp_ne_u32 vcc, 0, v13
    s_nop 4
    s_cmp_eq_u64 vcc, 0
    s_cbranch_scc1 L_fo7
    s_sub_u32 s69, s69, 1
    s_cmp_lg_u32 s69, 0
    s_cbranch_scc1 L_fo5
    s_add_u32 s58, s62, 0
    s_add_u32 s59, s62, 4096
    buffer_store_dwordx4 v[80:83], v9, s[24:27], s58 offen offset:0 sc1
    buffer_store_dwordx4 v[84:87], v9, s[24:27], s58 offen offset:1024 sc1
    buffer_store_dwordx4 v[88:91], v9, s[24:27], s58 offen offset:2048 sc1
    buffer_store_dwordx4 v[92:95], v9, s[24:27], s58 offen offset:3072 sc1
    s_mov_b64 exec, 15
    buffer_store_dwordx4 v[96:99], v14, s[24:27], s59 offen sc1
    s_mov_b64 exec, -1
    s_waitcnt vmcnt(0)
    s_add_u32 s58, s62, 4352
    s_add_u32 s59, s62, 8448
    buffer_load_dwordx4 v[116:119], v14, s[24:27], s59 offen sc1
    buffer_load_dwordx4 v[100:103], v9, s[24:27], s58 offen offset:0 sc1
    buffer_load_dwordx4 v[104:107], v9, s[24:27], s58 offen offset:1024 sc1
    buffer_load_dwordx4 v[108:111], v9, s[24:27], s58 offen offset:2048 sc1
    buffer_load_dwordx4 v[112:115], v9, s[24:27], s58 offen offset:3072 sc1
    s_waitcnt vmcnt(0)
    v_xor_b32 v13, v10, v103
    v_xor_b32 v11, v10, v107
    v_or_b32 v13, v13, v11
    v_xor_b32 v11, v10, v111
    v_or_b32 v13, v13, v11
    v_xor_b32 v11, v10, v115
    v_or_b32 v13, v13, v11
    v_xor_b32 v11, v10, v119
    v_or_b32 v13, v13, v11
    v_cmp_ne_u32 vcc, 0, v13
    s_nop 4
    s_cmp_eq_u64 vcc, 0
    s_cbranch_scc0 L_fin
L_fo7:
    v_max_f32 v11, v96, v116
    v_sub_f32 v16, v96, v11
    v_sub_f32 v17, v116, v11
    v_exp_f32 v16, v16
    v_exp_f32 v17, v17
    s_nop 0
    v_mul_f32 v12, v16, v97
    v_fmac_f32 v12, v17, v117
    v_rcp_f32 v12, v12
    s_add_u32 s58, s63, 0
    s_mul_i32 s58, s58, 1536
    v_mul_f32 v16, v16, v12
    v_mul_f32 v17, v17, v12
    v_mul_f32 v32, v80, v16
    v_fmac_f32 v32, v100, v17
    v_mul_f32 v33, v81, v16
    v_fmac_f32 v33, v101, v17
    v_mul_f32 v34, v82, v16
    v_fmac_f32 v34, v102, v17
    v_mul_f32 v35, v84, v16
    v_fmac_f32 v35, v104, v17
    v_mul_f32 v36, v85, v16
    v_fmac_f32 v36, v105, v17
    v_mul_f32 v37, v86, v16
    v_fmac_f32 v37, v106, v17
    v_mul_f32 v38, v88, v16
    v_fmac_f32 v38, v108, v17
    v_mul_f32 v39, v89, v16
    v_fmac_f32 v39, v109, v17
    v_mul_f32 v40, v90, v16
    v_fmac_f32 v40, v110, v17
    v_mul_f32 v41, v92, v16
    v_fmac_f32 v41, v112, v17
    v_mul_f32 v42, v93, v16
    v_fmac_f32 v42, v113, v17
    v_mul_f32 v43, v94, v16
    v_fmac_f32 v43, v114, v17
    v_cvt_pk_bf16_f32 v44, v32, v33
    v_cvt_pk_bf16_f32 v45, v34, v35
    v_cvt_pk_bf16_f32 v46, v36, v37
    v_cvt_pk_bf16_f32 v47, v38, v39
    v_cvt_pk_bf16_f32 v48, v40, v41
    v_cvt_pk_bf16_f32 v49, v42, v43
    buffer_store_dwordx2 v[44:45], v8, s[48:51], s58 offen offset:0
    buffer_store_dwordx2 v[46:47], v8, s[48:51], s58 offen offset:128
    buffer_store_dwordx2 v[48:49], v8, s[48:51], s58 offen offset:256
    s_branch L_fin
L_fmid:
    v_and_b32 v7, 1, v1
    v_mul_u32_u24 v7, 8704, v7
    v_add_u32 v7, 4108, v7
    s_movk_i32 s69, 41
L_fb4:
    s_barrier
    s_sub_u32 s69, s69, 1
    s_cmp_lg_u32 s69, 0
    s_cbranch_scc1 L_fb4
    v_add_u32 v13, 142336, v14
    v_lshlrev_b32 v11, 2, v1
    v_add_u32 v11, 142592, v11
    ds_read_b128 v[16:19], v13 offset:0
    ds_read_b128 v[20:23], v13 offset:64
    ds_read_b128 v[24:27], v13 offset:128
    ds_read_b128 v[28:31], v13 offset:192
    ds_read2st64_b32 v[32:33], v11 offset0:0 offset1:1
    ds_read2st64_b32 v[34:35], v11 offset0:2 offset1:3
    ds_read2st64_b32 v[36:37], v11 offset0:4 offset1:5
    ds_read2st64_b32 v[38:39], v11 offset0:6 offset1:7
    ds_read2st64_b32 v[40:41], v11 offset0:8 offset1:9
    ds_read2st64_b32 v[42:43], v11 offset0:10 offset1:11
    ds_read2st64_b32 v[44:45], v11 offset0:12 offset1:13
    ds_read2st64_b32 v[46:47], v11 offset0:14 offset1:15
    s_waitcnt lgkmcnt(4)
    ds_read2st64_b32 v[48:49], v11 offset0:16 offset1:17
    ds_read2st64_b32 v[50:51], v11 offset0:18 offset1:19
    ds_read2st64_b32 v[52:53], v11 offset0:20 offset1:21
    ds_read2st64_b32 v[54:55], v11 offset0:22 offset1:23
    ds_read2st64_b32 v[56:57], v11 offset0:24 offset1:25
    ds_read2st64_b32 v[58:59], v11 offset0:26 offset1:27
    ds_read2st64_b32 v[60:61], v11 offset0:28 offset1:29
    ds_read2st64_b32 v[62:63], v11 offset0:30 offset1:31
    s_waitcnt lgkmcnt(4)
    ds_read2st64_b32 v[64:65], v11 offset0:32 offset1:33
    ds_read2st64_b32 v[66:67], v11 offset0:34 offset1:35
    ds_read2st64_b32 v[68:69], v11 offset0:36 offset1:37
    ds_read2st64_b32 v[70:71], v11 offset0:38 offset1:39
    ds_read2st64_b32 v[72:73], v11 offset0:40 offset1:41
    ds_read2st64_b32 v[74:75], v11 offset0:42 offset1:43
    ds_read2st64_b32 v[76:77], v11 offset0:44 offset1:45
    ds_read2st64_b32 v[78:79], v11 offset0:46 offset1:47
    v_mov_b32 v83, v10
    v_mov_b32 v87, v10
    v_mov_b32 v91, v10
    v_mov_b32 v95, v10
    v_mov_b32 v99, v10
    v_mov_b32 v96, v16
    v_add_f32 v17, v17, v21
    v_add_f32 v25, v25, v29
    v_add_f32 v97, v17, v25
    v_add_f32 v18, v18, v22
    v_add_f32 v26, v26, v30
    v_add_f32 v98, v18, v26
    s_waitcnt lgkmcnt(0)
    v_add_f32 v32, v32, v44
    v_add_f32 v56, v56, v68
    v_add_f32 v32, v32, v56
    v_sub_f32 v80, v32, v98
    v_add_f32 v33, v33, v45
    v_add_f32 v57, v57, v69
    v_add_f32 v33, v33, v57
    v_sub_f32 v81, v33, v98
    v_add_f32 v34, v34, v46
    v_add_f32 v58, v58, v70
    v_add_f32 v34, v34, v58
    v_sub_f32 v82, v34, v98
    v_add_f32 v35, v35, v47
    v_add_f32 v59, v59, v71
    v_add_f32 v35, v35, v59
    v_sub_f32 v84, v35, v98
    v_add_f32 v36, v36, v48
    v_add_f32 v60, v60, v72
    v_add_f32 v36, v36, v60
    v_sub_f32 v85, v36, v98
    v_add_f32 v37, v37, v49
    v_add_f32 v61, v61, v73
    v_add_f32 v37, v37, v61
    v_sub_f32 v86, v37, v98
    v_add_f32 v38, v38, v50
    v_add_f32 v62, v62, v74
    v_add_f32 v38, v38, v62
    v_sub_f32 v88, v38, v98
    v_add_f32 v39, v39, v51
    v_add_f32 v63, v63, v75
    v_add_f32 v39, v39, v63
    v_sub_f32 v89, v39, v98
    v_add_f32 v40, v40, v52
    v_add_f32 v64, v64, v76
    v_add_f32 v40, v40, v64
    v_sub_f32 v90, v40, v98
    v_add_f32 v41, v41, v53
    v_add_f32 v65, v65, v77
    v_add_f32 v41, v41, v65
    v_sub_f32 v92, v41, v98
    v_add_f32 v42, v42, v54
    v_add_f32 v66, v66, v78
    v_add_f32 v42, v42, v66
    v_sub_f32 v93, v42, v98
    v_add_f32 v43, v43, v55
    v_add_f32 v67, v67, v79
    v_add_f32 v43, v43, v67
    v_sub_f32 v94, v43, v98
    s_movk_i32 s69, 40
L_fb5:
    s_barrier
    s_sub_u32 s69, s69, 1
    s_cmp_lg_u32 s69, 0
    s_cbranch_scc1 L_fb5
    v_add_u32 v13, 142336, v14
    v_lshlrev_b32 v11, 2, v1
    v_add_u32 v11, 142592, v11
    ds_read_b128 v[16:19], v13 offset:0
    ds_read_b128 v[20:23], v13 offset:64
    ds_read_b128 v[24:27], v13 offset:128
    ds_read_b128 v[28:31], v13 offset:192
    ds_read2st64_b32 v[32:33], v11 offset0:0 offset1:1
    ds_read2st64_b32 v[34:35], v11 offset0:2 offset1:3
    ds_read2st64_b32 v[36:37], v11 offset0:4 offset1:5
    ds_read2st64_b32 v[38:39], v11 offset0:6 offset1:7
    ds_read2st64_b32 v[40:41], v11 offset0:8 offset1:9
    ds_read2st64_b32 v[42:43], v11 offset0:10 offset1:11
    ds_read2st64_b32 v[44:45], v11 offset0:12 offset1:13
    ds_read2st64_b32 v[46:47], v11 offset0:14 offset1:15
    s_waitcnt lgkmcnt(4)
    ds_read2st64_b32 v[48:49], v11 offset0:16 offset1:17
    ds_read2st64_b32 v[50:51], v11 offset0:18 offset1:19
    ds_read2st64_b32 v[52:53], v11 offset0:20 offset1:21
    ds_read2st64_b32 v[54:55], v11 offset0:22 offset1:23
    ds_read2st64_b32 v[56:57], v11 offset0:24 offset1:25
    ds_read2st64_b32 v[58:59], v11 offset0:26 offset1:27
    ds_read2st64_b32 v[60:61], v11 offset0:28 offset1:29
    ds_read2st64_b32 v[62:63], v11 offset0:30 offset1:31
    s_waitcnt lgkmcnt(4)
    ds_read2st64_b32 v[64:65], v11 offset0:32 offset1:33
    ds_read2st64_b32 v[66:67], v11 offset0:34 offset1:35
    ds_read2st64_b32 v[68:69], v11 offset0:36 offset1:37
    ds_read2st64_b32 v[70:71], v11 offset0:38 offset1:39
    ds_read2st64_b32 v[72:73], v11 offset0:40 offset1:41
    ds_read2st64_b32 v[74:75], v11 offset0:42 offset1:43
    ds_read2st64_b32 v[76:77], v11 offset0:44 offset1:45
    ds_read2st64_b32 v[78:79], v11 offset0:46 offset1:47
    v_mov_b32 v103, v10
    v_mov_b32 v107, v10
    v_mov_b32 v111, v10
    v_mov_b32 v115, v10
    v_mov_b32 v119, v10
    v_mov_b32 v116, v16
    v_add_f32 v17, v17, v21
    v_add_f32 v25, v25, v29
    v_add_f32 v117, v17, v25
    v_add_f32 v18, v18, v22
    v_add_f32 v26, v26, v30
    v_add_f32 v118, v18, v26
    s_waitcnt lgkmcnt(0)
    v_add_f32 v32, v32, v44
    v_add_f32 v56, v56, v68
    v_add_f32 v32, v32, v56
    v_sub_f32 v100, v32, v118
    v_add_f32 v33, v33, v45
    v_add_f32 v57, v57, v69
    v_add_f32 v33, v33, v57
    v_sub_f32 v101, v33, v118
    v_add_f32 v34, v34, v46
    v_add_f32 v58, v58, v70
    v_add_f32 v34, v34, v58
    v_sub_f32 v102, v34, v118
    v_add_f32 v35, v35, v47
    v_add_f32 v59, v59, v71
    v_add_f32 v35, v35, v59
    v_sub_f32 v104, v35, v118
    v_add_f32 v36, v36, v48
    v_add_f32 v60, v60, v72
    v_add_f32 v36, v36, v60
    v_sub_f32 v105, v36, v118
    v_add_f32 v37, v37, v49
    v_add_f32 v61, v61, v73
    v_add_f32 v37, v37, v61
    v_sub_f32 v106, v37, v118
    v_add_f32 v38, v38, v50
    v_add_f32 v62, v62, v74
    v_add_f32 v38, v38, v62
    v_sub_f32 v108, v38, v118
    v_add_f32 v39, v39, v51
    v_add_f32 v63, v63, v75
    v_add_f32 v39, v39, v63
    v_sub_f32 v109, v39, v118
    v_add_f32 v40, v40, v52
    v_add_f32 v64, v64, v76
    v_add_f32 v40, v40, v64
    v_sub_f32 v110, v40, v118
    v_add_f32 v41, v41, v53
    v_add_f32 v65, v65, v77
    v_add_f32 v41, v41, v65
    v_sub_f32 v112, v41, v118
    v_add_f32 v42, v42, v54
    v_add_f32 v66, v66, v78
    v_add_f32 v42, v42, v66
    v_sub_f32 v113, v42, v118
    v_add_f32 v43, v43, v55
    v_add_f32 v67, v67, v79
    v_add_f32 v43, v43, v67
    v_sub_f32 v114, v43, v118
    s_movk_i32 s69, 46
L_fb6:
    s_barrier
    s_sub_u32 s69, s69, 1
    s_cmp_lg_u32 s69, 0
    s_cbranch_scc1 L_fb6
    s_add_u32 s58, s62, 4352
    s_add_u32 s59, s62, 8448
    buffer_store_dwordx4 v[80:83], v9, s[24:27], s58 offen offset:0 sc1
    buffer_store_dwordx4 v[84:87], v9, s[24:27], s58 offen offset:1024 sc1
    buffer_store_dwordx4 v[88:91], v9, s[24:27], s58 offen offset:2048 sc1
    buffer_store_dwordx4 v[92:95], v9, s[24:27], s58 offen offset:3072 sc1
    s_mov_b64 exec, 15
    buffer_store_dwordx4 v[96:99], v14, s[24:27], s59 offen sc1
    s_mov_b64 exec, -1
    s_add_u32 s58, s62, 13056
    s_add_u32 s59, s62, 17152
    buffer_store_dwordx4 v[100:103], v9, s[24:27], s58 offen offset:0 sc1
    buffer_store_dwordx4 v[104:107], v9, s[24:27], s58 offen offset:1024 sc1
    buffer_store_dwordx4 v[108:111], v9, s[24:27], s58 offen offset:2048 sc1
    buffer_store_dwordx4 v[112:115], v9, s[24:27], s58 offen offset:3072 sc1
    s_mov_b64 exec, 15
    buffer_store_dwordx4 v[116:119], v14, s[24:27], s59 offen sc1
    s_mov_b64 exec, -1
    s_barrier
    s_barrier
    s_waitcnt vmcnt(0)
    buffer_load_dword v15, v7, s[24:27], s62 offen sc1
    s_waitcnt vmcnt(0)
    v_cmp_eq_u32 vcc, v15, v10
    s_nop 4
    s_and_b32 s70, vcc_lo, 3
    s_cbranch_scc0 L_fin
    s_bitcmp1_b32 s70, 0
    s_cbranch_scc0 L_fm30
    s_waitcnt vmcnt(0)
    s_add_u32 s58, s62, 0
    s_add_u32 s59, s62, 4096
    buffer_load_dwordx4 v[136:139], v14, s[24:27], s59 offen sc1
    buffer_load_dwordx4 v[120:123], v9, s[24:27], s58 offen offset:0 sc1
    buffer_load_dwordx4 v[124:127], v9, s[24:27], s58 offen offset:1024 sc1
    buffer_load_dwordx4 v[128:131], v9, s[24:27], s58 offen offset:2048 sc1
    buffer_load_dwordx4 v[132:135], v9, s[24:27], s58 offen offset:3072 sc1
    s_waitcnt vmcnt(0)
    v_xor_b32 v13, v10, v123
    v_xor_b32 v11, v10, v127
    v_or_b32 v13, v13, v11
    v_xor_b32 v11, v10, v131
    v_or_b32 v13, v13, v11
    v_xor_b32 v11, v10, v135
    v_or_b32 v13, v13, v11
    v_xor_b32 v11, v10, v139
    v_or_b32 v13, v13, v11
    v_cmp_ne_u32 vcc, 0, v13
    s_nop 4
    s_cmp_eq_u64 vcc, 0
    s_cbranch_scc0 L_fm30
    v_max_f32 v11, v136, v96
    v_sub_f32 v16, v136, v11
    v_sub_f32 v17, v96, v11
    v_exp_f32 v16, v16
    v_exp_f32 v17, v17
    s_nop 0
    v_mul_f32 v12, v16, v137
    v_fmac_f32 v12, v17, v97
    v_rcp_f32 v12, v12
    s_add_u32 s58, s63, 0
    s_mul_i32 s58, s58, 1536
    v_mul_f32 v16, v16, v12
    v_mul_f32 v17, v17, v12
    v_mul_f32 v32, v120, v16
    v_fmac_f32 v32, v80, v17
    v_mul_f32 v33, v121, v16
    v_fmac_f32 v33, v81, v17
    v_mul_f32 v34, v122, v16
    v_fmac_f32 v34, v82, v17
    v_mul_f32 v35, v124, v16
    v_fmac_f32 v35, v84, v17
    v_mul_f32 v36, v125, v16
    v_fmac_f32 v36, v85, v17
    v_mul_f32 v37, v126, v16
    v_fmac_f32 v37, v86, v17
    v_mul_f32 v38, v128, v16
    v_fmac_f32 v38, v88, v17
    v_mul_f32 v39, v129, v16
    v_fmac_f32 v39, v89, v17
    v_mul_f32 v40, v130, v16
    v_fmac_f32 v40, v90, v17
    v_mul_f32 v41, v132, v16
    v_fmac_f32 v41, v92, v17
    v_mul_f32 v42, v133, v16
    v_fmac_f32 v42, v93, v17
    v_mul_f32 v43, v134, v16
    v_fmac_f32 v43, v94, v17
    v_cvt_pk_bf16_f32 v44, v32, v33
    v_cvt_pk_bf16_f32 v45, v34, v35
    v_cvt_pk_bf16_f32 v46, v36, v37
    v_cvt_pk_bf16_f32 v47, v38, v39
    v_cvt_pk_bf16_f32 v48, v40, v41
    v_cvt_pk_bf16_f32 v49, v42, v43
    buffer_store_dwordx2 v[44:45], v8, s[48:51], s58 offen offset:0
    buffer_store_dwordx2 v[46:47], v8, s[48:51], s58 offen offset:128
    buffer_store_dwordx2 v[48:49], v8, s[48:51], s58 offen offset:256
L_fm30:
    s_bitcmp1_b32 s70, 1
    s_cbranch_scc0 L_fm31
    s_waitcnt vmcnt(0)
    s_add_u32 s58, s62, 8704
    s_add_u32 s59, s62, 12800
    buffer_load_dwordx4 v[136:139], v14, s[24:27], s59 offen sc1
    buffer_load_dwordx4 v[120:123], v9, s[24:27], s58 offen offset:0 sc1
    buffer_load_dwordx4 v[124:127], v9, s[24:27], s58 offen offset:1024 sc1
    buffer_load_dwordx4 v[128:131], v9, s[24:27], s58 offen offset:2048 sc1
    buffer_load_dwordx4 v[132:135], v9, s[24:27], s58 offen offset:3072 sc1
    s_waitcnt vmcnt(0)
    v_xor_b32 v13, v10, v123
    v_xor_b32 v11, v10, v127
    v_or_b32 v13, v13, v11
    v_xor_b32 v11, v10, v131
    v_or_b32 v13, v13, v11
    v_xor_b32 v11, v10, v135
    v_or_b32 v13, v13, v11
    v_xor_b32 v11, v10, v139
    v_or_b32 v13, v13, v11
    v_cmp_ne_u32 vcc, 0, v13
    s_nop 4
    s_cmp_eq_u64 vcc, 0
    s_cbranch_scc0 L_fm31
    v_max_f32 v11, v136, v116
    v_sub_f32 v16, v136, v11
    v_sub_f32 v17, v116, v11
    v_exp_f32 v16, v16
    v_exp_f32 v17, v17
    s_nop 0
    v_mul_f32 v12, v16, v137
    v_fmac_f32 v12, v17, v117
    v_rcp_f32 v12, v12
    s_add_u32 s58, s63, 1
    s_mul_i32 s58, s58, 1536
    v_mul_f32 v16, v16, v12
    v_mul_f32 v17, v17, v12
    v_mul_f32 v32, v120, v16
    v_fmac_f32 v32, v100, v17
    v_mul_f32 v33, v121, v16
    v_fmac_f32 v33, v101, v17
    v_mul_f32 v34, v122, v16
    v_fmac_f32 v34, v102, v17
    v_mul_f32 v35, v124, v16
    v_fmac_f32 v35, v104, v17
    v_mul_f32 v36, v125, v16
    v_fmac_f32 v36, v105, v17
    v_mul_f32 v37, v126, v16
    v_fmac_f32 v37, v106, v17
    v_mul_f32 v38, v128, v16
    v_fmac_f32 v38, v108, v17
    v_mul_f32 v39, v129, v16
    v_fmac_f32 v39, v109, v17
    v_mul_f32 v40, v130, v16
    v_fmac_f32 v40, v110, v17
    v_mul_f32 v41, v132, v16
    v_fmac_f32 v41, v112, v17
    v_mul_f32 v42, v133, v16
    v_fmac_f32 v42, v113, v17
    v_mul_f32 v43, v134, v16
    v_fmac_f32 v43, v114, v17
    v_cvt_pk_bf16_f32 v44, v32, v33
    v_cvt_pk_bf16_f32 v45, v34, v35
    v_cvt_pk_bf16_f32 v46, v36, v37
    v_cvt_pk_bf16_f32 v47, v38, v39
    v_cvt_pk_bf16_f32 v48, v40, v41
    v_cvt_pk_bf16_f32 v49, v42, v43
    buffer_store_dwordx2 v[44:45], v8, s[48:51], s58 offen offset:0
    buffer_store_dwordx2 v[46:47], v8, s[48:51], s58 offen offset:128
    buffer_store_dwordx2 v[48:49], v8, s[48:51], s58 offen offset:256
L_fm31:
L_fin:
L_end:
    s_endpgm
.section .rodata,"a"
.p2align 6
.amdhsa_kernel standalone__kv_cache_quant_int4_int2_kv_with_per_channel_or_per_token_scales__sampling_kernel
  .amdhsa_next_free_vgpr 224
  .amdhsa_next_free_sgpr 102
  .amdhsa_accum_offset 224
  .amdhsa_group_segment_fixed_size 0
  .amdhsa_kernarg_size 80
  .amdhsa_user_sgpr_count 2
  .amdhsa_user_sgpr_kernarg_segment_ptr 1
  .amdhsa_system_sgpr_workgroup_id_x 1
  .amdhsa_float_denorm_mode_32 3
.end_amdhsa_kernel
```

```asm
; @launch grid=(256,1,1) block=(448,1,1) lds=155136
.amdgcn_target "amdgcn-amd-amdhsa--gfx950"
.text
.globl standalone__kv_cache_quant_int4_int2_kv_with_per_channel_or_per_token_scales__sampling_kernel
.p2align 8
.type standalone__kv_cache_quant_int4_int2_kv_with_per_channel_or_per_token_scales__sampling_kernel,@function
standalone__kv_cache_quant_int4_int2_kv_with_per_channel_or_per_token_scales__sampling_kernel:
    s_cmp_ge_u32 s2, 256
    s_cbranch_scc1 L_end
    s_load_dwordx16 s[4:19], s[0:1], 0
    s_load_dwordx4 s[20:23], s[0:1], 64
    v_lshrrev_b32 v2, 6, v0
    v_and_b32 v1, 63, v0
    v_readfirstlane_b32 s56, v2
    s_mov_b32 s67, 768
    s_mul_i32 s100, s2, 43691
    s_lshr_b32 s100, s100, 17
    s_mul_i32 s101, s100, 3
    s_sub_u32 s101, s2, s101
    s_cmp_eq_u32 s2, 255
    s_cselect_b32 s73, 16, 11
    s_cmp_eq_u32 s101, 1
    s_cselect_b32 s3, 5, s73
    s_cselect_b32 s73, 10, s73
    s_mul_i32 s58, s101, 21
    s_add_u32 s58, s58, 1
    s_lshr_b32 s58, s58, 1
    s_lshl_b32 s59, s100, 5
    s_add_u32 s57, s58, s59
    s_mul_i32 s58, s101, 11
    s_lshr_b32 s58, s58, 1
    s_lshl_b32 s59, s100, 4
    s_add_u32 s58, s58, s59
    s_add_u32 s58, s58, 2736
    s_sub_u32 s58, s58, s73
    v_cmp_le_u32 vcc, s73, v1
    v_add_u32 v3, s57, v1
    v_add_u32 v4, s58, v1
    v_cndmask_b32 v152, v3, v4, vcc
    s_cmp_eq_u32 s56, 4
    s_cbranch_scc0 L_roles
    s_setprio 3
    v_add_u32 v17, 0, v1
    v_mul_u32_u24 v22, 1366, v17
    v_bfe_u32 v11, v22, 16, 1
    v_lshrrev_b32 v14, 17, v22
    v_mul_u32_u24 v22, 31488, v14
    v_lshl_add_u32 v17, v17, 4, v22
    v_mov_b32 v8, v17
    v_add_u32 v18, 64, v1
    v_mul_u32_u24 v22, 1366, v18
    v_bfe_u32 v12, v22, 16, 1
    v_lshrrev_b32 v15, 17, v22
    v_mul_u32_u24 v22, 31488, v15
    v_lshl_add_u32 v18, v18, 4, v22
    v_mov_b32 v9, v18
    v_add_u32 v19, 128, v1
    v_mul_u32_u24 v22, 1366, v19
    v_bfe_u32 v13, v22, 16, 1
    v_lshrrev_b32 v16, 17, v22
    v_mul_u32_u24 v22, 31488, v16
    v_lshl_add_u32 v19, v19, 4, v22
    v_mov_b32 v10, v19
    s_mov_b32 s68, 0
    s_mov_b32 m0, 0
    s_movk_i32 s71, 1024
    s_mul_i32 s57, s57, 196608
    s_mov_b32 s84, 0x400000
    s_mov_b32 s85, 0x800
    s_movk_i32 s86, 1536
    s_mov_b32 s70, 18
    s_mov_b32 s74, 0
    v_mov_b32 v20, 4710
    v_mov_b32 v21, 154880
    ds_write_b32 v21, v20
    s_waitcnt lgkmcnt(0)
    s_mov_b32 s24, s6
    s_and_b32 s25, s7, 0xffff
    s_mov_b32 s26, 805306368
    s_mov_b32 s27, 0x20000
L_lw16:
    s_waitcnt vmcnt(16)
L_lw17:
    s_waitcnt vmcnt(17)
L_lw18:
    s_waitcnt vmcnt(18)
L_lw19:
    s_waitcnt vmcnt(19)
L_lw20:
    s_waitcnt vmcnt(20)
    buffer_load_dwordx4 v17, s[24:27], s57 offen nt lds
    s_add_u32 m0, m0, s71
    s_add_u32 s68, s68, 1
    s_and_b32 s58, s68, 63
    s_cmp_ge_u32 s58, 43
    s_cselect_b32 s69, -768, 0
    buffer_load_dwordx4 v18, s[24:27], s57 offen nt lds
    s_add_u32 m0, m0, s71
    s_cmp_eq_u32 s58, 21
    s_cselect_b32 s62, 33024, 0
    v_mad_u32_u24 v17, v11, s62, v8
    s_bitcmp1_b64 s[84:85], s58
    s_cselect_b32 s63, 34560, s86
    buffer_load_dwordx4 v19, s[24:27], s57 offen nt lds
    s_add_u32 m0, m0, s71
    s_add_u32 s57, s57, s63
    v_mad_i32_i24 v22, v15, s69, v9
    v_mad_u32_u24 v18, v12, s62, v22
    v_mad_i32_i24 v22, v16, s69, v10
    v_mad_u32_u24 v19, v13, s62, v22
    s_and_b32 s59, s68, 7
    s_cbranch_scc0 L_lunit
L_lad:
    s_cmp_eq_u32 s70, 20
    s_cbranch_scc1 L_lw20
    s_cmp_eq_u32 s70, 19
    s_cbranch_scc1 L_lw19
    s_cmp_eq_u32 s70, 18
    s_cbranch_scc1 L_lw18
    s_cmp_eq_u32 s70, 17
    s_cbranch_scc1 L_lw17
    s_branch L_lw16
L_lunit:
    s_waitcnt vmcnt(24)
    s_cmp_le_u32 s68, 16
    s_cbranch_scc1 L_lfirst
L_lbar:
    s_barrier
L_lnobar:
    s_waitcnt lgkmcnt(0)
    v_readfirstlane_b32 s59, v20
    ds_read_b32 v20, v21
    s_cmp_eq_u32 m0, 73728
    s_cselect_b32 m0, 0, m0
    s_and_b32 s74, s74, 255
    s_add_u32 s74, s74, s59
    s_lshr_b32 s70, s74, 8
    s_cmp_eq_u32 s58, 0
    s_cbranch_scc1 L_lblock
L_lsel:
    s_cmp_le_u32 s70, 20
    s_cbranch_scc1 L_lad
    s_cmp_le_u32 s70, 21
    s_cbranch_scc1 L_lw21
    s_cmp_le_u32 s70, 22
    s_cbranch_scc1 L_lw22
    s_cmp_le_u32 s70, 23
    s_cbranch_scc1 L_lw23
    s_cmp_le_u32 s70, 24
    s_cbranch_scc1 L_lw24
    s_branch L_lw25
L_lblock:
    s_bfe_u32 s58, s68, 262150
    v_readlane_b32 s57, v152, s58
    s_nop 3
    s_mul_i32 s57, s57, 196608
    s_cmp_eq_u32 s58, 0
    s_cbranch_scc0 L_lsel
    s_cmp_eq_u32 s68, 2048
    s_cbranch_scc1 L_ldone
    s_mov_b32 s24, s8
    s_and_b32 s25, s9, 0xffff
    s_branch L_lsel
L_lfirst:
    s_cmp_eq_u32 s68, 8
    s_cbranch_scc1 L_lnobar
    s_barrier
    s_branch L_lbar
L_ldone:
    s_waitcnt vmcnt(0)
    s_barrier
    s_endpgm
L_lw21:
    s_waitcnt vmcnt(21)
    buffer_load_dwordx4 v17, s[24:27], s57 offen nt lds
    s_add_u32 m0, m0, s71
    s_add_u32 s68, s68, 1
    s_and_b32 s58, s68, 63
    s_cmp_ge_u32 s58, 43
    s_cselect_b32 s69, -768, 0
    buffer_load_dwordx4 v18, s[24:27], s57 offen nt lds
    s_add_u32 m0, m0, s71
    s_cmp_eq_u32 s58, 21
    s_cselect_b32 s62, 33024, 0
    v_mad_u32_u24 v17, v11, s62, v8
    s_bitcmp1_b64 s[84:85], s58
    s_cselect_b32 s63, 34560, s86
    buffer_load_dwordx4 v19, s[24:27], s57 offen nt lds
    s_add_u32 m0, m0, s71
    s_add_u32 s57, s57, s63
    v_mad_i32_i24 v22, v15, s69, v9
    v_mad_u32_u24 v18, v12, s62, v22
    v_mad_i32_i24 v22, v16, s69, v10
    v_mad_u32_u24 v19, v13, s62, v22
    s_and_b32 s59, s68, 7
    s_cbranch_scc1 L_lw21
    s_branch L_lunit
L_lw22:
    s_waitcnt vmcnt(22)
    buffer_load_dwordx4 v17, s[24:27], s57 offen nt lds
    s_add_u32 m0, m0, s71
    s_add_u32 s68, s68, 1
    s_and_b32 s58, s68, 63
    s_cmp_ge_u32 s58, 43
    s_cselect_b32 s69, -768, 0
    buffer_load_dwordx4 v18, s[24:27], s57 offen nt lds
    s_add_u32 m0, m0, s71
    s_cmp_eq_u32 s58, 21
    s_cselect_b32 s62, 33024, 0
    v_mad_u32_u24 v17, v11, s62, v8
    s_bitcmp1_b64 s[84:85], s58
    s_cselect_b32 s63, 34560, s86
    buffer_load_dwordx4 v19, s[24:27], s57 offen nt lds
    s_add_u32 m0, m0, s71
    s_add_u32 s57, s57, s63
    v_mad_i32_i24 v22, v15, s69, v9
    v_mad_u32_u24 v18, v12, s62, v22
    v_mad_i32_i24 v22, v16, s69, v10
    v_mad_u32_u24 v19, v13, s62, v22
    s_and_b32 s59, s68, 7
    s_cbranch_scc1 L_lw22
    s_branch L_lunit
L_lw23:
    s_waitcnt vmcnt(23)
    buffer_load_dwordx4 v17, s[24:27], s57 offen nt lds
    s_add_u32 m0, m0, s71
    s_add_u32 s68, s68, 1
    s_and_b32 s58, s68, 63
    s_cmp_ge_u32 s58, 43
    s_cselect_b32 s69, -768, 0
    buffer_load_dwordx4 v18, s[24:27], s57 offen nt lds
    s_add_u32 m0, m0, s71
    s_cmp_eq_u32 s58, 21
    s_cselect_b32 s62, 33024, 0
    v_mad_u32_u24 v17, v11, s62, v8
    s_bitcmp1_b64 s[84:85], s58
    s_cselect_b32 s63, 34560, s86
    buffer_load_dwordx4 v19, s[24:27], s57 offen nt lds
    s_add_u32 m0, m0, s71
    s_add_u32 s57, s57, s63
    v_mad_i32_i24 v22, v15, s69, v9
    v_mad_u32_u24 v18, v12, s62, v22
    v_mad_i32_i24 v22, v16, s69, v10
    v_mad_u32_u24 v19, v13, s62, v22
    s_and_b32 s59, s68, 7
    s_cbranch_scc1 L_lw23
    s_branch L_lunit
L_lw24:
    s_waitcnt vmcnt(24)
    buffer_load_dwordx4 v17, s[24:27], s57 offen nt lds
    s_add_u32 m0, m0, s71
    s_add_u32 s68, s68, 1
    s_and_b32 s58, s68, 63
    s_cmp_ge_u32 s58, 43
    s_cselect_b32 s69, -768, 0
    buffer_load_dwordx4 v18, s[24:27], s57 offen nt lds
    s_add_u32 m0, m0, s71
    s_cmp_eq_u32 s58, 21
    s_cselect_b32 s62, 33024, 0
    v_mad_u32_u24 v17, v11, s62, v8
    s_bitcmp1_b64 s[84:85], s58
    s_cselect_b32 s63, 34560, s86
    buffer_load_dwordx4 v19, s[24:27], s57 offen nt lds
    s_add_u32 m0, m0, s71
    s_add_u32 s57, s57, s63
    v_mad_i32_i24 v22, v15, s69, v9
    v_mad_u32_u24 v18, v12, s62, v22
    v_mad_i32_i24 v22, v16, s69, v10
    v_mad_u32_u24 v19, v13, s62, v22
    s_and_b32 s59, s68, 7
    s_cbranch_scc1 L_lw24
    s_branch L_lunit
L_lw25:
    s_waitcnt vmcnt(25)
    buffer_load_dwordx4 v17, s[24:27], s57 offen nt lds
    s_add_u32 m0, m0, s71
    s_add_u32 s68, s68, 1
    s_and_b32 s58, s68, 63
    s_cmp_ge_u32 s58, 43
    s_cselect_b32 s69, -768, 0
    buffer_load_dwordx4 v18, s[24:27], s57 offen nt lds
    s_add_u32 m0, m0, s71
    s_cmp_eq_u32 s58, 21
    s_cselect_b32 s62, 33024, 0
    v_mad_u32_u24 v17, v11, s62, v8
    s_bitcmp1_b64 s[84:85], s58
    s_cselect_b32 s63, 34560, s86
    buffer_load_dwordx4 v19, s[24:27], s57 offen nt lds
    s_add_u32 m0, m0, s71
    s_add_u32 s57, s57, s63
    v_mad_i32_i24 v22, v15, s69, v9
    v_mad_u32_u24 v18, v12, s62, v22
    v_mad_i32_i24 v22, v16, s69, v10
    v_mad_u32_u24 v19, v13, s62, v22
    s_and_b32 s59, s68, 7
    s_cbranch_scc1 L_lw25
    s_branch L_lunit
L_roles:
    s_cmp_lt_u32 s56, 4
    s_cbranch_scc1 L_consumer
    s_cmp_eq_u32 s56, 5
    s_cbranch_scc1 L_finisher
    s_sub_u32 s58, s2, 16
    s_cmp_lt_u32 s58, 8
    s_cbranch_scc0 L_pw
    s_getpc_b64 s[44:45]
L_pc:
    s_and_b32 s45, s45, 0xffff
    s_mov_b32 s46, L_end - L_pc
    s_mov_b32 s47, 0x20000
    v_lshlrev_b32 v9, 7, v1
    s_movk_i32 s58, 0
    buffer_load_dword v12, v9, s[44:47], s58 offen
    s_movk_i32 s58, 8192
    buffer_load_dword v13, v9, s[44:47], s58 offen
    s_movk_i32 s58, 16384
    buffer_load_dword v14, v9, s[44:47], s58 offen
    s_movk_i32 s58, 24576
    buffer_load_dword v15, v9, s[44:47], s58 offen
L_pw:
    s_waitcnt lgkmcnt(0)
    s_mov_b32 s52, s22
    s_and_b32 s53, s23, 0xffff
    s_mov_b32 s54, 16793888
    s_mov_b32 s55, 0x20000
    s_mov_b32 s71, 0
    s_add_u32 s98, s22, 16777216
    s_addc_u32 s99, s23, 0
    s_min_u32 s58, s2, 16
    s_lshr_b32 s61, 0x926d, s58
    s_and_b32 s61, s61, 1
    s_and_b32 s59, s2, 7
    s_mul_i32 s59, s59, 4
    s_add_u32 s59, s59, 16777216
    v_mov_b32 v8, s59
    v_mov_b32 v10, 154880
    s_memtime s[28:29]
    s_memrealtime s[96:97]
    s_mov_b32 s32, 0
    s_mov_b64 exec, 1
    s_waitcnt lgkmcnt(0)
    s_barrier
    s_mov_b32 s63, 0
L_pace:
    s_barrier
    s_mov_b32 s62, s96
    s_mov_b32 s30, s28
    s_memtime s[28:29]
    s_memrealtime s[96:97]
    s_waitcnt lgkmcnt(0)
    s_sub_u32 s58, s96, s62
    s_mul_i32 s58, s58, 373
    s_sub_u32 s59, s28, s30
    s_lshl_b32 s59, s59, 4
    s_sub_i32 s58, s58, s59
    s_mul_i32 s58, s58, 60
    s_ashr_i32 s31, s58, 12
    s_cmp_eq_u32 s63, 0
    s_cbranch_scc1 L_pnext
    s_mov_b32 s58, 0
    s_sub_i32 s59, s84, s62
    s_add_i32 s60, s59, 5000
    s_cmp_lt_u32 s60, 10000
    s_cselect_b32 s59, s59, 200
    s_add_i32 s58, s58, s59
    s_sub_i32 s59, s85, s62
    s_add_i32 s60, s59, 5000
    s_cmp_lt_u32 s60, 10000
    s_cselect_b32 s59, s59, 200
    s_add_i32 s58, s58, s59
    s_sub_i32 s59, s86, s62
    s_add_i32 s60, s59, 5000
    s_cmp_lt_u32 s60, 10000
    s_cselect_b32 s59, s59, 200
    s_add_i32 s58, s58, s59
    s_sub_i32 s59, s87, s62
    s_add_i32 s60, s59, 5000
    s_cmp_lt_u32 s60, 10000
    s_cselect_b32 s59, s59, 200
    s_add_i32 s58, s58, s59
    s_sub_i32 s59, s88, s62
    s_add_i32 s60, s59, 5000
    s_cmp_lt_u32 s60, 10000
    s_cselect_b32 s59, s59, 200
    s_add_i32 s58, s58, s59
    s_sub_i32 s59, s89, s62
    s_add_i32 s60, s59, 5000
    s_cmp_lt_u32 s60, 10000
    s_cselect_b32 s59, s59, 200
    s_add_i32 s58, s58, s59
    s_sub_i32 s59, s90, s62
    s_add_i32 s60, s59, 5000
    s_cmp_lt_u32 s60, 10000
    s_cselect_b32 s59, s59, 200
    s_add_i32 s58, s58, s59
    s_sub_i32 s59, s91, s62
    s_add_i32 s60, s59, 5000
    s_cmp_lt_u32 s60, 10000
    s_cselect_b32 s59, s59, 200
    s_add_i32 s58, s58, s59
    s_min_u32 s59, s63, 12
    s_cmp_gt_i32 s58, 0
    s_cselect_b32 s63, s59, s63
    s_mul_i32 s58, s58, s63
    s_ashr_i32 s58, s58, 5
    s_mov_b32 s32, s58
L_pnext:
    s_sub_i32 s58, s31, s32
    s_add_i32 s58, s58, 4710
    s_max_i32 s58, s58, 4096
    s_min_i32 s70, s58, 6400
    v_mov_b32 v9, s70
    ds_write_b32 v10, v9
    s_and_b32 s58, s71, 768
    s_cselect_b32 s63, 0, 5
    s_cmp_ge_u32 s71, 14848
    s_cselect_b32 s63, 24, s63
    s_mul_i32 s58, s63, s61
    s_cmp_eq_u32 s58, 0
    s_cbranch_scc1 L_pnorep
    v_mov_b32 v11, s96
    buffer_store_dword v11, v8, s[52:55], s71 offen sc1
L_pnorep:
    s_barrier
    s_barrier
    s_barrier
    s_cmp_eq_u32 s63, 0
    s_cbranch_scc1 L_pnold
    s_load_dwordx8 s[84:91], s[98:99], s71
L_pnold:
    s_add_u32 s71, s71, 256
    s_cmp_lt_u32 s71, 16384
    s_cbranch_scc1 L_pace
    s_waitcnt lgkmcnt(0)
    s_mov_b64 exec, -1
    s_endpgm
L_consumer:
    v_lshrrev_b32 v3, 2, v1
    v_lshlrev_b32 v3, 3, v3
    v_and_b32 v4, 3, v1
    v_mul_u32_u24 v5, 384, v4
    v_add_u32 v15, v3, v5
    v_lshlrev_b32 v13, 4, v1
    s_mul_i32 s63, s56, 3072
    s_add_u32 s63, s63, 76800
    s_add_u32 s58, s56, 0
    v_readlane_b32 s84, v152, s58
    s_add_u32 s58, s56, 4
    v_readlane_b32 s85, v152, s58
    s_add_u32 s58, s56, 8
    v_readlane_b32 s86, v152, s58
    s_add_u32 s58, s56, 12
    v_readlane_b32 s87, v152, s58
    v_readlane_b32 s88, v152, 0
    s_min_u32 s58, s3, 15
    v_readlane_b32 s89, v152, s58
    v_readlane_b32 s90, v152, 15
    s_waitcnt lgkmcnt(0)
    s_mov_b32 s32, s12
    s_and_b32 s33, s13, 0xffff
    s_mov_b32 s34, 6291456
    s_mov_b32 s35, 0x20000
    s_mov_b32 s28, s10
    s_and_b32 s29, s11, 0xffff
    s_mov_b32 s30, 6291456
    s_mov_b32 s31, 0x20000
    s_mov_b32 exec_hi, 0xffff
    s_add_u32 m0, s63, 0
    s_mul_i32 s58, s84, 1536
    buffer_load_dwordx4 v13, s[32:35], s58 offen nt lds
    buffer_load_dwordx4 v13, s[32:35], s58 offen offset:768 nt lds
    s_add_u32 m0, m0, 1536
    s_nop 0
    buffer_load_dwordx4 v13, s[28:31], s58 offen nt lds
    buffer_load_dwordx4 v13, s[28:31], s58 offen offset:768 nt lds
    s_mov_b32 exec_hi, -1
    s_mov_b32 s44, s4
    s_and_b32 s45, s5, 0xffff
    s_mov_b32 s46, 393216
    s_mov_b32 s47, 0x20000
    s_lshr_b32 s58, s88, 4
    s_mul_i32 s58, s58, 1536
    buffer_load_dwordx2 v[160:161], v15, s[44:47], s58 offen offset:0 nt
    buffer_load_dwordx2 v[162:163], v15, s[44:47], s58 offen offset:128 nt
    buffer_load_dwordx2 v[164:165], v15, s[44:47], s58 offen offset:256 nt
    s_mov_b32 s64, 0x3fb8aa3b
    s_mov_b32 s65, 0x3d93cd3a
    s_mov_b32 s66, 0xffff0000
    v_bfe_u32 v36, v1, 2, 1
    v_lshl_add_u32 v36, v2, 2, v36
    v_bfe_u32 v37, v1, 3, 1
    v_lshrrev_b32 v38, 4, v1
    v_lshl_add_u32 v38, v38, 2, v4
    v_lshlrev_b32 v38, 3, v38
    v_add_u32 v38, 73728, v38
    s_movk_i32 s58, 384
    v_add_u32 v3, 0, v36
    v_cmp_le_u32 vcc, 43, v3
    v_add_u32 v5, 43, v3
    v_mov_b32 v6, 42
    v_cndmask_b32 v17, v3, v5, vcc
    v_cmp_le_u32 vcc, 86, v3
    v_add_u32 v5, 43, v17
    s_nop 0
    v_cndmask_b32 v17, v17, v5, vcc
    v_cndmask_b32 v6, 43, v6, vcc
    v_mad_u32_u24 v17, v6, v37, v17
    v_lshrrev_b32 v17, 6, v17
    v_mad_u32_u24 v17, v17, s58, v38
    v_add_u32 v3, 2, v36
    v_cmp_le_u32 vcc, 43, v3
    v_add_u32 v5, 43, v3
    v_mov_b32 v6, 42
    v_cndmask_b32 v18, v3, v5, vcc
    v_cmp_le_u32 vcc, 86, v3
    v_add_u32 v5, 43, v18
    s_nop 0
    v_cndmask_b32 v18, v18, v5, vcc
    v_cndmask_b32 v6, 43, v6, vcc
    v_mad_u32_u24 v18, v6, v37, v18
    v_lshrrev_b32 v18, 6, v18
    v_mad_u32_u24 v18, v18, s58, v38
    v_add_u32 v3, 16, v36
    v_cmp_le_u32 vcc, 43, v3
    v_add_u32 v5, 43, v3
    v_mov_b32 v6, 42
    v_cndmask_b32 v19, v3, v5, vcc
    v_cmp_le_u32 vcc, 86, v3
    v_add_u32 v5, 43, v19
    s_nop 0
    v_cndmask_b32 v19, v19, v5, vcc
    v_cndmask_b32 v6, 43, v6, vcc
    v_mad_u32_u24 v19, v6, v37, v19
    v_lshrrev_b32 v19, 6, v19
    v_mad_u32_u24 v19, v19, s58, v38
    v_add_u32 v3, 18, v36
    v_cmp_le_u32 vcc, 43, v3
    v_add_u32 v5, 43, v3
    v_mov_b32 v6, 42
    v_cndmask_b32 v20, v3, v5, vcc
    v_cmp_le_u32 vcc, 86, v3
    v_add_u32 v5, 43, v20
    s_nop 0
    v_cndmask_b32 v20, v20, v5, vcc
    v_cndmask_b32 v6, 43, v6, vcc
    v_mad_u32_u24 v20, v6, v37, v20
    v_lshrrev_b32 v20, 6, v20
    v_mad_u32_u24 v20, v20, s58, v38
    v_add_u32 v3, 32, v36
    v_cmp_le_u32 vcc, 43, v3
    v_add_u32 v5, 43, v3
    v_mov_b32 v6, 42
    v_cndmask_b32 v21, v3, v5, vcc
    v_cmp_le_u32 vcc, 86, v3
    v_add_u32 v5, 43, v21
    s_nop 0
    v_cndmask_b32 v21, v21, v5, vcc
    v_cndmask_b32 v6, 43, v6, vcc
    v_mad_u32_u24 v21, v6, v37, v21
    v_lshrrev_b32 v21, 6, v21
    v_mad_u32_u24 v21, v21, s58, v38
    v_add_u32 v3, 34, v36
    v_cmp_le_u32 vcc, 43, v3
    v_add_u32 v5, 43, v3
    v_mov_b32 v6, 42
    v_cndmask_b32 v22, v3, v5, vcc
    v_cmp_le_u32 vcc, 86, v3
    v_add_u32 v5, 43, v22
    s_nop 0
    v_cndmask_b32 v22, v22, v5, vcc
    v_cndmask_b32 v6, 43, v6, vcc
    v_mad_u32_u24 v22, v6, v37, v22
    v_lshrrev_b32 v22, 6, v22
    v_mad_u32_u24 v22, v22, s58, v38
    v_add_u32 v3, 48, v36
    v_cmp_le_u32 vcc, 43, v3
    v_add_u32 v5, 43, v3
    v_mov_b32 v6, 42
    v_cndmask_b32 v23, v3, v5, vcc
    v_cmp_le_u32 vcc, 86, v3
    v_add_u32 v5, 43, v23
    s_nop 0
    v_cndmask_b32 v23, v23, v5, vcc
    v_cndmask_b32 v6, 43, v6, vcc
    v_mad_u32_u24 v23, v6, v37, v23
    v_lshrrev_b32 v23, 6, v23
    v_mad_u32_u24 v23, v23, s58, v38
    v_add_u32 v3, 50, v36
    v_cmp_le_u32 vcc, 43, v3
    v_add_u32 v5, 43, v3
    v_mov_b32 v6, 42
    v_cndmask_b32 v24, v3, v5, vcc
    v_cmp_le_u32 vcc, 86, v3
    v_add_u32 v5, 43, v24
    s_nop 0
    v_cndmask_b32 v24, v24, v5, vcc
    v_cndmask_b32 v6, 43, v6, vcc
    v_mad_u32_u24 v24, v6, v37, v24
    v_lshrrev_b32 v24, 6, v24
    v_mad_u32_u24 v24, v24, s58, v38
    v_add_u32 v3, 64, v36
    v_cmp_le_u32 vcc, 43, v3
    v_add_u32 v5, 43, v3
    v_mov_b32 v6, 42
    v_cndmask_b32 v25, v3, v5, vcc
    v_cmp_le_u32 vcc, 86, v3
    v_add_u32 v5, 43, v25
    s_nop 0
    v_cndmask_b32 v25, v25, v5, vcc
    v_cndmask_b32 v6, 43, v6, vcc
    v_mad_u32_u24 v25, v6, v37, v25
    v_lshrrev_b32 v25, 6, v25
    v_mad_u32_u24 v25, v25, s58, v38
    v_add_u32 v3, 66, v36
    v_cmp_le_u32 vcc, 43, v3
    v_add_u32 v5, 43, v3
    v_mov_b32 v6, 42
    v_cndmask_b32 v26, v3, v5, vcc
    v_cmp_le_u32 vcc, 86, v3
    v_add_u32 v5, 43, v26
    s_nop 0
    v_cndmask_b32 v26, v26, v5, vcc
    v_cndmask_b32 v6, 43, v6, vcc
    v_mad_u32_u24 v26, v6, v37, v26
    v_lshrrev_b32 v26, 6, v26
    v_mad_u32_u24 v26, v26, s58, v38
    v_add_u32 v3, 80, v36
    v_cmp_le_u32 vcc, 43, v3
    v_add_u32 v5, 43, v3
    v_mov_b32 v6, 42
    v_cndmask_b32 v27, v3, v5, vcc
    v_cmp_le_u32 vcc, 86, v3
    v_add_u32 v5, 43, v27
    s_nop 0
    v_cndmask_b32 v27, v27, v5, vcc
    v_cndmask_b32 v6, 43, v6, vcc
    v_mad_u32_u24 v27, v6, v37, v27
    v_lshrrev_b32 v27, 6, v27
    v_mad_u32_u24 v27, v27, s58, v38
    v_add_u32 v3, 82, v36
    v_cmp_le_u32 vcc, 43, v3
    v_add_u32 v5, 43, v3
    v_mov_b32 v6, 42
    v_cndmask_b32 v28, v3, v5, vcc
    v_cmp_le_u32 vcc, 86, v3
    v_add_u32 v5, 43, v28
    s_nop 0
    v_cndmask_b32 v28, v28, v5, vcc
    v_cndmask_b32 v6, 43, v6, vcc
    v_mad_u32_u24 v28, v6, v37, v28
    v_lshrrev_b32 v28, 6, v28
    v_mad_u32_u24 v28, v28, s58, v38
    v_add_u32 v3, 96, v36
    v_cmp_le_u32 vcc, 43, v3
    v_add_u32 v5, 43, v3
    v_mov_b32 v6, 42
    v_cndmask_b32 v29, v3, v5, vcc
    v_cmp_le_u32 vcc, 86, v3
    v_add_u32 v5, 43, v29
    s_nop 0
    v_cndmask_b32 v29, v29, v5, vcc
    v_cndmask_b32 v6, 43, v6, vcc
    v_mad_u32_u24 v29, v6, v37, v29
    v_lshrrev_b32 v29, 6, v29
    v_mad_u32_u24 v29, v29, s58, v38
    v_add_u32 v3, 98, v36
    v_cmp_le_u32 vcc, 43, v3
    v_add_u32 v5, 43, v3
    v_mov_b32 v6, 42
    v_cndmask_b32 v30, v3, v5, vcc
    v_cmp_le_u32 vcc, 86, v3
    v_add_u32 v5, 43, v30
    s_nop 0
    v_cndmask_b32 v30, v30, v5, vcc
    v_cndmask_b32 v6, 43, v6, vcc
    v_mad_u32_u24 v30, v6, v37, v30
    v_lshrrev_b32 v30, 6, v30
    v_mad_u32_u24 v30, v30, s58, v38
    v_add_u32 v3, 112, v36
    v_cmp_le_u32 vcc, 43, v3
    v_add_u32 v5, 43, v3
    v_mov_b32 v6, 42
    v_cndmask_b32 v31, v3, v5, vcc
    v_cmp_le_u32 vcc, 86, v3
    v_add_u32 v5, 43, v31
    s_nop 0
    v_cndmask_b32 v31, v31, v5, vcc
    v_cndmask_b32 v6, 43, v6, vcc
    v_mad_u32_u24 v31, v6, v37, v31
    v_lshrrev_b32 v31, 6, v31
    v_mad_u32_u24 v31, v31, s58, v38
    v_add_u32 v3, 114, v36
    v_cmp_le_u32 vcc, 43, v3
    v_add_u32 v5, 43, v3
    v_mov_b32 v6, 42
    v_cndmask_b32 v32, v3, v5, vcc
    v_cmp_le_u32 vcc, 86, v3
    v_add_u32 v5, 43, v32
    s_nop 0
    v_cndmask_b32 v32, v32, v5, vcc
    v_cndmask_b32 v6, 43, v6, vcc
    v_mad_u32_u24 v32, v6, v37, v32
    v_lshrrev_b32 v32, 6, v32
    v_mad_u32_u24 v32, v32, s58, v38
    v_bfe_u32 v36, v1, 4, 1
    v_lshl_add_u32 v36, v2, 2, v36
    v_bfe_u32 v3, v1, 2, 2
    v_lshl_add_u32 v36, v3, 4, v36
    v_lshrrev_b32 v37, 5, v1
    s_mov_b32 s58, 125952
    v_add_u32 v3, 0, v36
    v_cmp_le_u32 vcc, 43, v3
    v_add_u32 v5, 43, v3
    v_mov_b32 v6, 42
    v_cndmask_b32 v7, v3, v5, vcc
    v_cmp_le_u32 vcc, 86, v3
    v_add_u32 v5, 43, v7
    s_nop 0
    v_cndmask_b32 v7, v7, v5, vcc
    v_cndmask_b32 v6, 43, v6, vcc
    v_mad_u32_u24 v7, v6, v37, v7
    v_lshl_add_u32 v7, v7, 1, s58
    v_add_u32 v3, 2, v36
    v_cmp_le_u32 vcc, 43, v3
    v_add_u32 v5, 43, v3
    v_mov_b32 v6, 42
    v_cndmask_b32 v8, v3, v5, vcc
    v_cmp_le_u32 vcc, 86, v3
    v_add_u32 v5, 43, v8
    s_nop 0
    v_cndmask_b32 v8, v8, v5, vcc
    v_cndmask_b32 v6, 43, v6, vcc
    v_mad_u32_u24 v8, v6, v37, v8
    v_lshl_add_u32 v8, v8, 1, s58
    v_add_u32 v3, 64, v36
    v_cmp_le_u32 vcc, 43, v3
    v_add_u32 v5, 43, v3
    v_mov_b32 v6, 42
    v_cndmask_b32 v9, v3, v5, vcc
    v_cmp_le_u32 vcc, 86, v3
    v_add_u32 v5, 43, v9
    s_nop 0
    v_cndmask_b32 v9, v9, v5, vcc
    v_cndmask_b32 v6, 43, v6, vcc
    v_mad_u32_u24 v9, v6, v37, v9
    v_lshl_add_u32 v9, v9, 1, s58
    v_add_u32 v3, 66, v36
    v_cmp_le_u32 vcc, 43, v3
    v_add_u32 v5, 43, v3
    v_mov_b32 v6, 42
    v_cndmask_b32 v10, v3, v5, vcc
    v_cmp_le_u32 vcc, 86, v3
    v_add_u32 v5, 43, v10
    s_nop 0
    v_cndmask_b32 v10, v10, v5, vcc
    v_cndmask_b32 v6, 43, v6, vcc
    v_mad_u32_u24 v10, v6, v37, v10
    v_lshl_add_u32 v10, v10, 1, s58
    v_lshlrev_b32 v11, 2, v1
    v_lshl_add_u32 v11, v2, 9, v11
    v_add_u32 v11, 73728, v11
    v_bfe_u32 v3, v1, 2, 2
    v_lshrrev_b32 v4, 4, v1
    v_and_b32 v5, 3, v1
    v_lshl_add_u32 v4, v4, 2, v5
    v_lshl_add_u32 v3, v2, 3, v3
    v_mul_u32_u24 v3, 768, v3
    v_lshl_add_u32 v12, v4, 4, v3
    v_and_b32 v3, 3, v1
    v_lshl_add_u32 v153, v3, 2, v2
    v_lshlrev_b32 v153, 2, v153
    v_add_u32 v153, 154944, v153
    v_mov_b32 v14, 0xff800000
    s_mov_b32 exec_hi, 0xffff
    s_add_u32 m0, s63, 12288
    s_mul_i32 s58, s85, 1536
    buffer_load_dwordx4 v13, s[32:35], s58 offen nt lds
    buffer_load_dwordx4 v13, s[32:35], s58 offen offset:768 nt lds
    s_add_u32 m0, m0, 1536
    s_nop 0
    buffer_load_dwordx4 v13, s[28:31], s58 offen nt lds
    buffer_load_dwordx4 v13, s[28:31], s58 offen offset:768 nt lds
    s_add_u32 m0, s63, 24576
    s_mul_i32 s58, s86, 1536
    buffer_load_dwordx4 v13, s[32:35], s58 offen nt lds
    buffer_load_dwordx4 v13, s[32:35], s58 offen offset:768 nt lds
    s_add_u32 m0, m0, 1536
    s_nop 0
    buffer_load_dwordx4 v13, s[28:31], s58 offen nt lds
    buffer_load_dwordx4 v13, s[28:31], s58 offen offset:768 nt lds
    s_add_u32 m0, s63, 36864
    s_mul_i32 s58, s87, 1536
    buffer_load_dwordx4 v13, s[32:35], s58 offen nt lds
    buffer_load_dwordx4 v13, s[32:35], s58 offen offset:768 nt lds
    s_add_u32 m0, m0, 1536
    s_nop 0
    buffer_load_dwordx4 v13, s[28:31], s58 offen nt lds
    buffer_load_dwordx4 v13, s[28:31], s58 offen offset:768 nt lds
    s_mov_b32 exec_hi, -1
    s_mov_b32 s36, s14
    s_and_b32 s37, s15, 0xffff
    s_mov_b32 s38, 2097152
    s_mov_b32 s39, 0x20000
    s_mov_b32 s40, s16
    s_and_b32 s41, s17, 0xffff
    s_mov_b32 s42, 2097152
    s_mov_b32 s43, 0x20000
    s_mov_b32 exec_hi, 0
    s_lshl_b32 s60, s56, 10
    s_add_u32 m0, s60, 125952
    s_lshl_b32 s58, s84, 9
    buffer_load_dwordx4 v13, s[36:39], s58 offen nt lds
    s_add_u32 m0, m0, 512
    s_nop 0
    buffer_load_dwordx4 v13, s[40:43], s58 offen nt lds
    s_add_u32 m0, s60, 130048
    s_lshl_b32 s58, s85, 9
    buffer_load_dwordx4 v13, s[36:39], s58 offen nt lds
    s_add_u32 m0, m0, 512
    s_nop 0
    buffer_load_dwordx4 v13, s[40:43], s58 offen nt lds
    s_add_u32 m0, s60, 134144
    s_lshl_b32 s58, s86, 9
    buffer_load_dwordx4 v13, s[36:39], s58 offen nt lds
    s_add_u32 m0, m0, 512
    s_nop 0
    buffer_load_dwordx4 v13, s[40:43], s58 offen nt lds
    s_add_u32 m0, s60, 138240
    s_lshl_b32 s58, s87, 9
    buffer_load_dwordx4 v13, s[36:39], s58 offen nt lds
    s_add_u32 m0, m0, 512
    s_nop 0
    buffer_load_dwordx4 v13, s[40:43], s58 offen nt lds
    s_mov_b32 exec_hi, -1
    s_lshr_b32 s58, s89, 4
    s_mul_i32 s58, s58, 1536
    buffer_load_dwordx2 v[166:167], v15, s[44:47], s58 offen offset:0 nt
    buffer_load_dwordx2 v[168:169], v15, s[44:47], s58 offen offset:128 nt
    buffer_load_dwordx2 v[170:171], v15, s[44:47], s58 offen offset:256 nt
    s_lshr_b32 s58, s90, 4
    s_mul_i32 s58, s58, 1536
    buffer_load_dwordx2 v[172:173], v15, s[44:47], s58 offen offset:0 nt
    buffer_load_dwordx2 v[174:175], v15, s[44:47], s58 offen offset:128 nt
    buffer_load_dwordx2 v[176:177], v15, s[44:47], s58 offen offset:256 nt
    s_mov_b32 s61, 0
    s_mov_b32 s62, 0
    s_movk_i32 s63, 3072
    s_waitcnt vmcnt(26)
    s_barrier
    v_add_u32 v33, s63, v17
    v_add_u32 v34, s63, v18
    ds_read_b64 v[108:109], v33 offset:0
    ds_read_b64 v[110:111], v33 offset:1536
    ds_read_b64 v[112:113], v33 offset:128
    ds_read_b64 v[114:115], v33 offset:1664
    ds_read_b64 v[116:117], v33 offset:256
    ds_read_b64 v[118:119], v33 offset:1792
    ds_read_b64 v[120:121], v34 offset:0
    ds_read_b64 v[122:123], v34 offset:1536
    ds_read_b64 v[124:125], v34 offset:128
    ds_read_b64 v[126:127], v34 offset:1664
    ds_read_b64 v[128:129], v34 offset:256
    ds_read_b64 v[130:131], v34 offset:1792
    s_waitcnt lgkmcnt(0)
    v_lshlrev_b32 v60, 16, v108
    v_and_b32 v61, s66, v108
    v_lshlrev_b32 v62, 16, v109
    v_and_b32 v63, s66, v109
    v_lshlrev_b32 v84, 16, v110
    v_and_b32 v85, s66, v110
    v_lshlrev_b32 v86, 16, v111
    v_and_b32 v87, s66, v111
    v_lshlrev_b32 v64, 16, v112
    v_and_b32 v65, s66, v112
    v_lshlrev_b32 v66, 16, v113
    v_and_b32 v67, s66, v113
    v_lshlrev_b32 v88, 16, v114
    v_and_b32 v89, s66, v114
    v_lshlrev_b32 v90, 16, v115
    v_and_b32 v91, s66, v115
    v_lshlrev_b32 v68, 16, v116
    v_and_b32 v69, s66, v116
    v_lshlrev_b32 v70, 16, v117
    v_and_b32 v71, s66, v117
    v_lshlrev_b32 v92, 16, v118
    v_and_b32 v93, s66, v118
    v_lshlrev_b32 v94, 16, v119
    v_and_b32 v95, s66, v119
    v_lshlrev_b32 v72, 16, v120
    v_and_b32 v73, s66, v120
    v_lshlrev_b32 v74, 16, v121
    v_and_b32 v75, s66, v121
    v_lshlrev_b32 v96, 16, v122
    v_and_b32 v97, s66, v122
    v_lshlrev_b32 v98, 16, v123
    v_and_b32 v99, s66, v123
    v_lshlrev_b32 v76, 16, v124
    v_and_b32 v77, s66, v124
    v_lshlrev_b32 v78, 16, v125
    v_and_b32 v79, s66, v125
    v_lshlrev_b32 v100, 16, v126
    v_and_b32 v101, s66, v126
    v_lshlrev_b32 v102, 16, v127
    v_and_b32 v103, s66, v127
    v_lshlrev_b32 v80, 16, v128
    v_and_b32 v81, s66, v128
    v_lshlrev_b32 v82, 16, v129
    v_and_b32 v83, s66, v129
    v_lshlrev_b32 v104, 16, v130
    v_and_b32 v105, s66, v130
    v_lshlrev_b32 v106, 16, v131
    v_and_b32 v107, s66, v131
L_kblk:
    v_add_u32 v13, s62, v12
    s_add_u32 s62, s62, 24576
    s_cmp_eq_u32 s62, 73728
    s_cselect_b32 s62, 0, s62
    s_barrier
    ds_read_b128 v[36:39], v13 offset:0
    ds_read_b128 v[40:43], v13 offset:256
    ds_read_b128 v[44:47], v13 offset:512
    ds_read_b128 v[48:51], v13 offset:3072
    ds_read_b128 v[52:55], v13 offset:3328
    ds_read_b128 v[56:59], v13 offset:3584
    s_waitcnt lgkmcnt(3)
    v_cvt_f32_i32 v36, v36
    v_cvt_f32_i32 v37, v37
    v_cvt_f32_i32 v38, v38
    v_cvt_f32_i32 v39, v39
    v_cvt_f32_i32 v40, v40
    v_cvt_f32_i32 v41, v41
    v_cvt_f32_i32 v42, v42
    v_cvt_f32_i32 v43, v43
    v_cvt_f32_i32 v44, v44
    v_cvt_f32_i32 v45, v45
    v_cvt_f32_i32 v46, v46
    v_cvt_f32_i32 v47, v47
    v_sub_f32 v36, v36, v60
    v_sub_f32 v37, v37, v61
    v_sub_f32 v38, v38, v62
    v_sub_f32 v39, v39, v63
    v_sub_f32 v40, v40, v64
    v_sub_f32 v41, v41, v65
    v_sub_f32 v42, v42, v66
    v_sub_f32 v43, v43, v67
    v_sub_f32 v44, v44, v68
    v_sub_f32 v45, v45, v69
    v_sub_f32 v46, v46, v70
    v_sub_f32 v47, v47, v71
    v_cvt_pk_bf16_f32 v36, 0, v36
    v_cvt_pk_bf16_f32 v37, 0, v37
    v_cvt_pk_bf16_f32 v38, 0, v38
    v_cvt_pk_bf16_f32 v39, 0, v39
    v_cvt_pk_bf16_f32 v40, 0, v40
    v_cvt_pk_bf16_f32 v41, 0, v41
    v_cvt_pk_bf16_f32 v42, 0, v42
    v_cvt_pk_bf16_f32 v43, 0, v43
    v_cvt_pk_bf16_f32 v44, 0, v44
    v_cvt_pk_bf16_f32 v45, 0, v45
    v_cvt_pk_bf16_f32 v46, 0, v46
    v_cvt_pk_bf16_f32 v47, 0, v47
    v_mul_f32 v36, v36, v84
    v_mul_f32 v37, v37, v85
    v_mul_f32 v38, v38, v86
    v_mul_f32 v39, v39, v87
    v_mul_f32 v40, v40, v88
    v_mul_f32 v41, v41, v89
    v_mul_f32 v42, v42, v90
    v_mul_f32 v43, v43, v91
    v_mul_f32 v44, v44, v92
    v_mul_f32 v45, v45, v93
    v_mul_f32 v46, v46, v94
    v_mul_f32 v47, v47, v95
    v_cvt_pk_bf16_f32 v132, v36, v37
    v_cvt_pk_bf16_f32 v133, v38, v39
    v_cvt_pk_bf16_f32 v134, v40, v41
    v_cvt_pk_bf16_f32 v135, v42, v43
    v_cvt_pk_bf16_f32 v136, v44, v45
    v_cvt_pk_bf16_f32 v137, v46, v47
    v_mfma_f32_16x16x16_bf16 v[144:147], v[132:133], v[160:161], 0
    v_mfma_f32_16x16x16_bf16 v[144:147], v[134:135], v[162:163], v[144:147]
    v_mfma_f32_16x16x16_bf16 v[144:147], v[136:137], v[164:165], v[144:147]
    s_waitcnt lgkmcnt(0)
    v_cvt_f32_i32 v48, v48
    v_cvt_f32_i32 v49, v49
    v_cvt_f32_i32 v50, v50
    v_cvt_f32_i32 v51, v51
    v_cvt_f32_i32 v52, v52
    v_cvt_f32_i32 v53, v53
    v_cvt_f32_i32 v54, v54
    v_cvt_f32_i32 v55, v55
    v_cvt_f32_i32 v56, v56
    v_cvt_f32_i32 v57, v57
    v_cvt_f32_i32 v58, v58
    v_cvt_f32_i32 v59, v59
    v_sub_f32 v48, v48, v72
    v_sub_f32 v49, v49, v73
    v_sub_f32 v50, v50, v74
    v_sub_f32 v51, v51, v75
    v_sub_f32 v52, v52, v76
    v_sub_f32 v53, v53, v77
    v_sub_f32 v54, v54, v78
    v_sub_f32 v55, v55, v79
    v_sub_f32 v56, v56, v80
    v_sub_f32 v57, v57, v81
    v_sub_f32 v58, v58, v82
    v_sub_f32 v59, v59, v83
    v_cvt_pk_bf16_f32 v48, 0, v48
    v_cvt_pk_bf16_f32 v49, 0, v49
    v_cvt_pk_bf16_f32 v50, 0, v50
    v_cvt_pk_bf16_f32 v51, 0, v51
    v_cvt_pk_bf16_f32 v52, 0, v52
    v_cvt_pk_bf16_f32 v53, 0, v53
    v_cvt_pk_bf16_f32 v54, 0, v54
    v_cvt_pk_bf16_f32 v55, 0, v55
    v_cvt_pk_bf16_f32 v56, 0, v56
    v_cvt_pk_bf16_f32 v57, 0, v57
    v_cvt_pk_bf16_f32 v58, 0, v58
    v_cvt_pk_bf16_f32 v59, 0, v59
    v_mul_f32 v48, v48, v96
    v_mul_f32 v49, v49, v97
    v_mul_f32 v50, v50, v98
    v_mul_f32 v51, v51, v99
    v_mul_f32 v52, v52, v100
    v_mul_f32 v53, v53, v101
    v_mul_f32 v54, v54, v102
    v_mul_f32 v55, v55, v103
    v_mul_f32 v56, v56, v104
    v_mul_f32 v57, v57, v105
    v_mul_f32 v58, v58, v106
    v_mul_f32 v59, v59, v107
    v_cvt_pk_bf16_f32 v138, v48, v49
    v_cvt_pk_bf16_f32 v139, v50, v51
    v_add_f32_dpp v3, v145, v144 row_ror:12 row_mask:0xf bank_mask:0xf
    v_cvt_pk_bf16_f32 v140, v52, v53
    v_cvt_pk_bf16_f32 v141, v54, v55
    v_add_f32_dpp v3, v146, v3 row_ror:8 row_mask:0xf bank_mask:0xf
    v_cvt_pk_bf16_f32 v142, v56, v57
    v_cvt_pk_bf16_f32 v143, v58, v59
    v_add_f32_dpp v15, v147, v3 row_ror:4 row_mask:0xf bank_mask:0x1
    v_mfma_f32_16x16x16_bf16 v[148:151], v[138:139], v[160:161], 0
    v_mfma_f32_16x16x16_bf16 v[148:151], v[140:141], v[162:163], v[148:151]
    v_mfma_f32_16x16x16_bf16 v[148:151], v[142:143], v[164:165], v[148:151]
    v_add_u32 v33, s63, v19
    v_add_u32 v34, s63, v20
    ds_read_b64 v[108:109], v33 offset:0
    ds_read_b64 v[110:111], v33 offset:1536
    ds_read_b64 v[112:113], v33 offset:128
    ds_read_b64 v[114:115], v33 offset:1664
    ds_read_b64 v[116:117], v33 offset:256
    ds_read_b64 v[118:119], v33 offset:1792
    ds_read_b64 v[120:121], v34 offset:0
    v_add_f32_dpp v4, v149, v148 row_ror:12 row_mask:0xf bank_mask:0xf
    ds_read_b64 v[122:123], v34 offset:1536
    ds_read_b64 v[124:125], v34 offset:128
    v_add_f32_dpp v4, v150, v4 row_ror:8 row_mask:0xf bank_mask:0xf
    ds_read_b64 v[126:127], v34 offset:1664
    ds_read_b64 v[128:129], v34 offset:256
    ds_read_b64 v[130:131], v34 offset:1792
    v_add_f32_dpp v16, v151, v4 row_ror:4 row_mask:0xf bank_mask:0x1
    s_waitcnt lgkmcnt(0)
    v_lshlrev_b32 v60, 16, v108
    v_and_b32 v61, s66, v108
    v_lshlrev_b32 v62, 16, v109
    v_and_b32 v63, s66, v109
    v_lshlrev_b32 v84, 16, v110
    v_and_b32 v85, s66, v110
    v_lshlrev_b32 v86, 16, v111
    v_and_b32 v87, s66, v111
    v_lshlrev_b32 v64, 16, v112
    v_and_b32 v65, s66, v112
    v_lshlrev_b32 v66, 16, v113
    v_and_b32 v67, s66, v113
    v_lshlrev_b32 v88, 16, v114
    v_and_b32 v89, s66, v114
    v_lshlrev_b32 v90, 16, v115
    v_and_b32 v91, s66, v115
    v_lshlrev_b32 v68, 16, v116
    v_and_b32 v69, s66, v116
    v_lshlrev_b32 v70, 16, v117
    v_and_b32 v71, s66, v117
    v_lshlrev_b32 v92, 16, v118
    v_and_b32 v93, s66, v118
    v_lshlrev_b32 v94, 16, v119
    v_and_b32 v95, s66, v119
    v_lshlrev_b32 v72, 16, v120
    v_and_b32 v73, s66, v120
    v_lshlrev_b32 v74, 16, v121
    v_and_b32 v75, s66, v121
    v_lshlrev_b32 v96, 16, v122
    v_and_b32 v97, s66, v122
    v_lshlrev_b32 v98, 16, v123
    v_and_b32 v99, s66, v123
    v_lshlrev_b32 v76, 16, v124
    v_and_b32 v77, s66, v124
    v_lshlrev_b32 v78, 16, v125
    v_and_b32 v79, s66, v125
    v_lshlrev_b32 v100, 16, v126
    v_and_b32 v101, s66, v126
    v_lshlrev_b32 v102, 16, v127
    v_and_b32 v103, s66, v127
    v_lshlrev_b32 v80, 16, v128
    v_and_b32 v81, s66, v128
    v_lshlrev_b32 v82, 16, v129
    v_and_b32 v83, s66, v129
    v_lshlrev_b32 v104, 16, v130
    v_and_b32 v105, s66, v130
    v_lshlrev_b32 v106, 16, v131
    v_and_b32 v107, s66, v131
    v_add_u32 v13, s62, v12
    s_add_u32 s62, s62, 24576
    s_cmp_eq_u32 s62, 73728
    s_cselect_b32 s62, 0, s62
    s_barrier
    ds_read_b128 v[36:39], v13 offset:0
    ds_read_b128 v[40:43], v13 offset:256
    ds_read_b128 v[44:47], v13 offset:512
    ds_read_b128 v[48:51], v13 offset:3072
    ds_read_b128 v[52:55], v13 offset:3328
    ds_read_b128 v[56:59], v13 offset:3584
    s_waitcnt lgkmcnt(3)
    v_cvt_f32_i32 v36, v36
    v_cvt_f32_i32 v37, v37
    v_cvt_f32_i32 v38, v38
    v_cvt_f32_i32 v39, v39
    v_cvt_f32_i32 v40, v40
    v_cvt_f32_i32 v41, v41
    v_cvt_f32_i32 v42, v42
    v_cvt_f32_i32 v43, v43
    v_cvt_f32_i32 v44, v44
    v_cvt_f32_i32 v45, v45
    v_cvt_f32_i32 v46, v46
    v_cvt_f32_i32 v47, v47
    v_sub_f32 v36, v36, v60
    v_sub_f32 v37, v37, v61
    v_sub_f32 v38, v38, v62
    v_sub_f32 v39, v39, v63
    v_sub_f32 v40, v40, v64
    v_sub_f32 v41, v41, v65
    v_sub_f32 v42, v42, v66
    v_sub_f32 v43, v43, v67
    v_sub_f32 v44, v44, v68
    v_sub_f32 v45, v45, v69
    v_sub_f32 v46, v46, v70
    v_sub_f32 v47, v47, v71
    v_cvt_pk_bf16_f32 v36, 0, v36
    v_cvt_pk_bf16_f32 v37, 0, v37
    v_cvt_pk_bf16_f32 v38, 0, v38
    v_cvt_pk_bf16_f32 v39, 0, v39
    v_cvt_pk_bf16_f32 v40, 0, v40
    v_cvt_pk_bf16_f32 v41, 0, v41
    v_cvt_pk_bf16_f32 v42, 0, v42
    v_cvt_pk_bf16_f32 v43, 0, v43
    v_cvt_pk_bf16_f32 v44, 0, v44
    v_cvt_pk_bf16_f32 v45, 0, v45
    v_cvt_pk_bf16_f32 v46, 0, v46
    v_cvt_pk_bf16_f32 v47, 0, v47
    v_mul_f32 v36, v36, v84
    v_mul_f32 v37, v37, v85
    v_mul_f32 v38, v38, v86
    v_mul_f32 v39, v39, v87
    v_mul_f32 v40, v40, v88
    v_mul_f32 v41, v41, v89
    v_mul_f32 v42, v42, v90
    v_mul_f32 v43, v43, v91
    v_mul_f32 v44, v44, v92
    v_mul_f32 v45, v45, v93
    v_mul_f32 v46, v46, v94
    v_mul_f32 v47, v47, v95
    v_cvt_pk_bf16_f32 v132, v36, v37
    v_cvt_pk_bf16_f32 v133, v38, v39
    v_cvt_pk_bf16_f32 v134, v40, v41
    v_cvt_pk_bf16_f32 v135, v42, v43
    v_cvt_pk_bf16_f32 v136, v44, v45
    v_cvt_pk_bf16_f32 v137, v46, v47
    v_mfma_f32_16x16x16_bf16 v[144:147], v[132:133], v[160:161], 0
    v_mfma_f32_16x16x16_bf16 v[144:147], v[134:135], v[162:163], v[144:147]
    v_mfma_f32_16x16x16_bf16 v[144:147], v[136:137], v[164:165], v[144:147]
    s_waitcnt lgkmcnt(0)
    v_cvt_f32_i32 v48, v48
    v_cvt_f32_i32 v49, v49
    v_cvt_f32_i32 v50, v50
    v_cvt_f32_i32 v51, v51
    v_cvt_f32_i32 v52, v52
    v_cvt_f32_i32 v53, v53
    v_cvt_f32_i32 v54, v54
    v_cvt_f32_i32 v55, v55
    v_cvt_f32_i32 v56, v56
    v_cvt_f32_i32 v57, v57
    v_cvt_f32_i32 v58, v58
    v_cvt_f32_i32 v59, v59
    v_sub_f32 v48, v48, v72
    v_sub_f32 v49, v49, v73
    v_sub_f32 v50, v50, v74
    v_sub_f32 v51, v51, v75
    v_sub_f32 v52, v52, v76
    v_sub_f32 v53, v53, v77
    v_sub_f32 v54, v54, v78
    v_sub_f32 v55, v55, v79
    v_sub_f32 v56, v56, v80
    v_sub_f32 v57, v57, v81
    v_sub_f32 v58, v58, v82
    v_sub_f32 v59, v59, v83
    v_cvt_pk_bf16_f32 v48, 0, v48
    v_cvt_pk_bf16_f32 v49, 0, v49
    v_cvt_pk_bf16_f32 v50, 0, v50
    v_cvt_pk_bf16_f32 v51, 0, v51
    v_cvt_pk_bf16_f32 v52, 0, v52
    v_cvt_pk_bf16_f32 v53, 0, v53
    v_cvt_pk_bf16_f32 v54, 0, v54
    v_cvt_pk_bf16_f32 v55, 0, v55
    v_cvt_pk_bf16_f32 v56, 0, v56
    v_cvt_pk_bf16_f32 v57, 0, v57
    v_cvt_pk_bf16_f32 v58, 0, v58
    v_cvt_pk_bf16_f32 v59, 0, v59
    v_mul_f32 v48, v48, v96
    v_mul_f32 v49, v49, v97
    v_mul_f32 v50, v50, v98
    v_mul_f32 v51, v51, v99
    v_mul_f32 v52, v52, v100
    v_mul_f32 v53, v53, v101
    v_mul_f32 v54, v54, v102
    v_mul_f32 v55, v55, v103
    v_mul_f32 v56, v56, v104
    v_mul_f32 v57, v57, v105
    v_mul_f32 v58, v58, v106
    v_mul_f32 v59, v59, v107
    v_cvt_pk_bf16_f32 v138, v48, v49
    v_cvt_pk_bf16_f32 v139, v50, v51
    v_add_f32_dpp v3, v146, v145 row_ror:12 row_mask:0xf bank_mask:0xf
    v_cvt_pk_bf16_f32 v140, v52, v53
    v_cvt_pk_bf16_f32 v141, v54, v55
    v_add_f32_dpp v3, v147, v3 row_ror:8 row_mask:0xf bank_mask:0xf
    v_cvt_pk_bf16_f32 v142, v56, v57
    v_cvt_pk_bf16_f32 v143, v58, v59
    v_add_f32_dpp v15, v144, v3 row_ror:4 row_mask:0xf bank_mask:0x2
    v_mfma_f32_16x16x16_bf16 v[148:151], v[138:139], v[160:161], 0
    v_mfma_f32_16x16x16_bf16 v[148:151], v[140:141], v[162:163], v[148:151]
    v_mfma_f32_16x16x16_bf16 v[148:151], v[142:143], v[164:165], v[148:151]
    v_add_u32 v33, s63, v21
    v_add_u32 v34, s63, v22
    ds_read_b64 v[108:109], v33 offset:0
    ds_read_b64 v[110:111], v33 offset:1536
    ds_read_b64 v[112:113], v33 offset:128
    ds_read_b64 v[114:115], v33 offset:1664
    ds_read_b64 v[116:117], v33 offset:256
    ds_read_b64 v[118:119], v33 offset:1792
    ds_read_b64 v[120:121], v34 offset:0
    v_add_f32_dpp v4, v150, v149 row_ror:12 row_mask:0xf bank_mask:0xf
    ds_read_b64 v[122:123], v34 offset:1536
    ds_read_b64 v[124:125], v34 offset:128
    v_add_f32_dpp v4, v151, v4 row_ror:8 row_mask:0xf bank_mask:0xf
    ds_read_b64 v[126:127], v34 offset:1664
    ds_read_b64 v[128:129], v34 offset:256
    ds_read_b64 v[130:131], v34 offset:1792
    v_add_f32_dpp v16, v148, v4 row_ror:4 row_mask:0xf bank_mask:0x2
    s_waitcnt lgkmcnt(0)
    v_lshlrev_b32 v60, 16, v108
    v_and_b32 v61, s66, v108
    v_lshlrev_b32 v62, 16, v109
    v_and_b32 v63, s66, v109
    v_lshlrev_b32 v84, 16, v110
    v_and_b32 v85, s66, v110
    v_lshlrev_b32 v86, 16, v111
    v_and_b32 v87, s66, v111
    v_lshlrev_b32 v64, 16, v112
    v_and_b32 v65, s66, v112
    v_lshlrev_b32 v66, 16, v113
    v_and_b32 v67, s66, v113
    v_lshlrev_b32 v88, 16, v114
    v_and_b32 v89, s66, v114
    v_lshlrev_b32 v90, 16, v115
    v_and_b32 v91, s66, v115
    v_lshlrev_b32 v68, 16, v116
    v_and_b32 v69, s66, v116
    v_lshlrev_b32 v70, 16, v117
    v_and_b32 v71, s66, v117
    v_lshlrev_b32 v92, 16, v118
    v_and_b32 v93, s66, v118
    v_lshlrev_b32 v94, 16, v119
    v_and_b32 v95, s66, v119
    v_lshlrev_b32 v72, 16, v120
    v_and_b32 v73, s66, v120
    v_lshlrev_b32 v74, 16, v121
    v_and_b32 v75, s66, v121
    v_lshlrev_b32 v96, 16, v122
    v_and_b32 v97, s66, v122
    v_lshlrev_b32 v98, 16, v123
    v_and_b32 v99, s66, v123
    v_lshlrev_b32 v76, 16, v124
    v_and_b32 v77, s66, v124
    v_lshlrev_b32 v78, 16, v125
    v_and_b32 v79, s66, v125
    v_lshlrev_b32 v100, 16, v126
    v_and_b32 v101, s66, v126
    v_lshlrev_b32 v102, 16, v127
    v_and_b32 v103, s66, v127
    v_lshlrev_b32 v80, 16, v128
    v_and_b32 v81, s66, v128
    v_lshlrev_b32 v82, 16, v129
    v_and_b32 v83, s66, v129
    v_lshlrev_b32 v104, 16, v130
    v_and_b32 v105, s66, v130
    v_lshlrev_b32 v106, 16, v131
    v_and_b32 v107, s66, v131
    v_add_u32 v13, s62, v12
    s_add_u32 s62, s62, 24576
    s_cmp_eq_u32 s62, 73728
    s_cselect_b32 s62, 0, s62
    s_barrier
    ds_read_b128 v[36:39], v13 offset:0
    ds_read_b128 v[40:43], v13 offset:256
    ds_read_b128 v[44:47], v13 offset:512
    ds_read_b128 v[48:51], v13 offset:3072
    ds_read_b128 v[52:55], v13 offset:3328
    ds_read_b128 v[56:59], v13 offset:3584
    s_waitcnt lgkmcnt(3)
    v_cvt_f32_i32 v36, v36
    v_cvt_f32_i32 v37, v37
    v_cvt_f32_i32 v38, v38
    v_cvt_f32_i32 v39, v39
    v_cvt_f32_i32 v40, v40
    v_cvt_f32_i32 v41, v41
    v_cvt_f32_i32 v42, v42
    v_cvt_f32_i32 v43, v43
    v_cvt_f32_i32 v44, v44
    v_cvt_f32_i32 v45, v45
    v_cvt_f32_i32 v46, v46
    v_cvt_f32_i32 v47, v47
    v_sub_f32 v36, v36, v60
    v_sub_f32 v37, v37, v61
    v_sub_f32 v38, v38, v62
    v_sub_f32 v39, v39, v63
    v_sub_f32 v40, v40, v64
    v_sub_f32 v41, v41, v65
    v_sub_f32 v42, v42, v66
    v_sub_f32 v43, v43, v67
    v_sub_f32 v44, v44, v68
    v_sub_f32 v45, v45, v69
    v_sub_f32 v46, v46, v70
    v_sub_f32 v47, v47, v71
    v_cvt_pk_bf16_f32 v36, 0, v36
    v_cvt_pk_bf16_f32 v37, 0, v37
    v_cvt_pk_bf16_f32 v38, 0, v38
    v_cvt_pk_bf16_f32 v39, 0, v39
    v_cvt_pk_bf16_f32 v40, 0, v40
    v_cvt_pk_bf16_f32 v41, 0, v41
    v_cvt_pk_bf16_f32 v42, 0, v42
    v_cvt_pk_bf16_f32 v43, 0, v43
    v_cvt_pk_bf16_f32 v44, 0, v44
    v_cvt_pk_bf16_f32 v45, 0, v45
    v_cvt_pk_bf16_f32 v46, 0, v46
    v_cvt_pk_bf16_f32 v47, 0, v47
    v_mul_f32 v36, v36, v84
    v_mul_f32 v37, v37, v85
    v_mul_f32 v38, v38, v86
    v_mul_f32 v39, v39, v87
    v_mul_f32 v40, v40, v88
    v_mul_f32 v41, v41, v89
    v_mul_f32 v42, v42, v90
    v_mul_f32 v43, v43, v91
    v_mul_f32 v44, v44, v92
    v_mul_f32 v45, v45, v93
    v_mul_f32 v46, v46, v94
    v_mul_f32 v47, v47, v95
    v_cvt_pk_bf16_f32 v132, v36, v37
    v_cvt_pk_bf16_f32 v133, v38, v39
    v_cvt_pk_bf16_f32 v134, v40, v41
    v_cvt_pk_bf16_f32 v135, v42, v43
    v_cvt_pk_bf16_f32 v136, v44, v45
    v_cvt_pk_bf16_f32 v137, v46, v47
    v_mfma_f32_16x16x16_bf16 v[144:147], v[132:133], v[160:161], 0
    v_mfma_f32_16x16x16_bf16 v[144:147], v[134:135], v[162:163], v[144:147]
    v_mfma_f32_16x16x16_bf16 v[144:147], v[136:137], v[164:165], v[144:147]
    s_waitcnt lgkmcnt(0)
    v_cvt_f32_i32 v48, v48
    v_cvt_f32_i32 v49, v49
    v_cvt_f32_i32 v50, v50
    v_cvt_f32_i32 v51, v51
    v_cvt_f32_i32 v52, v52
    v_cvt_f32_i32 v53, v53
    v_cvt_f32_i32 v54, v54
    v_cvt_f32_i32 v55, v55
    v_cvt_f32_i32 v56, v56
    v_cvt_f32_i32 v57, v57
    v_cvt_f32_i32 v58, v58
    v_cvt_f32_i32 v59, v59
    v_sub_f32 v48, v48, v72
    v_sub_f32 v49, v49, v73
    v_sub_f32 v50, v50, v74
    v_sub_f32 v51, v51, v75
    v_sub_f32 v52, v52, v76
    v_sub_f32 v53, v53, v77
    v_sub_f32 v54, v54, v78
    v_sub_f32 v55, v55, v79
    v_sub_f32 v56, v56, v80
    v_sub_f32 v57, v57, v81
    v_sub_f32 v58, v58, v82
    v_sub_f32 v59, v59, v83
    v_cvt_pk_bf16_f32 v48, 0, v48
    v_cvt_pk_bf16_f32 v49, 0, v49
    v_cvt_pk_bf16_f32 v50, 0, v50
    v_cvt_pk_bf16_f32 v51, 0, v51
    v_cvt_pk_bf16_f32 v52, 0, v52
    v_cvt_pk_bf16_f32 v53, 0, v53
    v_cvt_pk_bf16_f32 v54, 0, v54
    v_cvt_pk_bf16_f32 v55, 0, v55
    v_cvt_pk_bf16_f32 v56, 0, v56
    v_cvt_pk_bf16_f32 v57, 0, v57
    v_cvt_pk_bf16_f32 v58, 0, v58
    v_cvt_pk_bf16_f32 v59, 0, v59
    v_mul_f32 v48, v48, v96
    v_mul_f32 v49, v49, v97
    v_mul_f32 v50, v50, v98
    v_mul_f32 v51, v51, v99
    v_mul_f32 v52, v52, v100
    v_mul_f32 v53, v53, v101
    v_mul_f32 v54, v54, v102
    v_mul_f32 v55, v55, v103
    v_mul_f32 v56, v56, v104
    v_mul_f32 v57, v57, v105
    v_mul_f32 v58, v58, v106
    v_mul_f32 v59, v59, v107
    v_cvt_pk_bf16_f32 v138, v48, v49
    v_cvt_pk_bf16_f32 v139, v50, v51
    v_add_f32_dpp v3, v147, v146 row_ror:12 row_mask:0xf bank_mask:0xf
    v_cvt_pk_bf16_f32 v140, v52, v53
    v_cvt_pk_bf16_f32 v141, v54, v55
    v_add_f32_dpp v3, v144, v3 row_ror:8 row_mask:0xf bank_mask:0xf
    v_cvt_pk_bf16_f32 v142, v56, v57
    v_cvt_pk_bf16_f32 v143, v58, v59
    v_add_f32_dpp v15, v145, v3 row_ror:4 row_mask:0xf bank_mask:0x4
    v_mfma_f32_16x16x16_bf16 v[148:151], v[138:139], v[160:161], 0
    v_mfma_f32_16x16x16_bf16 v[148:151], v[140:141], v[162:163], v[148:151]
    v_mfma_f32_16x16x16_bf16 v[148:151], v[142:143], v[164:165], v[148:151]
    v_add_u32 v33, s63, v23
    v_add_u32 v34, s63, v24
    ds_read_b64 v[108:109], v33 offset:0
    ds_read_b64 v[110:111], v33 offset:1536
    ds_read_b64 v[112:113], v33 offset:128
    ds_read_b64 v[114:115], v33 offset:1664
    ds_read_b64 v[116:117], v33 offset:256
    ds_read_b64 v[118:119], v33 offset:1792
    ds_read_b64 v[120:121], v34 offset:0
    v_add_f32_dpp v4, v151, v150 row_ror:12 row_mask:0xf bank_mask:0xf
    ds_read_b64 v[122:123], v34 offset:1536
    ds_read_b64 v[124:125], v34 offset:128
    v_add_f32_dpp v4, v148, v4 row_ror:8 row_mask:0xf bank_mask:0xf
    ds_read_b64 v[126:127], v34 offset:1664
    ds_read_b64 v[128:129], v34 offset:256
    ds_read_b64 v[130:131], v34 offset:1792
    v_add_f32_dpp v16, v149, v4 row_ror:4 row_mask:0xf bank_mask:0x4
    s_waitcnt lgkmcnt(0)
    v_lshlrev_b32 v60, 16, v108
    v_and_b32 v61, s66, v108
    v_lshlrev_b32 v62, 16, v109
    v_and_b32 v63, s66, v109
    v_lshlrev_b32 v84, 16, v110
    v_and_b32 v85, s66, v110
    v_lshlrev_b32 v86, 16, v111
    v_and_b32 v87, s66, v111
    v_lshlrev_b32 v64, 16, v112
    v_and_b32 v65, s66, v112
    v_lshlrev_b32 v66, 16, v113
    v_and_b32 v67, s66, v113
    v_lshlrev_b32 v88, 16, v114
    v_and_b32 v89, s66, v114
    v_lshlrev_b32 v90, 16, v115
    v_and_b32 v91, s66, v115
    v_lshlrev_b32 v68, 16, v116
    v_and_b32 v69, s66, v116
    v_lshlrev_b32 v70, 16, v117
    v_and_b32 v71, s66, v117
    v_lshlrev_b32 v92, 16, v118
    v_and_b32 v93, s66, v118
    v_lshlrev_b32 v94, 16, v119
    v_and_b32 v95, s66, v119
    v_lshlrev_b32 v72, 16, v120
    v_and_b32 v73, s66, v120
    v_lshlrev_b32 v74, 16, v121
    v_and_b32 v75, s66, v121
    v_lshlrev_b32 v96, 16, v122
    v_and_b32 v97, s66, v122
    v_lshlrev_b32 v98, 16, v123
    v_and_b32 v99, s66, v123
    v_lshlrev_b32 v76, 16, v124
    v_and_b32 v77, s66, v124
    v_lshlrev_b32 v78, 16, v125
    v_and_b32 v79, s66, v125
    v_lshlrev_b32 v100, 16, v126
    v_and_b32 v101, s66, v126
    v_lshlrev_b32 v102, 16, v127
    v_and_b32 v103, s66, v127
    v_lshlrev_b32 v80, 16, v128
    v_and_b32 v81, s66, v128
    v_lshlrev_b32 v82, 16, v129
    v_and_b32 v83, s66, v129
    v_lshlrev_b32 v104, 16, v130
    v_and_b32 v105, s66, v130
    v_lshlrev_b32 v106, 16, v131
    v_and_b32 v107, s66, v131
    v_add_u32 v13, s62, v12
    s_add_u32 s62, s62, 24576
    s_cmp_eq_u32 s62, 73728
    s_cselect_b32 s62, 0, s62
    s_barrier
    ds_read_b128 v[36:39], v13 offset:0
    ds_read_b128 v[40:43], v13 offset:256
    ds_read_b128 v[44:47], v13 offset:512
    ds_read_b128 v[48:51], v13 offset:3072
    ds_read_b128 v[52:55], v13 offset:3328
    ds_read_b128 v[56:59], v13 offset:3584
    s_waitcnt lgkmcnt(3)
    v_cvt_f32_i32 v36, v36
    v_cvt_f32_i32 v37, v37
    v_cvt_f32_i32 v38, v38
    v_cvt_f32_i32 v39, v39
    v_cvt_f32_i32 v40, v40
    v_cvt_f32_i32 v41, v41
    v_cvt_f32_i32 v42, v42
    v_cvt_f32_i32 v43, v43
    v_cvt_f32_i32 v44, v44
    v_cvt_f32_i32 v45, v45
    v_cvt_f32_i32 v46, v46
    v_cvt_f32_i32 v47, v47
    v_sub_f32 v36, v36, v60
    v_sub_f32 v37, v37, v61
    v_sub_f32 v38, v38, v62
    v_sub_f32 v39, v39, v63
    v_sub_f32 v40, v40, v64
    v_sub_f32 v41, v41, v65
    v_sub_f32 v42, v42, v66
    v_sub_f32 v43, v43, v67
    v_sub_f32 v44, v44, v68
    v_sub_f32 v45, v45, v69
    v_sub_f32 v46, v46, v70
    v_sub_f32 v47, v47, v71
    v_cvt_pk_bf16_f32 v36, 0, v36
    v_cvt_pk_bf16_f32 v37, 0, v37
    v_cvt_pk_bf16_f32 v38, 0, v38
    v_cvt_pk_bf16_f32 v39, 0, v39
    v_cvt_pk_bf16_f32 v40, 0, v40
    v_cvt_pk_bf16_f32 v41, 0, v41
    v_cvt_pk_bf16_f32 v42, 0, v42
    v_cvt_pk_bf16_f32 v43, 0, v43
    v_cvt_pk_bf16_f32 v44, 0, v44
    v_cvt_pk_bf16_f32 v45, 0, v45
    v_cvt_pk_bf16_f32 v46, 0, v46
    v_cvt_pk_bf16_f32 v47, 0, v47
    v_mul_f32 v36, v36, v84
    v_mul_f32 v37, v37, v85
    v_mul_f32 v38, v38, v86
    v_mul_f32 v39, v39, v87
    v_mul_f32 v40, v40, v88
    v_mul_f32 v41, v41, v89
    v_mul_f32 v42, v42, v90
    v_mul_f32 v43, v43, v91
    v_mul_f32 v44, v44, v92
    v_mul_f32 v45, v45, v93
    v_mul_f32 v46, v46, v94
    v_mul_f32 v47, v47, v95
    v_cvt_pk_bf16_f32 v132, v36, v37
    v_cvt_pk_bf16_f32 v133, v38, v39
    v_cvt_pk_bf16_f32 v134, v40, v41
    v_cvt_pk_bf16_f32 v135, v42, v43
    v_cvt_pk_bf16_f32 v136, v44, v45
    v_cvt_pk_bf16_f32 v137, v46, v47
    v_mfma_f32_16x16x16_bf16 v[144:147], v[132:133], v[160:161], 0
    v_mfma_f32_16x16x16_bf16 v[144:147], v[134:135], v[162:163], v[144:147]
    v_mfma_f32_16x16x16_bf16 v[144:147], v[136:137], v[164:165], v[144:147]
    s_waitcnt lgkmcnt(0)
    v_cvt_f32_i32 v48, v48
    v_cvt_f32_i32 v49, v49
    v_cvt_f32_i32 v50, v50
    v_cvt_f32_i32 v51, v51
    v_cvt_f32_i32 v52, v52
    v_cvt_f32_i32 v53, v53
    v_cvt_f32_i32 v54, v54
    v_cvt_f32_i32 v55, v55
    v_cvt_f32_i32 v56, v56
    v_cvt_f32_i32 v57, v57
    v_cvt_f32_i32 v58, v58
    v_cvt_f32_i32 v59, v59
    v_sub_f32 v48, v48, v72
    v_sub_f32 v49, v49, v73
    v_sub_f32 v50, v50, v74
    v_sub_f32 v51, v51, v75
    v_sub_f32 v52, v52, v76
    v_sub_f32 v53, v53, v77
    v_sub_f32 v54, v54, v78
    v_sub_f32 v55, v55, v79
    v_sub_f32 v56, v56, v80
    v_sub_f32 v57, v57, v81
    v_sub_f32 v58, v58, v82
    v_sub_f32 v59, v59, v83
    v_cvt_pk_bf16_f32 v48, 0, v48
    v_cvt_pk_bf16_f32 v49, 0, v49
    v_cvt_pk_bf16_f32 v50, 0, v50
    v_cvt_pk_bf16_f32 v51, 0, v51
    v_cvt_pk_bf16_f32 v52, 0, v52
    v_cvt_pk_bf16_f32 v53, 0, v53
    v_cvt_pk_bf16_f32 v54, 0, v54
    v_cvt_pk_bf16_f32 v55, 0, v55
    v_cvt_pk_bf16_f32 v56, 0, v56
    v_cvt_pk_bf16_f32 v57, 0, v57
    v_cvt_pk_bf16_f32 v58, 0, v58
    v_cvt_pk_bf16_f32 v59, 0, v59
    v_mul_f32 v48, v48, v96
    v_mul_f32 v49, v49, v97
    v_mul_f32 v50, v50, v98
    v_mul_f32 v51, v51, v99
    v_mul_f32 v52, v52, v100
    v_mul_f32 v53, v53, v101
    v_mul_f32 v54, v54, v102
    v_mul_f32 v55, v55, v103
    v_mul_f32 v56, v56, v104
    v_mul_f32 v57, v57, v105
    v_mul_f32 v58, v58, v106
    v_mul_f32 v59, v59, v107
    v_cvt_pk_bf16_f32 v138, v48, v49
    v_cvt_pk_bf16_f32 v139, v50, v51
    v_add_f32_dpp v3, v144, v147 row_ror:12 row_mask:0xf bank_mask:0xf
    v_cvt_pk_bf16_f32 v140, v52, v53
    v_cvt_pk_bf16_f32 v141, v54, v55
    v_add_f32_dpp v3, v145, v3 row_ror:8 row_mask:0xf bank_mask:0xf
    v_cvt_pk_bf16_f32 v142, v56, v57
    v_cvt_pk_bf16_f32 v143, v58, v59
    v_add_f32_dpp v15, v146, v3 row_ror:4 row_mask:0xf bank_mask:0x8
    v_mfma_f32_16x16x16_bf16 v[148:151], v[138:139], v[160:161], 0
    v_mfma_f32_16x16x16_bf16 v[148:151], v[140:141], v[162:163], v[148:151]
    v_mfma_f32_16x16x16_bf16 v[148:151], v[142:143], v[164:165], v[148:151]
    v_add_u32 v33, s63, v25
    v_add_u32 v34, s63, v26
    ds_read_b64 v[108:109], v33 offset:0
    ds_read_b64 v[110:111], v33 offset:1536
    ds_read_b64 v[112:113], v33 offset:128
    ds_read_b64 v[114:115], v33 offset:1664
    ds_read_b64 v[116:117], v33 offset:256
    ds_read_b64 v[118:119], v33 offset:1792
    ds_read_b64 v[120:121], v34 offset:0
    v_add_f32_dpp v4, v148, v151 row_ror:12 row_mask:0xf bank_mask:0xf
    ds_read_b64 v[122:123], v34 offset:1536
    ds_read_b64 v[124:125], v34 offset:128
    v_add_f32_dpp v4, v149, v4 row_ror:8 row_mask:0xf bank_mask:0xf
    ds_read_b64 v[126:127], v34 offset:1664
    ds_read_b64 v[128:129], v34 offset:256
    ds_read_b64 v[130:131], v34 offset:1792
    v_add_f32_dpp v16, v150, v4 row_ror:4 row_mask:0xf bank_mask:0x8
    v_cvt_pk_bf16_f32 v3, 0, v15
    v_cvt_pk_bf16_f32 v4, 0, v16
    v_mul_f32 v3, s65, v3
    v_mul_f32 v4, s65, v4
    v_cvt_pk_bf16_f32 v5, v3, v4
    v_max3_f32 v14, v14, v3, v4
    ds_write_b32 v11, v5 offset:0
    s_waitcnt lgkmcnt(0)
    v_lshlrev_b32 v60, 16, v108
    v_and_b32 v61, s66, v108
    v_lshlrev_b32 v62, 16, v109
    v_and_b32 v63, s66, v109
    v_lshlrev_b32 v84, 16, v110
    v_and_b32 v85, s66, v110
    v_lshlrev_b32 v86, 16, v111
    v_and_b32 v87, s66, v111
    v_lshlrev_b32 v64, 16, v112
    v_and_b32 v65, s66, v112
    v_lshlrev_b32 v66, 16, v113
    v_and_b32 v67, s66, v113
    v_lshlrev_b32 v88, 16, v114
    v_and_b32 v89, s66, v114
    v_lshlrev_b32 v90, 16, v115
    v_and_b32 v91, s66, v115
    v_lshlrev_b32 v68, 16, v116
    v_and_b32 v69, s66, v116
    v_lshlrev_b32 v70, 16, v117
    v_and_b32 v71, s66, v117
    v_lshlrev_b32 v92, 16, v118
    v_and_b32 v93, s66, v118
    v_lshlrev_b32 v94, 16, v119
    v_and_b32 v95, s66, v119
    v_lshlrev_b32 v72, 16, v120
    v_and_b32 v73, s66, v120
    v_lshlrev_b32 v74, 16, v121
    v_and_b32 v75, s66, v121
    v_lshlrev_b32 v96, 16, v122
    v_and_b32 v97, s66, v122
    v_lshlrev_b32 v98, 16, v123
    v_and_b32 v99, s66, v123
    v_lshlrev_b32 v76, 16, v124
    v_and_b32 v77, s66, v124
    v_lshlrev_b32 v78, 16, v125
    v_and_b32 v79, s66, v125
    v_lshlrev_b32 v100, 16, v126
    v_and_b32 v101, s66, v126
    v_lshlrev_b32 v102, 16, v127
    v_and_b32 v103, s66, v127
    v_lshlrev_b32 v80, 16, v128
    v_and_b32 v81, s66, v128
    v_lshlrev_b32 v82, 16, v129
    v_and_b32 v83, s66, v129
    v_lshlrev_b32 v104, 16, v130
    v_and_b32 v105, s66, v130
    v_lshlrev_b32 v106, 16, v131
    v_and_b32 v107, s66, v131
    s_waitcnt vmcnt(0)
    v_add_u32 v13, s62, v12
    s_add_u32 s62, s62, 24576
    s_cmp_eq_u32 s62, 73728
    s_cselect_b32 s62, 0, s62
    s_barrier
    ds_read_b128 v[36:39], v13 offset:0
    ds_read_b128 v[40:43], v13 offset:256
    ds_read_b128 v[44:47], v13 offset:512
    ds_read_b128 v[48:51], v13 offset:3072
    ds_read_b128 v[52:55], v13 offset:3328
    ds_read_b128 v[56:59], v13 offset:3584
    s_waitcnt lgkmcnt(3)
    v_cvt_f32_i32 v36, v36
    v_cvt_f32_i32 v37, v37
    v_cvt_f32_i32 v38, v38
    v_cvt_f32_i32 v39, v39
    v_cvt_f32_i32 v40, v40
    v_cvt_f32_i32 v41, v41
    v_cvt_f32_i32 v42, v42
    v_cvt_f32_i32 v43, v43
    v_cvt_f32_i32 v44, v44
    v_cvt_f32_i32 v45, v45
    v_cvt_f32_i32 v46, v46
    v_cvt_f32_i32 v47, v47
    v_sub_f32 v36, v36, v60
    v_sub_f32 v37, v37, v61
    v_sub_f32 v38, v38, v62
    v_sub_f32 v39, v39, v63
    v_sub_f32 v40, v40, v64
    v_sub_f32 v41, v41, v65
    v_sub_f32 v42, v42, v66
    v_sub_f32 v43, v43, v67
    v_sub_f32 v44, v44, v68
    v_sub_f32 v45, v45, v69
    v_sub_f32 v46, v46, v70
    v_sub_f32 v47, v47, v71
    v_cvt_pk_bf16_f32 v36, 0, v36
    v_cvt_pk_bf16_f32 v37, 0, v37
    v_cvt_pk_bf16_f32 v38, 0, v38
    v_cvt_pk_bf16_f32 v39, 0, v39
    v_cvt_pk_bf16_f32 v40, 0, v40
    v_cvt_pk_bf16_f32 v41, 0, v41
    v_cvt_pk_bf16_f32 v42, 0, v42
    v_cvt_pk_bf16_f32 v43, 0, v43
    v_cvt_pk_bf16_f32 v44, 0, v44
    v_cvt_pk_bf16_f32 v45, 0, v45
    v_cvt_pk_bf16_f32 v46, 0, v46
    v_cvt_pk_bf16_f32 v47, 0, v47
    v_mul_f32 v36, v36, v84
    v_mul_f32 v37, v37, v85
    v_mul_f32 v38, v38, v86
    v_mul_f32 v39, v39, v87
    v_mul_f32 v40, v40, v88
    v_mul_f32 v41, v41, v89
    v_mul_f32 v42, v42, v90
    v_mul_f32 v43, v43, v91
    v_mul_f32 v44, v44, v92
    v_mul_f32 v45, v45, v93
    v_mul_f32 v46, v46, v94
    v_mul_f32 v47, v47, v95
    v_cvt_pk_bf16_f32 v132, v36, v37
    v_cvt_pk_bf16_f32 v133, v38, v39
    v_cvt_pk_bf16_f32 v134, v40, v41
    v_cvt_pk_bf16_f32 v135, v42, v43
    v_cvt_pk_bf16_f32 v136, v44, v45
    v_cvt_pk_bf16_f32 v137, v46, v47
    v_mfma_f32_16x16x16_bf16 v[144:147], v[132:133], v[160:161], 0
    v_mfma_f32_16x16x16_bf16 v[144:147], v[134:135], v[162:163], v[144:147]
    v_mfma_f32_16x16x16_bf16 v[144:147], v[136:137], v[164:165], v[144:147]
    s_waitcnt lgkmcnt(0)
    v_cvt_f32_i32 v48, v48
    v_cvt_f32_i32 v49, v49
    v_cvt_f32_i32 v50, v50
    v_cvt_f32_i32 v51, v51
    v_cvt_f32_i32 v52, v52
    v_cvt_f32_i32 v53, v53
    v_cvt_f32_i32 v54, v54
    v_cvt_f32_i32 v55, v55
    v_cvt_f32_i32 v56, v56
    v_cvt_f32_i32 v57, v57
    v_cvt_f32_i32 v58, v58
    v_cvt_f32_i32 v59, v59
    v_sub_f32 v48, v48, v72
    v_sub_f32 v49, v49, v73
    v_sub_f32 v50, v50, v74
    v_sub_f32 v51, v51, v75
    v_sub_f32 v52, v52, v76
    v_sub_f32 v53, v53, v77
    v_sub_f32 v54, v54, v78
    v_sub_f32 v55, v55, v79
    v_sub_f32 v56, v56, v80
    v_sub_f32 v57, v57, v81
    v_sub_f32 v58, v58, v82
    v_sub_f32 v59, v59, v83
    v_cvt_pk_bf16_f32 v48, 0, v48
    v_cvt_pk_bf16_f32 v49, 0, v49
    v_cvt_pk_bf16_f32 v50, 0, v50
    v_cvt_pk_bf16_f32 v51, 0, v51
    v_cvt_pk_bf16_f32 v52, 0, v52
    v_cvt_pk_bf16_f32 v53, 0, v53
    v_cvt_pk_bf16_f32 v54, 0, v54
    v_cvt_pk_bf16_f32 v55, 0, v55
    v_cvt_pk_bf16_f32 v56, 0, v56
    v_cvt_pk_bf16_f32 v57, 0, v57
    v_cvt_pk_bf16_f32 v58, 0, v58
    v_cvt_pk_bf16_f32 v59, 0, v59
    v_mul_f32 v48, v48, v96
    v_mul_f32 v49, v49, v97
    v_mul_f32 v50, v50, v98
    v_mul_f32 v51, v51, v99
    v_mul_f32 v52, v52, v100
    v_mul_f32 v53, v53, v101
    v_mul_f32 v54, v54, v102
    v_mul_f32 v55, v55, v103
    v_mul_f32 v56, v56, v104
    v_mul_f32 v57, v57, v105
    v_mul_f32 v58, v58, v106
    v_mul_f32 v59, v59, v107
    v_cvt_pk_bf16_f32 v138, v48, v49
    v_cvt_pk_bf16_f32 v139, v50, v51
    v_add_f32_dpp v3, v145, v144 row_ror:12 row_mask:0xf bank_mask:0xf
    v_cvt_pk_bf16_f32 v140, v52, v53
    v_cvt_pk_bf16_f32 v141, v54, v55
    v_add_f32_dpp v3, v146, v3 row_ror:8 row_mask:0xf bank_mask:0xf
    v_cvt_pk_bf16_f32 v142, v56, v57
    v_cvt_pk_bf16_f32 v143, v58, v59
    v_add_f32_dpp v15, v147, v3 row_ror:4 row_mask:0xf bank_mask:0x1
    v_mfma_f32_16x16x16_bf16 v[148:151], v[138:139], v[160:161], 0
    v_mfma_f32_16x16x16_bf16 v[148:151], v[140:141], v[162:163], v[148:151]
    v_mfma_f32_16x16x16_bf16 v[148:151], v[142:143], v[164:165], v[148:151]
    v_add_u32 v33, s63, v27
    v_add_u32 v34, s63, v28
    ds_read_b64 v[108:109], v33 offset:0
    ds_read_b64 v[110:111], v33 offset:1536
    ds_read_b64 v[112:113], v33 offset:128
    ds_read_b64 v[114:115], v33 offset:1664
    ds_read_b64 v[116:117], v33 offset:256
    ds_read_b64 v[118:119], v33 offset:1792
    ds_read_b64 v[120:121], v34 offset:0
    v_add_f32_dpp v4, v149, v148 row_ror:12 row_mask:0xf bank_mask:0xf
    ds_read_b64 v[122:123], v34 offset:1536
    ds_read_b64 v[124:125], v34 offset:128
    v_add_f32_dpp v4, v150, v4 row_ror:8 row_mask:0xf bank_mask:0xf
    ds_read_b64 v[126:127], v34 offset:1664
    ds_read_b64 v[128:129], v34 offset:256
    ds_read_b64 v[130:131], v34 offset:1792
    v_add_f32_dpp v16, v151, v4 row_ror:4 row_mask:0xf bank_mask:0x1
    s_waitcnt lgkmcnt(0)
    v_lshlrev_b32 v60, 16, v108
    v_and_b32 v61, s66, v108
    v_lshlrev_b32 v62, 16, v109
    v_and_b32 v63, s66, v109
    v_lshlrev_b32 v84, 16, v110
    v_and_b32 v85, s66, v110
    v_lshlrev_b32 v86, 16, v111
    v_and_b32 v87, s66, v111
    v_lshlrev_b32 v64, 16, v112
    v_and_b32 v65, s66, v112
    v_lshlrev_b32 v66, 16, v113
    v_and_b32 v67, s66, v113
    v_lshlrev_b32 v88, 16, v114
    v_and_b32 v89, s66, v114
    v_lshlrev_b32 v90, 16, v115
    v_and_b32 v91, s66, v115
    v_lshlrev_b32 v68, 16, v116
    v_and_b32 v69, s66, v116
    v_lshlrev_b32 v70, 16, v117
    v_and_b32 v71, s66, v117
    v_lshlrev_b32 v92, 16, v118
    v_and_b32 v93, s66, v118
    v_lshlrev_b32 v94, 16, v119
    v_and_b32 v95, s66, v119
    v_lshlrev_b32 v72, 16, v120
    v_and_b32 v73, s66, v120
    v_lshlrev_b32 v74, 16, v121
    v_and_b32 v75, s66, v121
    v_lshlrev_b32 v96, 16, v122
    v_and_b32 v97, s66, v122
    v_lshlrev_b32 v98, 16, v123
    v_and_b32 v99, s66, v123
    v_lshlrev_b32 v76, 16, v124
    v_and_b32 v77, s66, v124
    v_lshlrev_b32 v78, 16, v125
    v_and_b32 v79, s66, v125
    v_lshlrev_b32 v100, 16, v126
    v_and_b32 v101, s66, v126
    v_lshlrev_b32 v102, 16, v127
    v_and_b32 v103, s66, v127
    v_lshlrev_b32 v80, 16, v128
    v_and_b32 v81, s66, v128
    v_lshlrev_b32 v82, 16, v129
    v_and_b32 v83, s66, v129
    v_lshlrev_b32 v104, 16, v130
    v_and_b32 v105, s66, v130
    v_lshlrev_b32 v106, 16, v131
    v_and_b32 v107, s66, v131
    v_add_u32 v13, s62, v12
    s_add_u32 s62, s62, 24576
    s_cmp_eq_u32 s62, 73728
    s_cselect_b32 s62, 0, s62
    s_barrier
    ds_read_b128 v[36:39], v13 offset:0
    ds_read_b128 v[40:43], v13 offset:256
    ds_read_b128 v[44:47], v13 offset:512
    ds_read_b128 v[48:51], v13 offset:3072
    ds_read_b128 v[52:55], v13 offset:3328
    ds_read_b128 v[56:59], v13 offset:3584
    s_waitcnt lgkmcnt(3)
    v_cvt_f32_i32 v36, v36
    v_cvt_f32_i32 v37, v37
    v_cvt_f32_i32 v38, v38
    v_cvt_f32_i32 v39, v39
    v_cvt_f32_i32 v40, v40
    v_cvt_f32_i32 v41, v41
    v_cvt_f32_i32 v42, v42
    v_cvt_f32_i32 v43, v43
    v_cvt_f32_i32 v44, v44
    v_cvt_f32_i32 v45, v45
    v_cvt_f32_i32 v46, v46
    v_cvt_f32_i32 v47, v47
    v_sub_f32 v36, v36, v60
    v_sub_f32 v37, v37, v61
    v_sub_f32 v38, v38, v62
    v_sub_f32 v39, v39, v63
    v_sub_f32 v40, v40, v64
    v_sub_f32 v41, v41, v65
    v_sub_f32 v42, v42, v66
    v_sub_f32 v43, v43, v67
    v_sub_f32 v44, v44, v68
    v_sub_f32 v45, v45, v69
    v_sub_f32 v46, v46, v70
    v_sub_f32 v47, v47, v71
    v_cvt_pk_bf16_f32 v36, 0, v36
    v_cvt_pk_bf16_f32 v37, 0, v37
    v_cvt_pk_bf16_f32 v38, 0, v38
    v_cvt_pk_bf16_f32 v39, 0, v39
    v_cvt_pk_bf16_f32 v40, 0, v40
    v_cvt_pk_bf16_f32 v41, 0, v41
    v_cvt_pk_bf16_f32 v42, 0, v42
    v_cvt_pk_bf16_f32 v43, 0, v43
    v_cvt_pk_bf16_f32 v44, 0, v44
    v_cvt_pk_bf16_f32 v45, 0, v45
    v_cvt_pk_bf16_f32 v46, 0, v46
    v_cvt_pk_bf16_f32 v47, 0, v47
    v_mul_f32 v36, v36, v84
    v_mul_f32 v37, v37, v85
    v_mul_f32 v38, v38, v86
    v_mul_f32 v39, v39, v87
    v_mul_f32 v40, v40, v88
    v_mul_f32 v41, v41, v89
    v_mul_f32 v42, v42, v90
    v_mul_f32 v43, v43, v91
    v_mul_f32 v44, v44, v92
    v_mul_f32 v45, v45, v93
    v_mul_f32 v46, v46, v94
    v_mul_f32 v47, v47, v95
    v_cvt_pk_bf16_f32 v132, v36, v37
    v_cvt_pk_bf16_f32 v133, v38, v39
    v_cvt_pk_bf16_f32 v134, v40, v41
    v_cvt_pk_bf16_f32 v135, v42, v43
    v_cvt_pk_bf16_f32 v136, v44, v45
    v_cvt_pk_bf16_f32 v137, v46, v47
    v_mfma_f32_16x16x16_bf16 v[144:147], v[132:133], v[160:161], 0
    v_mfma_f32_16x16x16_bf16 v[144:147], v[134:135], v[162:163], v[144:147]
    v_mfma_f32_16x16x16_bf16 v[144:147], v[136:137], v[164:165], v[144:147]
    s_waitcnt lgkmcnt(0)
    v_cvt_f32_i32 v48, v48
    v_cvt_f32_i32 v49, v49
    v_cvt_f32_i32 v50, v50
    v_cvt_f32_i32 v51, v51
    v_cvt_f32_i32 v52, v52
    v_cvt_f32_i32 v53, v53
    v_cvt_f32_i32 v54, v54
    v_cvt_f32_i32 v55, v55
    v_cvt_f32_i32 v56, v56
    v_cvt_f32_i32 v57, v57
    v_cvt_f32_i32 v58, v58
    v_cvt_f32_i32 v59, v59
    v_sub_f32 v48, v48, v72
    v_sub_f32 v49, v49, v73
    v_sub_f32 v50, v50, v74
    v_sub_f32 v51, v51, v75
    v_sub_f32 v52, v52, v76
    v_sub_f32 v53, v53, v77
    v_sub_f32 v54, v54, v78
    v_sub_f32 v55, v55, v79
    v_sub_f32 v56, v56, v80
    v_sub_f32 v57, v57, v81
    v_sub_f32 v58, v58, v82
    v_sub_f32 v59, v59, v83
    v_cvt_pk_bf16_f32 v48, 0, v48
    v_cvt_pk_bf16_f32 v49, 0, v49
    v_cvt_pk_bf16_f32 v50, 0, v50
    v_cvt_pk_bf16_f32 v51, 0, v51
    v_cvt_pk_bf16_f32 v52, 0, v52
    v_cvt_pk_bf16_f32 v53, 0, v53
    v_cvt_pk_bf16_f32 v54, 0, v54
    v_cvt_pk_bf16_f32 v55, 0, v55
    v_cvt_pk_bf16_f32 v56, 0, v56
    v_cvt_pk_bf16_f32 v57, 0, v57
    v_cvt_pk_bf16_f32 v58, 0, v58
    v_cvt_pk_bf16_f32 v59, 0, v59
    v_mul_f32 v48, v48, v96
    v_mul_f32 v49, v49, v97
    v_mul_f32 v50, v50, v98
    v_mul_f32 v51, v51, v99
    v_mul_f32 v52, v52, v100
    v_mul_f32 v53, v53, v101
    v_mul_f32 v54, v54, v102
    v_mul_f32 v55, v55, v103
    v_mul_f32 v56, v56, v104
    v_mul_f32 v57, v57, v105
    v_mul_f32 v58, v58, v106
    v_mul_f32 v59, v59, v107
    v_cvt_pk_bf16_f32 v138, v48, v49
    v_cvt_pk_bf16_f32 v139, v50, v51
    v_add_f32_dpp v3, v146, v145 row_ror:12 row_mask:0xf bank_mask:0xf
    v_cvt_pk_bf16_f32 v140, v52, v53
    v_cvt_pk_bf16_f32 v141, v54, v55
    v_add_f32_dpp v3, v147, v3 row_ror:8 row_mask:0xf bank_mask:0xf
    v_cvt_pk_bf16_f32 v142, v56, v57
    v_cvt_pk_bf16_f32 v143, v58, v59
    v_add_f32_dpp v15, v144, v3 row_ror:4 row_mask:0xf bank_mask:0x2
    v_mfma_f32_16x16x16_bf16 v[148:151], v[138:139], v[160:161], 0
    v_mfma_f32_16x16x16_bf16 v[148:151], v[140:141], v[162:163], v[148:151]
    v_mfma_f32_16x16x16_bf16 v[148:151], v[142:143], v[164:165], v[148:151]
    v_add_u32 v33, s63, v29
    v_add_u32 v34, s63, v30
    ds_read_b64 v[108:109], v33 offset:0
    ds_read_b64 v[110:111], v33 offset:1536
    ds_read_b64 v[112:113], v33 offset:128
    ds_read_b64 v[114:115], v33 offset:1664
    ds_read_b64 v[116:117], v33 offset:256
    ds_read_b64 v[118:119], v33 offset:1792
    ds_read_b64 v[120:121], v34 offset:0
    v_add_f32_dpp v4, v150, v149 row_ror:12 row_mask:0xf bank_mask:0xf
    ds_read_b64 v[122:123], v34 offset:1536
    ds_read_b64 v[124:125], v34 offset:128
    v_add_f32_dpp v4, v151, v4 row_ror:8 row_mask:0xf bank_mask:0xf
    ds_read_b64 v[126:127], v34 offset:1664
    ds_read_b64 v[128:129], v34 offset:256
    ds_read_b64 v[130:131], v34 offset:1792
    v_add_f32_dpp v16, v148, v4 row_ror:4 row_mask:0xf bank_mask:0x2
    s_waitcnt lgkmcnt(0)
    v_lshlrev_b32 v60, 16, v108
    v_and_b32 v61, s66, v108
    v_lshlrev_b32 v62, 16, v109
    v_and_b32 v63, s66, v109
    v_lshlrev_b32 v84, 16, v110
    v_and_b32 v85, s66, v110
    v_lshlrev_b32 v86, 16, v111
    v_and_b32 v87, s66, v111
    v_lshlrev_b32 v64, 16, v112
    v_and_b32 v65, s66, v112
    v_lshlrev_b32 v66, 16, v113
    v_and_b32 v67, s66, v113
    v_lshlrev_b32 v88, 16, v114
    v_and_b32 v89, s66, v114
    v_lshlrev_b32 v90, 16, v115
    v_and_b32 v91, s66, v115
    v_lshlrev_b32 v68, 16, v116
    v_and_b32 v69, s66, v116
    v_lshlrev_b32 v70, 16, v117
    v_and_b32 v71, s66, v117
    v_lshlrev_b32 v92, 16, v118
    v_and_b32 v93, s66, v118
    v_lshlrev_b32 v94, 16, v119
    v_and_b32 v95, s66, v119
    v_lshlrev_b32 v72, 16, v120
    v_and_b32 v73, s66, v120
    v_lshlrev_b32 v74, 16, v121
    v_and_b32 v75, s66, v121
    v_lshlrev_b32 v96, 16, v122
    v_and_b32 v97, s66, v122
    v_lshlrev_b32 v98, 16, v123
    v_and_b32 v99, s66, v123
    v_lshlrev_b32 v76, 16, v124
    v_and_b32 v77, s66, v124
    v_lshlrev_b32 v78, 16, v125
    v_and_b32 v79, s66, v125
    v_lshlrev_b32 v100, 16, v126
    v_and_b32 v101, s66, v126
    v_lshlrev_b32 v102, 16, v127
    v_and_b32 v103, s66, v127
    v_lshlrev_b32 v80, 16, v128
    v_and_b32 v81, s66, v128
    v_lshlrev_b32 v82, 16, v129
    v_and_b32 v83, s66, v129
    v_lshlrev_b32 v104, 16, v130
    v_and_b32 v105, s66, v130
    v_lshlrev_b32 v106, 16, v131
    v_and_b32 v107, s66, v131
    v_add_u32 v13, s62, v12
    s_add_u32 s62, s62, 24576
    s_cmp_eq_u32 s62, 73728
    s_cselect_b32 s62, 0, s62
    s_barrier
    ds_read_b128 v[36:39], v13 offset:0
    ds_read_b128 v[40:43], v13 offset:256
    ds_read_b128 v[44:47], v13 offset:512
    ds_read_b128 v[48:51], v13 offset:3072
    ds_read_b128 v[52:55], v13 offset:3328
    ds_read_b128 v[56:59], v13 offset:3584
    s_waitcnt lgkmcnt(3)
    v_cvt_f32_i32 v36, v36
    v_cvt_f32_i32 v37, v37
    v_cvt_f32_i32 v38, v38
    v_cvt_f32_i32 v39, v39
    v_cvt_f32_i32 v40, v40
    v_cvt_f32_i32 v41, v41
    v_cvt_f32_i32 v42, v42
    v_cvt_f32_i32 v43, v43
    v_cvt_f32_i32 v44, v44
    v_cvt_f32_i32 v45, v45
    v_cvt_f32_i32 v46, v46
    v_cvt_f32_i32 v47, v47
    v_sub_f32 v36, v36, v60
    v_sub_f32 v37, v37, v61
    v_sub_f32 v38, v38, v62
    v_sub_f32 v39, v39, v63
    v_sub_f32 v40, v40, v64
    v_sub_f32 v41, v41, v65
    v_sub_f32 v42, v42, v66
    v_sub_f32 v43, v43, v67
    v_sub_f32 v44, v44, v68
    v_sub_f32 v45, v45, v69
    v_sub_f32 v46, v46, v70
    v_sub_f32 v47, v47, v71
    v_cvt_pk_bf16_f32 v36, 0, v36
    v_cvt_pk_bf16_f32 v37, 0, v37
    v_cvt_pk_bf16_f32 v38, 0, v38
    v_cvt_pk_bf16_f32 v39, 0, v39
    v_cvt_pk_bf16_f32 v40, 0, v40
    v_cvt_pk_bf16_f32 v41, 0, v41
    v_cvt_pk_bf16_f32 v42, 0, v42
    v_cvt_pk_bf16_f32 v43, 0, v43
    v_cvt_pk_bf16_f32 v44, 0, v44
    v_cvt_pk_bf16_f32 v45, 0, v45
    v_cvt_pk_bf16_f32 v46, 0, v46
    v_cvt_pk_bf16_f32 v47, 0, v47
    v_mul_f32 v36, v36, v84
    v_mul_f32 v37, v37, v85
    v_mul_f32 v38, v38, v86
    v_mul_f32 v39, v39, v87
    v_mul_f32 v40, v40, v88
    v_mul_f32 v41, v41, v89
    v_mul_f32 v42, v42, v90
    v_mul_f32 v43, v43, v91
    v_mul_f32 v44, v44, v92
    v_mul_f32 v45, v45, v93
    v_mul_f32 v46, v46, v94
    v_mul_f32 v47, v47, v95
    v_cvt_pk_bf16_f32 v132, v36, v37
    v_cvt_pk_bf16_f32 v133, v38, v39
    v_cvt_pk_bf16_f32 v134, v40, v41
    v_cvt_pk_bf16_f32 v135, v42, v43
    v_cvt_pk_bf16_f32 v136, v44, v45
    v_cvt_pk_bf16_f32 v137, v46, v47
    v_mfma_f32_16x16x16_bf16 v[144:147], v[132:133], v[160:161], 0
    v_mfma_f32_16x16x16_bf16 v[144:147], v[134:135], v[162:163], v[144:147]
    v_mfma_f32_16x16x16_bf16 v[144:147], v[136:137], v[164:165], v[144:147]
    s_waitcnt lgkmcnt(0)
    v_cvt_f32_i32 v48, v48
    v_cvt_f32_i32 v49, v49
    v_cvt_f32_i32 v50, v50
    v_cvt_f32_i32 v51, v51
    v_cvt_f32_i32 v52, v52
    v_cvt_f32_i32 v53, v53
    v_cvt_f32_i32 v54, v54
    v_cvt_f32_i32 v55, v55
    v_cvt_f32_i32 v56, v56
    v_cvt_f32_i32 v57, v57
    v_cvt_f32_i32 v58, v58
    v_cvt_f32_i32 v59, v59
    v_sub_f32 v48, v48, v72
    v_sub_f32 v49, v49, v73
    v_sub_f32 v50, v50, v74
    v_sub_f32 v51, v51, v75
    v_sub_f32 v52, v52, v76
    v_sub_f32 v53, v53, v77
    v_sub_f32 v54, v54, v78
    v_sub_f32 v55, v55, v79
    v_sub_f32 v56, v56, v80
    v_sub_f32 v57, v57, v81
    v_sub_f32 v58, v58, v82
    v_sub_f32 v59, v59, v83
    v_cvt_pk_bf16_f32 v48, 0, v48
    v_cvt_pk_bf16_f32 v49, 0, v49
    v_cvt_pk_bf16_f32 v50, 0, v50
    v_cvt_pk_bf16_f32 v51, 0, v51
    v_cvt_pk_bf16_f32 v52, 0, v52
    v_cvt_pk_bf16_f32 v53, 0, v53
    v_cvt_pk_bf16_f32 v54, 0, v54
    v_cvt_pk_bf16_f32 v55, 0, v55
    v_cvt_pk_bf16_f32 v56, 0, v56
    v_cvt_pk_bf16_f32 v57, 0, v57
    v_cvt_pk_bf16_f32 v58, 0, v58
    v_cvt_pk_bf16_f32 v59, 0, v59
    v_mul_f32 v48, v48, v96
    v_mul_f32 v49, v49, v97
    v_mul_f32 v50, v50, v98
    v_mul_f32 v51, v51, v99
    v_mul_f32 v52, v52, v100
    v_mul_f32 v53, v53, v101
    v_mul_f32 v54, v54, v102
    v_mul_f32 v55, v55, v103
    v_mul_f32 v56, v56, v104
    v_mul_f32 v57, v57, v105
    v_mul_f32 v58, v58, v106
    v_mul_f32 v59, v59, v107
    v_cvt_pk_bf16_f32 v138, v48, v49
    v_cvt_pk_bf16_f32 v139, v50, v51
    v_add_f32_dpp v3, v147, v146 row_ror:12 row_mask:0xf bank_mask:0xf
    v_cvt_pk_bf16_f32 v140, v52, v53
    v_cvt_pk_bf16_f32 v141, v54, v55
    v_add_f32_dpp v3, v144, v3 row_ror:8 row_mask:0xf bank_mask:0xf
    v_cvt_pk_bf16_f32 v142, v56, v57
    v_cvt_pk_bf16_f32 v143, v58, v59
    v_add_f32_dpp v15, v145, v3 row_ror:4 row_mask:0xf bank_mask:0x4
    v_mfma_f32_16x16x16_bf16 v[148:151], v[138:139], v[160:161], 0
    v_mfma_f32_16x16x16_bf16 v[148:151], v[140:141], v[162:163], v[148:151]
    v_mfma_f32_16x16x16_bf16 v[148:151], v[142:143], v[164:165], v[148:151]
    v_add_u32 v33, s63, v31
    v_add_u32 v34, s63, v32
    ds_read_b64 v[108:109], v33 offset:0
    ds_read_b64 v[110:111], v33 offset:1536
    ds_read_b64 v[112:113], v33 offset:128
    ds_read_b64 v[114:115], v33 offset:1664
    ds_read_b64 v[116:117], v33 offset:256
    ds_read_b64 v[118:119], v33 offset:1792
    ds_read_b64 v[120:121], v34 offset:0
    v_add_f32_dpp v4, v151, v150 row_ror:12 row_mask:0xf bank_mask:0xf
    ds_read_b64 v[122:123], v34 offset:1536
    ds_read_b64 v[124:125], v34 offset:128
    v_add_f32_dpp v4, v148, v4 row_ror:8 row_mask:0xf bank_mask:0xf
    ds_read_b64 v[126:127], v34 offset:1664
    ds_read_b64 v[128:129], v34 offset:256
    ds_read_b64 v[130:131], v34 offset:1792
    v_add_f32_dpp v16, v149, v4 row_ror:4 row_mask:0xf bank_mask:0x4
    s_waitcnt lgkmcnt(0)
    v_lshlrev_b32 v60, 16, v108
    v_and_b32 v61, s66, v108
    v_lshlrev_b32 v62, 16, v109
    v_and_b32 v63, s66, v109
    v_lshlrev_b32 v84, 16, v110
    v_and_b32 v85, s66, v110
    v_lshlrev_b32 v86, 16, v111
    v_and_b32 v87, s66, v111
    v_lshlrev_b32 v64, 16, v112
    v_and_b32 v65, s66, v112
    v_lshlrev_b32 v66, 16, v113
    v_and_b32 v67, s66, v113
    v_lshlrev_b32 v88, 16, v114
    v_and_b32 v89, s66, v114
    v_lshlrev_b32 v90, 16, v115
    v_and_b32 v91, s66, v115
    v_lshlrev_b32 v68, 16, v116
    v_and_b32 v69, s66, v116
    v_lshlrev_b32 v70, 16, v117
    v_and_b32 v71, s66, v117
    v_lshlrev_b32 v92, 16, v118
    v_and_b32 v93, s66, v118
    v_lshlrev_b32 v94, 16, v119
    v_and_b32 v95, s66, v119
    v_lshlrev_b32 v72, 16, v120
    v_and_b32 v73, s66, v120
    v_lshlrev_b32 v74, 16, v121
    v_and_b32 v75, s66, v121
    v_lshlrev_b32 v96, 16, v122
    v_and_b32 v97, s66, v122
    v_lshlrev_b32 v98, 16, v123
    v_and_b32 v99, s66, v123
    v_lshlrev_b32 v76, 16, v124
    v_and_b32 v77, s66, v124
    v_lshlrev_b32 v78, 16, v125
    v_and_b32 v79, s66, v125
    v_lshlrev_b32 v100, 16, v126
    v_and_b32 v101, s66, v126
    v_lshlrev_b32 v102, 16, v127
    v_and_b32 v103, s66, v127
    v_lshlrev_b32 v80, 16, v128
    v_and_b32 v81, s66, v128
    v_lshlrev_b32 v82, 16, v129
    v_and_b32 v83, s66, v129
    v_lshlrev_b32 v104, 16, v130
    v_and_b32 v105, s66, v130
    v_lshlrev_b32 v106, 16, v131
    v_and_b32 v107, s66, v131
    v_add_u32 v13, s62, v12
    s_add_u32 s62, s62, 24576
    s_cmp_eq_u32 s62, 73728
    s_cselect_b32 s62, 0, s62
    s_barrier
    ds_read_b128 v[36:39], v13 offset:0
    ds_read_b128 v[40:43], v13 offset:256
    ds_read_b128 v[44:47], v13 offset:512
    ds_read_b128 v[48:51], v13 offset:3072
    ds_read_b128 v[52:55], v13 offset:3328
    ds_read_b128 v[56:59], v13 offset:3584
    s_waitcnt lgkmcnt(3)
    v_cvt_f32_i32 v36, v36
    v_cvt_f32_i32 v37, v37
    v_cvt_f32_i32 v38, v38
    v_cvt_f32_i32 v39, v39
    v_cvt_f32_i32 v40, v40
    v_cvt_f32_i32 v41, v41
    v_cvt_f32_i32 v42, v42
    v_cvt_f32_i32 v43, v43
    v_cvt_f32_i32 v44, v44
    v_cvt_f32_i32 v45, v45
    v_cvt_f32_i32 v46, v46
    v_cvt_f32_i32 v47, v47
    v_sub_f32 v36, v36, v60
    v_sub_f32 v37, v37, v61
    v_sub_f32 v38, v38, v62
    v_sub_f32 v39, v39, v63
    v_sub_f32 v40, v40, v64
    v_sub_f32 v41, v41, v65
    v_sub_f32 v42, v42, v66
    v_sub_f32 v43, v43, v67
    v_sub_f32 v44, v44, v68
    v_sub_f32 v45, v45, v69
    v_sub_f32 v46, v46, v70
    v_sub_f32 v47, v47, v71
    v_cvt_pk_bf16_f32 v36, 0, v36
    v_cvt_pk_bf16_f32 v37, 0, v37
    v_cvt_pk_bf16_f32 v38, 0, v38
    v_cvt_pk_bf16_f32 v39, 0, v39
    v_cvt_pk_bf16_f32 v40, 0, v40
    v_cvt_pk_bf16_f32 v41, 0, v41
    v_cvt_pk_bf16_f32 v42, 0, v42
    v_cvt_pk_bf16_f32 v43, 0, v43
    v_cvt_pk_bf16_f32 v44, 0, v44
    v_cvt_pk_bf16_f32 v45, 0, v45
    v_cvt_pk_bf16_f32 v46, 0, v46
    v_cvt_pk_bf16_f32 v47, 0, v47
    v_mul_f32 v36, v36, v84
    v_mul_f32 v37, v37, v85
    v_mul_f32 v38, v38, v86
    v_mul_f32 v39, v39, v87
    v_mul_f32 v40, v40, v88
    v_mul_f32 v41, v41, v89
    v_mul_f32 v42, v42, v90
    v_mul_f32 v43, v43, v91
    v_mul_f32 v44, v44, v92
    v_mul_f32 v45, v45, v93
    v_mul_f32 v46, v46, v94
    v_mul_f32 v47, v47, v95
    v_cvt_pk_bf16_f32 v132, v36, v37
    v_cvt_pk_bf16_f32 v133, v38, v39
    v_cvt_pk_bf16_f32 v134, v40, v41
    v_cvt_pk_bf16_f32 v135, v42, v43
    v_cvt_pk_bf16_f32 v136, v44, v45
    v_cvt_pk_bf16_f32 v137, v46, v47
    v_mfma_f32_16x16x16_bf16 v[144:147], v[132:133], v[160:161], 0
    v_mfma_f32_16x16x16_bf16 v[144:147], v[134:135], v[162:163], v[144:147]
    v_mfma_f32_16x16x16_bf16 v[144:147], v[136:137], v[164:165], v[144:147]
    s_waitcnt lgkmcnt(0)
    v_cvt_f32_i32 v48, v48
    v_cvt_f32_i32 v49, v49
    v_cvt_f32_i32 v50, v50
    v_cvt_f32_i32 v51, v51
    v_cvt_f32_i32 v52, v52
    v_cvt_f32_i32 v53, v53
    v_cvt_f32_i32 v54, v54
    v_cvt_f32_i32 v55, v55
    v_cvt_f32_i32 v56, v56
    v_cvt_f32_i32 v57, v57
    v_cvt_f32_i32 v58, v58
    v_cvt_f32_i32 v59, v59
    v_sub_f32 v48, v48, v72
    v_sub_f32 v49, v49, v73
    v_sub_f32 v50, v50, v74
    v_sub_f32 v51, v51, v75
    v_sub_f32 v52, v52, v76
    v_sub_f32 v53, v53, v77
    v_sub_f32 v54, v54, v78
    v_sub_f32 v55, v55, v79
    v_sub_f32 v56, v56, v80
    v_sub_f32 v57, v57, v81
    v_sub_f32 v58, v58, v82
    v_sub_f32 v59, v59, v83
    v_cvt_pk_bf16_f32 v48, 0, v48
    v_cvt_pk_bf16_f32 v49, 0, v49
    v_cvt_pk_bf16_f32 v50, 0, v50
    v_cvt_pk_bf16_f32 v51, 0, v51
    v_cvt_pk_bf16_f32 v52, 0, v52
    v_cvt_pk_bf16_f32 v53, 0, v53
    v_cvt_pk_bf16_f32 v54, 0, v54
    v_cvt_pk_bf16_f32 v55, 0, v55
    v_cvt_pk_bf16_f32 v56, 0, v56
    v_cvt_pk_bf16_f32 v57, 0, v57
    v_cvt_pk_bf16_f32 v58, 0, v58
    v_cvt_pk_bf16_f32 v59, 0, v59
    v_mul_f32 v48, v48, v96
    v_mul_f32 v49, v49, v97
    v_mul_f32 v50, v50, v98
    v_mul_f32 v51, v51, v99
    v_mul_f32 v52, v52, v100
    v_mul_f32 v53, v53, v101
    v_mul_f32 v54, v54, v102
    v_mul_f32 v55, v55, v103
    v_mul_f32 v56, v56, v104
    v_mul_f32 v57, v57, v105
    v_mul_f32 v58, v58, v106
    v_mul_f32 v59, v59, v107
    v_cvt_pk_bf16_f32 v138, v48, v49
    v_cvt_pk_bf16_f32 v139, v50, v51
    v_add_f32_dpp v3, v144, v147 row_ror:12 row_mask:0xf bank_mask:0xf
    v_cvt_pk_bf16_f32 v140, v52, v53
    v_cvt_pk_bf16_f32 v141, v54, v55
    v_add_f32_dpp v3, v145, v3 row_ror:8 row_mask:0xf bank_mask:0xf
    v_cvt_pk_bf16_f32 v142, v56, v57
    v_cvt_pk_bf16_f32 v143, v58, v59
    v_add_f32_dpp v15, v146, v3 row_ror:4 row_mask:0xf bank_mask:0x8
    v_mfma_f32_16x16x16_bf16 v[148:151], v[138:139], v[160:161], 0
    v_mfma_f32_16x16x16_bf16 v[148:151], v[140:141], v[162:163], v[148:151]
    v_mfma_f32_16x16x16_bf16 v[148:151], v[142:143], v[164:165], v[148:151]
    s_add_u32 s63, s63, 3072
    v_add_u32 v33, s63, v17
    v_add_u32 v34, s63, v18
    ds_read_b64 v[108:109], v33 offset:0
    ds_read_b64 v[110:111], v33 offset:1536
    ds_read_b64 v[112:113], v33 offset:128
    ds_read_b64 v[114:115], v33 offset:1664
    ds_read_b64 v[116:117], v33 offset:256
    ds_read_b64 v[118:119], v33 offset:1792
    ds_read_b64 v[120:121], v34 offset:0
    v_add_f32_dpp v4, v148, v151 row_ror:12 row_mask:0xf bank_mask:0xf
    ds_read_b64 v[122:123], v34 offset:1536
    ds_read_b64 v[124:125], v34 offset:128
    v_add_f32_dpp v4, v149, v4 row_ror:8 row_mask:0xf bank_mask:0xf
    ds_read_b64 v[126:127], v34 offset:1664
    ds_read_b64 v[128:129], v34 offset:256
    ds_read_b64 v[130:131], v34 offset:1792
    v_add_f32_dpp v16, v150, v4 row_ror:4 row_mask:0xf bank_mask:0x8
    v_cvt_pk_bf16_f32 v3, 0, v15
    v_cvt_pk_bf16_f32 v4, 0, v16
    v_mul_f32 v3, s65, v3
    v_mul_f32 v4, s65, v4
    v_cvt_pk_bf16_f32 v5, v3, v4
    v_max3_f32 v14, v14, v3, v4
    ds_write_b32 v11, v5 offset:256
    s_waitcnt lgkmcnt(0)
    v_lshlrev_b32 v60, 16, v108
    v_and_b32 v61, s66, v108
    v_lshlrev_b32 v62, 16, v109
    v_and_b32 v63, s66, v109
    v_lshlrev_b32 v84, 16, v110
    v_and_b32 v85, s66, v110
    v_lshlrev_b32 v86, 16, v111
    v_and_b32 v87, s66, v111
    v_lshlrev_b32 v64, 16, v112
    v_and_b32 v65, s66, v112
    v_lshlrev_b32 v66, 16, v113
    v_and_b32 v67, s66, v113
    v_lshlrev_b32 v88, 16, v114
    v_and_b32 v89, s66, v114
    v_lshlrev_b32 v90, 16, v115
    v_and_b32 v91, s66, v115
    v_lshlrev_b32 v68, 16, v116
    v_and_b32 v69, s66, v116
    v_lshlrev_b32 v70, 16, v117
    v_and_b32 v71, s66, v117
    v_lshlrev_b32 v92, 16, v118
    v_and_b32 v93, s66, v118
    v_lshlrev_b32 v94, 16, v119
    v_and_b32 v95, s66, v119
    v_lshlrev_b32 v72, 16, v120
    v_and_b32 v73, s66, v120
    v_lshlrev_b32 v74, 16, v121
    v_and_b32 v75, s66, v121
    v_lshlrev_b32 v96, 16, v122
    v_and_b32 v97, s66, v122
    v_lshlrev_b32 v98, 16, v123
    v_and_b32 v99, s66, v123
    v_lshlrev_b32 v76, 16, v124
    v_and_b32 v77, s66, v124
    v_lshlrev_b32 v78, 16, v125
    v_and_b32 v79, s66, v125
    v_lshlrev_b32 v100, 16, v126
    v_and_b32 v101, s66, v126
    v_lshlrev_b32 v102, 16, v127
    v_and_b32 v103, s66, v127
    v_lshlrev_b32 v80, 16, v128
    v_and_b32 v81, s66, v128
    v_lshlrev_b32 v82, 16, v129
    v_and_b32 v83, s66, v129
    v_lshlrev_b32 v104, 16, v130
    v_and_b32 v105, s66, v130
    v_lshlrev_b32 v106, 16, v131
    v_and_b32 v107, s66, v131
    v_add_u32 v11, 3072, v11
    s_add_u32 s61, s61, 1
    s_cmp_eq_u32 s61, s3
    s_cbranch_scc1 L_kblk_end
    s_cmp_eq_u32 s61, s73
    s_cbranch_scc1 L_kblk_end
    s_cmp_lt_u32 s61, 16
    s_cbranch_scc1 L_kblk
L_kblk_end:
    s_nop 1
    v_max_f32_dpp v14, v14, v14 row_ror:4 row_mask:0xf bank_mask:0xf
    s_nop 1
    v_max_f32_dpp v14, v14, v14 row_ror:8 row_mask:0xf bank_mask:0xf
    v_mov_b32 v3, v14
    s_nop 1
    v_permlane16_swap_b32 v14, v3
    v_max_f32 v14, v14, v3
    v_mov_b32 v3, v14
    s_nop 1
    v_permlane32_swap_b32 v14, v3
    v_max_f32 v14, v14, v3
    v_cvt_pk_bf16_f32 v14, 0, v14
    v_mul_f32 v14, s64, v14
    ds_write_b32 v153, v14
    v_add_u32 v153, 64, v153
    v_mov_b32 v160, v166
    v_mov_b32 v161, v167
    v_mov_b32 v162, v168
    v_mov_b32 v163, v169
    v_mov_b32 v164, v170
    v_mov_b32 v165, v171
    v_mov_b32 v166, v172
    v_mov_b32 v167, v173
    v_mov_b32 v168, v174
    v_mov_b32 v169, v175
    v_mov_b32 v170, v176
    v_mov_b32 v171, v177
    v_mov_b32 v14, 0xff800000
    s_waitcnt lgkmcnt(0)
    s_cmp_lt_u32 s61, 16
    s_cbranch_scc1 L_kblk
    v_lshrrev_b32 v3, 4, v1
    v_and_b32 v4, 15, v1
    v_lshl_add_u32 v3, v2, 3, v3
    v_mul_u32_u24 v3, 768, v3
    v_lshl_add_u32 v12, v4, 4, v3
    v_subrev_u32 v11, 49152, v11
    s_mov_b32 s63, 0
    v_add_u32 v211, s63, v7
    v_add_u32 v212, s63, v8
    ds_read_b32 v210, v11 offset:0
    ds_read_u16 v213, v211 offset:512
    ds_read_u16 v214, v212 offset:512
    ds_read_u16 v211, v211
    ds_read_u16 v212, v212
    v_mov_b32 v184, 0
    v_mov_b32 v185, 0
    v_mov_b32 v186, 0
    v_mov_b32 v187, 0
    v_mov_b32 v188, 0
    v_mov_b32 v189, 0
    v_mov_b32 v190, 0
    v_mov_b32 v191, 0
    v_mov_b32 v192, 0
    v_mov_b32 v193, 0
    v_mov_b32 v194, 0
    v_mov_b32 v195, 0
    v_mov_b32 v196, 0
    v_mov_b32 v197, 0
    v_mov_b32 v198, 0
    v_mov_b32 v199, 0
    s_mov_b32 s61, 0
    v_and_b32 v3, 3, v1
    v_lshlrev_b32 v20, 4, v3
    v_add_u32 v153, 154944, v20
    v_add_u32 v18, 142336, v20
    v_lshl_add_u32 v155, v2, 6, v18
    v_lshl_add_u32 v20, v2, 6, v20
    v_add_u32 v20, 3072, v20
    v_mul_u32_u24 v154, 3072, v2
    v_lshl_add_u32 v154, v1, 4, v154
    v_add_u32 v154, 142592, v154
    v_lshlrev_b32 v4, 10, v2
    v_lshl_add_u32 v19, v1, 4, v4
    v_lshl_add_u32 v17, v1, 2, v4
    v_add_u32 v17, 142592, v17
    v_mul_u32_u24 v21, 384, v3
    v_lshrrev_b32 v4, 2, v1
    v_lshl_add_u32 v21, v4, 3, v21
    v_lshl_add_u32 v21, v2, 7, v21
    s_mov_b32 s48, s18
    s_and_b32 s49, s19, 0xffff
    s_mov_b32 s50, 393216
    s_mov_b32 s51, 0x20000
    s_mov_b32 s24, s22
    s_and_b32 s25, s23, 0xffff
    s_mov_b32 s26, 848640
    s_mov_b32 s27, 0x20000
    s_mul_i32 s68, s100, 9984
    s_mul_i32 s71, s2, 3328
    s_add_u32 s69, s68, 3328
    s_add_u32 s70, s68, 6656
    s_add_u32 s57, s100, 171
    s_cmp_eq_u32 s2, 255
    s_cselect_b32 s57, 170, s57
    s_mul_i32 s57, s57, 1536
    s_mov_b32 s84, 0x7060500
    s_mov_b32 s85, 0x7060501
    s_mov_b32 s86, 0x7060502
    s_mov_b32 s87, 0x7060503
    s_mov_b32 s88, 0x0c0c0400
    s_mov_b32 s89, 0x04000c0c
    s_mov_b32 s90, 0xffffff00
L_vround:
    v_mov_b32 v160, 0
    v_mov_b32 v161, 0
    v_mov_b32 v162, 0
    v_mov_b32 v163, 0
    v_mov_b32 v164, 0
    v_mov_b32 v165, 0
    v_mov_b32 v166, 0
    v_mov_b32 v167, 0
    v_mov_b32 v168, 0
    v_mov_b32 v169, 0
    v_mov_b32 v170, 0
    v_mov_b32 v171, 0
    v_mov_b32 v208, 0
    v_mov_b32 v209, 0
L_vblk:
    s_add_u32 s61, s61, 1
    s_cmp_eq_u32 s61, s3
    s_cselect_b32 s74, 1, 0
    s_cmp_eq_u32 s61, s73
    s_cselect_b32 s74, 1, s74
    s_cmp_eq_u32 s61, 16
    s_cselect_b32 s74, 1, s74
    v_add_u32 v13, s62, v12
    s_add_u32 s62, s62, 24576
    s_cmp_eq_u32 s62, 73728
    s_cselect_b32 s62, 0, s62
    s_barrier
    ds_read_b128 v[156:159], v153
    ds_read_b128 v[36:39], v13 offset:0
    ds_read_b128 v[48:51], v13 offset:3072
    ds_read_b128 v[40:43], v13 offset:256
    ds_read_b128 v[52:55], v13 offset:3328
    ds_read_b128 v[44:47], v13 offset:512
    ds_read_b128 v[56:59], v13 offset:3584
    s_waitcnt lgkmcnt(6)
    v_max_f32 v14, v156, v157
    v_max3_f32 v14, v14, v158, v159
    s_waitcnt lgkmcnt(6)
    v_lshlrev_b32 v215, 16, v210
    v_and_b32 v216, s66, v210
    v_fma_f32 v215, v215, s64, -v14
    v_fma_f32 v216, v216, s64, -v14
    v_exp_f32 v215, v215
    v_exp_f32 v216, v216
    v_lshlrev_b32 v217, 16, v211
    v_lshlrev_b32 v218, 16, v212
    v_mul_f32 v217, v215, v217
    v_mul_f32 v218, v216, v218
    v_add_f32 v208, v208, v215
    v_cvt_pk_bf16_f32 v217, v217, v218
    v_add_f32 v208, v208, v216
    v_lshlrev_b32 v219, 16, v213
    v_lshlrev_b32 v220, 16, v214
    v_lshlrev_b32 v215, 16, v217
    v_and_b32 v216, s66, v217
    v_fmac_f32 v209, v215, v219
    v_fmac_f32 v209, v216, v220
    v_mov_b32_dpp v184, v217 quad_perm:[0,1,2,3] row_mask:0xf bank_mask:0x1
    v_mov_b32_dpp v185, v217 row_ror:12 row_mask:0xf bank_mask:0x1
    v_mov_b32_dpp v186, v217 row_ror:8 row_mask:0xf bank_mask:0x1
    v_mov_b32_dpp v187, v217 row_ror:4 row_mask:0xf bank_mask:0x1
    v_mov_b32_dpp v188, v217 row_ror:4 row_mask:0xf bank_mask:0x2
    v_mov_b32_dpp v189, v217 quad_perm:[0,1,2,3] row_mask:0xf bank_mask:0x2
    v_mov_b32_dpp v190, v217 row_ror:12 row_mask:0xf bank_mask:0x2
    v_mov_b32_dpp v191, v217 row_ror:8 row_mask:0xf bank_mask:0x2
    v_mov_b32_dpp v192, v217 row_ror:8 row_mask:0xf bank_mask:0x4
    v_mov_b32_dpp v193, v217 row_ror:4 row_mask:0xf bank_mask:0x4
    v_mov_b32_dpp v194, v217 quad_perm:[0,1,2,3] row_mask:0xf bank_mask:0x4
    v_mov_b32_dpp v195, v217 row_ror:12 row_mask:0xf bank_mask:0x4
    v_mov_b32_dpp v196, v217 row_ror:12 row_mask:0xf bank_mask:0x8
    v_mov_b32_dpp v197, v217 row_ror:8 row_mask:0xf bank_mask:0x8
    v_mov_b32_dpp v198, v217 row_ror:4 row_mask:0xf bank_mask:0x8
    v_mov_b32_dpp v199, v217 quad_perm:[0,1,2,3] row_mask:0xf bank_mask:0x8
    s_waitcnt lgkmcnt(4)
    v_cvt_f32_i32 v36, v36
    v_cvt_f32_i32 v37, v37
    v_cvt_f32_i32 v38, v38
    v_cvt_f32_i32 v39, v39
    v_cvt_f32_i32 v48, v48
    v_cvt_f32_i32 v49, v49
    v_cvt_f32_i32 v50, v50
    v_cvt_f32_i32 v51, v51
    v_cvt_pk_bf16_f32 v60, v36, v48
    v_cvt_pk_bf16_f32 v64, v37, v49
    v_cvt_pk_bf16_f32 v68, v38, v50
    v_cvt_pk_bf16_f32 v72, v39, v51
    s_waitcnt lgkmcnt(2)
    v_cvt_f32_i32 v40, v40
    v_cvt_f32_i32 v41, v41
    v_cvt_f32_i32 v42, v42
    v_cvt_f32_i32 v43, v43
    v_cvt_f32_i32 v52, v52
    v_cvt_f32_i32 v53, v53
    v_cvt_f32_i32 v54, v54
    v_cvt_f32_i32 v55, v55
    v_cvt_pk_bf16_f32 v76, v40, v52
    v_cvt_pk_bf16_f32 v80, v41, v53
    v_cvt_pk_bf16_f32 v84, v42, v54
    v_cvt_pk_bf16_f32 v88, v43, v55
    s_waitcnt lgkmcnt(0)
    v_cvt_f32_i32 v44, v44
    v_cvt_f32_i32 v45, v45
    v_cvt_f32_i32 v46, v46
    v_cvt_f32_i32 v47, v47
    v_cvt_f32_i32 v56, v56
    v_cvt_f32_i32 v57, v57
    v_cvt_f32_i32 v58, v58
    v_cvt_f32_i32 v59, v59
    v_cvt_pk_bf16_f32 v92, v44, v56
    v_cvt_pk_bf16_f32 v96, v45, v57
    v_cvt_pk_bf16_f32 v100, v46, v58
    v_cvt_pk_bf16_f32 v104, v47, v59
    v_add_u32 v211, s63, v9
    v_add_u32 v212, s63, v10
    ds_read_b32 v210, v11 offset:256
    ds_read_u16 v213, v211 offset:512
    ds_read_u16 v214, v212 offset:512
    ds_read_u16 v211, v211
    ds_read_u16 v212, v212
    v_add_u32 v13, s62, v12
    s_add_u32 s62, s62, 24576
    s_cmp_eq_u32 s62, 73728
    s_cselect_b32 s62, 0, s62
    s_barrier
    ds_read_b128 v[36:39], v13 offset:0
    ds_read_b128 v[48:51], v13 offset:3072
    ds_read_b128 v[40:43], v13 offset:256
    ds_read_b128 v[52:55], v13 offset:3328
    ds_read_b128 v[44:47], v13 offset:512
    ds_read_b128 v[56:59], v13 offset:3584
    s_waitcnt lgkmcnt(4)
    v_cvt_f32_i32 v36, v36
    v_cvt_f32_i32 v37, v37
    v_cvt_f32_i32 v38, v38
    v_cvt_f32_i32 v39, v39
    v_cvt_f32_i32 v48, v48
    v_cvt_f32_i32 v49, v49
    v_cvt_f32_i32 v50, v50
    v_cvt_f32_i32 v51, v51
    v_cvt_pk_bf16_f32 v61, v36, v48
    v_cvt_pk_bf16_f32 v65, v37, v49
    v_cvt_pk_bf16_f32 v69, v38, v50
    v_cvt_pk_bf16_f32 v73, v39, v51
    s_waitcnt lgkmcnt(2)
    v_cvt_f32_i32 v40, v40
    v_cvt_f32_i32 v41, v41
    v_cvt_f32_i32 v42, v42
    v_cvt_f32_i32 v43, v43
    v_cvt_f32_i32 v52, v52
    v_cvt_f32_i32 v53, v53
    v_cvt_f32_i32 v54, v54
    v_cvt_f32_i32 v55, v55
    v_cvt_pk_bf16_f32 v77, v40, v52
    v_cvt_pk_bf16_f32 v81, v41, v53
    v_cvt_pk_bf16_f32 v85, v42, v54
    v_cvt_pk_bf16_f32 v89, v43, v55
    s_waitcnt lgkmcnt(0)
    v_cvt_f32_i32 v44, v44
    v_cvt_f32_i32 v45, v45
    v_cvt_f32_i32 v46, v46
    v_cvt_f32_i32 v47, v47
    v_cvt_f32_i32 v56, v56
    v_cvt_f32_i32 v57, v57
    v_cvt_f32_i32 v58, v58
    v_cvt_f32_i32 v59, v59
    v_cvt_pk_bf16_f32 v93, v44, v56
    v_cvt_pk_bf16_f32 v97, v45, v57
    v_cvt_pk_bf16_f32 v101, v46, v58
    v_cvt_pk_bf16_f32 v105, v47, v59
    v_add_u32 v13, s62, v12
    s_add_u32 s62, s62, 24576
    s_cmp_eq_u32 s62, 73728
    s_cselect_b32 s62, 0, s62
    s_barrier
    ds_read_b128 v[36:39], v13 offset:0
    ds_read_b128 v[48:51], v13 offset:3072
    ds_read_b128 v[40:43], v13 offset:256
    ds_read_b128 v[52:55], v13 offset:3328
    ds_read_b128 v[44:47], v13 offset:512
    ds_read_b128 v[56:59], v13 offset:3584
    s_waitcnt lgkmcnt(4)
    v_cvt_f32_i32 v36, v36
    v_cvt_f32_i32 v37, v37
    v_cvt_f32_i32 v38, v38
    v_cvt_f32_i32 v39, v39
    v_cvt_f32_i32 v48, v48
    v_cvt_f32_i32 v49, v49
    v_cvt_f32_i32 v50, v50
    v_cvt_f32_i32 v51, v51
    v_cvt_pk_bf16_f32 v62, v36, v48
    v_cvt_pk_bf16_f32 v66, v37, v49
    v_cvt_pk_bf16_f32 v70, v38, v50
    v_cvt_pk_bf16_f32 v74, v39, v51
    s_waitcnt lgkmcnt(2)
    v_cvt_f32_i32 v40, v40
    v_cvt_f32_i32 v41, v41
    v_cvt_f32_i32 v42, v42
    v_cvt_f32_i32 v43, v43
    v_cvt_f32_i32 v52, v52
    v_cvt_f32_i32 v53, v53
    v_cvt_f32_i32 v54, v54
    v_cvt_f32_i32 v55, v55
    v_cvt_pk_bf16_f32 v78, v40, v52
    v_cvt_pk_bf16_f32 v82, v41, v53
    v_cvt_pk_bf16_f32 v86, v42, v54
    v_cvt_pk_bf16_f32 v90, v43, v55
    s_waitcnt lgkmcnt(0)
    v_cvt_f32_i32 v44, v44
    v_cvt_f32_i32 v45, v45
    v_cvt_f32_i32 v46, v46
    v_cvt_f32_i32 v47, v47
    v_cvt_f32_i32 v56, v56
    v_cvt_f32_i32 v57, v57
    v_cvt_f32_i32 v58, v58
    v_cvt_f32_i32 v59, v59
    v_cvt_pk_bf16_f32 v94, v44, v56
    v_cvt_pk_bf16_f32 v98, v45, v57
    v_cvt_pk_bf16_f32 v102, v46, v58
    v_cvt_pk_bf16_f32 v106, v47, v59
    v_add_u32 v13, s62, v12
    s_add_u32 s62, s62, 24576
    s_cmp_eq_u32 s62, 73728
    s_cselect_b32 s62, 0, s62
    s_barrier
    ds_read_b128 v[36:39], v13 offset:0
    ds_read_b128 v[48:51], v13 offset:3072
    ds_read_b128 v[40:43], v13 offset:256
    ds_read_b128 v[52:55], v13 offset:3328
    ds_read_b128 v[44:47], v13 offset:512
    ds_read_b128 v[56:59], v13 offset:3584
    s_waitcnt lgkmcnt(4)
    v_cvt_f32_i32 v36, v36
    v_cvt_f32_i32 v37, v37
    v_cvt_f32_i32 v38, v38
    v_cvt_f32_i32 v39, v39
    v_cvt_f32_i32 v48, v48
    v_cvt_f32_i32 v49, v49
    v_cvt_f32_i32 v50, v50
    v_cvt_f32_i32 v51, v51
    v_cvt_pk_bf16_f32 v63, v36, v48
    v_cvt_pk_bf16_f32 v67, v37, v49
    v_cvt_pk_bf16_f32 v71, v38, v50
    v_cvt_pk_bf16_f32 v75, v39, v51
    s_waitcnt lgkmcnt(2)
    v_cvt_f32_i32 v40, v40
    v_cvt_f32_i32 v41, v41
    v_cvt_f32_i32 v42, v42
    v_mfma_f32_16x16x32_bf16 v[160:163], v[184:187], v[60:63], v[160:163]
    v_cvt_f32_i32 v43, v43
    v_cvt_f32_i32 v52, v52
    v_cvt_f32_i32 v53, v53
    v_mfma_f32_16x16x32_bf16 v[160:163], v[188:191], v[64:67], v[160:163]
    v_cvt_f32_i32 v54, v54
    v_cvt_f32_i32 v55, v55
    v_cvt_pk_bf16_f32 v79, v40, v52
    v_mfma_f32_16x16x32_bf16 v[160:163], v[192:195], v[68:71], v[160:163]
    v_cvt_pk_bf16_f32 v83, v41, v53
    v_cvt_pk_bf16_f32 v87, v42, v54
    v_cvt_pk_bf16_f32 v91, v43, v55
    v_mfma_f32_16x16x32_bf16 v[160:163], v[196:199], v[72:75], v[160:163]
    s_waitcnt lgkmcnt(0)
    v_cvt_f32_i32 v44, v44
    v_cvt_f32_i32 v45, v45
    v_cvt_f32_i32 v46, v46
    v_mfma_f32_16x16x32_bf16 v[164:167], v[184:187], v[76:79], v[164:167]
    v_cvt_f32_i32 v47, v47
    v_cvt_f32_i32 v56, v56
    v_cvt_f32_i32 v57, v57
    v_mfma_f32_16x16x32_bf16 v[164:167], v[188:191], v[80:83], v[164:167]
    v_cvt_f32_i32 v58, v58
    v_cvt_f32_i32 v59, v59
    v_cvt_pk_bf16_f32 v95, v44, v56
    v_mfma_f32_16x16x32_bf16 v[164:167], v[192:195], v[84:87], v[164:167]
    v_cvt_pk_bf16_f32 v99, v45, v57
    v_cvt_pk_bf16_f32 v103, v46, v58
    v_cvt_pk_bf16_f32 v107, v47, v59
    v_mfma_f32_16x16x32_bf16 v[164:167], v[196:199], v[88:91], v[164:167]
    v_mfma_f32_16x16x32_bf16 v[168:171], v[184:187], v[92:95], v[168:171]
    v_mfma_f32_16x16x32_bf16 v[168:171], v[188:191], v[96:99], v[168:171]
    v_mfma_f32_16x16x32_bf16 v[168:171], v[192:195], v[100:103], v[168:171]
    v_mfma_f32_16x16x32_bf16 v[168:171], v[196:199], v[104:107], v[168:171]
    v_add_u32 v13, s62, v12
    s_add_u32 s62, s62, 24576
    s_cmp_eq_u32 s62, 73728
    s_cselect_b32 s62, 0, s62
    s_barrier
    ds_read_b128 v[36:39], v13 offset:0
    ds_read_b128 v[48:51], v13 offset:3072
    ds_read_b128 v[40:43], v13 offset:256
    ds_read_b128 v[52:55], v13 offset:3328
    ds_read_b128 v[44:47], v13 offset:512
    ds_read_b128 v[56:59], v13 offset:3584
    s_waitcnt lgkmcnt(6)
    v_lshlrev_b32 v215, 16, v210
    v_and_b32 v216, s66, v210
    v_fma_f32 v215, v215, s64, -v14
    v_fma_f32 v216, v216, s64, -v14
    v_exp_f32 v215, v215
    v_exp_f32 v216, v216
    v_lshlrev_b32 v217, 16, v211
    v_lshlrev_b32 v218, 16, v212
    v_mul_f32 v217, v215, v217
    v_mul_f32 v218, v216, v218
    v_add_f32 v208, v208, v215
    v_cvt_pk_bf16_f32 v217, v217, v218
    v_add_f32 v208, v208, v216
    v_lshlrev_b32 v219, 16, v213
    v_lshlrev_b32 v220, 16, v214
    v_lshlrev_b32 v215, 16, v217
    v_and_b32 v216, s66, v217
    v_fmac_f32 v209, v215, v219
    v_fmac_f32 v209, v216, v220
    v_mov_b32_dpp v184, v217 quad_perm:[0,1,2,3] row_mask:0xf bank_mask:0x1
    v_mov_b32_dpp v185, v217 row_ror:12 row_mask:0xf bank_mask:0x1
    v_mov_b32_dpp v186, v217 row_ror:8 row_mask:0xf bank_mask:0x1
    v_mov_b32_dpp v187, v217 row_ror:4 row_mask:0xf bank_mask:0x1
    v_mov_b32_dpp v188, v217 row_ror:4 row_mask:0xf bank_mask:0x2
    v_mov_b32_dpp v189, v217 quad_perm:[0,1,2,3] row_mask:0xf bank_mask:0x2
    v_mov_b32_dpp v190, v217 row_ror:12 row_mask:0xf bank_mask:0x2
    v_mov_b32_dpp v191, v217 row_ror:8 row_mask:0xf bank_mask:0x2
    v_mov_b32_dpp v192, v217 row_ror:8 row_mask:0xf bank_mask:0x4
    v_mov_b32_dpp v193, v217 row_ror:4 row_mask:0xf bank_mask:0x4
    v_mov_b32_dpp v194, v217 quad_perm:[0,1,2,3] row_mask:0xf bank_mask:0x4
    v_mov_b32_dpp v195, v217 row_ror:12 row_mask:0xf bank_mask:0x4
    v_mov_b32_dpp v196, v217 row_ror:12 row_mask:0xf bank_mask:0x8
    v_mov_b32_dpp v197, v217 row_ror:8 row_mask:0xf bank_mask:0x8
    v_mov_b32_dpp v198, v217 row_ror:4 row_mask:0xf bank_mask:0x8
    v_mov_b32_dpp v199, v217 quad_perm:[0,1,2,3] row_mask:0xf bank_mask:0x8
    s_waitcnt lgkmcnt(4)
    v_cvt_f32_i32 v36, v36
    v_cvt_f32_i32 v37, v37
    v_cvt_f32_i32 v38, v38
    v_cvt_f32_i32 v39, v39
    v_cvt_f32_i32 v48, v48
    v_cvt_f32_i32 v49, v49
    v_cvt_f32_i32 v50, v50
    v_cvt_f32_i32 v51, v51
    v_cvt_pk_bf16_f32 v60, v36, v48
    v_cvt_pk_bf16_f32 v64, v37, v49
    v_cvt_pk_bf16_f32 v68, v38, v50
    v_cvt_pk_bf16_f32 v72, v39, v51
    s_waitcnt lgkmcnt(2)
    v_cvt_f32_i32 v40, v40
    v_cvt_f32_i32 v41, v41
    v_cvt_f32_i32 v42, v42
    v_cvt_f32_i32 v43, v43
    v_cvt_f32_i32 v52, v52
    v_cvt_f32_i32 v53, v53
    v_cvt_f32_i32 v54, v54
    v_cvt_f32_i32 v55, v55
    v_cvt_pk_bf16_f32 v76, v40, v52
    v_cvt_pk_bf16_f32 v80, v41, v53
    v_cvt_pk_bf16_f32 v84, v42, v54
    v_cvt_pk_bf16_f32 v88, v43, v55
    s_waitcnt lgkmcnt(0)
    v_cvt_f32_i32 v44, v44
    v_cvt_f32_i32 v45, v45
    v_cvt_f32_i32 v46, v46
    v_cvt_f32_i32 v47, v47
    v_cvt_f32_i32 v56, v56
    v_cvt_f32_i32 v57, v57
    v_cvt_f32_i32 v58, v58
    v_cvt_f32_i32 v59, v59
    v_cvt_pk_bf16_f32 v92, v44, v56
    v_cvt_pk_bf16_f32 v96, v45, v57
    v_cvt_pk_bf16_f32 v100, v46, v58
    v_cvt_pk_bf16_f32 v104, v47, v59
    v_add_u32 v11, 3072, v11
    s_add_u32 s63, s63, 1024
    v_add_u32 v211, s63, v7
    v_add_u32 v212, s63, v8
    ds_read_b32 v210, v11 offset:0
    ds_read_u16 v213, v211 offset:512
    ds_read_u16 v214, v212 offset:512
    ds_read_u16 v211, v211
    ds_read_u16 v212, v212
    v_add_u32 v13, s62, v12
    s_add_u32 s62, s62, 24576
    s_cmp_eq_u32 s62, 73728
    s_cselect_b32 s62, 0, s62
    s_barrier
    ds_read_b128 v[36:39], v13 offset:0
    ds_read_b128 v[48:51], v13 offset:3072
    ds_read_b128 v[40:43], v13 offset:256
    ds_read_b128 v[52:55], v13 offset:3328
    ds_read_b128 v[44:47], v13 offset:512
    ds_read_b128 v[56:59], v13 offset:3584
    s_waitcnt lgkmcnt(4)
    v_cvt_f32_i32 v36, v36
    v_cvt_f32_i32 v37, v37
    v_cvt_f32_i32 v38, v38
    v_cvt_f32_i32 v39, v39
    v_cvt_f32_i32 v48, v48
    v_cvt_f32_i32 v49, v49
    v_cvt_f32_i32 v50, v50
    v_cvt_f32_i32 v51, v51
    v_cvt_pk_bf16_f32 v61, v36, v48
    v_cvt_pk_bf16_f32 v65, v37, v49
    v_cvt_pk_bf16_f32 v69, v38, v50
    v_cvt_pk_bf16_f32 v73, v39, v51
    s_waitcnt lgkmcnt(2)
    v_cvt_f32_i32 v40, v40
    v_cvt_f32_i32 v41, v41
    v_cvt_f32_i32 v42, v42
    v_cvt_f32_i32 v43, v43
    v_cvt_f32_i32 v52, v52
    v_cvt_f32_i32 v53, v53
    v_cvt_f32_i32 v54, v54
    v_cvt_f32_i32 v55, v55
    v_cvt_pk_bf16_f32 v77, v40, v52
    v_cvt_pk_bf16_f32 v81, v41, v53
    v_cvt_pk_bf16_f32 v85, v42, v54
    v_cvt_pk_bf16_f32 v89, v43, v55
    s_waitcnt lgkmcnt(0)
    v_cvt_f32_i32 v44, v44
    v_cvt_f32_i32 v45, v45
    v_cvt_f32_i32 v46, v46
    v_cvt_f32_i32 v47, v47
    v_cvt_f32_i32 v56, v56
    v_cvt_f32_i32 v57, v57
    v_cvt_f32_i32 v58, v58
    v_cvt_f32_i32 v59, v59
    v_cvt_pk_bf16_f32 v93, v44, v56
    v_cvt_pk_bf16_f32 v97, v45, v57
    v_cvt_pk_bf16_f32 v101, v46, v58
    v_cvt_pk_bf16_f32 v105, v47, v59
    s_cmp_eq_u32 s74, 0
    s_cbranch_scc1 L_vnostat
    v_mov_b32 v22, 154884
    ds_read_b32 v22, v22
    s_nop 1
    v_add_f32_dpp v208, v208, v208 row_ror:4 row_mask:0xf bank_mask:0xf
    s_nop 1
    v_add_f32_dpp v208, v208, v208 row_ror:8 row_mask:0xf bank_mask:0xf
    v_mov_b32 v3, v208
    s_nop 1
    v_permlane16_swap_b32 v208, v3
    v_add_f32 v208, v208, v3
    v_mov_b32 v3, v208
    s_nop 1
    v_permlane32_swap_b32 v208, v3
    v_add_f32 v208, v208, v3
    s_nop 1
    v_add_f32_dpp v209, v209, v209 row_ror:4 row_mask:0xf bank_mask:0xf
    s_nop 1
    v_add_f32_dpp v209, v209, v209 row_ror:8 row_mask:0xf bank_mask:0xf
    v_mov_b32 v3, v209
    s_nop 1
    v_permlane16_swap_b32 v209, v3
    v_add_f32 v209, v209, v3
    v_mov_b32 v3, v209
    s_nop 1
    v_permlane32_swap_b32 v209, v3
    v_add_f32 v209, v209, v3
    v_mov_b32 v156, v14
    v_mov_b32 v157, v208
    v_mov_b32 v158, v209
    ds_write_b128 v155, v[156:159]
    v_add_u32 v153, 64, v153
L_vnostat:
    v_add_u32 v13, s62, v12
    s_add_u32 s62, s62, 24576
    s_cmp_eq_u32 s62, 73728
    s_cselect_b32 s62, 0, s62
    s_barrier
    ds_read_b128 v[36:39], v13 offset:0
    ds_read_b128 v[48:51], v13 offset:3072
    ds_read_b128 v[40:43], v13 offset:256
    ds_read_b128 v[52:55], v13 offset:3328
    ds_read_b128 v[44:47], v13 offset:512
    ds_read_b128 v[56:59], v13 offset:3584
    s_waitcnt lgkmcnt(4)
    v_cvt_f32_i32 v36, v36
    v_cvt_f32_i32 v37, v37
    v_cvt_f32_i32 v38, v38
    v_cvt_f32_i32 v39, v39
    v_cvt_f32_i32 v48, v48
    v_cvt_f32_i32 v49, v49
    v_cvt_f32_i32 v50, v50
    v_cvt_f32_i32 v51, v51
    v_cvt_pk_bf16_f32 v62, v36, v48
    v_cvt_pk_bf16_f32 v66, v37, v49
    v_cvt_pk_bf16_f32 v70, v38, v50
    v_cvt_pk_bf16_f32 v74, v39, v51
    s_waitcnt lgkmcnt(2)
    v_cvt_f32_i32 v40, v40
    v_cvt_f32_i32 v41, v41
    v_cvt_f32_i32 v42, v42
    v_cvt_f32_i32 v43, v43
    v_cvt_f32_i32 v52, v52
    v_cvt_f32_i32 v53, v53
    v_cvt_f32_i32 v54, v54
    v_cvt_f32_i32 v55, v55
    v_cvt_pk_bf16_f32 v78, v40, v52
    v_cvt_pk_bf16_f32 v82, v41, v53
    v_cvt_pk_bf16_f32 v86, v42, v54
    v_cvt_pk_bf16_f32 v90, v43, v55
    s_waitcnt lgkmcnt(0)
    v_cvt_f32_i32 v44, v44
    v_cvt_f32_i32 v45, v45
    v_cvt_f32_i32 v46, v46
    v_cvt_f32_i32 v47, v47
    v_cvt_f32_i32 v56, v56
    v_cvt_f32_i32 v57, v57
    v_cvt_f32_i32 v58, v58
    v_cvt_f32_i32 v59, v59
    v_cvt_pk_bf16_f32 v94, v44, v56
    v_cvt_pk_bf16_f32 v98, v45, v57
    v_cvt_pk_bf16_f32 v102, v46, v58
    v_cvt_pk_bf16_f32 v106, v47, v59
    v_add_u32 v13, s62, v12
    s_add_u32 s62, s62, 24576
    s_cmp_eq_u32 s62, 73728
    s_cselect_b32 s62, 0, s62
    s_barrier
    ds_read_b128 v[36:39], v13 offset:0
    ds_read_b128 v[48:51], v13 offset:3072
    ds_read_b128 v[40:43], v13 offset:256
    ds_read_b128 v[52:55], v13 offset:3328
    ds_read_b128 v[44:47], v13 offset:512
    ds_read_b128 v[56:59], v13 offset:3584
    s_waitcnt lgkmcnt(4)
    v_cvt_f32_i32 v36, v36
    v_cvt_f32_i32 v37, v37
    v_cvt_f32_i32 v38, v38
    v_cvt_f32_i32 v39, v39
    v_cvt_f32_i32 v48, v48
    v_cvt_f32_i32 v49, v49
    v_cvt_f32_i32 v50, v50
    v_cvt_f32_i32 v51, v51
    v_cvt_pk_bf16_f32 v63, v36, v48
    v_cvt_pk_bf16_f32 v67, v37, v49
    v_cvt_pk_bf16_f32 v71, v38, v50
    v_cvt_pk_bf16_f32 v75, v39, v51
    s_waitcnt lgkmcnt(2)
    v_cvt_f32_i32 v40, v40
    v_cvt_f32_i32 v41, v41
    v_cvt_f32_i32 v42, v42
    v_mfma_f32_16x16x32_bf16 v[160:163], v[184:187], v[60:63], v[160:163]
    v_cvt_f32_i32 v43, v43
    v_cvt_f32_i32 v52, v52
    v_cvt_f32_i32 v53, v53
    v_mfma_f32_16x16x32_bf16 v[160:163], v[188:191], v[64:67], v[160:163]
    v_cvt_f32_i32 v54, v54
    v_cvt_f32_i32 v55, v55
    v_cvt_pk_bf16_f32 v79, v40, v52
    v_mfma_f32_16x16x32_bf16 v[160:163], v[192:195], v[68:71], v[160:163]
    v_cvt_pk_bf16_f32 v83, v41, v53
    v_cvt_pk_bf16_f32 v87, v42, v54
    v_cvt_pk_bf16_f32 v91, v43, v55
    v_mfma_f32_16x16x32_bf16 v[160:163], v[196:199], v[72:75], v[160:163]
    s_waitcnt lgkmcnt(0)
    v_cvt_f32_i32 v44, v44
    v_cvt_f32_i32 v45, v45
    v_cvt_f32_i32 v46, v46
    v_mfma_f32_16x16x32_bf16 v[164:167], v[184:187], v[76:79], v[164:167]
    v_cvt_f32_i32 v47, v47
    v_cvt_f32_i32 v56, v56
    v_cvt_f32_i32 v57, v57
    v_mfma_f32_16x16x32_bf16 v[164:167], v[188:191], v[80:83], v[164:167]
    v_cvt_f32_i32 v58, v58
    v_cvt_f32_i32 v59, v59
    v_cvt_pk_bf16_f32 v95, v44, v56
    v_mfma_f32_16x16x32_bf16 v[164:167], v[192:195], v[84:87], v[164:167]
    v_cvt_pk_bf16_f32 v99, v45, v57
    v_cvt_pk_bf16_f32 v103, v46, v58
    v_cvt_pk_bf16_f32 v107, v47, v59
    v_mfma_f32_16x16x32_bf16 v[164:167], v[196:199], v[88:91], v[164:167]
    v_mfma_f32_16x16x32_bf16 v[168:171], v[184:187], v[92:95], v[168:171]
    v_mfma_f32_16x16x32_bf16 v[168:171], v[188:191], v[96:99], v[168:171]
    v_mfma_f32_16x16x32_bf16 v[168:171], v[192:195], v[100:103], v[168:171]
    v_mfma_f32_16x16x32_bf16 v[168:171], v[196:199], v[104:107], v[168:171]
    s_cmp_eq_u32 s74, 0
    s_cbranch_scc1 L_vblk
    ds_write_b128 v154, v[160:163]
    s_nop 0
    ds_write_b128 v154, v[164:167] offset:1024
    s_cmp_lt_u32 s61, 16
    s_nop 1
    ds_write_b128 v154, v[168:171] offset:2048
    s_waitcnt lgkmcnt(0)
    s_cbranch_scc1 L_vround
    s_barrier
    s_cmp_eq_u32 s56, 3
    s_cbranch_scc1 L_fin
    ds_read_b128 v[36:39], v18 offset:0
    ds_read_b128 v[40:43], v18 offset:64
    ds_read_b128 v[44:47], v18 offset:128
    ds_read_b128 v[48:51], v18 offset:192
    ds_read2st64_b32 v[60:61], v17 offset0:0 offset1:1
    ds_read2st64_b32 v[62:63], v17 offset0:2 offset1:3
    ds_read2st64_b32 v[64:65], v17 offset0:12 offset1:13
    ds_read2st64_b32 v[66:67], v17 offset0:14 offset1:15
    ds_read2st64_b32 v[68:69], v17 offset0:24 offset1:25
    ds_read2st64_b32 v[70:71], v17 offset0:26 offset1:27
    ds_read2st64_b32 v[72:73], v17 offset0:36 offset1:37
    ds_read2st64_b32 v[74:75], v17 offset0:38 offset1:39
    s_cmp_eq_u32 s101, 0
    s_cbranch_scc0 L_rp10
    buffer_load_dwordx4 v[172:175], v20, s[24:27], s69 offen sc1
    buffer_load_dwordx4 v[180:183], v20, s[24:27], s70 offen sc1
    buffer_load_dwordx4 v[168:171], v19, s[24:27], s69 offen sc1
    buffer_load_dwordx4 v[176:179], v19, s[24:27], s70 offen sc1
    s_branch L_rp12
L_rp10:
    s_cmp_eq_u32 s101, 1
    s_cbranch_scc0 L_rp11
    buffer_load_dwordx4 v[164:167], v20, s[24:27], s68 offen sc1
    buffer_load_dwordx4 v[180:183], v20, s[24:27], s70 offen sc1
    buffer_load_dwordx4 v[160:163], v19, s[24:27], s68 offen sc1
    buffer_load_dwordx4 v[176:179], v19, s[24:27], s70 offen sc1
    s_branch L_rp12
L_rp11:
    buffer_load_dwordx4 v[164:167], v20, s[24:27], s68 offen sc1
    buffer_load_dwordx4 v[172:175], v20, s[24:27], s69 offen sc1
    buffer_load_dwordx4 v[160:163], v19, s[24:27], s68 offen sc1
    buffer_load_dwordx4 v[168:171], v19, s[24:27], s69 offen sc1
L_rp12:
    s_waitcnt lgkmcnt(8)
    v_add_f32 v37, v37, v41
    v_add_f32 v45, v45, v49
    v_add_f32 v38, v38, v42
    v_add_f32 v46, v46, v50
    v_add_f32 v37, v37, v45
    v_add_f32 v38, v38, v46
    v_mov_b32 v39, v22
    s_waitcnt lgkmcnt(4)
    v_add_f32 v60, v60, v64
    v_add_f32 v61, v61, v65
    v_add_f32 v62, v62, v66
    v_add_f32 v63, v63, v67
    s_waitcnt lgkmcnt(0)
    v_add_f32 v68, v68, v72
    v_add_f32 v69, v69, v73
    v_add_f32 v70, v70, v74
    v_add_f32 v71, v71, v75
    v_add_f32 v60, v60, v68
    v_add_f32 v61, v61, v69
    v_add_f32 v62, v62, v70
    v_add_f32 v63, v63, v71
    v_sub_f32 v60, v60, v38
    v_sub_f32 v61, v61, v38
    v_sub_f32 v62, v62, v38
    v_sub_f32 v63, v63, v38
    s_cmp_eq_u32 s2, 255
    s_cbranch_scc1 L_rsolo
    v_perm_b32 v60, v60, v22, s84
    v_perm_b32 v61, v61, v22, s85
    v_perm_b32 v62, v62, v22, s86
    v_perm_b32 v63, v63, v22, s87
    buffer_store_dwordx4 v[60:63], v19, s[24:27], s71 offen sc1
    s_mov_b64 exec, 15
    buffer_store_dwordx4 v[36:39], v20, s[24:27], s71 offen sc1
    s_mov_b64 exec, -1
    s_cmp_eq_u32 s101, 0
    s_cbranch_scc0 L_rp20
    v_mov_b32 v160, v60
    v_mov_b32 v164, v36
    v_mov_b32 v161, v61
    v_mov_b32 v165, v37
    v_mov_b32 v162, v62
    v_mov_b32 v166, v38
    v_mov_b32 v163, v63
    v_mov_b32 v167, v39
    s_branch L_rp22
L_rp20:
    s_cmp_eq_u32 s101, 1
    s_cbranch_scc0 L_rp21
    v_mov_b32 v168, v60
    v_mov_b32 v172, v36
    v_mov_b32 v169, v61
    v_mov_b32 v173, v37
    v_mov_b32 v170, v62
    v_mov_b32 v174, v38
    v_mov_b32 v171, v63
    v_mov_b32 v175, v39
    s_branch L_rp22
L_rp21:
    v_mov_b32 v176, v60
    v_mov_b32 v180, v36
    v_mov_b32 v177, v61
    v_mov_b32 v181, v37
    v_mov_b32 v178, v62
    v_mov_b32 v182, v38
    v_mov_b32 v179, v63
    v_mov_b32 v183, v39
L_rp22:
    s_waitcnt vmcnt(4)
    v_xor_b32 v40, v167, v22
    v_xor_b32 v41, v175, v22
    v_xor_b32 v42, v183, v22
    v_or3_b32 v4, v40, v41, v42
    s_waitcnt vmcnt(2)
    v_perm_b32 v5, v161, v160, s88
    v_perm_b32 v6, v163, v162, s89
    v_bitop3_b32 v5, v5, v6, v22 bitop3:0x56
    v_or_b32 v4, v4, v5
    v_perm_b32 v5, v169, v168, s88
    v_perm_b32 v6, v171, v170, s89
    v_bitop3_b32 v5, v5, v6, v22 bitop3:0x56
    v_or_b32 v4, v4, v5
    v_perm_b32 v5, v177, v176, s88
    v_perm_b32 v6, v179, v178, s89
    v_bitop3_b32 v5, v5, v6, v22 bitop3:0x56
    v_or_b32 v4, v4, v5
    v_cmp_eq_u32 vcc, 0, v4
    s_nop 4
    s_cmp_eq_u64 vcc, -1
    s_cbranch_scc1 L_rmerge
    s_waitcnt vmcnt(0)
    s_cmp_eq_u32 s101, 0
    s_cbranch_scc0 L_rp30
    buffer_load_dwordx4 v[172:175], v20, s[24:27], s69 offen sc1
    buffer_load_dwordx4 v[180:183], v20, s[24:27], s70 offen sc1
    buffer_load_dwordx4 v[168:171], v19, s[24:27], s69 offen sc1
    buffer_load_dwordx4 v[176:179], v19, s[24:27], s70 offen sc1
    s_branch L_rp32
L_rp30:
    s_cmp_eq_u32 s101, 1
    s_cbranch_scc0 L_rp31
    buffer_load_dwordx4 v[164:167], v20, s[24:27], s68 offen sc1
    buffer_load_dwordx4 v[180:183], v20, s[24:27], s70 offen sc1
    buffer_load_dwordx4 v[160:163], v19, s[24:27], s68 offen sc1
    buffer_load_dwordx4 v[176:179], v19, s[24:27], s70 offen sc1
    s_branch L_rp32
L_rp31:
    buffer_load_dwordx4 v[164:167], v20, s[24:27], s68 offen sc1
    buffer_load_dwordx4 v[172:175], v20, s[24:27], s69 offen sc1
    buffer_load_dwordx4 v[160:163], v19, s[24:27], s68 offen sc1
    buffer_load_dwordx4 v[168:171], v19, s[24:27], s69 offen sc1
L_rp32:
    s_waitcnt vmcnt(2)
    v_xor_b32 v40, v167, v22
    v_xor_b32 v41, v175, v22
    v_xor_b32 v42, v183, v22
    v_or3_b32 v4, v40, v41, v42
    s_waitcnt vmcnt(0)
    v_perm_b32 v5, v161, v160, s88
    v_perm_b32 v6, v163, v162, s89
    v_bitop3_b32 v5, v5, v6, v22 bitop3:0x56
    v_or_b32 v4, v4, v5
    v_perm_b32 v5, v169, v168, s88
    v_perm_b32 v6, v171, v170, s89
    v_bitop3_b32 v5, v5, v6, v22 bitop3:0x56
    v_or_b32 v4, v4, v5
    v_perm_b32 v5, v177, v176, s88
    v_perm_b32 v6, v179, v178, s89
    v_bitop3_b32 v5, v5, v6, v22 bitop3:0x56
    v_or_b32 v4, v4, v5
    v_cmp_eq_u32 vcc, 0, v4
L_rmerge:
    v_max3_f32 v3, v164, v172, v180
    v_sub_f32 v164, v164, v3
    v_sub_f32 v172, v172, v3
    v_sub_f32 v180, v180, v3
    v_exp_f32 v164, v164
    v_exp_f32 v172, v172
    v_exp_f32 v180, v180
    s_and_b64 exec, exec, vcc
    s_cbranch_execz L_fin
    v_and_b32 v160, s90, v160
    v_and_b32 v161, s90, v161
    v_and_b32 v162, s90, v162
    v_and_b32 v163, s90, v163
    v_and_b32 v168, s90, v168
    v_and_b32 v169, s90, v169
    v_and_b32 v170, s90, v170
    v_and_b32 v171, s90, v171
    v_and_b32 v176, s90, v176
    v_and_b32 v177, s90, v177
    v_and_b32 v178, s90, v178
    v_and_b32 v179, s90, v179
    v_mul_f32 v37, v164, v165
    v_fmac_f32 v37, v172, v173
    v_fmac_f32 v37, v180, v181
    v_mul_f32 v60, v160, v164
    v_fmac_f32 v60, v168, v172
    v_fmac_f32 v60, v176, v180
    v_mul_f32 v61, v161, v164
    v_fmac_f32 v61, v169, v172
    v_fmac_f32 v61, v177, v180
    v_mul_f32 v62, v162, v164
    v_fmac_f32 v62, v170, v172
    v_fmac_f32 v62, v178, v180
    v_mul_f32 v63, v163, v164
    v_fmac_f32 v63, v171, v172
    v_fmac_f32 v63, v179, v180
L_rsolo:
    v_rcp_f32 v37, v37
    s_nop 0
    v_mul_f32 v60, v60, v37
    v_mul_f32 v61, v61, v37
    v_mul_f32 v62, v62, v37
    v_mul_f32 v63, v63, v37
    v_cvt_pk_bf16_f32 v64, v60, v61
    v_cvt_pk_bf16_f32 v65, v62, v63
    buffer_store_dwordx2 v[64:65], v21, s[48:51], s57 offen
    s_branch L_fin
L_finisher:
    v_and_b32 v14, 3, v1
    v_mul_u32_u24 v8, 384, v14
    v_lshrrev_b32 v13, 2, v1
    v_lshl_add_u32 v8, v13, 3, v8
    v_lshlrev_b32 v9, 4, v1
    v_lshlrev_b32 v14, 4, v14
    s_memrealtime s[96:97]
    s_waitcnt lgkmcnt(0)
    s_mov_b32 s48, s18
    s_and_b32 s49, s19, 0xffff
    s_mov_b32 s50, 393216
    s_mov_b32 s51, 0x20000
    s_mov_b32 s52, s20
    s_and_b32 s53, s21, 0xffff
    s_mov_b32 s54, 256
    s_mov_b32 s55, 0x20000
    s_mov_b32 s24, s22
    s_and_b32 s25, s23, 0xffff
    s_mov_b32 s26, 2528256
    s_mov_b32 s27, 0x20000
    s_cmp_eq_u32 s2, 0
    s_cbranch_scc0 L_fk
    s_or_b32 s71, s96, 1
    v_mov_b32 v16, s71
    v_mov_b32 v17, 0
    s_mov_b64 exec, 1
    buffer_atomic_cmpswap v[16:17], v9, s[52:55], 0 offen sc0 sc1
    s_mov_b64 exec, -1
    s_waitcnt vmcnt(0)
    v_readfirstlane_b32 s58, v16
    s_nop 3
    s_cmp_eq_u32 s58, 0
    s_cselect_b32 s71, s71, s58
L_fk:
    s_movk_i32 s69, 128
L_fb1:
    s_barrier
    s_sub_u32 s69, s69, 1
    s_cmp_lg_u32 s69, 0
    s_cbranch_scc1 L_fb1
    s_load_dword s71, s[20:21], 0
    s_barrier
    s_waitcnt lgkmcnt(0)
    s_cmp_eq_u32 s71, 0
    s_cbranch_scc0 L_ftag
    s_or_b32 s71, s96, 1
    v_mov_b32 v16, s71
    v_mov_b32 v17, 0
    s_mov_b64 exec, 1
    buffer_atomic_cmpswap v[16:17], v9, s[52:55], 0 offen sc0 sc1
    s_mov_b64 exec, -1
    s_waitcnt vmcnt(0)
    v_readfirstlane_b32 s58, v16
    s_nop 3
    s_cmp_eq_u32 s58, 0
    s_cselect_b32 s71, s71, s58
L_ftag:
    v_mov_b32 v10, s71
    v_mov_b32 v13, 154884
    ds_write_b32 v13, v10
    s_lshr_b32 s63, s101, 1
    s_lshl_b32 s58, s100, 1
    s_add_u32 s63, s63, s58
    s_mul_i32 s62, s63, 8704
    s_add_u32 s62, s62, 1048576
    s_waitcnt lgkmcnt(0)
    s_cmp_eq_u32 s2, 255
    s_cbranch_scc1 L_fin
    s_cmp_eq_u32 s101, 1
    s_cbranch_scc1 L_fmid
    s_movk_i32 s69, 89
L_fb2:
    s_barrier
    s_sub_u32 s69, s69, 1
    s_cmp_lg_u32 s69, 0
    s_cbranch_scc1 L_fb2
    v_add_u32 v13, 142336, v14
    v_lshlrev_b32 v11, 2, v1
    v_add_u32 v11, 142592, v11
    ds_read_b128 v[16:19], v13 offset:0
    ds_read_b128 v[20:23], v13 offset:64
    ds_read_b128 v[24:27], v13 offset:128
    ds_read_b128 v[28:31], v13 offset:192
    ds_read2st64_b32 v[32:33], v11 offset0:0 offset1:1
    ds_read2st64_b32 v[34:35], v11 offset0:2 offset1:3
    ds_read2st64_b32 v[36:37], v11 offset0:4 offset1:5
    ds_read2st64_b32 v[38:39], v11 offset0:6 offset1:7
    ds_read2st64_b32 v[40:41], v11 offset0:8 offset1:9
    ds_read2st64_b32 v[42:43], v11 offset0:10 offset1:11
    ds_read2st64_b32 v[44:45], v11 offset0:12 offset1:13
    ds_read2st64_b32 v[46:47], v11 offset0:14 offset1:15
    s_waitcnt lgkmcnt(4)
    ds_read2st64_b32 v[48:49], v11 offset0:16 offset1:17
    ds_read2st64_b32 v[50:51], v11 offset0:18 offset1:19
    ds_read2st64_b32 v[52:53], v11 offset0:20 offset1:21
    ds_read2st64_b32 v[54:55], v11 offset0:22 offset1:23
    ds_read2st64_b32 v[56:57], v11 offset0:24 offset1:25
    ds_read2st64_b32 v[58:59], v11 offset0:26 offset1:27
    ds_read2st64_b32 v[60:61], v11 offset0:28 offset1:29
    ds_read2st64_b32 v[62:63], v11 offset0:30 offset1:31
    s_waitcnt lgkmcnt(4)
    ds_read2st64_b32 v[64:65], v11 offset0:32 offset1:33
    ds_read2st64_b32 v[66:67], v11 offset0:34 offset1:35
    ds_read2st64_b32 v[68:69], v11 offset0:36 offset1:37
    ds_read2st64_b32 v[70:71], v11 offset0:38 offset1:39
    ds_read2st64_b32 v[72:73], v11 offset0:40 offset1:41
    ds_read2st64_b32 v[74:75], v11 offset0:42 offset1:43
    ds_read2st64_b32 v[76:77], v11 offset0:44 offset1:45
    ds_read2st64_b32 v[78:79], v11 offset0:46 offset1:47
    v_mov_b32 v83, v10
    v_mov_b32 v87, v10
    v_mov_b32 v91, v10
    v_mov_b32 v95, v10
    v_mov_b32 v99, v10
    v_mov_b32 v96, v16
    v_add_f32 v17, v17, v21
    v_add_f32 v25, v25, v29
    v_add_f32 v97, v17, v25
    v_add_f32 v18, v18, v22
    v_add_f32 v26, v26, v30
    v_add_f32 v98, v18, v26
    s_waitcnt lgkmcnt(0)
    v_add_f32 v32, v32, v44
    v_add_f32 v56, v56, v68
    v_add_f32 v32, v32, v56
    v_sub_f32 v80, v32, v98
    v_add_f32 v33, v33, v45
    v_add_f32 v57, v57, v69
    v_add_f32 v33, v33, v57
    v_sub_f32 v81, v33, v98
    v_add_f32 v34, v34, v46
    v_add_f32 v58, v58, v70
    v_add_f32 v34, v34, v58
    v_sub_f32 v82, v34, v98
    v_add_f32 v35, v35, v47
    v_add_f32 v59, v59, v71
    v_add_f32 v35, v35, v59
    v_sub_f32 v84, v35, v98
    v_add_f32 v36, v36, v48
    v_add_f32 v60, v60, v72
    v_add_f32 v36, v36, v60
    v_sub_f32 v85, v36, v98
    v_add_f32 v37, v37, v49
    v_add_f32 v61, v61, v73
    v_add_f32 v37, v37, v61
    v_sub_f32 v86, v37, v98
    v_add_f32 v38, v38, v50
    v_add_f32 v62, v62, v74
    v_add_f32 v38, v38, v62
    v_sub_f32 v88, v38, v98
    v_add_f32 v39, v39, v51
    v_add_f32 v63, v63, v75
    v_add_f32 v39, v39, v63
    v_sub_f32 v89, v39, v98
    v_add_f32 v40, v40, v52
    v_add_f32 v64, v64, v76
    v_add_f32 v40, v40, v64
    v_sub_f32 v90, v40, v98
    v_add_f32 v41, v41, v53
    v_add_f32 v65, v65, v77
    v_add_f32 v41, v41, v65
    v_sub_f32 v92, v41, v98
    v_add_f32 v42, v42, v54
    v_add_f32 v66, v66, v78
    v_add_f32 v42, v42, v66
    v_sub_f32 v93, v42, v98
    v_add_f32 v43, v43, v55
    v_add_f32 v67, v67, v79
    v_add_f32 v43, v43, v67
    v_sub_f32 v94, v43, v98
    s_movk_i32 s69, 39
L_fb3:
    s_barrier
    s_sub_u32 s69, s69, 1
    s_cmp_lg_u32 s69, 0
    s_cbranch_scc1 L_fb3
    s_barrier
    s_mov_b32 s69, 2
L_fo5:
    s_add_u32 s58, s62, 4352
    s_add_u32 s59, s62, 8448
    buffer_load_dwordx4 v[116:119], v14, s[24:27], s59 offen sc1
    buffer_load_dwordx4 v[100:103], v9, s[24:27], s58 offen offset:0 sc1
    buffer_load_dwordx4 v[104:107], v9, s[24:27], s58 offen offset:1024 sc1
    buffer_load_dwordx4 v[108:111], v9, s[24:27], s58 offen offset:2048 sc1
    buffer_load_dwordx4 v[112:115], v9, s[24:27], s58 offen offset:3072 sc1
    s_waitcnt vmcnt(0)
    v_xor_b32 v13, v10, v103
    v_xor_b32 v11, v10, v107
    v_or_b32 v13, v13, v11
    v_xor_b32 v11, v10, v111
    v_or_b32 v13, v13, v11
    v_xor_b32 v11, v10, v115
    v_or_b32 v13, v13, v11
    v_xor_b32 v11, v10, v119
    v_or_b32 v13, v13, v11
    v_cmp_ne_u32 vcc, 0, v13
    s_nop 4
    s_cmp_eq_u64 vcc, 0
    s_cbranch_scc1 L_fo7
    s_sub_u32 s69, s69, 1
    s_cmp_lg_u32 s69, 0
    s_cbranch_scc1 L_fo5
    s_add_u32 s58, s62, 0
    s_add_u32 s59, s62, 4096
    buffer_store_dwordx4 v[80:83], v9, s[24:27], s58 offen offset:0 sc1
    buffer_store_dwordx4 v[84:87], v9, s[24:27], s58 offen offset:1024 sc1
    buffer_store_dwordx4 v[88:91], v9, s[24:27], s58 offen offset:2048 sc1
    buffer_store_dwordx4 v[92:95], v9, s[24:27], s58 offen offset:3072 sc1
    s_mov_b64 exec, 15
    buffer_store_dwordx4 v[96:99], v14, s[24:27], s59 offen sc1
    s_mov_b64 exec, -1
    s_waitcnt vmcnt(0)
    s_add_u32 s58, s62, 4352
    s_add_u32 s59, s62, 8448
    buffer_load_dwordx4 v[116:119], v14, s[24:27], s59 offen sc1
    buffer_load_dwordx4 v[100:103], v9, s[24:27], s58 offen offset:0 sc1
    buffer_load_dwordx4 v[104:107], v9, s[24:27], s58 offen offset:1024 sc1
    buffer_load_dwordx4 v[108:111], v9, s[24:27], s58 offen offset:2048 sc1
    buffer_load_dwordx4 v[112:115], v9, s[24:27], s58 offen offset:3072 sc1
    s_waitcnt vmcnt(0)
    v_xor_b32 v13, v10, v103
    v_xor_b32 v11, v10, v107
    v_or_b32 v13, v13, v11
    v_xor_b32 v11, v10, v111
    v_or_b32 v13, v13, v11
    v_xor_b32 v11, v10, v115
    v_or_b32 v13, v13, v11
    v_xor_b32 v11, v10, v119
    v_or_b32 v13, v13, v11
    v_cmp_ne_u32 vcc, 0, v13
    s_nop 4
    s_cmp_eq_u64 vcc, 0
    s_cbranch_scc0 L_fin
L_fo7:
    v_max_f32 v11, v96, v116
    v_sub_f32 v16, v96, v11
    v_sub_f32 v17, v116, v11
    v_exp_f32 v16, v16
    v_exp_f32 v17, v17
    s_nop 0
    v_mul_f32 v12, v16, v97
    v_fmac_f32 v12, v17, v117
    v_rcp_f32 v12, v12
    s_add_u32 s58, s63, 0
    s_mul_i32 s58, s58, 1536
    v_mul_f32 v16, v16, v12
    v_mul_f32 v17, v17, v12
    v_mul_f32 v32, v80, v16
    v_fmac_f32 v32, v100, v17
    v_mul_f32 v33, v81, v16
    v_fmac_f32 v33, v101, v17
    v_mul_f32 v34, v82, v16
    v_fmac_f32 v34, v102, v17
    v_mul_f32 v35, v84, v16
    v_fmac_f32 v35, v104, v17
    v_mul_f32 v36, v85, v16
    v_fmac_f32 v36, v105, v17
    v_mul_f32 v37, v86, v16
    v_fmac_f32 v37, v106, v17
    v_mul_f32 v38, v88, v16
    v_fmac_f32 v38, v108, v17
    v_mul_f32 v39, v89, v16
    v_fmac_f32 v39, v109, v17
    v_mul_f32 v40, v90, v16
    v_fmac_f32 v40, v110, v17
    v_mul_f32 v41, v92, v16
    v_fmac_f32 v41, v112, v17
    v_mul_f32 v42, v93, v16
    v_fmac_f32 v42, v113, v17
    v_mul_f32 v43, v94, v16
    v_fmac_f32 v43, v114, v17
    v_cvt_pk_bf16_f32 v44, v32, v33
    v_cvt_pk_bf16_f32 v45, v34, v35
    v_cvt_pk_bf16_f32 v46, v36, v37
    v_cvt_pk_bf16_f32 v47, v38, v39
    v_cvt_pk_bf16_f32 v48, v40, v41
    v_cvt_pk_bf16_f32 v49, v42, v43
    buffer_store_dwordx2 v[44:45], v8, s[48:51], s58 offen offset:0
    buffer_store_dwordx2 v[46:47], v8, s[48:51], s58 offen offset:128
    buffer_store_dwordx2 v[48:49], v8, s[48:51], s58 offen offset:256
    s_branch L_fin
L_fmid:
    v_and_b32 v7, 1, v1
    v_mul_u32_u24 v7, 8704, v7
    v_add_u32 v7, 4108, v7
    s_movk_i32 s69, 41
L_fb4:
    s_barrier
    s_sub_u32 s69, s69, 1
    s_cmp_lg_u32 s69, 0
    s_cbranch_scc1 L_fb4
    v_add_u32 v13, 142336, v14
    v_lshlrev_b32 v11, 2, v1
    v_add_u32 v11, 142592, v11
    ds_read_b128 v[16:19], v13 offset:0
    ds_read_b128 v[20:23], v13 offset:64
    ds_read_b128 v[24:27], v13 offset:128
    ds_read_b128 v[28:31], v13 offset:192
    ds_read2st64_b32 v[32:33], v11 offset0:0 offset1:1
    ds_read2st64_b32 v[34:35], v11 offset0:2 offset1:3
    ds_read2st64_b32 v[36:37], v11 offset0:4 offset1:5
    ds_read2st64_b32 v[38:39], v11 offset0:6 offset1:7
    ds_read2st64_b32 v[40:41], v11 offset0:8 offset1:9
    ds_read2st64_b32 v[42:43], v11 offset0:10 offset1:11
    ds_read2st64_b32 v[44:45], v11 offset0:12 offset1:13
    ds_read2st64_b32 v[46:47], v11 offset0:14 offset1:15
    s_waitcnt lgkmcnt(4)
    ds_read2st64_b32 v[48:49], v11 offset0:16 offset1:17
    ds_read2st64_b32 v[50:51], v11 offset0:18 offset1:19
    ds_read2st64_b32 v[52:53], v11 offset0:20 offset1:21
    ds_read2st64_b32 v[54:55], v11 offset0:22 offset1:23
    ds_read2st64_b32 v[56:57], v11 offset0:24 offset1:25
    ds_read2st64_b32 v[58:59], v11 offset0:26 offset1:27
    ds_read2st64_b32 v[60:61], v11 offset0:28 offset1:29
    ds_read2st64_b32 v[62:63], v11 offset0:30 offset1:31
    s_waitcnt lgkmcnt(4)
    ds_read2st64_b32 v[64:65], v11 offset0:32 offset1:33
    ds_read2st64_b32 v[66:67], v11 offset0:34 offset1:35
    ds_read2st64_b32 v[68:69], v11 offset0:36 offset1:37
    ds_read2st64_b32 v[70:71], v11 offset0:38 offset1:39
    ds_read2st64_b32 v[72:73], v11 offset0:40 offset1:41
    ds_read2st64_b32 v[74:75], v11 offset0:42 offset1:43
    ds_read2st64_b32 v[76:77], v11 offset0:44 offset1:45
    ds_read2st64_b32 v[78:79], v11 offset0:46 offset1:47
    v_mov_b32 v83, v10
    v_mov_b32 v87, v10
    v_mov_b32 v91, v10
    v_mov_b32 v95, v10
    v_mov_b32 v99, v10
    v_mov_b32 v96, v16
    v_add_f32 v17, v17, v21
    v_add_f32 v25, v25, v29
    v_add_f32 v97, v17, v25
    v_add_f32 v18, v18, v22
    v_add_f32 v26, v26, v30
    v_add_f32 v98, v18, v26
    s_waitcnt lgkmcnt(0)
    v_add_f32 v32, v32, v44
    v_add_f32 v56, v56, v68
    v_add_f32 v32, v32, v56
    v_sub_f32 v80, v32, v98
    v_add_f32 v33, v33, v45
    v_add_f32 v57, v57, v69
    v_add_f32 v33, v33, v57
    v_sub_f32 v81, v33, v98
    v_add_f32 v34, v34, v46
    v_add_f32 v58, v58, v70
    v_add_f32 v34, v34, v58
    v_sub_f32 v82, v34, v98
    v_add_f32 v35, v35, v47
    v_add_f32 v59, v59, v71
    v_add_f32 v35, v35, v59
    v_sub_f32 v84, v35, v98
    v_add_f32 v36, v36, v48
    v_add_f32 v60, v60, v72
    v_add_f32 v36, v36, v60
    v_sub_f32 v85, v36, v98
    v_add_f32 v37, v37, v49
    v_add_f32 v61, v61, v73
    v_add_f32 v37, v37, v61
    v_sub_f32 v86, v37, v98
    v_add_f32 v38, v38, v50
    v_add_f32 v62, v62, v74
    v_add_f32 v38, v38, v62
    v_sub_f32 v88, v38, v98
    v_add_f32 v39, v39, v51
    v_add_f32 v63, v63, v75
    v_add_f32 v39, v39, v63
    v_sub_f32 v89, v39, v98
    v_add_f32 v40, v40, v52
    v_add_f32 v64, v64, v76
    v_add_f32 v40, v40, v64
    v_sub_f32 v90, v40, v98
    v_add_f32 v41, v41, v53
    v_add_f32 v65, v65, v77
    v_add_f32 v41, v41, v65
    v_sub_f32 v92, v41, v98
    v_add_f32 v42, v42, v54
    v_add_f32 v66, v66, v78
    v_add_f32 v42, v42, v66
    v_sub_f32 v93, v42, v98
    v_add_f32 v43, v43, v55
    v_add_f32 v67, v67, v79
    v_add_f32 v43, v43, v67
    v_sub_f32 v94, v43, v98
    s_movk_i32 s69, 40
L_fb5:
    s_barrier
    s_sub_u32 s69, s69, 1
    s_cmp_lg_u32 s69, 0
    s_cbranch_scc1 L_fb5
    v_add_u32 v13, 142336, v14
    v_lshlrev_b32 v11, 2, v1
    v_add_u32 v11, 142592, v11
    ds_read_b128 v[16:19], v13 offset:0
    ds_read_b128 v[20:23], v13 offset:64
    ds_read_b128 v[24:27], v13 offset:128
    ds_read_b128 v[28:31], v13 offset:192
    ds_read2st64_b32 v[32:33], v11 offset0:0 offset1:1
    ds_read2st64_b32 v[34:35], v11 offset0:2 offset1:3
    ds_read2st64_b32 v[36:37], v11 offset0:4 offset1:5
    ds_read2st64_b32 v[38:39], v11 offset0:6 offset1:7
    ds_read2st64_b32 v[40:41], v11 offset0:8 offset1:9
    ds_read2st64_b32 v[42:43], v11 offset0:10 offset1:11
    ds_read2st64_b32 v[44:45], v11 offset0:12 offset1:13
    ds_read2st64_b32 v[46:47], v11 offset0:14 offset1:15
    s_waitcnt lgkmcnt(4)
    ds_read2st64_b32 v[48:49], v11 offset0:16 offset1:17
    ds_read2st64_b32 v[50:51], v11 offset0:18 offset1:19
    ds_read2st64_b32 v[52:53], v11 offset0:20 offset1:21
    ds_read2st64_b32 v[54:55], v11 offset0:22 offset1:23
    ds_read2st64_b32 v[56:57], v11 offset0:24 offset1:25
    ds_read2st64_b32 v[58:59], v11 offset0:26 offset1:27
    ds_read2st64_b32 v[60:61], v11 offset0:28 offset1:29
    ds_read2st64_b32 v[62:63], v11 offset0:30 offset1:31
    s_waitcnt lgkmcnt(4)
    ds_read2st64_b32 v[64:65], v11 offset0:32 offset1:33
    ds_read2st64_b32 v[66:67], v11 offset0:34 offset1:35
    ds_read2st64_b32 v[68:69], v11 offset0:36 offset1:37
    ds_read2st64_b32 v[70:71], v11 offset0:38 offset1:39
    ds_read2st64_b32 v[72:73], v11 offset0:40 offset1:41
    ds_read2st64_b32 v[74:75], v11 offset0:42 offset1:43
    ds_read2st64_b32 v[76:77], v11 offset0:44 offset1:45
    ds_read2st64_b32 v[78:79], v11 offset0:46 offset1:47
    v_mov_b32 v103, v10
    v_mov_b32 v107, v10
    v_mov_b32 v111, v10
    v_mov_b32 v115, v10
    v_mov_b32 v119, v10
    v_mov_b32 v116, v16
    v_add_f32 v17, v17, v21
    v_add_f32 v25, v25, v29
    v_add_f32 v117, v17, v25
    v_add_f32 v18, v18, v22
    v_add_f32 v26, v26, v30
    v_add_f32 v118, v18, v26
    s_waitcnt lgkmcnt(0)
    v_add_f32 v32, v32, v44
    v_add_f32 v56, v56, v68
    v_add_f32 v32, v32, v56
    v_sub_f32 v100, v32, v118
    v_add_f32 v33, v33, v45
    v_add_f32 v57, v57, v69
    v_add_f32 v33, v33, v57
    v_sub_f32 v101, v33, v118
    v_add_f32 v34, v34, v46
    v_add_f32 v58, v58, v70
    v_add_f32 v34, v34, v58
    v_sub_f32 v102, v34, v118
    v_add_f32 v35, v35, v47
    v_add_f32 v59, v59, v71
    v_add_f32 v35, v35, v59
    v_sub_f32 v104, v35, v118
    v_add_f32 v36, v36, v48
    v_add_f32 v60, v60, v72
    v_add_f32 v36, v36, v60
    v_sub_f32 v105, v36, v118
    v_add_f32 v37, v37, v49
    v_add_f32 v61, v61, v73
    v_add_f32 v37, v37, v61
    v_sub_f32 v106, v37, v118
    v_add_f32 v38, v38, v50
    v_add_f32 v62, v62, v74
    v_add_f32 v38, v38, v62
    v_sub_f32 v108, v38, v118
    v_add_f32 v39, v39, v51
    v_add_f32 v63, v63, v75
    v_add_f32 v39, v39, v63
    v_sub_f32 v109, v39, v118
    v_add_f32 v40, v40, v52
    v_add_f32 v64, v64, v76
    v_add_f32 v40, v40, v64
    v_sub_f32 v110, v40, v118
    v_add_f32 v41, v41, v53
    v_add_f32 v65, v65, v77
    v_add_f32 v41, v41, v65
    v_sub_f32 v112, v41, v118
    v_add_f32 v42, v42, v54
    v_add_f32 v66, v66, v78
    v_add_f32 v42, v42, v66
    v_sub_f32 v113, v42, v118
    v_add_f32 v43, v43, v55
    v_add_f32 v67, v67, v79
    v_add_f32 v43, v43, v67
    v_sub_f32 v114, v43, v118
    s_movk_i32 s69, 46
L_fb6:
    s_barrier
    s_sub_u32 s69, s69, 1
    s_cmp_lg_u32 s69, 0
    s_cbranch_scc1 L_fb6
    s_add_u32 s58, s62, 4352
    s_add_u32 s59, s62, 8448
    buffer_store_dwordx4 v[80:83], v9, s[24:27], s58 offen offset:0 sc1
    buffer_store_dwordx4 v[84:87], v9, s[24:27], s58 offen offset:1024 sc1
    buffer_store_dwordx4 v[88:91], v9, s[24:27], s58 offen offset:2048 sc1
    buffer_store_dwordx4 v[92:95], v9, s[24:27], s58 offen offset:3072 sc1
    s_mov_b64 exec, 15
    buffer_store_dwordx4 v[96:99], v14, s[24:27], s59 offen sc1
    s_mov_b64 exec, -1
    s_add_u32 s58, s62, 13056
    s_add_u32 s59, s62, 17152
    buffer_store_dwordx4 v[100:103], v9, s[24:27], s58 offen offset:0 sc1
    buffer_store_dwordx4 v[104:107], v9, s[24:27], s58 offen offset:1024 sc1
    buffer_store_dwordx4 v[108:111], v9, s[24:27], s58 offen offset:2048 sc1
    buffer_store_dwordx4 v[112:115], v9, s[24:27], s58 offen offset:3072 sc1
    s_mov_b64 exec, 15
    buffer_store_dwordx4 v[116:119], v14, s[24:27], s59 offen sc1
    s_mov_b64 exec, -1
    s_barrier
    s_barrier
    s_waitcnt vmcnt(0)
    buffer_load_dword v15, v7, s[24:27], s62 offen sc1
    s_waitcnt vmcnt(0)
    v_cmp_eq_u32 vcc, v15, v10
    s_nop 4
    s_and_b32 s70, vcc_lo, 3
    s_cbranch_scc0 L_fin
    s_bitcmp1_b32 s70, 0
    s_cbranch_scc0 L_fm30
    s_waitcnt vmcnt(0)
    s_add_u32 s58, s62, 0
    s_add_u32 s59, s62, 4096
    buffer_load_dwordx4 v[136:139], v14, s[24:27], s59 offen sc1
    buffer_load_dwordx4 v[120:123], v9, s[24:27], s58 offen offset:0 sc1
    buffer_load_dwordx4 v[124:127], v9, s[24:27], s58 offen offset:1024 sc1
    buffer_load_dwordx4 v[128:131], v9, s[24:27], s58 offen offset:2048 sc1
    buffer_load_dwordx4 v[132:135], v9, s[24:27], s58 offen offset:3072 sc1
    s_waitcnt vmcnt(0)
    v_xor_b32 v13, v10, v123
    v_xor_b32 v11, v10, v127
    v_or_b32 v13, v13, v11
    v_xor_b32 v11, v10, v131
    v_or_b32 v13, v13, v11
    v_xor_b32 v11, v10, v135
    v_or_b32 v13, v13, v11
    v_xor_b32 v11, v10, v139
    v_or_b32 v13, v13, v11
    v_cmp_ne_u32 vcc, 0, v13
    s_nop 4
    s_cmp_eq_u64 vcc, 0
    s_cbranch_scc0 L_fm30
    v_max_f32 v11, v136, v96
    v_sub_f32 v16, v136, v11
    v_sub_f32 v17, v96, v11
    v_exp_f32 v16, v16
    v_exp_f32 v17, v17
    s_nop 0
    v_mul_f32 v12, v16, v137
    v_fmac_f32 v12, v17, v97
    v_rcp_f32 v12, v12
    s_add_u32 s58, s63, 0
    s_mul_i32 s58, s58, 1536
    v_mul_f32 v16, v16, v12
    v_mul_f32 v17, v17, v12
    v_mul_f32 v32, v120, v16
    v_fmac_f32 v32, v80, v17
    v_mul_f32 v33, v121, v16
    v_fmac_f32 v33, v81, v17
    v_mul_f32 v34, v122, v16
    v_fmac_f32 v34, v82, v17
    v_mul_f32 v35, v124, v16
    v_fmac_f32 v35, v84, v17
    v_mul_f32 v36, v125, v16
    v_fmac_f32 v36, v85, v17
    v_mul_f32 v37, v126, v16
    v_fmac_f32 v37, v86, v17
    v_mul_f32 v38, v128, v16
    v_fmac_f32 v38, v88, v17
    v_mul_f32 v39, v129, v16
    v_fmac_f32 v39, v89, v17
    v_mul_f32 v40, v130, v16
    v_fmac_f32 v40, v90, v17
    v_mul_f32 v41, v132, v16
    v_fmac_f32 v41, v92, v17
    v_mul_f32 v42, v133, v16
    v_fmac_f32 v42, v93, v17
    v_mul_f32 v43, v134, v16
    v_fmac_f32 v43, v94, v17
    v_cvt_pk_bf16_f32 v44, v32, v33
    v_cvt_pk_bf16_f32 v45, v34, v35
    v_cvt_pk_bf16_f32 v46, v36, v37
    v_cvt_pk_bf16_f32 v47, v38, v39
    v_cvt_pk_bf16_f32 v48, v40, v41
    v_cvt_pk_bf16_f32 v49, v42, v43
    buffer_store_dwordx2 v[44:45], v8, s[48:51], s58 offen offset:0
    buffer_store_dwordx2 v[46:47], v8, s[48:51], s58 offen offset:128
    buffer_store_dwordx2 v[48:49], v8, s[48:51], s58 offen offset:256
L_fm30:
    s_bitcmp1_b32 s70, 1
    s_cbranch_scc0 L_fm31
    s_waitcnt vmcnt(0)
    s_add_u32 s58, s62, 8704
    s_add_u32 s59, s62, 12800
    buffer_load_dwordx4 v[136:139], v14, s[24:27], s59 offen sc1
    buffer_load_dwordx4 v[120:123], v9, s[24:27], s58 offen offset:0 sc1
    buffer_load_dwordx4 v[124:127], v9, s[24:27], s58 offen offset:1024 sc1
    buffer_load_dwordx4 v[128:131], v9, s[24:27], s58 offen offset:2048 sc1
    buffer_load_dwordx4 v[132:135], v9, s[24:27], s58 offen offset:3072 sc1
    s_waitcnt vmcnt(0)
    v_xor_b32 v13, v10, v123
    v_xor_b32 v11, v10, v127
    v_or_b32 v13, v13, v11
    v_xor_b32 v11, v10, v131
    v_or_b32 v13, v13, v11
    v_xor_b32 v11, v10, v135
    v_or_b32 v13, v13, v11
    v_xor_b32 v11, v10, v139
    v_or_b32 v13, v13, v11
    v_cmp_ne_u32 vcc, 0, v13
    s_nop 4
    s_cmp_eq_u64 vcc, 0
    s_cbranch_scc0 L_fm31
    v_max_f32 v11, v136, v116
    v_sub_f32 v16, v136, v11
    v_sub_f32 v17, v116, v11
    v_exp_f32 v16, v16
    v_exp_f32 v17, v17
    s_nop 0
    v_mul_f32 v12, v16, v137
    v_fmac_f32 v12, v17, v117
    v_rcp_f32 v12, v12
    s_add_u32 s58, s63, 1
    s_mul_i32 s58, s58, 1536
    v_mul_f32 v16, v16, v12
    v_mul_f32 v17, v17, v12
    v_mul_f32 v32, v120, v16
    v_fmac_f32 v32, v100, v17
    v_mul_f32 v33, v121, v16
    v_fmac_f32 v33, v101, v17
    v_mul_f32 v34, v122, v16
    v_fmac_f32 v34, v102, v17
    v_mul_f32 v35, v124, v16
    v_fmac_f32 v35, v104, v17
    v_mul_f32 v36, v125, v16
    v_fmac_f32 v36, v105, v17
    v_mul_f32 v37, v126, v16
    v_fmac_f32 v37, v106, v17
    v_mul_f32 v38, v128, v16
    v_fmac_f32 v38, v108, v17
    v_mul_f32 v39, v129, v16
    v_fmac_f32 v39, v109, v17
    v_mul_f32 v40, v130, v16
    v_fmac_f32 v40, v110, v17
    v_mul_f32 v41, v132, v16
    v_fmac_f32 v41, v112, v17
    v_mul_f32 v42, v133, v16
    v_fmac_f32 v42, v113, v17
    v_mul_f32 v43, v134, v16
    v_fmac_f32 v43, v114, v17
    v_cvt_pk_bf16_f32 v44, v32, v33
    v_cvt_pk_bf16_f32 v45, v34, v35
    v_cvt_pk_bf16_f32 v46, v36, v37
    v_cvt_pk_bf16_f32 v47, v38, v39
    v_cvt_pk_bf16_f32 v48, v40, v41
    v_cvt_pk_bf16_f32 v49, v42, v43
    buffer_store_dwordx2 v[44:45], v8, s[48:51], s58 offen offset:0
    buffer_store_dwordx2 v[46:47], v8, s[48:51], s58 offen offset:128
    buffer_store_dwordx2 v[48:49], v8, s[48:51], s58 offen offset:256
L_fm31:
L_fin:
L_end:
    s_endpgm
.section .rodata,"a"
.p2align 6
.amdhsa_kernel standalone__kv_cache_quant_int4_int2_kv_with_per_channel_or_per_token_scales__sampling_kernel
  .amdhsa_next_free_vgpr 224
  .amdhsa_next_free_sgpr 102
  .amdhsa_accum_offset 224
  .amdhsa_group_segment_fixed_size 0
  .amdhsa_kernarg_size 80
  .amdhsa_user_sgpr_count 2
  .amdhsa_user_sgpr_kernarg_segment_ptr 1
  .amdhsa_system_sgpr_workgroup_id_x 1
  .amdhsa_float_denorm_mode_32 3
.end_amdhsa_kernel
```

```asm
; @launch grid=(256,1,1) block=(448,1,1) lds=155136
.amdgcn_target "amdgcn-amd-amdhsa--gfx950"
.text
.globl standalone__kv_cache_quant_int4_int2_kv_with_per_channel_or_per_token_scales__sampling_kernel
.p2align 8
.type standalone__kv_cache_quant_int4_int2_kv_with_per_channel_or_per_token_scales__sampling_kernel,@function
standalone__kv_cache_quant_int4_int2_kv_with_per_channel_or_per_token_scales__sampling_kernel:
    s_cmp_ge_u32 s2, 256
    s_cbranch_scc1 L_end
    s_load_dwordx16 s[4:19], s[0:1], 0
    s_load_dwordx4 s[20:23], s[0:1], 64
    v_lshrrev_b32 v2, 6, v0
    v_and_b32 v1, 63, v0
    v_readfirstlane_b32 s56, v2
    s_mov_b32 s67, 768
    s_mov_b32 s42, s2
    s_mov_b32 s2, 0
    s_bitcmp1_b32 s42, 0
    s_cselect_b32 s58, 1, 0
    s_xor_b32 s2, s2, s58
    s_bitcmp1_b32 s42, 1
    s_cselect_b32 s58, 2, 0
    s_xor_b32 s2, s2, s58
    s_bitcmp1_b32 s42, 2
    s_cselect_b32 s58, 6, 0
    s_xor_b32 s2, s2, s58
    s_bitcmp1_b32 s42, 3
    s_cselect_b32 s58, 8, 0
    s_xor_b32 s2, s2, s58
    s_bitcmp1_b32 s42, 4
    s_cselect_b32 s58, 17, 0
    s_xor_b32 s2, s2, s58
    s_bitcmp1_b32 s42, 5
    s_cselect_b32 s58, 34, 0
    s_xor_b32 s2, s2, s58
    s_bitcmp1_b32 s42, 6
    s_cselect_b32 s58, 70, 0
    s_xor_b32 s2, s2, s58
    s_bitcmp1_b32 s42, 7
    s_cselect_b32 s58, 129, 0
    s_xor_b32 s2, s2, s58
    s_mul_i32 s100, s2, 43691
    s_lshr_b32 s100, s100, 17
    s_mul_i32 s101, s100, 3
    s_sub_u32 s101, s2, s101
    s_cmp_eq_u32 s2, 255
    s_cselect_b32 s73, 16, 11
    s_cmp_eq_u32 s101, 1
    s_cselect_b32 s3, 5, s73
    s_cselect_b32 s73, 10, s73
    s_mul_i32 s58, s101, 21
    s_add_u32 s58, s58, 1
    s_lshr_b32 s58, s58, 1
    s_lshl_b32 s59, s100, 5
    s_add_u32 s57, s58, s59
    s_sub_u32 s58, 2, s101
    s_mul_i32 s58, s58, 11
    s_lshr_b32 s58, s58, 1
    s_lshl_b32 s59, s100, 4
    s_sub_u32 s58, s58, s59
    s_add_u32 s58, s58, 4080
    s_sub_u32 s58, s58, s73
    v_add_u32 v3, s57, v1
    v_add_u32 v4, s58, v1
    v_cmp_le_u32 vcc, s73, v1
    s_nop 1
    v_cndmask_b32 v152, v3, v4, vcc
    s_cmp_eq_u32 s56, 4
    s_cbranch_scc0 L_roles
    s_setprio 3
    v_add_u32 v17, 0, v1
    v_mul_u32_u24 v22, 1366, v17
    v_bfe_u32 v11, v22, 16, 1
    v_lshrrev_b32 v14, 17, v22
    v_mul_u32_u24 v22, 31488, v14
    v_lshl_add_u32 v17, v17, 4, v22
    v_mov_b32 v8, v17
    v_add_u32 v18, 64, v1
    v_mul_u32_u24 v22, 1366, v18
    v_bfe_u32 v12, v22, 16, 1
    v_lshrrev_b32 v15, 17, v22
    v_mul_u32_u24 v22, 31488, v15
    v_lshl_add_u32 v18, v18, 4, v22
    v_mov_b32 v9, v18
    v_add_u32 v19, 128, v1
    v_mul_u32_u24 v22, 1366, v19
    v_bfe_u32 v13, v22, 16, 1
    v_lshrrev_b32 v16, 17, v22
    v_mul_u32_u24 v22, 31488, v16
    v_lshl_add_u32 v19, v19, 4, v22
    v_mov_b32 v10, v19
    s_mov_b32 s68, 0
    s_mov_b32 m0, 0
    s_movk_i32 s71, 1024
    s_mul_i32 s57, s57, 196608
    s_mov_b32 s84, 0x400000
    s_mov_b32 s85, 0x800
    s_movk_i32 s86, 1536
    s_mov_b32 s70, 18
    s_mov_b32 s74, 0
    v_mov_b32 v20, 4710
    v_mov_b32 v21, 154880
    ds_write_b32 v21, v20
    s_waitcnt lgkmcnt(0)
    s_mov_b32 s24, s6
    s_and_b32 s25, s7, 0xffff
    s_mov_b32 s26, 805306368
    s_mov_b32 s27, 0x20000
L_lw16:
    s_waitcnt vmcnt(16)
L_lw17:
    s_waitcnt vmcnt(17)
L_lw18:
    s_waitcnt vmcnt(18)
L_lw19:
    s_waitcnt vmcnt(19)
L_lw20:
    s_waitcnt vmcnt(20)
    buffer_load_dwordx4 v17, s[24:27], s57 offen nt lds
    s_add_u32 m0, m0, s71
    s_add_u32 s68, s68, 1
    s_and_b32 s58, s68, 63
    s_cmp_ge_u32 s58, 43
    s_cselect_b32 s69, -768, 0
    buffer_load_dwordx4 v18, s[24:27], s57 offen nt lds
    s_add_u32 m0, m0, s71
    s_cmp_eq_u32 s58, 21
    s_cselect_b32 s62, 33024, 0
    v_mad_u32_u24 v17, v11, s62, v8
    s_bitcmp1_b64 s[84:85], s58
    s_cselect_b32 s63, 34560, s86
    buffer_load_dwordx4 v19, s[24:27], s57 offen nt lds
    s_add_u32 m0, m0, s71
    s_add_u32 s57, s57, s63
    v_mad_i32_i24 v22, v15, s69, v9
    v_mad_u32_u24 v18, v12, s62, v22
    v_mad_i32_i24 v22, v16, s69, v10
    v_mad_u32_u24 v19, v13, s62, v22
    s_and_b32 s59, s68, 7
    s_cbranch_scc0 L_lunit
L_lad:
    s_cmp_eq_u32 s70, 20
    s_cbranch_scc1 L_lw20
    s_cmp_eq_u32 s70, 19
    s_cbranch_scc1 L_lw19
    s_cmp_eq_u32 s70, 18
    s_cbranch_scc1 L_lw18
    s_cmp_eq_u32 s70, 17
    s_cbranch_scc1 L_lw17
    s_branch L_lw16
L_lunit:
    s_waitcnt vmcnt(24)
    s_cmp_le_u32 s68, 16
    s_cbranch_scc1 L_lfirst
L_lbar:
    s_barrier
L_lnobar:
    s_waitcnt lgkmcnt(0)
    v_readfirstlane_b32 s59, v20
    ds_read_b32 v20, v21
    s_cmp_eq_u32 m0, 73728
    s_cselect_b32 m0, 0, m0
    s_and_b32 s74, s74, 255
    s_add_u32 s74, s74, s59
    s_lshr_b32 s70, s74, 8
    s_cmp_eq_u32 s58, 0
    s_cbranch_scc1 L_lblock
L_lsel:
    s_cmp_le_u32 s70, 20
    s_cbranch_scc1 L_lad
    s_cmp_le_u32 s70, 21
    s_cbranch_scc1 L_lw21
    s_cmp_le_u32 s70, 22
    s_cbranch_scc1 L_lw22
    s_cmp_le_u32 s70, 23
    s_cbranch_scc1 L_lw23
    s_cmp_le_u32 s70, 24
    s_cbranch_scc1 L_lw24
    s_branch L_lw25
L_lblock:
    s_bfe_u32 s58, s68, 262150
    v_readlane_b32 s57, v152, s58
    s_nop 3
    s_mul_i32 s57, s57, 196608
    s_cmp_eq_u32 s58, 0
    s_cbranch_scc0 L_lsel
    s_cmp_eq_u32 s68, 2048
    s_cbranch_scc1 L_ldone
    s_mov_b32 s24, s8
    s_and_b32 s25, s9, 0xffff
    s_branch L_lsel
L_lfirst:
    s_cmp_eq_u32 s68, 8
    s_cbranch_scc1 L_lnobar
    s_barrier
    s_branch L_lbar
L_ldone:
    s_waitcnt vmcnt(0)
    s_barrier
    s_endpgm
L_lw21:
    s_waitcnt vmcnt(21)
    buffer_load_dwordx4 v17, s[24:27], s57 offen nt lds
    s_add_u32 m0, m0, s71
    s_add_u32 s68, s68, 1
    s_and_b32 s58, s68, 63
    s_cmp_ge_u32 s58, 43
    s_cselect_b32 s69, -768, 0
    buffer_load_dwordx4 v18, s[24:27], s57 offen nt lds
    s_add_u32 m0, m0, s71
    s_cmp_eq_u32 s58, 21
    s_cselect_b32 s62, 33024, 0
    v_mad_u32_u24 v17, v11, s62, v8
    s_bitcmp1_b64 s[84:85], s58
    s_cselect_b32 s63, 34560, s86
    buffer_load_dwordx4 v19, s[24:27], s57 offen nt lds
    s_add_u32 m0, m0, s71
    s_add_u32 s57, s57, s63
    v_mad_i32_i24 v22, v15, s69, v9
    v_mad_u32_u24 v18, v12, s62, v22
    v_mad_i32_i24 v22, v16, s69, v10
    v_mad_u32_u24 v19, v13, s62, v22
    s_and_b32 s59, s68, 7
    s_cbranch_scc1 L_lw21
    s_branch L_lunit
L_lw22:
    s_waitcnt vmcnt(22)
    buffer_load_dwordx4 v17, s[24:27], s57 offen nt lds
    s_add_u32 m0, m0, s71
    s_add_u32 s68, s68, 1
    s_and_b32 s58, s68, 63
    s_cmp_ge_u32 s58, 43
    s_cselect_b32 s69, -768, 0
    buffer_load_dwordx4 v18, s[24:27], s57 offen nt lds
    s_add_u32 m0, m0, s71
    s_cmp_eq_u32 s58, 21
    s_cselect_b32 s62, 33024, 0
    v_mad_u32_u24 v17, v11, s62, v8
    s_bitcmp1_b64 s[84:85], s58
    s_cselect_b32 s63, 34560, s86
    buffer_load_dwordx4 v19, s[24:27], s57 offen nt lds
    s_add_u32 m0, m0, s71
    s_add_u32 s57, s57, s63
    v_mad_i32_i24 v22, v15, s69, v9
    v_mad_u32_u24 v18, v12, s62, v22
    v_mad_i32_i24 v22, v16, s69, v10
    v_mad_u32_u24 v19, v13, s62, v22
    s_and_b32 s59, s68, 7
    s_cbranch_scc1 L_lw22
    s_branch L_lunit
L_lw23:
    s_waitcnt vmcnt(23)
    buffer_load_dwordx4 v17, s[24:27], s57 offen nt lds
    s_add_u32 m0, m0, s71
    s_add_u32 s68, s68, 1
    s_and_b32 s58, s68, 63
    s_cmp_ge_u32 s58, 43
    s_cselect_b32 s69, -768, 0
    buffer_load_dwordx4 v18, s[24:27], s57 offen nt lds
    s_add_u32 m0, m0, s71
    s_cmp_eq_u32 s58, 21
    s_cselect_b32 s62, 33024, 0
    v_mad_u32_u24 v17, v11, s62, v8
    s_bitcmp1_b64 s[84:85], s58
    s_cselect_b32 s63, 34560, s86
    buffer_load_dwordx4 v19, s[24:27], s57 offen nt lds
    s_add_u32 m0, m0, s71
    s_add_u32 s57, s57, s63
    v_mad_i32_i24 v22, v15, s69, v9
    v_mad_u32_u24 v18, v12, s62, v22
    v_mad_i32_i24 v22, v16, s69, v10
    v_mad_u32_u24 v19, v13, s62, v22
    s_and_b32 s59, s68, 7
    s_cbranch_scc1 L_lw23
    s_branch L_lunit
L_lw24:
    s_waitcnt vmcnt(24)
    buffer_load_dwordx4 v17, s[24:27], s57 offen nt lds
    s_add_u32 m0, m0, s71
    s_add_u32 s68, s68, 1
    s_and_b32 s58, s68, 63
    s_cmp_ge_u32 s58, 43
    s_cselect_b32 s69, -768, 0
    buffer_load_dwordx4 v18, s[24:27], s57 offen nt lds
    s_add_u32 m0, m0, s71
    s_cmp_eq_u32 s58, 21
    s_cselect_b32 s62, 33024, 0
    v_mad_u32_u24 v17, v11, s62, v8
    s_bitcmp1_b64 s[84:85], s58
    s_cselect_b32 s63, 34560, s86
    buffer_load_dwordx4 v19, s[24:27], s57 offen nt lds
    s_add_u32 m0, m0, s71
    s_add_u32 s57, s57, s63
    v_mad_i32_i24 v22, v15, s69, v9
    v_mad_u32_u24 v18, v12, s62, v22
    v_mad_i32_i24 v22, v16, s69, v10
    v_mad_u32_u24 v19, v13, s62, v22
    s_and_b32 s59, s68, 7
    s_cbranch_scc1 L_lw24
    s_branch L_lunit
L_lw25:
    s_waitcnt vmcnt(25)
    buffer_load_dwordx4 v17, s[24:27], s57 offen nt lds
    s_add_u32 m0, m0, s71
    s_add_u32 s68, s68, 1
    s_and_b32 s58, s68, 63
    s_cmp_ge_u32 s58, 43
    s_cselect_b32 s69, -768, 0
    buffer_load_dwordx4 v18, s[24:27], s57 offen nt lds
    s_add_u32 m0, m0, s71
    s_cmp_eq_u32 s58, 21
    s_cselect_b32 s62, 33024, 0
    v_mad_u32_u24 v17, v11, s62, v8
    s_bitcmp1_b64 s[84:85], s58
    s_cselect_b32 s63, 34560, s86
    buffer_load_dwordx4 v19, s[24:27], s57 offen nt lds
    s_add_u32 m0, m0, s71
    s_add_u32 s57, s57, s63
    v_mad_i32_i24 v22, v15, s69, v9
    v_mad_u32_u24 v18, v12, s62, v22
    v_mad_i32_i24 v22, v16, s69, v10
    v_mad_u32_u24 v19, v13, s62, v22
    s_and_b32 s59, s68, 7
    s_cbranch_scc1 L_lw25
    s_branch L_lunit
L_roles:
    s_cmp_lt_u32 s56, 4
    s_cbranch_scc1 L_consumer
    s_cmp_eq_u32 s56, 5
    s_cbranch_scc1 L_finisher
    s_sub_u32 s58, s42, 8
    s_cmp_lt_u32 s58, 8
    s_cbranch_scc0 L_pw
    s_getpc_b64 s[44:45]
L_pc:
    s_and_b32 s45, s45, 0xffff
    s_mov_b32 s46, L_end - L_pc
    s_mov_b32 s47, 0x20000
    v_lshlrev_b32 v9, 7, v1
    s_movk_i32 s58, 0
    buffer_load_dword v12, v9, s[44:47], s58 offen
    s_movk_i32 s58, 8192
    buffer_load_dword v13, v9, s[44:47], s58 offen
    s_movk_i32 s58, 16384
    buffer_load_dword v14, v9, s[44:47], s58 offen
    s_movk_i32 s58, 24576
    buffer_load_dword v15, v9, s[44:47], s58 offen
L_pw:
    s_waitcnt lgkmcnt(0)
    s_mov_b32 s52, s22
    s_and_b32 s53, s23, 0xffff
    s_mov_b32 s54, 16793888
    s_mov_b32 s55, 0x20000
    s_mov_b32 s71, 0
    s_add_u32 s98, s22, 16777216
    s_addc_u32 s99, s23, 0
    s_cmp_lt_u32 s42, 8
    s_cselect_b32 s61, 1, 0
    s_and_b32 s59, s42, 7
    s_mul_i32 s59, s59, 4
    s_add_u32 s59, s59, 16777216
    v_mov_b32 v8, s59
    v_mov_b32 v10, 154880
    s_memtime s[28:29]
    s_memrealtime s[96:97]
    s_mov_b32 s32, 0
    s_mov_b64 exec, 1
    s_waitcnt lgkmcnt(0)
    s_mov_b32 s33, s96
    s_barrier
    s_mov_b32 s63, 0
L_pace:
    s_barrier
    s_mov_b32 s62, s96
    s_mov_b32 s30, s28
    s_memtime s[28:29]
    s_memrealtime s[96:97]
    s_waitcnt lgkmcnt(0)
    s_sub_u32 s58, s96, s33
    s_mul_i32 s58, s58, 373
    s_mov_b32 s33, s96
    s_sub_u32 s59, s28, s30
    s_lshl_b32 s59, s59, 4
    s_sub_i32 s58, s58, s59
    s_mul_i32 s58, s58, 60
    s_ashr_i32 s31, s58, 12
    s_cmp_eq_u32 s63, 0
    s_cbranch_scc1 L_pnext
    s_mov_b32 s58, 0
    s_sub_i32 s59, s84, s62
    s_add_i32 s60, s59, 5000
    s_cmp_lt_u32 s60, 10000
    s_cselect_b32 s59, s59, 200
    s_add_i32 s58, s58, s59
    s_sub_i32 s59, s85, s62
    s_add_i32 s60, s59, 5000
    s_cmp_lt_u32 s60, 10000
    s_cselect_b32 s59, s59, 200
    s_add_i32 s58, s58, s59
    s_sub_i32 s59, s86, s62
    s_add_i32 s60, s59, 5000
    s_cmp_lt_u32 s60, 10000
    s_cselect_b32 s59, s59, 200
    s_add_i32 s58, s58, s59
    s_sub_i32 s59, s87, s62
    s_add_i32 s60, s59, 5000
    s_cmp_lt_u32 s60, 10000
    s_cselect_b32 s59, s59, 200
    s_add_i32 s58, s58, s59
    s_sub_i32 s59, s88, s62
    s_add_i32 s60, s59, 5000
    s_cmp_lt_u32 s60, 10000
    s_cselect_b32 s59, s59, 200
    s_add_i32 s58, s58, s59
    s_sub_i32 s59, s89, s62
    s_add_i32 s60, s59, 5000
    s_cmp_lt_u32 s60, 10000
    s_cselect_b32 s59, s59, 200
    s_add_i32 s58, s58, s59
    s_sub_i32 s59, s90, s62
    s_add_i32 s60, s59, 5000
    s_cmp_lt_u32 s60, 10000
    s_cselect_b32 s59, s59, 200
    s_add_i32 s58, s58, s59
    s_sub_i32 s59, s91, s62
    s_add_i32 s60, s59, 5000
    s_cmp_lt_u32 s60, 10000
    s_cselect_b32 s59, s59, 200
    s_add_i32 s58, s58, s59
    s_min_u32 s59, s63, 12
    s_cmp_gt_i32 s58, 0
    s_cselect_b32 s63, s59, s63
    s_mul_i32 s58, s58, s63
    s_ashr_i32 s58, s58, 5
    s_mov_b32 s32, s58
L_pnext:
    s_sub_i32 s58, s31, s32
    s_add_i32 s58, s58, 4710
    s_max_i32 s58, s58, 4096
    s_min_i32 s70, s58, 6400
    v_mov_b32 v9, s70
    ds_write_b32 v10, v9
    s_and_b32 s58, s71, 768
    s_cselect_b32 s63, 0, 5
    s_cmp_ge_u32 s71, 14848
    s_cselect_b32 s63, 24, s63
    s_mul_i32 s58, s63, s61
    s_cmp_eq_u32 s58, 0
    s_cbranch_scc1 L_pnorep
    v_mov_b32 v11, s96
    buffer_store_dword v11, v8, s[52:55], s71 offen sc1
L_pnorep:
    s_barrier
    s_barrier
    s_barrier
    s_cmp_eq_u32 s63, 0
    s_cbranch_scc1 L_pnold
    s_load_dwordx8 s[84:91], s[98:99], s71
L_pnold:
    s_add_u32 s71, s71, 256
    s_cmp_lt_u32 s71, 16384
    s_cbranch_scc1 L_pace
    s_waitcnt lgkmcnt(0)
    s_mov_b64 exec, -1
    s_endpgm
L_consumer:
    v_lshrrev_b32 v3, 2, v1
    v_lshlrev_b32 v3, 3, v3
    v_and_b32 v4, 3, v1
    v_mul_u32_u24 v5, 384, v4
    v_add_u32 v15, v3, v5
    v_lshlrev_b32 v13, 4, v1
    s_mul_i32 s63, s56, 3072
    s_add_u32 s63, s63, 76800
    s_add_u32 s58, s56, 0
    v_readlane_b32 s84, v152, s58
    s_add_u32 s58, s56, 4
    v_readlane_b32 s85, v152, s58
    s_add_u32 s58, s56, 8
    v_readlane_b32 s86, v152, s58
    s_add_u32 s58, s56, 12
    v_readlane_b32 s87, v152, s58
    v_readlane_b32 s88, v152, 0
    s_min_u32 s58, s3, 15
    v_readlane_b32 s89, v152, s58
    v_readlane_b32 s90, v152, 15
    s_waitcnt lgkmcnt(0)
    s_mov_b32 s32, s12
    s_and_b32 s33, s13, 0xffff
    s_mov_b32 s34, 6291456
    s_mov_b32 s35, 0x20000
    s_mov_b32 s28, s10
    s_and_b32 s29, s11, 0xffff
    s_mov_b32 s30, 6291456
    s_mov_b32 s31, 0x20000
    s_mov_b32 exec_hi, 0xffff
    s_add_u32 m0, s63, 0
    s_mul_i32 s58, s84, 1536
    buffer_load_dwordx4 v13, s[32:35], s58 offen nt lds
    buffer_load_dwordx4 v13, s[32:35], s58 offen offset:768 nt lds
    s_add_u32 m0, m0, 1536
    s_nop 0
    buffer_load_dwordx4 v13, s[28:31], s58 offen nt lds
    buffer_load_dwordx4 v13, s[28:31], s58 offen offset:768 nt lds
    s_mov_b32 exec_hi, -1
    s_mov_b32 s44, s4
    s_and_b32 s45, s5, 0xffff
    s_mov_b32 s46, 393216
    s_mov_b32 s47, 0x20000
    s_lshr_b32 s58, s88, 4
    s_mul_i32 s58, s58, 1536
    buffer_load_dwordx2 v[160:161], v15, s[44:47], s58 offen offset:0 nt
    buffer_load_dwordx2 v[162:163], v15, s[44:47], s58 offen offset:128 nt
    buffer_load_dwordx2 v[164:165], v15, s[44:47], s58 offen offset:256 nt
    s_mov_b32 s64, 0x3fb8aa3b
    s_mov_b32 s65, 0x3d93cd3a
    s_mov_b32 s66, 0xffff0000
    v_bfe_u32 v36, v1, 2, 1
    v_lshl_add_u32 v36, v2, 2, v36
    v_bfe_u32 v37, v1, 3, 1
    v_lshrrev_b32 v38, 4, v1
    v_lshl_add_u32 v38, v38, 2, v4
    v_lshlrev_b32 v38, 3, v38
    v_add_u32 v38, 73728, v38
    s_movk_i32 s58, 384
    v_add_u32 v3, 0, v36
    v_cmp_le_u32 vcc, 43, v3
    v_add_u32 v5, 43, v3
    v_mov_b32 v6, 42
    v_cndmask_b32 v17, v3, v5, vcc
    v_cmp_le_u32 vcc, 86, v3
    v_add_u32 v5, 43, v17
    s_nop 0
    v_cndmask_b32 v17, v17, v5, vcc
    v_cndmask_b32 v6, 43, v6, vcc
    v_mad_u32_u24 v17, v6, v37, v17
    v_lshrrev_b32 v17, 6, v17
    v_mad_u32_u24 v17, v17, s58, v38
    v_add_u32 v3, 2, v36
    v_cmp_le_u32 vcc, 43, v3
    v_add_u32 v5, 43, v3
    v_mov_b32 v6, 42
    v_cndmask_b32 v18, v3, v5, vcc
    v_cmp_le_u32 vcc, 86, v3
    v_add_u32 v5, 43, v18
    s_nop 0
    v_cndmask_b32 v18, v18, v5, vcc
    v_cndmask_b32 v6, 43, v6, vcc
    v_mad_u32_u24 v18, v6, v37, v18
    v_lshrrev_b32 v18, 6, v18
    v_mad_u32_u24 v18, v18, s58, v38
    v_add_u32 v3, 16, v36
    v_cmp_le_u32 vcc, 43, v3
    v_add_u32 v5, 43, v3
    v_mov_b32 v6, 42
    v_cndmask_b32 v19, v3, v5, vcc
    v_cmp_le_u32 vcc, 86, v3
    v_add_u32 v5, 43, v19
    s_nop 0
    v_cndmask_b32 v19, v19, v5, vcc
    v_cndmask_b32 v6, 43, v6, vcc
    v_mad_u32_u24 v19, v6, v37, v19
    v_lshrrev_b32 v19, 6, v19
    v_mad_u32_u24 v19, v19, s58, v38
    v_add_u32 v3, 18, v36
    v_cmp_le_u32 vcc, 43, v3
    v_add_u32 v5, 43, v3
    v_mov_b32 v6, 42
    v_cndmask_b32 v20, v3, v5, vcc
    v_cmp_le_u32 vcc, 86, v3
    v_add_u32 v5, 43, v20
    s_nop 0
    v_cndmask_b32 v20, v20, v5, vcc
    v_cndmask_b32 v6, 43, v6, vcc
    v_mad_u32_u24 v20, v6, v37, v20
    v_lshrrev_b32 v20, 6, v20
    v_mad_u32_u24 v20, v20, s58, v38
    v_add_u32 v3, 32, v36
    v_cmp_le_u32 vcc, 43, v3
    v_add_u32 v5, 43, v3
    v_mov_b32 v6, 42
    v_cndmask_b32 v21, v3, v5, vcc
    v_cmp_le_u32 vcc, 86, v3
    v_add_u32 v5, 43, v21
    s_nop 0
    v_cndmask_b32 v21, v21, v5, vcc
    v_cndmask_b32 v6, 43, v6, vcc
    v_mad_u32_u24 v21, v6, v37, v21
    v_lshrrev_b32 v21, 6, v21
    v_mad_u32_u24 v21, v21, s58, v38
    v_add_u32 v3, 34, v36
    v_cmp_le_u32 vcc, 43, v3
    v_add_u32 v5, 43, v3
    v_mov_b32 v6, 42
    v_cndmask_b32 v22, v3, v5, vcc
    v_cmp_le_u32 vcc, 86, v3
    v_add_u32 v5, 43, v22
    s_nop 0
    v_cndmask_b32 v22, v22, v5, vcc
    v_cndmask_b32 v6, 43, v6, vcc
    v_mad_u32_u24 v22, v6, v37, v22
    v_lshrrev_b32 v22, 6, v22
    v_mad_u32_u24 v22, v22, s58, v38
    v_add_u32 v3, 48, v36
    v_cmp_le_u32 vcc, 43, v3
    v_add_u32 v5, 43, v3
    v_mov_b32 v6, 42
    v_cndmask_b32 v23, v3, v5, vcc
    v_cmp_le_u32 vcc, 86, v3
    v_add_u32 v5, 43, v23
    s_nop 0
    v_cndmask_b32 v23, v23, v5, vcc
    v_cndmask_b32 v6, 43, v6, vcc
    v_mad_u32_u24 v23, v6, v37, v23
    v_lshrrev_b32 v23, 6, v23
    v_mad_u32_u24 v23, v23, s58, v38
    v_add_u32 v3, 50, v36
    v_cmp_le_u32 vcc, 43, v3
    v_add_u32 v5, 43, v3
    v_mov_b32 v6, 42
    v_cndmask_b32 v24, v3, v5, vcc
    v_cmp_le_u32 vcc, 86, v3
    v_add_u32 v5, 43, v24
    s_nop 0
    v_cndmask_b32 v24, v24, v5, vcc
    v_cndmask_b32 v6, 43, v6, vcc
    v_mad_u32_u24 v24, v6, v37, v24
    v_lshrrev_b32 v24, 6, v24
    v_mad_u32_u24 v24, v24, s58, v38
    v_add_u32 v3, 64, v36
    v_cmp_le_u32 vcc, 43, v3
    v_add_u32 v5, 43, v3
    v_mov_b32 v6, 42
    v_cndmask_b32 v25, v3, v5, vcc
    v_cmp_le_u32 vcc, 86, v3
    v_add_u32 v5, 43, v25
    s_nop 0
    v_cndmask_b32 v25, v25, v5, vcc
    v_cndmask_b32 v6, 43, v6, vcc
    v_mad_u32_u24 v25, v6, v37, v25
    v_lshrrev_b32 v25, 6, v25
    v_mad_u32_u24 v25, v25, s58, v38
    v_add_u32 v3, 66, v36
    v_cmp_le_u32 vcc, 43, v3
    v_add_u32 v5, 43, v3
    v_mov_b32 v6, 42
    v_cndmask_b32 v26, v3, v5, vcc
    v_cmp_le_u32 vcc, 86, v3
    v_add_u32 v5, 43, v26
    s_nop 0
    v_cndmask_b32 v26, v26, v5, vcc
    v_cndmask_b32 v6, 43, v6, vcc
    v_mad_u32_u24 v26, v6, v37, v26
    v_lshrrev_b32 v26, 6, v26
    v_mad_u32_u24 v26, v26, s58, v38
    v_add_u32 v3, 80, v36
    v_cmp_le_u32 vcc, 43, v3
    v_add_u32 v5, 43, v3
    v_mov_b32 v6, 42
    v_cndmask_b32 v27, v3, v5, vcc
    v_cmp_le_u32 vcc, 86, v3
    v_add_u32 v5, 43, v27
    s_nop 0
    v_cndmask_b32 v27, v27, v5, vcc
    v_cndmask_b32 v6, 43, v6, vcc
    v_mad_u32_u24 v27, v6, v37, v27
    v_lshrrev_b32 v27, 6, v27
    v_mad_u32_u24 v27, v27, s58, v38
    v_add_u32 v3, 82, v36
    v_cmp_le_u32 vcc, 43, v3
    v_add_u32 v5, 43, v3
    v_mov_b32 v6, 42
    v_cndmask_b32 v28, v3, v5, vcc
    v_cmp_le_u32 vcc, 86, v3
    v_add_u32 v5, 43, v28
    s_nop 0
    v_cndmask_b32 v28, v28, v5, vcc
    v_cndmask_b32 v6, 43, v6, vcc
    v_mad_u32_u24 v28, v6, v37, v28
    v_lshrrev_b32 v28, 6, v28
    v_mad_u32_u24 v28, v28, s58, v38
    v_add_u32 v3, 96, v36
    v_cmp_le_u32 vcc, 43, v3
    v_add_u32 v5, 43, v3
    v_mov_b32 v6, 42
    v_cndmask_b32 v29, v3, v5, vcc
    v_cmp_le_u32 vcc, 86, v3
    v_add_u32 v5, 43, v29
    s_nop 0
    v_cndmask_b32 v29, v29, v5, vcc
    v_cndmask_b32 v6, 43, v6, vcc
    v_mad_u32_u24 v29, v6, v37, v29
    v_lshrrev_b32 v29, 6, v29
    v_mad_u32_u24 v29, v29, s58, v38
    v_add_u32 v3, 98, v36
    v_cmp_le_u32 vcc, 43, v3
    v_add_u32 v5, 43, v3
    v_mov_b32 v6, 42
    v_cndmask_b32 v30, v3, v5, vcc
    v_cmp_le_u32 vcc, 86, v3
    v_add_u32 v5, 43, v30
    s_nop 0
    v_cndmask_b32 v30, v30, v5, vcc
    v_cndmask_b32 v6, 43, v6, vcc
    v_mad_u32_u24 v30, v6, v37, v30
    v_lshrrev_b32 v30, 6, v30
    v_mad_u32_u24 v30, v30, s58, v38
    v_add_u32 v3, 112, v36
    v_cmp_le_u32 vcc, 43, v3
    v_add_u32 v5, 43, v3
    v_mov_b32 v6, 42
    v_cndmask_b32 v31, v3, v5, vcc
    v_cmp_le_u32 vcc, 86, v3
    v_add_u32 v5, 43, v31
    s_nop 0
    v_cndmask_b32 v31, v31, v5, vcc
    v_cndmask_b32 v6, 43, v6, vcc
    v_mad_u32_u24 v31, v6, v37, v31
    v_lshrrev_b32 v31, 6, v31
    v_mad_u32_u24 v31, v31, s58, v38
    v_add_u32 v3, 114, v36
    v_cmp_le_u32 vcc, 43, v3
    v_add_u32 v5, 43, v3
    v_mov_b32 v6, 42
    v_cndmask_b32 v32, v3, v5, vcc
    v_cmp_le_u32 vcc, 86, v3
    v_add_u32 v5, 43, v32
    s_nop 0
    v_cndmask_b32 v32, v32, v5, vcc
    v_cndmask_b32 v6, 43, v6, vcc
    v_mad_u32_u24 v32, v6, v37, v32
    v_lshrrev_b32 v32, 6, v32
    v_mad_u32_u24 v32, v32, s58, v38
    v_bfe_u32 v36, v1, 4, 1
    v_lshl_add_u32 v36, v2, 2, v36
    v_bfe_u32 v3, v1, 2, 2
    v_lshl_add_u32 v36, v3, 4, v36
    v_lshrrev_b32 v37, 5, v1
    s_mov_b32 s58, 125952
    v_add_u32 v3, 0, v36
    v_cmp_le_u32 vcc, 43, v3
    v_add_u32 v5, 43, v3
    v_mov_b32 v6, 42
    v_cndmask_b32 v7, v3, v5, vcc
    v_cmp_le_u32 vcc, 86, v3
    v_add_u32 v5, 43, v7
    s_nop 0
    v_cndmask_b32 v7, v7, v5, vcc
    v_cndmask_b32 v6, 43, v6, vcc
    v_mad_u32_u24 v7, v6, v37, v7
    v_lshl_add_u32 v7, v7, 1, s58
    v_add_u32 v3, 2, v36
    v_cmp_le_u32 vcc, 43, v3
    v_add_u32 v5, 43, v3
    v_mov_b32 v6, 42
    v_cndmask_b32 v8, v3, v5, vcc
    v_cmp_le_u32 vcc, 86, v3
    v_add_u32 v5, 43, v8
    s_nop 0
    v_cndmask_b32 v8, v8, v5, vcc
    v_cndmask_b32 v6, 43, v6, vcc
    v_mad_u32_u24 v8, v6, v37, v8
    v_lshl_add_u32 v8, v8, 1, s58
    v_add_u32 v3, 64, v36
    v_cmp_le_u32 vcc, 43, v3
    v_add_u32 v5, 43, v3
    v_mov_b32 v6, 42
    v_cndmask_b32 v9, v3, v5, vcc
    v_cmp_le_u32 vcc, 86, v3
    v_add_u32 v5, 43, v9
    s_nop 0
    v_cndmask_b32 v9, v9, v5, vcc
    v_cndmask_b32 v6, 43, v6, vcc
    v_mad_u32_u24 v9, v6, v37, v9
    v_lshl_add_u32 v9, v9, 1, s58
    v_add_u32 v3, 66, v36
    v_cmp_le_u32 vcc, 43, v3
    v_add_u32 v5, 43, v3
    v_mov_b32 v6, 42
    v_cndmask_b32 v10, v3, v5, vcc
    v_cmp_le_u32 vcc, 86, v3
    v_add_u32 v5, 43, v10
    s_nop 0
    v_cndmask_b32 v10, v10, v5, vcc
    v_cndmask_b32 v6, 43, v6, vcc
    v_mad_u32_u24 v10, v6, v37, v10
    v_lshl_add_u32 v10, v10, 1, s58
    v_lshlrev_b32 v11, 2, v1
    v_lshl_add_u32 v11, v2, 9, v11
    v_add_u32 v11, 73728, v11
    v_bfe_u32 v3, v1, 2, 2
    v_lshrrev_b32 v4, 4, v1
    v_and_b32 v5, 3, v1
    v_lshl_add_u32 v4, v4, 2, v5
    v_lshl_add_u32 v3, v2, 3, v3
    v_mul_u32_u24 v3, 768, v3
    v_lshl_add_u32 v12, v4, 4, v3
    v_and_b32 v3, 3, v1
    v_lshl_add_u32 v153, v3, 2, v2
    v_lshlrev_b32 v153, 2, v153
    v_add_u32 v153, 154944, v153
    v_mov_b32 v14, 0xff800000
    s_mov_b32 exec_hi, 0xffff
    s_add_u32 m0, s63, 12288
    s_mul_i32 s58, s85, 1536
    buffer_load_dwordx4 v13, s[32:35], s58 offen nt lds
    buffer_load_dwordx4 v13, s[32:35], s58 offen offset:768 nt lds
    s_add_u32 m0, m0, 1536
    s_nop 0
    buffer_load_dwordx4 v13, s[28:31], s58 offen nt lds
    buffer_load_dwordx4 v13, s[28:31], s58 offen offset:768 nt lds
    s_add_u32 m0, s63, 24576
    s_mul_i32 s58, s86, 1536
    buffer_load_dwordx4 v13, s[32:35], s58 offen nt lds
    buffer_load_dwordx4 v13, s[32:35], s58 offen offset:768 nt lds
    s_add_u32 m0, m0, 1536
    s_nop 0
    buffer_load_dwordx4 v13, s[28:31], s58 offen nt lds
    buffer_load_dwordx4 v13, s[28:31], s58 offen offset:768 nt lds
    s_add_u32 m0, s63, 36864
    s_mul_i32 s58, s87, 1536
    buffer_load_dwordx4 v13, s[32:35], s58 offen nt lds
    buffer_load_dwordx4 v13, s[32:35], s58 offen offset:768 nt lds
    s_add_u32 m0, m0, 1536
    s_nop 0
    buffer_load_dwordx4 v13, s[28:31], s58 offen nt lds
    buffer_load_dwordx4 v13, s[28:31], s58 offen offset:768 nt lds
    s_mov_b32 exec_hi, -1
    s_mov_b32 s36, s14
    s_and_b32 s37, s15, 0xffff
    s_mov_b32 s38, 2097152
    s_mov_b32 s39, 0x20000
    s_mov_b32 s40, s16
    s_and_b32 s41, s17, 0xffff
    s_mov_b32 s42, 2097152
    s_mov_b32 s43, 0x20000
    s_mov_b32 exec_hi, 0
    s_lshl_b32 s60, s56, 10
    s_add_u32 m0, s60, 125952
    s_lshl_b32 s58, s84, 9
    buffer_load_dwordx4 v13, s[36:39], s58 offen nt lds
    s_add_u32 m0, m0, 512
    s_nop 0
    buffer_load_dwordx4 v13, s[40:43], s58 offen nt lds
    s_add_u32 m0, s60, 130048
    s_lshl_b32 s58, s85, 9
    buffer_load_dwordx4 v13, s[36:39], s58 offen nt lds
    s_add_u32 m0, m0, 512
    s_nop 0
    buffer_load_dwordx4 v13, s[40:43], s58 offen nt lds
    s_add_u32 m0, s60, 134144
    s_lshl_b32 s58, s86, 9
    buffer_load_dwordx4 v13, s[36:39], s58 offen nt lds
    s_add_u32 m0, m0, 512
    s_nop 0
    buffer_load_dwordx4 v13, s[40:43], s58 offen nt lds
    s_add_u32 m0, s60, 138240
    s_lshl_b32 s58, s87, 9
    buffer_load_dwordx4 v13, s[36:39], s58 offen nt lds
    s_add_u32 m0, m0, 512
    s_nop 0
    buffer_load_dwordx4 v13, s[40:43], s58 offen nt lds
    s_mov_b32 exec_hi, -1
    s_lshr_b32 s58, s89, 4
    s_mul_i32 s58, s58, 1536
    buffer_load_dwordx2 v[166:167], v15, s[44:47], s58 offen offset:0 nt
    buffer_load_dwordx2 v[168:169], v15, s[44:47], s58 offen offset:128 nt
    buffer_load_dwordx2 v[170:171], v15, s[44:47], s58 offen offset:256 nt
    s_lshr_b32 s58, s90, 4
    s_mul_i32 s58, s58, 1536
    buffer_load_dwordx2 v[172:173], v15, s[44:47], s58 offen offset:0 nt
    buffer_load_dwordx2 v[174:175], v15, s[44:47], s58 offen offset:128 nt
    buffer_load_dwordx2 v[176:177], v15, s[44:47], s58 offen offset:256 nt
    s_mov_b32 s61, 0
    s_mov_b32 s62, 0
    s_movk_i32 s63, 3072
    s_waitcnt vmcnt(26)
    s_barrier
    v_add_u32 v33, s63, v17
    v_add_u32 v34, s63, v18
    ds_read_b64 v[108:109], v33 offset:0
    ds_read_b64 v[110:111], v33 offset:1536
    ds_read_b64 v[112:113], v33 offset:128
    ds_read_b64 v[114:115], v33 offset:1664
    ds_read_b64 v[116:117], v33 offset:256
    ds_read_b64 v[118:119], v33 offset:1792
    ds_read_b64 v[120:121], v34 offset:0
    ds_read_b64 v[122:123], v34 offset:1536
    ds_read_b64 v[124:125], v34 offset:128
    ds_read_b64 v[126:127], v34 offset:1664
    ds_read_b64 v[128:129], v34 offset:256
    ds_read_b64 v[130:131], v34 offset:1792
    s_waitcnt lgkmcnt(0)
    v_lshlrev_b32 v60, 16, v108
    v_and_b32 v61, s66, v108
    v_lshlrev_b32 v62, 16, v109
    v_and_b32 v63, s66, v109
    v_lshlrev_b32 v84, 16, v110
    v_and_b32 v85, s66, v110
    v_lshlrev_b32 v86, 16, v111
    v_and_b32 v87, s66, v111
    v_lshlrev_b32 v64, 16, v112
    v_and_b32 v65, s66, v112
    v_lshlrev_b32 v66, 16, v113
    v_and_b32 v67, s66, v113
    v_lshlrev_b32 v88, 16, v114
    v_and_b32 v89, s66, v114
    v_lshlrev_b32 v90, 16, v115
    v_and_b32 v91, s66, v115
    v_lshlrev_b32 v68, 16, v116
    v_and_b32 v69, s66, v116
    v_lshlrev_b32 v70, 16, v117
    v_and_b32 v71, s66, v117
    v_lshlrev_b32 v92, 16, v118
    v_and_b32 v93, s66, v118
    v_lshlrev_b32 v94, 16, v119
    v_and_b32 v95, s66, v119
    v_lshlrev_b32 v72, 16, v120
    v_and_b32 v73, s66, v120
    v_lshlrev_b32 v74, 16, v121
    v_and_b32 v75, s66, v121
    v_lshlrev_b32 v96, 16, v122
    v_and_b32 v97, s66, v122
    v_lshlrev_b32 v98, 16, v123
    v_and_b32 v99, s66, v123
    v_lshlrev_b32 v76, 16, v124
    v_and_b32 v77, s66, v124
    v_lshlrev_b32 v78, 16, v125
    v_and_b32 v79, s66, v125
    v_lshlrev_b32 v100, 16, v126
    v_and_b32 v101, s66, v126
    v_lshlrev_b32 v102, 16, v127
    v_and_b32 v103, s66, v127
    v_lshlrev_b32 v80, 16, v128
    v_and_b32 v81, s66, v128
    v_lshlrev_b32 v82, 16, v129
    v_and_b32 v83, s66, v129
    v_lshlrev_b32 v104, 16, v130
    v_and_b32 v105, s66, v130
    v_lshlrev_b32 v106, 16, v131
    v_and_b32 v107, s66, v131
L_kblk:
    v_add_u32 v13, s62, v12
    s_add_u32 s62, s62, 24576
    s_cmp_eq_u32 s62, 73728
    s_cselect_b32 s62, 0, s62
    s_barrier
    ds_read_b128 v[36:39], v13 offset:0
    ds_read_b128 v[40:43], v13 offset:256
    ds_read_b128 v[44:47], v13 offset:512
    ds_read_b128 v[48:51], v13 offset:3072
    ds_read_b128 v[52:55], v13 offset:3328
    ds_read_b128 v[56:59], v13 offset:3584
    s_waitcnt lgkmcnt(3)
    v_cvt_f32_i32 v36, v36
    v_cvt_f32_i32 v37, v37
    v_cvt_f32_i32 v38, v38
    v_cvt_f32_i32 v39, v39
    v_cvt_f32_i32 v40, v40
    v_cvt_f32_i32 v41, v41
    v_cvt_f32_i32 v42, v42
    v_cvt_f32_i32 v43, v43
    v_cvt_f32_i32 v44, v44
    v_cvt_f32_i32 v45, v45
    v_cvt_f32_i32 v46, v46
    v_cvt_f32_i32 v47, v47
    v_sub_f32 v36, v36, v60
    v_sub_f32 v37, v37, v61
    v_sub_f32 v38, v38, v62
    v_sub_f32 v39, v39, v63
    v_sub_f32 v40, v40, v64
    v_sub_f32 v41, v41, v65
    v_sub_f32 v42, v42, v66
    v_sub_f32 v43, v43, v67
    v_sub_f32 v44, v44, v68
    v_sub_f32 v45, v45, v69
    v_sub_f32 v46, v46, v70
    v_sub_f32 v47, v47, v71
    v_cvt_pk_bf16_f32 v36, 0, v36
    v_cvt_pk_bf16_f32 v37, 0, v37
    v_cvt_pk_bf16_f32 v38, 0, v38
    v_cvt_pk_bf16_f32 v39, 0, v39
    v_cvt_pk_bf16_f32 v40, 0, v40
    v_cvt_pk_bf16_f32 v41, 0, v41
    v_cvt_pk_bf16_f32 v42, 0, v42
    v_cvt_pk_bf16_f32 v43, 0, v43
    v_cvt_pk_bf16_f32 v44, 0, v44
    v_cvt_pk_bf16_f32 v45, 0, v45
    v_cvt_pk_bf16_f32 v46, 0, v46
    v_cvt_pk_bf16_f32 v47, 0, v47
    v_mul_f32 v36, v36, v84
    v_mul_f32 v37, v37, v85
    v_mul_f32 v38, v38, v86
    v_mul_f32 v39, v39, v87
    v_mul_f32 v40, v40, v88
    v_mul_f32 v41, v41, v89
    v_mul_f32 v42, v42, v90
    v_mul_f32 v43, v43, v91
    v_mul_f32 v44, v44, v92
    v_mul_f32 v45, v45, v93
    v_mul_f32 v46, v46, v94
    v_mul_f32 v47, v47, v95
    v_cvt_pk_bf16_f32 v132, v36, v37
    v_cvt_pk_bf16_f32 v133, v38, v39
    v_cvt_pk_bf16_f32 v134, v40, v41
    v_cvt_pk_bf16_f32 v135, v42, v43
    v_cvt_pk_bf16_f32 v136, v44, v45
    v_cvt_pk_bf16_f32 v137, v46, v47
    v_mfma_f32_16x16x16_bf16 v[144:147], v[132:133], v[160:161], 0
    v_mfma_f32_16x16x16_bf16 v[144:147], v[134:135], v[162:163], v[144:147]
    v_mfma_f32_16x16x16_bf16 v[144:147], v[136:137], v[164:165], v[144:147]
    s_waitcnt lgkmcnt(0)
    v_cvt_f32_i32 v48, v48
    v_cvt_f32_i32 v49, v49
    v_cvt_f32_i32 v50, v50
    v_cvt_f32_i32 v51, v51
    v_cvt_f32_i32 v52, v52
    v_cvt_f32_i32 v53, v53
    v_cvt_f32_i32 v54, v54
    v_cvt_f32_i32 v55, v55
    v_cvt_f32_i32 v56, v56
    v_cvt_f32_i32 v57, v57
    v_cvt_f32_i32 v58, v58
    v_cvt_f32_i32 v59, v59
    v_sub_f32 v48, v48, v72
    v_sub_f32 v49, v49, v73
    v_sub_f32 v50, v50, v74
    v_sub_f32 v51, v51, v75
    v_sub_f32 v52, v52, v76
    v_sub_f32 v53, v53, v77
    v_sub_f32 v54, v54, v78
    v_sub_f32 v55, v55, v79
    v_sub_f32 v56, v56, v80
    v_sub_f32 v57, v57, v81
    v_sub_f32 v58, v58, v82
    v_sub_f32 v59, v59, v83
    v_cvt_pk_bf16_f32 v48, 0, v48
    v_cvt_pk_bf16_f32 v49, 0, v49
    v_cvt_pk_bf16_f32 v50, 0, v50
    v_cvt_pk_bf16_f32 v51, 0, v51
    v_cvt_pk_bf16_f32 v52, 0, v52
    v_cvt_pk_bf16_f32 v53, 0, v53
    v_cvt_pk_bf16_f32 v54, 0, v54
    v_cvt_pk_bf16_f32 v55, 0, v55
    v_cvt_pk_bf16_f32 v56, 0, v56
    v_cvt_pk_bf16_f32 v57, 0, v57
    v_cvt_pk_bf16_f32 v58, 0, v58
    v_cvt_pk_bf16_f32 v59, 0, v59
    v_mul_f32 v48, v48, v96
    v_mul_f32 v49, v49, v97
    v_mul_f32 v50, v50, v98
    v_mul_f32 v51, v51, v99
    v_mul_f32 v52, v52, v100
    v_mul_f32 v53, v53, v101
    v_mul_f32 v54, v54, v102
    v_mul_f32 v55, v55, v103
    v_mul_f32 v56, v56, v104
    v_mul_f32 v57, v57, v105
    v_mul_f32 v58, v58, v106
    v_mul_f32 v59, v59, v107
    v_cvt_pk_bf16_f32 v138, v48, v49
    v_cvt_pk_bf16_f32 v139, v50, v51
    v_add_f32_dpp v3, v145, v144 row_ror:12 row_mask:0xf bank_mask:0xf
    v_cvt_pk_bf16_f32 v140, v52, v53
    v_cvt_pk_bf16_f32 v141, v54, v55
    v_add_f32_dpp v3, v146, v3 row_ror:8 row_mask:0xf bank_mask:0xf
    v_cvt_pk_bf16_f32 v142, v56, v57
    v_cvt_pk_bf16_f32 v143, v58, v59
    v_add_f32_dpp v15, v147, v3 row_ror:4 row_mask:0xf bank_mask:0x1
    v_mfma_f32_16x16x16_bf16 v[148:151], v[138:139], v[160:161], 0
    v_mfma_f32_16x16x16_bf16 v[148:151], v[140:141], v[162:163], v[148:151]
    v_mfma_f32_16x16x16_bf16 v[148:151], v[142:143], v[164:165], v[148:151]
    v_add_u32 v33, s63, v19
    v_add_u32 v34, s63, v20
    ds_read_b64 v[108:109], v33 offset:0
    ds_read_b64 v[110:111], v33 offset:1536
    ds_read_b64 v[112:113], v33 offset:128
    ds_read_b64 v[114:115], v33 offset:1664
    ds_read_b64 v[116:117], v33 offset:256
    ds_read_b64 v[118:119], v33 offset:1792
    ds_read_b64 v[120:121], v34 offset:0
    v_add_f32_dpp v4, v149, v148 row_ror:12 row_mask:0xf bank_mask:0xf
    ds_read_b64 v[122:123], v34 offset:1536
    ds_read_b64 v[124:125], v34 offset:128
    v_add_f32_dpp v4, v150, v4 row_ror:8 row_mask:0xf bank_mask:0xf
    ds_read_b64 v[126:127], v34 offset:1664
    ds_read_b64 v[128:129], v34 offset:256
    ds_read_b64 v[130:131], v34 offset:1792
    v_add_f32_dpp v16, v151, v4 row_ror:4 row_mask:0xf bank_mask:0x1
    s_waitcnt lgkmcnt(0)
    v_lshlrev_b32 v60, 16, v108
    v_and_b32 v61, s66, v108
    v_lshlrev_b32 v62, 16, v109
    v_and_b32 v63, s66, v109
    v_lshlrev_b32 v84, 16, v110
    v_and_b32 v85, s66, v110
    v_lshlrev_b32 v86, 16, v111
    v_and_b32 v87, s66, v111
    v_lshlrev_b32 v64, 16, v112
    v_and_b32 v65, s66, v112
    v_lshlrev_b32 v66, 16, v113
    v_and_b32 v67, s66, v113
    v_lshlrev_b32 v88, 16, v114
    v_and_b32 v89, s66, v114
    v_lshlrev_b32 v90, 16, v115
    v_and_b32 v91, s66, v115
    v_lshlrev_b32 v68, 16, v116
    v_and_b32 v69, s66, v116
    v_lshlrev_b32 v70, 16, v117
    v_and_b32 v71, s66, v117
    v_lshlrev_b32 v92, 16, v118
    v_and_b32 v93, s66, v118
    v_lshlrev_b32 v94, 16, v119
    v_and_b32 v95, s66, v119
    v_lshlrev_b32 v72, 16, v120
    v_and_b32 v73, s66, v120
    v_lshlrev_b32 v74, 16, v121
    v_and_b32 v75, s66, v121
    v_lshlrev_b32 v96, 16, v122
    v_and_b32 v97, s66, v122
    v_lshlrev_b32 v98, 16, v123
    v_and_b32 v99, s66, v123
    v_lshlrev_b32 v76, 16, v124
    v_and_b32 v77, s66, v124
    v_lshlrev_b32 v78, 16, v125
    v_and_b32 v79, s66, v125
    v_lshlrev_b32 v100, 16, v126
    v_and_b32 v101, s66, v126
    v_lshlrev_b32 v102, 16, v127
    v_and_b32 v103, s66, v127
    v_lshlrev_b32 v80, 16, v128
    v_and_b32 v81, s66, v128
    v_lshlrev_b32 v82, 16, v129
    v_and_b32 v83, s66, v129
    v_lshlrev_b32 v104, 16, v130
    v_and_b32 v105, s66, v130
    v_lshlrev_b32 v106, 16, v131
    v_and_b32 v107, s66, v131
    v_add_u32 v13, s62, v12
    s_add_u32 s62, s62, 24576
    s_cmp_eq_u32 s62, 73728
    s_cselect_b32 s62, 0, s62
    s_barrier
    ds_read_b128 v[36:39], v13 offset:0
    ds_read_b128 v[40:43], v13 offset:256
    ds_read_b128 v[44:47], v13 offset:512
    ds_read_b128 v[48:51], v13 offset:3072
    ds_read_b128 v[52:55], v13 offset:3328
    ds_read_b128 v[56:59], v13 offset:3584
    s_waitcnt lgkmcnt(3)
    v_cvt_f32_i32 v36, v36
    v_cvt_f32_i32 v37, v37
    v_cvt_f32_i32 v38, v38
    v_cvt_f32_i32 v39, v39
    v_cvt_f32_i32 v40, v40
    v_cvt_f32_i32 v41, v41
    v_cvt_f32_i32 v42, v42
    v_cvt_f32_i32 v43, v43
    v_cvt_f32_i32 v44, v44
    v_cvt_f32_i32 v45, v45
    v_cvt_f32_i32 v46, v46
    v_cvt_f32_i32 v47, v47
    v_sub_f32 v36, v36, v60
    v_sub_f32 v37, v37, v61
    v_sub_f32 v38, v38, v62
    v_sub_f32 v39, v39, v63
    v_sub_f32 v40, v40, v64
    v_sub_f32 v41, v41, v65
    v_sub_f32 v42, v42, v66
    v_sub_f32 v43, v43, v67
    v_sub_f32 v44, v44, v68
    v_sub_f32 v45, v45, v69
    v_sub_f32 v46, v46, v70
    v_sub_f32 v47, v47, v71
    v_cvt_pk_bf16_f32 v36, 0, v36
    v_cvt_pk_bf16_f32 v37, 0, v37
    v_cvt_pk_bf16_f32 v38, 0, v38
    v_cvt_pk_bf16_f32 v39, 0, v39
    v_cvt_pk_bf16_f32 v40, 0, v40
    v_cvt_pk_bf16_f32 v41, 0, v41
    v_cvt_pk_bf16_f32 v42, 0, v42
    v_cvt_pk_bf16_f32 v43, 0, v43
    v_cvt_pk_bf16_f32 v44, 0, v44
    v_cvt_pk_bf16_f32 v45, 0, v45
    v_cvt_pk_bf16_f32 v46, 0, v46
    v_cvt_pk_bf16_f32 v47, 0, v47
    v_mul_f32 v36, v36, v84
    v_mul_f32 v37, v37, v85
    v_mul_f32 v38, v38, v86
    v_mul_f32 v39, v39, v87
    v_mul_f32 v40, v40, v88
    v_mul_f32 v41, v41, v89
    v_mul_f32 v42, v42, v90
    v_mul_f32 v43, v43, v91
    v_mul_f32 v44, v44, v92
    v_mul_f32 v45, v45, v93
    v_mul_f32 v46, v46, v94
    v_mul_f32 v47, v47, v95
    v_cvt_pk_bf16_f32 v132, v36, v37
    v_cvt_pk_bf16_f32 v133, v38, v39
    v_cvt_pk_bf16_f32 v134, v40, v41
    v_cvt_pk_bf16_f32 v135, v42, v43
    v_cvt_pk_bf16_f32 v136, v44, v45
    v_cvt_pk_bf16_f32 v137, v46, v47
    v_mfma_f32_16x16x16_bf16 v[144:147], v[132:133], v[160:161], 0
    v_mfma_f32_16x16x16_bf16 v[144:147], v[134:135], v[162:163], v[144:147]
    v_mfma_f32_16x16x16_bf16 v[144:147], v[136:137], v[164:165], v[144:147]
    s_waitcnt lgkmcnt(0)
    v_cvt_f32_i32 v48, v48
    v_cvt_f32_i32 v49, v49
    v_cvt_f32_i32 v50, v50
    v_cvt_f32_i32 v51, v51
    v_cvt_f32_i32 v52, v52
    v_cvt_f32_i32 v53, v53
    v_cvt_f32_i32 v54, v54
    v_cvt_f32_i32 v55, v55
    v_cvt_f32_i32 v56, v56
    v_cvt_f32_i32 v57, v57
    v_cvt_f32_i32 v58, v58
    v_cvt_f32_i32 v59, v59
    v_sub_f32 v48, v48, v72
    v_sub_f32 v49, v49, v73
    v_sub_f32 v50, v50, v74
    v_sub_f32 v51, v51, v75
    v_sub_f32 v52, v52, v76
    v_sub_f32 v53, v53, v77
    v_sub_f32 v54, v54, v78
    v_sub_f32 v55, v55, v79
    v_sub_f32 v56, v56, v80
    v_sub_f32 v57, v57, v81
    v_sub_f32 v58, v58, v82
    v_sub_f32 v59, v59, v83
    v_cvt_pk_bf16_f32 v48, 0, v48
    v_cvt_pk_bf16_f32 v49, 0, v49
    v_cvt_pk_bf16_f32 v50, 0, v50
    v_cvt_pk_bf16_f32 v51, 0, v51
    v_cvt_pk_bf16_f32 v52, 0, v52
    v_cvt_pk_bf16_f32 v53, 0, v53
    v_cvt_pk_bf16_f32 v54, 0, v54
    v_cvt_pk_bf16_f32 v55, 0, v55
    v_cvt_pk_bf16_f32 v56, 0, v56
    v_cvt_pk_bf16_f32 v57, 0, v57
    v_cvt_pk_bf16_f32 v58, 0, v58
    v_cvt_pk_bf16_f32 v59, 0, v59
    v_mul_f32 v48, v48, v96
    v_mul_f32 v49, v49, v97
    v_mul_f32 v50, v50, v98
    v_mul_f32 v51, v51, v99
    v_mul_f32 v52, v52, v100
    v_mul_f32 v53, v53, v101
    v_mul_f32 v54, v54, v102
    v_mul_f32 v55, v55, v103
    v_mul_f32 v56, v56, v104
    v_mul_f32 v57, v57, v105
    v_mul_f32 v58, v58, v106
    v_mul_f32 v59, v59, v107
    v_cvt_pk_bf16_f32 v138, v48, v49
    v_cvt_pk_bf16_f32 v139, v50, v51
    v_add_f32_dpp v3, v146, v145 row_ror:12 row_mask:0xf bank_mask:0xf
    v_cvt_pk_bf16_f32 v140, v52, v53
    v_cvt_pk_bf16_f32 v141, v54, v55
    v_add_f32_dpp v3, v147, v3 row_ror:8 row_mask:0xf bank_mask:0xf
    v_cvt_pk_bf16_f32 v142, v56, v57
    v_cvt_pk_bf16_f32 v143, v58, v59
    v_add_f32_dpp v15, v144, v3 row_ror:4 row_mask:0xf bank_mask:0x2
    v_mfma_f32_16x16x16_bf16 v[148:151], v[138:139], v[160:161], 0
    v_mfma_f32_16x16x16_bf16 v[148:151], v[140:141], v[162:163], v[148:151]
    v_mfma_f32_16x16x16_bf16 v[148:151], v[142:143], v[164:165], v[148:151]
    v_add_u32 v33, s63, v21
    v_add_u32 v34, s63, v22
    ds_read_b64 v[108:109], v33 offset:0
    ds_read_b64 v[110:111], v33 offset:1536
    ds_read_b64 v[112:113], v33 offset:128
    ds_read_b64 v[114:115], v33 offset:1664
    ds_read_b64 v[116:117], v33 offset:256
    ds_read_b64 v[118:119], v33 offset:1792
    ds_read_b64 v[120:121], v34 offset:0
    v_add_f32_dpp v4, v150, v149 row_ror:12 row_mask:0xf bank_mask:0xf
    ds_read_b64 v[122:123], v34 offset:1536
    ds_read_b64 v[124:125], v34 offset:128
    v_add_f32_dpp v4, v151, v4 row_ror:8 row_mask:0xf bank_mask:0xf
    ds_read_b64 v[126:127], v34 offset:1664
    ds_read_b64 v[128:129], v34 offset:256
    ds_read_b64 v[130:131], v34 offset:1792
    v_add_f32_dpp v16, v148, v4 row_ror:4 row_mask:0xf bank_mask:0x2
    s_waitcnt lgkmcnt(0)
    v_lshlrev_b32 v60, 16, v108
    v_and_b32 v61, s66, v108
    v_lshlrev_b32 v62, 16, v109
    v_and_b32 v63, s66, v109
    v_lshlrev_b32 v84, 16, v110
    v_and_b32 v85, s66, v110
    v_lshlrev_b32 v86, 16, v111
    v_and_b32 v87, s66, v111
    v_lshlrev_b32 v64, 16, v112
    v_and_b32 v65, s66, v112
    v_lshlrev_b32 v66, 16, v113
    v_and_b32 v67, s66, v113
    v_lshlrev_b32 v88, 16, v114
    v_and_b32 v89, s66, v114
    v_lshlrev_b32 v90, 16, v115
    v_and_b32 v91, s66, v115
    v_lshlrev_b32 v68, 16, v116
    v_and_b32 v69, s66, v116
    v_lshlrev_b32 v70, 16, v117
    v_and_b32 v71, s66, v117
    v_lshlrev_b32 v92, 16, v118
    v_and_b32 v93, s66, v118
    v_lshlrev_b32 v94, 16, v119
    v_and_b32 v95, s66, v119
    v_lshlrev_b32 v72, 16, v120
    v_and_b32 v73, s66, v120
    v_lshlrev_b32 v74, 16, v121
    v_and_b32 v75, s66, v121
    v_lshlrev_b32 v96, 16, v122
    v_and_b32 v97, s66, v122
    v_lshlrev_b32 v98, 16, v123
    v_and_b32 v99, s66, v123
    v_lshlrev_b32 v76, 16, v124
    v_and_b32 v77, s66, v124
    v_lshlrev_b32 v78, 16, v125
    v_and_b32 v79, s66, v125
    v_lshlrev_b32 v100, 16, v126
    v_and_b32 v101, s66, v126
    v_lshlrev_b32 v102, 16, v127
    v_and_b32 v103, s66, v127
    v_lshlrev_b32 v80, 16, v128
    v_and_b32 v81, s66, v128
    v_lshlrev_b32 v82, 16, v129
    v_and_b32 v83, s66, v129
    v_lshlrev_b32 v104, 16, v130
    v_and_b32 v105, s66, v130
    v_lshlrev_b32 v106, 16, v131
    v_and_b32 v107, s66, v131
    v_add_u32 v13, s62, v12
    s_add_u32 s62, s62, 24576
    s_cmp_eq_u32 s62, 73728
    s_cselect_b32 s62, 0, s62
    s_barrier
    ds_read_b128 v[36:39], v13 offset:0
    ds_read_b128 v[40:43], v13 offset:256
    ds_read_b128 v[44:47], v13 offset:512
    ds_read_b128 v[48:51], v13 offset:3072
    ds_read_b128 v[52:55], v13 offset:3328
    ds_read_b128 v[56:59], v13 offset:3584
    s_waitcnt lgkmcnt(3)
    v_cvt_f32_i32 v36, v36
    v_cvt_f32_i32 v37, v37
    v_cvt_f32_i32 v38, v38
    v_cvt_f32_i32 v39, v39
    v_cvt_f32_i32 v40, v40
    v_cvt_f32_i32 v41, v41
    v_cvt_f32_i32 v42, v42
    v_cvt_f32_i32 v43, v43
    v_cvt_f32_i32 v44, v44
    v_cvt_f32_i32 v45, v45
    v_cvt_f32_i32 v46, v46
    v_cvt_f32_i32 v47, v47
    v_sub_f32 v36, v36, v60
    v_sub_f32 v37, v37, v61
    v_sub_f32 v38, v38, v62
    v_sub_f32 v39, v39, v63
    v_sub_f32 v40, v40, v64
    v_sub_f32 v41, v41, v65
    v_sub_f32 v42, v42, v66
    v_sub_f32 v43, v43, v67
    v_sub_f32 v44, v44, v68
    v_sub_f32 v45, v45, v69
    v_sub_f32 v46, v46, v70
    v_sub_f32 v47, v47, v71
    v_cvt_pk_bf16_f32 v36, 0, v36
    v_cvt_pk_bf16_f32 v37, 0, v37
    v_cvt_pk_bf16_f32 v38, 0, v38
    v_cvt_pk_bf16_f32 v39, 0, v39
    v_cvt_pk_bf16_f32 v40, 0, v40
    v_cvt_pk_bf16_f32 v41, 0, v41
    v_cvt_pk_bf16_f32 v42, 0, v42
    v_cvt_pk_bf16_f32 v43, 0, v43
    v_cvt_pk_bf16_f32 v44, 0, v44
    v_cvt_pk_bf16_f32 v45, 0, v45
    v_cvt_pk_bf16_f32 v46, 0, v46
    v_cvt_pk_bf16_f32 v47, 0, v47
    v_mul_f32 v36, v36, v84
    v_mul_f32 v37, v37, v85
    v_mul_f32 v38, v38, v86
    v_mul_f32 v39, v39, v87
    v_mul_f32 v40, v40, v88
    v_mul_f32 v41, v41, v89
    v_mul_f32 v42, v42, v90
    v_mul_f32 v43, v43, v91
    v_mul_f32 v44, v44, v92
    v_mul_f32 v45, v45, v93
    v_mul_f32 v46, v46, v94
    v_mul_f32 v47, v47, v95
    v_cvt_pk_bf16_f32 v132, v36, v37
    v_cvt_pk_bf16_f32 v133, v38, v39
    v_cvt_pk_bf16_f32 v134, v40, v41
    v_cvt_pk_bf16_f32 v135, v42, v43
    v_cvt_pk_bf16_f32 v136, v44, v45
    v_cvt_pk_bf16_f32 v137, v46, v47
    v_mfma_f32_16x16x16_bf16 v[144:147], v[132:133], v[160:161], 0
    v_mfma_f32_16x16x16_bf16 v[144:147], v[134:135], v[162:163], v[144:147]
    v_mfma_f32_16x16x16_bf16 v[144:147], v[136:137], v[164:165], v[144:147]
    s_waitcnt lgkmcnt(0)
    v_cvt_f32_i32 v48, v48
    v_cvt_f32_i32 v49, v49
    v_cvt_f32_i32 v50, v50
    v_cvt_f32_i32 v51, v51
    v_cvt_f32_i32 v52, v52
    v_cvt_f32_i32 v53, v53
    v_cvt_f32_i32 v54, v54
    v_cvt_f32_i32 v55, v55
    v_cvt_f32_i32 v56, v56
    v_cvt_f32_i32 v57, v57
    v_cvt_f32_i32 v58, v58
    v_cvt_f32_i32 v59, v59
    v_sub_f32 v48, v48, v72
    v_sub_f32 v49, v49, v73
    v_sub_f32 v50, v50, v74
    v_sub_f32 v51, v51, v75
    v_sub_f32 v52, v52, v76
    v_sub_f32 v53, v53, v77
    v_sub_f32 v54, v54, v78
    v_sub_f32 v55, v55, v79
    v_sub_f32 v56, v56, v80
    v_sub_f32 v57, v57, v81
    v_sub_f32 v58, v58, v82
    v_sub_f32 v59, v59, v83
    v_cvt_pk_bf16_f32 v48, 0, v48
    v_cvt_pk_bf16_f32 v49, 0, v49
    v_cvt_pk_bf16_f32 v50, 0, v50
    v_cvt_pk_bf16_f32 v51, 0, v51
    v_cvt_pk_bf16_f32 v52, 0, v52
    v_cvt_pk_bf16_f32 v53, 0, v53
    v_cvt_pk_bf16_f32 v54, 0, v54
    v_cvt_pk_bf16_f32 v55, 0, v55
    v_cvt_pk_bf16_f32 v56, 0, v56
    v_cvt_pk_bf16_f32 v57, 0, v57
    v_cvt_pk_bf16_f32 v58, 0, v58
    v_cvt_pk_bf16_f32 v59, 0, v59
    v_mul_f32 v48, v48, v96
    v_mul_f32 v49, v49, v97
    v_mul_f32 v50, v50, v98
    v_mul_f32 v51, v51, v99
    v_mul_f32 v52, v52, v100
    v_mul_f32 v53, v53, v101
    v_mul_f32 v54, v54, v102
    v_mul_f32 v55, v55, v103
    v_mul_f32 v56, v56, v104
    v_mul_f32 v57, v57, v105
    v_mul_f32 v58, v58, v106
    v_mul_f32 v59, v59, v107
    v_cvt_pk_bf16_f32 v138, v48, v49
    v_cvt_pk_bf16_f32 v139, v50, v51
    v_add_f32_dpp v3, v147, v146 row_ror:12 row_mask:0xf bank_mask:0xf
    v_cvt_pk_bf16_f32 v140, v52, v53
    v_cvt_pk_bf16_f32 v141, v54, v55
    v_add_f32_dpp v3, v144, v3 row_ror:8 row_mask:0xf bank_mask:0xf
    v_cvt_pk_bf16_f32 v142, v56, v57
    v_cvt_pk_bf16_f32 v143, v58, v59
    v_add_f32_dpp v15, v145, v3 row_ror:4 row_mask:0xf bank_mask:0x4
    v_mfma_f32_16x16x16_bf16 v[148:151], v[138:139], v[160:161], 0
    v_mfma_f32_16x16x16_bf16 v[148:151], v[140:141], v[162:163], v[148:151]
    v_mfma_f32_16x16x16_bf16 v[148:151], v[142:143], v[164:165], v[148:151]
    v_add_u32 v33, s63, v23
    v_add_u32 v34, s63, v24
    ds_read_b64 v[108:109], v33 offset:0
    ds_read_b64 v[110:111], v33 offset:1536
    ds_read_b64 v[112:113], v33 offset:128
    ds_read_b64 v[114:115], v33 offset:1664
    ds_read_b64 v[116:117], v33 offset:256
    ds_read_b64 v[118:119], v33 offset:1792
    ds_read_b64 v[120:121], v34 offset:0
    v_add_f32_dpp v4, v151, v150 row_ror:12 row_mask:0xf bank_mask:0xf
    ds_read_b64 v[122:123], v34 offset:1536
    ds_read_b64 v[124:125], v34 offset:128
    v_add_f32_dpp v4, v148, v4 row_ror:8 row_mask:0xf bank_mask:0xf
    ds_read_b64 v[126:127], v34 offset:1664
    ds_read_b64 v[128:129], v34 offset:256
    ds_read_b64 v[130:131], v34 offset:1792
    v_add_f32_dpp v16, v149, v4 row_ror:4 row_mask:0xf bank_mask:0x4
    s_waitcnt lgkmcnt(0)
    v_lshlrev_b32 v60, 16, v108
    v_and_b32 v61, s66, v108
    v_lshlrev_b32 v62, 16, v109
    v_and_b32 v63, s66, v109
    v_lshlrev_b32 v84, 16, v110
    v_and_b32 v85, s66, v110
    v_lshlrev_b32 v86, 16, v111
    v_and_b32 v87, s66, v111
    v_lshlrev_b32 v64, 16, v112
    v_and_b32 v65, s66, v112
    v_lshlrev_b32 v66, 16, v113
    v_and_b32 v67, s66, v113
    v_lshlrev_b32 v88, 16, v114
    v_and_b32 v89, s66, v114
    v_lshlrev_b32 v90, 16, v115
    v_and_b32 v91, s66, v115
    v_lshlrev_b32 v68, 16, v116
    v_and_b32 v69, s66, v116
    v_lshlrev_b32 v70, 16, v117
    v_and_b32 v71, s66, v117
    v_lshlrev_b32 v92, 16, v118
    v_and_b32 v93, s66, v118
    v_lshlrev_b32 v94, 16, v119
    v_and_b32 v95, s66, v119
    v_lshlrev_b32 v72, 16, v120
    v_and_b32 v73, s66, v120
    v_lshlrev_b32 v74, 16, v121
    v_and_b32 v75, s66, v121
    v_lshlrev_b32 v96, 16, v122
    v_and_b32 v97, s66, v122
    v_lshlrev_b32 v98, 16, v123
    v_and_b32 v99, s66, v123
    v_lshlrev_b32 v76, 16, v124
    v_and_b32 v77, s66, v124
    v_lshlrev_b32 v78, 16, v125
    v_and_b32 v79, s66, v125
    v_lshlrev_b32 v100, 16, v126
    v_and_b32 v101, s66, v126
    v_lshlrev_b32 v102, 16, v127
    v_and_b32 v103, s66, v127
    v_lshlrev_b32 v80, 16, v128
    v_and_b32 v81, s66, v128
    v_lshlrev_b32 v82, 16, v129
    v_and_b32 v83, s66, v129
    v_lshlrev_b32 v104, 16, v130
    v_and_b32 v105, s66, v130
    v_lshlrev_b32 v106, 16, v131
    v_and_b32 v107, s66, v131
    v_add_u32 v13, s62, v12
    s_add_u32 s62, s62, 24576
    s_cmp_eq_u32 s62, 73728
    s_cselect_b32 s62, 0, s62
    s_barrier
    ds_read_b128 v[36:39], v13 offset:0
    ds_read_b128 v[40:43], v13 offset:256
    ds_read_b128 v[44:47], v13 offset:512
    ds_read_b128 v[48:51], v13 offset:3072
    ds_read_b128 v[52:55], v13 offset:3328
    ds_read_b128 v[56:59], v13 offset:3584
    s_waitcnt lgkmcnt(3)
    v_cvt_f32_i32 v36, v36
    v_cvt_f32_i32 v37, v37
    v_cvt_f32_i32 v38, v38
    v_cvt_f32_i32 v39, v39
    v_cvt_f32_i32 v40, v40
    v_cvt_f32_i32 v41, v41
    v_cvt_f32_i32 v42, v42
    v_cvt_f32_i32 v43, v43
    v_cvt_f32_i32 v44, v44
    v_cvt_f32_i32 v45, v45
    v_cvt_f32_i32 v46, v46
    v_cvt_f32_i32 v47, v47
    v_sub_f32 v36, v36, v60
    v_sub_f32 v37, v37, v61
    v_sub_f32 v38, v38, v62
    v_sub_f32 v39, v39, v63
    v_sub_f32 v40, v40, v64
    v_sub_f32 v41, v41, v65
    v_sub_f32 v42, v42, v66
    v_sub_f32 v43, v43, v67
    v_sub_f32 v44, v44, v68
    v_sub_f32 v45, v45, v69
    v_sub_f32 v46, v46, v70
    v_sub_f32 v47, v47, v71
    v_cvt_pk_bf16_f32 v36, 0, v36
    v_cvt_pk_bf16_f32 v37, 0, v37
    v_cvt_pk_bf16_f32 v38, 0, v38
    v_cvt_pk_bf16_f32 v39, 0, v39
    v_cvt_pk_bf16_f32 v40, 0, v40
    v_cvt_pk_bf16_f32 v41, 0, v41
    v_cvt_pk_bf16_f32 v42, 0, v42
    v_cvt_pk_bf16_f32 v43, 0, v43
    v_cvt_pk_bf16_f32 v44, 0, v44
    v_cvt_pk_bf16_f32 v45, 0, v45
    v_cvt_pk_bf16_f32 v46, 0, v46
    v_cvt_pk_bf16_f32 v47, 0, v47
    v_mul_f32 v36, v36, v84
    v_mul_f32 v37, v37, v85
    v_mul_f32 v38, v38, v86
    v_mul_f32 v39, v39, v87
    v_mul_f32 v40, v40, v88
    v_mul_f32 v41, v41, v89
    v_mul_f32 v42, v42, v90
    v_mul_f32 v43, v43, v91
    v_mul_f32 v44, v44, v92
    v_mul_f32 v45, v45, v93
    v_mul_f32 v46, v46, v94
    v_mul_f32 v47, v47, v95
    v_cvt_pk_bf16_f32 v132, v36, v37
    v_cvt_pk_bf16_f32 v133, v38, v39
    v_cvt_pk_bf16_f32 v134, v40, v41
    v_cvt_pk_bf16_f32 v135, v42, v43
    v_cvt_pk_bf16_f32 v136, v44, v45
    v_cvt_pk_bf16_f32 v137, v46, v47
    v_mfma_f32_16x16x16_bf16 v[144:147], v[132:133], v[160:161], 0
    v_mfma_f32_16x16x16_bf16 v[144:147], v[134:135], v[162:163], v[144:147]
    v_mfma_f32_16x16x16_bf16 v[144:147], v[136:137], v[164:165], v[144:147]
    s_waitcnt lgkmcnt(0)
    v_cvt_f32_i32 v48, v48
    v_cvt_f32_i32 v49, v49
    v_cvt_f32_i32 v50, v50
    v_cvt_f32_i32 v51, v51
    v_cvt_f32_i32 v52, v52
    v_cvt_f32_i32 v53, v53
    v_cvt_f32_i32 v54, v54
    v_cvt_f32_i32 v55, v55
    v_cvt_f32_i32 v56, v56
    v_cvt_f32_i32 v57, v57
    v_cvt_f32_i32 v58, v58
    v_cvt_f32_i32 v59, v59
    v_sub_f32 v48, v48, v72
    v_sub_f32 v49, v49, v73
    v_sub_f32 v50, v50, v74
    v_sub_f32 v51, v51, v75
    v_sub_f32 v52, v52, v76
    v_sub_f32 v53, v53, v77
    v_sub_f32 v54, v54, v78
    v_sub_f32 v55, v55, v79
    v_sub_f32 v56, v56, v80
    v_sub_f32 v57, v57, v81
    v_sub_f32 v58, v58, v82
    v_sub_f32 v59, v59, v83
    v_cvt_pk_bf16_f32 v48, 0, v48
    v_cvt_pk_bf16_f32 v49, 0, v49
    v_cvt_pk_bf16_f32 v50, 0, v50
    v_cvt_pk_bf16_f32 v51, 0, v51
    v_cvt_pk_bf16_f32 v52, 0, v52
    v_cvt_pk_bf16_f32 v53, 0, v53
    v_cvt_pk_bf16_f32 v54, 0, v54
    v_cvt_pk_bf16_f32 v55, 0, v55
    v_cvt_pk_bf16_f32 v56, 0, v56
    v_cvt_pk_bf16_f32 v57, 0, v57
    v_cvt_pk_bf16_f32 v58, 0, v58
    v_cvt_pk_bf16_f32 v59, 0, v59
    v_mul_f32 v48, v48, v96
    v_mul_f32 v49, v49, v97
    v_mul_f32 v50, v50, v98
    v_mul_f32 v51, v51, v99
    v_mul_f32 v52, v52, v100
    v_mul_f32 v53, v53, v101
    v_mul_f32 v54, v54, v102
    v_mul_f32 v55, v55, v103
    v_mul_f32 v56, v56, v104
    v_mul_f32 v57, v57, v105
    v_mul_f32 v58, v58, v106
    v_mul_f32 v59, v59, v107
    v_cvt_pk_bf16_f32 v138, v48, v49
    v_cvt_pk_bf16_f32 v139, v50, v51
    v_add_f32_dpp v3, v144, v147 row_ror:12 row_mask:0xf bank_mask:0xf
    v_cvt_pk_bf16_f32 v140, v52, v53
    v_cvt_pk_bf16_f32 v141, v54, v55
    v_add_f32_dpp v3, v145, v3 row_ror:8 row_mask:0xf bank_mask:0xf
    v_cvt_pk_bf16_f32 v142, v56, v57
    v_cvt_pk_bf16_f32 v143, v58, v59
    v_add_f32_dpp v15, v146, v3 row_ror:4 row_mask:0xf bank_mask:0x8
    v_mfma_f32_16x16x16_bf16 v[148:151], v[138:139], v[160:161], 0
    v_mfma_f32_16x16x16_bf16 v[148:151], v[140:141], v[162:163], v[148:151]
    v_mfma_f32_16x16x16_bf16 v[148:151], v[142:143], v[164:165], v[148:151]
    v_add_u32 v33, s63, v25
    v_add_u32 v34, s63, v26
    ds_read_b64 v[108:109], v33 offset:0
    ds_read_b64 v[110:111], v33 offset:1536
    ds_read_b64 v[112:113], v33 offset:128
    ds_read_b64 v[114:115], v33 offset:1664
    ds_read_b64 v[116:117], v33 offset:256
    ds_read_b64 v[118:119], v33 offset:1792
    ds_read_b64 v[120:121], v34 offset:0
    v_add_f32_dpp v4, v148, v151 row_ror:12 row_mask:0xf bank_mask:0xf
    ds_read_b64 v[122:123], v34 offset:1536
    ds_read_b64 v[124:125], v34 offset:128
    v_add_f32_dpp v4, v149, v4 row_ror:8 row_mask:0xf bank_mask:0xf
    ds_read_b64 v[126:127], v34 offset:1664
    ds_read_b64 v[128:129], v34 offset:256
    ds_read_b64 v[130:131], v34 offset:1792
    v_add_f32_dpp v16, v150, v4 row_ror:4 row_mask:0xf bank_mask:0x8
    v_cvt_pk_bf16_f32 v3, 0, v15
    v_cvt_pk_bf16_f32 v4, 0, v16
    v_mul_f32 v3, s65, v3
    v_mul_f32 v4, s65, v4
    v_cvt_pk_bf16_f32 v5, v3, v4
    v_max3_f32 v14, v14, v3, v4
    ds_write_b32 v11, v5 offset:0
    s_waitcnt lgkmcnt(0)
    v_lshlrev_b32 v60, 16, v108
    v_and_b32 v61, s66, v108
    v_lshlrev_b32 v62, 16, v109
    v_and_b32 v63, s66, v109
    v_lshlrev_b32 v84, 16, v110
    v_and_b32 v85, s66, v110
    v_lshlrev_b32 v86, 16, v111
    v_and_b32 v87, s66, v111
    v_lshlrev_b32 v64, 16, v112
    v_and_b32 v65, s66, v112
    v_lshlrev_b32 v66, 16, v113
    v_and_b32 v67, s66, v113
    v_lshlrev_b32 v88, 16, v114
    v_and_b32 v89, s66, v114
    v_lshlrev_b32 v90, 16, v115
    v_and_b32 v91, s66, v115
    v_lshlrev_b32 v68, 16, v116
    v_and_b32 v69, s66, v116
    v_lshlrev_b32 v70, 16, v117
    v_and_b32 v71, s66, v117
    v_lshlrev_b32 v92, 16, v118
    v_and_b32 v93, s66, v118
    v_lshlrev_b32 v94, 16, v119
    v_and_b32 v95, s66, v119
    v_lshlrev_b32 v72, 16, v120
    v_and_b32 v73, s66, v120
    v_lshlrev_b32 v74, 16, v121
    v_and_b32 v75, s66, v121
    v_lshlrev_b32 v96, 16, v122
    v_and_b32 v97, s66, v122
    v_lshlrev_b32 v98, 16, v123
    v_and_b32 v99, s66, v123
    v_lshlrev_b32 v76, 16, v124
    v_and_b32 v77, s66, v124
    v_lshlrev_b32 v78, 16, v125
    v_and_b32 v79, s66, v125
    v_lshlrev_b32 v100, 16, v126
    v_and_b32 v101, s66, v126
    v_lshlrev_b32 v102, 16, v127
    v_and_b32 v103, s66, v127
    v_lshlrev_b32 v80, 16, v128
    v_and_b32 v81, s66, v128
    v_lshlrev_b32 v82, 16, v129
    v_and_b32 v83, s66, v129
    v_lshlrev_b32 v104, 16, v130
    v_and_b32 v105, s66, v130
    v_lshlrev_b32 v106, 16, v131
    v_and_b32 v107, s66, v131
    s_waitcnt vmcnt(0)
    v_add_u32 v13, s62, v12
    s_add_u32 s62, s62, 24576
    s_cmp_eq_u32 s62, 73728
    s_cselect_b32 s62, 0, s62
    s_barrier
    ds_read_b128 v[36:39], v13 offset:0
    ds_read_b128 v[40:43], v13 offset:256
    ds_read_b128 v[44:47], v13 offset:512
    ds_read_b128 v[48:51], v13 offset:3072
    ds_read_b128 v[52:55], v13 offset:3328
    ds_read_b128 v[56:59], v13 offset:3584
    s_waitcnt lgkmcnt(3)
    v_cvt_f32_i32 v36, v36
    v_cvt_f32_i32 v37, v37
    v_cvt_f32_i32 v38, v38
    v_cvt_f32_i32 v39, v39
    v_cvt_f32_i32 v40, v40
    v_cvt_f32_i32 v41, v41
    v_cvt_f32_i32 v42, v42
    v_cvt_f32_i32 v43, v43
    v_cvt_f32_i32 v44, v44
    v_cvt_f32_i32 v45, v45
    v_cvt_f32_i32 v46, v46
    v_cvt_f32_i32 v47, v47
    v_sub_f32 v36, v36, v60
    v_sub_f32 v37, v37, v61
    v_sub_f32 v38, v38, v62
    v_sub_f32 v39, v39, v63
    v_sub_f32 v40, v40, v64
    v_sub_f32 v41, v41, v65
    v_sub_f32 v42, v42, v66
    v_sub_f32 v43, v43, v67
    v_sub_f32 v44, v44, v68
    v_sub_f32 v45, v45, v69
    v_sub_f32 v46, v46, v70
    v_sub_f32 v47, v47, v71
    v_cvt_pk_bf16_f32 v36, 0, v36
    v_cvt_pk_bf16_f32 v37, 0, v37
    v_cvt_pk_bf16_f32 v38, 0, v38
    v_cvt_pk_bf16_f32 v39, 0, v39
    v_cvt_pk_bf16_f32 v40, 0, v40
    v_cvt_pk_bf16_f32 v41, 0, v41
    v_cvt_pk_bf16_f32 v42, 0, v42
    v_cvt_pk_bf16_f32 v43, 0, v43
    v_cvt_pk_bf16_f32 v44, 0, v44
    v_cvt_pk_bf16_f32 v45, 0, v45
    v_cvt_pk_bf16_f32 v46, 0, v46
    v_cvt_pk_bf16_f32 v47, 0, v47
    v_mul_f32 v36, v36, v84
    v_mul_f32 v37, v37, v85
    v_mul_f32 v38, v38, v86
    v_mul_f32 v39, v39, v87
    v_mul_f32 v40, v40, v88
    v_mul_f32 v41, v41, v89
    v_mul_f32 v42, v42, v90
    v_mul_f32 v43, v43, v91
    v_mul_f32 v44, v44, v92
    v_mul_f32 v45, v45, v93
    v_mul_f32 v46, v46, v94
    v_mul_f32 v47, v47, v95
    v_cvt_pk_bf16_f32 v132, v36, v37
    v_cvt_pk_bf16_f32 v133, v38, v39
    v_cvt_pk_bf16_f32 v134, v40, v41
    v_cvt_pk_bf16_f32 v135, v42, v43
    v_cvt_pk_bf16_f32 v136, v44, v45
    v_cvt_pk_bf16_f32 v137, v46, v47
    v_mfma_f32_16x16x16_bf16 v[144:147], v[132:133], v[160:161], 0
    v_mfma_f32_16x16x16_bf16 v[144:147], v[134:135], v[162:163], v[144:147]
    v_mfma_f32_16x16x16_bf16 v[144:147], v[136:137], v[164:165], v[144:147]
    s_waitcnt lgkmcnt(0)
    v_cvt_f32_i32 v48, v48
    v_cvt_f32_i32 v49, v49
    v_cvt_f32_i32 v50, v50
    v_cvt_f32_i32 v51, v51
    v_cvt_f32_i32 v52, v52
    v_cvt_f32_i32 v53, v53
    v_cvt_f32_i32 v54, v54
    v_cvt_f32_i32 v55, v55
    v_cvt_f32_i32 v56, v56
    v_cvt_f32_i32 v57, v57
    v_cvt_f32_i32 v58, v58
    v_cvt_f32_i32 v59, v59
    v_sub_f32 v48, v48, v72
    v_sub_f32 v49, v49, v73
    v_sub_f32 v50, v50, v74
    v_sub_f32 v51, v51, v75
    v_sub_f32 v52, v52, v76
    v_sub_f32 v53, v53, v77
    v_sub_f32 v54, v54, v78
    v_sub_f32 v55, v55, v79
    v_sub_f32 v56, v56, v80
    v_sub_f32 v57, v57, v81
    v_sub_f32 v58, v58, v82
    v_sub_f32 v59, v59, v83
    v_cvt_pk_bf16_f32 v48, 0, v48
    v_cvt_pk_bf16_f32 v49, 0, v49
    v_cvt_pk_bf16_f32 v50, 0, v50
    v_cvt_pk_bf16_f32 v51, 0, v51
    v_cvt_pk_bf16_f32 v52, 0, v52
    v_cvt_pk_bf16_f32 v53, 0, v53
    v_cvt_pk_bf16_f32 v54, 0, v54
    v_cvt_pk_bf16_f32 v55, 0, v55
    v_cvt_pk_bf16_f32 v56, 0, v56
    v_cvt_pk_bf16_f32 v57, 0, v57
    v_cvt_pk_bf16_f32 v58, 0, v58
    v_cvt_pk_bf16_f32 v59, 0, v59
    v_mul_f32 v48, v48, v96
    v_mul_f32 v49, v49, v97
    v_mul_f32 v50, v50, v98
    v_mul_f32 v51, v51, v99
    v_mul_f32 v52, v52, v100
    v_mul_f32 v53, v53, v101
    v_mul_f32 v54, v54, v102
    v_mul_f32 v55, v55, v103
    v_mul_f32 v56, v56, v104
    v_mul_f32 v57, v57, v105
    v_mul_f32 v58, v58, v106
    v_mul_f32 v59, v59, v107
    v_cvt_pk_bf16_f32 v138, v48, v49
    v_cvt_pk_bf16_f32 v139, v50, v51
    v_add_f32_dpp v3, v145, v144 row_ror:12 row_mask:0xf bank_mask:0xf
    v_cvt_pk_bf16_f32 v140, v52, v53
    v_cvt_pk_bf16_f32 v141, v54, v55
    v_add_f32_dpp v3, v146, v3 row_ror:8 row_mask:0xf bank_mask:0xf
    v_cvt_pk_bf16_f32 v142, v56, v57
    v_cvt_pk_bf16_f32 v143, v58, v59
    v_add_f32_dpp v15, v147, v3 row_ror:4 row_mask:0xf bank_mask:0x1
    v_mfma_f32_16x16x16_bf16 v[148:151], v[138:139], v[160:161], 0
    v_mfma_f32_16x16x16_bf16 v[148:151], v[140:141], v[162:163], v[148:151]
    v_mfma_f32_16x16x16_bf16 v[148:151], v[142:143], v[164:165], v[148:151]
    v_add_u32 v33, s63, v27
    v_add_u32 v34, s63, v28
    ds_read_b64 v[108:109], v33 offset:0
    ds_read_b64 v[110:111], v33 offset:1536
    ds_read_b64 v[112:113], v33 offset:128
    ds_read_b64 v[114:115], v33 offset:1664
    ds_read_b64 v[116:117], v33 offset:256
    ds_read_b64 v[118:119], v33 offset:1792
    ds_read_b64 v[120:121], v34 offset:0
    v_add_f32_dpp v4, v149, v148 row_ror:12 row_mask:0xf bank_mask:0xf
    ds_read_b64 v[122:123], v34 offset:1536
    ds_read_b64 v[124:125], v34 offset:128
    v_add_f32_dpp v4, v150, v4 row_ror:8 row_mask:0xf bank_mask:0xf
    ds_read_b64 v[126:127], v34 offset:1664
    ds_read_b64 v[128:129], v34 offset:256
    ds_read_b64 v[130:131], v34 offset:1792
    v_add_f32_dpp v16, v151, v4 row_ror:4 row_mask:0xf bank_mask:0x1
    s_waitcnt lgkmcnt(0)
    v_lshlrev_b32 v60, 16, v108
    v_and_b32 v61, s66, v108
    v_lshlrev_b32 v62, 16, v109
    v_and_b32 v63, s66, v109
    v_lshlrev_b32 v84, 16, v110
    v_and_b32 v85, s66, v110
    v_lshlrev_b32 v86, 16, v111
    v_and_b32 v87, s66, v111
    v_lshlrev_b32 v64, 16, v112
    v_and_b32 v65, s66, v112
    v_lshlrev_b32 v66, 16, v113
    v_and_b32 v67, s66, v113
    v_lshlrev_b32 v88, 16, v114
    v_and_b32 v89, s66, v114
    v_lshlrev_b32 v90, 16, v115
    v_and_b32 v91, s66, v115
    v_lshlrev_b32 v68, 16, v116
    v_and_b32 v69, s66, v116
    v_lshlrev_b32 v70, 16, v117
    v_and_b32 v71, s66, v117
    v_lshlrev_b32 v92, 16, v118
    v_and_b32 v93, s66, v118
    v_lshlrev_b32 v94, 16, v119
    v_and_b32 v95, s66, v119
    v_lshlrev_b32 v72, 16, v120
    v_and_b32 v73, s66, v120
    v_lshlrev_b32 v74, 16, v121
    v_and_b32 v75, s66, v121
    v_lshlrev_b32 v96, 16, v122
    v_and_b32 v97, s66, v122
    v_lshlrev_b32 v98, 16, v123
    v_and_b32 v99, s66, v123
    v_lshlrev_b32 v76, 16, v124
    v_and_b32 v77, s66, v124
    v_lshlrev_b32 v78, 16, v125
    v_and_b32 v79, s66, v125
    v_lshlrev_b32 v100, 16, v126
    v_and_b32 v101, s66, v126
    v_lshlrev_b32 v102, 16, v127
    v_and_b32 v103, s66, v127
    v_lshlrev_b32 v80, 16, v128
    v_and_b32 v81, s66, v128
    v_lshlrev_b32 v82, 16, v129
    v_and_b32 v83, s66, v129
    v_lshlrev_b32 v104, 16, v130
    v_and_b32 v105, s66, v130
    v_lshlrev_b32 v106, 16, v131
    v_and_b32 v107, s66, v131
    v_add_u32 v13, s62, v12
    s_add_u32 s62, s62, 24576
    s_cmp_eq_u32 s62, 73728
    s_cselect_b32 s62, 0, s62
    s_barrier
    ds_read_b128 v[36:39], v13 offset:0
    ds_read_b128 v[40:43], v13 offset:256
    ds_read_b128 v[44:47], v13 offset:512
    ds_read_b128 v[48:51], v13 offset:3072
    ds_read_b128 v[52:55], v13 offset:3328
    ds_read_b128 v[56:59], v13 offset:3584
    s_waitcnt lgkmcnt(3)
    v_cvt_f32_i32 v36, v36
    v_cvt_f32_i32 v37, v37
    v_cvt_f32_i32 v38, v38
    v_cvt_f32_i32 v39, v39
    v_cvt_f32_i32 v40, v40
    v_cvt_f32_i32 v41, v41
    v_cvt_f32_i32 v42, v42
    v_cvt_f32_i32 v43, v43
    v_cvt_f32_i32 v44, v44
    v_cvt_f32_i32 v45, v45
    v_cvt_f32_i32 v46, v46
    v_cvt_f32_i32 v47, v47
    v_sub_f32 v36, v36, v60
    v_sub_f32 v37, v37, v61
    v_sub_f32 v38, v38, v62
    v_sub_f32 v39, v39, v63
    v_sub_f32 v40, v40, v64
    v_sub_f32 v41, v41, v65
    v_sub_f32 v42, v42, v66
    v_sub_f32 v43, v43, v67
    v_sub_f32 v44, v44, v68
    v_sub_f32 v45, v45, v69
    v_sub_f32 v46, v46, v70
    v_sub_f32 v47, v47, v71
    v_cvt_pk_bf16_f32 v36, 0, v36
    v_cvt_pk_bf16_f32 v37, 0, v37
    v_cvt_pk_bf16_f32 v38, 0, v38
    v_cvt_pk_bf16_f32 v39, 0, v39
    v_cvt_pk_bf16_f32 v40, 0, v40
    v_cvt_pk_bf16_f32 v41, 0, v41
    v_cvt_pk_bf16_f32 v42, 0, v42
    v_cvt_pk_bf16_f32 v43, 0, v43
    v_cvt_pk_bf16_f32 v44, 0, v44
    v_cvt_pk_bf16_f32 v45, 0, v45
    v_cvt_pk_bf16_f32 v46, 0, v46
    v_cvt_pk_bf16_f32 v47, 0, v47
    v_mul_f32 v36, v36, v84
    v_mul_f32 v37, v37, v85
    v_mul_f32 v38, v38, v86
    v_mul_f32 v39, v39, v87
    v_mul_f32 v40, v40, v88
    v_mul_f32 v41, v41, v89
    v_mul_f32 v42, v42, v90
    v_mul_f32 v43, v43, v91
    v_mul_f32 v44, v44, v92
    v_mul_f32 v45, v45, v93
    v_mul_f32 v46, v46, v94
    v_mul_f32 v47, v47, v95
    v_cvt_pk_bf16_f32 v132, v36, v37
    v_cvt_pk_bf16_f32 v133, v38, v39
    v_cvt_pk_bf16_f32 v134, v40, v41
    v_cvt_pk_bf16_f32 v135, v42, v43
    v_cvt_pk_bf16_f32 v136, v44, v45
    v_cvt_pk_bf16_f32 v137, v46, v47
    v_mfma_f32_16x16x16_bf16 v[144:147], v[132:133], v[160:161], 0
    v_mfma_f32_16x16x16_bf16 v[144:147], v[134:135], v[162:163], v[144:147]
    v_mfma_f32_16x16x16_bf16 v[144:147], v[136:137], v[164:165], v[144:147]
    s_waitcnt lgkmcnt(0)
    v_cvt_f32_i32 v48, v48
    v_cvt_f32_i32 v49, v49
    v_cvt_f32_i32 v50, v50
    v_cvt_f32_i32 v51, v51
    v_cvt_f32_i32 v52, v52
    v_cvt_f32_i32 v53, v53
    v_cvt_f32_i32 v54, v54
    v_cvt_f32_i32 v55, v55
    v_cvt_f32_i32 v56, v56
    v_cvt_f32_i32 v57, v57
    v_cvt_f32_i32 v58, v58
    v_cvt_f32_i32 v59, v59
    v_sub_f32 v48, v48, v72
    v_sub_f32 v49, v49, v73
    v_sub_f32 v50, v50, v74
    v_sub_f32 v51, v51, v75
    v_sub_f32 v52, v52, v76
    v_sub_f32 v53, v53, v77
    v_sub_f32 v54, v54, v78
    v_sub_f32 v55, v55, v79
    v_sub_f32 v56, v56, v80
    v_sub_f32 v57, v57, v81
    v_sub_f32 v58, v58, v82
    v_sub_f32 v59, v59, v83
    v_cvt_pk_bf16_f32 v48, 0, v48
    v_cvt_pk_bf16_f32 v49, 0, v49
    v_cvt_pk_bf16_f32 v50, 0, v50
    v_cvt_pk_bf16_f32 v51, 0, v51
    v_cvt_pk_bf16_f32 v52, 0, v52
    v_cvt_pk_bf16_f32 v53, 0, v53
    v_cvt_pk_bf16_f32 v54, 0, v54
    v_cvt_pk_bf16_f32 v55, 0, v55
    v_cvt_pk_bf16_f32 v56, 0, v56
    v_cvt_pk_bf16_f32 v57, 0, v57
    v_cvt_pk_bf16_f32 v58, 0, v58
    v_cvt_pk_bf16_f32 v59, 0, v59
    v_mul_f32 v48, v48, v96
    v_mul_f32 v49, v49, v97
    v_mul_f32 v50, v50, v98
    v_mul_f32 v51, v51, v99
    v_mul_f32 v52, v52, v100
    v_mul_f32 v53, v53, v101
    v_mul_f32 v54, v54, v102
    v_mul_f32 v55, v55, v103
    v_mul_f32 v56, v56, v104
    v_mul_f32 v57, v57, v105
    v_mul_f32 v58, v58, v106
    v_mul_f32 v59, v59, v107
    v_cvt_pk_bf16_f32 v138, v48, v49
    v_cvt_pk_bf16_f32 v139, v50, v51
    v_add_f32_dpp v3, v146, v145 row_ror:12 row_mask:0xf bank_mask:0xf
    v_cvt_pk_bf16_f32 v140, v52, v53
    v_cvt_pk_bf16_f32 v141, v54, v55
    v_add_f32_dpp v3, v147, v3 row_ror:8 row_mask:0xf bank_mask:0xf
    v_cvt_pk_bf16_f32 v142, v56, v57
    v_cvt_pk_bf16_f32 v143, v58, v59
    v_add_f32_dpp v15, v144, v3 row_ror:4 row_mask:0xf bank_mask:0x2
    v_mfma_f32_16x16x16_bf16 v[148:151], v[138:139], v[160:161], 0
    v_mfma_f32_16x16x16_bf16 v[148:151], v[140:141], v[162:163], v[148:151]
    v_mfma_f32_16x16x16_bf16 v[148:151], v[142:143], v[164:165], v[148:151]
    v_add_u32 v33, s63, v29
    v_add_u32 v34, s63, v30
    ds_read_b64 v[108:109], v33 offset:0
    ds_read_b64 v[110:111], v33 offset:1536
    ds_read_b64 v[112:113], v33 offset:128
    ds_read_b64 v[114:115], v33 offset:1664
    ds_read_b64 v[116:117], v33 offset:256
    ds_read_b64 v[118:119], v33 offset:1792
    ds_read_b64 v[120:121], v34 offset:0
    v_add_f32_dpp v4, v150, v149 row_ror:12 row_mask:0xf bank_mask:0xf
    ds_read_b64 v[122:123], v34 offset:1536
    ds_read_b64 v[124:125], v34 offset:128
    v_add_f32_dpp v4, v151, v4 row_ror:8 row_mask:0xf bank_mask:0xf
    ds_read_b64 v[126:127], v34 offset:1664
    ds_read_b64 v[128:129], v34 offset:256
    ds_read_b64 v[130:131], v34 offset:1792
    v_add_f32_dpp v16, v148, v4 row_ror:4 row_mask:0xf bank_mask:0x2
    s_waitcnt lgkmcnt(0)
    v_lshlrev_b32 v60, 16, v108
    v_and_b32 v61, s66, v108
    v_lshlrev_b32 v62, 16, v109
    v_and_b32 v63, s66, v109
    v_lshlrev_b32 v84, 16, v110
    v_and_b32 v85, s66, v110
    v_lshlrev_b32 v86, 16, v111
    v_and_b32 v87, s66, v111
    v_lshlrev_b32 v64, 16, v112
    v_and_b32 v65, s66, v112
    v_lshlrev_b32 v66, 16, v113
    v_and_b32 v67, s66, v113
    v_lshlrev_b32 v88, 16, v114
    v_and_b32 v89, s66, v114
    v_lshlrev_b32 v90, 16, v115
    v_and_b32 v91, s66, v115
    v_lshlrev_b32 v68, 16, v116
    v_and_b32 v69, s66, v116
    v_lshlrev_b32 v70, 16, v117
    v_and_b32 v71, s66, v117
    v_lshlrev_b32 v92, 16, v118
    v_and_b32 v93, s66, v118
    v_lshlrev_b32 v94, 16, v119
    v_and_b32 v95, s66, v119
    v_lshlrev_b32 v72, 16, v120
    v_and_b32 v73, s66, v120
    v_lshlrev_b32 v74, 16, v121
    v_and_b32 v75, s66, v121
    v_lshlrev_b32 v96, 16, v122
    v_and_b32 v97, s66, v122
    v_lshlrev_b32 v98, 16, v123
    v_and_b32 v99, s66, v123
    v_lshlrev_b32 v76, 16, v124
    v_and_b32 v77, s66, v124
    v_lshlrev_b32 v78, 16, v125
    v_and_b32 v79, s66, v125
    v_lshlrev_b32 v100, 16, v126
    v_and_b32 v101, s66, v126
    v_lshlrev_b32 v102, 16, v127
    v_and_b32 v103, s66, v127
    v_lshlrev_b32 v80, 16, v128
    v_and_b32 v81, s66, v128
    v_lshlrev_b32 v82, 16, v129
    v_and_b32 v83, s66, v129
    v_lshlrev_b32 v104, 16, v130
    v_and_b32 v105, s66, v130
    v_lshlrev_b32 v106, 16, v131
    v_and_b32 v107, s66, v131
    v_add_u32 v13, s62, v12
    s_add_u32 s62, s62, 24576
    s_cmp_eq_u32 s62, 73728
    s_cselect_b32 s62, 0, s62
    s_barrier
    ds_read_b128 v[36:39], v13 offset:0
    ds_read_b128 v[40:43], v13 offset:256
    ds_read_b128 v[44:47], v13 offset:512
    ds_read_b128 v[48:51], v13 offset:3072
    ds_read_b128 v[52:55], v13 offset:3328
    ds_read_b128 v[56:59], v13 offset:3584
    s_waitcnt lgkmcnt(3)
    v_cvt_f32_i32 v36, v36
    v_cvt_f32_i32 v37, v37
    v_cvt_f32_i32 v38, v38
    v_cvt_f32_i32 v39, v39
    v_cvt_f32_i32 v40, v40
    v_cvt_f32_i32 v41, v41
    v_cvt_f32_i32 v42, v42
    v_cvt_f32_i32 v43, v43
    v_cvt_f32_i32 v44, v44
    v_cvt_f32_i32 v45, v45
    v_cvt_f32_i32 v46, v46
    v_cvt_f32_i32 v47, v47
    v_sub_f32 v36, v36, v60
    v_sub_f32 v37, v37, v61
    v_sub_f32 v38, v38, v62
    v_sub_f32 v39, v39, v63
    v_sub_f32 v40, v40, v64
    v_sub_f32 v41, v41, v65
    v_sub_f32 v42, v42, v66
    v_sub_f32 v43, v43, v67
    v_sub_f32 v44, v44, v68
    v_sub_f32 v45, v45, v69
    v_sub_f32 v46, v46, v70
    v_sub_f32 v47, v47, v71
    v_cvt_pk_bf16_f32 v36, 0, v36
    v_cvt_pk_bf16_f32 v37, 0, v37
    v_cvt_pk_bf16_f32 v38, 0, v38
    v_cvt_pk_bf16_f32 v39, 0, v39
    v_cvt_pk_bf16_f32 v40, 0, v40
    v_cvt_pk_bf16_f32 v41, 0, v41
    v_cvt_pk_bf16_f32 v42, 0, v42
    v_cvt_pk_bf16_f32 v43, 0, v43
    v_cvt_pk_bf16_f32 v44, 0, v44
    v_cvt_pk_bf16_f32 v45, 0, v45
    v_cvt_pk_bf16_f32 v46, 0, v46
    v_cvt_pk_bf16_f32 v47, 0, v47
    v_mul_f32 v36, v36, v84
    v_mul_f32 v37, v37, v85
    v_mul_f32 v38, v38, v86
    v_mul_f32 v39, v39, v87
    v_mul_f32 v40, v40, v88
    v_mul_f32 v41, v41, v89
    v_mul_f32 v42, v42, v90
    v_mul_f32 v43, v43, v91
    v_mul_f32 v44, v44, v92
    v_mul_f32 v45, v45, v93
    v_mul_f32 v46, v46, v94
    v_mul_f32 v47, v47, v95
    v_cvt_pk_bf16_f32 v132, v36, v37
    v_cvt_pk_bf16_f32 v133, v38, v39
    v_cvt_pk_bf16_f32 v134, v40, v41
    v_cvt_pk_bf16_f32 v135, v42, v43
    v_cvt_pk_bf16_f32 v136, v44, v45
    v_cvt_pk_bf16_f32 v137, v46, v47
    v_mfma_f32_16x16x16_bf16 v[144:147], v[132:133], v[160:161], 0
    v_mfma_f32_16x16x16_bf16 v[144:147], v[134:135], v[162:163], v[144:147]
    v_mfma_f32_16x16x16_bf16 v[144:147], v[136:137], v[164:165], v[144:147]
    s_waitcnt lgkmcnt(0)
    v_cvt_f32_i32 v48, v48
    v_cvt_f32_i32 v49, v49
    v_cvt_f32_i32 v50, v50
    v_cvt_f32_i32 v51, v51
    v_cvt_f32_i32 v52, v52
    v_cvt_f32_i32 v53, v53
    v_cvt_f32_i32 v54, v54
    v_cvt_f32_i32 v55, v55
    v_cvt_f32_i32 v56, v56
    v_cvt_f32_i32 v57, v57
    v_cvt_f32_i32 v58, v58
    v_cvt_f32_i32 v59, v59
    v_sub_f32 v48, v48, v72
    v_sub_f32 v49, v49, v73
    v_sub_f32 v50, v50, v74
    v_sub_f32 v51, v51, v75
    v_sub_f32 v52, v52, v76
    v_sub_f32 v53, v53, v77
    v_sub_f32 v54, v54, v78
    v_sub_f32 v55, v55, v79
    v_sub_f32 v56, v56, v80
    v_sub_f32 v57, v57, v81
    v_sub_f32 v58, v58, v82
    v_sub_f32 v59, v59, v83
    v_cvt_pk_bf16_f32 v48, 0, v48
    v_cvt_pk_bf16_f32 v49, 0, v49
    v_cvt_pk_bf16_f32 v50, 0, v50
    v_cvt_pk_bf16_f32 v51, 0, v51
    v_cvt_pk_bf16_f32 v52, 0, v52
    v_cvt_pk_bf16_f32 v53, 0, v53
    v_cvt_pk_bf16_f32 v54, 0, v54
    v_cvt_pk_bf16_f32 v55, 0, v55
    v_cvt_pk_bf16_f32 v56, 0, v56
    v_cvt_pk_bf16_f32 v57, 0, v57
    v_cvt_pk_bf16_f32 v58, 0, v58
    v_cvt_pk_bf16_f32 v59, 0, v59
    v_mul_f32 v48, v48, v96
    v_mul_f32 v49, v49, v97
    v_mul_f32 v50, v50, v98
    v_mul_f32 v51, v51, v99
    v_mul_f32 v52, v52, v100
    v_mul_f32 v53, v53, v101
    v_mul_f32 v54, v54, v102
    v_mul_f32 v55, v55, v103
    v_mul_f32 v56, v56, v104
    v_mul_f32 v57, v57, v105
    v_mul_f32 v58, v58, v106
    v_mul_f32 v59, v59, v107
    v_cvt_pk_bf16_f32 v138, v48, v49
    v_cvt_pk_bf16_f32 v139, v50, v51
    v_add_f32_dpp v3, v147, v146 row_ror:12 row_mask:0xf bank_mask:0xf
    v_cvt_pk_bf16_f32 v140, v52, v53
    v_cvt_pk_bf16_f32 v141, v54, v55
    v_add_f32_dpp v3, v144, v3 row_ror:8 row_mask:0xf bank_mask:0xf
    v_cvt_pk_bf16_f32 v142, v56, v57
    v_cvt_pk_bf16_f32 v143, v58, v59
    v_add_f32_dpp v15, v145, v3 row_ror:4 row_mask:0xf bank_mask:0x4
    v_mfma_f32_16x16x16_bf16 v[148:151], v[138:139], v[160:161], 0
    v_mfma_f32_16x16x16_bf16 v[148:151], v[140:141], v[162:163], v[148:151]
    v_mfma_f32_16x16x16_bf16 v[148:151], v[142:143], v[164:165], v[148:151]
    v_add_u32 v33, s63, v31
    v_add_u32 v34, s63, v32
    ds_read_b64 v[108:109], v33 offset:0
    ds_read_b64 v[110:111], v33 offset:1536
    ds_read_b64 v[112:113], v33 offset:128
    ds_read_b64 v[114:115], v33 offset:1664
    ds_read_b64 v[116:117], v33 offset:256
    ds_read_b64 v[118:119], v33 offset:1792
    ds_read_b64 v[120:121], v34 offset:0
    v_add_f32_dpp v4, v151, v150 row_ror:12 row_mask:0xf bank_mask:0xf
    ds_read_b64 v[122:123], v34 offset:1536
    ds_read_b64 v[124:125], v34 offset:128
    v_add_f32_dpp v4, v148, v4 row_ror:8 row_mask:0xf bank_mask:0xf
    ds_read_b64 v[126:127], v34 offset:1664
    ds_read_b64 v[128:129], v34 offset:256
    ds_read_b64 v[130:131], v34 offset:1792
    v_add_f32_dpp v16, v149, v4 row_ror:4 row_mask:0xf bank_mask:0x4
    s_waitcnt lgkmcnt(0)
    v_lshlrev_b32 v60, 16, v108
    v_and_b32 v61, s66, v108
    v_lshlrev_b32 v62, 16, v109
    v_and_b32 v63, s66, v109
    v_lshlrev_b32 v84, 16, v110
    v_and_b32 v85, s66, v110
    v_lshlrev_b32 v86, 16, v111
    v_and_b32 v87, s66, v111
    v_lshlrev_b32 v64, 16, v112
    v_and_b32 v65, s66, v112
    v_lshlrev_b32 v66, 16, v113
    v_and_b32 v67, s66, v113
    v_lshlrev_b32 v88, 16, v114
    v_and_b32 v89, s66, v114
    v_lshlrev_b32 v90, 16, v115
    v_and_b32 v91, s66, v115
    v_lshlrev_b32 v68, 16, v116
    v_and_b32 v69, s66, v116
    v_lshlrev_b32 v70, 16, v117
    v_and_b32 v71, s66, v117
    v_lshlrev_b32 v92, 16, v118
    v_and_b32 v93, s66, v118
    v_lshlrev_b32 v94, 16, v119
    v_and_b32 v95, s66, v119
    v_lshlrev_b32 v72, 16, v120
    v_and_b32 v73, s66, v120
    v_lshlrev_b32 v74, 16, v121
    v_and_b32 v75, s66, v121
    v_lshlrev_b32 v96, 16, v122
    v_and_b32 v97, s66, v122
    v_lshlrev_b32 v98, 16, v123
    v_and_b32 v99, s66, v123
    v_lshlrev_b32 v76, 16, v124
    v_and_b32 v77, s66, v124
    v_lshlrev_b32 v78, 16, v125
    v_and_b32 v79, s66, v125
    v_lshlrev_b32 v100, 16, v126
    v_and_b32 v101, s66, v126
    v_lshlrev_b32 v102, 16, v127
    v_and_b32 v103, s66, v127
    v_lshlrev_b32 v80, 16, v128
    v_and_b32 v81, s66, v128
    v_lshlrev_b32 v82, 16, v129
    v_and_b32 v83, s66, v129
    v_lshlrev_b32 v104, 16, v130
    v_and_b32 v105, s66, v130
    v_lshlrev_b32 v106, 16, v131
    v_and_b32 v107, s66, v131
    v_add_u32 v13, s62, v12
    s_add_u32 s62, s62, 24576
    s_cmp_eq_u32 s62, 73728
    s_cselect_b32 s62, 0, s62
    s_barrier
    ds_read_b128 v[36:39], v13 offset:0
    ds_read_b128 v[40:43], v13 offset:256
    ds_read_b128 v[44:47], v13 offset:512
    ds_read_b128 v[48:51], v13 offset:3072
    ds_read_b128 v[52:55], v13 offset:3328
    ds_read_b128 v[56:59], v13 offset:3584
    s_waitcnt lgkmcnt(3)
    v_cvt_f32_i32 v36, v36
    v_cvt_f32_i32 v37, v37
    v_cvt_f32_i32 v38, v38
    v_cvt_f32_i32 v39, v39
    v_cvt_f32_i32 v40, v40
    v_cvt_f32_i32 v41, v41
    v_cvt_f32_i32 v42, v42
    v_cvt_f32_i32 v43, v43
    v_cvt_f32_i32 v44, v44
    v_cvt_f32_i32 v45, v45
    v_cvt_f32_i32 v46, v46
    v_cvt_f32_i32 v47, v47
    v_sub_f32 v36, v36, v60
    v_sub_f32 v37, v37, v61
    v_sub_f32 v38, v38, v62
    v_sub_f32 v39, v39, v63
    v_sub_f32 v40, v40, v64
    v_sub_f32 v41, v41, v65
    v_sub_f32 v42, v42, v66
    v_sub_f32 v43, v43, v67
    v_sub_f32 v44, v44, v68
    v_sub_f32 v45, v45, v69
    v_sub_f32 v46, v46, v70
    v_sub_f32 v47, v47, v71
    v_cvt_pk_bf16_f32 v36, 0, v36
    v_cvt_pk_bf16_f32 v37, 0, v37
    v_cvt_pk_bf16_f32 v38, 0, v38
    v_cvt_pk_bf16_f32 v39, 0, v39
    v_cvt_pk_bf16_f32 v40, 0, v40
    v_cvt_pk_bf16_f32 v41, 0, v41
    v_cvt_pk_bf16_f32 v42, 0, v42
    v_cvt_pk_bf16_f32 v43, 0, v43
    v_cvt_pk_bf16_f32 v44, 0, v44
    v_cvt_pk_bf16_f32 v45, 0, v45
    v_cvt_pk_bf16_f32 v46, 0, v46
    v_cvt_pk_bf16_f32 v47, 0, v47
    v_mul_f32 v36, v36, v84
    v_mul_f32 v37, v37, v85
    v_mul_f32 v38, v38, v86
    v_mul_f32 v39, v39, v87
    v_mul_f32 v40, v40, v88
    v_mul_f32 v41, v41, v89
    v_mul_f32 v42, v42, v90
    v_mul_f32 v43, v43, v91
    v_mul_f32 v44, v44, v92
    v_mul_f32 v45, v45, v93
    v_mul_f32 v46, v46, v94
    v_mul_f32 v47, v47, v95
    v_cvt_pk_bf16_f32 v132, v36, v37
    v_cvt_pk_bf16_f32 v133, v38, v39
    v_cvt_pk_bf16_f32 v134, v40, v41
    v_cvt_pk_bf16_f32 v135, v42, v43
    v_cvt_pk_bf16_f32 v136, v44, v45
    v_cvt_pk_bf16_f32 v137, v46, v47
    v_mfma_f32_16x16x16_bf16 v[144:147], v[132:133], v[160:161], 0
    v_mfma_f32_16x16x16_bf16 v[144:147], v[134:135], v[162:163], v[144:147]
    v_mfma_f32_16x16x16_bf16 v[144:147], v[136:137], v[164:165], v[144:147]
    s_waitcnt lgkmcnt(0)
    v_cvt_f32_i32 v48, v48
    v_cvt_f32_i32 v49, v49
    v_cvt_f32_i32 v50, v50
    v_cvt_f32_i32 v51, v51
    v_cvt_f32_i32 v52, v52
    v_cvt_f32_i32 v53, v53
    v_cvt_f32_i32 v54, v54
    v_cvt_f32_i32 v55, v55
    v_cvt_f32_i32 v56, v56
    v_cvt_f32_i32 v57, v57
    v_cvt_f32_i32 v58, v58
    v_cvt_f32_i32 v59, v59
    v_sub_f32 v48, v48, v72
    v_sub_f32 v49, v49, v73
    v_sub_f32 v50, v50, v74
    v_sub_f32 v51, v51, v75
    v_sub_f32 v52, v52, v76
    v_sub_f32 v53, v53, v77
    v_sub_f32 v54, v54, v78
    v_sub_f32 v55, v55, v79
    v_sub_f32 v56, v56, v80
    v_sub_f32 v57, v57, v81
    v_sub_f32 v58, v58, v82
    v_sub_f32 v59, v59, v83
    v_cvt_pk_bf16_f32 v48, 0, v48
    v_cvt_pk_bf16_f32 v49, 0, v49
    v_cvt_pk_bf16_f32 v50, 0, v50
    v_cvt_pk_bf16_f32 v51, 0, v51
    v_cvt_pk_bf16_f32 v52, 0, v52
    v_cvt_pk_bf16_f32 v53, 0, v53
    v_cvt_pk_bf16_f32 v54, 0, v54
    v_cvt_pk_bf16_f32 v55, 0, v55
    v_cvt_pk_bf16_f32 v56, 0, v56
    v_cvt_pk_bf16_f32 v57, 0, v57
    v_cvt_pk_bf16_f32 v58, 0, v58
    v_cvt_pk_bf16_f32 v59, 0, v59
    v_mul_f32 v48, v48, v96
    v_mul_f32 v49, v49, v97
    v_mul_f32 v50, v50, v98
    v_mul_f32 v51, v51, v99
    v_mul_f32 v52, v52, v100
    v_mul_f32 v53, v53, v101
    v_mul_f32 v54, v54, v102
    v_mul_f32 v55, v55, v103
    v_mul_f32 v56, v56, v104
    v_mul_f32 v57, v57, v105
    v_mul_f32 v58, v58, v106
    v_mul_f32 v59, v59, v107
    v_cvt_pk_bf16_f32 v138, v48, v49
    v_cvt_pk_bf16_f32 v139, v50, v51
    v_add_f32_dpp v3, v144, v147 row_ror:12 row_mask:0xf bank_mask:0xf
    v_cvt_pk_bf16_f32 v140, v52, v53
    v_cvt_pk_bf16_f32 v141, v54, v55
    v_add_f32_dpp v3, v145, v3 row_ror:8 row_mask:0xf bank_mask:0xf
    v_cvt_pk_bf16_f32 v142, v56, v57
    v_cvt_pk_bf16_f32 v143, v58, v59
    v_add_f32_dpp v15, v146, v3 row_ror:4 row_mask:0xf bank_mask:0x8
    v_mfma_f32_16x16x16_bf16 v[148:151], v[138:139], v[160:161], 0
    v_mfma_f32_16x16x16_bf16 v[148:151], v[140:141], v[162:163], v[148:151]
    v_mfma_f32_16x16x16_bf16 v[148:151], v[142:143], v[164:165], v[148:151]
    s_add_u32 s63, s63, 3072
    v_add_u32 v33, s63, v17
    v_add_u32 v34, s63, v18
    ds_read_b64 v[108:109], v33 offset:0
    ds_read_b64 v[110:111], v33 offset:1536
    ds_read_b64 v[112:113], v33 offset:128
    ds_read_b64 v[114:115], v33 offset:1664
    ds_read_b64 v[116:117], v33 offset:256
    ds_read_b64 v[118:119], v33 offset:1792
    ds_read_b64 v[120:121], v34 offset:0
    v_add_f32_dpp v4, v148, v151 row_ror:12 row_mask:0xf bank_mask:0xf
    ds_read_b64 v[122:123], v34 offset:1536
    ds_read_b64 v[124:125], v34 offset:128
    v_add_f32_dpp v4, v149, v4 row_ror:8 row_mask:0xf bank_mask:0xf
    ds_read_b64 v[126:127], v34 offset:1664
    ds_read_b64 v[128:129], v34 offset:256
    ds_read_b64 v[130:131], v34 offset:1792
    v_add_f32_dpp v16, v150, v4 row_ror:4 row_mask:0xf bank_mask:0x8
    v_cvt_pk_bf16_f32 v3, 0, v15
    v_cvt_pk_bf16_f32 v4, 0, v16
    v_mul_f32 v3, s65, v3
    v_mul_f32 v4, s65, v4
    v_cvt_pk_bf16_f32 v5, v3, v4
    v_max3_f32 v14, v14, v3, v4
    ds_write_b32 v11, v5 offset:256
    s_waitcnt lgkmcnt(0)
    v_lshlrev_b32 v60, 16, v108
    v_and_b32 v61, s66, v108
    v_lshlrev_b32 v62, 16, v109
    v_and_b32 v63, s66, v109
    v_lshlrev_b32 v84, 16, v110
    v_and_b32 v85, s66, v110
    v_lshlrev_b32 v86, 16, v111
    v_and_b32 v87, s66, v111
    v_lshlrev_b32 v64, 16, v112
    v_and_b32 v65, s66, v112
    v_lshlrev_b32 v66, 16, v113
    v_and_b32 v67, s66, v113
    v_lshlrev_b32 v88, 16, v114
    v_and_b32 v89, s66, v114
    v_lshlrev_b32 v90, 16, v115
    v_and_b32 v91, s66, v115
    v_lshlrev_b32 v68, 16, v116
    v_and_b32 v69, s66, v116
    v_lshlrev_b32 v70, 16, v117
    v_and_b32 v71, s66, v117
    v_lshlrev_b32 v92, 16, v118
    v_and_b32 v93, s66, v118
    v_lshlrev_b32 v94, 16, v119
    v_and_b32 v95, s66, v119
    v_lshlrev_b32 v72, 16, v120
    v_and_b32 v73, s66, v120
    v_lshlrev_b32 v74, 16, v121
    v_and_b32 v75, s66, v121
    v_lshlrev_b32 v96, 16, v122
    v_and_b32 v97, s66, v122
    v_lshlrev_b32 v98, 16, v123
    v_and_b32 v99, s66, v123
    v_lshlrev_b32 v76, 16, v124
    v_and_b32 v77, s66, v124
    v_lshlrev_b32 v78, 16, v125
    v_and_b32 v79, s66, v125
    v_lshlrev_b32 v100, 16, v126
    v_and_b32 v101, s66, v126
    v_lshlrev_b32 v102, 16, v127
    v_and_b32 v103, s66, v127
    v_lshlrev_b32 v80, 16, v128
    v_and_b32 v81, s66, v128
    v_lshlrev_b32 v82, 16, v129
    v_and_b32 v83, s66, v129
    v_lshlrev_b32 v104, 16, v130
    v_and_b32 v105, s66, v130
    v_lshlrev_b32 v106, 16, v131
    v_and_b32 v107, s66, v131
    v_add_u32 v11, 3072, v11
    s_add_u32 s61, s61, 1
    s_cmp_eq_u32 s61, s3
    s_cbranch_scc1 L_kblk_end
    s_cmp_eq_u32 s61, s73
    s_cbranch_scc1 L_kblk_end
    s_cmp_lt_u32 s61, 16
    s_cbranch_scc1 L_kblk
L_kblk_end:
    s_nop 1
    v_max_f32_dpp v14, v14, v14 row_ror:4 row_mask:0xf bank_mask:0xf
    s_nop 1
    v_max_f32_dpp v14, v14, v14 row_ror:8 row_mask:0xf bank_mask:0xf
    v_mov_b32 v3, v14
    s_nop 1
    v_permlane16_swap_b32 v14, v3
    v_max_f32 v14, v14, v3
    v_mov_b32 v3, v14
    s_nop 1
    v_permlane32_swap_b32 v14, v3
    v_max_f32 v14, v14, v3
    v_cvt_pk_bf16_f32 v14, 0, v14
    v_mul_f32 v14, s64, v14
    ds_write_b32 v153, v14
    v_add_u32 v153, 64, v153
    v_mov_b32 v160, v166
    v_mov_b32 v161, v167
    v_mov_b32 v162, v168
    v_mov_b32 v163, v169
    v_mov_b32 v164, v170
    v_mov_b32 v165, v171
    v_mov_b32 v166, v172
    v_mov_b32 v167, v173
    v_mov_b32 v168, v174
    v_mov_b32 v169, v175
    v_mov_b32 v170, v176
    v_mov_b32 v171, v177
    v_mov_b32 v14, 0xff800000
    s_waitcnt lgkmcnt(0)
    s_cmp_lt_u32 s61, 16
    s_cbranch_scc1 L_kblk
    v_lshrrev_b32 v3, 4, v1
    v_and_b32 v4, 15, v1
    v_lshl_add_u32 v3, v2, 3, v3
    v_mul_u32_u24 v3, 768, v3
    v_lshl_add_u32 v12, v4, 4, v3
    v_subrev_u32 v11, 49152, v11
    s_mov_b32 s63, 0
    v_add_u32 v211, s63, v7
    v_add_u32 v212, s63, v8
    ds_read_b32 v210, v11 offset:0
    ds_read_u16 v213, v211 offset:512
    ds_read_u16 v214, v212 offset:512
    ds_read_u16 v211, v211
    ds_read_u16 v212, v212
    v_mov_b32 v184, 0
    v_mov_b32 v185, 0
    v_mov_b32 v186, 0
    v_mov_b32 v187, 0
    v_mov_b32 v188, 0
    v_mov_b32 v189, 0
    v_mov_b32 v190, 0
    v_mov_b32 v191, 0
    v_mov_b32 v192, 0
    v_mov_b32 v193, 0
    v_mov_b32 v194, 0
    v_mov_b32 v195, 0
    v_mov_b32 v196, 0
    v_mov_b32 v197, 0
    v_mov_b32 v198, 0
    v_mov_b32 v199, 0
    s_mov_b32 s61, 0
    v_and_b32 v3, 3, v1
    v_lshlrev_b32 v20, 4, v3
    v_add_u32 v153, 154944, v20
    v_add_u32 v18, 142336, v20
    v_lshl_add_u32 v155, v2, 6, v18
    v_lshl_add_u32 v20, v2, 6, v20
    v_add_u32 v20, 3072, v20
    v_mul_u32_u24 v154, 3072, v2
    v_lshl_add_u32 v154, v1, 4, v154
    v_add_u32 v154, 142592, v154
    v_lshlrev_b32 v4, 10, v2
    v_lshl_add_u32 v19, v1, 4, v4
    v_lshl_add_u32 v17, v1, 2, v4
    v_add_u32 v17, 142592, v17
    v_mul_u32_u24 v21, 384, v3
    v_lshrrev_b32 v4, 2, v1
    v_lshl_add_u32 v21, v4, 3, v21
    v_lshl_add_u32 v21, v2, 7, v21
    s_mov_b32 s48, s18
    s_and_b32 s49, s19, 0xffff
    s_mov_b32 s50, 393216
    s_mov_b32 s51, 0x20000
    s_mov_b32 s24, s22
    s_and_b32 s25, s23, 0xffff
    s_mov_b32 s26, 848640
    s_mov_b32 s27, 0x20000
    s_mul_i32 s68, s100, 9984
    s_mul_i32 s71, s2, 3328
    s_add_u32 s69, s68, 3328
    s_add_u32 s70, s68, 6656
    s_sub_u32 s57, 255, s100
    s_mul_i32 s57, s57, 1536
    s_mov_b32 s84, 0x7060500
    s_mov_b32 s85, 0x7060501
    s_mov_b32 s86, 0x7060502
    s_mov_b32 s87, 0x7060503
    s_mov_b32 s88, 0x0c0c0400
    s_mov_b32 s89, 0x04000c0c
    s_mov_b32 s90, 0xffffff00
L_vround:
    v_mov_b32 v160, 0
    v_mov_b32 v161, 0
    v_mov_b32 v162, 0
    v_mov_b32 v163, 0
    v_mov_b32 v164, 0
    v_mov_b32 v165, 0
    v_mov_b32 v166, 0
    v_mov_b32 v167, 0
    v_mov_b32 v168, 0
    v_mov_b32 v169, 0
    v_mov_b32 v170, 0
    v_mov_b32 v171, 0
    v_mov_b32 v208, 0
    v_mov_b32 v209, 0
L_vblk:
    s_add_u32 s61, s61, 1
    s_cmp_eq_u32 s61, s3
    s_cselect_b32 s74, 1, 0
    s_cmp_eq_u32 s61, s73
    s_cselect_b32 s74, 1, s74
    s_cmp_eq_u32 s61, 16
    s_cselect_b32 s74, 1, s74
    v_add_u32 v13, s62, v12
    s_add_u32 s62, s62, 24576
    s_cmp_eq_u32 s62, 73728
    s_cselect_b32 s62, 0, s62
    s_barrier
    ds_read_b128 v[156:159], v153
    ds_read_b128 v[36:39], v13 offset:0
    ds_read_b128 v[48:51], v13 offset:3072
    ds_read_b128 v[40:43], v13 offset:256
    ds_read_b128 v[52:55], v13 offset:3328
    ds_read_b128 v[44:47], v13 offset:512
    ds_read_b128 v[56:59], v13 offset:3584
    s_waitcnt lgkmcnt(6)
    v_max_f32 v14, v156, v157
    v_max3_f32 v14, v14, v158, v159
    s_waitcnt lgkmcnt(6)
    v_lshlrev_b32 v215, 16, v210
    v_and_b32 v216, s66, v210
    v_fma_f32 v215, v215, s64, -v14
    v_fma_f32 v216, v216, s64, -v14
    v_exp_f32 v215, v215
    v_exp_f32 v216, v216
    v_lshlrev_b32 v217, 16, v211
    v_lshlrev_b32 v218, 16, v212
    v_mul_f32 v217, v215, v217
    v_mul_f32 v218, v216, v218
    v_add_f32 v208, v208, v215
    v_cvt_pk_bf16_f32 v217, v217, v218
    v_add_f32 v208, v208, v216
    v_lshlrev_b32 v219, 16, v213
    v_lshlrev_b32 v220, 16, v214
    v_lshlrev_b32 v215, 16, v217
    v_and_b32 v216, s66, v217
    v_fmac_f32 v209, v215, v219
    v_fmac_f32 v209, v216, v220
    v_mov_b32_dpp v184, v217 quad_perm:[0,1,2,3] row_mask:0xf bank_mask:0x1
    v_mov_b32_dpp v185, v217 row_ror:12 row_mask:0xf bank_mask:0x1
    v_mov_b32_dpp v186, v217 row_ror:8 row_mask:0xf bank_mask:0x1
    v_mov_b32_dpp v187, v217 row_ror:4 row_mask:0xf bank_mask:0x1
    v_mov_b32_dpp v188, v217 row_ror:4 row_mask:0xf bank_mask:0x2
    v_mov_b32_dpp v189, v217 quad_perm:[0,1,2,3] row_mask:0xf bank_mask:0x2
    v_mov_b32_dpp v190, v217 row_ror:12 row_mask:0xf bank_mask:0x2
    v_mov_b32_dpp v191, v217 row_ror:8 row_mask:0xf bank_mask:0x2
    v_mov_b32_dpp v192, v217 row_ror:8 row_mask:0xf bank_mask:0x4
    v_mov_b32_dpp v193, v217 row_ror:4 row_mask:0xf bank_mask:0x4
    v_mov_b32_dpp v194, v217 quad_perm:[0,1,2,3] row_mask:0xf bank_mask:0x4
    v_mov_b32_dpp v195, v217 row_ror:12 row_mask:0xf bank_mask:0x4
    v_mov_b32_dpp v196, v217 row_ror:12 row_mask:0xf bank_mask:0x8
    v_mov_b32_dpp v197, v217 row_ror:8 row_mask:0xf bank_mask:0x8
    v_mov_b32_dpp v198, v217 row_ror:4 row_mask:0xf bank_mask:0x8
    v_mov_b32_dpp v199, v217 quad_perm:[0,1,2,3] row_mask:0xf bank_mask:0x8
    s_waitcnt lgkmcnt(4)
    v_cvt_f32_i32 v36, v36
    v_cvt_f32_i32 v37, v37
    v_cvt_f32_i32 v38, v38
    v_cvt_f32_i32 v39, v39
    v_cvt_f32_i32 v48, v48
    v_cvt_f32_i32 v49, v49
    v_cvt_f32_i32 v50, v50
    v_cvt_f32_i32 v51, v51
    v_cvt_pk_bf16_f32 v60, v36, v48
    v_cvt_pk_bf16_f32 v64, v37, v49
    v_cvt_pk_bf16_f32 v68, v38, v50
    v_cvt_pk_bf16_f32 v72, v39, v51
    s_waitcnt lgkmcnt(2)
    v_cvt_f32_i32 v40, v40
    v_cvt_f32_i32 v41, v41
    v_cvt_f32_i32 v42, v42
    v_cvt_f32_i32 v43, v43
    v_cvt_f32_i32 v52, v52
    v_cvt_f32_i32 v53, v53
    v_cvt_f32_i32 v54, v54
    v_cvt_f32_i32 v55, v55
    v_cvt_pk_bf16_f32 v76, v40, v52
    v_cvt_pk_bf16_f32 v80, v41, v53
    v_cvt_pk_bf16_f32 v84, v42, v54
    v_cvt_pk_bf16_f32 v88, v43, v55
    s_waitcnt lgkmcnt(0)
    v_cvt_f32_i32 v44, v44
    v_cvt_f32_i32 v45, v45
    v_cvt_f32_i32 v46, v46
    v_cvt_f32_i32 v47, v47
    v_cvt_f32_i32 v56, v56
    v_cvt_f32_i32 v57, v57
    v_cvt_f32_i32 v58, v58
    v_cvt_f32_i32 v59, v59
    v_cvt_pk_bf16_f32 v92, v44, v56
    v_cvt_pk_bf16_f32 v96, v45, v57
    v_cvt_pk_bf16_f32 v100, v46, v58
    v_cvt_pk_bf16_f32 v104, v47, v59
    v_add_u32 v211, s63, v9
    v_add_u32 v212, s63, v10
    ds_read_b32 v210, v11 offset:256
    ds_read_u16 v213, v211 offset:512
    ds_read_u16 v214, v212 offset:512
    ds_read_u16 v211, v211
    ds_read_u16 v212, v212
    v_add_u32 v13, s62, v12
    s_add_u32 s62, s62, 24576
    s_cmp_eq_u32 s62, 73728
    s_cselect_b32 s62, 0, s62
    s_barrier
    ds_read_b128 v[36:39], v13 offset:0
    ds_read_b128 v[48:51], v13 offset:3072
    ds_read_b128 v[40:43], v13 offset:256
    ds_read_b128 v[52:55], v13 offset:3328
    ds_read_b128 v[44:47], v13 offset:512
    ds_read_b128 v[56:59], v13 offset:3584
    s_waitcnt lgkmcnt(4)
    v_cvt_f32_i32 v36, v36
    v_cvt_f32_i32 v37, v37
    v_cvt_f32_i32 v38, v38
    v_cvt_f32_i32 v39, v39
    v_cvt_f32_i32 v48, v48
    v_cvt_f32_i32 v49, v49
    v_cvt_f32_i32 v50, v50
    v_cvt_f32_i32 v51, v51
    v_cvt_pk_bf16_f32 v61, v36, v48
    v_cvt_pk_bf16_f32 v65, v37, v49
    v_cvt_pk_bf16_f32 v69, v38, v50
    v_cvt_pk_bf16_f32 v73, v39, v51
    s_waitcnt lgkmcnt(2)
    v_cvt_f32_i32 v40, v40
    v_cvt_f32_i32 v41, v41
    v_cvt_f32_i32 v42, v42
    v_cvt_f32_i32 v43, v43
    v_cvt_f32_i32 v52, v52
    v_cvt_f32_i32 v53, v53
    v_cvt_f32_i32 v54, v54
    v_cvt_f32_i32 v55, v55
    v_cvt_pk_bf16_f32 v77, v40, v52
    v_cvt_pk_bf16_f32 v81, v41, v53
    v_cvt_pk_bf16_f32 v85, v42, v54
    v_cvt_pk_bf16_f32 v89, v43, v55
    s_waitcnt lgkmcnt(0)
    v_cvt_f32_i32 v44, v44
    v_cvt_f32_i32 v45, v45
    v_cvt_f32_i32 v46, v46
    v_cvt_f32_i32 v47, v47
    v_cvt_f32_i32 v56, v56
    v_cvt_f32_i32 v57, v57
    v_cvt_f32_i32 v58, v58
    v_cvt_f32_i32 v59, v59
    v_cvt_pk_bf16_f32 v93, v44, v56
    v_cvt_pk_bf16_f32 v97, v45, v57
    v_cvt_pk_bf16_f32 v101, v46, v58
    v_cvt_pk_bf16_f32 v105, v47, v59
    v_add_u32 v13, s62, v12
    s_add_u32 s62, s62, 24576
    s_cmp_eq_u32 s62, 73728
    s_cselect_b32 s62, 0, s62
    s_barrier
    ds_read_b128 v[36:39], v13 offset:0
    ds_read_b128 v[48:51], v13 offset:3072
    ds_read_b128 v[40:43], v13 offset:256
    ds_read_b128 v[52:55], v13 offset:3328
    ds_read_b128 v[44:47], v13 offset:512
    ds_read_b128 v[56:59], v13 offset:3584
    s_waitcnt lgkmcnt(4)
    v_cvt_f32_i32 v36, v36
    v_cvt_f32_i32 v37, v37
    v_cvt_f32_i32 v38, v38
    v_cvt_f32_i32 v39, v39
    v_cvt_f32_i32 v48, v48
    v_cvt_f32_i32 v49, v49
    v_cvt_f32_i32 v50, v50
    v_cvt_f32_i32 v51, v51
    v_cvt_pk_bf16_f32 v62, v36, v48
    v_cvt_pk_bf16_f32 v66, v37, v49
    v_cvt_pk_bf16_f32 v70, v38, v50
    v_cvt_pk_bf16_f32 v74, v39, v51
    s_waitcnt lgkmcnt(2)
    v_cvt_f32_i32 v40, v40
    v_cvt_f32_i32 v41, v41
    v_cvt_f32_i32 v42, v42
    v_cvt_f32_i32 v43, v43
    v_cvt_f32_i32 v52, v52
    v_cvt_f32_i32 v53, v53
    v_cvt_f32_i32 v54, v54
    v_cvt_f32_i32 v55, v55
    v_cvt_pk_bf16_f32 v78, v40, v52
    v_cvt_pk_bf16_f32 v82, v41, v53
    v_cvt_pk_bf16_f32 v86, v42, v54
    v_cvt_pk_bf16_f32 v90, v43, v55
    s_waitcnt lgkmcnt(0)
    v_cvt_f32_i32 v44, v44
    v_cvt_f32_i32 v45, v45
    v_cvt_f32_i32 v46, v46
    v_cvt_f32_i32 v47, v47
    v_cvt_f32_i32 v56, v56
    v_cvt_f32_i32 v57, v57
    v_cvt_f32_i32 v58, v58
    v_cvt_f32_i32 v59, v59
    v_cvt_pk_bf16_f32 v94, v44, v56
    v_cvt_pk_bf16_f32 v98, v45, v57
    v_cvt_pk_bf16_f32 v102, v46, v58
    v_cvt_pk_bf16_f32 v106, v47, v59
    v_add_u32 v13, s62, v12
    s_add_u32 s62, s62, 24576
    s_cmp_eq_u32 s62, 73728
    s_cselect_b32 s62, 0, s62
    s_barrier
    ds_read_b128 v[36:39], v13 offset:0
    ds_read_b128 v[48:51], v13 offset:3072
    ds_read_b128 v[40:43], v13 offset:256
    ds_read_b128 v[52:55], v13 offset:3328
    ds_read_b128 v[44:47], v13 offset:512
    ds_read_b128 v[56:59], v13 offset:3584
    s_waitcnt lgkmcnt(4)
    v_cvt_f32_i32 v36, v36
    v_cvt_f32_i32 v37, v37
    v_cvt_f32_i32 v38, v38
    v_cvt_f32_i32 v39, v39
    v_cvt_f32_i32 v48, v48
    v_cvt_f32_i32 v49, v49
    v_cvt_f32_i32 v50, v50
    v_cvt_f32_i32 v51, v51
    v_cvt_pk_bf16_f32 v63, v36, v48
    v_cvt_pk_bf16_f32 v67, v37, v49
    v_cvt_pk_bf16_f32 v71, v38, v50
    v_cvt_pk_bf16_f32 v75, v39, v51
    s_waitcnt lgkmcnt(2)
    v_cvt_f32_i32 v40, v40
    v_cvt_f32_i32 v41, v41
    v_cvt_f32_i32 v42, v42
    v_mfma_f32_16x16x32_bf16 v[160:163], v[184:187], v[60:63], v[160:163]
    v_cvt_f32_i32 v43, v43
    v_cvt_f32_i32 v52, v52
    v_cvt_f32_i32 v53, v53
    v_mfma_f32_16x16x32_bf16 v[160:163], v[188:191], v[64:67], v[160:163]
    v_cvt_f32_i32 v54, v54
    v_cvt_f32_i32 v55, v55
    v_cvt_pk_bf16_f32 v79, v40, v52
    v_mfma_f32_16x16x32_bf16 v[160:163], v[192:195], v[68:71], v[160:163]
    v_cvt_pk_bf16_f32 v83, v41, v53
    v_cvt_pk_bf16_f32 v87, v42, v54
    v_cvt_pk_bf16_f32 v91, v43, v55
    v_mfma_f32_16x16x32_bf16 v[160:163], v[196:199], v[72:75], v[160:163]
    s_waitcnt lgkmcnt(0)
    v_cvt_f32_i32 v44, v44
    v_cvt_f32_i32 v45, v45
    v_cvt_f32_i32 v46, v46
    v_mfma_f32_16x16x32_bf16 v[164:167], v[184:187], v[76:79], v[164:167]
    v_cvt_f32_i32 v47, v47
    v_cvt_f32_i32 v56, v56
    v_cvt_f32_i32 v57, v57
    v_mfma_f32_16x16x32_bf16 v[164:167], v[188:191], v[80:83], v[164:167]
    v_cvt_f32_i32 v58, v58
    v_cvt_f32_i32 v59, v59
    v_cvt_pk_bf16_f32 v95, v44, v56
    v_mfma_f32_16x16x32_bf16 v[164:167], v[192:195], v[84:87], v[164:167]
    v_cvt_pk_bf16_f32 v99, v45, v57
    v_cvt_pk_bf16_f32 v103, v46, v58
    v_cvt_pk_bf16_f32 v107, v47, v59
    v_mfma_f32_16x16x32_bf16 v[164:167], v[196:199], v[88:91], v[164:167]
    v_mfma_f32_16x16x32_bf16 v[168:171], v[184:187], v[92:95], v[168:171]
    v_mfma_f32_16x16x32_bf16 v[168:171], v[188:191], v[96:99], v[168:171]
    v_mfma_f32_16x16x32_bf16 v[168:171], v[192:195], v[100:103], v[168:171]
    v_mfma_f32_16x16x32_bf16 v[168:171], v[196:199], v[104:107], v[168:171]
    v_add_u32 v13, s62, v12
    s_add_u32 s62, s62, 24576
    s_cmp_eq_u32 s62, 73728
    s_cselect_b32 s62, 0, s62
    s_barrier
    ds_read_b128 v[36:39], v13 offset:0
    ds_read_b128 v[48:51], v13 offset:3072
    ds_read_b128 v[40:43], v13 offset:256
    ds_read_b128 v[52:55], v13 offset:3328
    ds_read_b128 v[44:47], v13 offset:512
    ds_read_b128 v[56:59], v13 offset:3584
    s_waitcnt lgkmcnt(6)
    v_lshlrev_b32 v215, 16, v210
    v_and_b32 v216, s66, v210
    v_fma_f32 v215, v215, s64, -v14
    v_fma_f32 v216, v216, s64, -v14
    v_exp_f32 v215, v215
    v_exp_f32 v216, v216
    v_lshlrev_b32 v217, 16, v211
    v_lshlrev_b32 v218, 16, v212
    v_mul_f32 v217, v215, v217
    v_mul_f32 v218, v216, v218
    v_add_f32 v208, v208, v215
    v_cvt_pk_bf16_f32 v217, v217, v218
    v_add_f32 v208, v208, v216
    v_lshlrev_b32 v219, 16, v213
    v_lshlrev_b32 v220, 16, v214
    v_lshlrev_b32 v215, 16, v217
    v_and_b32 v216, s66, v217
    v_fmac_f32 v209, v215, v219
    v_fmac_f32 v209, v216, v220
    v_mov_b32_dpp v184, v217 quad_perm:[0,1,2,3] row_mask:0xf bank_mask:0x1
    v_mov_b32_dpp v185, v217 row_ror:12 row_mask:0xf bank_mask:0x1
    v_mov_b32_dpp v186, v217 row_ror:8 row_mask:0xf bank_mask:0x1
    v_mov_b32_dpp v187, v217 row_ror:4 row_mask:0xf bank_mask:0x1
    v_mov_b32_dpp v188, v217 row_ror:4 row_mask:0xf bank_mask:0x2
    v_mov_b32_dpp v189, v217 quad_perm:[0,1,2,3] row_mask:0xf bank_mask:0x2
    v_mov_b32_dpp v190, v217 row_ror:12 row_mask:0xf bank_mask:0x2
    v_mov_b32_dpp v191, v217 row_ror:8 row_mask:0xf bank_mask:0x2
    v_mov_b32_dpp v192, v217 row_ror:8 row_mask:0xf bank_mask:0x4
    v_mov_b32_dpp v193, v217 row_ror:4 row_mask:0xf bank_mask:0x4
    v_mov_b32_dpp v194, v217 quad_perm:[0,1,2,3] row_mask:0xf bank_mask:0x4
    v_mov_b32_dpp v195, v217 row_ror:12 row_mask:0xf bank_mask:0x4
    v_mov_b32_dpp v196, v217 row_ror:12 row_mask:0xf bank_mask:0x8
    v_mov_b32_dpp v197, v217 row_ror:8 row_mask:0xf bank_mask:0x8
    v_mov_b32_dpp v198, v217 row_ror:4 row_mask:0xf bank_mask:0x8
    v_mov_b32_dpp v199, v217 quad_perm:[0,1,2,3] row_mask:0xf bank_mask:0x8
    s_waitcnt lgkmcnt(4)
    v_cvt_f32_i32 v36, v36
    v_cvt_f32_i32 v37, v37
    v_cvt_f32_i32 v38, v38
    v_cvt_f32_i32 v39, v39
    v_cvt_f32_i32 v48, v48
    v_cvt_f32_i32 v49, v49
    v_cvt_f32_i32 v50, v50
    v_cvt_f32_i32 v51, v51
    v_cvt_pk_bf16_f32 v60, v36, v48
    v_cvt_pk_bf16_f32 v64, v37, v49
    v_cvt_pk_bf16_f32 v68, v38, v50
    v_cvt_pk_bf16_f32 v72, v39, v51
    s_waitcnt lgkmcnt(2)
    v_cvt_f32_i32 v40, v40
    v_cvt_f32_i32 v41, v41
    v_cvt_f32_i32 v42, v42
    v_cvt_f32_i32 v43, v43
    v_cvt_f32_i32 v52, v52
    v_cvt_f32_i32 v53, v53
    v_cvt_f32_i32 v54, v54
    v_cvt_f32_i32 v55, v55
    v_cvt_pk_bf16_f32 v76, v40, v52
    v_cvt_pk_bf16_f32 v80, v41, v53
    v_cvt_pk_bf16_f32 v84, v42, v54
    v_cvt_pk_bf16_f32 v88, v43, v55
    s_waitcnt lgkmcnt(0)
    v_cvt_f32_i32 v44, v44
    v_cvt_f32_i32 v45, v45
    v_cvt_f32_i32 v46, v46
    v_cvt_f32_i32 v47, v47
    v_cvt_f32_i32 v56, v56
    v_cvt_f32_i32 v57, v57
    v_cvt_f32_i32 v58, v58
    v_cvt_f32_i32 v59, v59
    v_cvt_pk_bf16_f32 v92, v44, v56
    v_cvt_pk_bf16_f32 v96, v45, v57
    v_cvt_pk_bf16_f32 v100, v46, v58
    v_cvt_pk_bf16_f32 v104, v47, v59
    v_add_u32 v11, 3072, v11
    s_add_u32 s63, s63, 1024
    v_add_u32 v211, s63, v7
    v_add_u32 v212, s63, v8
    ds_read_b32 v210, v11 offset:0
    ds_read_u16 v213, v211 offset:512
    ds_read_u16 v214, v212 offset:512
    ds_read_u16 v211, v211
    ds_read_u16 v212, v212
    v_add_u32 v13, s62, v12
    s_add_u32 s62, s62, 24576
    s_cmp_eq_u32 s62, 73728
    s_cselect_b32 s62, 0, s62
    s_barrier
    ds_read_b128 v[36:39], v13 offset:0
    ds_read_b128 v[48:51], v13 offset:3072
    ds_read_b128 v[40:43], v13 offset:256
    ds_read_b128 v[52:55], v13 offset:3328
    ds_read_b128 v[44:47], v13 offset:512
    ds_read_b128 v[56:59], v13 offset:3584
    s_waitcnt lgkmcnt(4)
    v_cvt_f32_i32 v36, v36
    v_cvt_f32_i32 v37, v37
    v_cvt_f32_i32 v38, v38
    v_cvt_f32_i32 v39, v39
    v_cvt_f32_i32 v48, v48
    v_cvt_f32_i32 v49, v49
    v_cvt_f32_i32 v50, v50
    v_cvt_f32_i32 v51, v51
    v_cvt_pk_bf16_f32 v61, v36, v48
    v_cvt_pk_bf16_f32 v65, v37, v49
    v_cvt_pk_bf16_f32 v69, v38, v50
    v_cvt_pk_bf16_f32 v73, v39, v51
    s_waitcnt lgkmcnt(2)
    v_cvt_f32_i32 v40, v40
    v_cvt_f32_i32 v41, v41
    v_cvt_f32_i32 v42, v42
    v_cvt_f32_i32 v43, v43
    v_cvt_f32_i32 v52, v52
    v_cvt_f32_i32 v53, v53
    v_cvt_f32_i32 v54, v54
    v_cvt_f32_i32 v55, v55
    v_cvt_pk_bf16_f32 v77, v40, v52
    v_cvt_pk_bf16_f32 v81, v41, v53
    v_cvt_pk_bf16_f32 v85, v42, v54
    v_cvt_pk_bf16_f32 v89, v43, v55
    s_waitcnt lgkmcnt(0)
    v_cvt_f32_i32 v44, v44
    v_cvt_f32_i32 v45, v45
    v_cvt_f32_i32 v46, v46
    v_cvt_f32_i32 v47, v47
    v_cvt_f32_i32 v56, v56
    v_cvt_f32_i32 v57, v57
    v_cvt_f32_i32 v58, v58
    v_cvt_f32_i32 v59, v59
    v_cvt_pk_bf16_f32 v93, v44, v56
    v_cvt_pk_bf16_f32 v97, v45, v57
    v_cvt_pk_bf16_f32 v101, v46, v58
    v_cvt_pk_bf16_f32 v105, v47, v59
    s_cmp_eq_u32 s74, 0
    s_cbranch_scc1 L_vnostat
    v_mov_b32 v22, 154884
    ds_read_b32 v22, v22
    s_nop 1
    v_add_f32_dpp v208, v208, v208 row_ror:4 row_mask:0xf bank_mask:0xf
    s_nop 1
    v_add_f32_dpp v208, v208, v208 row_ror:8 row_mask:0xf bank_mask:0xf
    v_mov_b32 v3, v208
    s_nop 1
    v_permlane16_swap_b32 v208, v3
    v_add_f32 v208, v208, v3
    v_mov_b32 v3, v208
    s_nop 1
    v_permlane32_swap_b32 v208, v3
    v_add_f32 v208, v208, v3
    s_nop 1
    v_add_f32_dpp v209, v209, v209 row_ror:4 row_mask:0xf bank_mask:0xf
    s_nop 1
    v_add_f32_dpp v209, v209, v209 row_ror:8 row_mask:0xf bank_mask:0xf
    v_mov_b32 v3, v209
    s_nop 1
    v_permlane16_swap_b32 v209, v3
    v_add_f32 v209, v209, v3
    v_mov_b32 v3, v209
    s_nop 1
    v_permlane32_swap_b32 v209, v3
    v_add_f32 v209, v209, v3
    v_mov_b32 v156, v14
    v_mov_b32 v157, v208
    v_mov_b32 v158, v209
    ds_write_b128 v155, v[156:159]
    v_add_u32 v153, 64, v153
L_vnostat:
    v_add_u32 v13, s62, v12
    s_add_u32 s62, s62, 24576
    s_cmp_eq_u32 s62, 73728
    s_cselect_b32 s62, 0, s62
    s_barrier
    ds_read_b128 v[36:39], v13 offset:0
    ds_read_b128 v[48:51], v13 offset:3072
    ds_read_b128 v[40:43], v13 offset:256
    ds_read_b128 v[52:55], v13 offset:3328
    ds_read_b128 v[44:47], v13 offset:512
    ds_read_b128 v[56:59], v13 offset:3584
    s_waitcnt lgkmcnt(4)
    v_cvt_f32_i32 v36, v36
    v_cvt_f32_i32 v37, v37
    v_cvt_f32_i32 v38, v38
    v_cvt_f32_i32 v39, v39
    v_cvt_f32_i32 v48, v48
    v_cvt_f32_i32 v49, v49
    v_cvt_f32_i32 v50, v50
    v_cvt_f32_i32 v51, v51
    v_cvt_pk_bf16_f32 v62, v36, v48
    v_cvt_pk_bf16_f32 v66, v37, v49
    v_cvt_pk_bf16_f32 v70, v38, v50
    v_cvt_pk_bf16_f32 v74, v39, v51
    s_waitcnt lgkmcnt(2)
    v_cvt_f32_i32 v40, v40
    v_cvt_f32_i32 v41, v41
    v_cvt_f32_i32 v42, v42
    v_cvt_f32_i32 v43, v43
    v_cvt_f32_i32 v52, v52
    v_cvt_f32_i32 v53, v53
    v_cvt_f32_i32 v54, v54
    v_cvt_f32_i32 v55, v55
    v_cvt_pk_bf16_f32 v78, v40, v52
    v_cvt_pk_bf16_f32 v82, v41, v53
    v_cvt_pk_bf16_f32 v86, v42, v54
    v_cvt_pk_bf16_f32 v90, v43, v55
    s_waitcnt lgkmcnt(0)
    v_cvt_f32_i32 v44, v44
    v_cvt_f32_i32 v45, v45
    v_cvt_f32_i32 v46, v46
    v_cvt_f32_i32 v47, v47
    v_cvt_f32_i32 v56, v56
    v_cvt_f32_i32 v57, v57
    v_cvt_f32_i32 v58, v58
    v_cvt_f32_i32 v59, v59
    v_cvt_pk_bf16_f32 v94, v44, v56
    v_cvt_pk_bf16_f32 v98, v45, v57
    v_cvt_pk_bf16_f32 v102, v46, v58
    v_cvt_pk_bf16_f32 v106, v47, v59
    v_add_u32 v13, s62, v12
    s_add_u32 s62, s62, 24576
    s_cmp_eq_u32 s62, 73728
    s_cselect_b32 s62, 0, s62
    s_barrier
    ds_read_b128 v[36:39], v13 offset:0
    ds_read_b128 v[48:51], v13 offset:3072
    ds_read_b128 v[40:43], v13 offset:256
    ds_read_b128 v[52:55], v13 offset:3328
    ds_read_b128 v[44:47], v13 offset:512
    ds_read_b128 v[56:59], v13 offset:3584
    s_waitcnt lgkmcnt(4)
    v_cvt_f32_i32 v36, v36
    v_cvt_f32_i32 v37, v37
    v_cvt_f32_i32 v38, v38
    v_cvt_f32_i32 v39, v39
    v_cvt_f32_i32 v48, v48
    v_cvt_f32_i32 v49, v49
    v_cvt_f32_i32 v50, v50
    v_cvt_f32_i32 v51, v51
    v_cvt_pk_bf16_f32 v63, v36, v48
    v_cvt_pk_bf16_f32 v67, v37, v49
    v_cvt_pk_bf16_f32 v71, v38, v50
    v_cvt_pk_bf16_f32 v75, v39, v51
    s_waitcnt lgkmcnt(2)
    v_cvt_f32_i32 v40, v40
    v_cvt_f32_i32 v41, v41
    v_cvt_f32_i32 v42, v42
    v_mfma_f32_16x16x32_bf16 v[160:163], v[184:187], v[60:63], v[160:163]
    v_cvt_f32_i32 v43, v43
    v_cvt_f32_i32 v52, v52
    v_cvt_f32_i32 v53, v53
    v_mfma_f32_16x16x32_bf16 v[160:163], v[188:191], v[64:67], v[160:163]
    v_cvt_f32_i32 v54, v54
    v_cvt_f32_i32 v55, v55
    v_cvt_pk_bf16_f32 v79, v40, v52
    v_mfma_f32_16x16x32_bf16 v[160:163], v[192:195], v[68:71], v[160:163]
    v_cvt_pk_bf16_f32 v83, v41, v53
    v_cvt_pk_bf16_f32 v87, v42, v54
    v_cvt_pk_bf16_f32 v91, v43, v55
    v_mfma_f32_16x16x32_bf16 v[160:163], v[196:199], v[72:75], v[160:163]
    s_waitcnt lgkmcnt(0)
    v_cvt_f32_i32 v44, v44
    v_cvt_f32_i32 v45, v45
    v_cvt_f32_i32 v46, v46
    v_mfma_f32_16x16x32_bf16 v[164:167], v[184:187], v[76:79], v[164:167]
    v_cvt_f32_i32 v47, v47
    v_cvt_f32_i32 v56, v56
    v_cvt_f32_i32 v57, v57
    v_mfma_f32_16x16x32_bf16 v[164:167], v[188:191], v[80:83], v[164:167]
    v_cvt_f32_i32 v58, v58
    v_cvt_f32_i32 v59, v59
    v_cvt_pk_bf16_f32 v95, v44, v56
    v_mfma_f32_16x16x32_bf16 v[164:167], v[192:195], v[84:87], v[164:167]
    v_cvt_pk_bf16_f32 v99, v45, v57
    v_cvt_pk_bf16_f32 v103, v46, v58
    v_cvt_pk_bf16_f32 v107, v47, v59
    v_mfma_f32_16x16x32_bf16 v[164:167], v[196:199], v[88:91], v[164:167]
    v_mfma_f32_16x16x32_bf16 v[168:171], v[184:187], v[92:95], v[168:171]
    v_mfma_f32_16x16x32_bf16 v[168:171], v[188:191], v[96:99], v[168:171]
    v_mfma_f32_16x16x32_bf16 v[168:171], v[192:195], v[100:103], v[168:171]
    v_mfma_f32_16x16x32_bf16 v[168:171], v[196:199], v[104:107], v[168:171]
    s_cmp_eq_u32 s74, 0
    s_cbranch_scc1 L_vblk
    ds_write_b128 v154, v[160:163]
    s_nop 0
    ds_write_b128 v154, v[164:167] offset:1024
    s_cmp_lt_u32 s61, 16
    s_nop 1
    ds_write_b128 v154, v[168:171] offset:2048
    s_waitcnt lgkmcnt(0)
    s_cbranch_scc1 L_vround
    s_barrier
    s_cmp_eq_u32 s56, 3
    s_cbranch_scc1 L_fin
    ds_read_b128 v[36:39], v18 offset:0
    ds_read_b128 v[40:43], v18 offset:64
    ds_read_b128 v[44:47], v18 offset:128
    ds_read_b128 v[48:51], v18 offset:192
    ds_read2st64_b32 v[60:61], v17 offset0:0 offset1:1
    ds_read2st64_b32 v[62:63], v17 offset0:2 offset1:3
    ds_read2st64_b32 v[64:65], v17 offset0:12 offset1:13
    ds_read2st64_b32 v[66:67], v17 offset0:14 offset1:15
    ds_read2st64_b32 v[68:69], v17 offset0:24 offset1:25
    ds_read2st64_b32 v[70:71], v17 offset0:26 offset1:27
    ds_read2st64_b32 v[72:73], v17 offset0:36 offset1:37
    ds_read2st64_b32 v[74:75], v17 offset0:38 offset1:39
    s_cmp_eq_u32 s101, 0
    s_cbranch_scc0 L_rp10
    buffer_load_dwordx4 v[172:175], v20, s[24:27], s69 offen sc1
    buffer_load_dwordx4 v[180:183], v20, s[24:27], s70 offen sc1
    buffer_load_dwordx4 v[168:171], v19, s[24:27], s69 offen sc1
    buffer_load_dwordx4 v[176:179], v19, s[24:27], s70 offen sc1
    s_branch L_rp12
L_rp10:
    s_cmp_eq_u32 s101, 1
    s_cbranch_scc0 L_rp11
    buffer_load_dwordx4 v[164:167], v20, s[24:27], s68 offen sc1
    buffer_load_dwordx4 v[180:183], v20, s[24:27], s70 offen sc1
    buffer_load_dwordx4 v[160:163], v19, s[24:27], s68 offen sc1
    buffer_load_dwordx4 v[176:179], v19, s[24:27], s70 offen sc1
    s_branch L_rp12
L_rp11:
    buffer_load_dwordx4 v[164:167], v20, s[24:27], s68 offen sc1
    buffer_load_dwordx4 v[172:175], v20, s[24:27], s69 offen sc1
    buffer_load_dwordx4 v[160:163], v19, s[24:27], s68 offen sc1
    buffer_load_dwordx4 v[168:171], v19, s[24:27], s69 offen sc1
L_rp12:
    s_waitcnt lgkmcnt(8)
    v_add_f32 v37, v37, v41
    v_add_f32 v45, v45, v49
    v_add_f32 v38, v38, v42
    v_add_f32 v46, v46, v50
    v_add_f32 v37, v37, v45
    v_add_f32 v38, v38, v46
    v_mov_b32 v39, v22
    s_waitcnt lgkmcnt(4)
    v_add_f32 v60, v60, v64
    v_add_f32 v61, v61, v65
    v_add_f32 v62, v62, v66
    v_add_f32 v63, v63, v67
    s_waitcnt lgkmcnt(0)
    v_add_f32 v68, v68, v72
    v_add_f32 v69, v69, v73
    v_add_f32 v70, v70, v74
    v_add_f32 v71, v71, v75
    v_add_f32 v60, v60, v68
    v_add_f32 v61, v61, v69
    v_add_f32 v62, v62, v70
    v_add_f32 v63, v63, v71
    v_sub_f32 v60, v60, v38
    v_sub_f32 v61, v61, v38
    v_sub_f32 v62, v62, v38
    v_sub_f32 v63, v63, v38
    s_cmp_eq_u32 s2, 255
    s_cbranch_scc1 L_rsolo
    v_perm_b32 v60, v60, v22, s84
    v_perm_b32 v61, v61, v22, s85
    v_perm_b32 v62, v62, v22, s86
    v_perm_b32 v63, v63, v22, s87
    buffer_store_dwordx4 v[60:63], v19, s[24:27], s71 offen sc1
    s_mov_b64 exec, 15
    buffer_store_dwordx4 v[36:39], v20, s[24:27], s71 offen sc1
    s_mov_b64 exec, -1
    s_cmp_eq_u32 s101, 0
    s_cbranch_scc0 L_rp20
    v_mov_b32 v160, v60
    v_mov_b32 v164, v36
    v_mov_b32 v161, v61
    v_mov_b32 v165, v37
    v_mov_b32 v162, v62
    v_mov_b32 v166, v38
    v_mov_b32 v163, v63
    v_mov_b32 v167, v39
    s_branch L_rp22
L_rp20:
    s_cmp_eq_u32 s101, 1
    s_cbranch_scc0 L_rp21
    v_mov_b32 v168, v60
    v_mov_b32 v172, v36
    v_mov_b32 v169, v61
    v_mov_b32 v173, v37
    v_mov_b32 v170, v62
    v_mov_b32 v174, v38
    v_mov_b32 v171, v63
    v_mov_b32 v175, v39
    s_branch L_rp22
L_rp21:
    v_mov_b32 v176, v60
    v_mov_b32 v180, v36
    v_mov_b32 v177, v61
    v_mov_b32 v181, v37
    v_mov_b32 v178, v62
    v_mov_b32 v182, v38
    v_mov_b32 v179, v63
    v_mov_b32 v183, v39
L_rp22:
    s_waitcnt vmcnt(4)
    v_xor_b32 v40, v167, v22
    v_xor_b32 v41, v175, v22
    v_xor_b32 v42, v183, v22
    v_or3_b32 v4, v40, v41, v42
    s_waitcnt vmcnt(2)
    v_perm_b32 v5, v161, v160, s88
    v_perm_b32 v6, v163, v162, s89
    v_bitop3_b32 v5, v5, v6, v22 bitop3:0x56
    v_or_b32 v4, v4, v5
    v_perm_b32 v5, v169, v168, s88
    v_perm_b32 v6, v171, v170, s89
    v_bitop3_b32 v5, v5, v6, v22 bitop3:0x56
    v_or_b32 v4, v4, v5
    v_perm_b32 v5, v177, v176, s88
    v_perm_b32 v6, v179, v178, s89
    v_bitop3_b32 v5, v5, v6, v22 bitop3:0x56
    v_or_b32 v4, v4, v5
    v_cmp_eq_u32 vcc, 0, v4
    s_nop 4
    s_cmp_eq_u64 vcc, -1
    s_cbranch_scc1 L_rmerge
    s_waitcnt vmcnt(0)
    s_cmp_eq_u32 s101, 0
    s_cbranch_scc0 L_rp30
    buffer_load_dwordx4 v[172:175], v20, s[24:27], s69 offen sc1
    buffer_load_dwordx4 v[180:183], v20, s[24:27], s70 offen sc1
    buffer_load_dwordx4 v[168:171], v19, s[24:27], s69 offen sc1
    buffer_load_dwordx4 v[176:179], v19, s[24:27], s70 offen sc1
    s_branch L_rp32
L_rp30:
    s_cmp_eq_u32 s101, 1
    s_cbranch_scc0 L_rp31
    buffer_load_dwordx4 v[164:167], v20, s[24:27], s68 offen sc1
    buffer_load_dwordx4 v[180:183], v20, s[24:27], s70 offen sc1
    buffer_load_dwordx4 v[160:163], v19, s[24:27], s68 offen sc1
    buffer_load_dwordx4 v[176:179], v19, s[24:27], s70 offen sc1
    s_branch L_rp32
L_rp31:
    buffer_load_dwordx4 v[164:167], v20, s[24:27], s68 offen sc1
    buffer_load_dwordx4 v[172:175], v20, s[24:27], s69 offen sc1
    buffer_load_dwordx4 v[160:163], v19, s[24:27], s68 offen sc1
    buffer_load_dwordx4 v[168:171], v19, s[24:27], s69 offen sc1
L_rp32:
    s_waitcnt vmcnt(2)
    v_xor_b32 v40, v167, v22
    v_xor_b32 v41, v175, v22
    v_xor_b32 v42, v183, v22
    v_or3_b32 v4, v40, v41, v42
    s_waitcnt vmcnt(0)
    v_perm_b32 v5, v161, v160, s88
    v_perm_b32 v6, v163, v162, s89
    v_bitop3_b32 v5, v5, v6, v22 bitop3:0x56
    v_or_b32 v4, v4, v5
    v_perm_b32 v5, v169, v168, s88
    v_perm_b32 v6, v171, v170, s89
    v_bitop3_b32 v5, v5, v6, v22 bitop3:0x56
    v_or_b32 v4, v4, v5
    v_perm_b32 v5, v177, v176, s88
    v_perm_b32 v6, v179, v178, s89
    v_bitop3_b32 v5, v5, v6, v22 bitop3:0x56
    v_or_b32 v4, v4, v5
    v_cmp_eq_u32 vcc, 0, v4
L_rmerge:
    v_max3_f32 v3, v164, v172, v180
    v_sub_f32 v164, v164, v3
    v_sub_f32 v172, v172, v3
    v_sub_f32 v180, v180, v3
    v_exp_f32 v164, v164
    v_exp_f32 v172, v172
    v_exp_f32 v180, v180
    s_and_b64 exec, exec, vcc
    s_cbranch_execz L_fin
    v_and_b32 v160, s90, v160
    v_and_b32 v161, s90, v161
    v_and_b32 v162, s90, v162
    v_and_b32 v163, s90, v163
    v_and_b32 v168, s90, v168
    v_and_b32 v169, s90, v169
    v_and_b32 v170, s90, v170
    v_and_b32 v171, s90, v171
    v_and_b32 v176, s90, v176
    v_and_b32 v177, s90, v177
    v_and_b32 v178, s90, v178
    v_and_b32 v179, s90, v179
    v_mul_f32 v37, v164, v165
    v_fmac_f32 v37, v172, v173
    v_fmac_f32 v37, v180, v181
    v_mul_f32 v60, v160, v164
    v_fmac_f32 v60, v168, v172
    v_fmac_f32 v60, v176, v180
    v_mul_f32 v61, v161, v164
    v_fmac_f32 v61, v169, v172
    v_fmac_f32 v61, v177, v180
    v_mul_f32 v62, v162, v164
    v_fmac_f32 v62, v170, v172
    v_fmac_f32 v62, v178, v180
    v_mul_f32 v63, v163, v164
    v_fmac_f32 v63, v171, v172
    v_fmac_f32 v63, v179, v180
L_rsolo:
    v_rcp_f32 v37, v37
    s_nop 0
    v_mul_f32 v60, v60, v37
    v_mul_f32 v61, v61, v37
    v_mul_f32 v62, v62, v37
    v_mul_f32 v63, v63, v37
    v_cvt_pk_bf16_f32 v64, v60, v61
    v_cvt_pk_bf16_f32 v65, v62, v63
    buffer_store_dwordx2 v[64:65], v21, s[48:51], s57 offen
    s_branch L_fin
L_finisher:
    v_and_b32 v14, 3, v1
    v_mul_u32_u24 v8, 384, v14
    v_lshrrev_b32 v13, 2, v1
    v_lshl_add_u32 v8, v13, 3, v8
    v_lshlrev_b32 v9, 4, v1
    v_lshlrev_b32 v14, 4, v14
    s_memrealtime s[96:97]
    s_waitcnt lgkmcnt(0)
    s_mov_b32 s48, s18
    s_and_b32 s49, s19, 0xffff
    s_mov_b32 s50, 393216
    s_mov_b32 s51, 0x20000
    s_mov_b32 s52, s20
    s_and_b32 s53, s21, 0xffff
    s_mov_b32 s54, 256
    s_mov_b32 s55, 0x20000
    s_mov_b32 s24, s22
    s_and_b32 s25, s23, 0xffff
    s_mov_b32 s26, 2528256
    s_mov_b32 s27, 0x20000
    s_cmp_eq_u32 s2, 0
    s_cbranch_scc0 L_fk
    s_or_b32 s71, s96, 1
    v_mov_b32 v16, s71
    v_mov_b32 v17, 0
    s_mov_b64 exec, 1
    buffer_atomic_cmpswap v[16:17], v9, s[52:55], 0 offen sc0 sc1
    s_mov_b64 exec, -1
    s_waitcnt vmcnt(0)
    v_readfirstlane_b32 s58, v16
    s_nop 3
    s_cmp_eq_u32 s58, 0
    s_cselect_b32 s71, s71, s58
L_fk:
    s_movk_i32 s69, 128
L_fb1:
    s_barrier
    s_sub_u32 s69, s69, 1
    s_cmp_lg_u32 s69, 0
    s_cbranch_scc1 L_fb1
    s_load_dword s71, s[20:21], 0
    s_barrier
    s_waitcnt lgkmcnt(0)
    s_cmp_eq_u32 s71, 0
    s_cbranch_scc0 L_ftag
    s_or_b32 s71, s96, 1
    v_mov_b32 v16, s71
    v_mov_b32 v17, 0
    s_mov_b64 exec, 1
    buffer_atomic_cmpswap v[16:17], v9, s[52:55], 0 offen sc0 sc1
    s_mov_b64 exec, -1
    s_waitcnt vmcnt(0)
    v_readfirstlane_b32 s58, v16
    s_nop 3
    s_cmp_eq_u32 s58, 0
    s_cselect_b32 s71, s71, s58
L_ftag:
    v_mov_b32 v10, s71
    v_mov_b32 v13, 154884
    ds_write_b32 v13, v10
    s_lshr_b32 s63, s101, 1
    s_lshl_b32 s58, s100, 1
    s_add_u32 s63, s63, s58
    s_mul_i32 s62, s63, 8704
    s_add_u32 s62, s62, 1048576
    s_waitcnt lgkmcnt(0)
    s_cmp_eq_u32 s2, 255
    s_cbranch_scc1 L_fin
    s_cmp_eq_u32 s101, 1
    s_cbranch_scc1 L_fmid
    s_movk_i32 s69, 89
L_fb2:
    s_barrier
    s_sub_u32 s69, s69, 1
    s_cmp_lg_u32 s69, 0
    s_cbranch_scc1 L_fb2
    v_add_u32 v13, 142336, v14
    v_lshlrev_b32 v11, 2, v1
    v_add_u32 v11, 142592, v11
    ds_read_b128 v[16:19], v13 offset:0
    ds_read_b128 v[20:23], v13 offset:64
    ds_read_b128 v[24:27], v13 offset:128
    ds_read_b128 v[28:31], v13 offset:192
    ds_read2st64_b32 v[32:33], v11 offset0:0 offset1:1
    ds_read2st64_b32 v[34:35], v11 offset0:2 offset1:3
    ds_read2st64_b32 v[36:37], v11 offset0:4 offset1:5
    ds_read2st64_b32 v[38:39], v11 offset0:6 offset1:7
    ds_read2st64_b32 v[40:41], v11 offset0:8 offset1:9
    ds_read2st64_b32 v[42:43], v11 offset0:10 offset1:11
    ds_read2st64_b32 v[44:45], v11 offset0:12 offset1:13
    ds_read2st64_b32 v[46:47], v11 offset0:14 offset1:15
    s_waitcnt lgkmcnt(4)
    ds_read2st64_b32 v[48:49], v11 offset0:16 offset1:17
    ds_read2st64_b32 v[50:51], v11 offset0:18 offset1:19
    ds_read2st64_b32 v[52:53], v11 offset0:20 offset1:21
    ds_read2st64_b32 v[54:55], v11 offset0:22 offset1:23
    ds_read2st64_b32 v[56:57], v11 offset0:24 offset1:25
    ds_read2st64_b32 v[58:59], v11 offset0:26 offset1:27
    ds_read2st64_b32 v[60:61], v11 offset0:28 offset1:29
    ds_read2st64_b32 v[62:63], v11 offset0:30 offset1:31
    s_waitcnt lgkmcnt(4)
    ds_read2st64_b32 v[64:65], v11 offset0:32 offset1:33
    ds_read2st64_b32 v[66:67], v11 offset0:34 offset1:35
    ds_read2st64_b32 v[68:69], v11 offset0:36 offset1:37
    ds_read2st64_b32 v[70:71], v11 offset0:38 offset1:39
    ds_read2st64_b32 v[72:73], v11 offset0:40 offset1:41
    ds_read2st64_b32 v[74:75], v11 offset0:42 offset1:43
    ds_read2st64_b32 v[76:77], v11 offset0:44 offset1:45
    ds_read2st64_b32 v[78:79], v11 offset0:46 offset1:47
    v_mov_b32 v83, v10
    v_mov_b32 v87, v10
    v_mov_b32 v91, v10
    v_mov_b32 v95, v10
    v_mov_b32 v99, v10
    v_mov_b32 v96, v16
    v_add_f32 v17, v17, v21
    v_add_f32 v25, v25, v29
    v_add_f32 v97, v17, v25
    v_add_f32 v18, v18, v22
    v_add_f32 v26, v26, v30
    v_add_f32 v98, v18, v26
    s_waitcnt lgkmcnt(0)
    v_add_f32 v32, v32, v44
    v_add_f32 v56, v56, v68
    v_add_f32 v32, v32, v56
    v_sub_f32 v80, v32, v98
    v_add_f32 v33, v33, v45
    v_add_f32 v57, v57, v69
    v_add_f32 v33, v33, v57
    v_sub_f32 v81, v33, v98
    v_add_f32 v34, v34, v46
    v_add_f32 v58, v58, v70
    v_add_f32 v34, v34, v58
    v_sub_f32 v82, v34, v98
    v_add_f32 v35, v35, v47
    v_add_f32 v59, v59, v71
    v_add_f32 v35, v35, v59
    v_sub_f32 v84, v35, v98
    v_add_f32 v36, v36, v48
    v_add_f32 v60, v60, v72
    v_add_f32 v36, v36, v60
    v_sub_f32 v85, v36, v98
    v_add_f32 v37, v37, v49
    v_add_f32 v61, v61, v73
    v_add_f32 v37, v37, v61
    v_sub_f32 v86, v37, v98
    v_add_f32 v38, v38, v50
    v_add_f32 v62, v62, v74
    v_add_f32 v38, v38, v62
    v_sub_f32 v88, v38, v98
    v_add_f32 v39, v39, v51
    v_add_f32 v63, v63, v75
    v_add_f32 v39, v39, v63
    v_sub_f32 v89, v39, v98
    v_add_f32 v40, v40, v52
    v_add_f32 v64, v64, v76
    v_add_f32 v40, v40, v64
    v_sub_f32 v90, v40, v98
    v_add_f32 v41, v41, v53
    v_add_f32 v65, v65, v77
    v_add_f32 v41, v41, v65
    v_sub_f32 v92, v41, v98
    v_add_f32 v42, v42, v54
    v_add_f32 v66, v66, v78
    v_add_f32 v42, v42, v66
    v_sub_f32 v93, v42, v98
    v_add_f32 v43, v43, v55
    v_add_f32 v67, v67, v79
    v_add_f32 v43, v43, v67
    v_sub_f32 v94, v43, v98
    s_movk_i32 s69, 39
L_fb3:
    s_barrier
    s_sub_u32 s69, s69, 1
    s_cmp_lg_u32 s69, 0
    s_cbranch_scc1 L_fb3
    s_barrier
    s_mov_b32 s69, 2
L_fo5:
    s_add_u32 s58, s62, 4352
    s_add_u32 s59, s62, 8448
    buffer_load_dwordx4 v[116:119], v14, s[24:27], s59 offen sc1
    buffer_load_dwordx4 v[100:103], v9, s[24:27], s58 offen offset:0 sc1
    buffer_load_dwordx4 v[104:107], v9, s[24:27], s58 offen offset:1024 sc1
    buffer_load_dwordx4 v[108:111], v9, s[24:27], s58 offen offset:2048 sc1
    buffer_load_dwordx4 v[112:115], v9, s[24:27], s58 offen offset:3072 sc1
    s_waitcnt vmcnt(0)
    v_xor_b32 v13, v10, v103
    v_xor_b32 v11, v10, v107
    v_or_b32 v13, v13, v11
    v_xor_b32 v11, v10, v111
    v_or_b32 v13, v13, v11
    v_xor_b32 v11, v10, v115
    v_or_b32 v13, v13, v11
    v_xor_b32 v11, v10, v119
    v_or_b32 v13, v13, v11
    v_cmp_ne_u32 vcc, 0, v13
    s_nop 4
    s_cmp_eq_u64 vcc, 0
    s_cbranch_scc1 L_fo7
    s_sub_u32 s69, s69, 1
    s_cmp_lg_u32 s69, 0
    s_cbranch_scc1 L_fo5
    s_add_u32 s58, s62, 0
    s_add_u32 s59, s62, 4096
    buffer_store_dwordx4 v[80:83], v9, s[24:27], s58 offen offset:0 sc1
    buffer_store_dwordx4 v[84:87], v9, s[24:27], s58 offen offset:1024 sc1
    buffer_store_dwordx4 v[88:91], v9, s[24:27], s58 offen offset:2048 sc1
    buffer_store_dwordx4 v[92:95], v9, s[24:27], s58 offen offset:3072 sc1
    s_mov_b64 exec, 15
    buffer_store_dwordx4 v[96:99], v14, s[24:27], s59 offen sc1
    s_mov_b64 exec, -1
    s_waitcnt vmcnt(0)
    s_add_u32 s58, s62, 4352
    s_add_u32 s59, s62, 8448
    buffer_load_dwordx4 v[116:119], v14, s[24:27], s59 offen sc1
    buffer_load_dwordx4 v[100:103], v9, s[24:27], s58 offen offset:0 sc1
    buffer_load_dwordx4 v[104:107], v9, s[24:27], s58 offen offset:1024 sc1
    buffer_load_dwordx4 v[108:111], v9, s[24:27], s58 offen offset:2048 sc1
    buffer_load_dwordx4 v[112:115], v9, s[24:27], s58 offen offset:3072 sc1
    s_waitcnt vmcnt(0)
    v_xor_b32 v13, v10, v103
    v_xor_b32 v11, v10, v107
    v_or_b32 v13, v13, v11
    v_xor_b32 v11, v10, v111
    v_or_b32 v13, v13, v11
    v_xor_b32 v11, v10, v115
    v_or_b32 v13, v13, v11
    v_xor_b32 v11, v10, v119
    v_or_b32 v13, v13, v11
    v_cmp_ne_u32 vcc, 0, v13
    s_nop 4
    s_cmp_eq_u64 vcc, 0
    s_cbranch_scc0 L_fin
L_fo7:
    v_max_f32 v11, v96, v116
    v_sub_f32 v16, v96, v11
    v_sub_f32 v17, v116, v11
    v_exp_f32 v16, v16
    v_exp_f32 v17, v17
    s_nop 0
    v_mul_f32 v12, v16, v97
    v_fmac_f32 v12, v17, v117
    v_rcp_f32 v12, v12
    s_add_u32 s58, s63, 0
    s_mul_i32 s58, s58, 1536
    v_mul_f32 v16, v16, v12
    v_mul_f32 v17, v17, v12
    v_mul_f32 v32, v80, v16
    v_fmac_f32 v32, v100, v17
    v_mul_f32 v33, v81, v16
    v_fmac_f32 v33, v101, v17
    v_mul_f32 v34, v82, v16
    v_fmac_f32 v34, v102, v17
    v_mul_f32 v35, v84, v16
    v_fmac_f32 v35, v104, v17
    v_mul_f32 v36, v85, v16
    v_fmac_f32 v36, v105, v17
    v_mul_f32 v37, v86, v16
    v_fmac_f32 v37, v106, v17
    v_mul_f32 v38, v88, v16
    v_fmac_f32 v38, v108, v17
    v_mul_f32 v39, v89, v16
    v_fmac_f32 v39, v109, v17
    v_mul_f32 v40, v90, v16
    v_fmac_f32 v40, v110, v17
    v_mul_f32 v41, v92, v16
    v_fmac_f32 v41, v112, v17
    v_mul_f32 v42, v93, v16
    v_fmac_f32 v42, v113, v17
    v_mul_f32 v43, v94, v16
    v_fmac_f32 v43, v114, v17
    v_cvt_pk_bf16_f32 v44, v32, v33
    v_cvt_pk_bf16_f32 v45, v34, v35
    v_cvt_pk_bf16_f32 v46, v36, v37
    v_cvt_pk_bf16_f32 v47, v38, v39
    v_cvt_pk_bf16_f32 v48, v40, v41
    v_cvt_pk_bf16_f32 v49, v42, v43
    buffer_store_dwordx2 v[44:45], v8, s[48:51], s58 offen offset:0
    buffer_store_dwordx2 v[46:47], v8, s[48:51], s58 offen offset:128
    buffer_store_dwordx2 v[48:49], v8, s[48:51], s58 offen offset:256
    s_branch L_fin
L_fmid:
    v_and_b32 v7, 1, v1
    v_mul_u32_u24 v7, 8704, v7
    v_add_u32 v7, 4108, v7
    s_movk_i32 s69, 41
L_fb4:
    s_barrier
    s_sub_u32 s69, s69, 1
    s_cmp_lg_u32 s69, 0
    s_cbranch_scc1 L_fb4
    v_add_u32 v13, 142336, v14
    v_lshlrev_b32 v11, 2, v1
    v_add_u32 v11, 142592, v11
    ds_read_b128 v[16:19], v13 offset:0
    ds_read_b128 v[20:23], v13 offset:64
    ds_read_b128 v[24:27], v13 offset:128
    ds_read_b128 v[28:31], v13 offset:192
    ds_read2st64_b32 v[32:33], v11 offset0:0 offset1:1
    ds_read2st64_b32 v[34:35], v11 offset0:2 offset1:3
    ds_read2st64_b32 v[36:37], v11 offset0:4 offset1:5
    ds_read2st64_b32 v[38:39], v11 offset0:6 offset1:7
    ds_read2st64_b32 v[40:41], v11 offset0:8 offset1:9
    ds_read2st64_b32 v[42:43], v11 offset0:10 offset1:11
    ds_read2st64_b32 v[44:45], v11 offset0:12 offset1:13
    ds_read2st64_b32 v[46:47], v11 offset0:14 offset1:15
    s_waitcnt lgkmcnt(4)
    ds_read2st64_b32 v[48:49], v11 offset0:16 offset1:17
    ds_read2st64_b32 v[50:51], v11 offset0:18 offset1:19
    ds_read2st64_b32 v[52:53], v11 offset0:20 offset1:21
    ds_read2st64_b32 v[54:55], v11 offset0:22 offset1:23
    ds_read2st64_b32 v[56:57], v11 offset0:24 offset1:25
    ds_read2st64_b32 v[58:59], v11 offset0:26 offset1:27
    ds_read2st64_b32 v[60:61], v11 offset0:28 offset1:29
    ds_read2st64_b32 v[62:63], v11 offset0:30 offset1:31
    s_waitcnt lgkmcnt(4)
    ds_read2st64_b32 v[64:65], v11 offset0:32 offset1:33
    ds_read2st64_b32 v[66:67], v11 offset0:34 offset1:35
    ds_read2st64_b32 v[68:69], v11 offset0:36 offset1:37
    ds_read2st64_b32 v[70:71], v11 offset0:38 offset1:39
    ds_read2st64_b32 v[72:73], v11 offset0:40 offset1:41
    ds_read2st64_b32 v[74:75], v11 offset0:42 offset1:43
    ds_read2st64_b32 v[76:77], v11 offset0:44 offset1:45
    ds_read2st64_b32 v[78:79], v11 offset0:46 offset1:47
    v_mov_b32 v83, v10
    v_mov_b32 v87, v10
    v_mov_b32 v91, v10
    v_mov_b32 v95, v10
    v_mov_b32 v99, v10
    v_mov_b32 v96, v16
    v_add_f32 v17, v17, v21
    v_add_f32 v25, v25, v29
    v_add_f32 v97, v17, v25
    v_add_f32 v18, v18, v22
    v_add_f32 v26, v26, v30
    v_add_f32 v98, v18, v26
    s_waitcnt lgkmcnt(0)
    v_add_f32 v32, v32, v44
    v_add_f32 v56, v56, v68
    v_add_f32 v32, v32, v56
    v_sub_f32 v80, v32, v98
    v_add_f32 v33, v33, v45
    v_add_f32 v57, v57, v69
    v_add_f32 v33, v33, v57
    v_sub_f32 v81, v33, v98
    v_add_f32 v34, v34, v46
    v_add_f32 v58, v58, v70
    v_add_f32 v34, v34, v58
    v_sub_f32 v82, v34, v98
    v_add_f32 v35, v35, v47
    v_add_f32 v59, v59, v71
    v_add_f32 v35, v35, v59
    v_sub_f32 v84, v35, v98
    v_add_f32 v36, v36, v48
    v_add_f32 v60, v60, v72
    v_add_f32 v36, v36, v60
    v_sub_f32 v85, v36, v98
    v_add_f32 v37, v37, v49
    v_add_f32 v61, v61, v73
    v_add_f32 v37, v37, v61
    v_sub_f32 v86, v37, v98
    v_add_f32 v38, v38, v50
    v_add_f32 v62, v62, v74
    v_add_f32 v38, v38, v62
    v_sub_f32 v88, v38, v98
    v_add_f32 v39, v39, v51
    v_add_f32 v63, v63, v75
    v_add_f32 v39, v39, v63
    v_sub_f32 v89, v39, v98
    v_add_f32 v40, v40, v52
    v_add_f32 v64, v64, v76
    v_add_f32 v40, v40, v64
    v_sub_f32 v90, v40, v98
    v_add_f32 v41, v41, v53
    v_add_f32 v65, v65, v77
    v_add_f32 v41, v41, v65
    v_sub_f32 v92, v41, v98
    v_add_f32 v42, v42, v54
    v_add_f32 v66, v66, v78
    v_add_f32 v42, v42, v66
    v_sub_f32 v93, v42, v98
    v_add_f32 v43, v43, v55
    v_add_f32 v67, v67, v79
    v_add_f32 v43, v43, v67
    v_sub_f32 v94, v43, v98
    s_movk_i32 s69, 40
L_fb5:
    s_barrier
    s_sub_u32 s69, s69, 1
    s_cmp_lg_u32 s69, 0
    s_cbranch_scc1 L_fb5
    v_add_u32 v13, 142336, v14
    v_lshlrev_b32 v11, 2, v1
    v_add_u32 v11, 142592, v11
    ds_read_b128 v[16:19], v13 offset:0
    ds_read_b128 v[20:23], v13 offset:64
    ds_read_b128 v[24:27], v13 offset:128
    ds_read_b128 v[28:31], v13 offset:192
    ds_read2st64_b32 v[32:33], v11 offset0:0 offset1:1
    ds_read2st64_b32 v[34:35], v11 offset0:2 offset1:3
    ds_read2st64_b32 v[36:37], v11 offset0:4 offset1:5
    ds_read2st64_b32 v[38:39], v11 offset0:6 offset1:7
    ds_read2st64_b32 v[40:41], v11 offset0:8 offset1:9
    ds_read2st64_b32 v[42:43], v11 offset0:10 offset1:11
    ds_read2st64_b32 v[44:45], v11 offset0:12 offset1:13
    ds_read2st64_b32 v[46:47], v11 offset0:14 offset1:15
    s_waitcnt lgkmcnt(4)
    ds_read2st64_b32 v[48:49], v11 offset0:16 offset1:17
    ds_read2st64_b32 v[50:51], v11 offset0:18 offset1:19
    ds_read2st64_b32 v[52:53], v11 offset0:20 offset1:21
    ds_read2st64_b32 v[54:55], v11 offset0:22 offset1:23
    ds_read2st64_b32 v[56:57], v11 offset0:24 offset1:25
    ds_read2st64_b32 v[58:59], v11 offset0:26 offset1:27
    ds_read2st64_b32 v[60:61], v11 offset0:28 offset1:29
    ds_read2st64_b32 v[62:63], v11 offset0:30 offset1:31
    s_waitcnt lgkmcnt(4)
    ds_read2st64_b32 v[64:65], v11 offset0:32 offset1:33
    ds_read2st64_b32 v[66:67], v11 offset0:34 offset1:35
    ds_read2st64_b32 v[68:69], v11 offset0:36 offset1:37
    ds_read2st64_b32 v[70:71], v11 offset0:38 offset1:39
    ds_read2st64_b32 v[72:73], v11 offset0:40 offset1:41
    ds_read2st64_b32 v[74:75], v11 offset0:42 offset1:43
    ds_read2st64_b32 v[76:77], v11 offset0:44 offset1:45
    ds_read2st64_b32 v[78:79], v11 offset0:46 offset1:47
    v_mov_b32 v103, v10
    v_mov_b32 v107, v10
    v_mov_b32 v111, v10
    v_mov_b32 v115, v10
    v_mov_b32 v119, v10
    v_mov_b32 v116, v16
    v_add_f32 v17, v17, v21
    v_add_f32 v25, v25, v29
    v_add_f32 v117, v17, v25
    v_add_f32 v18, v18, v22
    v_add_f32 v26, v26, v30
    v_add_f32 v118, v18, v26
    s_waitcnt lgkmcnt(0)
    v_add_f32 v32, v32, v44
    v_add_f32 v56, v56, v68
    v_add_f32 v32, v32, v56
    v_sub_f32 v100, v32, v118
    v_add_f32 v33, v33, v45
    v_add_f32 v57, v57, v69
    v_add_f32 v33, v33, v57
    v_sub_f32 v101, v33, v118
    v_add_f32 v34, v34, v46
    v_add_f32 v58, v58, v70
    v_add_f32 v34, v34, v58
    v_sub_f32 v102, v34, v118
    v_add_f32 v35, v35, v47
    v_add_f32 v59, v59, v71
    v_add_f32 v35, v35, v59
    v_sub_f32 v104, v35, v118
    v_add_f32 v36, v36, v48
    v_add_f32 v60, v60, v72
    v_add_f32 v36, v36, v60
    v_sub_f32 v105, v36, v118
    v_add_f32 v37, v37, v49
    v_add_f32 v61, v61, v73
    v_add_f32 v37, v37, v61
    v_sub_f32 v106, v37, v118
    v_add_f32 v38, v38, v50
    v_add_f32 v62, v62, v74
    v_add_f32 v38, v38, v62
    v_sub_f32 v108, v38, v118
    v_add_f32 v39, v39, v51
    v_add_f32 v63, v63, v75
    v_add_f32 v39, v39, v63
    v_sub_f32 v109, v39, v118
    v_add_f32 v40, v40, v52
    v_add_f32 v64, v64, v76
    v_add_f32 v40, v40, v64
    v_sub_f32 v110, v40, v118
    v_add_f32 v41, v41, v53
    v_add_f32 v65, v65, v77
    v_add_f32 v41, v41, v65
    v_sub_f32 v112, v41, v118
    v_add_f32 v42, v42, v54
    v_add_f32 v66, v66, v78
    v_add_f32 v42, v42, v66
    v_sub_f32 v113, v42, v118
    v_add_f32 v43, v43, v55
    v_add_f32 v67, v67, v79
    v_add_f32 v43, v43, v67
    v_sub_f32 v114, v43, v118
    s_movk_i32 s69, 46
L_fb6:
    s_barrier
    s_sub_u32 s69, s69, 1
    s_cmp_lg_u32 s69, 0
    s_cbranch_scc1 L_fb6
    s_add_u32 s58, s62, 4352
    s_add_u32 s59, s62, 8448
    buffer_store_dwordx4 v[80:83], v9, s[24:27], s58 offen offset:0 sc1
    buffer_store_dwordx4 v[84:87], v9, s[24:27], s58 offen offset:1024 sc1
    buffer_store_dwordx4 v[88:91], v9, s[24:27], s58 offen offset:2048 sc1
    buffer_store_dwordx4 v[92:95], v9, s[24:27], s58 offen offset:3072 sc1
    s_mov_b64 exec, 15
    buffer_store_dwordx4 v[96:99], v14, s[24:27], s59 offen sc1
    s_mov_b64 exec, -1
    s_add_u32 s58, s62, 13056
    s_add_u32 s59, s62, 17152
    buffer_store_dwordx4 v[100:103], v9, s[24:27], s58 offen offset:0 sc1
    buffer_store_dwordx4 v[104:107], v9, s[24:27], s58 offen offset:1024 sc1
    buffer_store_dwordx4 v[108:111], v9, s[24:27], s58 offen offset:2048 sc1
    buffer_store_dwordx4 v[112:115], v9, s[24:27], s58 offen offset:3072 sc1
    s_mov_b64 exec, 15
    buffer_store_dwordx4 v[116:119], v14, s[24:27], s59 offen sc1
    s_mov_b64 exec, -1
    s_barrier
    s_barrier
    s_waitcnt vmcnt(0)
    buffer_load_dword v15, v7, s[24:27], s62 offen sc1
    s_waitcnt vmcnt(0)
    v_cmp_eq_u32 vcc, v15, v10
    s_nop 4
    s_and_b32 s70, vcc_lo, 3
    s_cbranch_scc0 L_fin
    s_bitcmp1_b32 s70, 0
    s_cbranch_scc0 L_fm30
    s_waitcnt vmcnt(0)
    s_add_u32 s58, s62, 0
    s_add_u32 s59, s62, 4096
    buffer_load_dwordx4 v[136:139], v14, s[24:27], s59 offen sc1
    buffer_load_dwordx4 v[120:123], v9, s[24:27], s58 offen offset:0 sc1
    buffer_load_dwordx4 v[124:127], v9, s[24:27], s58 offen offset:1024 sc1
    buffer_load_dwordx4 v[128:131], v9, s[24:27], s58 offen offset:2048 sc1
    buffer_load_dwordx4 v[132:135], v9, s[24:27], s58 offen offset:3072 sc1
    s_waitcnt vmcnt(0)
    v_xor_b32 v13, v10, v123
    v_xor_b32 v11, v10, v127
    v_or_b32 v13, v13, v11
    v_xor_b32 v11, v10, v131
    v_or_b32 v13, v13, v11
    v_xor_b32 v11, v10, v135
    v_or_b32 v13, v13, v11
    v_xor_b32 v11, v10, v139
    v_or_b32 v13, v13, v11
    v_cmp_ne_u32 vcc, 0, v13
    s_nop 4
    s_cmp_eq_u64 vcc, 0
    s_cbranch_scc0 L_fm30
    v_max_f32 v11, v136, v96
    v_sub_f32 v16, v136, v11
    v_sub_f32 v17, v96, v11
    v_exp_f32 v16, v16
    v_exp_f32 v17, v17
    s_nop 0
    v_mul_f32 v12, v16, v137
    v_fmac_f32 v12, v17, v97
    v_rcp_f32 v12, v12
    s_add_u32 s58, s63, 0
    s_mul_i32 s58, s58, 1536
    v_mul_f32 v16, v16, v12
    v_mul_f32 v17, v17, v12
    v_mul_f32 v32, v120, v16
    v_fmac_f32 v32, v80, v17
    v_mul_f32 v33, v121, v16
    v_fmac_f32 v33, v81, v17
    v_mul_f32 v34, v122, v16
    v_fmac_f32 v34, v82, v17
    v_mul_f32 v35, v124, v16
    v_fmac_f32 v35, v84, v17
    v_mul_f32 v36, v125, v16
    v_fmac_f32 v36, v85, v17
    v_mul_f32 v37, v126, v16
    v_fmac_f32 v37, v86, v17
    v_mul_f32 v38, v128, v16
    v_fmac_f32 v38, v88, v17
    v_mul_f32 v39, v129, v16
    v_fmac_f32 v39, v89, v17
    v_mul_f32 v40, v130, v16
    v_fmac_f32 v40, v90, v17
    v_mul_f32 v41, v132, v16
    v_fmac_f32 v41, v92, v17
    v_mul_f32 v42, v133, v16
    v_fmac_f32 v42, v93, v17
    v_mul_f32 v43, v134, v16
    v_fmac_f32 v43, v94, v17
    v_cvt_pk_bf16_f32 v44, v32, v33
    v_cvt_pk_bf16_f32 v45, v34, v35
    v_cvt_pk_bf16_f32 v46, v36, v37
    v_cvt_pk_bf16_f32 v47, v38, v39
    v_cvt_pk_bf16_f32 v48, v40, v41
    v_cvt_pk_bf16_f32 v49, v42, v43
    buffer_store_dwordx2 v[44:45], v8, s[48:51], s58 offen offset:0
    buffer_store_dwordx2 v[46:47], v8, s[48:51], s58 offen offset:128
    buffer_store_dwordx2 v[48:49], v8, s[48:51], s58 offen offset:256
L_fm30:
    s_bitcmp1_b32 s70, 1
    s_cbranch_scc0 L_fm31
    s_waitcnt vmcnt(0)
    s_add_u32 s58, s62, 8704
    s_add_u32 s59, s62, 12800
    buffer_load_dwordx4 v[136:139], v14, s[24:27], s59 offen sc1
    buffer_load_dwordx4 v[120:123], v9, s[24:27], s58 offen offset:0 sc1
    buffer_load_dwordx4 v[124:127], v9, s[24:27], s58 offen offset:1024 sc1
    buffer_load_dwordx4 v[128:131], v9, s[24:27], s58 offen offset:2048 sc1
    buffer_load_dwordx4 v[132:135], v9, s[24:27], s58 offen offset:3072 sc1
    s_waitcnt vmcnt(0)
    v_xor_b32 v13, v10, v123
    v_xor_b32 v11, v10, v127
    v_or_b32 v13, v13, v11
    v_xor_b32 v11, v10, v131
    v_or_b32 v13, v13, v11
    v_xor_b32 v11, v10, v135
    v_or_b32 v13, v13, v11
    v_xor_b32 v11, v10, v139
    v_or_b32 v13, v13, v11
    v_cmp_ne_u32 vcc, 0, v13
    s_nop 4
    s_cmp_eq_u64 vcc, 0
    s_cbranch_scc0 L_fm31
    v_max_f32 v11, v136, v116
    v_sub_f32 v16, v136, v11
    v_sub_f32 v17, v116, v11
    v_exp_f32 v16, v16
    v_exp_f32 v17, v17
    s_nop 0
    v_mul_f32 v12, v16, v137
    v_fmac_f32 v12, v17, v117
    v_rcp_f32 v12, v12
    s_add_u32 s58, s63, 1
    s_mul_i32 s58, s58, 1536
    v_mul_f32 v16, v16, v12
    v_mul_f32 v17, v17, v12
    v_mul_f32 v32, v120, v16
    v_fmac_f32 v32, v100, v17
    v_mul_f32 v33, v121, v16
    v_fmac_f32 v33, v101, v17
    v_mul_f32 v34, v122, v16
    v_fmac_f32 v34, v102, v17
    v_mul_f32 v35, v124, v16
    v_fmac_f32 v35, v104, v17
    v_mul_f32 v36, v125, v16
    v_fmac_f32 v36, v105, v17
    v_mul_f32 v37, v126, v16
    v_fmac_f32 v37, v106, v17
    v_mul_f32 v38, v128, v16
    v_fmac_f32 v38, v108, v17
    v_mul_f32 v39, v129, v16
    v_fmac_f32 v39, v109, v17
    v_mul_f32 v40, v130, v16
    v_fmac_f32 v40, v110, v17
    v_mul_f32 v41, v132, v16
    v_fmac_f32 v41, v112, v17
    v_mul_f32 v42, v133, v16
    v_fmac_f32 v42, v113, v17
    v_mul_f32 v43, v134, v16
    v_fmac_f32 v43, v114, v17
    v_cvt_pk_bf16_f32 v44, v32, v33
    v_cvt_pk_bf16_f32 v45, v34, v35
    v_cvt_pk_bf16_f32 v46, v36, v37
    v_cvt_pk_bf16_f32 v47, v38, v39
    v_cvt_pk_bf16_f32 v48, v40, v41
    v_cvt_pk_bf16_f32 v49, v42, v43
    buffer_store_dwordx2 v[44:45], v8, s[48:51], s58 offen offset:0
    buffer_store_dwordx2 v[46:47], v8, s[48:51], s58 offen offset:128
    buffer_store_dwordx2 v[48:49], v8, s[48:51], s58 offen offset:256
L_fm31:
L_fin:
L_end:
    s_endpgm
.section .rodata,"a"
.p2align 6
.amdhsa_kernel standalone__kv_cache_quant_int4_int2_kv_with_per_channel_or_per_token_scales__sampling_kernel
  .amdhsa_next_free_vgpr 224
  .amdhsa_next_free_sgpr 102
  .amdhsa_accum_offset 224
  .amdhsa_group_segment_fixed_size 0
  .amdhsa_kernarg_size 80
  .amdhsa_user_sgpr_count 2
  .amdhsa_user_sgpr_kernarg_segment_ptr 1
  .amdhsa_system_sgpr_workgroup_id_x 1
  .amdhsa_float_denorm_mode_32 3
.end_amdhsa_kernel
```

```asm
; @launch grid=(256,1,1) block=(448,1,1) lds=161280
.amdgcn_target "amdgcn-amd-amdhsa--gfx950"
.text
.globl standalone__kv_cache_quant_int4_int2_kv_with_per_channel_or_per_token_scales__sampling_kernel
.p2align 8
.type standalone__kv_cache_quant_int4_int2_kv_with_per_channel_or_per_token_scales__sampling_kernel,@function
standalone__kv_cache_quant_int4_int2_kv_with_per_channel_or_per_token_scales__sampling_kernel:
    s_load_dwordx16 s[4:19], s[0:1], 0
    s_load_dwordx4 s[20:23], s[0:1], 64
    s_cmp_ge_u32 s2, 256
    s_cbranch_scc1 L_end
    v_lshrrev_b32 v2, 6, v0
    v_and_b32 v1, 63, v0
    v_readfirstlane_b32 s56, v2
    s_mov_b32 s72, s2
    s_bfe_u32 s58, s2, 196612
    s_lshr_b32 s59, s2, 7
    s_xor_b32 s2, s2, s58
    s_xor_b32 s2, s2, s59
    s_lshr_b32 s58, s2, 1
    s_and_b32 s58, s58, 2
    s_xor_b32 s2, s2, s58
    s_mul_i32 s57, s2, 1398112
    s_add_u32 s57, s57, 43691
    s_lshr_b32 s57, s57, 17
    v_lshlrev_b32 v8, 4, v1
    v_lshrrev_b32 v15, 5, v1
    v_mul_u32_u24 v9, 31488, v15
    v_add_u32 v9, v9, v8
    v_add_u32 v10, 31488, v8
    s_lshl_b32 s58, s57, 7
    s_add_u32 s58, s58, s56
    s_mul_i32 s58, s58, 1536
    s_mul_i32 m0, s56, 3072
    s_mov_b32 s26, 805306368
    s_mov_b32 s27, 0x20000
    s_waitcnt lgkmcnt(0)
    s_mov_b32 s24, s6
    s_and_b32 s25, s7, 0xffff
    buffer_load_dwordx4 v8, s[24:27], s58 offen offset:0 nt lds
    buffer_load_dwordx4 v9, s[24:27], s58 offen offset:1024 nt lds
    buffer_load_dwordx4 v10, s[24:27], s58 offen offset:2048 nt lds
    s_mul_i32 s100, s2, 43691
    s_lshr_b32 s100, s100, 17
    s_mul_i32 s101, s100, 3
    s_sub_u32 s101, s2, s101
    s_cmp_eq_u32 s2, 255
    s_cselect_b32 s73, 16, 11
    s_cmp_eq_u32 s101, 1
    s_cselect_b32 s3, 5, s73
    s_cselect_b32 s73, 10, s73
    s_sub_u32 s58, 2, s101
    s_mul_i32 s58, s58, 11
    s_lshr_b32 s58, s58, 1
    s_lshl_b32 s59, s100, 4
    s_sub_u32 s58, s58, s59
    s_add_u32 s58, s58, 4080
    s_sub_u32 s58, s58, s73
    v_cmp_le_u32 vcc, s73, v1
    v_add_u32 v3, s57, v1
    v_add_u32 v4, s58, v1
    v_cndmask_b32 v152, v3, v4, vcc
    s_cmp_eq_u32 s56, 4
    s_cbranch_scc1 L_loader
    s_cmp_lt_u32 s56, 4
    s_cbranch_scc1 L_consumer
    s_cmp_eq_u32 s56, 6
    s_cbranch_scc1 L_pacer
    s_waitcnt lgkmcnt(0)
    s_mov_b32 s44, s4
    s_and_b32 s45, s5, 0xffff
    s_mov_b32 s46, 393216
    s_mov_b32 s47, 0x20000
    s_mov_b32 s32, s12
    s_and_b32 s33, s13, 0xffff
    s_mov_b32 s34, 6291456
    s_mov_b32 s35, 0x20000
    s_mov_b32 s28, s10
    s_and_b32 s29, s11, 0xffff
    s_mov_b32 s30, 6291456
    s_mov_b32 s31, 0x20000
    s_mov_b32 s36, s14
    s_and_b32 s37, s15, 0xffff
    s_mov_b32 s38, 2097152
    s_mov_b32 s39, 0x20000
    s_mov_b32 s40, s16
    s_and_b32 s41, s17, 0xffff
    s_mov_b32 s42, 2097152
    s_mov_b32 s43, 0x20000
    s_sub_u32 s61, s56, 5
    s_mov_b32 s62, s61
    s_mov_b32 exec_hi, 0xffff
L_stq:
    s_mul_i32 s58, s62, s3
    s_cmp_lt_u32 s58, 15
    s_cbranch_scc0 L_stage
    v_readlane_b32 s58, v152, s58
    s_mul_i32 s59, s62, 1536
    s_add_u32 m0, s59, 155136
    s_add_u32 s62, s62, 1
    s_lshr_b32 s58, s58, 4
    s_mul_i32 s58, s58, 1536
    buffer_load_dwordx4 v8, s[44:47], s58 offen nt lds
    buffer_load_dwordx4 v8, s[44:47], s58 offen offset:768 nt lds
    s_branch L_stq
L_stage:
    v_readlane_b32 s60, v152, s61
    s_mul_i32 s59, s61, 3072
    s_add_u32 m0, s59, 76800
    s_mov_b32 exec_hi, 0xffff
    s_mul_i32 s58, s60, 1536
    buffer_load_dwordx4 v8, s[32:35], s58 offen nt lds
    buffer_load_dwordx4 v8, s[32:35], s58 offen offset:768 nt lds
    s_add_u32 m0, m0, 1536
    s_lshl_b32 s59, s61, 10
    buffer_load_dwordx4 v8, s[28:31], s58 offen nt lds
    buffer_load_dwordx4 v8, s[28:31], s58 offen offset:768 nt lds
    s_add_u32 m0, s59, 125952
    s_mov_b32 exec_hi, 0
    s_lshl_b32 s58, s60, 9
    buffer_load_dwordx4 v8, s[36:39], s58 offen nt lds
    s_add_u32 m0, m0, 512
    s_add_u32 s61, s61, 1
    buffer_load_dwordx4 v8, s[40:43], s58 offen nt lds
    s_cmp_lt_u32 s61, 16
    s_cbranch_scc1 L_stage
    s_mov_b32 exec_hi, -1
    s_branch L_finisher
L_loader:
    s_setprio 3
    v_add_u32 v22, 16, v1
    v_lshrrev_b32 v11, 6, v22
    v_xor_b32 v12, 1, v15
    v_add_u32 v22, 48, v1
    v_lshrrev_b32 v13, 6, v22
    v_mov_b32 v17, v8
    v_mov_b32 v18, v9
    v_mov_b32 v19, v10
    s_mov_b32 s68, 7
    s_mov_b32 m0, 21504
    s_movk_i32 s71, 3072
    s_mul_i32 s57, s57, 196608
    s_add_u32 s57, s57, 10752
    s_mov_b32 s84, 0x400000
    s_mov_b32 s85, 0x800
    s_movk_i32 s86, 1536
    s_mov_b32 s70, 18
    s_mov_b32 s74, 0
    v_mov_b32 v20, 4710
    v_mov_b32 v21, 154880
    ds_write_b32 v21, v20
L_lw16:
    s_waitcnt vmcnt(16)
L_lw17:
    s_waitcnt vmcnt(17)
L_lw18:
    s_waitcnt vmcnt(18)
L_lw19:
    s_waitcnt vmcnt(19)
L_lw20:
    s_waitcnt vmcnt(20)
    buffer_load_dwordx4 v17, s[24:27], s57 offen nt lds
    s_add_u32 s68, s68, 1
    s_and_b32 s58, s68, 63
    s_cmp_ge_u32 s58, 43
    s_cselect_b32 s69, -768, 0
    s_cmp_eq_u32 s58, 21
    buffer_load_dwordx4 v18, s[24:27], s57 offen offset:1024 nt lds
    s_cselect_b32 s62, 33024, 0
    v_mad_u32_u24 v17, v11, s62, v8
    v_mad_i32_i24 v22, v15, s69, v9
    v_mad_u32_u24 v18, v12, s62, v22
    s_bitcmp1_b64 s[84:85], s58
    buffer_load_dwordx4 v19, s[24:27], s57 offen offset:2048 nt lds
    s_cselect_b32 s63, 34560, s86
    s_add_u32 m0, m0, s71
    s_add_u32 s57, s57, s63
    v_add_u32 v22, s69, v10
    v_mad_u32_u24 v19, v13, s62, v22
    s_and_b32 s59, s68, 7
    s_cbranch_scc0 L_lunit
L_lad:
    s_cmp_eq_u32 s70, 20
    s_cbranch_scc1 L_lw20
    s_cmp_eq_u32 s70, 19
    s_cbranch_scc1 L_lw19
    s_cmp_eq_u32 s70, 18
    s_cbranch_scc1 L_lw18
    s_cmp_eq_u32 s70, 17
    s_cbranch_scc1 L_lw17
    s_branch L_lw16
L_lunit:
    s_waitcnt vmcnt(24)
    s_cmp_le_u32 s68, 16
    s_cbranch_scc1 L_lfirst
L_lbar:
    s_barrier
L_lnobar:
    s_waitcnt lgkmcnt(0)
    v_readfirstlane_b32 s59, v20
    ds_read_b32 v20, v21
    s_cmp_eq_u32 m0, 73728
    s_cselect_b32 m0, 0, m0
    s_and_b32 s74, s74, 255
    s_add_u32 s74, s74, s59
    s_lshr_b32 s70, s74, 8
    s_cmp_eq_u32 s58, 0
    s_cbranch_scc1 L_lblock
L_lsel:
    s_cmp_le_u32 s70, 20
    s_cbranch_scc1 L_lad
    s_cmp_le_u32 s70, 21
    s_cbranch_scc1 L_lw21
    s_cmp_le_u32 s70, 22
    s_cbranch_scc1 L_lw22
    s_cmp_le_u32 s70, 23
    s_cbranch_scc1 L_lw23
    s_cmp_le_u32 s70, 24
    s_cbranch_scc1 L_lw24
    s_branch L_lw25
L_lblock:
    s_bfe_u32 s58, s68, 262150
    v_readlane_b32 s57, v152, s58
    s_nop 3
    s_mul_i32 s57, s57, 196608
    s_cmp_eq_u32 s58, 0
    s_cbranch_scc0 L_lsel
    s_cmp_eq_u32 s68, 2048
    s_cbranch_scc1 L_ldone
    s_mov_b32 s24, s8
    s_and_b32 s25, s9, 0xffff
    s_branch L_lsel
L_lfirst:
    s_cmp_eq_u32 s68, 8
    s_cbranch_scc1 L_lnobar
    s_barrier
    s_branch L_lbar
L_ldone:
    s_waitcnt vmcnt(0)
    s_barrier
    s_endpgm
L_lw21:
    s_waitcnt vmcnt(21)
    buffer_load_dwordx4 v17, s[24:27], s57 offen nt lds
    s_add_u32 s68, s68, 1
    s_and_b32 s58, s68, 63
    s_cmp_ge_u32 s58, 43
    s_cselect_b32 s69, -768, 0
    s_cmp_eq_u32 s58, 21
    buffer_load_dwordx4 v18, s[24:27], s57 offen offset:1024 nt lds
    s_cselect_b32 s62, 33024, 0
    v_mad_u32_u24 v17, v11, s62, v8
    v_mad_i32_i24 v22, v15, s69, v9
    v_mad_u32_u24 v18, v12, s62, v22
    s_bitcmp1_b64 s[84:85], s58
    buffer_load_dwordx4 v19, s[24:27], s57 offen offset:2048 nt lds
    s_cselect_b32 s63, 34560, s86
    s_add_u32 m0, m0, s71
    s_add_u32 s57, s57, s63
    v_add_u32 v22, s69, v10
    v_mad_u32_u24 v19, v13, s62, v22
    s_and_b32 s59, s68, 7
    s_cbranch_scc1 L_lw21
    s_branch L_lunit
L_lw22:
    s_waitcnt vmcnt(22)
    buffer_load_dwordx4 v17, s[24:27], s57 offen nt lds
    s_add_u32 s68, s68, 1
    s_and_b32 s58, s68, 63
    s_cmp_ge_u32 s58, 43
    s_cselect_b32 s69, -768, 0
    s_cmp_eq_u32 s58, 21
    buffer_load_dwordx4 v18, s[24:27], s57 offen offset:1024 nt lds
    s_cselect_b32 s62, 33024, 0
    v_mad_u32_u24 v17, v11, s62, v8
    v_mad_i32_i24 v22, v15, s69, v9
    v_mad_u32_u24 v18, v12, s62, v22
    s_bitcmp1_b64 s[84:85], s58
    buffer_load_dwordx4 v19, s[24:27], s57 offen offset:2048 nt lds
    s_cselect_b32 s63, 34560, s86
    s_add_u32 m0, m0, s71
    s_add_u32 s57, s57, s63
    v_add_u32 v22, s69, v10
    v_mad_u32_u24 v19, v13, s62, v22
    s_and_b32 s59, s68, 7
    s_cbranch_scc1 L_lw22
    s_branch L_lunit
L_lw23:
    s_waitcnt vmcnt(23)
    buffer_load_dwordx4 v17, s[24:27], s57 offen nt lds
    s_add_u32 s68, s68, 1
    s_and_b32 s58, s68, 63
    s_cmp_ge_u32 s58, 43
    s_cselect_b32 s69, -768, 0
    s_cmp_eq_u32 s58, 21
    buffer_load_dwordx4 v18, s[24:27], s57 offen offset:1024 nt lds
    s_cselect_b32 s62, 33024, 0
    v_mad_u32_u24 v17, v11, s62, v8
    v_mad_i32_i24 v22, v15, s69, v9
    v_mad_u32_u24 v18, v12, s62, v22
    s_bitcmp1_b64 s[84:85], s58
    buffer_load_dwordx4 v19, s[24:27], s57 offen offset:2048 nt lds
    s_cselect_b32 s63, 34560, s86
    s_add_u32 m0, m0, s71
    s_add_u32 s57, s57, s63
    v_add_u32 v22, s69, v10
    v_mad_u32_u24 v19, v13, s62, v22
    s_and_b32 s59, s68, 7
    s_cbranch_scc1 L_lw23
    s_branch L_lunit
L_lw24:
    s_waitcnt vmcnt(24)
    buffer_load_dwordx4 v17, s[24:27], s57 offen nt lds
    s_add_u32 s68, s68, 1
    s_and_b32 s58, s68, 63
    s_cmp_ge_u32 s58, 43
    s_cselect_b32 s69, -768, 0
    s_cmp_eq_u32 s58, 21
    buffer_load_dwordx4 v18, s[24:27], s57 offen offset:1024 nt lds
    s_cselect_b32 s62, 33024, 0
    v_mad_u32_u24 v17, v11, s62, v8
    v_mad_i32_i24 v22, v15, s69, v9
    v_mad_u32_u24 v18, v12, s62, v22
    s_bitcmp1_b64 s[84:85], s58
    buffer_load_dwordx4 v19, s[24:27], s57 offen offset:2048 nt lds
    s_cselect_b32 s63, 34560, s86
    s_add_u32 m0, m0, s71
    s_add_u32 s57, s57, s63
    v_add_u32 v22, s69, v10
    v_mad_u32_u24 v19, v13, s62, v22
    s_and_b32 s59, s68, 7
    s_cbranch_scc1 L_lw24
    s_branch L_lunit
L_lw25:
    s_waitcnt vmcnt(25)
    buffer_load_dwordx4 v17, s[24:27], s57 offen nt lds
    s_add_u32 s68, s68, 1
    s_and_b32 s58, s68, 63
    s_cmp_ge_u32 s58, 43
    s_cselect_b32 s69, -768, 0
    s_cmp_eq_u32 s58, 21
    buffer_load_dwordx4 v18, s[24:27], s57 offen offset:1024 nt lds
    s_cselect_b32 s62, 33024, 0
    v_mad_u32_u24 v17, v11, s62, v8
    v_mad_i32_i24 v22, v15, s69, v9
    v_mad_u32_u24 v18, v12, s62, v22
    s_bitcmp1_b64 s[84:85], s58
    buffer_load_dwordx4 v19, s[24:27], s57 offen offset:2048 nt lds
    s_cselect_b32 s63, 34560, s86
    s_add_u32 m0, m0, s71
    s_add_u32 s57, s57, s63
    v_add_u32 v22, s69, v10
    v_mad_u32_u24 v19, v13, s62, v22
    s_and_b32 s59, s68, 7
    s_cbranch_scc1 L_lw25
    s_branch L_lunit
L_pacer:
    s_sub_u32 s58, s72, 8
    s_cmp_lt_u32 s58, 8
    s_cbranch_scc0 L_pw
    s_getpc_b64 s[44:45]
L_pc:
    s_and_b32 s45, s45, 0xffff
    s_mov_b32 s46, L_end - L_pc
    s_mov_b32 s47, 0x20000
    v_lshlrev_b32 v9, 7, v1
    s_movk_i32 s58, 0
    buffer_load_dword v12, v9, s[44:47], s58 offen
    s_movk_i32 s58, 8192
    buffer_load_dword v13, v9, s[44:47], s58 offen
    s_movk_i32 s58, 16384
    buffer_load_dword v14, v9, s[44:47], s58 offen
    s_movk_i32 s58, 24576
    buffer_load_dword v15, v9, s[44:47], s58 offen
L_pw:
    s_waitcnt lgkmcnt(0)
    s_mov_b32 s52, s22
    s_and_b32 s53, s23, 0xffff
    s_mov_b32 s54, 16793888
    s_mov_b32 s55, 0x20000
    s_mov_b32 s71, 0
    s_add_u32 s98, s22, 16777216
    s_addc_u32 s99, s23, 0
    s_cmp_lt_u32 s72, 8
    s_cselect_b32 s61, 1, 0
    s_and_b32 s59, s72, 7
    s_mul_i32 s59, s59, 4
    s_add_u32 s59, s59, 16777216
    v_mov_b32 v8, s59
    v_mov_b32 v10, 154880
    s_memtime s[28:29]
    s_memrealtime s[96:97]
    s_mov_b32 s32, 0
    s_mov_b64 exec, 1
    s_waitcnt lgkmcnt(0)
    s_mov_b32 s33, s96
    s_waitcnt vmcnt(0)
    s_barrier
    s_mov_b32 s63, 0
L_pace:
    s_barrier
    s_mov_b32 s62, s96
    s_mov_b32 s30, s28
    s_memtime s[28:29]
    s_memrealtime s[96:97]
    s_waitcnt lgkmcnt(0)
    s_sub_u32 s58, s96, s33
    s_mul_i32 s58, s58, 373
    s_mov_b32 s33, s96
    s_sub_u32 s59, s28, s30
    s_lshl_b32 s59, s59, 4
    s_sub_i32 s58, s58, s59
    s_mul_i32 s58, s58, 80
    s_ashr_i32 s31, s58, 12
    s_cmp_eq_u32 s63, 0
    s_cbranch_scc1 L_pnext
    s_mov_b32 s58, 0
    s_sub_i32 s59, s84, s62
    s_add_i32 s60, s59, 5000
    s_cmp_lt_u32 s60, 10000
    s_cselect_b32 s59, s59, 200
    s_add_i32 s58, s58, s59
    s_sub_i32 s59, s85, s62
    s_add_i32 s60, s59, 5000
    s_cmp_lt_u32 s60, 10000
    s_cselect_b32 s59, s59, 200
    s_add_i32 s58, s58, s59
    s_sub_i32 s59, s86, s62
    s_add_i32 s60, s59, 5000
    s_cmp_lt_u32 s60, 10000
    s_cselect_b32 s59, s59, 200
    s_add_i32 s58, s58, s59
    s_sub_i32 s59, s87, s62
    s_add_i32 s60, s59, 5000
    s_cmp_lt_u32 s60, 10000
    s_cselect_b32 s59, s59, 200
    s_add_i32 s58, s58, s59
    s_sub_i32 s59, s88, s62
    s_add_i32 s60, s59, 5000
    s_cmp_lt_u32 s60, 10000
    s_cselect_b32 s59, s59, 200
    s_add_i32 s58, s58, s59
    s_sub_i32 s59, s89, s62
    s_add_i32 s60, s59, 5000
    s_cmp_lt_u32 s60, 10000
    s_cselect_b32 s59, s59, 200
    s_add_i32 s58, s58, s59
    s_sub_i32 s59, s90, s62
    s_add_i32 s60, s59, 5000
    s_cmp_lt_u32 s60, 10000
    s_cselect_b32 s59, s59, 200
    s_add_i32 s58, s58, s59
    s_sub_i32 s59, s91, s62
    s_add_i32 s60, s59, 5000
    s_cmp_lt_u32 s60, 10000
    s_cselect_b32 s59, s59, 200
    s_add_i32 s58, s58, s59
    s_min_u32 s59, s63, 12
    s_cmp_gt_i32 s58, 0
    s_cselect_b32 s63, s59, s63
    s_mul_i32 s58, s58, s63
    s_ashr_i32 s58, s58, 5
    s_mov_b32 s32, s58
L_pnext:
    s_sub_i32 s58, s31, s32
    s_add_i32 s58, s58, 4710
    s_max_i32 s58, s58, 4096
    s_min_i32 s70, s58, 6400
    v_mov_b32 v9, s70
    ds_write_b32 v10, v9
    s_and_b32 s58, s71, 768
    s_cselect_b32 s63, 0, 5
    s_cmp_ge_u32 s71, 14848
    s_cselect_b32 s63, 24, s63
    s_mul_i32 s58, s63, s61
    s_cmp_eq_u32 s58, 0
    s_cbranch_scc1 L_pnorep
    v_mov_b32 v11, s96
    buffer_store_dword v11, v8, s[52:55], s71 offen sc1
L_pnorep:
    s_barrier
    s_barrier
    s_barrier
    s_cmp_eq_u32 s63, 0
    s_cbranch_scc1 L_pnold
    s_load_dwordx8 s[84:91], s[98:99], s71
L_pnold:
    s_add_u32 s71, s71, 256
    s_cmp_lt_u32 s71, 16384
    s_cbranch_scc1 L_pace
    s_waitcnt lgkmcnt(0)
    s_mov_b64 exec, -1
    s_endpgm
L_consumer:
    v_lshrrev_b32 v3, 2, v1
    v_lshlrev_b32 v3, 3, v3
    v_and_b32 v4, 3, v1
    v_mul_u32_u24 v5, 384, v4
    v_add_u32 v153, v3, v5
    v_add_u32 v153, 155136, v153
    s_mov_b32 s64, 0x3fb8aa3b
    s_mov_b32 s65, 0x3d93cd3a
    s_mov_b32 s66, 0xffff0000
    v_bfe_u32 v36, v1, 2, 1
    v_lshl_add_u32 v36, v2, 2, v36
    v_bfe_u32 v37, v1, 3, 1
    v_lshrrev_b32 v38, 4, v1
    v_lshl_add_u32 v38, v38, 2, v4
    v_lshlrev_b32 v38, 3, v38
    v_add_u32 v38, 73728, v38
    s_movk_i32 s58, 384
    v_add_u32 v3, 0, v36
    v_cmp_le_u32 vcc, 43, v3
    v_add_u32 v5, 43, v3
    v_mov_b32 v6, 42
    v_cndmask_b32 v17, v3, v5, vcc
    v_cmp_le_u32 vcc, 86, v3
    v_add_u32 v5, 43, v17
    s_nop 0
    v_cndmask_b32 v17, v17, v5, vcc
    v_cndmask_b32 v6, 43, v6, vcc
    v_mad_u32_u24 v17, v6, v37, v17
    v_lshrrev_b32 v17, 6, v17
    v_mad_u32_u24 v17, v17, s58, v38
    v_add_u32 v3, 2, v36
    v_cmp_le_u32 vcc, 43, v3
    v_add_u32 v5, 43, v3
    v_mov_b32 v6, 42
    v_cndmask_b32 v18, v3, v5, vcc
    v_cmp_le_u32 vcc, 86, v3
    v_add_u32 v5, 43, v18
    s_nop 0
    v_cndmask_b32 v18, v18, v5, vcc
    v_cndmask_b32 v6, 43, v6, vcc
    v_mad_u32_u24 v18, v6, v37, v18
    v_lshrrev_b32 v18, 6, v18
    v_mad_u32_u24 v18, v18, s58, v38
    v_add_u32 v3, 16, v36
    v_cmp_le_u32 vcc, 43, v3
    v_add_u32 v5, 43, v3
    v_mov_b32 v6, 42
    v_cndmask_b32 v19, v3, v5, vcc
    v_cmp_le_u32 vcc, 86, v3
    v_add_u32 v5, 43, v19
    s_nop 0
    v_cndmask_b32 v19, v19, v5, vcc
    v_cndmask_b32 v6, 43, v6, vcc
    v_mad_u32_u24 v19, v6, v37, v19
    v_lshrrev_b32 v19, 6, v19
    v_mad_u32_u24 v19, v19, s58, v38
    v_add_u32 v3, 18, v36
    v_cmp_le_u32 vcc, 43, v3
    v_add_u32 v5, 43, v3
    v_mov_b32 v6, 42
    v_cndmask_b32 v20, v3, v5, vcc
    v_cmp_le_u32 vcc, 86, v3
    v_add_u32 v5, 43, v20
    s_nop 0
    v_cndmask_b32 v20, v20, v5, vcc
    v_cndmask_b32 v6, 43, v6, vcc
    v_mad_u32_u24 v20, v6, v37, v20
    v_lshrrev_b32 v20, 6, v20
    v_mad_u32_u24 v20, v20, s58, v38
    v_add_u32 v3, 32, v36
    v_cmp_le_u32 vcc, 43, v3
    v_add_u32 v5, 43, v3
    v_mov_b32 v6, 42
    v_cndmask_b32 v21, v3, v5, vcc
    v_cmp_le_u32 vcc, 86, v3
    v_add_u32 v5, 43, v21
    s_nop 0
    v_cndmask_b32 v21, v21, v5, vcc
    v_cndmask_b32 v6, 43, v6, vcc
    v_mad_u32_u24 v21, v6, v37, v21
    v_lshrrev_b32 v21, 6, v21
    v_mad_u32_u24 v21, v21, s58, v38
    v_add_u32 v3, 34, v36
    v_cmp_le_u32 vcc, 43, v3
    v_add_u32 v5, 43, v3
    v_mov_b32 v6, 42
    v_cndmask_b32 v22, v3, v5, vcc
    v_cmp_le_u32 vcc, 86, v3
    v_add_u32 v5, 43, v22
    s_nop 0
    v_cndmask_b32 v22, v22, v5, vcc
    v_cndmask_b32 v6, 43, v6, vcc
    v_mad_u32_u24 v22, v6, v37, v22
    v_lshrrev_b32 v22, 6, v22
    v_mad_u32_u24 v22, v22, s58, v38
    v_add_u32 v3, 48, v36
    v_cmp_le_u32 vcc, 43, v3
    v_add_u32 v5, 43, v3
    v_mov_b32 v6, 42
    v_cndmask_b32 v23, v3, v5, vcc
    v_cmp_le_u32 vcc, 86, v3
    v_add_u32 v5, 43, v23
    s_nop 0
    v_cndmask_b32 v23, v23, v5, vcc
    v_cndmask_b32 v6, 43, v6, vcc
    v_mad_u32_u24 v23, v6, v37, v23
    v_lshrrev_b32 v23, 6, v23
    v_mad_u32_u24 v23, v23, s58, v38
    v_add_u32 v3, 50, v36
    v_cmp_le_u32 vcc, 43, v3
    v_add_u32 v5, 43, v3
    v_mov_b32 v6, 42
    v_cndmask_b32 v24, v3, v5, vcc
    v_cmp_le_u32 vcc, 86, v3
    v_add_u32 v5, 43, v24
    s_nop 0
    v_cndmask_b32 v24, v24, v5, vcc
    v_cndmask_b32 v6, 43, v6, vcc
    v_mad_u32_u24 v24, v6, v37, v24
    v_lshrrev_b32 v24, 6, v24
    v_mad_u32_u24 v24, v24, s58, v38
    v_add_u32 v3, 64, v36
    v_cmp_le_u32 vcc, 43, v3
    v_add_u32 v5, 43, v3
    v_mov_b32 v6, 42
    v_cndmask_b32 v25, v3, v5, vcc
    v_cmp_le_u32 vcc, 86, v3
    v_add_u32 v5, 43, v25
    s_nop 0
    v_cndmask_b32 v25, v25, v5, vcc
    v_cndmask_b32 v6, 43, v6, vcc
    v_mad_u32_u24 v25, v6, v37, v25
    v_lshrrev_b32 v25, 6, v25
    v_mad_u32_u24 v25, v25, s58, v38
    v_add_u32 v3, 66, v36
    v_cmp_le_u32 vcc, 43, v3
    v_add_u32 v5, 43, v3
    v_mov_b32 v6, 42
    v_cndmask_b32 v26, v3, v5, vcc
    v_cmp_le_u32 vcc, 86, v3
    v_add_u32 v5, 43, v26
    s_nop 0
    v_cndmask_b32 v26, v26, v5, vcc
    v_cndmask_b32 v6, 43, v6, vcc
    v_mad_u32_u24 v26, v6, v37, v26
    v_lshrrev_b32 v26, 6, v26
    v_mad_u32_u24 v26, v26, s58, v38
    v_add_u32 v3, 80, v36
    v_cmp_le_u32 vcc, 43, v3
    v_add_u32 v5, 43, v3
    v_mov_b32 v6, 42
    v_cndmask_b32 v27, v3, v5, vcc
    v_cmp_le_u32 vcc, 86, v3
    v_add_u32 v5, 43, v27
    s_nop 0
    v_cndmask_b32 v27, v27, v5, vcc
    v_cndmask_b32 v6, 43, v6, vcc
    v_mad_u32_u24 v27, v6, v37, v27
    v_lshrrev_b32 v27, 6, v27
    v_mad_u32_u24 v27, v27, s58, v38
    v_add_u32 v3, 82, v36
    v_cmp_le_u32 vcc, 43, v3
    v_add_u32 v5, 43, v3
    v_mov_b32 v6, 42
    v_cndmask_b32 v28, v3, v5, vcc
    v_cmp_le_u32 vcc, 86, v3
    v_add_u32 v5, 43, v28
    s_nop 0
    v_cndmask_b32 v28, v28, v5, vcc
    v_cndmask_b32 v6, 43, v6, vcc
    v_mad_u32_u24 v28, v6, v37, v28
    v_lshrrev_b32 v28, 6, v28
    v_mad_u32_u24 v28, v28, s58, v38
    v_add_u32 v3, 96, v36
    v_cmp_le_u32 vcc, 43, v3
    v_add_u32 v5, 43, v3
    v_mov_b32 v6, 42
    v_cndmask_b32 v29, v3, v5, vcc
    v_cmp_le_u32 vcc, 86, v3
    v_add_u32 v5, 43, v29
    s_nop 0
    v_cndmask_b32 v29, v29, v5, vcc
    v_cndmask_b32 v6, 43, v6, vcc
    v_mad_u32_u24 v29, v6, v37, v29
    v_lshrrev_b32 v29, 6, v29
    v_mad_u32_u24 v29, v29, s58, v38
    v_add_u32 v3, 98, v36
    v_cmp_le_u32 vcc, 43, v3
    v_add_u32 v5, 43, v3
    v_mov_b32 v6, 42
    v_cndmask_b32 v30, v3, v5, vcc
    v_cmp_le_u32 vcc, 86, v3
    v_add_u32 v5, 43, v30
    s_nop 0
    v_cndmask_b32 v30, v30, v5, vcc
    v_cndmask_b32 v6, 43, v6, vcc
    v_mad_u32_u24 v30, v6, v37, v30
    v_lshrrev_b32 v30, 6, v30
    v_mad_u32_u24 v30, v30, s58, v38
    v_add_u32 v3, 112, v36
    v_cmp_le_u32 vcc, 43, v3
    v_add_u32 v5, 43, v3
    v_mov_b32 v6, 42
    v_cndmask_b32 v31, v3, v5, vcc
    v_cmp_le_u32 vcc, 86, v3
    v_add_u32 v5, 43, v31
    s_nop 0
    v_cndmask_b32 v31, v31, v5, vcc
    v_cndmask_b32 v6, 43, v6, vcc
    v_mad_u32_u24 v31, v6, v37, v31
    v_lshrrev_b32 v31, 6, v31
    v_mad_u32_u24 v31, v31, s58, v38
    v_add_u32 v3, 114, v36
    v_cmp_le_u32 vcc, 43, v3
    v_add_u32 v5, 43, v3
    v_mov_b32 v6, 42
    v_cndmask_b32 v32, v3, v5, vcc
    v_cmp_le_u32 vcc, 86, v3
    v_add_u32 v5, 43, v32
    s_nop 0
    v_cndmask_b32 v32, v32, v5, vcc
    v_cndmask_b32 v6, 43, v6, vcc
    v_mad_u32_u24 v32, v6, v37, v32
    v_lshrrev_b32 v32, 6, v32
    v_mad_u32_u24 v32, v32, s58, v38
    v_bfe_u32 v36, v1, 4, 1
    v_lshl_add_u32 v36, v2, 2, v36
    v_bfe_u32 v3, v1, 2, 2
    v_lshl_add_u32 v36, v3, 4, v36
    v_lshrrev_b32 v37, 5, v1
    s_mov_b32 s58, 125952
    v_add_u32 v3, 0, v36
    v_cmp_le_u32 vcc, 43, v3
    v_add_u32 v5, 43, v3
    v_mov_b32 v6, 42
    v_cndmask_b32 v7, v3, v5, vcc
    v_cmp_le_u32 vcc, 86, v3
    v_add_u32 v5, 43, v7
    s_nop 0
    v_cndmask_b32 v7, v7, v5, vcc
    v_cndmask_b32 v6, 43, v6, vcc
    v_mad_u32_u24 v7, v6, v37, v7
    v_lshl_add_u32 v7, v7, 1, s58
    v_add_u32 v3, 2, v36
    v_cmp_le_u32 vcc, 43, v3
    v_add_u32 v5, 43, v3
    v_mov_b32 v6, 42
    v_cndmask_b32 v8, v3, v5, vcc
    v_cmp_le_u32 vcc, 86, v3
    v_add_u32 v5, 43, v8
    s_nop 0
    v_cndmask_b32 v8, v8, v5, vcc
    v_cndmask_b32 v6, 43, v6, vcc
    v_mad_u32_u24 v8, v6, v37, v8
    v_lshl_add_u32 v8, v8, 1, s58
    v_add_u32 v3, 64, v36
    v_cmp_le_u32 vcc, 43, v3
    v_add_u32 v5, 43, v3
    v_mov_b32 v6, 42
    v_cndmask_b32 v9, v3, v5, vcc
    v_cmp_le_u32 vcc, 86, v3
    v_add_u32 v5, 43, v9
    s_nop 0
    v_cndmask_b32 v9, v9, v5, vcc
    v_cndmask_b32 v6, 43, v6, vcc
    v_mad_u32_u24 v9, v6, v37, v9
    v_lshl_add_u32 v9, v9, 1, s58
    v_add_u32 v3, 66, v36
    v_cmp_le_u32 vcc, 43, v3
    v_add_u32 v5, 43, v3
    v_mov_b32 v6, 42
    v_cndmask_b32 v10, v3, v5, vcc
    v_cmp_le_u32 vcc, 86, v3
    v_add_u32 v5, 43, v10
    s_nop 0
    v_cndmask_b32 v10, v10, v5, vcc
    v_cndmask_b32 v6, 43, v6, vcc
    v_mad_u32_u24 v10, v6, v37, v10
    v_lshl_add_u32 v10, v10, 1, s58
    v_lshlrev_b32 v11, 2, v1
    v_lshl_add_u32 v11, v2, 9, v11
    v_add_u32 v11, 73728, v11
    v_bfe_u32 v3, v1, 2, 2
    v_lshrrev_b32 v4, 4, v1
    v_and_b32 v5, 3, v1
    v_lshl_add_u32 v4, v4, 2, v5
    v_lshl_add_u32 v3, v2, 3, v3
    v_mul_u32_u24 v3, 768, v3
    v_lshl_add_u32 v12, v4, 4, v3
    v_and_b32 v3, 3, v1
    v_lshl_add_u32 v154, v3, 2, v2
    v_lshlrev_b32 v154, 2, v154
    v_add_u32 v154, 154944, v154
    v_mov_b32 v14, 0xff800000
    s_mov_b32 s61, 0
    s_mov_b32 s62, 0
    s_movk_i32 s63, 3072
    s_waitcnt vmcnt(0) lgkmcnt(0)
    s_barrier
    ds_read_b64 v[164:165], v153 offset:0
    ds_read_b64 v[166:167], v153 offset:128
    ds_read_b64 v[168:169], v153 offset:256
    v_add_u32 v153, 1536, v153
    v_add_u32 v33, s63, v17
    v_add_u32 v34, s63, v18
    ds_read_b64 v[108:109], v33 offset:0
    ds_read_b64 v[110:111], v33 offset:1536
    ds_read_b64 v[112:113], v33 offset:128
    ds_read_b64 v[114:115], v33 offset:1664
    ds_read_b64 v[116:117], v33 offset:256
    ds_read_b64 v[118:119], v33 offset:1792
    ds_read_b64 v[120:121], v34 offset:0
    ds_read_b64 v[122:123], v34 offset:1536
    ds_read_b64 v[124:125], v34 offset:128
    ds_read_b64 v[126:127], v34 offset:1664
    ds_read_b64 v[128:129], v34 offset:256
    ds_read_b64 v[130:131], v34 offset:1792
    s_waitcnt lgkmcnt(0)
    v_lshlrev_b32 v60, 16, v108
    v_and_b32 v61, s66, v108
    v_lshlrev_b32 v62, 16, v109
    v_and_b32 v63, s66, v109
    v_lshlrev_b32 v84, 16, v110
    v_and_b32 v85, s66, v110
    v_lshlrev_b32 v86, 16, v111
    v_and_b32 v87, s66, v111
    v_lshlrev_b32 v64, 16, v112
    v_and_b32 v65, s66, v112
    v_lshlrev_b32 v66, 16, v113
    v_and_b32 v67, s66, v113
    v_lshlrev_b32 v88, 16, v114
    v_and_b32 v89, s66, v114
    v_lshlrev_b32 v90, 16, v115
    v_and_b32 v91, s66, v115
    v_lshlrev_b32 v68, 16, v116
    v_and_b32 v69, s66, v116
    v_lshlrev_b32 v70, 16, v117
    v_and_b32 v71, s66, v117
    v_lshlrev_b32 v92, 16, v118
    v_and_b32 v93, s66, v118
    v_lshlrev_b32 v94, 16, v119
    v_and_b32 v95, s66, v119
    v_lshlrev_b32 v72, 16, v120
    v_and_b32 v73, s66, v120
    v_lshlrev_b32 v74, 16, v121
    v_and_b32 v75, s66, v121
    v_lshlrev_b32 v96, 16, v122
    v_and_b32 v97, s66, v122
    v_lshlrev_b32 v98, 16, v123
    v_and_b32 v99, s66, v123
    v_lshlrev_b32 v76, 16, v124
    v_and_b32 v77, s66, v124
    v_lshlrev_b32 v78, 16, v125
    v_and_b32 v79, s66, v125
    v_lshlrev_b32 v100, 16, v126
    v_and_b32 v101, s66, v126
    v_lshlrev_b32 v102, 16, v127
    v_and_b32 v103, s66, v127
    v_lshlrev_b32 v80, 16, v128
    v_and_b32 v81, s66, v128
    v_lshlrev_b32 v82, 16, v129
    v_and_b32 v83, s66, v129
    v_lshlrev_b32 v104, 16, v130
    v_and_b32 v105, s66, v130
    v_lshlrev_b32 v106, 16, v131
    v_and_b32 v107, s66, v131
L_kblk:
    v_add_u32 v13, s62, v12
    s_add_u32 s62, s62, 24576
    s_cmp_eq_u32 s62, 73728
    s_cselect_b32 s62, 0, s62
    s_barrier
    ds_read_b128 v[36:39], v13 offset:0
    ds_read_b128 v[40:43], v13 offset:256
    ds_read_b128 v[44:47], v13 offset:512
    ds_read_b128 v[48:51], v13 offset:3072
    ds_read_b128 v[52:55], v13 offset:3328
    ds_read_b128 v[56:59], v13 offset:3584
    s_waitcnt lgkmcnt(3)
    v_cvt_f32_i32 v36, v36
    v_cvt_f32_i32 v37, v37
    v_cvt_f32_i32 v38, v38
    v_cvt_f32_i32 v39, v39
    v_cvt_f32_i32 v40, v40
    v_cvt_f32_i32 v41, v41
    v_cvt_f32_i32 v42, v42
    v_cvt_f32_i32 v43, v43
    v_cvt_f32_i32 v44, v44
    v_cvt_f32_i32 v45, v45
    v_cvt_f32_i32 v46, v46
    v_cvt_f32_i32 v47, v47
    v_sub_f32 v36, v36, v60
    v_sub_f32 v37, v37, v61
    v_sub_f32 v38, v38, v62
    v_sub_f32 v39, v39, v63
    v_sub_f32 v40, v40, v64
    v_sub_f32 v41, v41, v65
    v_sub_f32 v42, v42, v66
    v_sub_f32 v43, v43, v67
    v_sub_f32 v44, v44, v68
    v_sub_f32 v45, v45, v69
    v_sub_f32 v46, v46, v70
    v_sub_f32 v47, v47, v71
    v_cvt_pk_bf16_f32 v36, 0, v36
    v_cvt_pk_bf16_f32 v37, 0, v37
    v_cvt_pk_bf16_f32 v38, 0, v38
    v_cvt_pk_bf16_f32 v39, 0, v39
    v_cvt_pk_bf16_f32 v40, 0, v40
    v_cvt_pk_bf16_f32 v41, 0, v41
    v_cvt_pk_bf16_f32 v42, 0, v42
    v_cvt_pk_bf16_f32 v43, 0, v43
    v_cvt_pk_bf16_f32 v44, 0, v44
    v_cvt_pk_bf16_f32 v45, 0, v45
    v_cvt_pk_bf16_f32 v46, 0, v46
    v_cvt_pk_bf16_f32 v47, 0, v47
    v_mul_f32 v36, v36, v84
    v_mul_f32 v37, v37, v85
    v_mul_f32 v38, v38, v86
    v_mul_f32 v39, v39, v87
    v_mul_f32 v40, v40, v88
    v_mul_f32 v41, v41, v89
    v_mul_f32 v42, v42, v90
    v_mul_f32 v43, v43, v91
    v_mul_f32 v44, v44, v92
    v_mul_f32 v45, v45, v93
    v_mul_f32 v46, v46, v94
    v_mul_f32 v47, v47, v95
    v_cvt_pk_bf16_f32 v132, v36, v37
    v_cvt_pk_bf16_f32 v133, v38, v39
    v_cvt_pk_bf16_f32 v134, v40, v41
    v_cvt_pk_bf16_f32 v135, v42, v43
    v_cvt_pk_bf16_f32 v136, v44, v45
    v_cvt_pk_bf16_f32 v137, v46, v47
    v_mfma_f32_16x16x16_bf16 v[144:147], v[132:133], v[164:165], 0
    v_mfma_f32_16x16x16_bf16 v[144:147], v[134:135], v[166:167], v[144:147]
    v_mfma_f32_16x16x16_bf16 v[144:147], v[136:137], v[168:169], v[144:147]
    s_waitcnt lgkmcnt(0)
    v_cvt_f32_i32 v48, v48
    v_cvt_f32_i32 v49, v49
    v_cvt_f32_i32 v50, v50
    v_cvt_f32_i32 v51, v51
    v_cvt_f32_i32 v52, v52
    v_cvt_f32_i32 v53, v53
    v_cvt_f32_i32 v54, v54
    v_cvt_f32_i32 v55, v55
    v_cvt_f32_i32 v56, v56
    v_cvt_f32_i32 v57, v57
    v_cvt_f32_i32 v58, v58
    v_cvt_f32_i32 v59, v59
    v_sub_f32 v48, v48, v72
    v_sub_f32 v49, v49, v73
    v_sub_f32 v50, v50, v74
    v_sub_f32 v51, v51, v75
    v_sub_f32 v52, v52, v76
    v_sub_f32 v53, v53, v77
    v_sub_f32 v54, v54, v78
    v_sub_f32 v55, v55, v79
    v_sub_f32 v56, v56, v80
    v_sub_f32 v57, v57, v81
    v_sub_f32 v58, v58, v82
    v_sub_f32 v59, v59, v83
    v_cvt_pk_bf16_f32 v48, 0, v48
    v_cvt_pk_bf16_f32 v49, 0, v49
    v_cvt_pk_bf16_f32 v50, 0, v50
    v_cvt_pk_bf16_f32 v51, 0, v51
    v_cvt_pk_bf16_f32 v52, 0, v52
    v_cvt_pk_bf16_f32 v53, 0, v53
    v_cvt_pk_bf16_f32 v54, 0, v54
    v_cvt_pk_bf16_f32 v55, 0, v55
    v_cvt_pk_bf16_f32 v56, 0, v56
    v_cvt_pk_bf16_f32 v57, 0, v57
    v_cvt_pk_bf16_f32 v58, 0, v58
    v_cvt_pk_bf16_f32 v59, 0, v59
    v_mul_f32 v48, v48, v96
    v_mul_f32 v49, v49, v97
    v_mul_f32 v50, v50, v98
    v_mul_f32 v51, v51, v99
    v_mul_f32 v52, v52, v100
    v_mul_f32 v53, v53, v101
    v_mul_f32 v54, v54, v102
    v_mul_f32 v55, v55, v103
    v_mul_f32 v56, v56, v104
    v_mul_f32 v57, v57, v105
    v_mul_f32 v58, v58, v106
    v_mul_f32 v59, v59, v107
    v_cvt_pk_bf16_f32 v138, v48, v49
    v_cvt_pk_bf16_f32 v139, v50, v51
    v_add_f32_dpp v3, v145, v144 row_ror:12 row_mask:0xf bank_mask:0xf
    v_cvt_pk_bf16_f32 v140, v52, v53
    v_cvt_pk_bf16_f32 v141, v54, v55
    v_add_f32_dpp v3, v146, v3 row_ror:8 row_mask:0xf bank_mask:0xf
    v_cvt_pk_bf16_f32 v142, v56, v57
    v_cvt_pk_bf16_f32 v143, v58, v59
    v_add_f32_dpp v15, v147, v3 row_ror:4 row_mask:0xf bank_mask:0x1
    v_mfma_f32_16x16x16_bf16 v[148:151], v[138:139], v[164:165], 0
    v_mfma_f32_16x16x16_bf16 v[148:151], v[140:141], v[166:167], v[148:151]
    v_mfma_f32_16x16x16_bf16 v[148:151], v[142:143], v[168:169], v[148:151]
    v_add_u32 v33, s63, v19
    v_add_u32 v34, s63, v20
    ds_read_b64 v[108:109], v33 offset:0
    ds_read_b64 v[110:111], v33 offset:1536
    ds_read_b64 v[112:113], v33 offset:128
    ds_read_b64 v[114:115], v33 offset:1664
    ds_read_b64 v[116:117], v33 offset:256
    ds_read_b64 v[118:119], v33 offset:1792
    ds_read_b64 v[120:121], v34 offset:0
    v_add_f32_dpp v4, v149, v148 row_ror:12 row_mask:0xf bank_mask:0xf
    ds_read_b64 v[122:123], v34 offset:1536
    ds_read_b64 v[124:125], v34 offset:128
    v_add_f32_dpp v4, v150, v4 row_ror:8 row_mask:0xf bank_mask:0xf
    ds_read_b64 v[126:127], v34 offset:1664
    ds_read_b64 v[128:129], v34 offset:256
    ds_read_b64 v[130:131], v34 offset:1792
    v_add_f32_dpp v16, v151, v4 row_ror:4 row_mask:0xf bank_mask:0x1
    s_waitcnt lgkmcnt(0)
    v_lshlrev_b32 v60, 16, v108
    v_and_b32 v61, s66, v108
    v_lshlrev_b32 v62, 16, v109
    v_and_b32 v63, s66, v109
    v_lshlrev_b32 v84, 16, v110
    v_and_b32 v85, s66, v110
    v_lshlrev_b32 v86, 16, v111
    v_and_b32 v87, s66, v111
    v_lshlrev_b32 v64, 16, v112
    v_and_b32 v65, s66, v112
    v_lshlrev_b32 v66, 16, v113
    v_and_b32 v67, s66, v113
    v_lshlrev_b32 v88, 16, v114
    v_and_b32 v89, s66, v114
    v_lshlrev_b32 v90, 16, v115
    v_and_b32 v91, s66, v115
    v_lshlrev_b32 v68, 16, v116
    v_and_b32 v69, s66, v116
    v_lshlrev_b32 v70, 16, v117
    v_and_b32 v71, s66, v117
    v_lshlrev_b32 v92, 16, v118
    v_and_b32 v93, s66, v118
    v_lshlrev_b32 v94, 16, v119
    v_and_b32 v95, s66, v119
    v_lshlrev_b32 v72, 16, v120
    v_and_b32 v73, s66, v120
    v_lshlrev_b32 v74, 16, v121
    v_and_b32 v75, s66, v121
    v_lshlrev_b32 v96, 16, v122
    v_and_b32 v97, s66, v122
    v_lshlrev_b32 v98, 16, v123
    v_and_b32 v99, s66, v123
    v_lshlrev_b32 v76, 16, v124
    v_and_b32 v77, s66, v124
    v_lshlrev_b32 v78, 16, v125
    v_and_b32 v79, s66, v125
    v_lshlrev_b32 v100, 16, v126
    v_and_b32 v101, s66, v126
    v_lshlrev_b32 v102, 16, v127
    v_and_b32 v103, s66, v127
    v_lshlrev_b32 v80, 16, v128
    v_and_b32 v81, s66, v128
    v_lshlrev_b32 v82, 16, v129
    v_and_b32 v83, s66, v129
    v_lshlrev_b32 v104, 16, v130
    v_and_b32 v105, s66, v130
    v_lshlrev_b32 v106, 16, v131
    v_and_b32 v107, s66, v131
    v_add_u32 v13, s62, v12
    s_add_u32 s62, s62, 24576
    s_cmp_eq_u32 s62, 73728
    s_cselect_b32 s62, 0, s62
    s_barrier
    ds_read_b128 v[36:39], v13 offset:0
    ds_read_b128 v[40:43], v13 offset:256
    ds_read_b128 v[44:47], v13 offset:512
    ds_read_b128 v[48:51], v13 offset:3072
    ds_read_b128 v[52:55], v13 offset:3328
    ds_read_b128 v[56:59], v13 offset:3584
    s_waitcnt lgkmcnt(3)
    v_cvt_f32_i32 v36, v36
    v_cvt_f32_i32 v37, v37
    v_cvt_f32_i32 v38, v38
    v_cvt_f32_i32 v39, v39
    v_cvt_f32_i32 v40, v40
    v_cvt_f32_i32 v41, v41
    v_cvt_f32_i32 v42, v42
    v_cvt_f32_i32 v43, v43
    v_cvt_f32_i32 v44, v44
    v_cvt_f32_i32 v45, v45
    v_cvt_f32_i32 v46, v46
    v_cvt_f32_i32 v47, v47
    v_sub_f32 v36, v36, v60
    v_sub_f32 v37, v37, v61
    v_sub_f32 v38, v38, v62
    v_sub_f32 v39, v39, v63
    v_sub_f32 v40, v40, v64
    v_sub_f32 v41, v41, v65
    v_sub_f32 v42, v42, v66
    v_sub_f32 v43, v43, v67
    v_sub_f32 v44, v44, v68
    v_sub_f32 v45, v45, v69
    v_sub_f32 v46, v46, v70
    v_sub_f32 v47, v47, v71
    v_cvt_pk_bf16_f32 v36, 0, v36
    v_cvt_pk_bf16_f32 v37, 0, v37
    v_cvt_pk_bf16_f32 v38, 0, v38
    v_cvt_pk_bf16_f32 v39, 0, v39
    v_cvt_pk_bf16_f32 v40, 0, v40
    v_cvt_pk_bf16_f32 v41, 0, v41
    v_cvt_pk_bf16_f32 v42, 0, v42
    v_cvt_pk_bf16_f32 v43, 0, v43
    v_cvt_pk_bf16_f32 v44, 0, v44
    v_cvt_pk_bf16_f32 v45, 0, v45
    v_cvt_pk_bf16_f32 v46, 0, v46
    v_cvt_pk_bf16_f32 v47, 0, v47
    v_mul_f32 v36, v36, v84
    v_mul_f32 v37, v37, v85
    v_mul_f32 v38, v38, v86
    v_mul_f32 v39, v39, v87
    v_mul_f32 v40, v40, v88
    v_mul_f32 v41, v41, v89
    v_mul_f32 v42, v42, v90
    v_mul_f32 v43, v43, v91
    v_mul_f32 v44, v44, v92
    v_mul_f32 v45, v45, v93
    v_mul_f32 v46, v46, v94
    v_mul_f32 v47, v47, v95
    v_cvt_pk_bf16_f32 v132, v36, v37
    v_cvt_pk_bf16_f32 v133, v38, v39
    v_cvt_pk_bf16_f32 v134, v40, v41
    v_cvt_pk_bf16_f32 v135, v42, v43
    v_cvt_pk_bf16_f32 v136, v44, v45
    v_cvt_pk_bf16_f32 v137, v46, v47
    v_mfma_f32_16x16x16_bf16 v[144:147], v[132:133], v[164:165], 0
    v_mfma_f32_16x16x16_bf16 v[144:147], v[134:135], v[166:167], v[144:147]
    v_mfma_f32_16x16x16_bf16 v[144:147], v[136:137], v[168:169], v[144:147]
    s_waitcnt lgkmcnt(0)
    v_cvt_f32_i32 v48, v48
    v_cvt_f32_i32 v49, v49
    v_cvt_f32_i32 v50, v50
    v_cvt_f32_i32 v51, v51
    v_cvt_f32_i32 v52, v52
    v_cvt_f32_i32 v53, v53
    v_cvt_f32_i32 v54, v54
    v_cvt_f32_i32 v55, v55
    v_cvt_f32_i32 v56, v56
    v_cvt_f32_i32 v57, v57
    v_cvt_f32_i32 v58, v58
    v_cvt_f32_i32 v59, v59
    v_sub_f32 v48, v48, v72
    v_sub_f32 v49, v49, v73
    v_sub_f32 v50, v50, v74
    v_sub_f32 v51, v51, v75
    v_sub_f32 v52, v52, v76
    v_sub_f32 v53, v53, v77
    v_sub_f32 v54, v54, v78
    v_sub_f32 v55, v55, v79
    v_sub_f32 v56, v56, v80
    v_sub_f32 v57, v57, v81
    v_sub_f32 v58, v58, v82
    v_sub_f32 v59, v59, v83
    v_cvt_pk_bf16_f32 v48, 0, v48
    v_cvt_pk_bf16_f32 v49, 0, v49
    v_cvt_pk_bf16_f32 v50, 0, v50
    v_cvt_pk_bf16_f32 v51, 0, v51
    v_cvt_pk_bf16_f32 v52, 0, v52
    v_cvt_pk_bf16_f32 v53, 0, v53
    v_cvt_pk_bf16_f32 v54, 0, v54
    v_cvt_pk_bf16_f32 v55, 0, v55
    v_cvt_pk_bf16_f32 v56, 0, v56
    v_cvt_pk_bf16_f32 v57, 0, v57
    v_cvt_pk_bf16_f32 v58, 0, v58
    v_cvt_pk_bf16_f32 v59, 0, v59
    v_mul_f32 v48, v48, v96
    v_mul_f32 v49, v49, v97
    v_mul_f32 v50, v50, v98
    v_mul_f32 v51, v51, v99
    v_mul_f32 v52, v52, v100
    v_mul_f32 v53, v53, v101
    v_mul_f32 v54, v54, v102
    v_mul_f32 v55, v55, v103
    v_mul_f32 v56, v56, v104
    v_mul_f32 v57, v57, v105
    v_mul_f32 v58, v58, v106
    v_mul_f32 v59, v59, v107
    v_cvt_pk_bf16_f32 v138, v48, v49
    v_cvt_pk_bf16_f32 v139, v50, v51
    v_add_f32_dpp v3, v146, v145 row_ror:12 row_mask:0xf bank_mask:0xf
    v_cvt_pk_bf16_f32 v140, v52, v53
    v_cvt_pk_bf16_f32 v141, v54, v55
    v_add_f32_dpp v3, v147, v3 row_ror:8 row_mask:0xf bank_mask:0xf
    v_cvt_pk_bf16_f32 v142, v56, v57
    v_cvt_pk_bf16_f32 v143, v58, v59
    v_add_f32_dpp v15, v144, v3 row_ror:4 row_mask:0xf bank_mask:0x2
    v_mfma_f32_16x16x16_bf16 v[148:151], v[138:139], v[164:165], 0
    v_mfma_f32_16x16x16_bf16 v[148:151], v[140:141], v[166:167], v[148:151]
    v_mfma_f32_16x16x16_bf16 v[148:151], v[142:143], v[168:169], v[148:151]
    v_add_u32 v33, s63, v21
    v_add_u32 v34, s63, v22
    ds_read_b64 v[108:109], v33 offset:0
    ds_read_b64 v[110:111], v33 offset:1536
    ds_read_b64 v[112:113], v33 offset:128
    ds_read_b64 v[114:115], v33 offset:1664
    ds_read_b64 v[116:117], v33 offset:256
    ds_read_b64 v[118:119], v33 offset:1792
    ds_read_b64 v[120:121], v34 offset:0
    v_add_f32_dpp v4, v150, v149 row_ror:12 row_mask:0xf bank_mask:0xf
    ds_read_b64 v[122:123], v34 offset:1536
    ds_read_b64 v[124:125], v34 offset:128
    v_add_f32_dpp v4, v151, v4 row_ror:8 row_mask:0xf bank_mask:0xf
    ds_read_b64 v[126:127], v34 offset:1664
    ds_read_b64 v[128:129], v34 offset:256
    ds_read_b64 v[130:131], v34 offset:1792
    v_add_f32_dpp v16, v148, v4 row_ror:4 row_mask:0xf bank_mask:0x2
    s_waitcnt lgkmcnt(0)
    v_lshlrev_b32 v60, 16, v108
    v_and_b32 v61, s66, v108
    v_lshlrev_b32 v62, 16, v109
    v_and_b32 v63, s66, v109
    v_lshlrev_b32 v84, 16, v110
    v_and_b32 v85, s66, v110
    v_lshlrev_b32 v86, 16, v111
    v_and_b32 v87, s66, v111
    v_lshlrev_b32 v64, 16, v112
    v_and_b32 v65, s66, v112
    v_lshlrev_b32 v66, 16, v113
    v_and_b32 v67, s66, v113
    v_lshlrev_b32 v88, 16, v114
    v_and_b32 v89, s66, v114
    v_lshlrev_b32 v90, 16, v115
    v_and_b32 v91, s66, v115
    v_lshlrev_b32 v68, 16, v116
    v_and_b32 v69, s66, v116
    v_lshlrev_b32 v70, 16, v117
    v_and_b32 v71, s66, v117
    v_lshlrev_b32 v92, 16, v118
    v_and_b32 v93, s66, v118
    v_lshlrev_b32 v94, 16, v119
    v_and_b32 v95, s66, v119
    v_lshlrev_b32 v72, 16, v120
    v_and_b32 v73, s66, v120
    v_lshlrev_b32 v74, 16, v121
    v_and_b32 v75, s66, v121
    v_lshlrev_b32 v96, 16, v122
    v_and_b32 v97, s66, v122
    v_lshlrev_b32 v98, 16, v123
    v_and_b32 v99, s66, v123
    v_lshlrev_b32 v76, 16, v124
    v_and_b32 v77, s66, v124
    v_lshlrev_b32 v78, 16, v125
    v_and_b32 v79, s66, v125
    v_lshlrev_b32 v100, 16, v126
    v_and_b32 v101, s66, v126
    v_lshlrev_b32 v102, 16, v127
    v_and_b32 v103, s66, v127
    v_lshlrev_b32 v80, 16, v128
    v_and_b32 v81, s66, v128
    v_lshlrev_b32 v82, 16, v129
    v_and_b32 v83, s66, v129
    v_lshlrev_b32 v104, 16, v130
    v_and_b32 v105, s66, v130
    v_lshlrev_b32 v106, 16, v131
    v_and_b32 v107, s66, v131
    v_add_u32 v13, s62, v12
    s_add_u32 s62, s62, 24576
    s_cmp_eq_u32 s62, 73728
    s_cselect_b32 s62, 0, s62
    s_barrier
    ds_read_b128 v[36:39], v13 offset:0
    ds_read_b128 v[40:43], v13 offset:256
    ds_read_b128 v[44:47], v13 offset:512
    ds_read_b128 v[48:51], v13 offset:3072
    ds_read_b128 v[52:55], v13 offset:3328
    ds_read_b128 v[56:59], v13 offset:3584
    s_waitcnt lgkmcnt(3)
    v_cvt_f32_i32 v36, v36
    v_cvt_f32_i32 v37, v37
    v_cvt_f32_i32 v38, v38
    v_cvt_f32_i32 v39, v39
    v_cvt_f32_i32 v40, v40
    v_cvt_f32_i32 v41, v41
    v_cvt_f32_i32 v42, v42
    v_cvt_f32_i32 v43, v43
    v_cvt_f32_i32 v44, v44
    v_cvt_f32_i32 v45, v45
    v_cvt_f32_i32 v46, v46
    v_cvt_f32_i32 v47, v47
    v_sub_f32 v36, v36, v60
    v_sub_f32 v37, v37, v61
    v_sub_f32 v38, v38, v62
    v_sub_f32 v39, v39, v63
    v_sub_f32 v40, v40, v64
    v_sub_f32 v41, v41, v65
    v_sub_f32 v42, v42, v66
    v_sub_f32 v43, v43, v67
    v_sub_f32 v44, v44, v68
    v_sub_f32 v45, v45, v69
    v_sub_f32 v46, v46, v70
    v_sub_f32 v47, v47, v71
    v_cvt_pk_bf16_f32 v36, 0, v36
    v_cvt_pk_bf16_f32 v37, 0, v37
    v_cvt_pk_bf16_f32 v38, 0, v38
    v_cvt_pk_bf16_f32 v39, 0, v39
    v_cvt_pk_bf16_f32 v40, 0, v40
    v_cvt_pk_bf16_f32 v41, 0, v41
    v_cvt_pk_bf16_f32 v42, 0, v42
    v_cvt_pk_bf16_f32 v43, 0, v43
    v_cvt_pk_bf16_f32 v44, 0, v44
    v_cvt_pk_bf16_f32 v45, 0, v45
    v_cvt_pk_bf16_f32 v46, 0, v46
    v_cvt_pk_bf16_f32 v47, 0, v47
    v_mul_f32 v36, v36, v84
    v_mul_f32 v37, v37, v85
    v_mul_f32 v38, v38, v86
    v_mul_f32 v39, v39, v87
    v_mul_f32 v40, v40, v88
    v_mul_f32 v41, v41, v89
    v_mul_f32 v42, v42, v90
    v_mul_f32 v43, v43, v91
    v_mul_f32 v44, v44, v92
    v_mul_f32 v45, v45, v93
    v_mul_f32 v46, v46, v94
    v_mul_f32 v47, v47, v95
    v_cvt_pk_bf16_f32 v132, v36, v37
    v_cvt_pk_bf16_f32 v133, v38, v39
    v_cvt_pk_bf16_f32 v134, v40, v41
    v_cvt_pk_bf16_f32 v135, v42, v43
    v_cvt_pk_bf16_f32 v136, v44, v45
    v_cvt_pk_bf16_f32 v137, v46, v47
    v_mfma_f32_16x16x16_bf16 v[144:147], v[132:133], v[164:165], 0
    v_mfma_f32_16x16x16_bf16 v[144:147], v[134:135], v[166:167], v[144:147]
    v_mfma_f32_16x16x16_bf16 v[144:147], v[136:137], v[168:169], v[144:147]
    s_waitcnt lgkmcnt(0)
    v_cvt_f32_i32 v48, v48
    v_cvt_f32_i32 v49, v49
    v_cvt_f32_i32 v50, v50
    v_cvt_f32_i32 v51, v51
    v_cvt_f32_i32 v52, v52
    v_cvt_f32_i32 v53, v53
    v_cvt_f32_i32 v54, v54
    v_cvt_f32_i32 v55, v55
    v_cvt_f32_i32 v56, v56
    v_cvt_f32_i32 v57, v57
    v_cvt_f32_i32 v58, v58
    v_cvt_f32_i32 v59, v59
    v_sub_f32 v48, v48, v72
    v_sub_f32 v49, v49, v73
    v_sub_f32 v50, v50, v74
    v_sub_f32 v51, v51, v75
    v_sub_f32 v52, v52, v76
    v_sub_f32 v53, v53, v77
    v_sub_f32 v54, v54, v78
    v_sub_f32 v55, v55, v79
    v_sub_f32 v56, v56, v80
    v_sub_f32 v57, v57, v81
    v_sub_f32 v58, v58, v82
    v_sub_f32 v59, v59, v83
    v_cvt_pk_bf16_f32 v48, 0, v48
    v_cvt_pk_bf16_f32 v49, 0, v49
    v_cvt_pk_bf16_f32 v50, 0, v50
    v_cvt_pk_bf16_f32 v51, 0, v51
    v_cvt_pk_bf16_f32 v52, 0, v52
    v_cvt_pk_bf16_f32 v53, 0, v53
    v_cvt_pk_bf16_f32 v54, 0, v54
    v_cvt_pk_bf16_f32 v55, 0, v55
    v_cvt_pk_bf16_f32 v56, 0, v56
    v_cvt_pk_bf16_f32 v57, 0, v57
    v_cvt_pk_bf16_f32 v58, 0, v58
    v_cvt_pk_bf16_f32 v59, 0, v59
    v_mul_f32 v48, v48, v96
    v_mul_f32 v49, v49, v97
    v_mul_f32 v50, v50, v98
    v_mul_f32 v51, v51, v99
    v_mul_f32 v52, v52, v100
    v_mul_f32 v53, v53, v101
    v_mul_f32 v54, v54, v102
    v_mul_f32 v55, v55, v103
    v_mul_f32 v56, v56, v104
    v_mul_f32 v57, v57, v105
    v_mul_f32 v58, v58, v106
    v_mul_f32 v59, v59, v107
    v_cvt_pk_bf16_f32 v138, v48, v49
    v_cvt_pk_bf16_f32 v139, v50, v51
    v_add_f32_dpp v3, v147, v146 row_ror:12 row_mask:0xf bank_mask:0xf
    v_cvt_pk_bf16_f32 v140, v52, v53
    v_cvt_pk_bf16_f32 v141, v54, v55
    v_add_f32_dpp v3, v144, v3 row_ror:8 row_mask:0xf bank_mask:0xf
    v_cvt_pk_bf16_f32 v142, v56, v57
    v_cvt_pk_bf16_f32 v143, v58, v59
    v_add_f32_dpp v15, v145, v3 row_ror:4 row_mask:0xf bank_mask:0x4
    v_mfma_f32_16x16x16_bf16 v[148:151], v[138:139], v[164:165], 0
    v_mfma_f32_16x16x16_bf16 v[148:151], v[140:141], v[166:167], v[148:151]
    v_mfma_f32_16x16x16_bf16 v[148:151], v[142:143], v[168:169], v[148:151]
    v_add_u32 v33, s63, v23
    v_add_u32 v34, s63, v24
    ds_read_b64 v[108:109], v33 offset:0
    ds_read_b64 v[110:111], v33 offset:1536
    ds_read_b64 v[112:113], v33 offset:128
    ds_read_b64 v[114:115], v33 offset:1664
    ds_read_b64 v[116:117], v33 offset:256
    ds_read_b64 v[118:119], v33 offset:1792
    ds_read_b64 v[120:121], v34 offset:0
    v_add_f32_dpp v4, v151, v150 row_ror:12 row_mask:0xf bank_mask:0xf
    ds_read_b64 v[122:123], v34 offset:1536
    ds_read_b64 v[124:125], v34 offset:128
    v_add_f32_dpp v4, v148, v4 row_ror:8 row_mask:0xf bank_mask:0xf
    ds_read_b64 v[126:127], v34 offset:1664
    ds_read_b64 v[128:129], v34 offset:256
    ds_read_b64 v[130:131], v34 offset:1792
    v_add_f32_dpp v16, v149, v4 row_ror:4 row_mask:0xf bank_mask:0x4
    s_waitcnt lgkmcnt(0)
    v_lshlrev_b32 v60, 16, v108
    v_and_b32 v61, s66, v108
    v_lshlrev_b32 v62, 16, v109
    v_and_b32 v63, s66, v109
    v_lshlrev_b32 v84, 16, v110
    v_and_b32 v85, s66, v110
    v_lshlrev_b32 v86, 16, v111
    v_and_b32 v87, s66, v111
    v_lshlrev_b32 v64, 16, v112
    v_and_b32 v65, s66, v112
    v_lshlrev_b32 v66, 16, v113
    v_and_b32 v67, s66, v113
    v_lshlrev_b32 v88, 16, v114
    v_and_b32 v89, s66, v114
    v_lshlrev_b32 v90, 16, v115
    v_and_b32 v91, s66, v115
    v_lshlrev_b32 v68, 16, v116
    v_and_b32 v69, s66, v116
    v_lshlrev_b32 v70, 16, v117
    v_and_b32 v71, s66, v117
    v_lshlrev_b32 v92, 16, v118
    v_and_b32 v93, s66, v118
    v_lshlrev_b32 v94, 16, v119
    v_and_b32 v95, s66, v119
    v_lshlrev_b32 v72, 16, v120
    v_and_b32 v73, s66, v120
    v_lshlrev_b32 v74, 16, v121
    v_and_b32 v75, s66, v121
    v_lshlrev_b32 v96, 16, v122
    v_and_b32 v97, s66, v122
    v_lshlrev_b32 v98, 16, v123
    v_and_b32 v99, s66, v123
    v_lshlrev_b32 v76, 16, v124
    v_and_b32 v77, s66, v124
    v_lshlrev_b32 v78, 16, v125
    v_and_b32 v79, s66, v125
    v_lshlrev_b32 v100, 16, v126
    v_and_b32 v101, s66, v126
    v_lshlrev_b32 v102, 16, v127
    v_and_b32 v103, s66, v127
    v_lshlrev_b32 v80, 16, v128
    v_and_b32 v81, s66, v128
    v_lshlrev_b32 v82, 16, v129
    v_and_b32 v83, s66, v129
    v_lshlrev_b32 v104, 16, v130
    v_and_b32 v105, s66, v130
    v_lshlrev_b32 v106, 16, v131
    v_and_b32 v107, s66, v131
    v_add_u32 v13, s62, v12
    s_add_u32 s62, s62, 24576
    s_cmp_eq_u32 s62, 73728
    s_cselect_b32 s62, 0, s62
    s_barrier
    ds_read_b128 v[36:39], v13 offset:0
    ds_read_b128 v[40:43], v13 offset:256
    ds_read_b128 v[44:47], v13 offset:512
    ds_read_b128 v[48:51], v13 offset:3072
    ds_read_b128 v[52:55], v13 offset:3328
    ds_read_b128 v[56:59], v13 offset:3584
    s_waitcnt lgkmcnt(3)
    v_cvt_f32_i32 v36, v36
    v_cvt_f32_i32 v37, v37
    v_cvt_f32_i32 v38, v38
    v_cvt_f32_i32 v39, v39
    v_cvt_f32_i32 v40, v40
    v_cvt_f32_i32 v41, v41
    v_cvt_f32_i32 v42, v42
    v_cvt_f32_i32 v43, v43
    v_cvt_f32_i32 v44, v44
    v_cvt_f32_i32 v45, v45
    v_cvt_f32_i32 v46, v46
    v_cvt_f32_i32 v47, v47
    v_sub_f32 v36, v36, v60
    v_sub_f32 v37, v37, v61
    v_sub_f32 v38, v38, v62
    v_sub_f32 v39, v39, v63
    v_sub_f32 v40, v40, v64
    v_sub_f32 v41, v41, v65
    v_sub_f32 v42, v42, v66
    v_sub_f32 v43, v43, v67
    v_sub_f32 v44, v44, v68
    v_sub_f32 v45, v45, v69
    v_sub_f32 v46, v46, v70
    v_sub_f32 v47, v47, v71
    v_cvt_pk_bf16_f32 v36, 0, v36
    v_cvt_pk_bf16_f32 v37, 0, v37
    v_cvt_pk_bf16_f32 v38, 0, v38
    v_cvt_pk_bf16_f32 v39, 0, v39
    v_cvt_pk_bf16_f32 v40, 0, v40
    v_cvt_pk_bf16_f32 v41, 0, v41
    v_cvt_pk_bf16_f32 v42, 0, v42
    v_cvt_pk_bf16_f32 v43, 0, v43
    v_cvt_pk_bf16_f32 v44, 0, v44
    v_cvt_pk_bf16_f32 v45, 0, v45
    v_cvt_pk_bf16_f32 v46, 0, v46
    v_cvt_pk_bf16_f32 v47, 0, v47
    v_mul_f32 v36, v36, v84
    v_mul_f32 v37, v37, v85
    v_mul_f32 v38, v38, v86
    v_mul_f32 v39, v39, v87
    v_mul_f32 v40, v40, v88
    v_mul_f32 v41, v41, v89
    v_mul_f32 v42, v42, v90
    v_mul_f32 v43, v43, v91
    v_mul_f32 v44, v44, v92
    v_mul_f32 v45, v45, v93
    v_mul_f32 v46, v46, v94
    v_mul_f32 v47, v47, v95
    v_cvt_pk_bf16_f32 v132, v36, v37
    v_cvt_pk_bf16_f32 v133, v38, v39
    v_cvt_pk_bf16_f32 v134, v40, v41
    v_cvt_pk_bf16_f32 v135, v42, v43
    v_cvt_pk_bf16_f32 v136, v44, v45
    v_cvt_pk_bf16_f32 v137, v46, v47
    v_mfma_f32_16x16x16_bf16 v[144:147], v[132:133], v[164:165], 0
    v_mfma_f32_16x16x16_bf16 v[144:147], v[134:135], v[166:167], v[144:147]
    v_mfma_f32_16x16x16_bf16 v[144:147], v[136:137], v[168:169], v[144:147]
    s_waitcnt lgkmcnt(0)
    v_cvt_f32_i32 v48, v48
    v_cvt_f32_i32 v49, v49
    v_cvt_f32_i32 v50, v50
    v_cvt_f32_i32 v51, v51
    v_cvt_f32_i32 v52, v52
    v_cvt_f32_i32 v53, v53
    v_cvt_f32_i32 v54, v54
    v_cvt_f32_i32 v55, v55
    v_cvt_f32_i32 v56, v56
    v_cvt_f32_i32 v57, v57
    v_cvt_f32_i32 v58, v58
    v_cvt_f32_i32 v59, v59
    v_sub_f32 v48, v48, v72
    v_sub_f32 v49, v49, v73
    v_sub_f32 v50, v50, v74
    v_sub_f32 v51, v51, v75
    v_sub_f32 v52, v52, v76
    v_sub_f32 v53, v53, v77
    v_sub_f32 v54, v54, v78
    v_sub_f32 v55, v55, v79
    v_sub_f32 v56, v56, v80
    v_sub_f32 v57, v57, v81
    v_sub_f32 v58, v58, v82
    v_sub_f32 v59, v59, v83
    v_cvt_pk_bf16_f32 v48, 0, v48
    v_cvt_pk_bf16_f32 v49, 0, v49
    v_cvt_pk_bf16_f32 v50, 0, v50
    v_cvt_pk_bf16_f32 v51, 0, v51
    v_cvt_pk_bf16_f32 v52, 0, v52
    v_cvt_pk_bf16_f32 v53, 0, v53
    v_cvt_pk_bf16_f32 v54, 0, v54
    v_cvt_pk_bf16_f32 v55, 0, v55
    v_cvt_pk_bf16_f32 v56, 0, v56
    v_cvt_pk_bf16_f32 v57, 0, v57
    v_cvt_pk_bf16_f32 v58, 0, v58
    v_cvt_pk_bf16_f32 v59, 0, v59
    v_mul_f32 v48, v48, v96
    v_mul_f32 v49, v49, v97
    v_mul_f32 v50, v50, v98
    v_mul_f32 v51, v51, v99
    v_mul_f32 v52, v52, v100
    v_mul_f32 v53, v53, v101
    v_mul_f32 v54, v54, v102
    v_mul_f32 v55, v55, v103
    v_mul_f32 v56, v56, v104
    v_mul_f32 v57, v57, v105
    v_mul_f32 v58, v58, v106
    v_mul_f32 v59, v59, v107
    v_cvt_pk_bf16_f32 v138, v48, v49
    v_cvt_pk_bf16_f32 v139, v50, v51
    v_add_f32_dpp v3, v144, v147 row_ror:12 row_mask:0xf bank_mask:0xf
    v_cvt_pk_bf16_f32 v140, v52, v53
    v_cvt_pk_bf16_f32 v141, v54, v55
    v_add_f32_dpp v3, v145, v3 row_ror:8 row_mask:0xf bank_mask:0xf
    v_cvt_pk_bf16_f32 v142, v56, v57
    v_cvt_pk_bf16_f32 v143, v58, v59
    v_add_f32_dpp v15, v146, v3 row_ror:4 row_mask:0xf bank_mask:0x8
    v_mfma_f32_16x16x16_bf16 v[148:151], v[138:139], v[164:165], 0
    v_mfma_f32_16x16x16_bf16 v[148:151], v[140:141], v[166:167], v[148:151]
    v_mfma_f32_16x16x16_bf16 v[148:151], v[142:143], v[168:169], v[148:151]
    v_add_u32 v33, s63, v25
    v_add_u32 v34, s63, v26
    ds_read_b64 v[108:109], v33 offset:0
    ds_read_b64 v[110:111], v33 offset:1536
    ds_read_b64 v[112:113], v33 offset:128
    ds_read_b64 v[114:115], v33 offset:1664
    ds_read_b64 v[116:117], v33 offset:256
    ds_read_b64 v[118:119], v33 offset:1792
    ds_read_b64 v[120:121], v34 offset:0
    v_add_f32_dpp v4, v148, v151 row_ror:12 row_mask:0xf bank_mask:0xf
    ds_read_b64 v[122:123], v34 offset:1536
    ds_read_b64 v[124:125], v34 offset:128
    v_add_f32_dpp v4, v149, v4 row_ror:8 row_mask:0xf bank_mask:0xf
    ds_read_b64 v[126:127], v34 offset:1664
    ds_read_b64 v[128:129], v34 offset:256
    ds_read_b64 v[130:131], v34 offset:1792
    v_add_f32_dpp v16, v150, v4 row_ror:4 row_mask:0xf bank_mask:0x8
    v_cvt_pk_bf16_f32 v3, 0, v15
    v_cvt_pk_bf16_f32 v4, 0, v16
    v_mul_f32 v3, s65, v3
    v_mul_f32 v4, s65, v4
    v_cvt_pk_bf16_f32 v5, v3, v4
    v_max3_f32 v14, v14, v3, v4
    ds_write_b32 v11, v5 offset:0
    s_waitcnt lgkmcnt(0)
    v_lshlrev_b32 v60, 16, v108
    v_and_b32 v61, s66, v108
    v_lshlrev_b32 v62, 16, v109
    v_and_b32 v63, s66, v109
    v_lshlrev_b32 v84, 16, v110
    v_and_b32 v85, s66, v110
    v_lshlrev_b32 v86, 16, v111
    v_and_b32 v87, s66, v111
    v_lshlrev_b32 v64, 16, v112
    v_and_b32 v65, s66, v112
    v_lshlrev_b32 v66, 16, v113
    v_and_b32 v67, s66, v113
    v_lshlrev_b32 v88, 16, v114
    v_and_b32 v89, s66, v114
    v_lshlrev_b32 v90, 16, v115
    v_and_b32 v91, s66, v115
    v_lshlrev_b32 v68, 16, v116
    v_and_b32 v69, s66, v116
    v_lshlrev_b32 v70, 16, v117
    v_and_b32 v71, s66, v117
    v_lshlrev_b32 v92, 16, v118
    v_and_b32 v93, s66, v118
    v_lshlrev_b32 v94, 16, v119
    v_and_b32 v95, s66, v119
    v_lshlrev_b32 v72, 16, v120
    v_and_b32 v73, s66, v120
    v_lshlrev_b32 v74, 16, v121
    v_and_b32 v75, s66, v121
    v_lshlrev_b32 v96, 16, v122
    v_and_b32 v97, s66, v122
    v_lshlrev_b32 v98, 16, v123
    v_and_b32 v99, s66, v123
    v_lshlrev_b32 v76, 16, v124
    v_and_b32 v77, s66, v124
    v_lshlrev_b32 v78, 16, v125
    v_and_b32 v79, s66, v125
    v_lshlrev_b32 v100, 16, v126
    v_and_b32 v101, s66, v126
    v_lshlrev_b32 v102, 16, v127
    v_and_b32 v103, s66, v127
    v_lshlrev_b32 v80, 16, v128
    v_and_b32 v81, s66, v128
    v_lshlrev_b32 v82, 16, v129
    v_and_b32 v83, s66, v129
    v_lshlrev_b32 v104, 16, v130
    v_and_b32 v105, s66, v130
    v_lshlrev_b32 v106, 16, v131
    v_and_b32 v107, s66, v131
    v_add_u32 v13, s62, v12
    s_add_u32 s62, s62, 24576
    s_cmp_eq_u32 s62, 73728
    s_cselect_b32 s62, 0, s62
    s_barrier
    ds_read_b128 v[36:39], v13 offset:0
    ds_read_b128 v[40:43], v13 offset:256
    ds_read_b128 v[44:47], v13 offset:512
    ds_read_b128 v[48:51], v13 offset:3072
    ds_read_b128 v[52:55], v13 offset:3328
    ds_read_b128 v[56:59], v13 offset:3584
    s_waitcnt lgkmcnt(3)
    v_cvt_f32_i32 v36, v36
    v_cvt_f32_i32 v37, v37
    v_cvt_f32_i32 v38, v38
    v_cvt_f32_i32 v39, v39
    v_cvt_f32_i32 v40, v40
    v_cvt_f32_i32 v41, v41
    v_cvt_f32_i32 v42, v42
    v_cvt_f32_i32 v43, v43
    v_cvt_f32_i32 v44, v44
    v_cvt_f32_i32 v45, v45
    v_cvt_f32_i32 v46, v46
    v_cvt_f32_i32 v47, v47
    v_sub_f32 v36, v36, v60
    v_sub_f32 v37, v37, v61
    v_sub_f32 v38, v38, v62
    v_sub_f32 v39, v39, v63
    v_sub_f32 v40, v40, v64
    v_sub_f32 v41, v41, v65
    v_sub_f32 v42, v42, v66
    v_sub_f32 v43, v43, v67
    v_sub_f32 v44, v44, v68
    v_sub_f32 v45, v45, v69
    v_sub_f32 v46, v46, v70
    v_sub_f32 v47, v47, v71
    v_cvt_pk_bf16_f32 v36, 0, v36
    v_cvt_pk_bf16_f32 v37, 0, v37
    v_cvt_pk_bf16_f32 v38, 0, v38
    v_cvt_pk_bf16_f32 v39, 0, v39
    v_cvt_pk_bf16_f32 v40, 0, v40
    v_cvt_pk_bf16_f32 v41, 0, v41
    v_cvt_pk_bf16_f32 v42, 0, v42
    v_cvt_pk_bf16_f32 v43, 0, v43
    v_cvt_pk_bf16_f32 v44, 0, v44
    v_cvt_pk_bf16_f32 v45, 0, v45
    v_cvt_pk_bf16_f32 v46, 0, v46
    v_cvt_pk_bf16_f32 v47, 0, v47
    v_mul_f32 v36, v36, v84
    v_mul_f32 v37, v37, v85
    v_mul_f32 v38, v38, v86
    v_mul_f32 v39, v39, v87
    v_mul_f32 v40, v40, v88
    v_mul_f32 v41, v41, v89
    v_mul_f32 v42, v42, v90
    v_mul_f32 v43, v43, v91
    v_mul_f32 v44, v44, v92
    v_mul_f32 v45, v45, v93
    v_mul_f32 v46, v46, v94
    v_mul_f32 v47, v47, v95
    v_cvt_pk_bf16_f32 v132, v36, v37
    v_cvt_pk_bf16_f32 v133, v38, v39
    v_cvt_pk_bf16_f32 v134, v40, v41
    v_cvt_pk_bf16_f32 v135, v42, v43
    v_cvt_pk_bf16_f32 v136, v44, v45
    v_cvt_pk_bf16_f32 v137, v46, v47
    v_mfma_f32_16x16x16_bf16 v[144:147], v[132:133], v[164:165], 0
    v_mfma_f32_16x16x16_bf16 v[144:147], v[134:135], v[166:167], v[144:147]
    v_mfma_f32_16x16x16_bf16 v[144:147], v[136:137], v[168:169], v[144:147]
    s_waitcnt lgkmcnt(0)
    v_cvt_f32_i32 v48, v48
    v_cvt_f32_i32 v49, v49
    v_cvt_f32_i32 v50, v50
    v_cvt_f32_i32 v51, v51
    v_cvt_f32_i32 v52, v52
    v_cvt_f32_i32 v53, v53
    v_cvt_f32_i32 v54, v54
    v_cvt_f32_i32 v55, v55
    v_cvt_f32_i32 v56, v56
    v_cvt_f32_i32 v57, v57
    v_cvt_f32_i32 v58, v58
    v_cvt_f32_i32 v59, v59
    v_sub_f32 v48, v48, v72
    v_sub_f32 v49, v49, v73
    v_sub_f32 v50, v50, v74
    v_sub_f32 v51, v51, v75
    v_sub_f32 v52, v52, v76
    v_sub_f32 v53, v53, v77
    v_sub_f32 v54, v54, v78
    v_sub_f32 v55, v55, v79
    v_sub_f32 v56, v56, v80
    v_sub_f32 v57, v57, v81
    v_sub_f32 v58, v58, v82
    v_sub_f32 v59, v59, v83
    v_cvt_pk_bf16_f32 v48, 0, v48
    v_cvt_pk_bf16_f32 v49, 0, v49
    v_cvt_pk_bf16_f32 v50, 0, v50
    v_cvt_pk_bf16_f32 v51, 0, v51
    v_cvt_pk_bf16_f32 v52, 0, v52
    v_cvt_pk_bf16_f32 v53, 0, v53
    v_cvt_pk_bf16_f32 v54, 0, v54
    v_cvt_pk_bf16_f32 v55, 0, v55
    v_cvt_pk_bf16_f32 v56, 0, v56
    v_cvt_pk_bf16_f32 v57, 0, v57
    v_cvt_pk_bf16_f32 v58, 0, v58
    v_cvt_pk_bf16_f32 v59, 0, v59
    v_mul_f32 v48, v48, v96
    v_mul_f32 v49, v49, v97
    v_mul_f32 v50, v50, v98
    v_mul_f32 v51, v51, v99
    v_mul_f32 v52, v52, v100
    v_mul_f32 v53, v53, v101
    v_mul_f32 v54, v54, v102
    v_mul_f32 v55, v55, v103
    v_mul_f32 v56, v56, v104
    v_mul_f32 v57, v57, v105
    v_mul_f32 v58, v58, v106
    v_mul_f32 v59, v59, v107
    v_cvt_pk_bf16_f32 v138, v48, v49
    v_cvt_pk_bf16_f32 v139, v50, v51
    v_add_f32_dpp v3, v145, v144 row_ror:12 row_mask:0xf bank_mask:0xf
    v_cvt_pk_bf16_f32 v140, v52, v53
    v_cvt_pk_bf16_f32 v141, v54, v55
    v_add_f32_dpp v3, v146, v3 row_ror:8 row_mask:0xf bank_mask:0xf
    v_cvt_pk_bf16_f32 v142, v56, v57
    v_cvt_pk_bf16_f32 v143, v58, v59
    v_add_f32_dpp v15, v147, v3 row_ror:4 row_mask:0xf bank_mask:0x1
    v_mfma_f32_16x16x16_bf16 v[148:151], v[138:139], v[164:165], 0
    v_mfma_f32_16x16x16_bf16 v[148:151], v[140:141], v[166:167], v[148:151]
    v_mfma_f32_16x16x16_bf16 v[148:151], v[142:143], v[168:169], v[148:151]
    v_add_u32 v33, s63, v27
    v_add_u32 v34, s63, v28
    ds_read_b64 v[108:109], v33 offset:0
    ds_read_b64 v[110:111], v33 offset:1536
    ds_read_b64 v[112:113], v33 offset:128
    ds_read_b64 v[114:115], v33 offset:1664
    ds_read_b64 v[116:117], v33 offset:256
    ds_read_b64 v[118:119], v33 offset:1792
    ds_read_b64 v[120:121], v34 offset:0
    v_add_f32_dpp v4, v149, v148 row_ror:12 row_mask:0xf bank_mask:0xf
    ds_read_b64 v[122:123], v34 offset:1536
    ds_read_b64 v[124:125], v34 offset:128
    v_add_f32_dpp v4, v150, v4 row_ror:8 row_mask:0xf bank_mask:0xf
    ds_read_b64 v[126:127], v34 offset:1664
    ds_read_b64 v[128:129], v34 offset:256
    ds_read_b64 v[130:131], v34 offset:1792
    v_add_f32_dpp v16, v151, v4 row_ror:4 row_mask:0xf bank_mask:0x1
    s_waitcnt lgkmcnt(0)
    v_lshlrev_b32 v60, 16, v108
    v_and_b32 v61, s66, v108
    v_lshlrev_b32 v62, 16, v109
    v_and_b32 v63, s66, v109
    v_lshlrev_b32 v84, 16, v110
    v_and_b32 v85, s66, v110
    v_lshlrev_b32 v86, 16, v111
    v_and_b32 v87, s66, v111
    v_lshlrev_b32 v64, 16, v112
    v_and_b32 v65, s66, v112
    v_lshlrev_b32 v66, 16, v113
    v_and_b32 v67, s66, v113
    v_lshlrev_b32 v88, 16, v114
    v_and_b32 v89, s66, v114
    v_lshlrev_b32 v90, 16, v115
    v_and_b32 v91, s66, v115
    v_lshlrev_b32 v68, 16, v116
    v_and_b32 v69, s66, v116
    v_lshlrev_b32 v70, 16, v117
    v_and_b32 v71, s66, v117
    v_lshlrev_b32 v92, 16, v118
    v_and_b32 v93, s66, v118
    v_lshlrev_b32 v94, 16, v119
    v_and_b32 v95, s66, v119
    v_lshlrev_b32 v72, 16, v120
    v_and_b32 v73, s66, v120
    v_lshlrev_b32 v74, 16, v121
    v_and_b32 v75, s66, v121
    v_lshlrev_b32 v96, 16, v122
    v_and_b32 v97, s66, v122
    v_lshlrev_b32 v98, 16, v123
    v_and_b32 v99, s66, v123
    v_lshlrev_b32 v76, 16, v124
    v_and_b32 v77, s66, v124
    v_lshlrev_b32 v78, 16, v125
    v_and_b32 v79, s66, v125
    v_lshlrev_b32 v100, 16, v126
    v_and_b32 v101, s66, v126
    v_lshlrev_b32 v102, 16, v127
    v_and_b32 v103, s66, v127
    v_lshlrev_b32 v80, 16, v128
    v_and_b32 v81, s66, v128
    v_lshlrev_b32 v82, 16, v129
    v_and_b32 v83, s66, v129
    v_lshlrev_b32 v104, 16, v130
    v_and_b32 v105, s66, v130
    v_lshlrev_b32 v106, 16, v131
    v_and_b32 v107, s66, v131
    v_add_u32 v13, s62, v12
    s_add_u32 s62, s62, 24576
    s_cmp_eq_u32 s62, 73728
    s_cselect_b32 s62, 0, s62
    s_barrier
    ds_read_b128 v[36:39], v13 offset:0
    ds_read_b128 v[40:43], v13 offset:256
    ds_read_b128 v[44:47], v13 offset:512
    ds_read_b128 v[48:51], v13 offset:3072
    ds_read_b128 v[52:55], v13 offset:3328
    ds_read_b128 v[56:59], v13 offset:3584
    s_waitcnt lgkmcnt(3)
    v_cvt_f32_i32 v36, v36
    v_cvt_f32_i32 v37, v37
    v_cvt_f32_i32 v38, v38
    v_cvt_f32_i32 v39, v39
    v_cvt_f32_i32 v40, v40
    v_cvt_f32_i32 v41, v41
    v_cvt_f32_i32 v42, v42
    v_cvt_f32_i32 v43, v43
    v_cvt_f32_i32 v44, v44
    v_cvt_f32_i32 v45, v45
    v_cvt_f32_i32 v46, v46
    v_cvt_f32_i32 v47, v47
    v_sub_f32 v36, v36, v60
    v_sub_f32 v37, v37, v61
    v_sub_f32 v38, v38, v62
    v_sub_f32 v39, v39, v63
    v_sub_f32 v40, v40, v64
    v_sub_f32 v41, v41, v65
    v_sub_f32 v42, v42, v66
    v_sub_f32 v43, v43, v67
    v_sub_f32 v44, v44, v68
    v_sub_f32 v45, v45, v69
    v_sub_f32 v46, v46, v70
    v_sub_f32 v47, v47, v71
    v_cvt_pk_bf16_f32 v36, 0, v36
    v_cvt_pk_bf16_f32 v37, 0, v37
    v_cvt_pk_bf16_f32 v38, 0, v38
    v_cvt_pk_bf16_f32 v39, 0, v39
    v_cvt_pk_bf16_f32 v40, 0, v40
    v_cvt_pk_bf16_f32 v41, 0, v41
    v_cvt_pk_bf16_f32 v42, 0, v42
    v_cvt_pk_bf16_f32 v43, 0, v43
    v_cvt_pk_bf16_f32 v44, 0, v44
    v_cvt_pk_bf16_f32 v45, 0, v45
    v_cvt_pk_bf16_f32 v46, 0, v46
    v_cvt_pk_bf16_f32 v47, 0, v47
    v_mul_f32 v36, v36, v84
    v_mul_f32 v37, v37, v85
    v_mul_f32 v38, v38, v86
    v_mul_f32 v39, v39, v87
    v_mul_f32 v40, v40, v88
    v_mul_f32 v41, v41, v89
    v_mul_f32 v42, v42, v90
    v_mul_f32 v43, v43, v91
    v_mul_f32 v44, v44, v92
    v_mul_f32 v45, v45, v93
    v_mul_f32 v46, v46, v94
    v_mul_f32 v47, v47, v95
    v_cvt_pk_bf16_f32 v132, v36, v37
    v_cvt_pk_bf16_f32 v133, v38, v39
    v_cvt_pk_bf16_f32 v134, v40, v41
    v_cvt_pk_bf16_f32 v135, v42, v43
    v_cvt_pk_bf16_f32 v136, v44, v45
    v_cvt_pk_bf16_f32 v137, v46, v47
    v_mfma_f32_16x16x16_bf16 v[144:147], v[132:133], v[164:165], 0
    v_mfma_f32_16x16x16_bf16 v[144:147], v[134:135], v[166:167], v[144:147]
    v_mfma_f32_16x16x16_bf16 v[144:147], v[136:137], v[168:169], v[144:147]
    s_waitcnt lgkmcnt(0)
    v_cvt_f32_i32 v48, v48
    v_cvt_f32_i32 v49, v49
    v_cvt_f32_i32 v50, v50
    v_cvt_f32_i32 v51, v51
    v_cvt_f32_i32 v52, v52
    v_cvt_f32_i32 v53, v53
    v_cvt_f32_i32 v54, v54
    v_cvt_f32_i32 v55, v55
    v_cvt_f32_i32 v56, v56
    v_cvt_f32_i32 v57, v57
    v_cvt_f32_i32 v58, v58
    v_cvt_f32_i32 v59, v59
    v_sub_f32 v48, v48, v72
    v_sub_f32 v49, v49, v73
    v_sub_f32 v50, v50, v74
    v_sub_f32 v51, v51, v75
    v_sub_f32 v52, v52, v76
    v_sub_f32 v53, v53, v77
    v_sub_f32 v54, v54, v78
    v_sub_f32 v55, v55, v79
    v_sub_f32 v56, v56, v80
    v_sub_f32 v57, v57, v81
    v_sub_f32 v58, v58, v82
    v_sub_f32 v59, v59, v83
    v_cvt_pk_bf16_f32 v48, 0, v48
    v_cvt_pk_bf16_f32 v49, 0, v49
    v_cvt_pk_bf16_f32 v50, 0, v50
    v_cvt_pk_bf16_f32 v51, 0, v51
    v_cvt_pk_bf16_f32 v52, 0, v52
    v_cvt_pk_bf16_f32 v53, 0, v53
    v_cvt_pk_bf16_f32 v54, 0, v54
    v_cvt_pk_bf16_f32 v55, 0, v55
    v_cvt_pk_bf16_f32 v56, 0, v56
    v_cvt_pk_bf16_f32 v57, 0, v57
    v_cvt_pk_bf16_f32 v58, 0, v58
    v_cvt_pk_bf16_f32 v59, 0, v59
    v_mul_f32 v48, v48, v96
    v_mul_f32 v49, v49, v97
    v_mul_f32 v50, v50, v98
    v_mul_f32 v51, v51, v99
    v_mul_f32 v52, v52, v100
    v_mul_f32 v53, v53, v101
    v_mul_f32 v54, v54, v102
    v_mul_f32 v55, v55, v103
    v_mul_f32 v56, v56, v104
    v_mul_f32 v57, v57, v105
    v_mul_f32 v58, v58, v106
    v_mul_f32 v59, v59, v107
    v_cvt_pk_bf16_f32 v138, v48, v49
    v_cvt_pk_bf16_f32 v139, v50, v51
    v_add_f32_dpp v3, v146, v145 row_ror:12 row_mask:0xf bank_mask:0xf
    v_cvt_pk_bf16_f32 v140, v52, v53
    v_cvt_pk_bf16_f32 v141, v54, v55
    v_add_f32_dpp v3, v147, v3 row_ror:8 row_mask:0xf bank_mask:0xf
    v_cvt_pk_bf16_f32 v142, v56, v57
    v_cvt_pk_bf16_f32 v143, v58, v59
    v_add_f32_dpp v15, v144, v3 row_ror:4 row_mask:0xf bank_mask:0x2
    v_mfma_f32_16x16x16_bf16 v[148:151], v[138:139], v[164:165], 0
    v_mfma_f32_16x16x16_bf16 v[148:151], v[140:141], v[166:167], v[148:151]
    v_mfma_f32_16x16x16_bf16 v[148:151], v[142:143], v[168:169], v[148:151]
    v_add_u32 v33, s63, v29
    v_add_u32 v34, s63, v30
    ds_read_b64 v[108:109], v33 offset:0
    ds_read_b64 v[110:111], v33 offset:1536
    ds_read_b64 v[112:113], v33 offset:128
    ds_read_b64 v[114:115], v33 offset:1664
    ds_read_b64 v[116:117], v33 offset:256
    ds_read_b64 v[118:119], v33 offset:1792
    ds_read_b64 v[120:121], v34 offset:0
    v_add_f32_dpp v4, v150, v149 row_ror:12 row_mask:0xf bank_mask:0xf
    ds_read_b64 v[122:123], v34 offset:1536
    ds_read_b64 v[124:125], v34 offset:128
    v_add_f32_dpp v4, v151, v4 row_ror:8 row_mask:0xf bank_mask:0xf
    ds_read_b64 v[126:127], v34 offset:1664
    ds_read_b64 v[128:129], v34 offset:256
    ds_read_b64 v[130:131], v34 offset:1792
    v_add_f32_dpp v16, v148, v4 row_ror:4 row_mask:0xf bank_mask:0x2
    s_waitcnt lgkmcnt(0)
    v_lshlrev_b32 v60, 16, v108
    v_and_b32 v61, s66, v108
    v_lshlrev_b32 v62, 16, v109
    v_and_b32 v63, s66, v109
    v_lshlrev_b32 v84, 16, v110
    v_and_b32 v85, s66, v110
    v_lshlrev_b32 v86, 16, v111
    v_and_b32 v87, s66, v111
    v_lshlrev_b32 v64, 16, v112
    v_and_b32 v65, s66, v112
    v_lshlrev_b32 v66, 16, v113
    v_and_b32 v67, s66, v113
    v_lshlrev_b32 v88, 16, v114
    v_and_b32 v89, s66, v114
    v_lshlrev_b32 v90, 16, v115
    v_and_b32 v91, s66, v115
    v_lshlrev_b32 v68, 16, v116
    v_and_b32 v69, s66, v116
    v_lshlrev_b32 v70, 16, v117
    v_and_b32 v71, s66, v117
    v_lshlrev_b32 v92, 16, v118
    v_and_b32 v93, s66, v118
    v_lshlrev_b32 v94, 16, v119
    v_and_b32 v95, s66, v119
    v_lshlrev_b32 v72, 16, v120
    v_and_b32 v73, s66, v120
    v_lshlrev_b32 v74, 16, v121
    v_and_b32 v75, s66, v121
    v_lshlrev_b32 v96, 16, v122
    v_and_b32 v97, s66, v122
    v_lshlrev_b32 v98, 16, v123
    v_and_b32 v99, s66, v123
    v_lshlrev_b32 v76, 16, v124
    v_and_b32 v77, s66, v124
    v_lshlrev_b32 v78, 16, v125
    v_and_b32 v79, s66, v125
    v_lshlrev_b32 v100, 16, v126
    v_and_b32 v101, s66, v126
    v_lshlrev_b32 v102, 16, v127
    v_and_b32 v103, s66, v127
    v_lshlrev_b32 v80, 16, v128
    v_and_b32 v81, s66, v128
    v_lshlrev_b32 v82, 16, v129
    v_and_b32 v83, s66, v129
    v_lshlrev_b32 v104, 16, v130
    v_and_b32 v105, s66, v130
    v_lshlrev_b32 v106, 16, v131
    v_and_b32 v107, s66, v131
    v_add_u32 v13, s62, v12
    s_add_u32 s62, s62, 24576
    s_cmp_eq_u32 s62, 73728
    s_cselect_b32 s62, 0, s62
    s_barrier
    ds_read_b128 v[36:39], v13 offset:0
    ds_read_b128 v[40:43], v13 offset:256
    ds_read_b128 v[44:47], v13 offset:512
    ds_read_b128 v[48:51], v13 offset:3072
    ds_read_b128 v[52:55], v13 offset:3328
    ds_read_b128 v[56:59], v13 offset:3584
    s_waitcnt lgkmcnt(3)
    v_cvt_f32_i32 v36, v36
    v_cvt_f32_i32 v37, v37
    v_cvt_f32_i32 v38, v38
    v_cvt_f32_i32 v39, v39
    v_cvt_f32_i32 v40, v40
    v_cvt_f32_i32 v41, v41
    v_cvt_f32_i32 v42, v42
    v_cvt_f32_i32 v43, v43
    v_cvt_f32_i32 v44, v44
    v_cvt_f32_i32 v45, v45
    v_cvt_f32_i32 v46, v46
    v_cvt_f32_i32 v47, v47
    v_sub_f32 v36, v36, v60
    v_sub_f32 v37, v37, v61
    v_sub_f32 v38, v38, v62
    v_sub_f32 v39, v39, v63
    v_sub_f32 v40, v40, v64
    v_sub_f32 v41, v41, v65
    v_sub_f32 v42, v42, v66
    v_sub_f32 v43, v43, v67
    v_sub_f32 v44, v44, v68
    v_sub_f32 v45, v45, v69
    v_sub_f32 v46, v46, v70
    v_sub_f32 v47, v47, v71
    v_cvt_pk_bf16_f32 v36, 0, v36
    v_cvt_pk_bf16_f32 v37, 0, v37
    v_cvt_pk_bf16_f32 v38, 0, v38
    v_cvt_pk_bf16_f32 v39, 0, v39
    v_cvt_pk_bf16_f32 v40, 0, v40
    v_cvt_pk_bf16_f32 v41, 0, v41
    v_cvt_pk_bf16_f32 v42, 0, v42
    v_cvt_pk_bf16_f32 v43, 0, v43
    v_cvt_pk_bf16_f32 v44, 0, v44
    v_cvt_pk_bf16_f32 v45, 0, v45
    v_cvt_pk_bf16_f32 v46, 0, v46
    v_cvt_pk_bf16_f32 v47, 0, v47
    v_mul_f32 v36, v36, v84
    v_mul_f32 v37, v37, v85
    v_mul_f32 v38, v38, v86
    v_mul_f32 v39, v39, v87
    v_mul_f32 v40, v40, v88
    v_mul_f32 v41, v41, v89
    v_mul_f32 v42, v42, v90
    v_mul_f32 v43, v43, v91
    v_mul_f32 v44, v44, v92
    v_mul_f32 v45, v45, v93
    v_mul_f32 v46, v46, v94
    v_mul_f32 v47, v47, v95
    v_cvt_pk_bf16_f32 v132, v36, v37
    v_cvt_pk_bf16_f32 v133, v38, v39
    v_cvt_pk_bf16_f32 v134, v40, v41
    v_cvt_pk_bf16_f32 v135, v42, v43
    v_cvt_pk_bf16_f32 v136, v44, v45
    v_cvt_pk_bf16_f32 v137, v46, v47
    v_mfma_f32_16x16x16_bf16 v[144:147], v[132:133], v[164:165], 0
    v_mfma_f32_16x16x16_bf16 v[144:147], v[134:135], v[166:167], v[144:147]
    v_mfma_f32_16x16x16_bf16 v[144:147], v[136:137], v[168:169], v[144:147]
    s_waitcnt lgkmcnt(0)
    v_cvt_f32_i32 v48, v48
    v_cvt_f32_i32 v49, v49
    v_cvt_f32_i32 v50, v50
    v_cvt_f32_i32 v51, v51
    v_cvt_f32_i32 v52, v52
    v_cvt_f32_i32 v53, v53
    v_cvt_f32_i32 v54, v54
    v_cvt_f32_i32 v55, v55
    v_cvt_f32_i32 v56, v56
    v_cvt_f32_i32 v57, v57
    v_cvt_f32_i32 v58, v58
    v_cvt_f32_i32 v59, v59
    v_sub_f32 v48, v48, v72
    v_sub_f32 v49, v49, v73
    v_sub_f32 v50, v50, v74
    v_sub_f32 v51, v51, v75
    v_sub_f32 v52, v52, v76
    v_sub_f32 v53, v53, v77
    v_sub_f32 v54, v54, v78
    v_sub_f32 v55, v55, v79
    v_sub_f32 v56, v56, v80
    v_sub_f32 v57, v57, v81
    v_sub_f32 v58, v58, v82
    v_sub_f32 v59, v59, v83
    v_cvt_pk_bf16_f32 v48, 0, v48
    v_cvt_pk_bf16_f32 v49, 0, v49
    v_cvt_pk_bf16_f32 v50, 0, v50
    v_cvt_pk_bf16_f32 v51, 0, v51
    v_cvt_pk_bf16_f32 v52, 0, v52
    v_cvt_pk_bf16_f32 v53, 0, v53
    v_cvt_pk_bf16_f32 v54, 0, v54
    v_cvt_pk_bf16_f32 v55, 0, v55
    v_cvt_pk_bf16_f32 v56, 0, v56
    v_cvt_pk_bf16_f32 v57, 0, v57
    v_cvt_pk_bf16_f32 v58, 0, v58
    v_cvt_pk_bf16_f32 v59, 0, v59
    v_mul_f32 v48, v48, v96
    v_mul_f32 v49, v49, v97
    v_mul_f32 v50, v50, v98
    v_mul_f32 v51, v51, v99
    v_mul_f32 v52, v52, v100
    v_mul_f32 v53, v53, v101
    v_mul_f32 v54, v54, v102
    v_mul_f32 v55, v55, v103
    v_mul_f32 v56, v56, v104
    v_mul_f32 v57, v57, v105
    v_mul_f32 v58, v58, v106
    v_mul_f32 v59, v59, v107
    v_cvt_pk_bf16_f32 v138, v48, v49
    v_cvt_pk_bf16_f32 v139, v50, v51
    v_add_f32_dpp v3, v147, v146 row_ror:12 row_mask:0xf bank_mask:0xf
    v_cvt_pk_bf16_f32 v140, v52, v53
    v_cvt_pk_bf16_f32 v141, v54, v55
    v_add_f32_dpp v3, v144, v3 row_ror:8 row_mask:0xf bank_mask:0xf
    v_cvt_pk_bf16_f32 v142, v56, v57
    v_cvt_pk_bf16_f32 v143, v58, v59
    v_add_f32_dpp v15, v145, v3 row_ror:4 row_mask:0xf bank_mask:0x4
    v_mfma_f32_16x16x16_bf16 v[148:151], v[138:139], v[164:165], 0
    v_mfma_f32_16x16x16_bf16 v[148:151], v[140:141], v[166:167], v[148:151]
    v_mfma_f32_16x16x16_bf16 v[148:151], v[142:143], v[168:169], v[148:151]
    v_add_u32 v33, s63, v31
    v_add_u32 v34, s63, v32
    ds_read_b64 v[108:109], v33 offset:0
    ds_read_b64 v[110:111], v33 offset:1536
    ds_read_b64 v[112:113], v33 offset:128
    ds_read_b64 v[114:115], v33 offset:1664
    ds_read_b64 v[116:117], v33 offset:256
    ds_read_b64 v[118:119], v33 offset:1792
    ds_read_b64 v[120:121], v34 offset:0
    v_add_f32_dpp v4, v151, v150 row_ror:12 row_mask:0xf bank_mask:0xf
    ds_read_b64 v[122:123], v34 offset:1536
    ds_read_b64 v[124:125], v34 offset:128
    v_add_f32_dpp v4, v148, v4 row_ror:8 row_mask:0xf bank_mask:0xf
    ds_read_b64 v[126:127], v34 offset:1664
    ds_read_b64 v[128:129], v34 offset:256
    ds_read_b64 v[130:131], v34 offset:1792
    v_add_f32_dpp v16, v149, v4 row_ror:4 row_mask:0xf bank_mask:0x4
    s_waitcnt lgkmcnt(0)
    v_lshlrev_b32 v60, 16, v108
    v_and_b32 v61, s66, v108
    v_lshlrev_b32 v62, 16, v109
    v_and_b32 v63, s66, v109
    v_lshlrev_b32 v84, 16, v110
    v_and_b32 v85, s66, v110
    v_lshlrev_b32 v86, 16, v111
    v_and_b32 v87, s66, v111
    v_lshlrev_b32 v64, 16, v112
    v_and_b32 v65, s66, v112
    v_lshlrev_b32 v66, 16, v113
    v_and_b32 v67, s66, v113
    v_lshlrev_b32 v88, 16, v114
    v_and_b32 v89, s66, v114
    v_lshlrev_b32 v90, 16, v115
    v_and_b32 v91, s66, v115
    v_lshlrev_b32 v68, 16, v116
    v_and_b32 v69, s66, v116
    v_lshlrev_b32 v70, 16, v117
    v_and_b32 v71, s66, v117
    v_lshlrev_b32 v92, 16, v118
    v_and_b32 v93, s66, v118
    v_lshlrev_b32 v94, 16, v119
    v_and_b32 v95, s66, v119
    v_lshlrev_b32 v72, 16, v120
    v_and_b32 v73, s66, v120
    v_lshlrev_b32 v74, 16, v121
    v_and_b32 v75, s66, v121
    v_lshlrev_b32 v96, 16, v122
    v_and_b32 v97, s66, v122
    v_lshlrev_b32 v98, 16, v123
    v_and_b32 v99, s66, v123
    v_lshlrev_b32 v76, 16, v124
    v_and_b32 v77, s66, v124
    v_lshlrev_b32 v78, 16, v125
    v_and_b32 v79, s66, v125
    v_lshlrev_b32 v100, 16, v126
    v_and_b32 v101, s66, v126
    v_lshlrev_b32 v102, 16, v127
    v_and_b32 v103, s66, v127
    v_lshlrev_b32 v80, 16, v128
    v_and_b32 v81, s66, v128
    v_lshlrev_b32 v82, 16, v129
    v_and_b32 v83, s66, v129
    v_lshlrev_b32 v104, 16, v130
    v_and_b32 v105, s66, v130
    v_lshlrev_b32 v106, 16, v131
    v_and_b32 v107, s66, v131
    v_add_u32 v13, s62, v12
    s_add_u32 s62, s62, 24576
    s_cmp_eq_u32 s62, 73728
    s_cselect_b32 s62, 0, s62
    s_barrier
    ds_read_b128 v[36:39], v13 offset:0
    ds_read_b128 v[40:43], v13 offset:256
    ds_read_b128 v[44:47], v13 offset:512
    ds_read_b128 v[48:51], v13 offset:3072
    ds_read_b128 v[52:55], v13 offset:3328
    ds_read_b128 v[56:59], v13 offset:3584
    s_waitcnt lgkmcnt(3)
    v_cvt_f32_i32 v36, v36
    v_cvt_f32_i32 v37, v37
    v_cvt_f32_i32 v38, v38
    v_cvt_f32_i32 v39, v39
    v_cvt_f32_i32 v40, v40
    v_cvt_f32_i32 v41, v41
    v_cvt_f32_i32 v42, v42
    v_cvt_f32_i32 v43, v43
    v_cvt_f32_i32 v44, v44
    v_cvt_f32_i32 v45, v45
    v_cvt_f32_i32 v46, v46
    v_cvt_f32_i32 v47, v47
    v_sub_f32 v36, v36, v60
    v_sub_f32 v37, v37, v61
    v_sub_f32 v38, v38, v62
    v_sub_f32 v39, v39, v63
    v_sub_f32 v40, v40, v64
    v_sub_f32 v41, v41, v65
    v_sub_f32 v42, v42, v66
    v_sub_f32 v43, v43, v67
    v_sub_f32 v44, v44, v68
    v_sub_f32 v45, v45, v69
    v_sub_f32 v46, v46, v70
    v_sub_f32 v47, v47, v71
    v_cvt_pk_bf16_f32 v36, 0, v36
    v_cvt_pk_bf16_f32 v37, 0, v37
    v_cvt_pk_bf16_f32 v38, 0, v38
    v_cvt_pk_bf16_f32 v39, 0, v39
    v_cvt_pk_bf16_f32 v40, 0, v40
    v_cvt_pk_bf16_f32 v41, 0, v41
    v_cvt_pk_bf16_f32 v42, 0, v42
    v_cvt_pk_bf16_f32 v43, 0, v43
    v_cvt_pk_bf16_f32 v44, 0, v44
    v_cvt_pk_bf16_f32 v45, 0, v45
    v_cvt_pk_bf16_f32 v46, 0, v46
    v_cvt_pk_bf16_f32 v47, 0, v47
    v_mul_f32 v36, v36, v84
    v_mul_f32 v37, v37, v85
    v_mul_f32 v38, v38, v86
    v_mul_f32 v39, v39, v87
    v_mul_f32 v40, v40, v88
    v_mul_f32 v41, v41, v89
    v_mul_f32 v42, v42, v90
    v_mul_f32 v43, v43, v91
    v_mul_f32 v44, v44, v92
    v_mul_f32 v45, v45, v93
    v_mul_f32 v46, v46, v94
    v_mul_f32 v47, v47, v95
    v_cvt_pk_bf16_f32 v132, v36, v37
    v_cvt_pk_bf16_f32 v133, v38, v39
    v_cvt_pk_bf16_f32 v134, v40, v41
    v_cvt_pk_bf16_f32 v135, v42, v43
    v_cvt_pk_bf16_f32 v136, v44, v45
    v_cvt_pk_bf16_f32 v137, v46, v47
    v_mfma_f32_16x16x16_bf16 v[144:147], v[132:133], v[164:165], 0
    v_mfma_f32_16x16x16_bf16 v[144:147], v[134:135], v[166:167], v[144:147]
    v_mfma_f32_16x16x16_bf16 v[144:147], v[136:137], v[168:169], v[144:147]
    s_waitcnt lgkmcnt(0)
    v_cvt_f32_i32 v48, v48
    v_cvt_f32_i32 v49, v49
    v_cvt_f32_i32 v50, v50
    v_cvt_f32_i32 v51, v51
    v_cvt_f32_i32 v52, v52
    v_cvt_f32_i32 v53, v53
    v_cvt_f32_i32 v54, v54
    v_cvt_f32_i32 v55, v55
    v_cvt_f32_i32 v56, v56
    v_cvt_f32_i32 v57, v57
    v_cvt_f32_i32 v58, v58
    v_cvt_f32_i32 v59, v59
    v_sub_f32 v48, v48, v72
    v_sub_f32 v49, v49, v73
    v_sub_f32 v50, v50, v74
    v_sub_f32 v51, v51, v75
    v_sub_f32 v52, v52, v76
    v_sub_f32 v53, v53, v77
    v_sub_f32 v54, v54, v78
    v_sub_f32 v55, v55, v79
    v_sub_f32 v56, v56, v80
    v_sub_f32 v57, v57, v81
    v_sub_f32 v58, v58, v82
    v_sub_f32 v59, v59, v83
    v_cvt_pk_bf16_f32 v48, 0, v48
    v_cvt_pk_bf16_f32 v49, 0, v49
    v_cvt_pk_bf16_f32 v50, 0, v50
    v_cvt_pk_bf16_f32 v51, 0, v51
    v_cvt_pk_bf16_f32 v52, 0, v52
    v_cvt_pk_bf16_f32 v53, 0, v53
    v_cvt_pk_bf16_f32 v54, 0, v54
    v_cvt_pk_bf16_f32 v55, 0, v55
    v_cvt_pk_bf16_f32 v56, 0, v56
    v_cvt_pk_bf16_f32 v57, 0, v57
    v_cvt_pk_bf16_f32 v58, 0, v58
    v_cvt_pk_bf16_f32 v59, 0, v59
    v_mul_f32 v48, v48, v96
    v_mul_f32 v49, v49, v97
    v_mul_f32 v50, v50, v98
    v_mul_f32 v51, v51, v99
    v_mul_f32 v52, v52, v100
    v_mul_f32 v53, v53, v101
    v_mul_f32 v54, v54, v102
    v_mul_f32 v55, v55, v103
    v_mul_f32 v56, v56, v104
    v_mul_f32 v57, v57, v105
    v_mul_f32 v58, v58, v106
    v_mul_f32 v59, v59, v107
    v_cvt_pk_bf16_f32 v138, v48, v49
    v_cvt_pk_bf16_f32 v139, v50, v51
    v_add_f32_dpp v3, v144, v147 row_ror:12 row_mask:0xf bank_mask:0xf
    v_cvt_pk_bf16_f32 v140, v52, v53
    v_cvt_pk_bf16_f32 v141, v54, v55
    v_add_f32_dpp v3, v145, v3 row_ror:8 row_mask:0xf bank_mask:0xf
    v_cvt_pk_bf16_f32 v142, v56, v57
    v_cvt_pk_bf16_f32 v143, v58, v59
    v_add_f32_dpp v15, v146, v3 row_ror:4 row_mask:0xf bank_mask:0x8
    v_mfma_f32_16x16x16_bf16 v[148:151], v[138:139], v[164:165], 0
    v_mfma_f32_16x16x16_bf16 v[148:151], v[140:141], v[166:167], v[148:151]
    v_mfma_f32_16x16x16_bf16 v[148:151], v[142:143], v[168:169], v[148:151]
    s_add_u32 s63, s63, 3072
    v_add_u32 v33, s63, v17
    v_add_u32 v34, s63, v18
    ds_read_b64 v[108:109], v33 offset:0
    ds_read_b64 v[110:111], v33 offset:1536
    ds_read_b64 v[112:113], v33 offset:128
    ds_read_b64 v[114:115], v33 offset:1664
    ds_read_b64 v[116:117], v33 offset:256
    ds_read_b64 v[118:119], v33 offset:1792
    ds_read_b64 v[120:121], v34 offset:0
    v_add_f32_dpp v4, v148, v151 row_ror:12 row_mask:0xf bank_mask:0xf
    ds_read_b64 v[122:123], v34 offset:1536
    ds_read_b64 v[124:125], v34 offset:128
    v_add_f32_dpp v4, v149, v4 row_ror:8 row_mask:0xf bank_mask:0xf
    ds_read_b64 v[126:127], v34 offset:1664
    ds_read_b64 v[128:129], v34 offset:256
    ds_read_b64 v[130:131], v34 offset:1792
    v_add_f32_dpp v16, v150, v4 row_ror:4 row_mask:0xf bank_mask:0x8
    v_cvt_pk_bf16_f32 v3, 0, v15
    v_cvt_pk_bf16_f32 v4, 0, v16
    v_mul_f32 v3, s65, v3
    v_mul_f32 v4, s65, v4
    v_cvt_pk_bf16_f32 v5, v3, v4
    v_max3_f32 v14, v14, v3, v4
    ds_write_b32 v11, v5 offset:256
    s_waitcnt lgkmcnt(0)
    v_lshlrev_b32 v60, 16, v108
    v_and_b32 v61, s66, v108
    v_lshlrev_b32 v62, 16, v109
    v_and_b32 v63, s66, v109
    v_lshlrev_b32 v84, 16, v110
    v_and_b32 v85, s66, v110
    v_lshlrev_b32 v86, 16, v111
    v_and_b32 v87, s66, v111
    v_lshlrev_b32 v64, 16, v112
    v_and_b32 v65, s66, v112
    v_lshlrev_b32 v66, 16, v113
    v_and_b32 v67, s66, v113
    v_lshlrev_b32 v88, 16, v114
    v_and_b32 v89, s66, v114
    v_lshlrev_b32 v90, 16, v115
    v_and_b32 v91, s66, v115
    v_lshlrev_b32 v68, 16, v116
    v_and_b32 v69, s66, v116
    v_lshlrev_b32 v70, 16, v117
    v_and_b32 v71, s66, v117
    v_lshlrev_b32 v92, 16, v118
    v_and_b32 v93, s66, v118
    v_lshlrev_b32 v94, 16, v119
    v_and_b32 v95, s66, v119
    v_lshlrev_b32 v72, 16, v120
    v_and_b32 v73, s66, v120
    v_lshlrev_b32 v74, 16, v121
    v_and_b32 v75, s66, v121
    v_lshlrev_b32 v96, 16, v122
    v_and_b32 v97, s66, v122
    v_lshlrev_b32 v98, 16, v123
    v_and_b32 v99, s66, v123
    v_lshlrev_b32 v76, 16, v124
    v_and_b32 v77, s66, v124
    v_lshlrev_b32 v78, 16, v125
    v_and_b32 v79, s66, v125
    v_lshlrev_b32 v100, 16, v126
    v_and_b32 v101, s66, v126
    v_lshlrev_b32 v102, 16, v127
    v_and_b32 v103, s66, v127
    v_lshlrev_b32 v80, 16, v128
    v_and_b32 v81, s66, v128
    v_lshlrev_b32 v82, 16, v129
    v_and_b32 v83, s66, v129
    v_lshlrev_b32 v104, 16, v130
    v_and_b32 v105, s66, v130
    v_lshlrev_b32 v106, 16, v131
    v_and_b32 v107, s66, v131
    v_add_u32 v11, 3072, v11
    s_add_u32 s61, s61, 1
    s_cmp_eq_u32 s61, s3
    s_cbranch_scc1 L_kblk_end
    s_cmp_eq_u32 s61, s73
    s_cbranch_scc1 L_kblk_end
    s_cmp_lt_u32 s61, 16
    s_cbranch_scc1 L_kblk
L_kblk_end:
    s_nop 1
    v_max_f32_dpp v14, v14, v14 row_ror:4 row_mask:0xf bank_mask:0xf
    s_nop 1
    v_max_f32_dpp v14, v14, v14 row_ror:8 row_mask:0xf bank_mask:0xf
    v_mov_b32 v3, v14
    s_nop 1
    v_permlane16_swap_b32 v14, v3
    v_max_f32 v14, v14, v3
    v_mov_b32 v3, v14
    s_nop 1
    v_permlane32_swap_b32 v14, v3
    v_max_f32 v14, v14, v3
    v_cvt_pk_bf16_f32 v14, 0, v14
    v_mul_f32 v14, s64, v14
    ds_write_b32 v154, v14
    v_add_u32 v154, 64, v154
    ds_read_b64 v[164:165], v153 offset:0
    ds_read_b64 v[166:167], v153 offset:128
    ds_read_b64 v[168:169], v153 offset:256
    v_add_u32 v153, 1536, v153
    v_mov_b32 v14, 0xff800000
    s_waitcnt lgkmcnt(0)
    s_cmp_lt_u32 s61, 16
    s_cbranch_scc1 L_kblk
    v_lshrrev_b32 v3, 4, v1
    v_and_b32 v4, 15, v1
    v_lshl_add_u32 v3, v2, 3, v3
    v_mul_u32_u24 v3, 768, v3
    v_lshl_add_u32 v12, v4, 4, v3
    v_subrev_u32 v11, 49152, v11
    s_mov_b32 s63, 0
    v_add_u32 v215, s63, v7
    v_add_u32 v216, s63, v8
    ds_read_b32 v214, v11 offset:0
    ds_read_u16 v217, v215 offset:512
    ds_read_u16 v218, v216 offset:512
    ds_read_u16 v215, v215
    ds_read_u16 v216, v216
    v_mov_b32 v188, 0
    v_mov_b32 v189, 0
    v_mov_b32 v190, 0
    v_mov_b32 v191, 0
    v_mov_b32 v192, 0
    v_mov_b32 v193, 0
    v_mov_b32 v194, 0
    v_mov_b32 v195, 0
    v_mov_b32 v196, 0
    v_mov_b32 v197, 0
    v_mov_b32 v198, 0
    v_mov_b32 v199, 0
    v_mov_b32 v200, 0
    v_mov_b32 v201, 0
    v_mov_b32 v202, 0
    v_mov_b32 v203, 0
    s_mov_b32 s61, 0
    v_and_b32 v3, 3, v1
    v_lshlrev_b32 v20, 4, v3
    v_add_u32 v154, 154944, v20
    v_add_u32 v18, 142336, v20
    v_lshl_add_u32 v156, v2, 6, v18
    v_lshl_add_u32 v20, v2, 6, v20
    v_add_u32 v20, 3072, v20
    v_mul_u32_u24 v155, 3072, v2
    v_lshl_add_u32 v155, v1, 4, v155
    v_add_u32 v155, 142592, v155
    v_lshlrev_b32 v4, 10, v2
    v_lshl_add_u32 v19, v1, 4, v4
    v_lshl_add_u32 v17, v1, 2, v4
    v_add_u32 v17, 142592, v17
    v_mul_u32_u24 v21, 384, v3
    v_lshrrev_b32 v4, 2, v1
    v_lshl_add_u32 v21, v4, 3, v21
    v_lshl_add_u32 v21, v2, 7, v21
    s_mov_b32 s48, s18
    s_and_b32 s49, s19, 0xffff
    s_mov_b32 s50, 393216
    s_mov_b32 s51, 0x20000
    s_mov_b32 s24, s22
    s_and_b32 s25, s23, 0xffff
    s_mov_b32 s26, 848640
    s_mov_b32 s27, 0x20000
    s_mul_i32 s68, s100, 9984
    s_mul_i32 s71, s2, 3328
    s_add_u32 s69, s68, 3328
    s_add_u32 s70, s68, 6656
    s_sub_u32 s57, 255, s100
    s_mul_i32 s57, s57, 1536
    s_mov_b32 s84, 0x7060500
    s_mov_b32 s85, 0x7060501
    s_mov_b32 s86, 0x7060502
    s_mov_b32 s87, 0x7060503
    s_mov_b32 s88, 0x0c0c0400
    s_mov_b32 s89, 0x04000c0c
    s_mov_b32 s90, 0xffffff00
L_vround:
    v_mov_b32 v164, 0
    v_mov_b32 v165, 0
    v_mov_b32 v166, 0
    v_mov_b32 v167, 0
    v_mov_b32 v168, 0
    v_mov_b32 v169, 0
    v_mov_b32 v170, 0
    v_mov_b32 v171, 0
    v_mov_b32 v172, 0
    v_mov_b32 v173, 0
    v_mov_b32 v174, 0
    v_mov_b32 v175, 0
    v_mov_b32 v212, 0
    v_mov_b32 v213, 0
L_vblk:
    s_add_u32 s61, s61, 1
    s_cmp_eq_u32 s61, s3
    s_cselect_b32 s74, 1, 0
    s_cmp_eq_u32 s61, s73
    s_cselect_b32 s74, 1, s74
    s_cmp_eq_u32 s61, 16
    s_cselect_b32 s74, 1, s74
    v_add_u32 v13, s62, v12
    s_add_u32 s62, s62, 24576
    s_cmp_eq_u32 s62, 73728
    s_cselect_b32 s62, 0, s62
    s_barrier
    ds_read_b128 v[160:163], v154
    ds_read_b128 v[36:39], v13 offset:0
    ds_read_b128 v[48:51], v13 offset:3072
    ds_read_b128 v[40:43], v13 offset:256
    ds_read_b128 v[52:55], v13 offset:3328
    ds_read_b128 v[44:47], v13 offset:512
    ds_read_b128 v[56:59], v13 offset:3584
    s_waitcnt lgkmcnt(6)
    v_max_f32 v14, v160, v161
    v_max3_f32 v14, v14, v162, v163
    s_waitcnt lgkmcnt(6)
    v_lshlrev_b32 v219, 16, v214
    v_and_b32 v220, s66, v214
    v_fma_f32 v219, v219, s64, -v14
    v_fma_f32 v220, v220, s64, -v14
    v_exp_f32 v219, v219
    v_exp_f32 v220, v220
    v_lshlrev_b32 v221, 16, v215
    v_lshlrev_b32 v222, 16, v216
    v_mul_f32 v221, v219, v221
    v_mul_f32 v222, v220, v222
    v_add_f32 v212, v212, v219
    v_cvt_pk_bf16_f32 v221, v221, v222
    v_add_f32 v212, v212, v220
    v_lshlrev_b32 v223, 16, v217
    v_lshlrev_b32 v224, 16, v218
    v_lshlrev_b32 v219, 16, v221
    v_and_b32 v220, s66, v221
    v_fmac_f32 v213, v219, v223
    v_fmac_f32 v213, v220, v224
    v_mov_b32_dpp v188, v221 quad_perm:[0,1,2,3] row_mask:0xf bank_mask:0x1
    v_mov_b32_dpp v189, v221 row_ror:12 row_mask:0xf bank_mask:0x1
    v_mov_b32_dpp v190, v221 row_ror:8 row_mask:0xf bank_mask:0x1
    v_mov_b32_dpp v191, v221 row_ror:4 row_mask:0xf bank_mask:0x1
    v_mov_b32_dpp v192, v221 row_ror:4 row_mask:0xf bank_mask:0x2
    v_mov_b32_dpp v193, v221 quad_perm:[0,1,2,3] row_mask:0xf bank_mask:0x2
    v_mov_b32_dpp v194, v221 row_ror:12 row_mask:0xf bank_mask:0x2
    v_mov_b32_dpp v195, v221 row_ror:8 row_mask:0xf bank_mask:0x2
    v_mov_b32_dpp v196, v221 row_ror:8 row_mask:0xf bank_mask:0x4
    v_mov_b32_dpp v197, v221 row_ror:4 row_mask:0xf bank_mask:0x4
    v_mov_b32_dpp v198, v221 quad_perm:[0,1,2,3] row_mask:0xf bank_mask:0x4
    v_mov_b32_dpp v199, v221 row_ror:12 row_mask:0xf bank_mask:0x4
    v_mov_b32_dpp v200, v221 row_ror:12 row_mask:0xf bank_mask:0x8
    v_mov_b32_dpp v201, v221 row_ror:8 row_mask:0xf bank_mask:0x8
    v_mov_b32_dpp v202, v221 row_ror:4 row_mask:0xf bank_mask:0x8
    v_mov_b32_dpp v203, v221 quad_perm:[0,1,2,3] row_mask:0xf bank_mask:0x8
    s_waitcnt lgkmcnt(4)
    v_cvt_f32_i32 v36, v36
    v_cvt_f32_i32 v37, v37
    v_cvt_f32_i32 v38, v38
    v_cvt_f32_i32 v39, v39
    v_cvt_f32_i32 v48, v48
    v_cvt_f32_i32 v49, v49
    v_cvt_f32_i32 v50, v50
    v_cvt_f32_i32 v51, v51
    v_cvt_pk_bf16_f32 v60, v36, v48
    v_cvt_pk_bf16_f32 v64, v37, v49
    v_cvt_pk_bf16_f32 v68, v38, v50
    v_cvt_pk_bf16_f32 v72, v39, v51
    s_waitcnt lgkmcnt(2)
    v_cvt_f32_i32 v40, v40
    v_cvt_f32_i32 v41, v41
    v_cvt_f32_i32 v42, v42
    v_cvt_f32_i32 v43, v43
    v_cvt_f32_i32 v52, v52
    v_cvt_f32_i32 v53, v53
    v_cvt_f32_i32 v54, v54
    v_cvt_f32_i32 v55, v55
    v_cvt_pk_bf16_f32 v76, v40, v52
    v_cvt_pk_bf16_f32 v80, v41, v53
    v_cvt_pk_bf16_f32 v84, v42, v54
    v_cvt_pk_bf16_f32 v88, v43, v55
    s_waitcnt lgkmcnt(0)
    v_cvt_f32_i32 v44, v44
    v_cvt_f32_i32 v45, v45
    v_cvt_f32_i32 v46, v46
    v_cvt_f32_i32 v47, v47
    v_cvt_f32_i32 v56, v56
    v_cvt_f32_i32 v57, v57
    v_cvt_f32_i32 v58, v58
    v_cvt_f32_i32 v59, v59
    v_cvt_pk_bf16_f32 v92, v44, v56
    v_cvt_pk_bf16_f32 v96, v45, v57
    v_cvt_pk_bf16_f32 v100, v46, v58
    v_cvt_pk_bf16_f32 v104, v47, v59
    v_add_u32 v215, s63, v9
    v_add_u32 v216, s63, v10
    ds_read_b32 v214, v11 offset:256
    ds_read_u16 v217, v215 offset:512
    ds_read_u16 v218, v216 offset:512
    ds_read_u16 v215, v215
    ds_read_u16 v216, v216
    v_add_u32 v13, s62, v12
    s_add_u32 s62, s62, 24576
    s_cmp_eq_u32 s62, 73728
    s_cselect_b32 s62, 0, s62
    s_barrier
    ds_read_b128 v[36:39], v13 offset:0
    ds_read_b128 v[48:51], v13 offset:3072
    ds_read_b128 v[40:43], v13 offset:256
    ds_read_b128 v[52:55], v13 offset:3328
    ds_read_b128 v[44:47], v13 offset:512
    ds_read_b128 v[56:59], v13 offset:3584
    s_waitcnt lgkmcnt(4)
    v_cvt_f32_i32 v36, v36
    v_cvt_f32_i32 v37, v37
    v_cvt_f32_i32 v38, v38
    v_cvt_f32_i32 v39, v39
    v_cvt_f32_i32 v48, v48
    v_cvt_f32_i32 v49, v49
    v_cvt_f32_i32 v50, v50
    v_cvt_f32_i32 v51, v51
    v_cvt_pk_bf16_f32 v61, v36, v48
    v_cvt_pk_bf16_f32 v65, v37, v49
    v_cvt_pk_bf16_f32 v69, v38, v50
    v_cvt_pk_bf16_f32 v73, v39, v51
    s_waitcnt lgkmcnt(2)
    v_cvt_f32_i32 v40, v40
    v_cvt_f32_i32 v41, v41
    v_cvt_f32_i32 v42, v42
    v_cvt_f32_i32 v43, v43
    v_cvt_f32_i32 v52, v52
    v_cvt_f32_i32 v53, v53
    v_cvt_f32_i32 v54, v54
    v_cvt_f32_i32 v55, v55
    v_cvt_pk_bf16_f32 v77, v40, v52
    v_cvt_pk_bf16_f32 v81, v41, v53
    v_cvt_pk_bf16_f32 v85, v42, v54
    v_cvt_pk_bf16_f32 v89, v43, v55
    s_waitcnt lgkmcnt(0)
    v_cvt_f32_i32 v44, v44
    v_cvt_f32_i32 v45, v45
    v_cvt_f32_i32 v46, v46
    v_cvt_f32_i32 v47, v47
    v_cvt_f32_i32 v56, v56
    v_cvt_f32_i32 v57, v57
    v_cvt_f32_i32 v58, v58
    v_cvt_f32_i32 v59, v59
    v_cvt_pk_bf16_f32 v93, v44, v56
    v_cvt_pk_bf16_f32 v97, v45, v57
    v_cvt_pk_bf16_f32 v101, v46, v58
    v_cvt_pk_bf16_f32 v105, v47, v59
    v_add_u32 v13, s62, v12
    s_add_u32 s62, s62, 24576
    s_cmp_eq_u32 s62, 73728
    s_cselect_b32 s62, 0, s62
    s_barrier
    ds_read_b128 v[36:39], v13 offset:0
    ds_read_b128 v[48:51], v13 offset:3072
    ds_read_b128 v[40:43], v13 offset:256
    ds_read_b128 v[52:55], v13 offset:3328
    ds_read_b128 v[44:47], v13 offset:512
    ds_read_b128 v[56:59], v13 offset:3584
    s_waitcnt lgkmcnt(4)
    v_cvt_f32_i32 v36, v36
    v_cvt_f32_i32 v37, v37
    v_cvt_f32_i32 v38, v38
    v_cvt_f32_i32 v39, v39
    v_cvt_f32_i32 v48, v48
    v_cvt_f32_i32 v49, v49
    v_cvt_f32_i32 v50, v50
    v_cvt_f32_i32 v51, v51
    v_cvt_pk_bf16_f32 v62, v36, v48
    v_cvt_pk_bf16_f32 v66, v37, v49
    v_cvt_pk_bf16_f32 v70, v38, v50
    v_cvt_pk_bf16_f32 v74, v39, v51
    s_waitcnt lgkmcnt(2)
    v_cvt_f32_i32 v40, v40
    v_cvt_f32_i32 v41, v41
    v_cvt_f32_i32 v42, v42
    v_cvt_f32_i32 v43, v43
    v_cvt_f32_i32 v52, v52
    v_cvt_f32_i32 v53, v53
    v_cvt_f32_i32 v54, v54
    v_cvt_f32_i32 v55, v55
    v_cvt_pk_bf16_f32 v78, v40, v52
    v_cvt_pk_bf16_f32 v82, v41, v53
    v_cvt_pk_bf16_f32 v86, v42, v54
    v_cvt_pk_bf16_f32 v90, v43, v55
    s_waitcnt lgkmcnt(0)
    v_cvt_f32_i32 v44, v44
    v_cvt_f32_i32 v45, v45
    v_cvt_f32_i32 v46, v46
    v_cvt_f32_i32 v47, v47
    v_cvt_f32_i32 v56, v56
    v_cvt_f32_i32 v57, v57
    v_cvt_f32_i32 v58, v58
    v_cvt_f32_i32 v59, v59
    v_cvt_pk_bf16_f32 v94, v44, v56
    v_cvt_pk_bf16_f32 v98, v45, v57
    v_cvt_pk_bf16_f32 v102, v46, v58
    v_cvt_pk_bf16_f32 v106, v47, v59
    v_add_u32 v13, s62, v12
    s_add_u32 s62, s62, 24576
    s_cmp_eq_u32 s62, 73728
    s_cselect_b32 s62, 0, s62
    s_barrier
    ds_read_b128 v[36:39], v13 offset:0
    ds_read_b128 v[48:51], v13 offset:3072
    ds_read_b128 v[40:43], v13 offset:256
    ds_read_b128 v[52:55], v13 offset:3328
    ds_read_b128 v[44:47], v13 offset:512
    ds_read_b128 v[56:59], v13 offset:3584
    s_waitcnt lgkmcnt(4)
    v_cvt_f32_i32 v36, v36
    v_cvt_f32_i32 v37, v37
    v_cvt_f32_i32 v38, v38
    v_cvt_f32_i32 v39, v39
    v_cvt_f32_i32 v48, v48
    v_cvt_f32_i32 v49, v49
    v_cvt_f32_i32 v50, v50
    v_cvt_f32_i32 v51, v51
    v_cvt_pk_bf16_f32 v63, v36, v48
    v_cvt_pk_bf16_f32 v67, v37, v49
    v_cvt_pk_bf16_f32 v71, v38, v50
    v_cvt_pk_bf16_f32 v75, v39, v51
    s_waitcnt lgkmcnt(2)
    v_cvt_f32_i32 v40, v40
    v_cvt_f32_i32 v41, v41
    v_cvt_f32_i32 v42, v42
    v_mfma_f32_16x16x32_bf16 v[164:167], v[188:191], v[60:63], v[164:167]
    v_cvt_f32_i32 v43, v43
    v_cvt_f32_i32 v52, v52
    v_cvt_f32_i32 v53, v53
    v_mfma_f32_16x16x32_bf16 v[164:167], v[192:195], v[64:67], v[164:167]
    v_cvt_f32_i32 v54, v54
    v_cvt_f32_i32 v55, v55
    v_cvt_pk_bf16_f32 v79, v40, v52
    v_mfma_f32_16x16x32_bf16 v[164:167], v[196:199], v[68:71], v[164:167]
    v_cvt_pk_bf16_f32 v83, v41, v53
    v_cvt_pk_bf16_f32 v87, v42, v54
    v_cvt_pk_bf16_f32 v91, v43, v55
    v_mfma_f32_16x16x32_bf16 v[164:167], v[200:203], v[72:75], v[164:167]
    s_waitcnt lgkmcnt(0)
    v_cvt_f32_i32 v44, v44
    v_cvt_f32_i32 v45, v45
    v_cvt_f32_i32 v46, v46
    v_mfma_f32_16x16x32_bf16 v[168:171], v[188:191], v[76:79], v[168:171]
    v_cvt_f32_i32 v47, v47
    v_cvt_f32_i32 v56, v56
    v_cvt_f32_i32 v57, v57
    v_mfma_f32_16x16x32_bf16 v[168:171], v[192:195], v[80:83], v[168:171]
    v_cvt_f32_i32 v58, v58
    v_cvt_f32_i32 v59, v59
    v_cvt_pk_bf16_f32 v95, v44, v56
    v_mfma_f32_16x16x32_bf16 v[168:171], v[196:199], v[84:87], v[168:171]
    v_cvt_pk_bf16_f32 v99, v45, v57
    v_cvt_pk_bf16_f32 v103, v46, v58
    v_cvt_pk_bf16_f32 v107, v47, v59
    v_mfma_f32_16x16x32_bf16 v[168:171], v[200:203], v[88:91], v[168:171]
    v_mfma_f32_16x16x32_bf16 v[172:175], v[188:191], v[92:95], v[172:175]
    v_mfma_f32_16x16x32_bf16 v[172:175], v[192:195], v[96:99], v[172:175]
    v_mfma_f32_16x16x32_bf16 v[172:175], v[196:199], v[100:103], v[172:175]
    v_mfma_f32_16x16x32_bf16 v[172:175], v[200:203], v[104:107], v[172:175]
    v_add_u32 v13, s62, v12
    s_add_u32 s62, s62, 24576
    s_cmp_eq_u32 s62, 73728
    s_cselect_b32 s62, 0, s62
    s_barrier
    ds_read_b128 v[36:39], v13 offset:0
    ds_read_b128 v[48:51], v13 offset:3072
    ds_read_b128 v[40:43], v13 offset:256
    ds_read_b128 v[52:55], v13 offset:3328
    ds_read_b128 v[44:47], v13 offset:512
    ds_read_b128 v[56:59], v13 offset:3584
    s_waitcnt lgkmcnt(6)
    v_lshlrev_b32 v219, 16, v214
    v_and_b32 v220, s66, v214
    v_fma_f32 v219, v219, s64, -v14
    v_fma_f32 v220, v220, s64, -v14
    v_exp_f32 v219, v219
    v_exp_f32 v220, v220
    v_lshlrev_b32 v221, 16, v215
    v_lshlrev_b32 v222, 16, v216
    v_mul_f32 v221, v219, v221
    v_mul_f32 v222, v220, v222
    v_add_f32 v212, v212, v219
    v_cvt_pk_bf16_f32 v221, v221, v222
    v_add_f32 v212, v212, v220
    v_lshlrev_b32 v223, 16, v217
    v_lshlrev_b32 v224, 16, v218
    v_lshlrev_b32 v219, 16, v221
    v_and_b32 v220, s66, v221
    v_fmac_f32 v213, v219, v223
    v_fmac_f32 v213, v220, v224
    v_mov_b32_dpp v188, v221 quad_perm:[0,1,2,3] row_mask:0xf bank_mask:0x1
    v_mov_b32_dpp v189, v221 row_ror:12 row_mask:0xf bank_mask:0x1
    v_mov_b32_dpp v190, v221 row_ror:8 row_mask:0xf bank_mask:0x1
    v_mov_b32_dpp v191, v221 row_ror:4 row_mask:0xf bank_mask:0x1
    v_mov_b32_dpp v192, v221 row_ror:4 row_mask:0xf bank_mask:0x2
    v_mov_b32_dpp v193, v221 quad_perm:[0,1,2,3] row_mask:0xf bank_mask:0x2
    v_mov_b32_dpp v194, v221 row_ror:12 row_mask:0xf bank_mask:0x2
    v_mov_b32_dpp v195, v221 row_ror:8 row_mask:0xf bank_mask:0x2
    v_mov_b32_dpp v196, v221 row_ror:8 row_mask:0xf bank_mask:0x4
    v_mov_b32_dpp v197, v221 row_ror:4 row_mask:0xf bank_mask:0x4
    v_mov_b32_dpp v198, v221 quad_perm:[0,1,2,3] row_mask:0xf bank_mask:0x4
    v_mov_b32_dpp v199, v221 row_ror:12 row_mask:0xf bank_mask:0x4
    v_mov_b32_dpp v200, v221 row_ror:12 row_mask:0xf bank_mask:0x8
    v_mov_b32_dpp v201, v221 row_ror:8 row_mask:0xf bank_mask:0x8
    v_mov_b32_dpp v202, v221 row_ror:4 row_mask:0xf bank_mask:0x8
    v_mov_b32_dpp v203, v221 quad_perm:[0,1,2,3] row_mask:0xf bank_mask:0x8
    s_waitcnt lgkmcnt(4)
    v_cvt_f32_i32 v36, v36
    v_cvt_f32_i32 v37, v37
    v_cvt_f32_i32 v38, v38
    v_cvt_f32_i32 v39, v39
    v_cvt_f32_i32 v48, v48
    v_cvt_f32_i32 v49, v49
    v_cvt_f32_i32 v50, v50
    v_cvt_f32_i32 v51, v51
    v_cvt_pk_bf16_f32 v60, v36, v48
    v_cvt_pk_bf16_f32 v64, v37, v49
    v_cvt_pk_bf16_f32 v68, v38, v50
    v_cvt_pk_bf16_f32 v72, v39, v51
    s_waitcnt lgkmcnt(2)
    v_cvt_f32_i32 v40, v40
    v_cvt_f32_i32 v41, v41
    v_cvt_f32_i32 v42, v42
    v_cvt_f32_i32 v43, v43
    v_cvt_f32_i32 v52, v52
    v_cvt_f32_i32 v53, v53
    v_cvt_f32_i32 v54, v54
    v_cvt_f32_i32 v55, v55
    v_cvt_pk_bf16_f32 v76, v40, v52
    v_cvt_pk_bf16_f32 v80, v41, v53
    v_cvt_pk_bf16_f32 v84, v42, v54
    v_cvt_pk_bf16_f32 v88, v43, v55
    s_waitcnt lgkmcnt(0)
    v_cvt_f32_i32 v44, v44
    v_cvt_f32_i32 v45, v45
    v_cvt_f32_i32 v46, v46
    v_cvt_f32_i32 v47, v47
    v_cvt_f32_i32 v56, v56
    v_cvt_f32_i32 v57, v57
    v_cvt_f32_i32 v58, v58
    v_cvt_f32_i32 v59, v59
    v_cvt_pk_bf16_f32 v92, v44, v56
    v_cvt_pk_bf16_f32 v96, v45, v57
    v_cvt_pk_bf16_f32 v100, v46, v58
    v_cvt_pk_bf16_f32 v104, v47, v59
    v_add_u32 v11, 3072, v11
    s_add_u32 s63, s63, 1024
    v_add_u32 v215, s63, v7
    v_add_u32 v216, s63, v8
    ds_read_b32 v214, v11 offset:0
    ds_read_u16 v217, v215 offset:512
    ds_read_u16 v218, v216 offset:512
    ds_read_u16 v215, v215
    ds_read_u16 v216, v216
    v_add_u32 v13, s62, v12
    s_add_u32 s62, s62, 24576
    s_cmp_eq_u32 s62, 73728
    s_cselect_b32 s62, 0, s62
    s_barrier
    ds_read_b128 v[36:39], v13 offset:0
    ds_read_b128 v[48:51], v13 offset:3072
    ds_read_b128 v[40:43], v13 offset:256
    ds_read_b128 v[52:55], v13 offset:3328
    ds_read_b128 v[44:47], v13 offset:512
    ds_read_b128 v[56:59], v13 offset:3584
    s_waitcnt lgkmcnt(4)
    v_cvt_f32_i32 v36, v36
    v_cvt_f32_i32 v37, v37
    v_cvt_f32_i32 v38, v38
    v_cvt_f32_i32 v39, v39
    v_cvt_f32_i32 v48, v48
    v_cvt_f32_i32 v49, v49
    v_cvt_f32_i32 v50, v50
    v_cvt_f32_i32 v51, v51
    v_cvt_pk_bf16_f32 v61, v36, v48
    v_cvt_pk_bf16_f32 v65, v37, v49
    v_cvt_pk_bf16_f32 v69, v38, v50
    v_cvt_pk_bf16_f32 v73, v39, v51
    s_waitcnt lgkmcnt(2)
    v_cvt_f32_i32 v40, v40
    v_cvt_f32_i32 v41, v41
    v_cvt_f32_i32 v42, v42
    v_cvt_f32_i32 v43, v43
    v_cvt_f32_i32 v52, v52
    v_cvt_f32_i32 v53, v53
    v_cvt_f32_i32 v54, v54
    v_cvt_f32_i32 v55, v55
    v_cvt_pk_bf16_f32 v77, v40, v52
    v_cvt_pk_bf16_f32 v81, v41, v53
    v_cvt_pk_bf16_f32 v85, v42, v54
    v_cvt_pk_bf16_f32 v89, v43, v55
    s_waitcnt lgkmcnt(0)
    v_cvt_f32_i32 v44, v44
    v_cvt_f32_i32 v45, v45
    v_cvt_f32_i32 v46, v46
    v_cvt_f32_i32 v47, v47
    v_cvt_f32_i32 v56, v56
    v_cvt_f32_i32 v57, v57
    v_cvt_f32_i32 v58, v58
    v_cvt_f32_i32 v59, v59
    v_cvt_pk_bf16_f32 v93, v44, v56
    v_cvt_pk_bf16_f32 v97, v45, v57
    v_cvt_pk_bf16_f32 v101, v46, v58
    v_cvt_pk_bf16_f32 v105, v47, v59
    s_cmp_eq_u32 s74, 0
    s_cbranch_scc1 L_vnostat
    v_mov_b32 v22, 154884
    ds_read_b32 v22, v22
    s_nop 1
    v_add_f32_dpp v212, v212, v212 row_ror:4 row_mask:0xf bank_mask:0xf
    s_nop 1
    v_add_f32_dpp v212, v212, v212 row_ror:8 row_mask:0xf bank_mask:0xf
    v_mov_b32 v3, v212
    s_nop 1
    v_permlane16_swap_b32 v212, v3
    v_add_f32 v212, v212, v3
    v_mov_b32 v3, v212
    s_nop 1
    v_permlane32_swap_b32 v212, v3
    v_add_f32 v212, v212, v3
    s_nop 1
    v_add_f32_dpp v213, v213, v213 row_ror:4 row_mask:0xf bank_mask:0xf
    s_nop 1
    v_add_f32_dpp v213, v213, v213 row_ror:8 row_mask:0xf bank_mask:0xf
    v_mov_b32 v3, v213
    s_nop 1
    v_permlane16_swap_b32 v213, v3
    v_add_f32 v213, v213, v3
    v_mov_b32 v3, v213
    s_nop 1
    v_permlane32_swap_b32 v213, v3
    v_add_f32 v213, v213, v3
    v_mov_b32 v160, v14
    v_mov_b32 v161, v212
    v_mov_b32 v162, v213
    ds_write_b128 v156, v[160:163]
    v_add_u32 v154, 64, v154
L_vnostat:
    v_add_u32 v13, s62, v12
    s_add_u32 s62, s62, 24576
    s_cmp_eq_u32 s62, 73728
    s_cselect_b32 s62, 0, s62
    s_barrier
    ds_read_b128 v[36:39], v13 offset:0
    ds_read_b128 v[48:51], v13 offset:3072
    ds_read_b128 v[40:43], v13 offset:256
    ds_read_b128 v[52:55], v13 offset:3328
    ds_read_b128 v[44:47], v13 offset:512
    ds_read_b128 v[56:59], v13 offset:3584
    s_waitcnt lgkmcnt(4)
    v_cvt_f32_i32 v36, v36
    v_cvt_f32_i32 v37, v37
    v_cvt_f32_i32 v38, v38
    v_cvt_f32_i32 v39, v39
    v_cvt_f32_i32 v48, v48
    v_cvt_f32_i32 v49, v49
    v_cvt_f32_i32 v50, v50
    v_cvt_f32_i32 v51, v51
    v_cvt_pk_bf16_f32 v62, v36, v48
    v_cvt_pk_bf16_f32 v66, v37, v49
    v_cvt_pk_bf16_f32 v70, v38, v50
    v_cvt_pk_bf16_f32 v74, v39, v51
    s_waitcnt lgkmcnt(2)
    v_cvt_f32_i32 v40, v40
    v_cvt_f32_i32 v41, v41
    v_cvt_f32_i32 v42, v42
    v_cvt_f32_i32 v43, v43
    v_cvt_f32_i32 v52, v52
    v_cvt_f32_i32 v53, v53
    v_cvt_f32_i32 v54, v54
    v_cvt_f32_i32 v55, v55
    v_cvt_pk_bf16_f32 v78, v40, v52
    v_cvt_pk_bf16_f32 v82, v41, v53
    v_cvt_pk_bf16_f32 v86, v42, v54
    v_cvt_pk_bf16_f32 v90, v43, v55
    s_waitcnt lgkmcnt(0)
    v_cvt_f32_i32 v44, v44
    v_cvt_f32_i32 v45, v45
    v_cvt_f32_i32 v46, v46
    v_cvt_f32_i32 v47, v47
    v_cvt_f32_i32 v56, v56
    v_cvt_f32_i32 v57, v57
    v_cvt_f32_i32 v58, v58
    v_cvt_f32_i32 v59, v59
    v_cvt_pk_bf16_f32 v94, v44, v56
    v_cvt_pk_bf16_f32 v98, v45, v57
    v_cvt_pk_bf16_f32 v102, v46, v58
    v_cvt_pk_bf16_f32 v106, v47, v59
    v_add_u32 v13, s62, v12
    s_add_u32 s62, s62, 24576
    s_cmp_eq_u32 s62, 73728
    s_cselect_b32 s62, 0, s62
    s_barrier
    ds_read_b128 v[36:39], v13 offset:0
    ds_read_b128 v[48:51], v13 offset:3072
    ds_read_b128 v[40:43], v13 offset:256
    ds_read_b128 v[52:55], v13 offset:3328
    ds_read_b128 v[44:47], v13 offset:512
    ds_read_b128 v[56:59], v13 offset:3584
    s_waitcnt lgkmcnt(4)
    v_cvt_f32_i32 v36, v36
    v_cvt_f32_i32 v37, v37
    v_cvt_f32_i32 v38, v38
    v_cvt_f32_i32 v39, v39
    v_cvt_f32_i32 v48, v48
    v_cvt_f32_i32 v49, v49
    v_cvt_f32_i32 v50, v50
    v_cvt_f32_i32 v51, v51
    v_cvt_pk_bf16_f32 v63, v36, v48
    v_cvt_pk_bf16_f32 v67, v37, v49
    v_cvt_pk_bf16_f32 v71, v38, v50
    v_cvt_pk_bf16_f32 v75, v39, v51
    s_waitcnt lgkmcnt(2)
    v_cvt_f32_i32 v40, v40
    v_cvt_f32_i32 v41, v41
    v_cvt_f32_i32 v42, v42
    v_mfma_f32_16x16x32_bf16 v[164:167], v[188:191], v[60:63], v[164:167]
    v_cvt_f32_i32 v43, v43
    v_cvt_f32_i32 v52, v52
    v_cvt_f32_i32 v53, v53
    v_mfma_f32_16x16x32_bf16 v[164:167], v[192:195], v[64:67], v[164:167]
    v_cvt_f32_i32 v54, v54
    v_cvt_f32_i32 v55, v55
    v_cvt_pk_bf16_f32 v79, v40, v52
    v_mfma_f32_16x16x32_bf16 v[164:167], v[196:199], v[68:71], v[164:167]
    v_cvt_pk_bf16_f32 v83, v41, v53
    v_cvt_pk_bf16_f32 v87, v42, v54
    v_cvt_pk_bf16_f32 v91, v43, v55
    v_mfma_f32_16x16x32_bf16 v[164:167], v[200:203], v[72:75], v[164:167]
    s_waitcnt lgkmcnt(0)
    v_cvt_f32_i32 v44, v44
    v_cvt_f32_i32 v45, v45
    v_cvt_f32_i32 v46, v46
    v_mfma_f32_16x16x32_bf16 v[168:171], v[188:191], v[76:79], v[168:171]
    v_cvt_f32_i32 v47, v47
    v_cvt_f32_i32 v56, v56
    v_cvt_f32_i32 v57, v57
    v_mfma_f32_16x16x32_bf16 v[168:171], v[192:195], v[80:83], v[168:171]
    v_cvt_f32_i32 v58, v58
    v_cvt_f32_i32 v59, v59
    v_cvt_pk_bf16_f32 v95, v44, v56
    v_mfma_f32_16x16x32_bf16 v[168:171], v[196:199], v[84:87], v[168:171]
    v_cvt_pk_bf16_f32 v99, v45, v57
    v_cvt_pk_bf16_f32 v103, v46, v58
    v_cvt_pk_bf16_f32 v107, v47, v59
    v_mfma_f32_16x16x32_bf16 v[168:171], v[200:203], v[88:91], v[168:171]
    v_mfma_f32_16x16x32_bf16 v[172:175], v[188:191], v[92:95], v[172:175]
    v_mfma_f32_16x16x32_bf16 v[172:175], v[192:195], v[96:99], v[172:175]
    v_mfma_f32_16x16x32_bf16 v[172:175], v[196:199], v[100:103], v[172:175]
    v_mfma_f32_16x16x32_bf16 v[172:175], v[200:203], v[104:107], v[172:175]
    s_cmp_eq_u32 s74, 0
    s_cbranch_scc1 L_vblk
    ds_write_b128 v155, v[164:167]
    s_nop 0
    ds_write_b128 v155, v[168:171] offset:1024
    s_cmp_lt_u32 s61, 16
    s_nop 1
    ds_write_b128 v155, v[172:175] offset:2048
    s_waitcnt lgkmcnt(0)
    s_cbranch_scc1 L_vround
    s_barrier
    s_cmp_eq_u32 s56, 3
    s_cbranch_scc1 L_fin
    ds_read_b128 v[36:39], v18 offset:0
    ds_read_b128 v[40:43], v18 offset:64
    ds_read_b128 v[44:47], v18 offset:128
    ds_read_b128 v[48:51], v18 offset:192
    ds_read2st64_b32 v[60:61], v17 offset0:0 offset1:1
    ds_read2st64_b32 v[62:63], v17 offset0:2 offset1:3
    ds_read2st64_b32 v[64:65], v17 offset0:12 offset1:13
    ds_read2st64_b32 v[66:67], v17 offset0:14 offset1:15
    ds_read2st64_b32 v[68:69], v17 offset0:24 offset1:25
    ds_read2st64_b32 v[70:71], v17 offset0:26 offset1:27
    ds_read2st64_b32 v[72:73], v17 offset0:36 offset1:37
    ds_read2st64_b32 v[74:75], v17 offset0:38 offset1:39
    s_cmp_eq_u32 s101, 0
    s_cbranch_scc0 L_rp10
    buffer_load_dwordx4 v[176:179], v20, s[24:27], s69 offen sc1
    buffer_load_dwordx4 v[184:187], v20, s[24:27], s70 offen sc1
    buffer_load_dwordx4 v[172:175], v19, s[24:27], s69 offen sc1
    buffer_load_dwordx4 v[180:183], v19, s[24:27], s70 offen sc1
    s_branch L_rp12
L_rp10:
    s_cmp_eq_u32 s101, 1
    s_cbranch_scc0 L_rp11
    buffer_load_dwordx4 v[168:171], v20, s[24:27], s68 offen sc1
    buffer_load_dwordx4 v[184:187], v20, s[24:27], s70 offen sc1
    buffer_load_dwordx4 v[164:167], v19, s[24:27], s68 offen sc1
    buffer_load_dwordx4 v[180:183], v19, s[24:27], s70 offen sc1
    s_branch L_rp12
L_rp11:
    buffer_load_dwordx4 v[168:171], v20, s[24:27], s68 offen sc1
    buffer_load_dwordx4 v[176:179], v20, s[24:27], s69 offen sc1
    buffer_load_dwordx4 v[164:167], v19, s[24:27], s68 offen sc1
    buffer_load_dwordx4 v[172:175], v19, s[24:27], s69 offen sc1
L_rp12:
    s_waitcnt lgkmcnt(8)
    v_add_f32 v37, v37, v41
    v_add_f32 v45, v45, v49
    v_add_f32 v38, v38, v42
    v_add_f32 v46, v46, v50
    v_add_f32 v37, v37, v45
    v_add_f32 v38, v38, v46
    v_mov_b32 v39, v22
    s_waitcnt lgkmcnt(4)
    v_add_f32 v60, v60, v64
    v_add_f32 v61, v61, v65
    v_add_f32 v62, v62, v66
    v_add_f32 v63, v63, v67
    s_waitcnt lgkmcnt(0)
    v_add_f32 v68, v68, v72
    v_add_f32 v69, v69, v73
    v_add_f32 v70, v70, v74
    v_add_f32 v71, v71, v75
    v_add_f32 v60, v60, v68
    v_add_f32 v61, v61, v69
    v_add_f32 v62, v62, v70
    v_add_f32 v63, v63, v71
    v_sub_f32 v60, v60, v38
    v_sub_f32 v61, v61, v38
    v_sub_f32 v62, v62, v38
    v_sub_f32 v63, v63, v38
    s_cmp_eq_u32 s2, 255
    s_cbranch_scc1 L_rsolo
    v_perm_b32 v60, v60, v22, s84
    v_perm_b32 v61, v61, v22, s85
    v_perm_b32 v62, v62, v22, s86
    v_perm_b32 v63, v63, v22, s87
    buffer_store_dwordx4 v[60:63], v19, s[24:27], s71 offen sc1
    s_mov_b64 exec, 15
    buffer_store_dwordx4 v[36:39], v20, s[24:27], s71 offen sc1
    s_mov_b64 exec, -1
    s_cmp_eq_u32 s101, 0
    s_cbranch_scc0 L_rp20
    v_mov_b32 v164, v60
    v_mov_b32 v168, v36
    v_mov_b32 v165, v61
    v_mov_b32 v169, v37
    v_mov_b32 v166, v62
    v_mov_b32 v170, v38
    v_mov_b32 v167, v63
    v_mov_b32 v171, v39
    s_branch L_rp22
L_rp20:
    s_cmp_eq_u32 s101, 1
    s_cbranch_scc0 L_rp21
    v_mov_b32 v172, v60
    v_mov_b32 v176, v36
    v_mov_b32 v173, v61
    v_mov_b32 v177, v37
    v_mov_b32 v174, v62
    v_mov_b32 v178, v38
    v_mov_b32 v175, v63
    v_mov_b32 v179, v39
    s_branch L_rp22
L_rp21:
    v_mov_b32 v180, v60
    v_mov_b32 v184, v36
    v_mov_b32 v181, v61
    v_mov_b32 v185, v37
    v_mov_b32 v182, v62
    v_mov_b32 v186, v38
    v_mov_b32 v183, v63
    v_mov_b32 v187, v39
L_rp22:
    s_waitcnt vmcnt(4)
    v_xor_b32 v40, v171, v22
    v_xor_b32 v41, v179, v22
    v_xor_b32 v42, v187, v22
    v_or3_b32 v4, v40, v41, v42
    s_waitcnt vmcnt(2)
    v_perm_b32 v5, v165, v164, s88
    v_perm_b32 v6, v167, v166, s89
    v_bitop3_b32 v5, v5, v6, v22 bitop3:0x56
    v_or_b32 v4, v4, v5
    v_perm_b32 v5, v173, v172, s88
    v_perm_b32 v6, v175, v174, s89
    v_bitop3_b32 v5, v5, v6, v22 bitop3:0x56
    v_or_b32 v4, v4, v5
    v_perm_b32 v5, v181, v180, s88
    v_perm_b32 v6, v183, v182, s89
    v_bitop3_b32 v5, v5, v6, v22 bitop3:0x56
    v_or_b32 v4, v4, v5
    v_cmp_eq_u32 vcc, 0, v4
    s_nop 4
    s_cmp_eq_u64 vcc, -1
    s_cbranch_scc1 L_rmerge
    s_waitcnt vmcnt(0)
    s_cmp_eq_u32 s101, 0
    s_cbranch_scc0 L_rp30
    buffer_load_dwordx4 v[176:179], v20, s[24:27], s69 offen sc1
    buffer_load_dwordx4 v[184:187], v20, s[24:27], s70 offen sc1
    buffer_load_dwordx4 v[172:175], v19, s[24:27], s69 offen sc1
    buffer_load_dwordx4 v[180:183], v19, s[24:27], s70 offen sc1
    s_branch L_rp32
L_rp30:
    s_cmp_eq_u32 s101, 1
    s_cbranch_scc0 L_rp31
    buffer_load_dwordx4 v[168:171], v20, s[24:27], s68 offen sc1
    buffer_load_dwordx4 v[184:187], v20, s[24:27], s70 offen sc1
    buffer_load_dwordx4 v[164:167], v19, s[24:27], s68 offen sc1
    buffer_load_dwordx4 v[180:183], v19, s[24:27], s70 offen sc1
    s_branch L_rp32
L_rp31:
    buffer_load_dwordx4 v[168:171], v20, s[24:27], s68 offen sc1
    buffer_load_dwordx4 v[176:179], v20, s[24:27], s69 offen sc1
    buffer_load_dwordx4 v[164:167], v19, s[24:27], s68 offen sc1
    buffer_load_dwordx4 v[172:175], v19, s[24:27], s69 offen sc1
L_rp32:
    s_waitcnt vmcnt(2)
    v_xor_b32 v40, v171, v22
    v_xor_b32 v41, v179, v22
    v_xor_b32 v42, v187, v22
    v_or3_b32 v4, v40, v41, v42
    s_waitcnt vmcnt(0)
    v_perm_b32 v5, v165, v164, s88
    v_perm_b32 v6, v167, v166, s89
    v_bitop3_b32 v5, v5, v6, v22 bitop3:0x56
    v_or_b32 v4, v4, v5
    v_perm_b32 v5, v173, v172, s88
    v_perm_b32 v6, v175, v174, s89
    v_bitop3_b32 v5, v5, v6, v22 bitop3:0x56
    v_or_b32 v4, v4, v5
    v_perm_b32 v5, v181, v180, s88
    v_perm_b32 v6, v183, v182, s89
    v_bitop3_b32 v5, v5, v6, v22 bitop3:0x56
    v_or_b32 v4, v4, v5
    v_cmp_eq_u32 vcc, 0, v4
L_rmerge:
    v_max3_f32 v3, v168, v176, v184
    v_sub_f32 v168, v168, v3
    v_sub_f32 v176, v176, v3
    v_sub_f32 v184, v184, v3
    v_exp_f32 v168, v168
    v_exp_f32 v176, v176
    v_exp_f32 v184, v184
    s_and_b64 exec, exec, vcc
    s_cbranch_execz L_fin
    v_and_b32 v164, s90, v164
    v_and_b32 v165, s90, v165
    v_and_b32 v166, s90, v166
    v_and_b32 v167, s90, v167
    v_and_b32 v172, s90, v172
    v_and_b32 v173, s90, v173
    v_and_b32 v174, s90, v174
    v_and_b32 v175, s90, v175
    v_and_b32 v180, s90, v180
    v_and_b32 v181, s90, v181
    v_and_b32 v182, s90, v182
    v_and_b32 v183, s90, v183
    v_mul_f32 v37, v168, v169
    v_fmac_f32 v37, v176, v177
    v_fmac_f32 v37, v184, v185
    v_mul_f32 v60, v164, v168
    v_fmac_f32 v60, v172, v176
    v_fmac_f32 v60, v180, v184
    v_mul_f32 v61, v165, v168
    v_fmac_f32 v61, v173, v176
    v_fmac_f32 v61, v181, v184
    v_mul_f32 v62, v166, v168
    v_fmac_f32 v62, v174, v176
    v_fmac_f32 v62, v182, v184
    v_mul_f32 v63, v167, v168
    v_fmac_f32 v63, v175, v176
    v_fmac_f32 v63, v183, v184
L_rsolo:
    v_rcp_f32 v37, v37
    s_nop 0
    v_mul_f32 v60, v60, v37
    v_mul_f32 v61, v61, v37
    v_mul_f32 v62, v62, v37
    v_mul_f32 v63, v63, v37
    v_cvt_pk_bf16_f32 v64, v60, v61
    v_cvt_pk_bf16_f32 v65, v62, v63
    buffer_store_dwordx2 v[64:65], v21, s[48:51], s57 offen
    s_branch L_fin
L_finisher:
    v_and_b32 v14, 3, v1
    v_mul_u32_u24 v8, 384, v14
    v_lshrrev_b32 v13, 2, v1
    v_lshl_add_u32 v8, v13, 3, v8
    v_lshlrev_b32 v9, 4, v1
    v_lshlrev_b32 v14, 4, v14
    s_memrealtime s[96:97]
    s_waitcnt lgkmcnt(0)
    s_mov_b32 s48, s18
    s_and_b32 s49, s19, 0xffff
    s_mov_b32 s50, 393216
    s_mov_b32 s51, 0x20000
    s_mov_b32 s52, s20
    s_and_b32 s53, s21, 0xffff
    s_mov_b32 s54, 256
    s_mov_b32 s55, 0x20000
    s_mov_b32 s24, s22
    s_and_b32 s25, s23, 0xffff
    s_mov_b32 s26, 2528256
    s_mov_b32 s27, 0x20000
L_fk:
    s_waitcnt vmcnt(63)
    s_movk_i32 s69, 4
L_fb1:
    s_barrier
    s_sub_u32 s69, s69, 1
    s_cmp_lg_u32 s69, 0
    s_cbranch_scc1 L_fb1
    s_waitcnt vmcnt(0)
    s_cmp_eq_u32 s2, 0
    s_cbranch_scc0 L_fk2
    s_or_b32 s71, s96, 1
    v_mov_b32 v16, s71
    v_mov_b32 v17, 0
    s_mov_b64 exec, 1
    buffer_atomic_cmpswap v[16:17], v9, s[52:55], 0 offen sc1
    s_mov_b64 exec, -1
L_fk2:
    s_movk_i32 s69, 124
L_fb2:
    s_barrier
    s_sub_u32 s69, s69, 1
    s_cmp_lg_u32 s69, 0
    s_cbranch_scc1 L_fb2
    s_load_dword s71, s[20:21], 0
    s_barrier
    s_waitcnt lgkmcnt(0)
    s_cmp_eq_u32 s71, 0
    s_cbranch_scc0 L_ftag
    s_or_b32 s71, s96, 1
    v_mov_b32 v16, s71
    v_mov_b32 v17, 0
    s_mov_b64 exec, 1
    buffer_atomic_cmpswap v[16:17], v9, s[52:55], 0 offen sc0 sc1
    s_mov_b64 exec, -1
    s_waitcnt vmcnt(0)
    v_readfirstlane_b32 s58, v16
    s_nop 3
    s_cmp_eq_u32 s58, 0
    s_cselect_b32 s71, s71, s58
L_ftag:
    v_mov_b32 v10, s71
    v_mov_b32 v13, 154884
    ds_write_b32 v13, v10
    s_lshr_b32 s63, s101, 1
    s_lshl_b32 s58, s100, 1
    s_add_u32 s63, s63, s58
    s_mul_i32 s62, s63, 8704
    s_add_u32 s62, s62, 1048576
    s_waitcnt lgkmcnt(0)
    s_cmp_eq_u32 s2, 255
    s_cbranch_scc1 L_fin
    s_cmp_eq_u32 s101, 1
    s_cbranch_scc1 L_fmid
    s_movk_i32 s69, 89
L_fb3:
    s_barrier
    s_sub_u32 s69, s69, 1
    s_cmp_lg_u32 s69, 0
    s_cbranch_scc1 L_fb3
    v_add_u32 v13, 142336, v14
    v_lshlrev_b32 v11, 2, v1
    v_add_u32 v11, 142592, v11
    ds_read_b128 v[16:19], v13 offset:0
    ds_read_b128 v[20:23], v13 offset:64
    ds_read_b128 v[24:27], v13 offset:128
    ds_read_b128 v[28:31], v13 offset:192
    ds_read2st64_b32 v[32:33], v11 offset0:0 offset1:1
    ds_read2st64_b32 v[34:35], v11 offset0:2 offset1:3
    ds_read2st64_b32 v[36:37], v11 offset0:4 offset1:5
    ds_read2st64_b32 v[38:39], v11 offset0:6 offset1:7
    ds_read2st64_b32 v[40:41], v11 offset0:8 offset1:9
    ds_read2st64_b32 v[42:43], v11 offset0:10 offset1:11
    ds_read2st64_b32 v[44:45], v11 offset0:12 offset1:13
    ds_read2st64_b32 v[46:47], v11 offset0:14 offset1:15
    s_waitcnt lgkmcnt(4)
    ds_read2st64_b32 v[48:49], v11 offset0:16 offset1:17
    ds_read2st64_b32 v[50:51], v11 offset0:18 offset1:19
    ds_read2st64_b32 v[52:53], v11 offset0:20 offset1:21
    ds_read2st64_b32 v[54:55], v11 offset0:22 offset1:23
    ds_read2st64_b32 v[56:57], v11 offset0:24 offset1:25
    ds_read2st64_b32 v[58:59], v11 offset0:26 offset1:27
    ds_read2st64_b32 v[60:61], v11 offset0:28 offset1:29
    ds_read2st64_b32 v[62:63], v11 offset0:30 offset1:31
    s_waitcnt lgkmcnt(4)
    ds_read2st64_b32 v[64:65], v11 offset0:32 offset1:33
    ds_read2st64_b32 v[66:67], v11 offset0:34 offset1:35
    ds_read2st64_b32 v[68:69], v11 offset0:36 offset1:37
    ds_read2st64_b32 v[70:71], v11 offset0:38 offset1:39
    ds_read2st64_b32 v[72:73], v11 offset0:40 offset1:41
    ds_read2st64_b32 v[74:75], v11 offset0:42 offset1:43
    ds_read2st64_b32 v[76:77], v11 offset0:44 offset1:45
    ds_read2st64_b32 v[78:79], v11 offset0:46 offset1:47
    v_mov_b32 v83, v10
    v_mov_b32 v87, v10
    v_mov_b32 v91, v10
    v_mov_b32 v95, v10
    v_mov_b32 v99, v10
    v_mov_b32 v96, v16
    v_add_f32 v17, v17, v21
    v_add_f32 v25, v25, v29
    v_add_f32 v97, v17, v25
    v_add_f32 v18, v18, v22
    v_add_f32 v26, v26, v30
    v_add_f32 v98, v18, v26
    s_waitcnt lgkmcnt(0)
    v_add_f32 v32, v32, v44
    v_add_f32 v56, v56, v68
    v_add_f32 v32, v32, v56
    v_sub_f32 v80, v32, v98
    v_add_f32 v33, v33, v45
    v_add_f32 v57, v57, v69
    v_add_f32 v33, v33, v57
    v_sub_f32 v81, v33, v98
    v_add_f32 v34, v34, v46
    v_add_f32 v58, v58, v70
    v_add_f32 v34, v34, v58
    v_sub_f32 v82, v34, v98
    v_add_f32 v35, v35, v47
    v_add_f32 v59, v59, v71
    v_add_f32 v35, v35, v59
    v_sub_f32 v84, v35, v98
    v_add_f32 v36, v36, v48
    v_add_f32 v60, v60, v72
    v_add_f32 v36, v36, v60
    v_sub_f32 v85, v36, v98
    v_add_f32 v37, v37, v49
    v_add_f32 v61, v61, v73
    v_add_f32 v37, v37, v61
    v_sub_f32 v86, v37, v98
    v_add_f32 v38, v38, v50
    v_add_f32 v62, v62, v74
    v_add_f32 v38, v38, v62
    v_sub_f32 v88, v38, v98
    v_add_f32 v39, v39, v51
    v_add_f32 v63, v63, v75
    v_add_f32 v39, v39, v63
    v_sub_f32 v89, v39, v98
    v_add_f32 v40, v40, v52
    v_add_f32 v64, v64, v76
    v_add_f32 v40, v40, v64
    v_sub_f32 v90, v40, v98
    v_add_f32 v41, v41, v53
    v_add_f32 v65, v65, v77
    v_add_f32 v41, v41, v65
    v_sub_f32 v92, v41, v98
    v_add_f32 v42, v42, v54
    v_add_f32 v66, v66, v78
    v_add_f32 v42, v42, v66
    v_sub_f32 v93, v42, v98
    v_add_f32 v43, v43, v55
    v_add_f32 v67, v67, v79
    v_add_f32 v43, v43, v67
    v_sub_f32 v94, v43, v98
    s_movk_i32 s69, 39
L_fb4:
    s_barrier
    s_sub_u32 s69, s69, 1
    s_cmp_lg_u32 s69, 0
    s_cbranch_scc1 L_fb4
    s_barrier
    s_mov_b32 s69, 2
L_fo5:
    s_add_u32 s58, s62, 4352
    s_add_u32 s59, s62, 8448
    buffer_load_dwordx4 v[116:119], v14, s[24:27], s59 offen sc1
    buffer_load_dwordx4 v[100:103], v9, s[24:27], s58 offen offset:0 sc1
    buffer_load_dwordx4 v[104:107], v9, s[24:27], s58 offen offset:1024 sc1
    buffer_load_dwordx4 v[108:111], v9, s[24:27], s58 offen offset:2048 sc1
    buffer_load_dwordx4 v[112:115], v9, s[24:27], s58 offen offset:3072 sc1
    s_waitcnt vmcnt(0)
    v_xor_b32 v13, v10, v103
    v_xor_b32 v11, v10, v107
    v_or_b32 v13, v13, v11
    v_xor_b32 v11, v10, v111
    v_or_b32 v13, v13, v11
    v_xor_b32 v11, v10, v115
    v_or_b32 v13, v13, v11
    v_xor_b32 v11, v10, v119
    v_or_b32 v13, v13, v11
    v_cmp_ne_u32 vcc, 0, v13
    s_nop 4
    s_cmp_eq_u64 vcc, 0
    s_cbranch_scc1 L_fo7
    s_sub_u32 s69, s69, 1
    s_cmp_lg_u32 s69, 0
    s_cbranch_scc1 L_fo5
    s_add_u32 s58, s62, 0
    s_add_u32 s59, s62, 4096
    buffer_store_dwordx4 v[80:83], v9, s[24:27], s58 offen offset:0 sc1
    buffer_store_dwordx4 v[84:87], v9, s[24:27], s58 offen offset:1024 sc1
    buffer_store_dwordx4 v[88:91], v9, s[24:27], s58 offen offset:2048 sc1
    buffer_store_dwordx4 v[92:95], v9, s[24:27], s58 offen offset:3072 sc1
    s_mov_b64 exec, 15
    buffer_store_dwordx4 v[96:99], v14, s[24:27], s59 offen sc1
    s_mov_b64 exec, -1
    s_waitcnt vmcnt(0)
    s_add_u32 s58, s62, 4352
    s_add_u32 s59, s62, 8448
    buffer_load_dwordx4 v[116:119], v14, s[24:27], s59 offen sc1
    buffer_load_dwordx4 v[100:103], v9, s[24:27], s58 offen offset:0 sc1
    buffer_load_dwordx4 v[104:107], v9, s[24:27], s58 offen offset:1024 sc1
    buffer_load_dwordx4 v[108:111], v9, s[24:27], s58 offen offset:2048 sc1
    buffer_load_dwordx4 v[112:115], v9, s[24:27], s58 offen offset:3072 sc1
    s_waitcnt vmcnt(0)
    v_xor_b32 v13, v10, v103
    v_xor_b32 v11, v10, v107
    v_or_b32 v13, v13, v11
    v_xor_b32 v11, v10, v111
    v_or_b32 v13, v13, v11
    v_xor_b32 v11, v10, v115
    v_or_b32 v13, v13, v11
    v_xor_b32 v11, v10, v119
    v_or_b32 v13, v13, v11
    v_cmp_ne_u32 vcc, 0, v13
    s_nop 4
    s_cmp_eq_u64 vcc, 0
    s_cbranch_scc0 L_fin
L_fo7:
    v_max_f32 v11, v96, v116
    v_sub_f32 v16, v96, v11
    v_sub_f32 v17, v116, v11
    v_exp_f32 v16, v16
    v_exp_f32 v17, v17
    s_nop 0
    v_mul_f32 v12, v16, v97
    v_fmac_f32 v12, v17, v117
    v_rcp_f32 v12, v12
    s_add_u32 s58, s63, 0
    s_mul_i32 s58, s58, 1536
    v_mul_f32 v16, v16, v12
    v_mul_f32 v17, v17, v12
    v_mul_f32 v32, v80, v16
    v_fmac_f32 v32, v100, v17
    v_mul_f32 v33, v81, v16
    v_fmac_f32 v33, v101, v17
    v_mul_f32 v34, v82, v16
    v_fmac_f32 v34, v102, v17
    v_mul_f32 v35, v84, v16
    v_fmac_f32 v35, v104, v17
    v_mul_f32 v36, v85, v16
    v_fmac_f32 v36, v105, v17
    v_mul_f32 v37, v86, v16
    v_fmac_f32 v37, v106, v17
    v_mul_f32 v38, v88, v16
    v_fmac_f32 v38, v108, v17
    v_mul_f32 v39, v89, v16
    v_fmac_f32 v39, v109, v17
    v_mul_f32 v40, v90, v16
    v_fmac_f32 v40, v110, v17
    v_mul_f32 v41, v92, v16
    v_fmac_f32 v41, v112, v17
    v_mul_f32 v42, v93, v16
    v_fmac_f32 v42, v113, v17
    v_mul_f32 v43, v94, v16
    v_fmac_f32 v43, v114, v17
    v_cvt_pk_bf16_f32 v44, v32, v33
    v_cvt_pk_bf16_f32 v45, v34, v35
    v_cvt_pk_bf16_f32 v46, v36, v37
    v_cvt_pk_bf16_f32 v47, v38, v39
    v_cvt_pk_bf16_f32 v48, v40, v41
    v_cvt_pk_bf16_f32 v49, v42, v43
    buffer_store_dwordx2 v[44:45], v8, s[48:51], s58 offen offset:0
    buffer_store_dwordx2 v[46:47], v8, s[48:51], s58 offen offset:128
    buffer_store_dwordx2 v[48:49], v8, s[48:51], s58 offen offset:256
    s_branch L_fin
L_fmid:
    v_and_b32 v7, 1, v1
    v_mul_u32_u24 v7, 8704, v7
    v_add_u32 v7, 4108, v7
    s_movk_i32 s69, 41
L_fb5:
    s_barrier
    s_sub_u32 s69, s69, 1
    s_cmp_lg_u32 s69, 0
    s_cbranch_scc1 L_fb5
    v_add_u32 v13, 142336, v14
    v_lshlrev_b32 v11, 2, v1
    v_add_u32 v11, 142592, v11
    ds_read_b128 v[16:19], v13 offset:0
    ds_read_b128 v[20:23], v13 offset:64
    ds_read_b128 v[24:27], v13 offset:128
    ds_read_b128 v[28:31], v13 offset:192
    ds_read2st64_b32 v[32:33], v11 offset0:0 offset1:1
    ds_read2st64_b32 v[34:35], v11 offset0:2 offset1:3
    ds_read2st64_b32 v[36:37], v11 offset0:4 offset1:5
    ds_read2st64_b32 v[38:39], v11 offset0:6 offset1:7
    ds_read2st64_b32 v[40:41], v11 offset0:8 offset1:9
    ds_read2st64_b32 v[42:43], v11 offset0:10 offset1:11
    ds_read2st64_b32 v[44:45], v11 offset0:12 offset1:13
    ds_read2st64_b32 v[46:47], v11 offset0:14 offset1:15
    s_waitcnt lgkmcnt(4)
    ds_read2st64_b32 v[48:49], v11 offset0:16 offset1:17
    ds_read2st64_b32 v[50:51], v11 offset0:18 offset1:19
    ds_read2st64_b32 v[52:53], v11 offset0:20 offset1:21
    ds_read2st64_b32 v[54:55], v11 offset0:22 offset1:23
    ds_read2st64_b32 v[56:57], v11 offset0:24 offset1:25
    ds_read2st64_b32 v[58:59], v11 offset0:26 offset1:27
    ds_read2st64_b32 v[60:61], v11 offset0:28 offset1:29
    ds_read2st64_b32 v[62:63], v11 offset0:30 offset1:31
    s_waitcnt lgkmcnt(4)
    ds_read2st64_b32 v[64:65], v11 offset0:32 offset1:33
    ds_read2st64_b32 v[66:67], v11 offset0:34 offset1:35
    ds_read2st64_b32 v[68:69], v11 offset0:36 offset1:37
    ds_read2st64_b32 v[70:71], v11 offset0:38 offset1:39
    ds_read2st64_b32 v[72:73], v11 offset0:40 offset1:41
    ds_read2st64_b32 v[74:75], v11 offset0:42 offset1:43
    ds_read2st64_b32 v[76:77], v11 offset0:44 offset1:45
    ds_read2st64_b32 v[78:79], v11 offset0:46 offset1:47
    v_mov_b32 v83, v10
    v_mov_b32 v87, v10
    v_mov_b32 v91, v10
    v_mov_b32 v95, v10
    v_mov_b32 v99, v10
    v_mov_b32 v96, v16
    v_add_f32 v17, v17, v21
    v_add_f32 v25, v25, v29
    v_add_f32 v97, v17, v25
    v_add_f32 v18, v18, v22
    v_add_f32 v26, v26, v30
    v_add_f32 v98, v18, v26
    s_waitcnt lgkmcnt(0)
    v_add_f32 v32, v32, v44
    v_add_f32 v56, v56, v68
    v_add_f32 v32, v32, v56
    v_sub_f32 v80, v32, v98
    v_add_f32 v33, v33, v45
    v_add_f32 v57, v57, v69
    v_add_f32 v33, v33, v57
    v_sub_f32 v81, v33, v98
    v_add_f32 v34, v34, v46
    v_add_f32 v58, v58, v70
    v_add_f32 v34, v34, v58
    v_sub_f32 v82, v34, v98
    v_add_f32 v35, v35, v47
    v_add_f32 v59, v59, v71
    v_add_f32 v35, v35, v59
    v_sub_f32 v84, v35, v98
    v_add_f32 v36, v36, v48
    v_add_f32 v60, v60, v72
    v_add_f32 v36, v36, v60
    v_sub_f32 v85, v36, v98
    v_add_f32 v37, v37, v49
    v_add_f32 v61, v61, v73
    v_add_f32 v37, v37, v61
    v_sub_f32 v86, v37, v98
    v_add_f32 v38, v38, v50
    v_add_f32 v62, v62, v74
    v_add_f32 v38, v38, v62
    v_sub_f32 v88, v38, v98
    v_add_f32 v39, v39, v51
    v_add_f32 v63, v63, v75
    v_add_f32 v39, v39, v63
    v_sub_f32 v89, v39, v98
    v_add_f32 v40, v40, v52
    v_add_f32 v64, v64, v76
    v_add_f32 v40, v40, v64
    v_sub_f32 v90, v40, v98
    v_add_f32 v41, v41, v53
    v_add_f32 v65, v65, v77
    v_add_f32 v41, v41, v65
    v_sub_f32 v92, v41, v98
    v_add_f32 v42, v42, v54
    v_add_f32 v66, v66, v78
    v_add_f32 v42, v42, v66
    v_sub_f32 v93, v42, v98
    v_add_f32 v43, v43, v55
    v_add_f32 v67, v67, v79
    v_add_f32 v43, v43, v67
    v_sub_f32 v94, v43, v98
    s_movk_i32 s69, 40
L_fb6:
    s_barrier
    s_sub_u32 s69, s69, 1
    s_cmp_lg_u32 s69, 0
    s_cbranch_scc1 L_fb6
    v_add_u32 v13, 142336, v14
    v_lshlrev_b32 v11, 2, v1
    v_add_u32 v11, 142592, v11
    ds_read_b128 v[16:19], v13 offset:0
    ds_read_b128 v[20:23], v13 offset:64
    ds_read_b128 v[24:27], v13 offset:128
    ds_read_b128 v[28:31], v13 offset:192
    ds_read2st64_b32 v[32:33], v11 offset0:0 offset1:1
    ds_read2st64_b32 v[34:35], v11 offset0:2 offset1:3
    ds_read2st64_b32 v[36:37], v11 offset0:4 offset1:5
    ds_read2st64_b32 v[38:39], v11 offset0:6 offset1:7
    ds_read2st64_b32 v[40:41], v11 offset0:8 offset1:9
    ds_read2st64_b32 v[42:43], v11 offset0:10 offset1:11
    ds_read2st64_b32 v[44:45], v11 offset0:12 offset1:13
    ds_read2st64_b32 v[46:47], v11 offset0:14 offset1:15
    s_waitcnt lgkmcnt(4)
    ds_read2st64_b32 v[48:49], v11 offset0:16 offset1:17
    ds_read2st64_b32 v[50:51], v11 offset0:18 offset1:19
    ds_read2st64_b32 v[52:53], v11 offset0:20 offset1:21
    ds_read2st64_b32 v[54:55], v11 offset0:22 offset1:23
    ds_read2st64_b32 v[56:57], v11 offset0:24 offset1:25
    ds_read2st64_b32 v[58:59], v11 offset0:26 offset1:27
    ds_read2st64_b32 v[60:61], v11 offset0:28 offset1:29
    ds_read2st64_b32 v[62:63], v11 offset0:30 offset1:31
    s_waitcnt lgkmcnt(4)
    ds_read2st64_b32 v[64:65], v11 offset0:32 offset1:33
    ds_read2st64_b32 v[66:67], v11 offset0:34 offset1:35
    ds_read2st64_b32 v[68:69], v11 offset0:36 offset1:37
    ds_read2st64_b32 v[70:71], v11 offset0:38 offset1:39
    ds_read2st64_b32 v[72:73], v11 offset0:40 offset1:41
    ds_read2st64_b32 v[74:75], v11 offset0:42 offset1:43
    ds_read2st64_b32 v[76:77], v11 offset0:44 offset1:45
    ds_read2st64_b32 v[78:79], v11 offset0:46 offset1:47
    v_mov_b32 v103, v10
    v_mov_b32 v107, v10
    v_mov_b32 v111, v10
    v_mov_b32 v115, v10
    v_mov_b32 v119, v10
    v_mov_b32 v116, v16
    v_add_f32 v17, v17, v21
    v_add_f32 v25, v25, v29
    v_add_f32 v117, v17, v25
    v_add_f32 v18, v18, v22
    v_add_f32 v26, v26, v30
    v_add_f32 v118, v18, v26
    s_waitcnt lgkmcnt(0)
    v_add_f32 v32, v32, v44
    v_add_f32 v56, v56, v68
    v_add_f32 v32, v32, v56
    v_sub_f32 v100, v32, v118
    v_add_f32 v33, v33, v45
    v_add_f32 v57, v57, v69
    v_add_f32 v33, v33, v57
    v_sub_f32 v101, v33, v118
    v_add_f32 v34, v34, v46
    v_add_f32 v58, v58, v70
    v_add_f32 v34, v34, v58
    v_sub_f32 v102, v34, v118
    v_add_f32 v35, v35, v47
    v_add_f32 v59, v59, v71
    v_add_f32 v35, v35, v59
    v_sub_f32 v104, v35, v118
    v_add_f32 v36, v36, v48
    v_add_f32 v60, v60, v72
    v_add_f32 v36, v36, v60
    v_sub_f32 v105, v36, v118
    v_add_f32 v37, v37, v49
    v_add_f32 v61, v61, v73
    v_add_f32 v37, v37, v61
    v_sub_f32 v106, v37, v118
    v_add_f32 v38, v38, v50
    v_add_f32 v62, v62, v74
    v_add_f32 v38, v38, v62
    v_sub_f32 v108, v38, v118
    v_add_f32 v39, v39, v51
    v_add_f32 v63, v63, v75
    v_add_f32 v39, v39, v63
    v_sub_f32 v109, v39, v118
    v_add_f32 v40, v40, v52
    v_add_f32 v64, v64, v76
    v_add_f32 v40, v40, v64
    v_sub_f32 v110, v40, v118
    v_add_f32 v41, v41, v53
    v_add_f32 v65, v65, v77
    v_add_f32 v41, v41, v65
    v_sub_f32 v112, v41, v118
    v_add_f32 v42, v42, v54
    v_add_f32 v66, v66, v78
    v_add_f32 v42, v42, v66
    v_sub_f32 v113, v42, v118
    v_add_f32 v43, v43, v55
    v_add_f32 v67, v67, v79
    v_add_f32 v43, v43, v67
    v_sub_f32 v114, v43, v118
    s_movk_i32 s69, 46
L_fb7:
    s_barrier
    s_sub_u32 s69, s69, 1
    s_cmp_lg_u32 s69, 0
    s_cbranch_scc1 L_fb7
    s_add_u32 s58, s62, 4352
    s_add_u32 s59, s62, 8448
    buffer_store_dwordx4 v[80:83], v9, s[24:27], s58 offen offset:0 sc1
    buffer_store_dwordx4 v[84:87], v9, s[24:27], s58 offen offset:1024 sc1
    buffer_store_dwordx4 v[88:91], v9, s[24:27], s58 offen offset:2048 sc1
    buffer_store_dwordx4 v[92:95], v9, s[24:27], s58 offen offset:3072 sc1
    s_mov_b64 exec, 15
    buffer_store_dwordx4 v[96:99], v14, s[24:27], s59 offen sc1
    s_mov_b64 exec, -1
    s_add_u32 s58, s62, 13056
    s_add_u32 s59, s62, 17152
    buffer_store_dwordx4 v[100:103], v9, s[24:27], s58 offen offset:0 sc1
    buffer_store_dwordx4 v[104:107], v9, s[24:27], s58 offen offset:1024 sc1
    buffer_store_dwordx4 v[108:111], v9, s[24:27], s58 offen offset:2048 sc1
    buffer_store_dwordx4 v[112:115], v9, s[24:27], s58 offen offset:3072 sc1
    s_mov_b64 exec, 15
    buffer_store_dwordx4 v[116:119], v14, s[24:27], s59 offen sc1
    s_mov_b64 exec, -1
    s_barrier
    s_barrier
    s_waitcnt vmcnt(0)
    buffer_load_dword v15, v7, s[24:27], s62 offen sc1
    s_waitcnt vmcnt(0)
    v_cmp_eq_u32 vcc, v15, v10
    s_nop 4
    s_and_b32 s70, vcc_lo, 3
    s_cbranch_scc0 L_fin
    s_bitcmp1_b32 s70, 0
    s_cbranch_scc0 L_fm30
    s_waitcnt vmcnt(0)
    s_add_u32 s58, s62, 0
    s_add_u32 s59, s62, 4096
    buffer_load_dwordx4 v[136:139], v14, s[24:27], s59 offen sc1
    buffer_load_dwordx4 v[120:123], v9, s[24:27], s58 offen offset:0 sc1
    buffer_load_dwordx4 v[124:127], v9, s[24:27], s58 offen offset:1024 sc1
    buffer_load_dwordx4 v[128:131], v9, s[24:27], s58 offen offset:2048 sc1
    buffer_load_dwordx4 v[132:135], v9, s[24:27], s58 offen offset:3072 sc1
    s_waitcnt vmcnt(0)
    v_xor_b32 v13, v10, v123
    v_xor_b32 v11, v10, v127
    v_or_b32 v13, v13, v11
    v_xor_b32 v11, v10, v131
    v_or_b32 v13, v13, v11
    v_xor_b32 v11, v10, v135
    v_or_b32 v13, v13, v11
    v_xor_b32 v11, v10, v139
    v_or_b32 v13, v13, v11
    v_cmp_ne_u32 vcc, 0, v13
    s_nop 4
    s_cmp_eq_u64 vcc, 0
    s_cbranch_scc0 L_fm30
    v_max_f32 v11, v136, v96
    v_sub_f32 v16, v136, v11
    v_sub_f32 v17, v96, v11
    v_exp_f32 v16, v16
    v_exp_f32 v17, v17
    s_nop 0
    v_mul_f32 v12, v16, v137
    v_fmac_f32 v12, v17, v97
    v_rcp_f32 v12, v12
    s_add_u32 s58, s63, 0
    s_mul_i32 s58, s58, 1536
    v_mul_f32 v16, v16, v12
    v_mul_f32 v17, v17, v12
    v_mul_f32 v32, v120, v16
    v_fmac_f32 v32, v80, v17
    v_mul_f32 v33, v121, v16
    v_fmac_f32 v33, v81, v17
    v_mul_f32 v34, v122, v16
    v_fmac_f32 v34, v82, v17
    v_mul_f32 v35, v124, v16
    v_fmac_f32 v35, v84, v17
    v_mul_f32 v36, v125, v16
    v_fmac_f32 v36, v85, v17
    v_mul_f32 v37, v126, v16
    v_fmac_f32 v37, v86, v17
    v_mul_f32 v38, v128, v16
    v_fmac_f32 v38, v88, v17
    v_mul_f32 v39, v129, v16
    v_fmac_f32 v39, v89, v17
    v_mul_f32 v40, v130, v16
    v_fmac_f32 v40, v90, v17
    v_mul_f32 v41, v132, v16
    v_fmac_f32 v41, v92, v17
    v_mul_f32 v42, v133, v16
    v_fmac_f32 v42, v93, v17
    v_mul_f32 v43, v134, v16
    v_fmac_f32 v43, v94, v17
    v_cvt_pk_bf16_f32 v44, v32, v33
    v_cvt_pk_bf16_f32 v45, v34, v35
    v_cvt_pk_bf16_f32 v46, v36, v37
    v_cvt_pk_bf16_f32 v47, v38, v39
    v_cvt_pk_bf16_f32 v48, v40, v41
    v_cvt_pk_bf16_f32 v49, v42, v43
    buffer_store_dwordx2 v[44:45], v8, s[48:51], s58 offen offset:0
    buffer_store_dwordx2 v[46:47], v8, s[48:51], s58 offen offset:128
    buffer_store_dwordx2 v[48:49], v8, s[48:51], s58 offen offset:256
L_fm30:
    s_bitcmp1_b32 s70, 1
    s_cbranch_scc0 L_fm31
    s_waitcnt vmcnt(0)
    s_add_u32 s58, s62, 8704
    s_add_u32 s59, s62, 12800
    buffer_load_dwordx4 v[136:139], v14, s[24:27], s59 offen sc1
    buffer_load_dwordx4 v[120:123], v9, s[24:27], s58 offen offset:0 sc1
    buffer_load_dwordx4 v[124:127], v9, s[24:27], s58 offen offset:1024 sc1
    buffer_load_dwordx4 v[128:131], v9, s[24:27], s58 offen offset:2048 sc1
    buffer_load_dwordx4 v[132:135], v9, s[24:27], s58 offen offset:3072 sc1
    s_waitcnt vmcnt(0)
    v_xor_b32 v13, v10, v123
    v_xor_b32 v11, v10, v127
    v_or_b32 v13, v13, v11
    v_xor_b32 v11, v10, v131
    v_or_b32 v13, v13, v11
    v_xor_b32 v11, v10, v135
    v_or_b32 v13, v13, v11
    v_xor_b32 v11, v10, v139
    v_or_b32 v13, v13, v11
    v_cmp_ne_u32 vcc, 0, v13
    s_nop 4
    s_cmp_eq_u64 vcc, 0
    s_cbranch_scc0 L_fm31
    v_max_f32 v11, v136, v116
    v_sub_f32 v16, v136, v11
    v_sub_f32 v17, v116, v11
    v_exp_f32 v16, v16
    v_exp_f32 v17, v17
    s_nop 0
    v_mul_f32 v12, v16, v137
    v_fmac_f32 v12, v17, v117
    v_rcp_f32 v12, v12
    s_add_u32 s58, s63, 1
    s_mul_i32 s58, s58, 1536
    v_mul_f32 v16, v16, v12
    v_mul_f32 v17, v17, v12
    v_mul_f32 v32, v120, v16
    v_fmac_f32 v32, v100, v17
    v_mul_f32 v33, v121, v16
    v_fmac_f32 v33, v101, v17
    v_mul_f32 v34, v122, v16
    v_fmac_f32 v34, v102, v17
    v_mul_f32 v35, v124, v16
    v_fmac_f32 v35, v104, v17
    v_mul_f32 v36, v125, v16
    v_fmac_f32 v36, v105, v17
    v_mul_f32 v37, v126, v16
    v_fmac_f32 v37, v106, v17
    v_mul_f32 v38, v128, v16
    v_fmac_f32 v38, v108, v17
    v_mul_f32 v39, v129, v16
    v_fmac_f32 v39, v109, v17
    v_mul_f32 v40, v130, v16
    v_fmac_f32 v40, v110, v17
    v_mul_f32 v41, v132, v16
    v_fmac_f32 v41, v112, v17
    v_mul_f32 v42, v133, v16
    v_fmac_f32 v42, v113, v17
    v_mul_f32 v43, v134, v16
    v_fmac_f32 v43, v114, v17
    v_cvt_pk_bf16_f32 v44, v32, v33
    v_cvt_pk_bf16_f32 v45, v34, v35
    v_cvt_pk_bf16_f32 v46, v36, v37
    v_cvt_pk_bf16_f32 v47, v38, v39
    v_cvt_pk_bf16_f32 v48, v40, v41
    v_cvt_pk_bf16_f32 v49, v42, v43
    buffer_store_dwordx2 v[44:45], v8, s[48:51], s58 offen offset:0
    buffer_store_dwordx2 v[46:47], v8, s[48:51], s58 offen offset:128
    buffer_store_dwordx2 v[48:49], v8, s[48:51], s58 offen offset:256
L_fm31:
L_fin:
L_end:
    s_endpgm
.section .rodata,"a"
.p2align 6
.amdhsa_kernel standalone__kv_cache_quant_int4_int2_kv_with_per_channel_or_per_token_scales__sampling_kernel
  .amdhsa_next_free_vgpr 232
  .amdhsa_next_free_sgpr 102
  .amdhsa_accum_offset 232
  .amdhsa_group_segment_fixed_size 0
  .amdhsa_kernarg_size 80
  .amdhsa_user_sgpr_count 2
  .amdhsa_user_sgpr_kernarg_segment_ptr 1
  .amdhsa_system_sgpr_workgroup_id_x 1
  .amdhsa_float_denorm_mode_32 3
.end_amdhsa_kernel
```

```asm
; @launch grid=(256,1,1) block=(448,1,1) lds=161280
.amdgcn_target "amdgcn-amd-amdhsa--gfx950"
.text
.globl standalone__kv_cache_quant_int4_int2_kv_with_per_channel_or_per_token_scales__sampling_kernel
.p2align 8
.type standalone__kv_cache_quant_int4_int2_kv_with_per_channel_or_per_token_scales__sampling_kernel,@function
standalone__kv_cache_quant_int4_int2_kv_with_per_channel_or_per_token_scales__sampling_kernel:
    s_load_dwordx16 s[4:19], s[0:1], 0
    s_load_dwordx4 s[20:23], s[0:1], 64
    s_cmp_ge_u32 s2, 256
    s_cbranch_scc1 L_end
    v_lshrrev_b32 v2, 6, v0
    v_and_b32 v1, 63, v0
    v_readfirstlane_b32 s56, v2
    s_mov_b32 s72, s2
    s_bfe_u32 s58, s2, 196612
    s_lshr_b32 s59, s2, 1
    s_and_b32 s59, s59, 2
    s_xor_b32 s2, s2, s58
    s_xor_b32 s2, s2, s59
    s_bfe_u32 s58, s2, 65537
    s_xor_b32 s2, s2, s58
    s_mul_i32 s57, s2, 1398112
    s_add_u32 s57, s57, 43691
    s_lshr_b32 s57, s57, 17
    v_lshlrev_b32 v8, 4, v1
    v_lshrrev_b32 v15, 5, v1
    v_mul_u32_u24 v9, 31488, v15
    v_add_u32 v9, v9, v8
    v_add_u32 v10, 31488, v8
    s_lshl_b32 s58, s57, 7
    s_add_u32 s58, s58, s56
    s_mul_i32 s58, s58, 1536
    s_mul_i32 m0, s56, 3072
    s_mov_b32 s26, 805306368
    s_mov_b32 s27, 0x20000
    s_waitcnt lgkmcnt(0)
    s_mov_b32 s24, s6
    s_and_b32 s25, s7, 0xffff
    buffer_load_dwordx4 v8, s[24:27], s58 offen offset:0 nt lds
    buffer_load_dwordx4 v9, s[24:27], s58 offen offset:1024 nt lds
    buffer_load_dwordx4 v10, s[24:27], s58 offen offset:2048 nt lds
    s_mul_i32 s100, s2, 43691
    s_lshr_b32 s100, s100, 17
    s_mul_i32 s101, s100, 3
    s_sub_u32 s101, s2, s101
    s_cmp_eq_u32 s2, 255
    s_cselect_b32 s73, 16, 11
    s_cmp_eq_u32 s101, 1
    s_cselect_b32 s3, 5, s73
    s_cselect_b32 s73, 10, s73
    s_sub_u32 s58, 2, s101
    s_mul_i32 s58, s58, 11
    s_lshr_b32 s58, s58, 1
    s_lshl_b32 s59, s100, 4
    s_sub_u32 s58, s58, s59
    s_add_u32 s58, s58, 4080
    s_sub_u32 s58, s58, s73
    v_cmp_le_u32 vcc, s73, v1
    v_add_u32 v3, s57, v1
    v_add_u32 v4, s58, v1
    v_cndmask_b32 v152, v3, v4, vcc
    s_cmp_eq_u32 s56, 4
    s_cbranch_scc1 L_loader
    s_cmp_lt_u32 s56, 4
    s_cbranch_scc1 L_consumer
    s_cmp_eq_u32 s56, 6
    s_cbranch_scc1 L_ctl
    s_waitcnt lgkmcnt(0)
    s_mov_b32 s44, s4
    s_and_b32 s45, s5, 0xffff
    s_mov_b32 s46, 393216
    s_mov_b32 s47, 0x20000
    s_mov_b32 s32, s12
    s_and_b32 s33, s13, 0xffff
    s_mov_b32 s34, 6291456
    s_mov_b32 s35, 0x20000
    s_mov_b32 s28, s10
    s_and_b32 s29, s11, 0xffff
    s_mov_b32 s30, 6291456
    s_mov_b32 s31, 0x20000
    s_mov_b32 s36, s14
    s_and_b32 s37, s15, 0xffff
    s_mov_b32 s38, 2097152
    s_mov_b32 s39, 0x20000
    s_mov_b32 s40, s16
    s_and_b32 s41, s17, 0xffff
    s_mov_b32 s42, 2097152
    s_mov_b32 s43, 0x20000
    s_sub_u32 s61, s56, 5
    s_mov_b32 s62, s61
    s_mov_b32 exec_hi, 0xffff
L_stq:
    s_mul_i32 s58, s62, s3
    s_cmp_lt_u32 s58, 15
    s_cbranch_scc0 L_stage
    v_readlane_b32 s58, v152, s58
    s_mul_i32 s59, s62, 1536
    s_add_u32 m0, s59, 155136
    s_add_u32 s62, s62, 1
    s_lshr_b32 s58, s58, 4
    s_mul_i32 s58, s58, 1536
    buffer_load_dwordx4 v8, s[44:47], s58 offen nt lds
    buffer_load_dwordx4 v8, s[44:47], s58 offen offset:768 nt lds
    s_branch L_stq
L_stage:
    v_readlane_b32 s60, v152, s61
    s_mul_i32 s59, s61, 3072
    s_add_u32 m0, s59, 76800
    s_mov_b32 exec_hi, 0xffff
    s_mul_i32 s58, s60, 1536
    buffer_load_dwordx4 v8, s[32:35], s58 offen nt lds
    buffer_load_dwordx4 v8, s[32:35], s58 offen offset:768 nt lds
    s_add_u32 m0, m0, 1536
    s_lshl_b32 s59, s61, 10
    buffer_load_dwordx4 v8, s[28:31], s58 offen nt lds
    buffer_load_dwordx4 v8, s[28:31], s58 offen offset:768 nt lds
    s_add_u32 m0, s59, 125952
    s_mov_b32 exec_hi, 0
    s_lshl_b32 s58, s60, 9
    buffer_load_dwordx4 v8, s[36:39], s58 offen nt lds
    s_add_u32 m0, m0, 512
    s_add_u32 s61, s61, 1
    buffer_load_dwordx4 v8, s[40:43], s58 offen nt lds
    s_cmp_lt_u32 s61, 16
    s_cbranch_scc1 L_stage
    s_mov_b32 exec_hi, -1
    s_branch L_finisher
L_loader:
    s_setprio 3
    v_add_u32 v22, 16, v1
    v_lshrrev_b32 v11, 6, v22
    v_xor_b32 v12, 1, v15
    v_add_u32 v22, 48, v1
    v_lshrrev_b32 v13, 6, v22
    v_mov_b32 v17, v8
    v_mov_b32 v18, v9
    v_mov_b32 v19, v10
    s_mov_b32 s68, 7
    s_mov_b32 m0, 21504
    s_movk_i32 s71, 3072
    s_mul_i32 s57, s57, 196608
    s_add_u32 s57, s57, 10752
    s_mov_b32 s84, 0x400000
    s_mov_b32 s85, 0x800
    s_movk_i32 s86, 1536
    s_mov_b32 s70, 18
    s_mov_b32 s74, 0
    v_mov_b32 v20, 4710
    v_mov_b32 v21, 154880
    ds_write_b32 v21, v20
L_lw16:
    s_waitcnt vmcnt(16)
L_lw17:
    s_waitcnt vmcnt(17)
L_lw18:
    s_waitcnt vmcnt(18)
L_lw19:
    s_waitcnt vmcnt(19)
L_lw20:
    s_waitcnt vmcnt(20)
    buffer_load_dwordx4 v17, s[24:27], s57 offen nt lds
    s_add_u32 s68, s68, 1
    s_and_b32 s58, s68, 63
    s_cmp_ge_u32 s58, 43
    s_cselect_b32 s69, -768, 0
    s_cmp_eq_u32 s58, 21
    buffer_load_dwordx4 v18, s[24:27], s57 offen offset:1024 nt lds
    s_cselect_b32 s62, 33024, 0
    v_mad_u32_u24 v17, v11, s62, v8
    v_mad_i32_i24 v22, v15, s69, v9
    v_mad_u32_u24 v18, v12, s62, v22
    s_bitcmp1_b64 s[84:85], s58
    buffer_load_dwordx4 v19, s[24:27], s57 offen offset:2048 nt lds
    s_cselect_b32 s63, 34560, s86
    s_add_u32 m0, m0, s71
    s_add_u32 s57, s57, s63
    v_add_u32 v22, s69, v10
    v_mad_u32_u24 v19, v13, s62, v22
    s_and_b32 s59, s68, 7
    s_cbranch_scc0 L_lunit
L_lad:
    s_cmp_eq_u32 s70, 20
    s_cbranch_scc1 L_lw20
    s_cmp_eq_u32 s70, 19
    s_cbranch_scc1 L_lw19
    s_cmp_eq_u32 s70, 18
    s_cbranch_scc1 L_lw18
    s_cmp_eq_u32 s70, 17
    s_cbranch_scc1 L_lw17
    s_branch L_lw16
L_lunit:
    s_waitcnt vmcnt(24)
    s_cmp_le_u32 s68, 16
    s_cbranch_scc1 L_lfirst
L_lbar:
    s_barrier
L_lnobar:
    s_waitcnt lgkmcnt(0)
    v_readfirstlane_b32 s59, v20
    ds_read_b32 v20, v21
    s_cmp_eq_u32 m0, 73728
    s_cselect_b32 m0, 0, m0
    s_and_b32 s74, s74, 255
    s_add_u32 s74, s74, s59
    s_lshr_b32 s70, s74, 8
    s_cmp_eq_u32 s58, 0
    s_cbranch_scc1 L_lblock
L_lsel:
    s_cmp_le_u32 s70, 20
    s_cbranch_scc1 L_lad
    s_cmp_le_u32 s70, 21
    s_cbranch_scc1 L_lw21
    s_cmp_le_u32 s70, 22
    s_cbranch_scc1 L_lw22
    s_cmp_le_u32 s70, 23
    s_cbranch_scc1 L_lw23
    s_cmp_le_u32 s70, 24
    s_cbranch_scc1 L_lw24
    s_branch L_lw25
L_lblock:
    s_bfe_u32 s58, s68, 262150
    v_readlane_b32 s57, v152, s58
    s_nop 3
    s_mul_i32 s57, s57, 196608
    s_cmp_eq_u32 s58, 0
    s_cbranch_scc0 L_lsel
    s_cmp_eq_u32 s68, 2048
    s_cbranch_scc1 L_ldone
    s_mov_b32 s24, s8
    s_and_b32 s25, s9, 0xffff
    s_branch L_lsel
L_lfirst:
    s_cmp_eq_u32 s68, 8
    s_cbranch_scc1 L_lnobar
    s_barrier
    s_branch L_lbar
L_ldone:
    s_waitcnt vmcnt(0)
    s_barrier
    s_endpgm
L_lw21:
    s_waitcnt vmcnt(21)
    buffer_load_dwordx4 v17, s[24:27], s57 offen nt lds
    s_add_u32 s68, s68, 1
    s_and_b32 s58, s68, 63
    s_cmp_ge_u32 s58, 43
    s_cselect_b32 s69, -768, 0
    s_cmp_eq_u32 s58, 21
    buffer_load_dwordx4 v18, s[24:27], s57 offen offset:1024 nt lds
    s_cselect_b32 s62, 33024, 0
    v_mad_u32_u24 v17, v11, s62, v8
    v_mad_i32_i24 v22, v15, s69, v9
    v_mad_u32_u24 v18, v12, s62, v22
    s_bitcmp1_b64 s[84:85], s58
    buffer_load_dwordx4 v19, s[24:27], s57 offen offset:2048 nt lds
    s_cselect_b32 s63, 34560, s86
    s_add_u32 m0, m0, s71
    s_add_u32 s57, s57, s63
    v_add_u32 v22, s69, v10
    v_mad_u32_u24 v19, v13, s62, v22
    s_and_b32 s59, s68, 7
    s_cbranch_scc1 L_lw21
    s_branch L_lunit
L_lw22:
    s_waitcnt vmcnt(22)
    buffer_load_dwordx4 v17, s[24:27], s57 offen nt lds
    s_add_u32 s68, s68, 1
    s_and_b32 s58, s68, 63
    s_cmp_ge_u32 s58, 43
    s_cselect_b32 s69, -768, 0
    s_cmp_eq_u32 s58, 21
    buffer_load_dwordx4 v18, s[24:27], s57 offen offset:1024 nt lds
    s_cselect_b32 s62, 33024, 0
    v_mad_u32_u24 v17, v11, s62, v8
    v_mad_i32_i24 v22, v15, s69, v9
    v_mad_u32_u24 v18, v12, s62, v22
    s_bitcmp1_b64 s[84:85], s58
    buffer_load_dwordx4 v19, s[24:27], s57 offen offset:2048 nt lds
    s_cselect_b32 s63, 34560, s86
    s_add_u32 m0, m0, s71
    s_add_u32 s57, s57, s63
    v_add_u32 v22, s69, v10
    v_mad_u32_u24 v19, v13, s62, v22
    s_and_b32 s59, s68, 7
    s_cbranch_scc1 L_lw22
    s_branch L_lunit
L_lw23:
    s_waitcnt vmcnt(23)
    buffer_load_dwordx4 v17, s[24:27], s57 offen nt lds
    s_add_u32 s68, s68, 1
    s_and_b32 s58, s68, 63
    s_cmp_ge_u32 s58, 43
    s_cselect_b32 s69, -768, 0
    s_cmp_eq_u32 s58, 21
    buffer_load_dwordx4 v18, s[24:27], s57 offen offset:1024 nt lds
    s_cselect_b32 s62, 33024, 0
    v_mad_u32_u24 v17, v11, s62, v8
    v_mad_i32_i24 v22, v15, s69, v9
    v_mad_u32_u24 v18, v12, s62, v22
    s_bitcmp1_b64 s[84:85], s58
    buffer_load_dwordx4 v19, s[24:27], s57 offen offset:2048 nt lds
    s_cselect_b32 s63, 34560, s86
    s_add_u32 m0, m0, s71
    s_add_u32 s57, s57, s63
    v_add_u32 v22, s69, v10
    v_mad_u32_u24 v19, v13, s62, v22
    s_and_b32 s59, s68, 7
    s_cbranch_scc1 L_lw23
    s_branch L_lunit
L_lw24:
    s_waitcnt vmcnt(24)
    buffer_load_dwordx4 v17, s[24:27], s57 offen nt lds
    s_add_u32 s68, s68, 1
    s_and_b32 s58, s68, 63
    s_cmp_ge_u32 s58, 43
    s_cselect_b32 s69, -768, 0
    s_cmp_eq_u32 s58, 21
    buffer_load_dwordx4 v18, s[24:27], s57 offen offset:1024 nt lds
    s_cselect_b32 s62, 33024, 0
    v_mad_u32_u24 v17, v11, s62, v8
    v_mad_i32_i24 v22, v15, s69, v9
    v_mad_u32_u24 v18, v12, s62, v22
    s_bitcmp1_b64 s[84:85], s58
    buffer_load_dwordx4 v19, s[24:27], s57 offen offset:2048 nt lds
    s_cselect_b32 s63, 34560, s86
    s_add_u32 m0, m0, s71
    s_add_u32 s57, s57, s63
    v_add_u32 v22, s69, v10
    v_mad_u32_u24 v19, v13, s62, v22
    s_and_b32 s59, s68, 7
    s_cbranch_scc1 L_lw24
    s_branch L_lunit
L_lw25:
    s_waitcnt vmcnt(25)
    buffer_load_dwordx4 v17, s[24:27], s57 offen nt lds
    s_add_u32 s68, s68, 1
    s_and_b32 s58, s68, 63
    s_cmp_ge_u32 s58, 43
    s_cselect_b32 s69, -768, 0
    s_cmp_eq_u32 s58, 21
    buffer_load_dwordx4 v18, s[24:27], s57 offen offset:1024 nt lds
    s_cselect_b32 s62, 33024, 0
    v_mad_u32_u24 v17, v11, s62, v8
    v_mad_i32_i24 v22, v15, s69, v9
    v_mad_u32_u24 v18, v12, s62, v22
    s_bitcmp1_b64 s[84:85], s58
    buffer_load_dwordx4 v19, s[24:27], s57 offen offset:2048 nt lds
    s_cselect_b32 s63, 34560, s86
    s_add_u32 m0, m0, s71
    s_add_u32 s57, s57, s63
    v_add_u32 v22, s69, v10
    v_mad_u32_u24 v19, v13, s62, v22
    s_and_b32 s59, s68, 7
    s_cbranch_scc1 L_lw25
    s_branch L_lunit
L_ctl:
    s_sub_u32 s58, s72, 8
    s_cmp_lt_u32 s58, 8
    s_cbranch_scc0 L_ctl_init
    s_getpc_b64 s[44:45]
L_pc:
    s_and_b32 s45, s45, 0xffff
    s_mov_b32 s46, L_end - L_pc
    s_mov_b32 s47, 0x20000
    v_lshlrev_b32 v9, 7, v1
    s_movk_i32 s58, 0
    buffer_load_dword v12, v9, s[44:47], s58 offen
    s_movk_i32 s58, 8192
    buffer_load_dword v13, v9, s[44:47], s58 offen
    s_movk_i32 s58, 16384
    buffer_load_dword v14, v9, s[44:47], s58 offen
    s_movk_i32 s58, 24576
    buffer_load_dword v15, v9, s[44:47], s58 offen
L_ctl_init:
    s_waitcnt lgkmcnt(0)
    s_mov_b32 s52, s22
    s_and_b32 s53, s23, 0xffff
    s_mov_b32 s54, 16793888
    s_mov_b32 s55, 0x20000
    s_mov_b32 s71, 0
    s_add_u32 s98, s22, 16777216
    s_addc_u32 s99, s23, 0
    s_cmp_lt_u32 s72, 8
    s_cselect_b32 s61, 1, 0
    s_and_b32 s59, s72, 7
    s_mul_i32 s59, s59, 4
    s_add_u32 s59, s59, 16777216
    v_mov_b32 v8, s59
    v_mov_b32 v10, 154880
    s_memtime s[28:29]
    s_memrealtime s[96:97]
    s_mov_b32 s32, 0
    s_mov_b64 exec, 1
    s_waitcnt lgkmcnt(0)
    s_mov_b32 s33, s96
    s_waitcnt vmcnt(0)
    s_barrier
    s_mov_b32 s63, 0
L_ctl_loop:
    s_barrier
    s_mov_b32 s62, s96
    s_mov_b32 s30, s28
    s_memtime s[28:29]
    s_memrealtime s[96:97]
    s_waitcnt lgkmcnt(0)
    s_sub_u32 s58, s96, s33
    s_mul_i32 s58, s58, 373
    s_mov_b32 s33, s96
    s_sub_u32 s59, s28, s30
    s_lshl_b32 s59, s59, 4
    s_sub_i32 s58, s58, s59
    s_mul_i32 s58, s58, 80
    s_ashr_i32 s31, s58, 12
    s_cmp_eq_u32 s63, 0
    s_cbranch_scc1 L_ctl_set
    s_mov_b32 s58, 0
    s_sub_i32 s59, s84, s62
    s_add_i32 s60, s59, 5000
    s_cmp_lt_u32 s60, 10000
    s_cselect_b32 s59, s59, 200
    s_add_i32 s58, s58, s59
    s_sub_i32 s59, s85, s62
    s_add_i32 s60, s59, 5000
    s_cmp_lt_u32 s60, 10000
    s_cselect_b32 s59, s59, 200
    s_add_i32 s58, s58, s59
    s_sub_i32 s59, s86, s62
    s_add_i32 s60, s59, 5000
    s_cmp_lt_u32 s60, 10000
    s_cselect_b32 s59, s59, 200
    s_add_i32 s58, s58, s59
    s_sub_i32 s59, s87, s62
    s_add_i32 s60, s59, 5000
    s_cmp_lt_u32 s60, 10000
    s_cselect_b32 s59, s59, 200
    s_add_i32 s58, s58, s59
    s_sub_i32 s59, s88, s62
    s_add_i32 s60, s59, 5000
    s_cmp_lt_u32 s60, 10000
    s_cselect_b32 s59, s59, 200
    s_add_i32 s58, s58, s59
    s_sub_i32 s59, s89, s62
    s_add_i32 s60, s59, 5000
    s_cmp_lt_u32 s60, 10000
    s_cselect_b32 s59, s59, 200
    s_add_i32 s58, s58, s59
    s_sub_i32 s59, s90, s62
    s_add_i32 s60, s59, 5000
    s_cmp_lt_u32 s60, 10000
    s_cselect_b32 s59, s59, 200
    s_add_i32 s58, s58, s59
    s_sub_i32 s59, s91, s62
    s_add_i32 s60, s59, 5000
    s_cmp_lt_u32 s60, 10000
    s_cselect_b32 s59, s59, 200
    s_add_i32 s58, s58, s59
    s_min_u32 s59, s63, 12
    s_cmp_gt_i32 s58, 0
    s_cselect_b32 s63, s59, s63
    s_mul_i32 s58, s58, s63
    s_ashr_i32 s58, s58, 5
    s_mov_b32 s32, s58
L_ctl_set:
    s_sub_i32 s58, s31, s32
    s_add_i32 s58, s58, 4710
    s_max_i32 s58, s58, 4096
    s_min_i32 s70, s58, 6400
    v_mov_b32 v9, s70
    ds_write_b32 v10, v9
    s_and_b32 s58, s71, 768
    s_cselect_b32 s63, 0, 5
    s_cmp_ge_u32 s71, 14848
    s_cselect_b32 s63, 24, s63
    s_cmp_eq_u32 s71, 16128
    s_cselect_b32 s63, 0, s63
    s_mul_i32 s58, s63, s61
    s_cmp_eq_u32 s58, 0
    s_cbranch_scc1 L_ctl_norep
    v_mov_b32 v11, s96
    buffer_store_dword v11, v8, s[52:55], s71 offen sc1
L_ctl_norep:
    s_barrier
    s_barrier
    s_barrier
    s_cmp_eq_u32 s63, 0
    s_cbranch_scc1 L_ctl_nold
    s_load_dwordx8 s[84:91], s[98:99], s71
L_ctl_nold:
    s_add_u32 s71, s71, 256
    s_cmp_lt_u32 s71, 16384
    s_cbranch_scc1 L_ctl_loop
    s_waitcnt lgkmcnt(0)
    s_mov_b64 exec, -1
    s_endpgm
L_consumer:
    v_lshrrev_b32 v3, 2, v1
    v_lshlrev_b32 v3, 3, v3
    v_and_b32 v4, 3, v1
    v_mul_u32_u24 v5, 384, v4
    v_add_u32 v153, v3, v5
    v_add_u32 v153, 155136, v153
    s_mov_b32 s64, 0x3fb8aa3b
    s_mov_b32 s65, 0x3d93cd3a
    s_mov_b32 s66, 0xffff0000
    v_bfe_u32 v36, v1, 2, 1
    v_lshl_add_u32 v36, v2, 2, v36
    v_bfe_u32 v37, v1, 3, 1
    v_lshrrev_b32 v38, 4, v1
    v_lshl_add_u32 v38, v38, 2, v4
    v_lshlrev_b32 v38, 3, v38
    v_add_u32 v38, 73728, v38
    s_movk_i32 s58, 384
    v_add_u32 v3, 0, v36
    v_cmp_le_u32 vcc, 43, v3
    v_add_u32 v5, 43, v3
    v_mov_b32 v6, 42
    v_cndmask_b32 v17, v3, v5, vcc
    v_cmp_le_u32 vcc, 86, v3
    v_add_u32 v5, 43, v17
    s_nop 0
    v_cndmask_b32 v17, v17, v5, vcc
    v_cndmask_b32 v6, 43, v6, vcc
    v_mad_u32_u24 v17, v6, v37, v17
    v_lshrrev_b32 v17, 6, v17
    v_mad_u32_u24 v17, v17, s58, v38
    v_add_u32 v3, 2, v36
    v_cmp_le_u32 vcc, 43, v3
    v_add_u32 v5, 43, v3
    v_mov_b32 v6, 42
    v_cndmask_b32 v18, v3, v5, vcc
    v_cmp_le_u32 vcc, 86, v3
    v_add_u32 v5, 43, v18
    s_nop 0
    v_cndmask_b32 v18, v18, v5, vcc
    v_cndmask_b32 v6, 43, v6, vcc
    v_mad_u32_u24 v18, v6, v37, v18
    v_lshrrev_b32 v18, 6, v18
    v_mad_u32_u24 v18, v18, s58, v38
    v_add_u32 v3, 16, v36
    v_cmp_le_u32 vcc, 43, v3
    v_add_u32 v5, 43, v3
    v_mov_b32 v6, 42
    v_cndmask_b32 v19, v3, v5, vcc
    v_cmp_le_u32 vcc, 86, v3
    v_add_u32 v5, 43, v19
    s_nop 0
    v_cndmask_b32 v19, v19, v5, vcc
    v_cndmask_b32 v6, 43, v6, vcc
    v_mad_u32_u24 v19, v6, v37, v19
    v_lshrrev_b32 v19, 6, v19
    v_mad_u32_u24 v19, v19, s58, v38
    v_add_u32 v3, 18, v36
    v_cmp_le_u32 vcc, 43, v3
    v_add_u32 v5, 43, v3
    v_mov_b32 v6, 42
    v_cndmask_b32 v20, v3, v5, vcc
    v_cmp_le_u32 vcc, 86, v3
    v_add_u32 v5, 43, v20
    s_nop 0
    v_cndmask_b32 v20, v20, v5, vcc
    v_cndmask_b32 v6, 43, v6, vcc
    v_mad_u32_u24 v20, v6, v37, v20
    v_lshrrev_b32 v20, 6, v20
    v_mad_u32_u24 v20, v20, s58, v38
    v_add_u32 v3, 32, v36
    v_cmp_le_u32 vcc, 43, v3
    v_add_u32 v5, 43, v3
    v_mov_b32 v6, 42
    v_cndmask_b32 v21, v3, v5, vcc
    v_cmp_le_u32 vcc, 86, v3
    v_add_u32 v5, 43, v21
    s_nop 0
    v_cndmask_b32 v21, v21, v5, vcc
    v_cndmask_b32 v6, 43, v6, vcc
    v_mad_u32_u24 v21, v6, v37, v21
    v_lshrrev_b32 v21, 6, v21
    v_mad_u32_u24 v21, v21, s58, v38
    v_add_u32 v3, 34, v36
    v_cmp_le_u32 vcc, 43, v3
    v_add_u32 v5, 43, v3
    v_mov_b32 v6, 42
    v_cndmask_b32 v22, v3, v5, vcc
    v_cmp_le_u32 vcc, 86, v3
    v_add_u32 v5, 43, v22
    s_nop 0
    v_cndmask_b32 v22, v22, v5, vcc
    v_cndmask_b32 v6, 43, v6, vcc
    v_mad_u32_u24 v22, v6, v37, v22
    v_lshrrev_b32 v22, 6, v22
    v_mad_u32_u24 v22, v22, s58, v38
    v_add_u32 v3, 48, v36
    v_cmp_le_u32 vcc, 43, v3
    v_add_u32 v5, 43, v3
    v_mov_b32 v6, 42
    v_cndmask_b32 v23, v3, v5, vcc
    v_cmp_le_u32 vcc, 86, v3
    v_add_u32 v5, 43, v23
    s_nop 0
    v_cndmask_b32 v23, v23, v5, vcc
    v_cndmask_b32 v6, 43, v6, vcc
    v_mad_u32_u24 v23, v6, v37, v23
    v_lshrrev_b32 v23, 6, v23
    v_mad_u32_u24 v23, v23, s58, v38
    v_add_u32 v3, 50, v36
    v_cmp_le_u32 vcc, 43, v3
    v_add_u32 v5, 43, v3
    v_mov_b32 v6, 42
    v_cndmask_b32 v24, v3, v5, vcc
    v_cmp_le_u32 vcc, 86, v3
    v_add_u32 v5, 43, v24
    s_nop 0
    v_cndmask_b32 v24, v24, v5, vcc
    v_cndmask_b32 v6, 43, v6, vcc
    v_mad_u32_u24 v24, v6, v37, v24
    v_lshrrev_b32 v24, 6, v24
    v_mad_u32_u24 v24, v24, s58, v38
    v_add_u32 v3, 64, v36
    v_cmp_le_u32 vcc, 43, v3
    v_add_u32 v5, 43, v3
    v_mov_b32 v6, 42
    v_cndmask_b32 v25, v3, v5, vcc
    v_cmp_le_u32 vcc, 86, v3
    v_add_u32 v5, 43, v25
    s_nop 0
    v_cndmask_b32 v25, v25, v5, vcc
    v_cndmask_b32 v6, 43, v6, vcc
    v_mad_u32_u24 v25, v6, v37, v25
    v_lshrrev_b32 v25, 6, v25
    v_mad_u32_u24 v25, v25, s58, v38
    v_add_u32 v3, 66, v36
    v_cmp_le_u32 vcc, 43, v3
    v_add_u32 v5, 43, v3
    v_mov_b32 v6, 42
    v_cndmask_b32 v26, v3, v5, vcc
    v_cmp_le_u32 vcc, 86, v3
    v_add_u32 v5, 43, v26
    s_nop 0
    v_cndmask_b32 v26, v26, v5, vcc
    v_cndmask_b32 v6, 43, v6, vcc
    v_mad_u32_u24 v26, v6, v37, v26
    v_lshrrev_b32 v26, 6, v26
    v_mad_u32_u24 v26, v26, s58, v38
    v_add_u32 v3, 80, v36
    v_cmp_le_u32 vcc, 43, v3
    v_add_u32 v5, 43, v3
    v_mov_b32 v6, 42
    v_cndmask_b32 v27, v3, v5, vcc
    v_cmp_le_u32 vcc, 86, v3
    v_add_u32 v5, 43, v27
    s_nop 0
    v_cndmask_b32 v27, v27, v5, vcc
    v_cndmask_b32 v6, 43, v6, vcc
    v_mad_u32_u24 v27, v6, v37, v27
    v_lshrrev_b32 v27, 6, v27
    v_mad_u32_u24 v27, v27, s58, v38
    v_add_u32 v3, 82, v36
    v_cmp_le_u32 vcc, 43, v3
    v_add_u32 v5, 43, v3
    v_mov_b32 v6, 42
    v_cndmask_b32 v28, v3, v5, vcc
    v_cmp_le_u32 vcc, 86, v3
    v_add_u32 v5, 43, v28
    s_nop 0
    v_cndmask_b32 v28, v28, v5, vcc
    v_cndmask_b32 v6, 43, v6, vcc
    v_mad_u32_u24 v28, v6, v37, v28
    v_lshrrev_b32 v28, 6, v28
    v_mad_u32_u24 v28, v28, s58, v38
    v_add_u32 v3, 96, v36
    v_cmp_le_u32 vcc, 43, v3
    v_add_u32 v5, 43, v3
    v_mov_b32 v6, 42
    v_cndmask_b32 v29, v3, v5, vcc
    v_cmp_le_u32 vcc, 86, v3
    v_add_u32 v5, 43, v29
    s_nop 0
    v_cndmask_b32 v29, v29, v5, vcc
    v_cndmask_b32 v6, 43, v6, vcc
    v_mad_u32_u24 v29, v6, v37, v29
    v_lshrrev_b32 v29, 6, v29
    v_mad_u32_u24 v29, v29, s58, v38
    v_add_u32 v3, 98, v36
    v_cmp_le_u32 vcc, 43, v3
    v_add_u32 v5, 43, v3
    v_mov_b32 v6, 42
    v_cndmask_b32 v30, v3, v5, vcc
    v_cmp_le_u32 vcc, 86, v3
    v_add_u32 v5, 43, v30
    s_nop 0
    v_cndmask_b32 v30, v30, v5, vcc
    v_cndmask_b32 v6, 43, v6, vcc
    v_mad_u32_u24 v30, v6, v37, v30
    v_lshrrev_b32 v30, 6, v30
    v_mad_u32_u24 v30, v30, s58, v38
    v_add_u32 v3, 112, v36
    v_cmp_le_u32 vcc, 43, v3
    v_add_u32 v5, 43, v3
    v_mov_b32 v6, 42
    v_cndmask_b32 v31, v3, v5, vcc
    v_cmp_le_u32 vcc, 86, v3
    v_add_u32 v5, 43, v31
    s_nop 0
    v_cndmask_b32 v31, v31, v5, vcc
    v_cndmask_b32 v6, 43, v6, vcc
    v_mad_u32_u24 v31, v6, v37, v31
    v_lshrrev_b32 v31, 6, v31
    v_mad_u32_u24 v31, v31, s58, v38
    v_add_u32 v3, 114, v36
    v_cmp_le_u32 vcc, 43, v3
    v_add_u32 v5, 43, v3
    v_mov_b32 v6, 42
    v_cndmask_b32 v32, v3, v5, vcc
    v_cmp_le_u32 vcc, 86, v3
    v_add_u32 v5, 43, v32
    s_nop 0
    v_cndmask_b32 v32, v32, v5, vcc
    v_cndmask_b32 v6, 43, v6, vcc
    v_mad_u32_u24 v32, v6, v37, v32
    v_lshrrev_b32 v32, 6, v32
    v_mad_u32_u24 v32, v32, s58, v38
    v_bfe_u32 v36, v1, 4, 1
    v_lshl_add_u32 v36, v2, 2, v36
    v_bfe_u32 v3, v1, 2, 2
    v_lshl_add_u32 v36, v3, 4, v36
    v_lshrrev_b32 v37, 5, v1
    s_mov_b32 s58, 125952
    v_add_u32 v3, 0, v36
    v_cmp_le_u32 vcc, 43, v3
    v_add_u32 v5, 43, v3
    v_mov_b32 v6, 42
    v_cndmask_b32 v7, v3, v5, vcc
    v_cmp_le_u32 vcc, 86, v3
    v_add_u32 v5, 43, v7
    s_nop 0
    v_cndmask_b32 v7, v7, v5, vcc
    v_cndmask_b32 v6, 43, v6, vcc
    v_mad_u32_u24 v7, v6, v37, v7
    v_lshl_add_u32 v7, v7, 1, s58
    v_add_u32 v3, 2, v36
    v_cmp_le_u32 vcc, 43, v3
    v_add_u32 v5, 43, v3
    v_mov_b32 v6, 42
    v_cndmask_b32 v8, v3, v5, vcc
    v_cmp_le_u32 vcc, 86, v3
    v_add_u32 v5, 43, v8
    s_nop 0
    v_cndmask_b32 v8, v8, v5, vcc
    v_cndmask_b32 v6, 43, v6, vcc
    v_mad_u32_u24 v8, v6, v37, v8
    v_lshl_add_u32 v8, v8, 1, s58
    v_add_u32 v3, 64, v36
    v_cmp_le_u32 vcc, 43, v3
    v_add_u32 v5, 43, v3
    v_mov_b32 v6, 42
    v_cndmask_b32 v9, v3, v5, vcc
    v_cmp_le_u32 vcc, 86, v3
    v_add_u32 v5, 43, v9
    s_nop 0
    v_cndmask_b32 v9, v9, v5, vcc
    v_cndmask_b32 v6, 43, v6, vcc
    v_mad_u32_u24 v9, v6, v37, v9
    v_lshl_add_u32 v9, v9, 1, s58
    v_add_u32 v3, 66, v36
    v_cmp_le_u32 vcc, 43, v3
    v_add_u32 v5, 43, v3
    v_mov_b32 v6, 42
    v_cndmask_b32 v10, v3, v5, vcc
    v_cmp_le_u32 vcc, 86, v3
    v_add_u32 v5, 43, v10
    s_nop 0
    v_cndmask_b32 v10, v10, v5, vcc
    v_cndmask_b32 v6, 43, v6, vcc
    v_mad_u32_u24 v10, v6, v37, v10
    v_lshl_add_u32 v10, v10, 1, s58
    v_lshlrev_b32 v11, 2, v1
    v_lshl_add_u32 v11, v2, 9, v11
    v_add_u32 v11, 73728, v11
    v_bfe_u32 v3, v1, 2, 2
    v_lshrrev_b32 v4, 4, v1
    v_and_b32 v5, 3, v1
    v_lshl_add_u32 v4, v4, 2, v5
    v_lshl_add_u32 v3, v2, 3, v3
    v_mul_u32_u24 v3, 768, v3
    v_lshl_add_u32 v12, v4, 4, v3
    v_and_b32 v3, 3, v1
    v_lshl_add_u32 v154, v3, 2, v2
    v_lshlrev_b32 v154, 2, v154
    v_add_u32 v154, 154944, v154
    v_mov_b32 v14, 0xff800000
    s_mov_b32 s61, 0
    s_mov_b32 s62, 0
    s_movk_i32 s63, 3072
    s_waitcnt vmcnt(0) lgkmcnt(0)
    s_barrier
    ds_read_b64 v[164:165], v153 offset:0
    ds_read_b64 v[166:167], v153 offset:128
    ds_read_b64 v[168:169], v153 offset:256
    v_add_u32 v153, 1536, v153
    v_add_u32 v33, s63, v17
    v_add_u32 v34, s63, v18
    ds_read_b64 v[108:109], v33 offset:0
    ds_read_b64 v[110:111], v33 offset:1536
    ds_read_b64 v[112:113], v33 offset:128
    ds_read_b64 v[114:115], v33 offset:1664
    ds_read_b64 v[116:117], v33 offset:256
    ds_read_b64 v[118:119], v33 offset:1792
    ds_read_b64 v[120:121], v34 offset:0
    ds_read_b64 v[122:123], v34 offset:1536
    ds_read_b64 v[124:125], v34 offset:128
    ds_read_b64 v[126:127], v34 offset:1664
    ds_read_b64 v[128:129], v34 offset:256
    ds_read_b64 v[130:131], v34 offset:1792
    s_waitcnt lgkmcnt(0)
    v_lshlrev_b32 v60, 16, v108
    v_and_b32 v61, s66, v108
    v_lshlrev_b32 v62, 16, v109
    v_and_b32 v63, s66, v109
    v_lshlrev_b32 v84, 16, v110
    v_and_b32 v85, s66, v110
    v_lshlrev_b32 v86, 16, v111
    v_and_b32 v87, s66, v111
    v_lshlrev_b32 v64, 16, v112
    v_and_b32 v65, s66, v112
    v_lshlrev_b32 v66, 16, v113
    v_and_b32 v67, s66, v113
    v_lshlrev_b32 v88, 16, v114
    v_and_b32 v89, s66, v114
    v_lshlrev_b32 v90, 16, v115
    v_and_b32 v91, s66, v115
    v_lshlrev_b32 v68, 16, v116
    v_and_b32 v69, s66, v116
    v_lshlrev_b32 v70, 16, v117
    v_and_b32 v71, s66, v117
    v_lshlrev_b32 v92, 16, v118
    v_and_b32 v93, s66, v118
    v_lshlrev_b32 v94, 16, v119
    v_and_b32 v95, s66, v119
    v_lshlrev_b32 v72, 16, v120
    v_and_b32 v73, s66, v120
    v_lshlrev_b32 v74, 16, v121
    v_and_b32 v75, s66, v121
    v_lshlrev_b32 v96, 16, v122
    v_and_b32 v97, s66, v122
    v_lshlrev_b32 v98, 16, v123
    v_and_b32 v99, s66, v123
    v_lshlrev_b32 v76, 16, v124
    v_and_b32 v77, s66, v124
    v_lshlrev_b32 v78, 16, v125
    v_and_b32 v79, s66, v125
    v_lshlrev_b32 v100, 16, v126
    v_and_b32 v101, s66, v126
    v_lshlrev_b32 v102, 16, v127
    v_and_b32 v103, s66, v127
    v_lshlrev_b32 v80, 16, v128
    v_and_b32 v81, s66, v128
    v_lshlrev_b32 v82, 16, v129
    v_and_b32 v83, s66, v129
    v_lshlrev_b32 v104, 16, v130
    v_and_b32 v105, s66, v130
    v_lshlrev_b32 v106, 16, v131
    v_and_b32 v107, s66, v131
L_kblk:
    v_add_u32 v13, s62, v12
    s_add_u32 s62, s62, 24576
    s_cmp_eq_u32 s62, 73728
    s_cselect_b32 s62, 0, s62
    s_barrier
    ds_read_b128 v[36:39], v13 offset:0
    ds_read_b128 v[40:43], v13 offset:256
    ds_read_b128 v[44:47], v13 offset:512
    ds_read_b128 v[48:51], v13 offset:3072
    ds_read_b128 v[52:55], v13 offset:3328
    ds_read_b128 v[56:59], v13 offset:3584
    s_waitcnt lgkmcnt(3)
    v_cvt_f32_i32 v36, v36
    v_cvt_f32_i32 v37, v37
    v_cvt_f32_i32 v38, v38
    v_cvt_f32_i32 v39, v39
    v_cvt_f32_i32 v40, v40
    v_cvt_f32_i32 v41, v41
    v_cvt_f32_i32 v42, v42
    v_cvt_f32_i32 v43, v43
    v_cvt_f32_i32 v44, v44
    v_cvt_f32_i32 v45, v45
    v_cvt_f32_i32 v46, v46
    v_cvt_f32_i32 v47, v47
    v_sub_f32 v36, v36, v60
    v_sub_f32 v37, v37, v61
    v_sub_f32 v38, v38, v62
    v_sub_f32 v39, v39, v63
    v_sub_f32 v40, v40, v64
    v_sub_f32 v41, v41, v65
    v_sub_f32 v42, v42, v66
    v_sub_f32 v43, v43, v67
    v_sub_f32 v44, v44, v68
    v_sub_f32 v45, v45, v69
    v_sub_f32 v46, v46, v70
    v_sub_f32 v47, v47, v71
    v_cvt_pk_bf16_f32 v36, 0, v36
    v_cvt_pk_bf16_f32 v37, 0, v37
    v_cvt_pk_bf16_f32 v38, 0, v38
    v_cvt_pk_bf16_f32 v39, 0, v39
    v_cvt_pk_bf16_f32 v40, 0, v40
    v_cvt_pk_bf16_f32 v41, 0, v41
    v_cvt_pk_bf16_f32 v42, 0, v42
    v_cvt_pk_bf16_f32 v43, 0, v43
    v_cvt_pk_bf16_f32 v44, 0, v44
    v_cvt_pk_bf16_f32 v45, 0, v45
    v_cvt_pk_bf16_f32 v46, 0, v46
    v_cvt_pk_bf16_f32 v47, 0, v47
    v_mul_f32 v36, v36, v84
    v_mul_f32 v37, v37, v85
    v_mul_f32 v38, v38, v86
    v_mul_f32 v39, v39, v87
    v_mul_f32 v40, v40, v88
    v_mul_f32 v41, v41, v89
    v_mul_f32 v42, v42, v90
    v_mul_f32 v43, v43, v91
    v_mul_f32 v44, v44, v92
    v_mul_f32 v45, v45, v93
    v_mul_f32 v46, v46, v94
    v_mul_f32 v47, v47, v95
    v_cvt_pk_bf16_f32 v132, v36, v37
    v_cvt_pk_bf16_f32 v133, v38, v39
    v_cvt_pk_bf16_f32 v134, v40, v41
    v_cvt_pk_bf16_f32 v135, v42, v43
    v_cvt_pk_bf16_f32 v136, v44, v45
    v_cvt_pk_bf16_f32 v137, v46, v47
    v_mfma_f32_16x16x16_bf16 v[144:147], v[132:133], v[164:165], 0
    v_mfma_f32_16x16x16_bf16 v[144:147], v[134:135], v[166:167], v[144:147]
    v_mfma_f32_16x16x16_bf16 v[144:147], v[136:137], v[168:169], v[144:147]
    s_waitcnt lgkmcnt(0)
    v_cvt_f32_i32 v48, v48
    v_cvt_f32_i32 v49, v49
    v_cvt_f32_i32 v50, v50
    v_cvt_f32_i32 v51, v51
    v_cvt_f32_i32 v52, v52
    v_cvt_f32_i32 v53, v53
    v_cvt_f32_i32 v54, v54
    v_cvt_f32_i32 v55, v55
    v_cvt_f32_i32 v56, v56
    v_cvt_f32_i32 v57, v57
    v_cvt_f32_i32 v58, v58
    v_cvt_f32_i32 v59, v59
    v_sub_f32 v48, v48, v72
    v_sub_f32 v49, v49, v73
    v_sub_f32 v50, v50, v74
    v_sub_f32 v51, v51, v75
    v_sub_f32 v52, v52, v76
    v_sub_f32 v53, v53, v77
    v_sub_f32 v54, v54, v78
    v_sub_f32 v55, v55, v79
    v_sub_f32 v56, v56, v80
    v_sub_f32 v57, v57, v81
    v_sub_f32 v58, v58, v82
    v_sub_f32 v59, v59, v83
    v_cvt_pk_bf16_f32 v48, 0, v48
    v_cvt_pk_bf16_f32 v49, 0, v49
    v_cvt_pk_bf16_f32 v50, 0, v50
    v_cvt_pk_bf16_f32 v51, 0, v51
    v_cvt_pk_bf16_f32 v52, 0, v52
    v_cvt_pk_bf16_f32 v53, 0, v53
    v_cvt_pk_bf16_f32 v54, 0, v54
    v_cvt_pk_bf16_f32 v55, 0, v55
    v_cvt_pk_bf16_f32 v56, 0, v56
    v_cvt_pk_bf16_f32 v57, 0, v57
    v_cvt_pk_bf16_f32 v58, 0, v58
    v_cvt_pk_bf16_f32 v59, 0, v59
    v_mul_f32 v48, v48, v96
    v_mul_f32 v49, v49, v97
    v_mul_f32 v50, v50, v98
    v_mul_f32 v51, v51, v99
    v_mul_f32 v52, v52, v100
    v_mul_f32 v53, v53, v101
    v_mul_f32 v54, v54, v102
    v_mul_f32 v55, v55, v103
    v_mul_f32 v56, v56, v104
    v_mul_f32 v57, v57, v105
    v_mul_f32 v58, v58, v106
    v_mul_f32 v59, v59, v107
    v_cvt_pk_bf16_f32 v138, v48, v49
    v_cvt_pk_bf16_f32 v139, v50, v51
    v_add_f32_dpp v3, v145, v144 row_ror:12 row_mask:0xf bank_mask:0xf
    v_cvt_pk_bf16_f32 v140, v52, v53
    v_cvt_pk_bf16_f32 v141, v54, v55
    v_add_f32_dpp v3, v146, v3 row_ror:8 row_mask:0xf bank_mask:0xf
    v_cvt_pk_bf16_f32 v142, v56, v57
    v_cvt_pk_bf16_f32 v143, v58, v59
    v_add_f32_dpp v15, v147, v3 row_ror:4 row_mask:0xf bank_mask:0x1
    v_mfma_f32_16x16x16_bf16 v[148:151], v[138:139], v[164:165], 0
    v_mfma_f32_16x16x16_bf16 v[148:151], v[140:141], v[166:167], v[148:151]
    v_mfma_f32_16x16x16_bf16 v[148:151], v[142:143], v[168:169], v[148:151]
    v_add_u32 v33, s63, v19
    v_add_u32 v34, s63, v20
    ds_read_b64 v[108:109], v33 offset:0
    ds_read_b64 v[110:111], v33 offset:1536
    ds_read_b64 v[112:113], v33 offset:128
    ds_read_b64 v[114:115], v33 offset:1664
    ds_read_b64 v[116:117], v33 offset:256
    ds_read_b64 v[118:119], v33 offset:1792
    ds_read_b64 v[120:121], v34 offset:0
    v_add_f32_dpp v4, v149, v148 row_ror:12 row_mask:0xf bank_mask:0xf
    ds_read_b64 v[122:123], v34 offset:1536
    ds_read_b64 v[124:125], v34 offset:128
    v_add_f32_dpp v4, v150, v4 row_ror:8 row_mask:0xf bank_mask:0xf
    ds_read_b64 v[126:127], v34 offset:1664
    ds_read_b64 v[128:129], v34 offset:256
    ds_read_b64 v[130:131], v34 offset:1792
    v_add_f32_dpp v16, v151, v4 row_ror:4 row_mask:0xf bank_mask:0x1
    s_waitcnt lgkmcnt(0)
    v_lshlrev_b32 v60, 16, v108
    v_and_b32 v61, s66, v108
    v_lshlrev_b32 v62, 16, v109
    v_and_b32 v63, s66, v109
    v_lshlrev_b32 v84, 16, v110
    v_and_b32 v85, s66, v110
    v_lshlrev_b32 v86, 16, v111
    v_and_b32 v87, s66, v111
    v_lshlrev_b32 v64, 16, v112
    v_and_b32 v65, s66, v112
    v_lshlrev_b32 v66, 16, v113
    v_and_b32 v67, s66, v113
    v_lshlrev_b32 v88, 16, v114
    v_and_b32 v89, s66, v114
    v_lshlrev_b32 v90, 16, v115
    v_and_b32 v91, s66, v115
    v_lshlrev_b32 v68, 16, v116
    v_and_b32 v69, s66, v116
    v_lshlrev_b32 v70, 16, v117
    v_and_b32 v71, s66, v117
    v_lshlrev_b32 v92, 16, v118
    v_and_b32 v93, s66, v118
    v_lshlrev_b32 v94, 16, v119
    v_and_b32 v95, s66, v119
    v_lshlrev_b32 v72, 16, v120
    v_and_b32 v73, s66, v120
    v_lshlrev_b32 v74, 16, v121
    v_and_b32 v75, s66, v121
    v_lshlrev_b32 v96, 16, v122
    v_and_b32 v97, s66, v122
    v_lshlrev_b32 v98, 16, v123
    v_and_b32 v99, s66, v123
    v_lshlrev_b32 v76, 16, v124
    v_and_b32 v77, s66, v124
    v_lshlrev_b32 v78, 16, v125
    v_and_b32 v79, s66, v125
    v_lshlrev_b32 v100, 16, v126
    v_and_b32 v101, s66, v126
    v_lshlrev_b32 v102, 16, v127
    v_and_b32 v103, s66, v127
    v_lshlrev_b32 v80, 16, v128
    v_and_b32 v81, s66, v128
    v_lshlrev_b32 v82, 16, v129
    v_and_b32 v83, s66, v129
    v_lshlrev_b32 v104, 16, v130
    v_and_b32 v105, s66, v130
    v_lshlrev_b32 v106, 16, v131
    v_and_b32 v107, s66, v131
    v_add_u32 v13, s62, v12
    s_add_u32 s62, s62, 24576
    s_cmp_eq_u32 s62, 73728
    s_cselect_b32 s62, 0, s62
    s_barrier
    ds_read_b128 v[36:39], v13 offset:0
    ds_read_b128 v[40:43], v13 offset:256
    ds_read_b128 v[44:47], v13 offset:512
    ds_read_b128 v[48:51], v13 offset:3072
    ds_read_b128 v[52:55], v13 offset:3328
    ds_read_b128 v[56:59], v13 offset:3584
    s_waitcnt lgkmcnt(3)
    v_cvt_f32_i32 v36, v36
    v_cvt_f32_i32 v37, v37
    v_cvt_f32_i32 v38, v38
    v_cvt_f32_i32 v39, v39
    v_cvt_f32_i32 v40, v40
    v_cvt_f32_i32 v41, v41
    v_cvt_f32_i32 v42, v42
    v_cvt_f32_i32 v43, v43
    v_cvt_f32_i32 v44, v44
    v_cvt_f32_i32 v45, v45
    v_cvt_f32_i32 v46, v46
    v_cvt_f32_i32 v47, v47
    v_sub_f32 v36, v36, v60
    v_sub_f32 v37, v37, v61
    v_sub_f32 v38, v38, v62
    v_sub_f32 v39, v39, v63
    v_sub_f32 v40, v40, v64
    v_sub_f32 v41, v41, v65
    v_sub_f32 v42, v42, v66
    v_sub_f32 v43, v43, v67
    v_sub_f32 v44, v44, v68
    v_sub_f32 v45, v45, v69
    v_sub_f32 v46, v46, v70
    v_sub_f32 v47, v47, v71
    v_cvt_pk_bf16_f32 v36, 0, v36
    v_cvt_pk_bf16_f32 v37, 0, v37
    v_cvt_pk_bf16_f32 v38, 0, v38
    v_cvt_pk_bf16_f32 v39, 0, v39
    v_cvt_pk_bf16_f32 v40, 0, v40
    v_cvt_pk_bf16_f32 v41, 0, v41
    v_cvt_pk_bf16_f32 v42, 0, v42
    v_cvt_pk_bf16_f32 v43, 0, v43
    v_cvt_pk_bf16_f32 v44, 0, v44
    v_cvt_pk_bf16_f32 v45, 0, v45
    v_cvt_pk_bf16_f32 v46, 0, v46
    v_cvt_pk_bf16_f32 v47, 0, v47
    v_mul_f32 v36, v36, v84
    v_mul_f32 v37, v37, v85
    v_mul_f32 v38, v38, v86
    v_mul_f32 v39, v39, v87
    v_mul_f32 v40, v40, v88
    v_mul_f32 v41, v41, v89
    v_mul_f32 v42, v42, v90
    v_mul_f32 v43, v43, v91
    v_mul_f32 v44, v44, v92
    v_mul_f32 v45, v45, v93
    v_mul_f32 v46, v46, v94
    v_mul_f32 v47, v47, v95
    v_cvt_pk_bf16_f32 v132, v36, v37
    v_cvt_pk_bf16_f32 v133, v38, v39
    v_cvt_pk_bf16_f32 v134, v40, v41
    v_cvt_pk_bf16_f32 v135, v42, v43
    v_cvt_pk_bf16_f32 v136, v44, v45
    v_cvt_pk_bf16_f32 v137, v46, v47
    v_mfma_f32_16x16x16_bf16 v[144:147], v[132:133], v[164:165], 0
    v_mfma_f32_16x16x16_bf16 v[144:147], v[134:135], v[166:167], v[144:147]
    v_mfma_f32_16x16x16_bf16 v[144:147], v[136:137], v[168:169], v[144:147]
    s_waitcnt lgkmcnt(0)
    v_cvt_f32_i32 v48, v48
    v_cvt_f32_i32 v49, v49
    v_cvt_f32_i32 v50, v50
    v_cvt_f32_i32 v51, v51
    v_cvt_f32_i32 v52, v52
    v_cvt_f32_i32 v53, v53
    v_cvt_f32_i32 v54, v54
    v_cvt_f32_i32 v55, v55
    v_cvt_f32_i32 v56, v56
    v_cvt_f32_i32 v57, v57
    v_cvt_f32_i32 v58, v58
    v_cvt_f32_i32 v59, v59
    v_sub_f32 v48, v48, v72
    v_sub_f32 v49, v49, v73
    v_sub_f32 v50, v50, v74
    v_sub_f32 v51, v51, v75
    v_sub_f32 v52, v52, v76
    v_sub_f32 v53, v53, v77
    v_sub_f32 v54, v54, v78
    v_sub_f32 v55, v55, v79
    v_sub_f32 v56, v56, v80
    v_sub_f32 v57, v57, v81
    v_sub_f32 v58, v58, v82
    v_sub_f32 v59, v59, v83
    v_cvt_pk_bf16_f32 v48, 0, v48
    v_cvt_pk_bf16_f32 v49, 0, v49
    v_cvt_pk_bf16_f32 v50, 0, v50
    v_cvt_pk_bf16_f32 v51, 0, v51
    v_cvt_pk_bf16_f32 v52, 0, v52
    v_cvt_pk_bf16_f32 v53, 0, v53
    v_cvt_pk_bf16_f32 v54, 0, v54
    v_cvt_pk_bf16_f32 v55, 0, v55
    v_cvt_pk_bf16_f32 v56, 0, v56
    v_cvt_pk_bf16_f32 v57, 0, v57
    v_cvt_pk_bf16_f32 v58, 0, v58
    v_cvt_pk_bf16_f32 v59, 0, v59
    v_mul_f32 v48, v48, v96
    v_mul_f32 v49, v49, v97
    v_mul_f32 v50, v50, v98
    v_mul_f32 v51, v51, v99
    v_mul_f32 v52, v52, v100
    v_mul_f32 v53, v53, v101
    v_mul_f32 v54, v54, v102
    v_mul_f32 v55, v55, v103
    v_mul_f32 v56, v56, v104
    v_mul_f32 v57, v57, v105
    v_mul_f32 v58, v58, v106
    v_mul_f32 v59, v59, v107
    v_cvt_pk_bf16_f32 v138, v48, v49
    v_cvt_pk_bf16_f32 v139, v50, v51
    v_add_f32_dpp v3, v146, v145 row_ror:12 row_mask:0xf bank_mask:0xf
    v_cvt_pk_bf16_f32 v140, v52, v53
    v_cvt_pk_bf16_f32 v141, v54, v55
    v_add_f32_dpp v3, v147, v3 row_ror:8 row_mask:0xf bank_mask:0xf
    v_cvt_pk_bf16_f32 v142, v56, v57
    v_cvt_pk_bf16_f32 v143, v58, v59
    v_add_f32_dpp v15, v144, v3 row_ror:4 row_mask:0xf bank_mask:0x2
    v_mfma_f32_16x16x16_bf16 v[148:151], v[138:139], v[164:165], 0
    v_mfma_f32_16x16x16_bf16 v[148:151], v[140:141], v[166:167], v[148:151]
    v_mfma_f32_16x16x16_bf16 v[148:151], v[142:143], v[168:169], v[148:151]
    v_add_u32 v33, s63, v21
    v_add_u32 v34, s63, v22
    ds_read_b64 v[108:109], v33 offset:0
    ds_read_b64 v[110:111], v33 offset:1536
    ds_read_b64 v[112:113], v33 offset:128
    ds_read_b64 v[114:115], v33 offset:1664
    ds_read_b64 v[116:117], v33 offset:256
    ds_read_b64 v[118:119], v33 offset:1792
    ds_read_b64 v[120:121], v34 offset:0
    v_add_f32_dpp v4, v150, v149 row_ror:12 row_mask:0xf bank_mask:0xf
    ds_read_b64 v[122:123], v34 offset:1536
    ds_read_b64 v[124:125], v34 offset:128
    v_add_f32_dpp v4, v151, v4 row_ror:8 row_mask:0xf bank_mask:0xf
    ds_read_b64 v[126:127], v34 offset:1664
    ds_read_b64 v[128:129], v34 offset:256
    ds_read_b64 v[130:131], v34 offset:1792
    v_add_f32_dpp v16, v148, v4 row_ror:4 row_mask:0xf bank_mask:0x2
    s_waitcnt lgkmcnt(0)
    v_lshlrev_b32 v60, 16, v108
    v_and_b32 v61, s66, v108
    v_lshlrev_b32 v62, 16, v109
    v_and_b32 v63, s66, v109
    v_lshlrev_b32 v84, 16, v110
    v_and_b32 v85, s66, v110
    v_lshlrev_b32 v86, 16, v111
    v_and_b32 v87, s66, v111
    v_lshlrev_b32 v64, 16, v112
    v_and_b32 v65, s66, v112
    v_lshlrev_b32 v66, 16, v113
    v_and_b32 v67, s66, v113
    v_lshlrev_b32 v88, 16, v114
    v_and_b32 v89, s66, v114
    v_lshlrev_b32 v90, 16, v115
    v_and_b32 v91, s66, v115
    v_lshlrev_b32 v68, 16, v116
    v_and_b32 v69, s66, v116
    v_lshlrev_b32 v70, 16, v117
    v_and_b32 v71, s66, v117
    v_lshlrev_b32 v92, 16, v118
    v_and_b32 v93, s66, v118
    v_lshlrev_b32 v94, 16, v119
    v_and_b32 v95, s66, v119
    v_lshlrev_b32 v72, 16, v120
    v_and_b32 v73, s66, v120
    v_lshlrev_b32 v74, 16, v121
    v_and_b32 v75, s66, v121
    v_lshlrev_b32 v96, 16, v122
    v_and_b32 v97, s66, v122
    v_lshlrev_b32 v98, 16, v123
    v_and_b32 v99, s66, v123
    v_lshlrev_b32 v76, 16, v124
    v_and_b32 v77, s66, v124
    v_lshlrev_b32 v78, 16, v125
    v_and_b32 v79, s66, v125
    v_lshlrev_b32 v100, 16, v126
    v_and_b32 v101, s66, v126
    v_lshlrev_b32 v102, 16, v127
    v_and_b32 v103, s66, v127
    v_lshlrev_b32 v80, 16, v128
    v_and_b32 v81, s66, v128
    v_lshlrev_b32 v82, 16, v129
    v_and_b32 v83, s66, v129
    v_lshlrev_b32 v104, 16, v130
    v_and_b32 v105, s66, v130
    v_lshlrev_b32 v106, 16, v131
    v_and_b32 v107, s66, v131
    v_add_u32 v13, s62, v12
    s_add_u32 s62, s62, 24576
    s_cmp_eq_u32 s62, 73728
    s_cselect_b32 s62, 0, s62
    s_barrier
    ds_read_b128 v[36:39], v13 offset:0
    ds_read_b128 v[40:43], v13 offset:256
    ds_read_b128 v[44:47], v13 offset:512
    ds_read_b128 v[48:51], v13 offset:3072
    ds_read_b128 v[52:55], v13 offset:3328
    ds_read_b128 v[56:59], v13 offset:3584
    s_waitcnt lgkmcnt(3)
    v_cvt_f32_i32 v36, v36
    v_cvt_f32_i32 v37, v37
    v_cvt_f32_i32 v38, v38
    v_cvt_f32_i32 v39, v39
    v_cvt_f32_i32 v40, v40
    v_cvt_f32_i32 v41, v41
    v_cvt_f32_i32 v42, v42
    v_cvt_f32_i32 v43, v43
    v_cvt_f32_i32 v44, v44
    v_cvt_f32_i32 v45, v45
    v_cvt_f32_i32 v46, v46
    v_cvt_f32_i32 v47, v47
    v_sub_f32 v36, v36, v60
    v_sub_f32 v37, v37, v61
    v_sub_f32 v38, v38, v62
    v_sub_f32 v39, v39, v63
    v_sub_f32 v40, v40, v64
    v_sub_f32 v41, v41, v65
    v_sub_f32 v42, v42, v66
    v_sub_f32 v43, v43, v67
    v_sub_f32 v44, v44, v68
    v_sub_f32 v45, v45, v69
    v_sub_f32 v46, v46, v70
    v_sub_f32 v47, v47, v71
    v_cvt_pk_bf16_f32 v36, 0, v36
    v_cvt_pk_bf16_f32 v37, 0, v37
    v_cvt_pk_bf16_f32 v38, 0, v38
    v_cvt_pk_bf16_f32 v39, 0, v39
    v_cvt_pk_bf16_f32 v40, 0, v40
    v_cvt_pk_bf16_f32 v41, 0, v41
    v_cvt_pk_bf16_f32 v42, 0, v42
    v_cvt_pk_bf16_f32 v43, 0, v43
    v_cvt_pk_bf16_f32 v44, 0, v44
    v_cvt_pk_bf16_f32 v45, 0, v45
    v_cvt_pk_bf16_f32 v46, 0, v46
    v_cvt_pk_bf16_f32 v47, 0, v47
    v_mul_f32 v36, v36, v84
    v_mul_f32 v37, v37, v85
    v_mul_f32 v38, v38, v86
    v_mul_f32 v39, v39, v87
    v_mul_f32 v40, v40, v88
    v_mul_f32 v41, v41, v89
    v_mul_f32 v42, v42, v90
    v_mul_f32 v43, v43, v91
    v_mul_f32 v44, v44, v92
    v_mul_f32 v45, v45, v93
    v_mul_f32 v46, v46, v94
    v_mul_f32 v47, v47, v95
    v_cvt_pk_bf16_f32 v132, v36, v37
    v_cvt_pk_bf16_f32 v133, v38, v39
    v_cvt_pk_bf16_f32 v134, v40, v41
    v_cvt_pk_bf16_f32 v135, v42, v43
    v_cvt_pk_bf16_f32 v136, v44, v45
    v_cvt_pk_bf16_f32 v137, v46, v47
    v_mfma_f32_16x16x16_bf16 v[144:147], v[132:133], v[164:165], 0
    v_mfma_f32_16x16x16_bf16 v[144:147], v[134:135], v[166:167], v[144:147]
    v_mfma_f32_16x16x16_bf16 v[144:147], v[136:137], v[168:169], v[144:147]
    s_waitcnt lgkmcnt(0)
    v_cvt_f32_i32 v48, v48
    v_cvt_f32_i32 v49, v49
    v_cvt_f32_i32 v50, v50
    v_cvt_f32_i32 v51, v51
    v_cvt_f32_i32 v52, v52
    v_cvt_f32_i32 v53, v53
    v_cvt_f32_i32 v54, v54
    v_cvt_f32_i32 v55, v55
    v_cvt_f32_i32 v56, v56
    v_cvt_f32_i32 v57, v57
    v_cvt_f32_i32 v58, v58
    v_cvt_f32_i32 v59, v59
    v_sub_f32 v48, v48, v72
    v_sub_f32 v49, v49, v73
    v_sub_f32 v50, v50, v74
    v_sub_f32 v51, v51, v75
    v_sub_f32 v52, v52, v76
    v_sub_f32 v53, v53, v77
    v_sub_f32 v54, v54, v78
    v_sub_f32 v55, v55, v79
    v_sub_f32 v56, v56, v80
    v_sub_f32 v57, v57, v81
    v_sub_f32 v58, v58, v82
    v_sub_f32 v59, v59, v83
    v_cvt_pk_bf16_f32 v48, 0, v48
    v_cvt_pk_bf16_f32 v49, 0, v49
    v_cvt_pk_bf16_f32 v50, 0, v50
    v_cvt_pk_bf16_f32 v51, 0, v51
    v_cvt_pk_bf16_f32 v52, 0, v52
    v_cvt_pk_bf16_f32 v53, 0, v53
    v_cvt_pk_bf16_f32 v54, 0, v54
    v_cvt_pk_bf16_f32 v55, 0, v55
    v_cvt_pk_bf16_f32 v56, 0, v56
    v_cvt_pk_bf16_f32 v57, 0, v57
    v_cvt_pk_bf16_f32 v58, 0, v58
    v_cvt_pk_bf16_f32 v59, 0, v59
    v_mul_f32 v48, v48, v96
    v_mul_f32 v49, v49, v97
    v_mul_f32 v50, v50, v98
    v_mul_f32 v51, v51, v99
    v_mul_f32 v52, v52, v100
    v_mul_f32 v53, v53, v101
    v_mul_f32 v54, v54, v102
    v_mul_f32 v55, v55, v103
    v_mul_f32 v56, v56, v104
    v_mul_f32 v57, v57, v105
    v_mul_f32 v58, v58, v106
    v_mul_f32 v59, v59, v107
    v_cvt_pk_bf16_f32 v138, v48, v49
    v_cvt_pk_bf16_f32 v139, v50, v51
    v_add_f32_dpp v3, v147, v146 row_ror:12 row_mask:0xf bank_mask:0xf
    v_cvt_pk_bf16_f32 v140, v52, v53
    v_cvt_pk_bf16_f32 v141, v54, v55
    v_add_f32_dpp v3, v144, v3 row_ror:8 row_mask:0xf bank_mask:0xf
    v_cvt_pk_bf16_f32 v142, v56, v57
    v_cvt_pk_bf16_f32 v143, v58, v59
    v_add_f32_dpp v15, v145, v3 row_ror:4 row_mask:0xf bank_mask:0x4
    v_mfma_f32_16x16x16_bf16 v[148:151], v[138:139], v[164:165], 0
    v_mfma_f32_16x16x16_bf16 v[148:151], v[140:141], v[166:167], v[148:151]
    v_mfma_f32_16x16x16_bf16 v[148:151], v[142:143], v[168:169], v[148:151]
    v_add_u32 v33, s63, v23
    v_add_u32 v34, s63, v24
    ds_read_b64 v[108:109], v33 offset:0
    ds_read_b64 v[110:111], v33 offset:1536
    ds_read_b64 v[112:113], v33 offset:128
    ds_read_b64 v[114:115], v33 offset:1664
    ds_read_b64 v[116:117], v33 offset:256
    ds_read_b64 v[118:119], v33 offset:1792
    ds_read_b64 v[120:121], v34 offset:0
    v_add_f32_dpp v4, v151, v150 row_ror:12 row_mask:0xf bank_mask:0xf
    ds_read_b64 v[122:123], v34 offset:1536
    ds_read_b64 v[124:125], v34 offset:128
    v_add_f32_dpp v4, v148, v4 row_ror:8 row_mask:0xf bank_mask:0xf
    ds_read_b64 v[126:127], v34 offset:1664
    ds_read_b64 v[128:129], v34 offset:256
    ds_read_b64 v[130:131], v34 offset:1792
    v_add_f32_dpp v16, v149, v4 row_ror:4 row_mask:0xf bank_mask:0x4
    s_waitcnt lgkmcnt(0)
    v_lshlrev_b32 v60, 16, v108
    v_and_b32 v61, s66, v108
    v_lshlrev_b32 v62, 16, v109
    v_and_b32 v63, s66, v109
    v_lshlrev_b32 v84, 16, v110
    v_and_b32 v85, s66, v110
    v_lshlrev_b32 v86, 16, v111
    v_and_b32 v87, s66, v111
    v_lshlrev_b32 v64, 16, v112
    v_and_b32 v65, s66, v112
    v_lshlrev_b32 v66, 16, v113
    v_and_b32 v67, s66, v113
    v_lshlrev_b32 v88, 16, v114
    v_and_b32 v89, s66, v114
    v_lshlrev_b32 v90, 16, v115
    v_and_b32 v91, s66, v115
    v_lshlrev_b32 v68, 16, v116
    v_and_b32 v69, s66, v116
    v_lshlrev_b32 v70, 16, v117
    v_and_b32 v71, s66, v117
    v_lshlrev_b32 v92, 16, v118
    v_and_b32 v93, s66, v118
    v_lshlrev_b32 v94, 16, v119
    v_and_b32 v95, s66, v119
    v_lshlrev_b32 v72, 16, v120
    v_and_b32 v73, s66, v120
    v_lshlrev_b32 v74, 16, v121
    v_and_b32 v75, s66, v121
    v_lshlrev_b32 v96, 16, v122
    v_and_b32 v97, s66, v122
    v_lshlrev_b32 v98, 16, v123
    v_and_b32 v99, s66, v123
    v_lshlrev_b32 v76, 16, v124
    v_and_b32 v77, s66, v124
    v_lshlrev_b32 v78, 16, v125
    v_and_b32 v79, s66, v125
    v_lshlrev_b32 v100, 16, v126
    v_and_b32 v101, s66, v126
    v_lshlrev_b32 v102, 16, v127
    v_and_b32 v103, s66, v127
    v_lshlrev_b32 v80, 16, v128
    v_and_b32 v81, s66, v128
    v_lshlrev_b32 v82, 16, v129
    v_and_b32 v83, s66, v129
    v_lshlrev_b32 v104, 16, v130
    v_and_b32 v105, s66, v130
    v_lshlrev_b32 v106, 16, v131
    v_and_b32 v107, s66, v131
    v_add_u32 v13, s62, v12
    s_add_u32 s62, s62, 24576
    s_cmp_eq_u32 s62, 73728
    s_cselect_b32 s62, 0, s62
    s_barrier
    ds_read_b128 v[36:39], v13 offset:0
    ds_read_b128 v[40:43], v13 offset:256
    ds_read_b128 v[44:47], v13 offset:512
    ds_read_b128 v[48:51], v13 offset:3072
    ds_read_b128 v[52:55], v13 offset:3328
    ds_read_b128 v[56:59], v13 offset:3584
    s_waitcnt lgkmcnt(3)
    v_cvt_f32_i32 v36, v36
    v_cvt_f32_i32 v37, v37
    v_cvt_f32_i32 v38, v38
    v_cvt_f32_i32 v39, v39
    v_cvt_f32_i32 v40, v40
    v_cvt_f32_i32 v41, v41
    v_cvt_f32_i32 v42, v42
    v_cvt_f32_i32 v43, v43
    v_cvt_f32_i32 v44, v44
    v_cvt_f32_i32 v45, v45
    v_cvt_f32_i32 v46, v46
    v_cvt_f32_i32 v47, v47
    v_sub_f32 v36, v36, v60
    v_sub_f32 v37, v37, v61
    v_sub_f32 v38, v38, v62
    v_sub_f32 v39, v39, v63
    v_sub_f32 v40, v40, v64
    v_sub_f32 v41, v41, v65
    v_sub_f32 v42, v42, v66
    v_sub_f32 v43, v43, v67
    v_sub_f32 v44, v44, v68
    v_sub_f32 v45, v45, v69
    v_sub_f32 v46, v46, v70
    v_sub_f32 v47, v47, v71
    v_cvt_pk_bf16_f32 v36, 0, v36
    v_cvt_pk_bf16_f32 v37, 0, v37
    v_cvt_pk_bf16_f32 v38, 0, v38
    v_cvt_pk_bf16_f32 v39, 0, v39
    v_cvt_pk_bf16_f32 v40, 0, v40
    v_cvt_pk_bf16_f32 v41, 0, v41
    v_cvt_pk_bf16_f32 v42, 0, v42
    v_cvt_pk_bf16_f32 v43, 0, v43
    v_cvt_pk_bf16_f32 v44, 0, v44
    v_cvt_pk_bf16_f32 v45, 0, v45
    v_cvt_pk_bf16_f32 v46, 0, v46
    v_cvt_pk_bf16_f32 v47, 0, v47
    v_mul_f32 v36, v36, v84
    v_mul_f32 v37, v37, v85
    v_mul_f32 v38, v38, v86
    v_mul_f32 v39, v39, v87
    v_mul_f32 v40, v40, v88
    v_mul_f32 v41, v41, v89
    v_mul_f32 v42, v42, v90
    v_mul_f32 v43, v43, v91
    v_mul_f32 v44, v44, v92
    v_mul_f32 v45, v45, v93
    v_mul_f32 v46, v46, v94
    v_mul_f32 v47, v47, v95
    v_cvt_pk_bf16_f32 v132, v36, v37
    v_cvt_pk_bf16_f32 v133, v38, v39
    v_cvt_pk_bf16_f32 v134, v40, v41
    v_cvt_pk_bf16_f32 v135, v42, v43
    v_cvt_pk_bf16_f32 v136, v44, v45
    v_cvt_pk_bf16_f32 v137, v46, v47
    v_mfma_f32_16x16x16_bf16 v[144:147], v[132:133], v[164:165], 0
    v_mfma_f32_16x16x16_bf16 v[144:147], v[134:135], v[166:167], v[144:147]
    v_mfma_f32_16x16x16_bf16 v[144:147], v[136:137], v[168:169], v[144:147]
    s_waitcnt lgkmcnt(0)
    v_cvt_f32_i32 v48, v48
    v_cvt_f32_i32 v49, v49
    v_cvt_f32_i32 v50, v50
    v_cvt_f32_i32 v51, v51
    v_cvt_f32_i32 v52, v52
    v_cvt_f32_i32 v53, v53
    v_cvt_f32_i32 v54, v54
    v_cvt_f32_i32 v55, v55
    v_cvt_f32_i32 v56, v56
    v_cvt_f32_i32 v57, v57
    v_cvt_f32_i32 v58, v58
    v_cvt_f32_i32 v59, v59
    v_sub_f32 v48, v48, v72
    v_sub_f32 v49, v49, v73
    v_sub_f32 v50, v50, v74
    v_sub_f32 v51, v51, v75
    v_sub_f32 v52, v52, v76
    v_sub_f32 v53, v53, v77
    v_sub_f32 v54, v54, v78
    v_sub_f32 v55, v55, v79
    v_sub_f32 v56, v56, v80
    v_sub_f32 v57, v57, v81
    v_sub_f32 v58, v58, v82
    v_sub_f32 v59, v59, v83
    v_cvt_pk_bf16_f32 v48, 0, v48
    v_cvt_pk_bf16_f32 v49, 0, v49
    v_cvt_pk_bf16_f32 v50, 0, v50
    v_cvt_pk_bf16_f32 v51, 0, v51
    v_cvt_pk_bf16_f32 v52, 0, v52
    v_cvt_pk_bf16_f32 v53, 0, v53
    v_cvt_pk_bf16_f32 v54, 0, v54
    v_cvt_pk_bf16_f32 v55, 0, v55
    v_cvt_pk_bf16_f32 v56, 0, v56
    v_cvt_pk_bf16_f32 v57, 0, v57
    v_cvt_pk_bf16_f32 v58, 0, v58
    v_cvt_pk_bf16_f32 v59, 0, v59
    v_mul_f32 v48, v48, v96
    v_mul_f32 v49, v49, v97
    v_mul_f32 v50, v50, v98
    v_mul_f32 v51, v51, v99
    v_mul_f32 v52, v52, v100
    v_mul_f32 v53, v53, v101
    v_mul_f32 v54, v54, v102
    v_mul_f32 v55, v55, v103
    v_mul_f32 v56, v56, v104
    v_mul_f32 v57, v57, v105
    v_mul_f32 v58, v58, v106
    v_mul_f32 v59, v59, v107
    v_cvt_pk_bf16_f32 v138, v48, v49
    v_cvt_pk_bf16_f32 v139, v50, v51
    v_add_f32_dpp v3, v144, v147 row_ror:12 row_mask:0xf bank_mask:0xf
    v_cvt_pk_bf16_f32 v140, v52, v53
    v_cvt_pk_bf16_f32 v141, v54, v55
    v_add_f32_dpp v3, v145, v3 row_ror:8 row_mask:0xf bank_mask:0xf
    v_cvt_pk_bf16_f32 v142, v56, v57
    v_cvt_pk_bf16_f32 v143, v58, v59
    v_add_f32_dpp v15, v146, v3 row_ror:4 row_mask:0xf bank_mask:0x8
    v_mfma_f32_16x16x16_bf16 v[148:151], v[138:139], v[164:165], 0
    v_mfma_f32_16x16x16_bf16 v[148:151], v[140:141], v[166:167], v[148:151]
    v_mfma_f32_16x16x16_bf16 v[148:151], v[142:143], v[168:169], v[148:151]
    v_add_u32 v33, s63, v25
    v_add_u32 v34, s63, v26
    ds_read_b64 v[108:109], v33 offset:0
    ds_read_b64 v[110:111], v33 offset:1536
    ds_read_b64 v[112:113], v33 offset:128
    ds_read_b64 v[114:115], v33 offset:1664
    ds_read_b64 v[116:117], v33 offset:256
    ds_read_b64 v[118:119], v33 offset:1792
    ds_read_b64 v[120:121], v34 offset:0
    v_add_f32_dpp v4, v148, v151 row_ror:12 row_mask:0xf bank_mask:0xf
    ds_read_b64 v[122:123], v34 offset:1536
    ds_read_b64 v[124:125], v34 offset:128
    v_add_f32_dpp v4, v149, v4 row_ror:8 row_mask:0xf bank_mask:0xf
    ds_read_b64 v[126:127], v34 offset:1664
    ds_read_b64 v[128:129], v34 offset:256
    ds_read_b64 v[130:131], v34 offset:1792
    v_add_f32_dpp v16, v150, v4 row_ror:4 row_mask:0xf bank_mask:0x8
    v_cvt_pk_bf16_f32 v3, 0, v15
    v_cvt_pk_bf16_f32 v4, 0, v16
    v_mul_f32 v3, s65, v3
    v_mul_f32 v4, s65, v4
    v_cvt_pk_bf16_f32 v5, v3, v4
    v_max3_f32 v14, v14, v3, v4
    ds_write_b32 v11, v5 offset:0
    s_waitcnt lgkmcnt(0)
    v_lshlrev_b32 v60, 16, v108
    v_and_b32 v61, s66, v108
    v_lshlrev_b32 v62, 16, v109
    v_and_b32 v63, s66, v109
    v_lshlrev_b32 v84, 16, v110
    v_and_b32 v85, s66, v110
    v_lshlrev_b32 v86, 16, v111
    v_and_b32 v87, s66, v111
    v_lshlrev_b32 v64, 16, v112
    v_and_b32 v65, s66, v112
    v_lshlrev_b32 v66, 16, v113
    v_and_b32 v67, s66, v113
    v_lshlrev_b32 v88, 16, v114
    v_and_b32 v89, s66, v114
    v_lshlrev_b32 v90, 16, v115
    v_and_b32 v91, s66, v115
    v_lshlrev_b32 v68, 16, v116
    v_and_b32 v69, s66, v116
    v_lshlrev_b32 v70, 16, v117
    v_and_b32 v71, s66, v117
    v_lshlrev_b32 v92, 16, v118
    v_and_b32 v93, s66, v118
    v_lshlrev_b32 v94, 16, v119
    v_and_b32 v95, s66, v119
    v_lshlrev_b32 v72, 16, v120
    v_and_b32 v73, s66, v120
    v_lshlrev_b32 v74, 16, v121
    v_and_b32 v75, s66, v121
    v_lshlrev_b32 v96, 16, v122
    v_and_b32 v97, s66, v122
    v_lshlrev_b32 v98, 16, v123
    v_and_b32 v99, s66, v123
    v_lshlrev_b32 v76, 16, v124
    v_and_b32 v77, s66, v124
    v_lshlrev_b32 v78, 16, v125
    v_and_b32 v79, s66, v125
    v_lshlrev_b32 v100, 16, v126
    v_and_b32 v101, s66, v126
    v_lshlrev_b32 v102, 16, v127
    v_and_b32 v103, s66, v127
    v_lshlrev_b32 v80, 16, v128
    v_and_b32 v81, s66, v128
    v_lshlrev_b32 v82, 16, v129
    v_and_b32 v83, s66, v129
    v_lshlrev_b32 v104, 16, v130
    v_and_b32 v105, s66, v130
    v_lshlrev_b32 v106, 16, v131
    v_and_b32 v107, s66, v131
    v_add_u32 v13, s62, v12
    s_add_u32 s62, s62, 24576
    s_cmp_eq_u32 s62, 73728
    s_cselect_b32 s62, 0, s62
    s_barrier
    ds_read_b128 v[36:39], v13 offset:0
    ds_read_b128 v[40:43], v13 offset:256
    ds_read_b128 v[44:47], v13 offset:512
    ds_read_b128 v[48:51], v13 offset:3072
    ds_read_b128 v[52:55], v13 offset:3328
    ds_read_b128 v[56:59], v13 offset:3584
    s_waitcnt lgkmcnt(3)
    v_cvt_f32_i32 v36, v36
    v_cvt_f32_i32 v37, v37
    v_cvt_f32_i32 v38, v38
    v_cvt_f32_i32 v39, v39
    v_cvt_f32_i32 v40, v40
    v_cvt_f32_i32 v41, v41
    v_cvt_f32_i32 v42, v42
    v_cvt_f32_i32 v43, v43
    v_cvt_f32_i32 v44, v44
    v_cvt_f32_i32 v45, v45
    v_cvt_f32_i32 v46, v46
    v_cvt_f32_i32 v47, v47
    v_sub_f32 v36, v36, v60
    v_sub_f32 v37, v37, v61
    v_sub_f32 v38, v38, v62
    v_sub_f32 v39, v39, v63
    v_sub_f32 v40, v40, v64
    v_sub_f32 v41, v41, v65
    v_sub_f32 v42, v42, v66
    v_sub_f32 v43, v43, v67
    v_sub_f32 v44, v44, v68
    v_sub_f32 v45, v45, v69
    v_sub_f32 v46, v46, v70
    v_sub_f32 v47, v47, v71
    v_cvt_pk_bf16_f32 v36, 0, v36
    v_cvt_pk_bf16_f32 v37, 0, v37
    v_cvt_pk_bf16_f32 v38, 0, v38
    v_cvt_pk_bf16_f32 v39, 0, v39
    v_cvt_pk_bf16_f32 v40, 0, v40
    v_cvt_pk_bf16_f32 v41, 0, v41
    v_cvt_pk_bf16_f32 v42, 0, v42
    v_cvt_pk_bf16_f32 v43, 0, v43
    v_cvt_pk_bf16_f32 v44, 0, v44
    v_cvt_pk_bf16_f32 v45, 0, v45
    v_cvt_pk_bf16_f32 v46, 0, v46
    v_cvt_pk_bf16_f32 v47, 0, v47
    v_mul_f32 v36, v36, v84
    v_mul_f32 v37, v37, v85
    v_mul_f32 v38, v38, v86
    v_mul_f32 v39, v39, v87
    v_mul_f32 v40, v40, v88
    v_mul_f32 v41, v41, v89
    v_mul_f32 v42, v42, v90
    v_mul_f32 v43, v43, v91
    v_mul_f32 v44, v44, v92
    v_mul_f32 v45, v45, v93
    v_mul_f32 v46, v46, v94
    v_mul_f32 v47, v47, v95
    v_cvt_pk_bf16_f32 v132, v36, v37
    v_cvt_pk_bf16_f32 v133, v38, v39
    v_cvt_pk_bf16_f32 v134, v40, v41
    v_cvt_pk_bf16_f32 v135, v42, v43
    v_cvt_pk_bf16_f32 v136, v44, v45
    v_cvt_pk_bf16_f32 v137, v46, v47
    v_mfma_f32_16x16x16_bf16 v[144:147], v[132:133], v[164:165], 0
    v_mfma_f32_16x16x16_bf16 v[144:147], v[134:135], v[166:167], v[144:147]
    v_mfma_f32_16x16x16_bf16 v[144:147], v[136:137], v[168:169], v[144:147]
    s_waitcnt lgkmcnt(0)
    v_cvt_f32_i32 v48, v48
    v_cvt_f32_i32 v49, v49
    v_cvt_f32_i32 v50, v50
    v_cvt_f32_i32 v51, v51
    v_cvt_f32_i32 v52, v52
    v_cvt_f32_i32 v53, v53
    v_cvt_f32_i32 v54, v54
    v_cvt_f32_i32 v55, v55
    v_cvt_f32_i32 v56, v56
    v_cvt_f32_i32 v57, v57
    v_cvt_f32_i32 v58, v58
    v_cvt_f32_i32 v59, v59
    v_sub_f32 v48, v48, v72
    v_sub_f32 v49, v49, v73
    v_sub_f32 v50, v50, v74
    v_sub_f32 v51, v51, v75
    v_sub_f32 v52, v52, v76
    v_sub_f32 v53, v53, v77
    v_sub_f32 v54, v54, v78
    v_sub_f32 v55, v55, v79
    v_sub_f32 v56, v56, v80
    v_sub_f32 v57, v57, v81
    v_sub_f32 v58, v58, v82
    v_sub_f32 v59, v59, v83
    v_cvt_pk_bf16_f32 v48, 0, v48
    v_cvt_pk_bf16_f32 v49, 0, v49
    v_cvt_pk_bf16_f32 v50, 0, v50
    v_cvt_pk_bf16_f32 v51, 0, v51
    v_cvt_pk_bf16_f32 v52, 0, v52
    v_cvt_pk_bf16_f32 v53, 0, v53
    v_cvt_pk_bf16_f32 v54, 0, v54
    v_cvt_pk_bf16_f32 v55, 0, v55
    v_cvt_pk_bf16_f32 v56, 0, v56
    v_cvt_pk_bf16_f32 v57, 0, v57
    v_cvt_pk_bf16_f32 v58, 0, v58
    v_cvt_pk_bf16_f32 v59, 0, v59
    v_mul_f32 v48, v48, v96
    v_mul_f32 v49, v49, v97
    v_mul_f32 v50, v50, v98
    v_mul_f32 v51, v51, v99
    v_mul_f32 v52, v52, v100
    v_mul_f32 v53, v53, v101
    v_mul_f32 v54, v54, v102
    v_mul_f32 v55, v55, v103
    v_mul_f32 v56, v56, v104
    v_mul_f32 v57, v57, v105
    v_mul_f32 v58, v58, v106
    v_mul_f32 v59, v59, v107
    v_cvt_pk_bf16_f32 v138, v48, v49
    v_cvt_pk_bf16_f32 v139, v50, v51
    v_add_f32_dpp v3, v145, v144 row_ror:12 row_mask:0xf bank_mask:0xf
    v_cvt_pk_bf16_f32 v140, v52, v53
    v_cvt_pk_bf16_f32 v141, v54, v55
    v_add_f32_dpp v3, v146, v3 row_ror:8 row_mask:0xf bank_mask:0xf
    v_cvt_pk_bf16_f32 v142, v56, v57
    v_cvt_pk_bf16_f32 v143, v58, v59
    v_add_f32_dpp v15, v147, v3 row_ror:4 row_mask:0xf bank_mask:0x1
    v_mfma_f32_16x16x16_bf16 v[148:151], v[138:139], v[164:165], 0
    v_mfma_f32_16x16x16_bf16 v[148:151], v[140:141], v[166:167], v[148:151]
    v_mfma_f32_16x16x16_bf16 v[148:151], v[142:143], v[168:169], v[148:151]
    v_add_u32 v33, s63, v27
    v_add_u32 v34, s63, v28
    ds_read_b64 v[108:109], v33 offset:0
    ds_read_b64 v[110:111], v33 offset:1536
    ds_read_b64 v[112:113], v33 offset:128
    ds_read_b64 v[114:115], v33 offset:1664
    ds_read_b64 v[116:117], v33 offset:256
    ds_read_b64 v[118:119], v33 offset:1792
    ds_read_b64 v[120:121], v34 offset:0
    v_add_f32_dpp v4, v149, v148 row_ror:12 row_mask:0xf bank_mask:0xf
    ds_read_b64 v[122:123], v34 offset:1536
    ds_read_b64 v[124:125], v34 offset:128
    v_add_f32_dpp v4, v150, v4 row_ror:8 row_mask:0xf bank_mask:0xf
    ds_read_b64 v[126:127], v34 offset:1664
    ds_read_b64 v[128:129], v34 offset:256
    ds_read_b64 v[130:131], v34 offset:1792
    v_add_f32_dpp v16, v151, v4 row_ror:4 row_mask:0xf bank_mask:0x1
    s_waitcnt lgkmcnt(0)
    v_lshlrev_b32 v60, 16, v108
    v_and_b32 v61, s66, v108
    v_lshlrev_b32 v62, 16, v109
    v_and_b32 v63, s66, v109
    v_lshlrev_b32 v84, 16, v110
    v_and_b32 v85, s66, v110
    v_lshlrev_b32 v86, 16, v111
    v_and_b32 v87, s66, v111
    v_lshlrev_b32 v64, 16, v112
    v_and_b32 v65, s66, v112
    v_lshlrev_b32 v66, 16, v113
    v_and_b32 v67, s66, v113
    v_lshlrev_b32 v88, 16, v114
    v_and_b32 v89, s66, v114
    v_lshlrev_b32 v90, 16, v115
    v_and_b32 v91, s66, v115
    v_lshlrev_b32 v68, 16, v116
    v_and_b32 v69, s66, v116
    v_lshlrev_b32 v70, 16, v117
    v_and_b32 v71, s66, v117
    v_lshlrev_b32 v92, 16, v118
    v_and_b32 v93, s66, v118
    v_lshlrev_b32 v94, 16, v119
    v_and_b32 v95, s66, v119
    v_lshlrev_b32 v72, 16, v120
    v_and_b32 v73, s66, v120
    v_lshlrev_b32 v74, 16, v121
    v_and_b32 v75, s66, v121
    v_lshlrev_b32 v96, 16, v122
    v_and_b32 v97, s66, v122
    v_lshlrev_b32 v98, 16, v123
    v_and_b32 v99, s66, v123
    v_lshlrev_b32 v76, 16, v124
    v_and_b32 v77, s66, v124
    v_lshlrev_b32 v78, 16, v125
    v_and_b32 v79, s66, v125
    v_lshlrev_b32 v100, 16, v126
    v_and_b32 v101, s66, v126
    v_lshlrev_b32 v102, 16, v127
    v_and_b32 v103, s66, v127
    v_lshlrev_b32 v80, 16, v128
    v_and_b32 v81, s66, v128
    v_lshlrev_b32 v82, 16, v129
    v_and_b32 v83, s66, v129
    v_lshlrev_b32 v104, 16, v130
    v_and_b32 v105, s66, v130
    v_lshlrev_b32 v106, 16, v131
    v_and_b32 v107, s66, v131
    v_add_u32 v13, s62, v12
    s_add_u32 s62, s62, 24576
    s_cmp_eq_u32 s62, 73728
    s_cselect_b32 s62, 0, s62
    s_barrier
    ds_read_b128 v[36:39], v13 offset:0
    ds_read_b128 v[40:43], v13 offset:256
    ds_read_b128 v[44:47], v13 offset:512
    ds_read_b128 v[48:51], v13 offset:3072
    ds_read_b128 v[52:55], v13 offset:3328
    ds_read_b128 v[56:59], v13 offset:3584
    s_waitcnt lgkmcnt(3)
    v_cvt_f32_i32 v36, v36
    v_cvt_f32_i32 v37, v37
    v_cvt_f32_i32 v38, v38
    v_cvt_f32_i32 v39, v39
    v_cvt_f32_i32 v40, v40
    v_cvt_f32_i32 v41, v41
    v_cvt_f32_i32 v42, v42
    v_cvt_f32_i32 v43, v43
    v_cvt_f32_i32 v44, v44
    v_cvt_f32_i32 v45, v45
    v_cvt_f32_i32 v46, v46
    v_cvt_f32_i32 v47, v47
    v_sub_f32 v36, v36, v60
    v_sub_f32 v37, v37, v61
    v_sub_f32 v38, v38, v62
    v_sub_f32 v39, v39, v63
    v_sub_f32 v40, v40, v64
    v_sub_f32 v41, v41, v65
    v_sub_f32 v42, v42, v66
    v_sub_f32 v43, v43, v67
    v_sub_f32 v44, v44, v68
    v_sub_f32 v45, v45, v69
    v_sub_f32 v46, v46, v70
    v_sub_f32 v47, v47, v71
    v_cvt_pk_bf16_f32 v36, 0, v36
    v_cvt_pk_bf16_f32 v37, 0, v37
    v_cvt_pk_bf16_f32 v38, 0, v38
    v_cvt_pk_bf16_f32 v39, 0, v39
    v_cvt_pk_bf16_f32 v40, 0, v40
    v_cvt_pk_bf16_f32 v41, 0, v41
    v_cvt_pk_bf16_f32 v42, 0, v42
    v_cvt_pk_bf16_f32 v43, 0, v43
    v_cvt_pk_bf16_f32 v44, 0, v44
    v_cvt_pk_bf16_f32 v45, 0, v45
    v_cvt_pk_bf16_f32 v46, 0, v46
    v_cvt_pk_bf16_f32 v47, 0, v47
    v_mul_f32 v36, v36, v84
    v_mul_f32 v37, v37, v85
    v_mul_f32 v38, v38, v86
    v_mul_f32 v39, v39, v87
    v_mul_f32 v40, v40, v88
    v_mul_f32 v41, v41, v89
    v_mul_f32 v42, v42, v90
    v_mul_f32 v43, v43, v91
    v_mul_f32 v44, v44, v92
    v_mul_f32 v45, v45, v93
    v_mul_f32 v46, v46, v94
    v_mul_f32 v47, v47, v95
    v_cvt_pk_bf16_f32 v132, v36, v37
    v_cvt_pk_bf16_f32 v133, v38, v39
    v_cvt_pk_bf16_f32 v134, v40, v41
    v_cvt_pk_bf16_f32 v135, v42, v43
    v_cvt_pk_bf16_f32 v136, v44, v45
    v_cvt_pk_bf16_f32 v137, v46, v47
    v_mfma_f32_16x16x16_bf16 v[144:147], v[132:133], v[164:165], 0
    v_mfma_f32_16x16x16_bf16 v[144:147], v[134:135], v[166:167], v[144:147]
    v_mfma_f32_16x16x16_bf16 v[144:147], v[136:137], v[168:169], v[144:147]
    s_waitcnt lgkmcnt(0)
    v_cvt_f32_i32 v48, v48
    v_cvt_f32_i32 v49, v49
    v_cvt_f32_i32 v50, v50
    v_cvt_f32_i32 v51, v51
    v_cvt_f32_i32 v52, v52
    v_cvt_f32_i32 v53, v53
    v_cvt_f32_i32 v54, v54
    v_cvt_f32_i32 v55, v55
    v_cvt_f32_i32 v56, v56
    v_cvt_f32_i32 v57, v57
    v_cvt_f32_i32 v58, v58
    v_cvt_f32_i32 v59, v59
    v_sub_f32 v48, v48, v72
    v_sub_f32 v49, v49, v73
    v_sub_f32 v50, v50, v74
    v_sub_f32 v51, v51, v75
    v_sub_f32 v52, v52, v76
    v_sub_f32 v53, v53, v77
    v_sub_f32 v54, v54, v78
    v_sub_f32 v55, v55, v79
    v_sub_f32 v56, v56, v80
    v_sub_f32 v57, v57, v81
    v_sub_f32 v58, v58, v82
    v_sub_f32 v59, v59, v83
    v_cvt_pk_bf16_f32 v48, 0, v48
    v_cvt_pk_bf16_f32 v49, 0, v49
    v_cvt_pk_bf16_f32 v50, 0, v50
    v_cvt_pk_bf16_f32 v51, 0, v51
    v_cvt_pk_bf16_f32 v52, 0, v52
    v_cvt_pk_bf16_f32 v53, 0, v53
    v_cvt_pk_bf16_f32 v54, 0, v54
    v_cvt_pk_bf16_f32 v55, 0, v55
    v_cvt_pk_bf16_f32 v56, 0, v56
    v_cvt_pk_bf16_f32 v57, 0, v57
    v_cvt_pk_bf16_f32 v58, 0, v58
    v_cvt_pk_bf16_f32 v59, 0, v59
    v_mul_f32 v48, v48, v96
    v_mul_f32 v49, v49, v97
    v_mul_f32 v50, v50, v98
    v_mul_f32 v51, v51, v99
    v_mul_f32 v52, v52, v100
    v_mul_f32 v53, v53, v101
    v_mul_f32 v54, v54, v102
    v_mul_f32 v55, v55, v103
    v_mul_f32 v56, v56, v104
    v_mul_f32 v57, v57, v105
    v_mul_f32 v58, v58, v106
    v_mul_f32 v59, v59, v107
    v_cvt_pk_bf16_f32 v138, v48, v49
    v_cvt_pk_bf16_f32 v139, v50, v51
    v_add_f32_dpp v3, v146, v145 row_ror:12 row_mask:0xf bank_mask:0xf
    v_cvt_pk_bf16_f32 v140, v52, v53
    v_cvt_pk_bf16_f32 v141, v54, v55
    v_add_f32_dpp v3, v147, v3 row_ror:8 row_mask:0xf bank_mask:0xf
    v_cvt_pk_bf16_f32 v142, v56, v57
    v_cvt_pk_bf16_f32 v143, v58, v59
    v_add_f32_dpp v15, v144, v3 row_ror:4 row_mask:0xf bank_mask:0x2
    v_mfma_f32_16x16x16_bf16 v[148:151], v[138:139], v[164:165], 0
    v_mfma_f32_16x16x16_bf16 v[148:151], v[140:141], v[166:167], v[148:151]
    v_mfma_f32_16x16x16_bf16 v[148:151], v[142:143], v[168:169], v[148:151]
    v_add_u32 v33, s63, v29
    v_add_u32 v34, s63, v30
    ds_read_b64 v[108:109], v33 offset:0
    ds_read_b64 v[110:111], v33 offset:1536
    ds_read_b64 v[112:113], v33 offset:128
    ds_read_b64 v[114:115], v33 offset:1664
    ds_read_b64 v[116:117], v33 offset:256
    ds_read_b64 v[118:119], v33 offset:1792
    ds_read_b64 v[120:121], v34 offset:0
    v_add_f32_dpp v4, v150, v149 row_ror:12 row_mask:0xf bank_mask:0xf
    ds_read_b64 v[122:123], v34 offset:1536
    ds_read_b64 v[124:125], v34 offset:128
    v_add_f32_dpp v4, v151, v4 row_ror:8 row_mask:0xf bank_mask:0xf
    ds_read_b64 v[126:127], v34 offset:1664
    ds_read_b64 v[128:129], v34 offset:256
    ds_read_b64 v[130:131], v34 offset:1792
    v_add_f32_dpp v16, v148, v4 row_ror:4 row_mask:0xf bank_mask:0x2
    s_waitcnt lgkmcnt(0)
    v_lshlrev_b32 v60, 16, v108
    v_and_b32 v61, s66, v108
    v_lshlrev_b32 v62, 16, v109
    v_and_b32 v63, s66, v109
    v_lshlrev_b32 v84, 16, v110
    v_and_b32 v85, s66, v110
    v_lshlrev_b32 v86, 16, v111
    v_and_b32 v87, s66, v111
    v_lshlrev_b32 v64, 16, v112
    v_and_b32 v65, s66, v112
    v_lshlrev_b32 v66, 16, v113
    v_and_b32 v67, s66, v113
    v_lshlrev_b32 v88, 16, v114
    v_and_b32 v89, s66, v114
    v_lshlrev_b32 v90, 16, v115
    v_and_b32 v91, s66, v115
    v_lshlrev_b32 v68, 16, v116
    v_and_b32 v69, s66, v116
    v_lshlrev_b32 v70, 16, v117
    v_and_b32 v71, s66, v117
    v_lshlrev_b32 v92, 16, v118
    v_and_b32 v93, s66, v118
    v_lshlrev_b32 v94, 16, v119
    v_and_b32 v95, s66, v119
    v_lshlrev_b32 v72, 16, v120
    v_and_b32 v73, s66, v120
    v_lshlrev_b32 v74, 16, v121
    v_and_b32 v75, s66, v121
    v_lshlrev_b32 v96, 16, v122
    v_and_b32 v97, s66, v122
    v_lshlrev_b32 v98, 16, v123
    v_and_b32 v99, s66, v123
    v_lshlrev_b32 v76, 16, v124
    v_and_b32 v77, s66, v124
    v_lshlrev_b32 v78, 16, v125
    v_and_b32 v79, s66, v125
    v_lshlrev_b32 v100, 16, v126
    v_and_b32 v101, s66, v126
    v_lshlrev_b32 v102, 16, v127
    v_and_b32 v103, s66, v127
    v_lshlrev_b32 v80, 16, v128
    v_and_b32 v81, s66, v128
    v_lshlrev_b32 v82, 16, v129
    v_and_b32 v83, s66, v129
    v_lshlrev_b32 v104, 16, v130
    v_and_b32 v105, s66, v130
    v_lshlrev_b32 v106, 16, v131
    v_and_b32 v107, s66, v131
    v_add_u32 v13, s62, v12
    s_add_u32 s62, s62, 24576
    s_cmp_eq_u32 s62, 73728
    s_cselect_b32 s62, 0, s62
    s_barrier
    ds_read_b128 v[36:39], v13 offset:0
    ds_read_b128 v[40:43], v13 offset:256
    ds_read_b128 v[44:47], v13 offset:512
    ds_read_b128 v[48:51], v13 offset:3072
    ds_read_b128 v[52:55], v13 offset:3328
    ds_read_b128 v[56:59], v13 offset:3584
    s_waitcnt lgkmcnt(3)
    v_cvt_f32_i32 v36, v36
    v_cvt_f32_i32 v37, v37
    v_cvt_f32_i32 v38, v38
    v_cvt_f32_i32 v39, v39
    v_cvt_f32_i32 v40, v40
    v_cvt_f32_i32 v41, v41
    v_cvt_f32_i32 v42, v42
    v_cvt_f32_i32 v43, v43
    v_cvt_f32_i32 v44, v44
    v_cvt_f32_i32 v45, v45
    v_cvt_f32_i32 v46, v46
    v_cvt_f32_i32 v47, v47
    v_sub_f32 v36, v36, v60
    v_sub_f32 v37, v37, v61
    v_sub_f32 v38, v38, v62
    v_sub_f32 v39, v39, v63
    v_sub_f32 v40, v40, v64
    v_sub_f32 v41, v41, v65
    v_sub_f32 v42, v42, v66
    v_sub_f32 v43, v43, v67
    v_sub_f32 v44, v44, v68
    v_sub_f32 v45, v45, v69
    v_sub_f32 v46, v46, v70
    v_sub_f32 v47, v47, v71
    v_cvt_pk_bf16_f32 v36, 0, v36
    v_cvt_pk_bf16_f32 v37, 0, v37
    v_cvt_pk_bf16_f32 v38, 0, v38
    v_cvt_pk_bf16_f32 v39, 0, v39
    v_cvt_pk_bf16_f32 v40, 0, v40
    v_cvt_pk_bf16_f32 v41, 0, v41
    v_cvt_pk_bf16_f32 v42, 0, v42
    v_cvt_pk_bf16_f32 v43, 0, v43
    v_cvt_pk_bf16_f32 v44, 0, v44
    v_cvt_pk_bf16_f32 v45, 0, v45
    v_cvt_pk_bf16_f32 v46, 0, v46
    v_cvt_pk_bf16_f32 v47, 0, v47
    v_mul_f32 v36, v36, v84
    v_mul_f32 v37, v37, v85
    v_mul_f32 v38, v38, v86
    v_mul_f32 v39, v39, v87
    v_mul_f32 v40, v40, v88
    v_mul_f32 v41, v41, v89
    v_mul_f32 v42, v42, v90
    v_mul_f32 v43, v43, v91
    v_mul_f32 v44, v44, v92
    v_mul_f32 v45, v45, v93
    v_mul_f32 v46, v46, v94
    v_mul_f32 v47, v47, v95
    v_cvt_pk_bf16_f32 v132, v36, v37
    v_cvt_pk_bf16_f32 v133, v38, v39
    v_cvt_pk_bf16_f32 v134, v40, v41
    v_cvt_pk_bf16_f32 v135, v42, v43
    v_cvt_pk_bf16_f32 v136, v44, v45
    v_cvt_pk_bf16_f32 v137, v46, v47
    v_mfma_f32_16x16x16_bf16 v[144:147], v[132:133], v[164:165], 0
    v_mfma_f32_16x16x16_bf16 v[144:147], v[134:135], v[166:167], v[144:147]
    v_mfma_f32_16x16x16_bf16 v[144:147], v[136:137], v[168:169], v[144:147]
    s_waitcnt lgkmcnt(0)
    v_cvt_f32_i32 v48, v48
    v_cvt_f32_i32 v49, v49
    v_cvt_f32_i32 v50, v50
    v_cvt_f32_i32 v51, v51
    v_cvt_f32_i32 v52, v52
    v_cvt_f32_i32 v53, v53
    v_cvt_f32_i32 v54, v54
    v_cvt_f32_i32 v55, v55
    v_cvt_f32_i32 v56, v56
    v_cvt_f32_i32 v57, v57
    v_cvt_f32_i32 v58, v58
    v_cvt_f32_i32 v59, v59
    v_sub_f32 v48, v48, v72
    v_sub_f32 v49, v49, v73
    v_sub_f32 v50, v50, v74
    v_sub_f32 v51, v51, v75
    v_sub_f32 v52, v52, v76
    v_sub_f32 v53, v53, v77
    v_sub_f32 v54, v54, v78
    v_sub_f32 v55, v55, v79
    v_sub_f32 v56, v56, v80
    v_sub_f32 v57, v57, v81
    v_sub_f32 v58, v58, v82
    v_sub_f32 v59, v59, v83
    v_cvt_pk_bf16_f32 v48, 0, v48
    v_cvt_pk_bf16_f32 v49, 0, v49
    v_cvt_pk_bf16_f32 v50, 0, v50
    v_cvt_pk_bf16_f32 v51, 0, v51
    v_cvt_pk_bf16_f32 v52, 0, v52
    v_cvt_pk_bf16_f32 v53, 0, v53
    v_cvt_pk_bf16_f32 v54, 0, v54
    v_cvt_pk_bf16_f32 v55, 0, v55
    v_cvt_pk_bf16_f32 v56, 0, v56
    v_cvt_pk_bf16_f32 v57, 0, v57
    v_cvt_pk_bf16_f32 v58, 0, v58
    v_cvt_pk_bf16_f32 v59, 0, v59
    v_mul_f32 v48, v48, v96
    v_mul_f32 v49, v49, v97
    v_mul_f32 v50, v50, v98
    v_mul_f32 v51, v51, v99
    v_mul_f32 v52, v52, v100
    v_mul_f32 v53, v53, v101
    v_mul_f32 v54, v54, v102
    v_mul_f32 v55, v55, v103
    v_mul_f32 v56, v56, v104
    v_mul_f32 v57, v57, v105
    v_mul_f32 v58, v58, v106
    v_mul_f32 v59, v59, v107
    v_cvt_pk_bf16_f32 v138, v48, v49
    v_cvt_pk_bf16_f32 v139, v50, v51
    v_add_f32_dpp v3, v147, v146 row_ror:12 row_mask:0xf bank_mask:0xf
    v_cvt_pk_bf16_f32 v140, v52, v53
    v_cvt_pk_bf16_f32 v141, v54, v55
    v_add_f32_dpp v3, v144, v3 row_ror:8 row_mask:0xf bank_mask:0xf
    v_cvt_pk_bf16_f32 v142, v56, v57
    v_cvt_pk_bf16_f32 v143, v58, v59
    v_add_f32_dpp v15, v145, v3 row_ror:4 row_mask:0xf bank_mask:0x4
    v_mfma_f32_16x16x16_bf16 v[148:151], v[138:139], v[164:165], 0
    v_mfma_f32_16x16x16_bf16 v[148:151], v[140:141], v[166:167], v[148:151]
    v_mfma_f32_16x16x16_bf16 v[148:151], v[142:143], v[168:169], v[148:151]
    v_add_u32 v33, s63, v31
    v_add_u32 v34, s63, v32
    ds_read_b64 v[108:109], v33 offset:0
    ds_read_b64 v[110:111], v33 offset:1536
    ds_read_b64 v[112:113], v33 offset:128
    ds_read_b64 v[114:115], v33 offset:1664
    ds_read_b64 v[116:117], v33 offset:256
    ds_read_b64 v[118:119], v33 offset:1792
    ds_read_b64 v[120:121], v34 offset:0
    v_add_f32_dpp v4, v151, v150 row_ror:12 row_mask:0xf bank_mask:0xf
    ds_read_b64 v[122:123], v34 offset:1536
    ds_read_b64 v[124:125], v34 offset:128
    v_add_f32_dpp v4, v148, v4 row_ror:8 row_mask:0xf bank_mask:0xf
    ds_read_b64 v[126:127], v34 offset:1664
    ds_read_b64 v[128:129], v34 offset:256
    ds_read_b64 v[130:131], v34 offset:1792
    v_add_f32_dpp v16, v149, v4 row_ror:4 row_mask:0xf bank_mask:0x4
    s_waitcnt lgkmcnt(0)
    v_lshlrev_b32 v60, 16, v108
    v_and_b32 v61, s66, v108
    v_lshlrev_b32 v62, 16, v109
    v_and_b32 v63, s66, v109
    v_lshlrev_b32 v84, 16, v110
    v_and_b32 v85, s66, v110
    v_lshlrev_b32 v86, 16, v111
    v_and_b32 v87, s66, v111
    v_lshlrev_b32 v64, 16, v112
    v_and_b32 v65, s66, v112
    v_lshlrev_b32 v66, 16, v113
    v_and_b32 v67, s66, v113
    v_lshlrev_b32 v88, 16, v114
    v_and_b32 v89, s66, v114
    v_lshlrev_b32 v90, 16, v115
    v_and_b32 v91, s66, v115
    v_lshlrev_b32 v68, 16, v116
    v_and_b32 v69, s66, v116
    v_lshlrev_b32 v70, 16, v117
    v_and_b32 v71, s66, v117
    v_lshlrev_b32 v92, 16, v118
    v_and_b32 v93, s66, v118
    v_lshlrev_b32 v94, 16, v119
    v_and_b32 v95, s66, v119
    v_lshlrev_b32 v72, 16, v120
    v_and_b32 v73, s66, v120
    v_lshlrev_b32 v74, 16, v121
    v_and_b32 v75, s66, v121
    v_lshlrev_b32 v96, 16, v122
    v_and_b32 v97, s66, v122
    v_lshlrev_b32 v98, 16, v123
    v_and_b32 v99, s66, v123
    v_lshlrev_b32 v76, 16, v124
    v_and_b32 v77, s66, v124
    v_lshlrev_b32 v78, 16, v125
    v_and_b32 v79, s66, v125
    v_lshlrev_b32 v100, 16, v126
    v_and_b32 v101, s66, v126
    v_lshlrev_b32 v102, 16, v127
    v_and_b32 v103, s66, v127
    v_lshlrev_b32 v80, 16, v128
    v_and_b32 v81, s66, v128
    v_lshlrev_b32 v82, 16, v129
    v_and_b32 v83, s66, v129
    v_lshlrev_b32 v104, 16, v130
    v_and_b32 v105, s66, v130
    v_lshlrev_b32 v106, 16, v131
    v_and_b32 v107, s66, v131
    v_add_u32 v13, s62, v12
    s_add_u32 s62, s62, 24576
    s_cmp_eq_u32 s62, 73728
    s_cselect_b32 s62, 0, s62
    s_barrier
    ds_read_b128 v[36:39], v13 offset:0
    ds_read_b128 v[40:43], v13 offset:256
    ds_read_b128 v[44:47], v13 offset:512
    ds_read_b128 v[48:51], v13 offset:3072
    ds_read_b128 v[52:55], v13 offset:3328
    ds_read_b128 v[56:59], v13 offset:3584
    s_waitcnt lgkmcnt(3)
    v_cvt_f32_i32 v36, v36
    v_cvt_f32_i32 v37, v37
    v_cvt_f32_i32 v38, v38
    v_cvt_f32_i32 v39, v39
    v_cvt_f32_i32 v40, v40
    v_cvt_f32_i32 v41, v41
    v_cvt_f32_i32 v42, v42
    v_cvt_f32_i32 v43, v43
    v_cvt_f32_i32 v44, v44
    v_cvt_f32_i32 v45, v45
    v_cvt_f32_i32 v46, v46
    v_cvt_f32_i32 v47, v47
    v_sub_f32 v36, v36, v60
    v_sub_f32 v37, v37, v61
    v_sub_f32 v38, v38, v62
    v_sub_f32 v39, v39, v63
    v_sub_f32 v40, v40, v64
    v_sub_f32 v41, v41, v65
    v_sub_f32 v42, v42, v66
    v_sub_f32 v43, v43, v67
    v_sub_f32 v44, v44, v68
    v_sub_f32 v45, v45, v69
    v_sub_f32 v46, v46, v70
    v_sub_f32 v47, v47, v71
    v_cvt_pk_bf16_f32 v36, 0, v36
    v_cvt_pk_bf16_f32 v37, 0, v37
    v_cvt_pk_bf16_f32 v38, 0, v38
    v_cvt_pk_bf16_f32 v39, 0, v39
    v_cvt_pk_bf16_f32 v40, 0, v40
    v_cvt_pk_bf16_f32 v41, 0, v41
    v_cvt_pk_bf16_f32 v42, 0, v42
    v_cvt_pk_bf16_f32 v43, 0, v43
    v_cvt_pk_bf16_f32 v44, 0, v44
    v_cvt_pk_bf16_f32 v45, 0, v45
    v_cvt_pk_bf16_f32 v46, 0, v46
    v_cvt_pk_bf16_f32 v47, 0, v47
    v_mul_f32 v36, v36, v84
    v_mul_f32 v37, v37, v85
    v_mul_f32 v38, v38, v86
    v_mul_f32 v39, v39, v87
    v_mul_f32 v40, v40, v88
    v_mul_f32 v41, v41, v89
    v_mul_f32 v42, v42, v90
    v_mul_f32 v43, v43, v91
    v_mul_f32 v44, v44, v92
    v_mul_f32 v45, v45, v93
    v_mul_f32 v46, v46, v94
    v_mul_f32 v47, v47, v95
    v_cvt_pk_bf16_f32 v132, v36, v37
    v_cvt_pk_bf16_f32 v133, v38, v39
    v_cvt_pk_bf16_f32 v134, v40, v41
    v_cvt_pk_bf16_f32 v135, v42, v43
    v_cvt_pk_bf16_f32 v136, v44, v45
    v_cvt_pk_bf16_f32 v137, v46, v47
    v_mfma_f32_16x16x16_bf16 v[144:147], v[132:133], v[164:165], 0
    v_mfma_f32_16x16x16_bf16 v[144:147], v[134:135], v[166:167], v[144:147]
    v_mfma_f32_16x16x16_bf16 v[144:147], v[136:137], v[168:169], v[144:147]
    s_waitcnt lgkmcnt(0)
    v_cvt_f32_i32 v48, v48
    v_cvt_f32_i32 v49, v49
    v_cvt_f32_i32 v50, v50
    v_cvt_f32_i32 v51, v51
    v_cvt_f32_i32 v52, v52
    v_cvt_f32_i32 v53, v53
    v_cvt_f32_i32 v54, v54
    v_cvt_f32_i32 v55, v55
    v_cvt_f32_i32 v56, v56
    v_cvt_f32_i32 v57, v57
    v_cvt_f32_i32 v58, v58
    v_cvt_f32_i32 v59, v59
    v_sub_f32 v48, v48, v72
    v_sub_f32 v49, v49, v73
    v_sub_f32 v50, v50, v74
    v_sub_f32 v51, v51, v75
    v_sub_f32 v52, v52, v76
    v_sub_f32 v53, v53, v77
    v_sub_f32 v54, v54, v78
    v_sub_f32 v55, v55, v79
    v_sub_f32 v56, v56, v80
    v_sub_f32 v57, v57, v81
    v_sub_f32 v58, v58, v82
    v_sub_f32 v59, v59, v83
    v_cvt_pk_bf16_f32 v48, 0, v48
    v_cvt_pk_bf16_f32 v49, 0, v49
    v_cvt_pk_bf16_f32 v50, 0, v50
    v_cvt_pk_bf16_f32 v51, 0, v51
    v_cvt_pk_bf16_f32 v52, 0, v52
    v_cvt_pk_bf16_f32 v53, 0, v53
    v_cvt_pk_bf16_f32 v54, 0, v54
    v_cvt_pk_bf16_f32 v55, 0, v55
    v_cvt_pk_bf16_f32 v56, 0, v56
    v_cvt_pk_bf16_f32 v57, 0, v57
    v_cvt_pk_bf16_f32 v58, 0, v58
    v_cvt_pk_bf16_f32 v59, 0, v59
    v_mul_f32 v48, v48, v96
    v_mul_f32 v49, v49, v97
    v_mul_f32 v50, v50, v98
    v_mul_f32 v51, v51, v99
    v_mul_f32 v52, v52, v100
    v_mul_f32 v53, v53, v101
    v_mul_f32 v54, v54, v102
    v_mul_f32 v55, v55, v103
    v_mul_f32 v56, v56, v104
    v_mul_f32 v57, v57, v105
    v_mul_f32 v58, v58, v106
    v_mul_f32 v59, v59, v107
    v_cvt_pk_bf16_f32 v138, v48, v49
    v_cvt_pk_bf16_f32 v139, v50, v51
    v_add_f32_dpp v3, v144, v147 row_ror:12 row_mask:0xf bank_mask:0xf
    v_cvt_pk_bf16_f32 v140, v52, v53
    v_cvt_pk_bf16_f32 v141, v54, v55
    v_add_f32_dpp v3, v145, v3 row_ror:8 row_mask:0xf bank_mask:0xf
    v_cvt_pk_bf16_f32 v142, v56, v57
    v_cvt_pk_bf16_f32 v143, v58, v59
    v_add_f32_dpp v15, v146, v3 row_ror:4 row_mask:0xf bank_mask:0x8
    v_mfma_f32_16x16x16_bf16 v[148:151], v[138:139], v[164:165], 0
    v_mfma_f32_16x16x16_bf16 v[148:151], v[140:141], v[166:167], v[148:151]
    v_mfma_f32_16x16x16_bf16 v[148:151], v[142:143], v[168:169], v[148:151]
    s_add_u32 s63, s63, 3072
    v_add_u32 v33, s63, v17
    v_add_u32 v34, s63, v18
    ds_read_b64 v[108:109], v33 offset:0
    ds_read_b64 v[110:111], v33 offset:1536
    ds_read_b64 v[112:113], v33 offset:128
    ds_read_b64 v[114:115], v33 offset:1664
    ds_read_b64 v[116:117], v33 offset:256
    ds_read_b64 v[118:119], v33 offset:1792
    ds_read_b64 v[120:121], v34 offset:0
    v_add_f32_dpp v4, v148, v151 row_ror:12 row_mask:0xf bank_mask:0xf
    ds_read_b64 v[122:123], v34 offset:1536
    ds_read_b64 v[124:125], v34 offset:128
    v_add_f32_dpp v4, v149, v4 row_ror:8 row_mask:0xf bank_mask:0xf
    ds_read_b64 v[126:127], v34 offset:1664
    ds_read_b64 v[128:129], v34 offset:256
    ds_read_b64 v[130:131], v34 offset:1792
    v_add_f32_dpp v16, v150, v4 row_ror:4 row_mask:0xf bank_mask:0x8
    v_cvt_pk_bf16_f32 v3, 0, v15
    v_cvt_pk_bf16_f32 v4, 0, v16
    v_mul_f32 v3, s65, v3
    v_mul_f32 v4, s65, v4
    v_cvt_pk_bf16_f32 v5, v3, v4
    v_max3_f32 v14, v14, v3, v4
    ds_write_b32 v11, v5 offset:256
    s_waitcnt lgkmcnt(0)
    v_lshlrev_b32 v60, 16, v108
    v_and_b32 v61, s66, v108
    v_lshlrev_b32 v62, 16, v109
    v_and_b32 v63, s66, v109
    v_lshlrev_b32 v84, 16, v110
    v_and_b32 v85, s66, v110
    v_lshlrev_b32 v86, 16, v111
    v_and_b32 v87, s66, v111
    v_lshlrev_b32 v64, 16, v112
    v_and_b32 v65, s66, v112
    v_lshlrev_b32 v66, 16, v113
    v_and_b32 v67, s66, v113
    v_lshlrev_b32 v88, 16, v114
    v_and_b32 v89, s66, v114
    v_lshlrev_b32 v90, 16, v115
    v_and_b32 v91, s66, v115
    v_lshlrev_b32 v68, 16, v116
    v_and_b32 v69, s66, v116
    v_lshlrev_b32 v70, 16, v117
    v_and_b32 v71, s66, v117
    v_lshlrev_b32 v92, 16, v118
    v_and_b32 v93, s66, v118
    v_lshlrev_b32 v94, 16, v119
    v_and_b32 v95, s66, v119
    v_lshlrev_b32 v72, 16, v120
    v_and_b32 v73, s66, v120
    v_lshlrev_b32 v74, 16, v121
    v_and_b32 v75, s66, v121
    v_lshlrev_b32 v96, 16, v122
    v_and_b32 v97, s66, v122
    v_lshlrev_b32 v98, 16, v123
    v_and_b32 v99, s66, v123
    v_lshlrev_b32 v76, 16, v124
    v_and_b32 v77, s66, v124
    v_lshlrev_b32 v78, 16, v125
    v_and_b32 v79, s66, v125
    v_lshlrev_b32 v100, 16, v126
    v_and_b32 v101, s66, v126
    v_lshlrev_b32 v102, 16, v127
    v_and_b32 v103, s66, v127
    v_lshlrev_b32 v80, 16, v128
    v_and_b32 v81, s66, v128
    v_lshlrev_b32 v82, 16, v129
    v_and_b32 v83, s66, v129
    v_lshlrev_b32 v104, 16, v130
    v_and_b32 v105, s66, v130
    v_lshlrev_b32 v106, 16, v131
    v_and_b32 v107, s66, v131
    v_add_u32 v11, 3072, v11
    s_add_u32 s61, s61, 1
    s_cmp_eq_u32 s61, s3
    s_cbranch_scc1 L_kblk_end
    s_cmp_eq_u32 s61, s73
    s_cbranch_scc1 L_kblk_end
    s_cmp_lt_u32 s61, 16
    s_cbranch_scc1 L_kblk
L_kblk_end:
    s_nop 1
    v_max_f32_dpp v14, v14, v14 row_ror:4 row_mask:0xf bank_mask:0xf
    s_nop 1
    v_max_f32_dpp v14, v14, v14 row_ror:8 row_mask:0xf bank_mask:0xf
    v_mov_b32 v3, v14
    s_nop 1
    v_permlane16_swap_b32 v14, v3
    v_max_f32 v14, v14, v3
    v_mov_b32 v3, v14
    s_nop 1
    v_permlane32_swap_b32 v14, v3
    v_max_f32 v14, v14, v3
    v_cvt_pk_bf16_f32 v14, 0, v14
    v_mul_f32 v14, s64, v14
    ds_write_b32 v154, v14
    v_add_u32 v154, 64, v154
    ds_read_b64 v[164:165], v153 offset:0
    ds_read_b64 v[166:167], v153 offset:128
    ds_read_b64 v[168:169], v153 offset:256
    v_add_u32 v153, 1536, v153
    v_mov_b32 v14, 0xff800000
    s_waitcnt lgkmcnt(0)
    s_cmp_lt_u32 s61, 16
    s_cbranch_scc1 L_kblk
    v_lshrrev_b32 v3, 4, v1
    v_and_b32 v4, 15, v1
    v_lshl_add_u32 v3, v2, 3, v3
    v_mul_u32_u24 v3, 768, v3
    v_lshl_add_u32 v12, v4, 4, v3
    v_subrev_u32 v11, 49152, v11
    s_mov_b32 s63, 0
    v_add_u32 v215, s63, v7
    v_add_u32 v216, s63, v8
    ds_read_b32 v214, v11 offset:0
    ds_read_u16 v217, v215 offset:512
    ds_read_u16 v218, v216 offset:512
    ds_read_u16 v215, v215
    ds_read_u16 v216, v216
    v_mov_b32 v188, 0
    v_mov_b32 v189, 0
    v_mov_b32 v190, 0
    v_mov_b32 v191, 0
    v_mov_b32 v192, 0
    v_mov_b32 v193, 0
    v_mov_b32 v194, 0
    v_mov_b32 v195, 0
    v_mov_b32 v196, 0
    v_mov_b32 v197, 0
    v_mov_b32 v198, 0
    v_mov_b32 v199, 0
    v_mov_b32 v200, 0
    v_mov_b32 v201, 0
    v_mov_b32 v202, 0
    v_mov_b32 v203, 0
    s_mov_b32 s61, 0
    v_and_b32 v3, 3, v1
    v_lshlrev_b32 v20, 4, v3
    v_add_u32 v154, 154944, v20
    v_add_u32 v18, 142336, v20
    v_lshl_add_u32 v156, v2, 6, v18
    v_lshl_add_u32 v20, v2, 6, v20
    v_add_u32 v20, 3072, v20
    v_mul_u32_u24 v155, 3072, v2
    v_lshl_add_u32 v155, v1, 4, v155
    v_add_u32 v155, 142592, v155
    v_lshlrev_b32 v4, 10, v2
    v_lshl_add_u32 v19, v1, 4, v4
    v_lshl_add_u32 v17, v1, 2, v4
    v_add_u32 v17, 142592, v17
    v_mul_u32_u24 v21, 384, v3
    v_lshrrev_b32 v4, 2, v1
    v_lshl_add_u32 v21, v4, 3, v21
    v_lshl_add_u32 v21, v2, 7, v21
    s_mov_b32 s48, s18
    s_and_b32 s49, s19, 0xffff
    s_mov_b32 s50, 393216
    s_mov_b32 s51, 0x20000
    s_mov_b32 s24, s22
    s_and_b32 s25, s23, 0xffff
    s_mov_b32 s26, 848640
    s_mov_b32 s27, 0x20000
    s_mul_i32 s68, s100, 9984
    s_mul_i32 s71, s2, 3328
    s_add_u32 s69, s68, 3328
    s_add_u32 s70, s68, 6656
    s_sub_u32 s57, 255, s100
    s_mul_i32 s57, s57, 1536
    s_mov_b32 s84, 0x7060500
    s_mov_b32 s85, 0x7060501
    s_mov_b32 s86, 0x7060502
    s_mov_b32 s87, 0x7060503
    s_mov_b32 s88, 0x0c0c0400
    s_mov_b32 s89, 0x04000c0c
    s_mov_b32 s90, 0xffffff00
L_vround:
    v_mov_b32 v164, 0
    v_mov_b32 v165, 0
    v_mov_b32 v166, 0
    v_mov_b32 v167, 0
    v_mov_b32 v168, 0
    v_mov_b32 v169, 0
    v_mov_b32 v170, 0
    v_mov_b32 v171, 0
    v_mov_b32 v172, 0
    v_mov_b32 v173, 0
    v_mov_b32 v174, 0
    v_mov_b32 v175, 0
    v_mov_b32 v212, 0
    v_mov_b32 v213, 0
L_vblk:
    s_add_u32 s61, s61, 1
    s_cmp_eq_u32 s61, s3
    s_cselect_b32 s74, 1, 0
    s_cmp_eq_u32 s61, s73
    s_cselect_b32 s74, 1, s74
    s_cmp_eq_u32 s61, 16
    s_cselect_b32 s74, 1, s74
    v_add_u32 v13, s62, v12
    s_add_u32 s62, s62, 24576
    s_cmp_eq_u32 s62, 73728
    s_cselect_b32 s62, 0, s62
    s_barrier
    ds_read_b128 v[160:163], v154
    ds_read_b128 v[36:39], v13 offset:0
    ds_read_b128 v[48:51], v13 offset:3072
    ds_read_b128 v[40:43], v13 offset:256
    ds_read_b128 v[52:55], v13 offset:3328
    ds_read_b128 v[44:47], v13 offset:512
    ds_read_b128 v[56:59], v13 offset:3584
    s_waitcnt lgkmcnt(6)
    v_max_f32 v14, v160, v161
    v_max3_f32 v14, v14, v162, v163
    s_waitcnt lgkmcnt(6)
    v_lshlrev_b32 v219, 16, v214
    v_and_b32 v220, s66, v214
    v_fma_f32 v219, v219, s64, -v14
    v_fma_f32 v220, v220, s64, -v14
    v_exp_f32 v219, v219
    v_exp_f32 v220, v220
    v_lshlrev_b32 v221, 16, v215
    v_lshlrev_b32 v222, 16, v216
    v_mul_f32 v221, v219, v221
    v_mul_f32 v222, v220, v222
    v_add_f32 v212, v212, v219
    v_cvt_pk_bf16_f32 v221, v221, v222
    v_add_f32 v212, v212, v220
    v_lshlrev_b32 v223, 16, v217
    v_lshlrev_b32 v224, 16, v218
    v_lshlrev_b32 v219, 16, v221
    v_and_b32 v220, s66, v221
    v_fmac_f32 v213, v219, v223
    v_fmac_f32 v213, v220, v224
    v_mov_b32_dpp v188, v221 quad_perm:[0,1,2,3] row_mask:0xf bank_mask:0x1
    v_mov_b32_dpp v189, v221 row_ror:12 row_mask:0xf bank_mask:0x1
    v_mov_b32_dpp v190, v221 row_ror:8 row_mask:0xf bank_mask:0x1
    v_mov_b32_dpp v191, v221 row_ror:4 row_mask:0xf bank_mask:0x1
    v_mov_b32_dpp v192, v221 row_ror:4 row_mask:0xf bank_mask:0x2
    v_mov_b32_dpp v193, v221 quad_perm:[0,1,2,3] row_mask:0xf bank_mask:0x2
    v_mov_b32_dpp v194, v221 row_ror:12 row_mask:0xf bank_mask:0x2
    v_mov_b32_dpp v195, v221 row_ror:8 row_mask:0xf bank_mask:0x2
    v_mov_b32_dpp v196, v221 row_ror:8 row_mask:0xf bank_mask:0x4
    v_mov_b32_dpp v197, v221 row_ror:4 row_mask:0xf bank_mask:0x4
    v_mov_b32_dpp v198, v221 quad_perm:[0,1,2,3] row_mask:0xf bank_mask:0x4
    v_mov_b32_dpp v199, v221 row_ror:12 row_mask:0xf bank_mask:0x4
    v_mov_b32_dpp v200, v221 row_ror:12 row_mask:0xf bank_mask:0x8
    v_mov_b32_dpp v201, v221 row_ror:8 row_mask:0xf bank_mask:0x8
    v_mov_b32_dpp v202, v221 row_ror:4 row_mask:0xf bank_mask:0x8
    v_mov_b32_dpp v203, v221 quad_perm:[0,1,2,3] row_mask:0xf bank_mask:0x8
    s_waitcnt lgkmcnt(4)
    v_cvt_f32_i32 v36, v36
    v_cvt_f32_i32 v37, v37
    v_cvt_f32_i32 v38, v38
    v_cvt_f32_i32 v39, v39
    v_cvt_f32_i32 v48, v48
    v_cvt_f32_i32 v49, v49
    v_cvt_f32_i32 v50, v50
    v_cvt_f32_i32 v51, v51
    v_cvt_pk_bf16_f32 v60, v36, v48
    v_cvt_pk_bf16_f32 v64, v37, v49
    v_cvt_pk_bf16_f32 v68, v38, v50
    v_cvt_pk_bf16_f32 v72, v39, v51
    s_waitcnt lgkmcnt(2)
    v_cvt_f32_i32 v40, v40
    v_cvt_f32_i32 v41, v41
    v_cvt_f32_i32 v42, v42
    v_cvt_f32_i32 v43, v43
    v_cvt_f32_i32 v52, v52
    v_cvt_f32_i32 v53, v53
    v_cvt_f32_i32 v54, v54
    v_cvt_f32_i32 v55, v55
    v_cvt_pk_bf16_f32 v76, v40, v52
    v_cvt_pk_bf16_f32 v80, v41, v53
    v_cvt_pk_bf16_f32 v84, v42, v54
    v_cvt_pk_bf16_f32 v88, v43, v55
    s_waitcnt lgkmcnt(0)
    v_cvt_f32_i32 v44, v44
    v_cvt_f32_i32 v45, v45
    v_cvt_f32_i32 v46, v46
    v_cvt_f32_i32 v47, v47
    v_cvt_f32_i32 v56, v56
    v_cvt_f32_i32 v57, v57
    v_cvt_f32_i32 v58, v58
    v_cvt_f32_i32 v59, v59
    v_cvt_pk_bf16_f32 v92, v44, v56
    v_cvt_pk_bf16_f32 v96, v45, v57
    v_cvt_pk_bf16_f32 v100, v46, v58
    v_cvt_pk_bf16_f32 v104, v47, v59
    v_add_u32 v215, s63, v9
    v_add_u32 v216, s63, v10
    ds_read_b32 v214, v11 offset:256
    ds_read_u16 v217, v215 offset:512
    ds_read_u16 v218, v216 offset:512
    ds_read_u16 v215, v215
    ds_read_u16 v216, v216
    v_add_u32 v13, s62, v12
    s_add_u32 s62, s62, 24576
    s_cmp_eq_u32 s62, 73728
    s_cselect_b32 s62, 0, s62
    s_barrier
    ds_read_b128 v[36:39], v13 offset:0
    ds_read_b128 v[48:51], v13 offset:3072
    ds_read_b128 v[40:43], v13 offset:256
    ds_read_b128 v[52:55], v13 offset:3328
    ds_read_b128 v[44:47], v13 offset:512
    ds_read_b128 v[56:59], v13 offset:3584
    s_waitcnt lgkmcnt(4)
    v_cvt_f32_i32 v36, v36
    v_cvt_f32_i32 v37, v37
    v_cvt_f32_i32 v38, v38
    v_cvt_f32_i32 v39, v39
    v_cvt_f32_i32 v48, v48
    v_cvt_f32_i32 v49, v49
    v_cvt_f32_i32 v50, v50
    v_cvt_f32_i32 v51, v51
    v_cvt_pk_bf16_f32 v61, v36, v48
    v_cvt_pk_bf16_f32 v65, v37, v49
    v_cvt_pk_bf16_f32 v69, v38, v50
    v_cvt_pk_bf16_f32 v73, v39, v51
    s_waitcnt lgkmcnt(2)
    v_cvt_f32_i32 v40, v40
    v_cvt_f32_i32 v41, v41
    v_cvt_f32_i32 v42, v42
    v_cvt_f32_i32 v43, v43
    v_cvt_f32_i32 v52, v52
    v_cvt_f32_i32 v53, v53
    v_cvt_f32_i32 v54, v54
    v_cvt_f32_i32 v55, v55
    v_cvt_pk_bf16_f32 v77, v40, v52
    v_cvt_pk_bf16_f32 v81, v41, v53
    v_cvt_pk_bf16_f32 v85, v42, v54
    v_cvt_pk_bf16_f32 v89, v43, v55
    s_waitcnt lgkmcnt(0)
    v_cvt_f32_i32 v44, v44
    v_cvt_f32_i32 v45, v45
    v_cvt_f32_i32 v46, v46
    v_cvt_f32_i32 v47, v47
    v_cvt_f32_i32 v56, v56
    v_cvt_f32_i32 v57, v57
    v_cvt_f32_i32 v58, v58
    v_cvt_f32_i32 v59, v59
    v_cvt_pk_bf16_f32 v93, v44, v56
    v_cvt_pk_bf16_f32 v97, v45, v57
    v_cvt_pk_bf16_f32 v101, v46, v58
    v_cvt_pk_bf16_f32 v105, v47, v59
    v_add_u32 v13, s62, v12
    s_add_u32 s62, s62, 24576
    s_cmp_eq_u32 s62, 73728
    s_cselect_b32 s62, 0, s62
    s_barrier
    ds_read_b128 v[36:39], v13 offset:0
    ds_read_b128 v[48:51], v13 offset:3072
    ds_read_b128 v[40:43], v13 offset:256
    ds_read_b128 v[52:55], v13 offset:3328
    ds_read_b128 v[44:47], v13 offset:512
    ds_read_b128 v[56:59], v13 offset:3584
    s_waitcnt lgkmcnt(4)
    v_cvt_f32_i32 v36, v36
    v_cvt_f32_i32 v37, v37
    v_cvt_f32_i32 v38, v38
    v_cvt_f32_i32 v39, v39
    v_cvt_f32_i32 v48, v48
    v_cvt_f32_i32 v49, v49
    v_cvt_f32_i32 v50, v50
    v_cvt_f32_i32 v51, v51
    v_cvt_pk_bf16_f32 v62, v36, v48
    v_cvt_pk_bf16_f32 v66, v37, v49
    v_cvt_pk_bf16_f32 v70, v38, v50
    v_cvt_pk_bf16_f32 v74, v39, v51
    s_waitcnt lgkmcnt(2)
    v_cvt_f32_i32 v40, v40
    v_cvt_f32_i32 v41, v41
    v_cvt_f32_i32 v42, v42
    v_cvt_f32_i32 v43, v43
    v_cvt_f32_i32 v52, v52
    v_cvt_f32_i32 v53, v53
    v_cvt_f32_i32 v54, v54
    v_cvt_f32_i32 v55, v55
    v_cvt_pk_bf16_f32 v78, v40, v52
    v_cvt_pk_bf16_f32 v82, v41, v53
    v_cvt_pk_bf16_f32 v86, v42, v54
    v_cvt_pk_bf16_f32 v90, v43, v55
    s_waitcnt lgkmcnt(0)
    v_cvt_f32_i32 v44, v44
    v_cvt_f32_i32 v45, v45
    v_cvt_f32_i32 v46, v46
    v_cvt_f32_i32 v47, v47
    v_cvt_f32_i32 v56, v56
    v_cvt_f32_i32 v57, v57
    v_cvt_f32_i32 v58, v58
    v_cvt_f32_i32 v59, v59
    v_cvt_pk_bf16_f32 v94, v44, v56
    v_cvt_pk_bf16_f32 v98, v45, v57
    v_cvt_pk_bf16_f32 v102, v46, v58
    v_cvt_pk_bf16_f32 v106, v47, v59
    v_add_u32 v13, s62, v12
    s_add_u32 s62, s62, 24576
    s_cmp_eq_u32 s62, 73728
    s_cselect_b32 s62, 0, s62
    s_barrier
    ds_read_b128 v[36:39], v13 offset:0
    ds_read_b128 v[48:51], v13 offset:3072
    ds_read_b128 v[40:43], v13 offset:256
    ds_read_b128 v[52:55], v13 offset:3328
    ds_read_b128 v[44:47], v13 offset:512
    ds_read_b128 v[56:59], v13 offset:3584
    s_waitcnt lgkmcnt(4)
    v_cvt_f32_i32 v36, v36
    v_cvt_f32_i32 v37, v37
    v_cvt_f32_i32 v38, v38
    v_cvt_f32_i32 v39, v39
    v_cvt_f32_i32 v48, v48
    v_cvt_f32_i32 v49, v49
    v_cvt_f32_i32 v50, v50
    v_cvt_f32_i32 v51, v51
    v_cvt_pk_bf16_f32 v63, v36, v48
    v_cvt_pk_bf16_f32 v67, v37, v49
    v_cvt_pk_bf16_f32 v71, v38, v50
    v_cvt_pk_bf16_f32 v75, v39, v51
    s_waitcnt lgkmcnt(2)
    v_cvt_f32_i32 v40, v40
    v_cvt_f32_i32 v41, v41
    v_cvt_f32_i32 v42, v42
    v_mfma_f32_16x16x32_bf16 v[164:167], v[188:191], v[60:63], v[164:167]
    v_cvt_f32_i32 v43, v43
    v_cvt_f32_i32 v52, v52
    v_cvt_f32_i32 v53, v53
    v_mfma_f32_16x16x32_bf16 v[164:167], v[192:195], v[64:67], v[164:167]
    v_cvt_f32_i32 v54, v54
    v_cvt_f32_i32 v55, v55
    v_cvt_pk_bf16_f32 v79, v40, v52
    v_mfma_f32_16x16x32_bf16 v[164:167], v[196:199], v[68:71], v[164:167]
    v_cvt_pk_bf16_f32 v83, v41, v53
    v_cvt_pk_bf16_f32 v87, v42, v54
    v_cvt_pk_bf16_f32 v91, v43, v55
    v_mfma_f32_16x16x32_bf16 v[164:167], v[200:203], v[72:75], v[164:167]
    s_waitcnt lgkmcnt(0)
    v_cvt_f32_i32 v44, v44
    v_cvt_f32_i32 v45, v45
    v_cvt_f32_i32 v46, v46
    v_mfma_f32_16x16x32_bf16 v[168:171], v[188:191], v[76:79], v[168:171]
    v_cvt_f32_i32 v47, v47
    v_cvt_f32_i32 v56, v56
    v_cvt_f32_i32 v57, v57
    v_mfma_f32_16x16x32_bf16 v[168:171], v[192:195], v[80:83], v[168:171]
    v_cvt_f32_i32 v58, v58
    v_cvt_f32_i32 v59, v59
    v_cvt_pk_bf16_f32 v95, v44, v56
    v_mfma_f32_16x16x32_bf16 v[168:171], v[196:199], v[84:87], v[168:171]
    v_cvt_pk_bf16_f32 v99, v45, v57
    v_cvt_pk_bf16_f32 v103, v46, v58
    v_cvt_pk_bf16_f32 v107, v47, v59
    v_mfma_f32_16x16x32_bf16 v[168:171], v[200:203], v[88:91], v[168:171]
    v_mfma_f32_16x16x32_bf16 v[172:175], v[188:191], v[92:95], v[172:175]
    v_mfma_f32_16x16x32_bf16 v[172:175], v[192:195], v[96:99], v[172:175]
    v_mfma_f32_16x16x32_bf16 v[172:175], v[196:199], v[100:103], v[172:175]
    v_mfma_f32_16x16x32_bf16 v[172:175], v[200:203], v[104:107], v[172:175]
    v_add_u32 v13, s62, v12
    s_add_u32 s62, s62, 24576
    s_cmp_eq_u32 s62, 73728
    s_cselect_b32 s62, 0, s62
    s_barrier
    ds_read_b128 v[36:39], v13 offset:0
    ds_read_b128 v[48:51], v13 offset:3072
    ds_read_b128 v[40:43], v13 offset:256
    ds_read_b128 v[52:55], v13 offset:3328
    ds_read_b128 v[44:47], v13 offset:512
    ds_read_b128 v[56:59], v13 offset:3584
    s_waitcnt lgkmcnt(6)
    v_lshlrev_b32 v219, 16, v214
    v_and_b32 v220, s66, v214
    v_fma_f32 v219, v219, s64, -v14
    v_fma_f32 v220, v220, s64, -v14
    v_exp_f32 v219, v219
    v_exp_f32 v220, v220
    v_lshlrev_b32 v221, 16, v215
    v_lshlrev_b32 v222, 16, v216
    v_mul_f32 v221, v219, v221
    v_mul_f32 v222, v220, v222
    v_add_f32 v212, v212, v219
    v_cvt_pk_bf16_f32 v221, v221, v222
    v_add_f32 v212, v212, v220
    v_lshlrev_b32 v223, 16, v217
    v_lshlrev_b32 v224, 16, v218
    v_lshlrev_b32 v219, 16, v221
    v_and_b32 v220, s66, v221
    v_fmac_f32 v213, v219, v223
    v_fmac_f32 v213, v220, v224
    v_mov_b32_dpp v188, v221 quad_perm:[0,1,2,3] row_mask:0xf bank_mask:0x1
    v_mov_b32_dpp v189, v221 row_ror:12 row_mask:0xf bank_mask:0x1
    v_mov_b32_dpp v190, v221 row_ror:8 row_mask:0xf bank_mask:0x1
    v_mov_b32_dpp v191, v221 row_ror:4 row_mask:0xf bank_mask:0x1
    v_mov_b32_dpp v192, v221 row_ror:4 row_mask:0xf bank_mask:0x2
    v_mov_b32_dpp v193, v221 quad_perm:[0,1,2,3] row_mask:0xf bank_mask:0x2
    v_mov_b32_dpp v194, v221 row_ror:12 row_mask:0xf bank_mask:0x2
    v_mov_b32_dpp v195, v221 row_ror:8 row_mask:0xf bank_mask:0x2
    v_mov_b32_dpp v196, v221 row_ror:8 row_mask:0xf bank_mask:0x4
    v_mov_b32_dpp v197, v221 row_ror:4 row_mask:0xf bank_mask:0x4
    v_mov_b32_dpp v198, v221 quad_perm:[0,1,2,3] row_mask:0xf bank_mask:0x4
    v_mov_b32_dpp v199, v221 row_ror:12 row_mask:0xf bank_mask:0x4
    v_mov_b32_dpp v200, v221 row_ror:12 row_mask:0xf bank_mask:0x8
    v_mov_b32_dpp v201, v221 row_ror:8 row_mask:0xf bank_mask:0x8
    v_mov_b32_dpp v202, v221 row_ror:4 row_mask:0xf bank_mask:0x8
    v_mov_b32_dpp v203, v221 quad_perm:[0,1,2,3] row_mask:0xf bank_mask:0x8
    s_waitcnt lgkmcnt(4)
    v_cvt_f32_i32 v36, v36
    v_cvt_f32_i32 v37, v37
    v_cvt_f32_i32 v38, v38
    v_cvt_f32_i32 v39, v39
    v_cvt_f32_i32 v48, v48
    v_cvt_f32_i32 v49, v49
    v_cvt_f32_i32 v50, v50
    v_cvt_f32_i32 v51, v51
    v_cvt_pk_bf16_f32 v60, v36, v48
    v_cvt_pk_bf16_f32 v64, v37, v49
    v_cvt_pk_bf16_f32 v68, v38, v50
    v_cvt_pk_bf16_f32 v72, v39, v51
    s_waitcnt lgkmcnt(2)
    v_cvt_f32_i32 v40, v40
    v_cvt_f32_i32 v41, v41
    v_cvt_f32_i32 v42, v42
    v_cvt_f32_i32 v43, v43
    v_cvt_f32_i32 v52, v52
    v_cvt_f32_i32 v53, v53
    v_cvt_f32_i32 v54, v54
    v_cvt_f32_i32 v55, v55
    v_cvt_pk_bf16_f32 v76, v40, v52
    v_cvt_pk_bf16_f32 v80, v41, v53
    v_cvt_pk_bf16_f32 v84, v42, v54
    v_cvt_pk_bf16_f32 v88, v43, v55
    s_waitcnt lgkmcnt(0)
    v_cvt_f32_i32 v44, v44
    v_cvt_f32_i32 v45, v45
    v_cvt_f32_i32 v46, v46
    v_cvt_f32_i32 v47, v47
    v_cvt_f32_i32 v56, v56
    v_cvt_f32_i32 v57, v57
    v_cvt_f32_i32 v58, v58
    v_cvt_f32_i32 v59, v59
    v_cvt_pk_bf16_f32 v92, v44, v56
    v_cvt_pk_bf16_f32 v96, v45, v57
    v_cvt_pk_bf16_f32 v100, v46, v58
    v_cvt_pk_bf16_f32 v104, v47, v59
    v_add_u32 v11, 3072, v11
    s_add_u32 s63, s63, 1024
    v_add_u32 v215, s63, v7
    v_add_u32 v216, s63, v8
    ds_read_b32 v214, v11 offset:0
    ds_read_u16 v217, v215 offset:512
    ds_read_u16 v218, v216 offset:512
    ds_read_u16 v215, v215
    ds_read_u16 v216, v216
    v_add_u32 v13, s62, v12
    s_add_u32 s62, s62, 24576
    s_cmp_eq_u32 s62, 73728
    s_cselect_b32 s62, 0, s62
    s_barrier
    ds_read_b128 v[36:39], v13 offset:0
    ds_read_b128 v[48:51], v13 offset:3072
    ds_read_b128 v[40:43], v13 offset:256
    ds_read_b128 v[52:55], v13 offset:3328
    ds_read_b128 v[44:47], v13 offset:512
    ds_read_b128 v[56:59], v13 offset:3584
    s_waitcnt lgkmcnt(4)
    v_cvt_f32_i32 v36, v36
    v_cvt_f32_i32 v37, v37
    v_cvt_f32_i32 v38, v38
    v_cvt_f32_i32 v39, v39
    v_cvt_f32_i32 v48, v48
    v_cvt_f32_i32 v49, v49
    v_cvt_f32_i32 v50, v50
    v_cvt_f32_i32 v51, v51
    v_cvt_pk_bf16_f32 v61, v36, v48
    v_cvt_pk_bf16_f32 v65, v37, v49
    v_cvt_pk_bf16_f32 v69, v38, v50
    v_cvt_pk_bf16_f32 v73, v39, v51
    s_waitcnt lgkmcnt(2)
    v_cvt_f32_i32 v40, v40
    v_cvt_f32_i32 v41, v41
    v_cvt_f32_i32 v42, v42
    v_cvt_f32_i32 v43, v43
    v_cvt_f32_i32 v52, v52
    v_cvt_f32_i32 v53, v53
    v_cvt_f32_i32 v54, v54
    v_cvt_f32_i32 v55, v55
    v_cvt_pk_bf16_f32 v77, v40, v52
    v_cvt_pk_bf16_f32 v81, v41, v53
    v_cvt_pk_bf16_f32 v85, v42, v54
    v_cvt_pk_bf16_f32 v89, v43, v55
    s_waitcnt lgkmcnt(0)
    v_cvt_f32_i32 v44, v44
    v_cvt_f32_i32 v45, v45
    v_cvt_f32_i32 v46, v46
    v_cvt_f32_i32 v47, v47
    v_cvt_f32_i32 v56, v56
    v_cvt_f32_i32 v57, v57
    v_cvt_f32_i32 v58, v58
    v_cvt_f32_i32 v59, v59
    v_cvt_pk_bf16_f32 v93, v44, v56
    v_cvt_pk_bf16_f32 v97, v45, v57
    v_cvt_pk_bf16_f32 v101, v46, v58
    v_cvt_pk_bf16_f32 v105, v47, v59
    s_cmp_eq_u32 s74, 0
    s_cbranch_scc1 L_vnostat
    v_mov_b32 v22, 154884
    ds_read_b32 v22, v22
    s_nop 1
    v_add_f32_dpp v212, v212, v212 row_ror:4 row_mask:0xf bank_mask:0xf
    s_nop 1
    v_add_f32_dpp v212, v212, v212 row_ror:8 row_mask:0xf bank_mask:0xf
    v_mov_b32 v3, v212
    s_nop 1
    v_permlane16_swap_b32 v212, v3
    v_add_f32 v212, v212, v3
    v_mov_b32 v3, v212
    s_nop 1
    v_permlane32_swap_b32 v212, v3
    v_add_f32 v212, v212, v3
    s_nop 1
    v_add_f32_dpp v213, v213, v213 row_ror:4 row_mask:0xf bank_mask:0xf
    s_nop 1
    v_add_f32_dpp v213, v213, v213 row_ror:8 row_mask:0xf bank_mask:0xf
    v_mov_b32 v3, v213
    s_nop 1
    v_permlane16_swap_b32 v213, v3
    v_add_f32 v213, v213, v3
    v_mov_b32 v3, v213
    s_nop 1
    v_permlane32_swap_b32 v213, v3
    v_add_f32 v213, v213, v3
    v_mov_b32 v160, v14
    v_mov_b32 v161, v212
    v_mov_b32 v162, v213
    ds_write_b128 v156, v[160:163]
    v_add_u32 v154, 64, v154
L_vnostat:
    v_add_u32 v13, s62, v12
    s_add_u32 s62, s62, 24576
    s_cmp_eq_u32 s62, 73728
    s_cselect_b32 s62, 0, s62
    s_barrier
    ds_read_b128 v[36:39], v13 offset:0
    ds_read_b128 v[48:51], v13 offset:3072
    ds_read_b128 v[40:43], v13 offset:256
    ds_read_b128 v[52:55], v13 offset:3328
    ds_read_b128 v[44:47], v13 offset:512
    ds_read_b128 v[56:59], v13 offset:3584
    s_waitcnt lgkmcnt(4)
    v_cvt_f32_i32 v36, v36
    v_cvt_f32_i32 v37, v37
    v_cvt_f32_i32 v38, v38
    v_cvt_f32_i32 v39, v39
    v_cvt_f32_i32 v48, v48
    v_cvt_f32_i32 v49, v49
    v_cvt_f32_i32 v50, v50
    v_cvt_f32_i32 v51, v51
    v_cvt_pk_bf16_f32 v62, v36, v48
    v_cvt_pk_bf16_f32 v66, v37, v49
    v_cvt_pk_bf16_f32 v70, v38, v50
    v_cvt_pk_bf16_f32 v74, v39, v51
    s_waitcnt lgkmcnt(2)
    v_cvt_f32_i32 v40, v40
    v_cvt_f32_i32 v41, v41
    v_cvt_f32_i32 v42, v42
    v_cvt_f32_i32 v43, v43
    v_cvt_f32_i32 v52, v52
    v_cvt_f32_i32 v53, v53
    v_cvt_f32_i32 v54, v54
    v_cvt_f32_i32 v55, v55
    v_cvt_pk_bf16_f32 v78, v40, v52
    v_cvt_pk_bf16_f32 v82, v41, v53
    v_cvt_pk_bf16_f32 v86, v42, v54
    v_cvt_pk_bf16_f32 v90, v43, v55
    s_waitcnt lgkmcnt(0)
    v_cvt_f32_i32 v44, v44
    v_cvt_f32_i32 v45, v45
    v_cvt_f32_i32 v46, v46
    v_cvt_f32_i32 v47, v47
    v_cvt_f32_i32 v56, v56
    v_cvt_f32_i32 v57, v57
    v_cvt_f32_i32 v58, v58
    v_cvt_f32_i32 v59, v59
    v_cvt_pk_bf16_f32 v94, v44, v56
    v_cvt_pk_bf16_f32 v98, v45, v57
    v_cvt_pk_bf16_f32 v102, v46, v58
    v_cvt_pk_bf16_f32 v106, v47, v59
    v_add_u32 v13, s62, v12
    s_add_u32 s62, s62, 24576
    s_cmp_eq_u32 s62, 73728
    s_cselect_b32 s62, 0, s62
    s_barrier
    ds_read_b128 v[36:39], v13 offset:0
    ds_read_b128 v[48:51], v13 offset:3072
    ds_read_b128 v[40:43], v13 offset:256
    ds_read_b128 v[52:55], v13 offset:3328
    ds_read_b128 v[44:47], v13 offset:512
    ds_read_b128 v[56:59], v13 offset:3584
    s_waitcnt lgkmcnt(4)
    v_cvt_f32_i32 v36, v36
    v_cvt_f32_i32 v37, v37
    v_cvt_f32_i32 v38, v38
    v_cvt_f32_i32 v39, v39
    v_cvt_f32_i32 v48, v48
    v_cvt_f32_i32 v49, v49
    v_cvt_f32_i32 v50, v50
    v_cvt_f32_i32 v51, v51
    v_cvt_pk_bf16_f32 v63, v36, v48
    v_cvt_pk_bf16_f32 v67, v37, v49
    v_cvt_pk_bf16_f32 v71, v38, v50
    v_cvt_pk_bf16_f32 v75, v39, v51
    s_waitcnt lgkmcnt(2)
    v_cvt_f32_i32 v40, v40
    v_cvt_f32_i32 v41, v41
    v_cvt_f32_i32 v42, v42
    v_mfma_f32_16x16x32_bf16 v[164:167], v[188:191], v[60:63], v[164:167]
    v_cvt_f32_i32 v43, v43
    v_cvt_f32_i32 v52, v52
    v_cvt_f32_i32 v53, v53
    v_mfma_f32_16x16x32_bf16 v[164:167], v[192:195], v[64:67], v[164:167]
    v_cvt_f32_i32 v54, v54
    v_cvt_f32_i32 v55, v55
    v_cvt_pk_bf16_f32 v79, v40, v52
    v_mfma_f32_16x16x32_bf16 v[164:167], v[196:199], v[68:71], v[164:167]
    v_cvt_pk_bf16_f32 v83, v41, v53
    v_cvt_pk_bf16_f32 v87, v42, v54
    v_cvt_pk_bf16_f32 v91, v43, v55
    v_mfma_f32_16x16x32_bf16 v[164:167], v[200:203], v[72:75], v[164:167]
    s_waitcnt lgkmcnt(0)
    v_cvt_f32_i32 v44, v44
    v_cvt_f32_i32 v45, v45
    v_cvt_f32_i32 v46, v46
    v_mfma_f32_16x16x32_bf16 v[168:171], v[188:191], v[76:79], v[168:171]
    v_cvt_f32_i32 v47, v47
    v_cvt_f32_i32 v56, v56
    v_cvt_f32_i32 v57, v57
    v_mfma_f32_16x16x32_bf16 v[168:171], v[192:195], v[80:83], v[168:171]
    v_cvt_f32_i32 v58, v58
    v_cvt_f32_i32 v59, v59
    v_cvt_pk_bf16_f32 v95, v44, v56
    v_mfma_f32_16x16x32_bf16 v[168:171], v[196:199], v[84:87], v[168:171]
    v_cvt_pk_bf16_f32 v99, v45, v57
    v_cvt_pk_bf16_f32 v103, v46, v58
    v_cvt_pk_bf16_f32 v107, v47, v59
    v_mfma_f32_16x16x32_bf16 v[168:171], v[200:203], v[88:91], v[168:171]
    v_mfma_f32_16x16x32_bf16 v[172:175], v[188:191], v[92:95], v[172:175]
    v_mfma_f32_16x16x32_bf16 v[172:175], v[192:195], v[96:99], v[172:175]
    v_mfma_f32_16x16x32_bf16 v[172:175], v[196:199], v[100:103], v[172:175]
    v_mfma_f32_16x16x32_bf16 v[172:175], v[200:203], v[104:107], v[172:175]
    s_cmp_eq_u32 s74, 0
    s_cbranch_scc1 L_vblk
    ds_write_b128 v155, v[164:167]
    s_nop 0
    ds_write_b128 v155, v[168:171] offset:1024
    s_cmp_lt_u32 s61, 16
    s_nop 1
    ds_write_b128 v155, v[172:175] offset:2048
    s_waitcnt lgkmcnt(0)
    s_cbranch_scc1 L_vround
    s_barrier
    s_cmp_eq_u32 s56, 3
    s_cbranch_scc1 L_fin
    ds_read_b128 v[36:39], v18 offset:0
    ds_read_b128 v[40:43], v18 offset:64
    ds_read_b128 v[44:47], v18 offset:128
    ds_read_b128 v[48:51], v18 offset:192
    ds_read2st64_b32 v[60:61], v17 offset0:0 offset1:1
    ds_read2st64_b32 v[62:63], v17 offset0:2 offset1:3
    ds_read2st64_b32 v[64:65], v17 offset0:12 offset1:13
    ds_read2st64_b32 v[66:67], v17 offset0:14 offset1:15
    ds_read2st64_b32 v[68:69], v17 offset0:24 offset1:25
    ds_read2st64_b32 v[70:71], v17 offset0:26 offset1:27
    ds_read2st64_b32 v[72:73], v17 offset0:36 offset1:37
    ds_read2st64_b32 v[74:75], v17 offset0:38 offset1:39
    s_cmp_eq_u32 s101, 0
    s_cbranch_scc0 L_rp10
    buffer_load_dwordx4 v[176:179], v20, s[24:27], s69 offen sc1
    buffer_load_dwordx4 v[184:187], v20, s[24:27], s70 offen sc1
    buffer_load_dwordx4 v[172:175], v19, s[24:27], s69 offen sc1
    buffer_load_dwordx4 v[180:183], v19, s[24:27], s70 offen sc1
    s_branch L_rp12
L_rp10:
    s_cmp_eq_u32 s101, 1
    s_cbranch_scc0 L_rp11
    buffer_load_dwordx4 v[168:171], v20, s[24:27], s68 offen sc1
    buffer_load_dwordx4 v[184:187], v20, s[24:27], s70 offen sc1
    buffer_load_dwordx4 v[164:167], v19, s[24:27], s68 offen sc1
    buffer_load_dwordx4 v[180:183], v19, s[24:27], s70 offen sc1
    s_branch L_rp12
L_rp11:
    buffer_load_dwordx4 v[168:171], v20, s[24:27], s68 offen sc1
    buffer_load_dwordx4 v[176:179], v20, s[24:27], s69 offen sc1
    buffer_load_dwordx4 v[164:167], v19, s[24:27], s68 offen sc1
    buffer_load_dwordx4 v[172:175], v19, s[24:27], s69 offen sc1
L_rp12:
    s_waitcnt lgkmcnt(8)
    v_add_f32 v37, v37, v41
    v_add_f32 v45, v45, v49
    v_add_f32 v38, v38, v42
    v_add_f32 v46, v46, v50
    v_add_f32 v37, v37, v45
    v_add_f32 v38, v38, v46
    v_mov_b32 v39, v22
    s_waitcnt lgkmcnt(4)
    v_add_f32 v60, v60, v64
    v_add_f32 v61, v61, v65
    v_add_f32 v62, v62, v66
    v_add_f32 v63, v63, v67
    s_waitcnt lgkmcnt(0)
    v_add_f32 v68, v68, v72
    v_add_f32 v69, v69, v73
    v_add_f32 v70, v70, v74
    v_add_f32 v71, v71, v75
    v_add_f32 v60, v60, v68
    v_add_f32 v61, v61, v69
    v_add_f32 v62, v62, v70
    v_add_f32 v63, v63, v71
    v_sub_f32 v60, v60, v38
    v_sub_f32 v61, v61, v38
    v_sub_f32 v62, v62, v38
    v_sub_f32 v63, v63, v38
    s_cmp_eq_u32 s2, 255
    s_cbranch_scc1 L_rsolo
    v_perm_b32 v60, v60, v22, s84
    v_perm_b32 v61, v61, v22, s85
    v_perm_b32 v62, v62, v22, s86
    v_perm_b32 v63, v63, v22, s87
    buffer_store_dwordx4 v[60:63], v19, s[24:27], s71 offen sc1
    s_mov_b64 exec, 15
    buffer_store_dwordx4 v[36:39], v20, s[24:27], s71 offen sc1
    s_mov_b64 exec, -1
    s_cmp_eq_u32 s101, 0
    s_cbranch_scc0 L_rp20
    v_mov_b32 v164, v60
    v_mov_b32 v168, v36
    v_mov_b32 v165, v61
    v_mov_b32 v169, v37
    v_mov_b32 v166, v62
    v_mov_b32 v170, v38
    v_mov_b32 v167, v63
    v_mov_b32 v171, v39
    s_branch L_rp22
L_rp20:
    s_cmp_eq_u32 s101, 1
    s_cbranch_scc0 L_rp21
    v_mov_b32 v172, v60
    v_mov_b32 v176, v36
    v_mov_b32 v173, v61
    v_mov_b32 v177, v37
    v_mov_b32 v174, v62
    v_mov_b32 v178, v38
    v_mov_b32 v175, v63
    v_mov_b32 v179, v39
    s_branch L_rp22
L_rp21:
    v_mov_b32 v180, v60
    v_mov_b32 v184, v36
    v_mov_b32 v181, v61
    v_mov_b32 v185, v37
    v_mov_b32 v182, v62
    v_mov_b32 v186, v38
    v_mov_b32 v183, v63
    v_mov_b32 v187, v39
L_rp22:
    s_waitcnt vmcnt(4)
    v_xor_b32 v40, v171, v22
    v_xor_b32 v41, v179, v22
    v_xor_b32 v42, v187, v22
    v_or3_b32 v4, v40, v41, v42
    s_waitcnt vmcnt(2)
    v_perm_b32 v5, v165, v164, s88
    v_perm_b32 v6, v167, v166, s89
    v_bitop3_b32 v5, v5, v6, v22 bitop3:0x56
    v_or_b32 v4, v4, v5
    v_perm_b32 v5, v173, v172, s88
    v_perm_b32 v6, v175, v174, s89
    v_bitop3_b32 v5, v5, v6, v22 bitop3:0x56
    v_or_b32 v4, v4, v5
    v_perm_b32 v5, v181, v180, s88
    v_perm_b32 v6, v183, v182, s89
    v_bitop3_b32 v5, v5, v6, v22 bitop3:0x56
    v_or_b32 v4, v4, v5
    v_cmp_eq_u32 vcc, 0, v4
    s_nop 4
    s_cmp_eq_u64 vcc, -1
    s_cbranch_scc1 L_rmerge
    s_waitcnt vmcnt(0)
    s_cmp_eq_u32 s101, 0
    s_cbranch_scc0 L_rp30
    buffer_load_dwordx4 v[176:179], v20, s[24:27], s69 offen sc1
    buffer_load_dwordx4 v[184:187], v20, s[24:27], s70 offen sc1
    buffer_load_dwordx4 v[172:175], v19, s[24:27], s69 offen sc1
    buffer_load_dwordx4 v[180:183], v19, s[24:27], s70 offen sc1
    s_branch L_rp32
L_rp30:
    s_cmp_eq_u32 s101, 1
    s_cbranch_scc0 L_rp31
    buffer_load_dwordx4 v[168:171], v20, s[24:27], s68 offen sc1
    buffer_load_dwordx4 v[184:187], v20, s[24:27], s70 offen sc1
    buffer_load_dwordx4 v[164:167], v19, s[24:27], s68 offen sc1
    buffer_load_dwordx4 v[180:183], v19, s[24:27], s70 offen sc1
    s_branch L_rp32
L_rp31:
    buffer_load_dwordx4 v[168:171], v20, s[24:27], s68 offen sc1
    buffer_load_dwordx4 v[176:179], v20, s[24:27], s69 offen sc1
    buffer_load_dwordx4 v[164:167], v19, s[24:27], s68 offen sc1
    buffer_load_dwordx4 v[172:175], v19, s[24:27], s69 offen sc1
L_rp32:
    s_waitcnt vmcnt(2)
    v_xor_b32 v40, v171, v22
    v_xor_b32 v41, v179, v22
    v_xor_b32 v42, v187, v22
    v_or3_b32 v4, v40, v41, v42
    s_waitcnt vmcnt(0)
    v_perm_b32 v5, v165, v164, s88
    v_perm_b32 v6, v167, v166, s89
    v_bitop3_b32 v5, v5, v6, v22 bitop3:0x56
    v_or_b32 v4, v4, v5
    v_perm_b32 v5, v173, v172, s88
    v_perm_b32 v6, v175, v174, s89
    v_bitop3_b32 v5, v5, v6, v22 bitop3:0x56
    v_or_b32 v4, v4, v5
    v_perm_b32 v5, v181, v180, s88
    v_perm_b32 v6, v183, v182, s89
    v_bitop3_b32 v5, v5, v6, v22 bitop3:0x56
    v_or_b32 v4, v4, v5
    v_cmp_eq_u32 vcc, 0, v4
L_rmerge:
    v_max3_f32 v3, v168, v176, v184
    v_sub_f32 v168, v168, v3
    v_sub_f32 v176, v176, v3
    v_sub_f32 v184, v184, v3
    v_exp_f32 v168, v168
    v_exp_f32 v176, v176
    v_exp_f32 v184, v184
    s_and_b64 exec, exec, vcc
    s_cbranch_execz L_fin
    v_and_b32 v164, s90, v164
    v_and_b32 v165, s90, v165
    v_and_b32 v166, s90, v166
    v_and_b32 v167, s90, v167
    v_and_b32 v172, s90, v172
    v_and_b32 v173, s90, v173
    v_and_b32 v174, s90, v174
    v_and_b32 v175, s90, v175
    v_and_b32 v180, s90, v180
    v_and_b32 v181, s90, v181
    v_and_b32 v182, s90, v182
    v_and_b32 v183, s90, v183
    v_mul_f32 v37, v168, v169
    v_fmac_f32 v37, v176, v177
    v_fmac_f32 v37, v184, v185
    v_mul_f32 v60, v164, v168
    v_fmac_f32 v60, v172, v176
    v_fmac_f32 v60, v180, v184
    v_mul_f32 v61, v165, v168
    v_fmac_f32 v61, v173, v176
    v_fmac_f32 v61, v181, v184
    v_mul_f32 v62, v166, v168
    v_fmac_f32 v62, v174, v176
    v_fmac_f32 v62, v182, v184
    v_mul_f32 v63, v167, v168
    v_fmac_f32 v63, v175, v176
    v_fmac_f32 v63, v183, v184
L_rsolo:
    v_rcp_f32 v37, v37
    s_nop 0
    v_mul_f32 v60, v60, v37
    v_mul_f32 v61, v61, v37
    v_mul_f32 v62, v62, v37
    v_mul_f32 v63, v63, v37
    v_cvt_pk_bf16_f32 v64, v60, v61
    v_cvt_pk_bf16_f32 v65, v62, v63
    buffer_store_dwordx2 v[64:65], v21, s[48:51], s57 offen
    s_branch L_fin
L_finisher:
    v_and_b32 v14, 3, v1
    v_mul_u32_u24 v8, 384, v14
    v_lshrrev_b32 v13, 2, v1
    v_lshl_add_u32 v8, v13, 3, v8
    v_lshlrev_b32 v9, 4, v1
    v_lshlrev_b32 v14, 4, v14
    s_memrealtime s[96:97]
    s_waitcnt lgkmcnt(0)
    s_mov_b32 s48, s18
    s_and_b32 s49, s19, 0xffff
    s_mov_b32 s50, 393216
    s_mov_b32 s51, 0x20000
    s_mov_b32 s52, s20
    s_and_b32 s53, s21, 0xffff
    s_mov_b32 s54, 256
    s_mov_b32 s55, 0x20000
    s_mov_b32 s24, s22
    s_and_b32 s25, s23, 0xffff
    s_mov_b32 s26, 2528256
    s_mov_b32 s27, 0x20000
L_fk:
    s_waitcnt vmcnt(63)
    s_movk_i32 s69, 4
L_fb1:
    s_barrier
    s_sub_u32 s69, s69, 1
    s_cmp_lg_u32 s69, 0
    s_cbranch_scc1 L_fb1
    s_waitcnt vmcnt(0)
    s_cmp_eq_u32 s2, 0
    s_cbranch_scc0 L_fk2
    s_or_b32 s71, s96, 1
    v_mov_b32 v16, s71
    v_mov_b32 v17, 0
    s_mov_b64 exec, 1
    buffer_atomic_cmpswap v[16:17], v9, s[52:55], 0 offen sc1
    s_mov_b64 exec, -1
L_fk2:
    s_movk_i32 s69, 124
L_fb2:
    s_barrier
    s_sub_u32 s69, s69, 1
    s_cmp_lg_u32 s69, 0
    s_cbranch_scc1 L_fb2
    s_load_dword s71, s[20:21], 0
    s_barrier
    s_waitcnt lgkmcnt(0)
    s_cmp_eq_u32 s71, 0
    s_cbranch_scc0 L_ftag
    s_or_b32 s71, s96, 1
    v_mov_b32 v16, s71
    v_mov_b32 v17, 0
    s_mov_b64 exec, 1
    buffer_atomic_cmpswap v[16:17], v9, s[52:55], 0 offen sc0 sc1
    s_mov_b64 exec, -1
    s_waitcnt vmcnt(0)
    v_readfirstlane_b32 s58, v16
    s_nop 3
    s_cmp_eq_u32 s58, 0
    s_cselect_b32 s71, s71, s58
L_ftag:
    v_mov_b32 v10, s71
    v_mov_b32 v13, 154884
    ds_write_b32 v13, v10
    s_lshr_b32 s63, s101, 1
    s_lshl_b32 s58, s100, 1
    s_add_u32 s63, s63, s58
    s_mul_i32 s62, s63, 8704
    s_add_u32 s62, s62, 1048576
    s_waitcnt lgkmcnt(0)
    s_cmp_eq_u32 s2, 255
    s_cbranch_scc1 L_fin
    s_cmp_eq_u32 s101, 1
    s_cbranch_scc1 L_fmid
    s_movk_i32 s69, 89
L_fb3:
    s_barrier
    s_sub_u32 s69, s69, 1
    s_cmp_lg_u32 s69, 0
    s_cbranch_scc1 L_fb3
    v_add_u32 v13, 142336, v14
    v_lshlrev_b32 v11, 2, v1
    v_add_u32 v11, 142592, v11
    ds_read_b128 v[16:19], v13 offset:0
    ds_read_b128 v[20:23], v13 offset:64
    ds_read_b128 v[24:27], v13 offset:128
    ds_read_b128 v[28:31], v13 offset:192
    ds_read2st64_b32 v[32:33], v11 offset0:0 offset1:1
    ds_read2st64_b32 v[34:35], v11 offset0:2 offset1:3
    ds_read2st64_b32 v[36:37], v11 offset0:4 offset1:5
    ds_read2st64_b32 v[38:39], v11 offset0:6 offset1:7
    ds_read2st64_b32 v[40:41], v11 offset0:8 offset1:9
    ds_read2st64_b32 v[42:43], v11 offset0:10 offset1:11
    ds_read2st64_b32 v[44:45], v11 offset0:12 offset1:13
    ds_read2st64_b32 v[46:47], v11 offset0:14 offset1:15
    s_waitcnt lgkmcnt(4)
    ds_read2st64_b32 v[48:49], v11 offset0:16 offset1:17
    ds_read2st64_b32 v[50:51], v11 offset0:18 offset1:19
    ds_read2st64_b32 v[52:53], v11 offset0:20 offset1:21
    ds_read2st64_b32 v[54:55], v11 offset0:22 offset1:23
    ds_read2st64_b32 v[56:57], v11 offset0:24 offset1:25
    ds_read2st64_b32 v[58:59], v11 offset0:26 offset1:27
    ds_read2st64_b32 v[60:61], v11 offset0:28 offset1:29
    ds_read2st64_b32 v[62:63], v11 offset0:30 offset1:31
    s_waitcnt lgkmcnt(4)
    ds_read2st64_b32 v[64:65], v11 offset0:32 offset1:33
    ds_read2st64_b32 v[66:67], v11 offset0:34 offset1:35
    ds_read2st64_b32 v[68:69], v11 offset0:36 offset1:37
    ds_read2st64_b32 v[70:71], v11 offset0:38 offset1:39
    ds_read2st64_b32 v[72:73], v11 offset0:40 offset1:41
    ds_read2st64_b32 v[74:75], v11 offset0:42 offset1:43
    ds_read2st64_b32 v[76:77], v11 offset0:44 offset1:45
    ds_read2st64_b32 v[78:79], v11 offset0:46 offset1:47
    v_mov_b32 v83, v10
    v_mov_b32 v87, v10
    v_mov_b32 v91, v10
    v_mov_b32 v95, v10
    v_mov_b32 v99, v10
    v_mov_b32 v96, v16
    v_add_f32 v17, v17, v21
    v_add_f32 v25, v25, v29
    v_add_f32 v97, v17, v25
    v_add_f32 v18, v18, v22
    v_add_f32 v26, v26, v30
    v_add_f32 v98, v18, v26
    s_waitcnt lgkmcnt(0)
    v_add_f32 v32, v32, v44
    v_add_f32 v56, v56, v68
    v_add_f32 v32, v32, v56
    v_sub_f32 v80, v32, v98
    v_add_f32 v33, v33, v45
    v_add_f32 v57, v57, v69
    v_add_f32 v33, v33, v57
    v_sub_f32 v81, v33, v98
    v_add_f32 v34, v34, v46
    v_add_f32 v58, v58, v70
    v_add_f32 v34, v34, v58
    v_sub_f32 v82, v34, v98
    v_add_f32 v35, v35, v47
    v_add_f32 v59, v59, v71
    v_add_f32 v35, v35, v59
    v_sub_f32 v84, v35, v98
    v_add_f32 v36, v36, v48
    v_add_f32 v60, v60, v72
    v_add_f32 v36, v36, v60
    v_sub_f32 v85, v36, v98
    v_add_f32 v37, v37, v49
    v_add_f32 v61, v61, v73
    v_add_f32 v37, v37, v61
    v_sub_f32 v86, v37, v98
    v_add_f32 v38, v38, v50
    v_add_f32 v62, v62, v74
    v_add_f32 v38, v38, v62
    v_sub_f32 v88, v38, v98
    v_add_f32 v39, v39, v51
    v_add_f32 v63, v63, v75
    v_add_f32 v39, v39, v63
    v_sub_f32 v89, v39, v98
    v_add_f32 v40, v40, v52
    v_add_f32 v64, v64, v76
    v_add_f32 v40, v40, v64
    v_sub_f32 v90, v40, v98
    v_add_f32 v41, v41, v53
    v_add_f32 v65, v65, v77
    v_add_f32 v41, v41, v65
    v_sub_f32 v92, v41, v98
    v_add_f32 v42, v42, v54
    v_add_f32 v66, v66, v78
    v_add_f32 v42, v42, v66
    v_sub_f32 v93, v42, v98
    v_add_f32 v43, v43, v55
    v_add_f32 v67, v67, v79
    v_add_f32 v43, v43, v67
    v_sub_f32 v94, v43, v98
    s_movk_i32 s69, 39
L_fb4:
    s_barrier
    s_sub_u32 s69, s69, 1
    s_cmp_lg_u32 s69, 0
    s_cbranch_scc1 L_fb4
    s_barrier
    s_mov_b32 s69, 2
L_fo5:
    s_add_u32 s58, s62, 4352
    s_add_u32 s59, s62, 8448
    buffer_load_dwordx4 v[116:119], v14, s[24:27], s59 offen sc1
    buffer_load_dwordx4 v[100:103], v9, s[24:27], s58 offen offset:0 sc1
    buffer_load_dwordx4 v[104:107], v9, s[24:27], s58 offen offset:1024 sc1
    buffer_load_dwordx4 v[108:111], v9, s[24:27], s58 offen offset:2048 sc1
    buffer_load_dwordx4 v[112:115], v9, s[24:27], s58 offen offset:3072 sc1
    s_waitcnt vmcnt(0)
    v_xor_b32 v13, v10, v103
    v_xor_b32 v11, v10, v107
    v_or_b32 v13, v13, v11
    v_xor_b32 v11, v10, v111
    v_or_b32 v13, v13, v11
    v_xor_b32 v11, v10, v115
    v_or_b32 v13, v13, v11
    v_xor_b32 v11, v10, v119
    v_or_b32 v13, v13, v11
    v_cmp_ne_u32 vcc, 0, v13
    s_nop 4
    s_cmp_eq_u64 vcc, 0
    s_cbranch_scc1 L_fo7
    s_sub_u32 s69, s69, 1
    s_cmp_lg_u32 s69, 0
    s_cbranch_scc1 L_fo5
    s_add_u32 s58, s62, 0
    s_add_u32 s59, s62, 4096
    buffer_store_dwordx4 v[80:83], v9, s[24:27], s58 offen offset:0 sc1
    buffer_store_dwordx4 v[84:87], v9, s[24:27], s58 offen offset:1024 sc1
    buffer_store_dwordx4 v[88:91], v9, s[24:27], s58 offen offset:2048 sc1
    buffer_store_dwordx4 v[92:95], v9, s[24:27], s58 offen offset:3072 sc1
    s_mov_b64 exec, 15
    buffer_store_dwordx4 v[96:99], v14, s[24:27], s59 offen sc1
    s_mov_b64 exec, -1
    s_waitcnt vmcnt(0)
    s_add_u32 s58, s62, 4352
    s_add_u32 s59, s62, 8448
    buffer_load_dwordx4 v[116:119], v14, s[24:27], s59 offen sc1
    buffer_load_dwordx4 v[100:103], v9, s[24:27], s58 offen offset:0 sc1
    buffer_load_dwordx4 v[104:107], v9, s[24:27], s58 offen offset:1024 sc1
    buffer_load_dwordx4 v[108:111], v9, s[24:27], s58 offen offset:2048 sc1
    buffer_load_dwordx4 v[112:115], v9, s[24:27], s58 offen offset:3072 sc1
    s_waitcnt vmcnt(0)
    v_xor_b32 v13, v10, v103
    v_xor_b32 v11, v10, v107
    v_or_b32 v13, v13, v11
    v_xor_b32 v11, v10, v111
    v_or_b32 v13, v13, v11
    v_xor_b32 v11, v10, v115
    v_or_b32 v13, v13, v11
    v_xor_b32 v11, v10, v119
    v_or_b32 v13, v13, v11
    v_cmp_ne_u32 vcc, 0, v13
    s_nop 4
    s_cmp_eq_u64 vcc, 0
    s_cbranch_scc0 L_fin
L_fo7:
    v_max_f32 v11, v96, v116
    v_sub_f32 v16, v96, v11
    v_sub_f32 v17, v116, v11
    v_exp_f32 v16, v16
    v_exp_f32 v17, v17
    s_nop 0
    v_mul_f32 v12, v16, v97
    v_fmac_f32 v12, v17, v117
    v_rcp_f32 v12, v12
    s_add_u32 s58, s63, 0
    s_mul_i32 s58, s58, 1536
    v_mul_f32 v16, v16, v12
    v_mul_f32 v17, v17, v12
    v_mul_f32 v32, v80, v16
    v_fmac_f32 v32, v100, v17
    v_mul_f32 v33, v81, v16
    v_fmac_f32 v33, v101, v17
    v_mul_f32 v34, v82, v16
    v_fmac_f32 v34, v102, v17
    v_mul_f32 v35, v84, v16
    v_fmac_f32 v35, v104, v17
    v_mul_f32 v36, v85, v16
    v_fmac_f32 v36, v105, v17
    v_mul_f32 v37, v86, v16
    v_fmac_f32 v37, v106, v17
    v_mul_f32 v38, v88, v16
    v_fmac_f32 v38, v108, v17
    v_mul_f32 v39, v89, v16
    v_fmac_f32 v39, v109, v17
    v_mul_f32 v40, v90, v16
    v_fmac_f32 v40, v110, v17
    v_mul_f32 v41, v92, v16
    v_fmac_f32 v41, v112, v17
    v_mul_f32 v42, v93, v16
    v_fmac_f32 v42, v113, v17
    v_mul_f32 v43, v94, v16
    v_fmac_f32 v43, v114, v17
    v_cvt_pk_bf16_f32 v44, v32, v33
    v_cvt_pk_bf16_f32 v45, v34, v35
    v_cvt_pk_bf16_f32 v46, v36, v37
    v_cvt_pk_bf16_f32 v47, v38, v39
    v_cvt_pk_bf16_f32 v48, v40, v41
    v_cvt_pk_bf16_f32 v49, v42, v43
    buffer_store_dwordx2 v[44:45], v8, s[48:51], s58 offen offset:0
    buffer_store_dwordx2 v[46:47], v8, s[48:51], s58 offen offset:128
    buffer_store_dwordx2 v[48:49], v8, s[48:51], s58 offen offset:256
    s_branch L_fin
L_fmid:
    v_and_b32 v7, 1, v1
    v_mul_u32_u24 v7, 8704, v7
    v_add_u32 v7, 4108, v7
    s_movk_i32 s69, 41
L_fb5:
    s_barrier
    s_sub_u32 s69, s69, 1
    s_cmp_lg_u32 s69, 0
    s_cbranch_scc1 L_fb5
    v_add_u32 v13, 142336, v14
    v_lshlrev_b32 v11, 2, v1
    v_add_u32 v11, 142592, v11
    ds_read_b128 v[16:19], v13 offset:0
    ds_read_b128 v[20:23], v13 offset:64
    ds_read_b128 v[24:27], v13 offset:128
    ds_read_b128 v[28:31], v13 offset:192
    ds_read2st64_b32 v[32:33], v11 offset0:0 offset1:1
    ds_read2st64_b32 v[34:35], v11 offset0:2 offset1:3
    ds_read2st64_b32 v[36:37], v11 offset0:4 offset1:5
    ds_read2st64_b32 v[38:39], v11 offset0:6 offset1:7
    ds_read2st64_b32 v[40:41], v11 offset0:8 offset1:9
    ds_read2st64_b32 v[42:43], v11 offset0:10 offset1:11
    ds_read2st64_b32 v[44:45], v11 offset0:12 offset1:13
    ds_read2st64_b32 v[46:47], v11 offset0:14 offset1:15
    s_waitcnt lgkmcnt(4)
    ds_read2st64_b32 v[48:49], v11 offset0:16 offset1:17
    ds_read2st64_b32 v[50:51], v11 offset0:18 offset1:19
    ds_read2st64_b32 v[52:53], v11 offset0:20 offset1:21
    ds_read2st64_b32 v[54:55], v11 offset0:22 offset1:23
    ds_read2st64_b32 v[56:57], v11 offset0:24 offset1:25
    ds_read2st64_b32 v[58:59], v11 offset0:26 offset1:27
    ds_read2st64_b32 v[60:61], v11 offset0:28 offset1:29
    ds_read2st64_b32 v[62:63], v11 offset0:30 offset1:31
    s_waitcnt lgkmcnt(4)
    ds_read2st64_b32 v[64:65], v11 offset0:32 offset1:33
    ds_read2st64_b32 v[66:67], v11 offset0:34 offset1:35
    ds_read2st64_b32 v[68:69], v11 offset0:36 offset1:37
    ds_read2st64_b32 v[70:71], v11 offset0:38 offset1:39
    ds_read2st64_b32 v[72:73], v11 offset0:40 offset1:41
    ds_read2st64_b32 v[74:75], v11 offset0:42 offset1:43
    ds_read2st64_b32 v[76:77], v11 offset0:44 offset1:45
    ds_read2st64_b32 v[78:79], v11 offset0:46 offset1:47
    v_mov_b32 v83, v10
    v_mov_b32 v87, v10
    v_mov_b32 v91, v10
    v_mov_b32 v95, v10
    v_mov_b32 v99, v10
    v_mov_b32 v96, v16
    v_add_f32 v17, v17, v21
    v_add_f32 v25, v25, v29
    v_add_f32 v97, v17, v25
    v_add_f32 v18, v18, v22
    v_add_f32 v26, v26, v30
    v_add_f32 v98, v18, v26
    s_waitcnt lgkmcnt(0)
    v_add_f32 v32, v32, v44
    v_add_f32 v56, v56, v68
    v_add_f32 v32, v32, v56
    v_sub_f32 v80, v32, v98
    v_add_f32 v33, v33, v45
    v_add_f32 v57, v57, v69
    v_add_f32 v33, v33, v57
    v_sub_f32 v81, v33, v98
    v_add_f32 v34, v34, v46
    v_add_f32 v58, v58, v70
    v_add_f32 v34, v34, v58
    v_sub_f32 v82, v34, v98
    v_add_f32 v35, v35, v47
    v_add_f32 v59, v59, v71
    v_add_f32 v35, v35, v59
    v_sub_f32 v84, v35, v98
    v_add_f32 v36, v36, v48
    v_add_f32 v60, v60, v72
    v_add_f32 v36, v36, v60
    v_sub_f32 v85, v36, v98
    v_add_f32 v37, v37, v49
    v_add_f32 v61, v61, v73
    v_add_f32 v37, v37, v61
    v_sub_f32 v86, v37, v98
    v_add_f32 v38, v38, v50
    v_add_f32 v62, v62, v74
    v_add_f32 v38, v38, v62
    v_sub_f32 v88, v38, v98
    v_add_f32 v39, v39, v51
    v_add_f32 v63, v63, v75
    v_add_f32 v39, v39, v63
    v_sub_f32 v89, v39, v98
    v_add_f32 v40, v40, v52
    v_add_f32 v64, v64, v76
    v_add_f32 v40, v40, v64
    v_sub_f32 v90, v40, v98
    v_add_f32 v41, v41, v53
    v_add_f32 v65, v65, v77
    v_add_f32 v41, v41, v65
    v_sub_f32 v92, v41, v98
    v_add_f32 v42, v42, v54
    v_add_f32 v66, v66, v78
    v_add_f32 v42, v42, v66
    v_sub_f32 v93, v42, v98
    v_add_f32 v43, v43, v55
    v_add_f32 v67, v67, v79
    v_add_f32 v43, v43, v67
    v_sub_f32 v94, v43, v98
    s_movk_i32 s69, 40
L_fb6:
    s_barrier
    s_sub_u32 s69, s69, 1
    s_cmp_lg_u32 s69, 0
    s_cbranch_scc1 L_fb6
    v_add_u32 v13, 142336, v14
    v_lshlrev_b32 v11, 2, v1
    v_add_u32 v11, 142592, v11
    ds_read_b128 v[16:19], v13 offset:0
    ds_read_b128 v[20:23], v13 offset:64
    ds_read_b128 v[24:27], v13 offset:128
    ds_read_b128 v[28:31], v13 offset:192
    ds_read2st64_b32 v[32:33], v11 offset0:0 offset1:1
    ds_read2st64_b32 v[34:35], v11 offset0:2 offset1:3
    ds_read2st64_b32 v[36:37], v11 offset0:4 offset1:5
    ds_read2st64_b32 v[38:39], v11 offset0:6 offset1:7
    ds_read2st64_b32 v[40:41], v11 offset0:8 offset1:9
    ds_read2st64_b32 v[42:43], v11 offset0:10 offset1:11
    ds_read2st64_b32 v[44:45], v11 offset0:12 offset1:13
    ds_read2st64_b32 v[46:47], v11 offset0:14 offset1:15
    s_waitcnt lgkmcnt(4)
    ds_read2st64_b32 v[48:49], v11 offset0:16 offset1:17
    ds_read2st64_b32 v[50:51], v11 offset0:18 offset1:19
    ds_read2st64_b32 v[52:53], v11 offset0:20 offset1:21
    ds_read2st64_b32 v[54:55], v11 offset0:22 offset1:23
    ds_read2st64_b32 v[56:57], v11 offset0:24 offset1:25
    ds_read2st64_b32 v[58:59], v11 offset0:26 offset1:27
    ds_read2st64_b32 v[60:61], v11 offset0:28 offset1:29
    ds_read2st64_b32 v[62:63], v11 offset0:30 offset1:31
    s_waitcnt lgkmcnt(4)
    ds_read2st64_b32 v[64:65], v11 offset0:32 offset1:33
    ds_read2st64_b32 v[66:67], v11 offset0:34 offset1:35
    ds_read2st64_b32 v[68:69], v11 offset0:36 offset1:37
    ds_read2st64_b32 v[70:71], v11 offset0:38 offset1:39
    ds_read2st64_b32 v[72:73], v11 offset0:40 offset1:41
    ds_read2st64_b32 v[74:75], v11 offset0:42 offset1:43
    ds_read2st64_b32 v[76:77], v11 offset0:44 offset1:45
    ds_read2st64_b32 v[78:79], v11 offset0:46 offset1:47
    v_mov_b32 v103, v10
    v_mov_b32 v107, v10
    v_mov_b32 v111, v10
    v_mov_b32 v115, v10
    v_mov_b32 v119, v10
    v_mov_b32 v116, v16
    v_add_f32 v17, v17, v21
    v_add_f32 v25, v25, v29
    v_add_f32 v117, v17, v25
    v_add_f32 v18, v18, v22
    v_add_f32 v26, v26, v30
    v_add_f32 v118, v18, v26
    s_waitcnt lgkmcnt(0)
    v_add_f32 v32, v32, v44
    v_add_f32 v56, v56, v68
    v_add_f32 v32, v32, v56
    v_sub_f32 v100, v32, v118
    v_add_f32 v33, v33, v45
    v_add_f32 v57, v57, v69
    v_add_f32 v33, v33, v57
    v_sub_f32 v101, v33, v118
    v_add_f32 v34, v34, v46
    v_add_f32 v58, v58, v70
    v_add_f32 v34, v34, v58
    v_sub_f32 v102, v34, v118
    v_add_f32 v35, v35, v47
    v_add_f32 v59, v59, v71
    v_add_f32 v35, v35, v59
    v_sub_f32 v104, v35, v118
    v_add_f32 v36, v36, v48
    v_add_f32 v60, v60, v72
    v_add_f32 v36, v36, v60
    v_sub_f32 v105, v36, v118
    v_add_f32 v37, v37, v49
    v_add_f32 v61, v61, v73
    v_add_f32 v37, v37, v61
    v_sub_f32 v106, v37, v118
    v_add_f32 v38, v38, v50
    v_add_f32 v62, v62, v74
    v_add_f32 v38, v38, v62
    v_sub_f32 v108, v38, v118
    v_add_f32 v39, v39, v51
    v_add_f32 v63, v63, v75
    v_add_f32 v39, v39, v63
    v_sub_f32 v109, v39, v118
    v_add_f32 v40, v40, v52
    v_add_f32 v64, v64, v76
    v_add_f32 v40, v40, v64
    v_sub_f32 v110, v40, v118
    v_add_f32 v41, v41, v53
    v_add_f32 v65, v65, v77
    v_add_f32 v41, v41, v65
    v_sub_f32 v112, v41, v118
    v_add_f32 v42, v42, v54
    v_add_f32 v66, v66, v78
    v_add_f32 v42, v42, v66
    v_sub_f32 v113, v42, v118
    v_add_f32 v43, v43, v55
    v_add_f32 v67, v67, v79
    v_add_f32 v43, v43, v67
    v_sub_f32 v114, v43, v118
    s_movk_i32 s69, 46
L_fb7:
    s_barrier
    s_sub_u32 s69, s69, 1
    s_cmp_lg_u32 s69, 0
    s_cbranch_scc1 L_fb7
    s_add_u32 s58, s62, 4352
    s_add_u32 s59, s62, 8448
    buffer_store_dwordx4 v[80:83], v9, s[24:27], s58 offen offset:0 sc1
    buffer_store_dwordx4 v[84:87], v9, s[24:27], s58 offen offset:1024 sc1
    buffer_store_dwordx4 v[88:91], v9, s[24:27], s58 offen offset:2048 sc1
    buffer_store_dwordx4 v[92:95], v9, s[24:27], s58 offen offset:3072 sc1
    s_mov_b64 exec, 15
    buffer_store_dwordx4 v[96:99], v14, s[24:27], s59 offen sc1
    s_mov_b64 exec, -1
    s_add_u32 s58, s62, 13056
    s_add_u32 s59, s62, 17152
    buffer_store_dwordx4 v[100:103], v9, s[24:27], s58 offen offset:0 sc1
    buffer_store_dwordx4 v[104:107], v9, s[24:27], s58 offen offset:1024 sc1
    buffer_store_dwordx4 v[108:111], v9, s[24:27], s58 offen offset:2048 sc1
    buffer_store_dwordx4 v[112:115], v9, s[24:27], s58 offen offset:3072 sc1
    s_mov_b64 exec, 15
    buffer_store_dwordx4 v[116:119], v14, s[24:27], s59 offen sc1
    s_mov_b64 exec, -1
    s_barrier
    s_barrier
    s_waitcnt vmcnt(0)
    buffer_load_dword v15, v7, s[24:27], s62 offen sc1
    s_waitcnt vmcnt(0)
    v_cmp_eq_u32 vcc, v15, v10
    s_nop 4
    s_and_b32 s70, vcc_lo, 3
    s_cbranch_scc0 L_fin
    s_bitcmp1_b32 s70, 0
    s_cbranch_scc0 L_fm30
    s_waitcnt vmcnt(0)
    s_add_u32 s58, s62, 0
    s_add_u32 s59, s62, 4096
    buffer_load_dwordx4 v[136:139], v14, s[24:27], s59 offen sc1
    buffer_load_dwordx4 v[120:123], v9, s[24:27], s58 offen offset:0 sc1
    buffer_load_dwordx4 v[124:127], v9, s[24:27], s58 offen offset:1024 sc1
    buffer_load_dwordx4 v[128:131], v9, s[24:27], s58 offen offset:2048 sc1
    buffer_load_dwordx4 v[132:135], v9, s[24:27], s58 offen offset:3072 sc1
    s_waitcnt vmcnt(0)
    v_xor_b32 v13, v10, v123
    v_xor_b32 v11, v10, v127
    v_or_b32 v13, v13, v11
    v_xor_b32 v11, v10, v131
    v_or_b32 v13, v13, v11
    v_xor_b32 v11, v10, v135
    v_or_b32 v13, v13, v11
    v_xor_b32 v11, v10, v139
    v_or_b32 v13, v13, v11
    v_cmp_ne_u32 vcc, 0, v13
    s_nop 4
    s_cmp_eq_u64 vcc, 0
    s_cbranch_scc0 L_fm30
    v_max_f32 v11, v136, v96
    v_sub_f32 v16, v136, v11
    v_sub_f32 v17, v96, v11
    v_exp_f32 v16, v16
    v_exp_f32 v17, v17
    s_nop 0
    v_mul_f32 v12, v16, v137
    v_fmac_f32 v12, v17, v97
    v_rcp_f32 v12, v12
    s_add_u32 s58, s63, 0
    s_mul_i32 s58, s58, 1536
    v_mul_f32 v16, v16, v12
    v_mul_f32 v17, v17, v12
    v_mul_f32 v32, v120, v16
    v_fmac_f32 v32, v80, v17
    v_mul_f32 v33, v121, v16
    v_fmac_f32 v33, v81, v17
    v_mul_f32 v34, v122, v16
    v_fmac_f32 v34, v82, v17
    v_mul_f32 v35, v124, v16
    v_fmac_f32 v35, v84, v17
    v_mul_f32 v36, v125, v16
    v_fmac_f32 v36, v85, v17
    v_mul_f32 v37, v126, v16
    v_fmac_f32 v37, v86, v17
    v_mul_f32 v38, v128, v16
    v_fmac_f32 v38, v88, v17
    v_mul_f32 v39, v129, v16
    v_fmac_f32 v39, v89, v17
    v_mul_f32 v40, v130, v16
    v_fmac_f32 v40, v90, v17
    v_mul_f32 v41, v132, v16
    v_fmac_f32 v41, v92, v17
    v_mul_f32 v42, v133, v16
    v_fmac_f32 v42, v93, v17
    v_mul_f32 v43, v134, v16
    v_fmac_f32 v43, v94, v17
    v_cvt_pk_bf16_f32 v44, v32, v33
    v_cvt_pk_bf16_f32 v45, v34, v35
    v_cvt_pk_bf16_f32 v46, v36, v37
    v_cvt_pk_bf16_f32 v47, v38, v39
    v_cvt_pk_bf16_f32 v48, v40, v41
    v_cvt_pk_bf16_f32 v49, v42, v43
    buffer_store_dwordx2 v[44:45], v8, s[48:51], s58 offen offset:0
    buffer_store_dwordx2 v[46:47], v8, s[48:51], s58 offen offset:128
    buffer_store_dwordx2 v[48:49], v8, s[48:51], s58 offen offset:256
L_fm30:
    s_bitcmp1_b32 s70, 1
    s_cbranch_scc0 L_fm31
    s_waitcnt vmcnt(0)
    s_add_u32 s58, s62, 8704
    s_add_u32 s59, s62, 12800
    buffer_load_dwordx4 v[136:139], v14, s[24:27], s59 offen sc1
    buffer_load_dwordx4 v[120:123], v9, s[24:27], s58 offen offset:0 sc1
    buffer_load_dwordx4 v[124:127], v9, s[24:27], s58 offen offset:1024 sc1
    buffer_load_dwordx4 v[128:131], v9, s[24:27], s58 offen offset:2048 sc1
    buffer_load_dwordx4 v[132:135], v9, s[24:27], s58 offen offset:3072 sc1
    s_waitcnt vmcnt(0)
    v_xor_b32 v13, v10, v123
    v_xor_b32 v11, v10, v127
    v_or_b32 v13, v13, v11
    v_xor_b32 v11, v10, v131
    v_or_b32 v13, v13, v11
    v_xor_b32 v11, v10, v135
    v_or_b32 v13, v13, v11
    v_xor_b32 v11, v10, v139
    v_or_b32 v13, v13, v11
    v_cmp_ne_u32 vcc, 0, v13
    s_nop 4
    s_cmp_eq_u64 vcc, 0
    s_cbranch_scc0 L_fm31
    v_max_f32 v11, v136, v116
    v_sub_f32 v16, v136, v11
    v_sub_f32 v17, v116, v11
    v_exp_f32 v16, v16
    v_exp_f32 v17, v17
    s_nop 0
    v_mul_f32 v12, v16, v137
    v_fmac_f32 v12, v17, v117
    v_rcp_f32 v12, v12
    s_add_u32 s58, s63, 1
    s_mul_i32 s58, s58, 1536
    v_mul_f32 v16, v16, v12
    v_mul_f32 v17, v17, v12
    v_mul_f32 v32, v120, v16
    v_fmac_f32 v32, v100, v17
    v_mul_f32 v33, v121, v16
    v_fmac_f32 v33, v101, v17
    v_mul_f32 v34, v122, v16
    v_fmac_f32 v34, v102, v17
    v_mul_f32 v35, v124, v16
    v_fmac_f32 v35, v104, v17
    v_mul_f32 v36, v125, v16
    v_fmac_f32 v36, v105, v17
    v_mul_f32 v37, v126, v16
    v_fmac_f32 v37, v106, v17
    v_mul_f32 v38, v128, v16
    v_fmac_f32 v38, v108, v17
    v_mul_f32 v39, v129, v16
    v_fmac_f32 v39, v109, v17
    v_mul_f32 v40, v130, v16
    v_fmac_f32 v40, v110, v17
    v_mul_f32 v41, v132, v16
    v_fmac_f32 v41, v112, v17
    v_mul_f32 v42, v133, v16
    v_fmac_f32 v42, v113, v17
    v_mul_f32 v43, v134, v16
    v_fmac_f32 v43, v114, v17
    v_cvt_pk_bf16_f32 v44, v32, v33
    v_cvt_pk_bf16_f32 v45, v34, v35
    v_cvt_pk_bf16_f32 v46, v36, v37
    v_cvt_pk_bf16_f32 v47, v38, v39
    v_cvt_pk_bf16_f32 v48, v40, v41
    v_cvt_pk_bf16_f32 v49, v42, v43
    buffer_store_dwordx2 v[44:45], v8, s[48:51], s58 offen offset:0
    buffer_store_dwordx2 v[46:47], v8, s[48:51], s58 offen offset:128
    buffer_store_dwordx2 v[48:49], v8, s[48:51], s58 offen offset:256
L_fm31:
L_fin:
L_end:
    s_endpgm
.section .rodata,"a"
.p2align 6
.amdhsa_kernel standalone__kv_cache_quant_int4_int2_kv_with_per_channel_or_per_token_scales__sampling_kernel
  .amdhsa_next_free_vgpr 232
  .amdhsa_next_free_sgpr 102
  .amdhsa_accum_offset 232
  .amdhsa_group_segment_fixed_size 0
  .amdhsa_kernarg_size 80
  .amdhsa_user_sgpr_count 2
  .amdhsa_user_sgpr_kernarg_segment_ptr 1
  .amdhsa_system_sgpr_workgroup_id_x 1
  .amdhsa_float_denorm_mode_32 3
.end_amdhsa_kernel
```

```asm
; @launch grid=(256,1,1) block=(448,1,1) lds=161280
.amdgcn_target "amdgcn-amd-amdhsa--gfx950"
.text
.globl standalone__kv_cache_quant_int4_int2_kv_with_per_channel_or_per_token_scales__sampling_kernel
.p2align 8
.type standalone__kv_cache_quant_int4_int2_kv_with_per_channel_or_per_token_scales__sampling_kernel,@function
standalone__kv_cache_quant_int4_int2_kv_with_per_channel_or_per_token_scales__sampling_kernel:
    s_load_dwordx16 s[4:19], s[0:1], 0
    s_load_dwordx4 s[20:23], s[0:1], 64
    s_cmp_ge_u32 s2, 256
    s_cbranch_scc1 L_end
    v_lshrrev_b32 v2, 6, v0
    v_and_b32 v1, 63, v0
    v_readfirstlane_b32 s56, v2
    s_mov_b32 s72, s2
    s_bfe_u32 s58, s2, 196612
    s_lshr_b32 s59, s2, 1
    s_and_b32 s59, s59, 2
    s_xor_b32 s2, s2, s58
    s_xor_b32 s2, s2, s59
    s_bfe_u32 s58, s2, 65537
    s_xor_b32 s2, s2, s58
    s_mul_i32 s57, s2, 1398112
    s_add_u32 s57, s57, 43691
    s_lshr_b32 s57, s57, 17
    v_lshlrev_b32 v8, 4, v1
    s_and_b32 s59, s56, 1
    s_mul_i32 s59, s59, 31488
    s_lshl_b32 s58, s57, 7
    s_add_u32 s58, s58, s56
    s_mul_i32 s58, s58, 1536
    s_add_u32 s58, s58, s59
    s_mul_i32 m0, s56, 3072
    s_mov_b32 s26, 805306368
    s_mov_b32 s27, 0x20000
    s_waitcnt lgkmcnt(0)
    s_mov_b32 s24, s6
    s_and_b32 s25, s7, 0xffff
    buffer_load_dwordx4 v8, s[24:27], s58 offen offset:0 nt lds
    buffer_load_dwordx4 v8, s[24:27], s58 offen offset:1024 nt lds
    buffer_load_dwordx4 v8, s[24:27], s58 offen offset:2048 nt lds
    s_mul_i32 s100, s2, 43691
    s_lshr_b32 s100, s100, 17
    s_mul_i32 s101, s100, 3
    s_sub_u32 s101, s2, s101
    s_cmp_eq_u32 s2, 255
    s_cselect_b32 s73, 16, 11
    s_cmp_eq_u32 s101, 1
    s_cselect_b32 s3, 5, s73
    s_cselect_b32 s73, 10, s73
    s_sub_u32 s58, 2, s101
    s_mul_i32 s58, s58, 11
    s_lshr_b32 s58, s58, 1
    s_lshl_b32 s59, s100, 4
    s_sub_u32 s58, s58, s59
    s_add_u32 s58, s58, 4080
    s_sub_u32 s58, s58, s73
    v_cmp_le_u32 vcc, s73, v1
    v_add_u32 v3, s57, v1
    v_add_u32 v4, s58, v1
    v_cndmask_b32 v152, v3, v4, vcc
    s_cmp_eq_u32 s56, 4
    s_cbranch_scc1 L_loader
    s_cmp_lt_u32 s56, 4
    s_cbranch_scc1 L_consumer
    s_cmp_eq_u32 s56, 6
    s_cbranch_scc1 L_ctl
    s_waitcnt lgkmcnt(0)
    s_mov_b32 s44, s4
    s_and_b32 s45, s5, 0xffff
    s_mov_b32 s46, 393216
    s_mov_b32 s47, 0x20000
    s_mov_b32 s32, s12
    s_and_b32 s33, s13, 0xffff
    s_mov_b32 s34, 6291456
    s_mov_b32 s35, 0x20000
    s_mov_b32 s28, s10
    s_and_b32 s29, s11, 0xffff
    s_mov_b32 s30, 6291456
    s_mov_b32 s31, 0x20000
    s_mov_b32 s36, s14
    s_and_b32 s37, s15, 0xffff
    s_mov_b32 s38, 2097152
    s_mov_b32 s39, 0x20000
    s_mov_b32 s40, s16
    s_and_b32 s41, s17, 0xffff
    s_mov_b32 s42, 2097152
    s_mov_b32 s43, 0x20000
    s_sub_u32 s61, s56, 5
    s_mov_b32 s62, s61
    s_mov_b32 exec_hi, 0xffff
L_stq:
    s_mul_i32 s58, s62, s3
    s_cmp_lt_u32 s58, 15
    s_cbranch_scc0 L_stage
    v_readlane_b32 s58, v152, s58
    s_mul_i32 s59, s62, 1536
    s_add_u32 m0, s59, 155136
    s_add_u32 s62, s62, 1
    s_lshr_b32 s58, s58, 4
    s_mul_i32 s58, s58, 1536
    buffer_load_dwordx4 v8, s[44:47], s58 offen nt lds
    buffer_load_dwordx4 v8, s[44:47], s58 offen offset:768 nt lds
    s_branch L_stq
L_stage:
    v_readlane_b32 s60, v152, s61
    s_mul_i32 s59, s61, 3072
    s_add_u32 m0, s59, 76800
    s_mov_b32 exec_hi, 0xffff
    s_mul_i32 s58, s60, 1536
    buffer_load_dwordx4 v8, s[32:35], s58 offen nt lds
    buffer_load_dwordx4 v8, s[32:35], s58 offen offset:768 nt lds
    s_add_u32 m0, m0, 1536
    s_lshl_b32 s59, s61, 10
    buffer_load_dwordx4 v8, s[28:31], s58 offen nt lds
    buffer_load_dwordx4 v8, s[28:31], s58 offen offset:768 nt lds
    s_add_u32 m0, s59, 125952
    s_mov_b32 exec_hi, 0
    s_lshl_b32 s58, s60, 9
    buffer_load_dwordx4 v8, s[36:39], s58 offen nt lds
    s_add_u32 m0, m0, 512
    s_add_u32 s61, s61, 1
    buffer_load_dwordx4 v8, s[40:43], s58 offen nt lds
    s_cmp_lt_u32 s61, 16
    s_cbranch_scc1 L_stage
    s_mov_b32 exec_hi, -1
    s_branch L_finisher
L_loader:
    s_setprio 3
    s_mul_i32 s57, s57, 196608
    s_add_u32 s69, s57, 42240
    s_mov_b32 m0, 21504
    s_add_u32 s57, s57, 12288
    buffer_load_dwordx4 v8, s[24:27], s69 offen offset:0 nt lds
    buffer_load_dwordx4 v8, s[24:27], s69 offen offset:1024 nt lds
    buffer_load_dwordx4 v8, s[24:27], s69 offen offset:2048 nt lds
    s_add_u32 s69, s69, 3072
    v_lshrrev_b32 v11, 5, v1
    v_add_u32 v22, 48, v1
    v_lshrrev_b32 v12, 6, v22
    v_mov_b32 v13, v8
    v_mov_b32 v14, v8
    v_mov_b32 v15, v8
    v_mov_b32 v16, v8
    s_mov_b32 s68, 4
    s_mov_b32 s62, 24576
    s_mov_b32 s63, 0
    s_mov_b32 s86, 0
    s_mov_b32 s87, 0
    s_mov_b32 s70, 18
    s_mov_b32 s74, 0
    v_mov_b32 v20, 4736
    v_mov_b32 v21, 154880
    ds_write_b32 v21, v20
    s_mov_b32 s58, 4
    s_branch L_lnobar
L_lw16:
    s_waitcnt vmcnt(16)
L_lw17:
    s_waitcnt vmcnt(17)
L_lw18:
    s_waitcnt vmcnt(18)
L_lw19:
    s_waitcnt vmcnt(19)
L_lw20:
    s_waitcnt vmcnt(20)
L_lw21:
    s_waitcnt vmcnt(21)
    buffer_load_dwordx4 v8, s[24:27], s57 offen offset:0 nt lds
    s_add_u32 s68, s68, 1
    s_and_b32 s58, s68, 31
    s_add_u32 s60, s63, 3072
    s_add_u32 s88, s60, s86
    buffer_load_dwordx4 v13, s[24:27], s57 offen offset:1024 nt lds
    s_add_u32 m0, s62, 3072
    s_add_u32 s89, s60, s87
    s_cmp_eq_u32 s58, 10
    s_cselect_b32 s63, 33024, 0
    s_cmp_eq_u32 s58, 21
    s_cselect_b32 s86, 33024, 0
    s_cselect_b32 s87, 32256, 0
    buffer_load_dwordx4 v8, s[24:27], s69 offen offset:0 nt lds
    s_add_u32 m0, s62, 0
    v_mad_u32_u24 v22, v12, s63, v8
    v_mad_u32_u24 v13, v11, s86, v8
    s_cmp_eq_u32 s70, 21
    s_cbranch_scc1 L_lx1__21
    s_cmp_eq_u32 s70, 20
    s_cbranch_scc1 L_lx1__20
    s_cmp_eq_u32 s70, 19
    s_cbranch_scc1 L_lx1__19
    s_cmp_eq_u32 s70, 18
    s_cbranch_scc1 L_lx1__18
    s_cmp_eq_u32 s70, 17
    s_cbranch_scc1 L_lx1__17
L_lx1__16:
    s_waitcnt vmcnt(16)
L_lx1__17:
    s_waitcnt vmcnt(17)
L_lx1__18:
    s_waitcnt vmcnt(18)
L_lx1__19:
    s_waitcnt vmcnt(19)
L_lx1__20:
    s_waitcnt vmcnt(20)
L_lx1__21:
    s_waitcnt vmcnt(21)
    buffer_load_dwordx4 v14, s[24:27], s57 offen offset:2048 nt lds
    s_add_u32 m0, s62, 3072
    v_add_u32 v14, s86, v22
    s_add_u32 s57, s57, s88
    buffer_load_dwordx4 v15, s[24:27], s69 offen offset:1024 nt lds
    v_mad_u32_u24 v15, v11, s87, v8
    buffer_load_dwordx4 v16, s[24:27], s69 offen offset:2048 nt lds
    v_add_u32 v16, s87, v22
    s_add_u32 s69, s69, s89
    s_add_u32 s62, s62, 6144
    s_add_u32 m0, s62, 0
    s_and_b32 s59, s68, 3
    s_cbranch_scc0 L_lunit
L_lad:
    s_cmp_eq_u32 s70, 21
    s_cbranch_scc1 L_lw21
    s_cmp_eq_u32 s70, 20
    s_cbranch_scc1 L_lw20
    s_cmp_eq_u32 s70, 19
    s_cbranch_scc1 L_lw19
    s_cmp_eq_u32 s70, 18
    s_cbranch_scc1 L_lw18
    s_cmp_eq_u32 s70, 17
    s_cbranch_scc1 L_lw17
    s_branch L_lw16
L_lunit:
    s_waitcnt vmcnt(24)
    s_cmp_eq_u32 s68, 8
    s_cbranch_scc1 L_lfirst
L_lbar:
    s_barrier
L_lnobar:
    s_waitcnt lgkmcnt(0)
    v_readfirstlane_b32 s59, v20
    ds_read_b32 v20, v21
    s_cmp_eq_u32 s62, 73728
    s_cselect_b32 s62, 0, s62
    s_add_u32 m0, s62, 0
    s_and_b32 s74, s74, 255
    s_add_u32 s74, s74, s59
    s_lshr_b32 s70, s74, 8
    s_cmp_eq_u32 s58, 0
    s_cbranch_scc1 L_lblock
L_lsel:
    s_cmp_le_u32 s70, 21
    s_cbranch_scc1 L_lad
    s_cmp_le_u32 s70, 22
    s_cbranch_scc1 L_lw22
    s_cmp_le_u32 s70, 23
    s_cbranch_scc1 L_lw23
    s_cmp_le_u32 s70, 24
    s_cbranch_scc1 L_lw24
    s_branch L_lw25
L_lblock:
    s_bfe_u32 s58, s68, 262149
    v_readlane_b32 s57, v152, s58
    s_nop 3
    s_mul_i32 s57, s57, 196608
    s_add_u32 s69, s57, 33024
    s_cmp_eq_u32 s58, 0
    s_cbranch_scc0 L_lsel
    s_cmp_eq_u32 s68, 1024
    s_cbranch_scc1 L_ldone
    s_mov_b32 s24, s8
    s_and_b32 s25, s9, 0xffff
    s_branch L_lsel
L_lfirst:
    s_barrier
    s_branch L_lbar
L_ldone:
    s_waitcnt vmcnt(0)
    s_barrier
    s_endpgm
L_lw22:
    s_waitcnt vmcnt(22)
    buffer_load_dwordx4 v8, s[24:27], s57 offen offset:0 nt lds
    s_add_u32 s68, s68, 1
    s_and_b32 s58, s68, 31
    s_add_u32 s60, s63, 3072
    s_add_u32 s88, s60, s86
    buffer_load_dwordx4 v13, s[24:27], s57 offen offset:1024 nt lds
    s_add_u32 m0, s62, 3072
    s_add_u32 s89, s60, s87
    s_cmp_eq_u32 s58, 10
    s_cselect_b32 s63, 33024, 0
    s_cmp_eq_u32 s58, 21
    s_cselect_b32 s86, 33024, 0
    s_cselect_b32 s87, 32256, 0
    buffer_load_dwordx4 v8, s[24:27], s69 offen offset:0 nt lds
    s_add_u32 m0, s62, 0
    v_mad_u32_u24 v22, v12, s63, v8
    v_mad_u32_u24 v13, v11, s86, v8
L_lx1_22_22:
    s_waitcnt vmcnt(22)
    buffer_load_dwordx4 v14, s[24:27], s57 offen offset:2048 nt lds
    s_add_u32 m0, s62, 3072
    v_add_u32 v14, s86, v22
    s_add_u32 s57, s57, s88
    buffer_load_dwordx4 v15, s[24:27], s69 offen offset:1024 nt lds
    v_mad_u32_u24 v15, v11, s87, v8
    buffer_load_dwordx4 v16, s[24:27], s69 offen offset:2048 nt lds
    v_add_u32 v16, s87, v22
    s_add_u32 s69, s69, s89
    s_add_u32 s62, s62, 6144
    s_add_u32 m0, s62, 0
    s_and_b32 s59, s68, 3
    s_cbranch_scc1 L_lw22
    s_branch L_lunit
L_lw23:
    s_waitcnt vmcnt(23)
    buffer_load_dwordx4 v8, s[24:27], s57 offen offset:0 nt lds
    s_add_u32 s68, s68, 1
    s_and_b32 s58, s68, 31
    s_add_u32 s60, s63, 3072
    s_add_u32 s88, s60, s86
    buffer_load_dwordx4 v13, s[24:27], s57 offen offset:1024 nt lds
    s_add_u32 m0, s62, 3072
    s_add_u32 s89, s60, s87
    s_cmp_eq_u32 s58, 10
    s_cselect_b32 s63, 33024, 0
    s_cmp_eq_u32 s58, 21
    s_cselect_b32 s86, 33024, 0
    s_cselect_b32 s87, 32256, 0
    buffer_load_dwordx4 v8, s[24:27], s69 offen offset:0 nt lds
    s_add_u32 m0, s62, 0
    v_mad_u32_u24 v22, v12, s63, v8
    v_mad_u32_u24 v13, v11, s86, v8
L_lx1_23_23:
    s_waitcnt vmcnt(23)
    buffer_load_dwordx4 v14, s[24:27], s57 offen offset:2048 nt lds
    s_add_u32 m0, s62, 3072
    v_add_u32 v14, s86, v22
    s_add_u32 s57, s57, s88
    buffer_load_dwordx4 v15, s[24:27], s69 offen offset:1024 nt lds
    v_mad_u32_u24 v15, v11, s87, v8
    buffer_load_dwordx4 v16, s[24:27], s69 offen offset:2048 nt lds
    v_add_u32 v16, s87, v22
    s_add_u32 s69, s69, s89
    s_add_u32 s62, s62, 6144
    s_add_u32 m0, s62, 0
    s_and_b32 s59, s68, 3
    s_cbranch_scc1 L_lw23
    s_branch L_lunit
L_lw24:
    s_waitcnt vmcnt(24)
    buffer_load_dwordx4 v8, s[24:27], s57 offen offset:0 nt lds
    s_add_u32 s68, s68, 1
    s_and_b32 s58, s68, 31
    s_add_u32 s60, s63, 3072
    s_add_u32 s88, s60, s86
    buffer_load_dwordx4 v13, s[24:27], s57 offen offset:1024 nt lds
    s_add_u32 m0, s62, 3072
    s_add_u32 s89, s60, s87
    s_cmp_eq_u32 s58, 10
    s_cselect_b32 s63, 33024, 0
    s_cmp_eq_u32 s58, 21
    s_cselect_b32 s86, 33024, 0
    s_cselect_b32 s87, 32256, 0
    buffer_load_dwordx4 v8, s[24:27], s69 offen offset:0 nt lds
    s_add_u32 m0, s62, 0
    v_mad_u32_u24 v22, v12, s63, v8
    v_mad_u32_u24 v13, v11, s86, v8
L_lx1_24_24:
    s_waitcnt vmcnt(24)
    buffer_load_dwordx4 v14, s[24:27], s57 offen offset:2048 nt lds
    s_add_u32 m0, s62, 3072
    v_add_u32 v14, s86, v22
    s_add_u32 s57, s57, s88
    buffer_load_dwordx4 v15, s[24:27], s69 offen offset:1024 nt lds
    v_mad_u32_u24 v15, v11, s87, v8
    buffer_load_dwordx4 v16, s[24:27], s69 offen offset:2048 nt lds
    v_add_u32 v16, s87, v22
    s_add_u32 s69, s69, s89
    s_add_u32 s62, s62, 6144
    s_add_u32 m0, s62, 0
    s_and_b32 s59, s68, 3
    s_cbranch_scc1 L_lw24
    s_branch L_lunit
L_lw25:
    s_waitcnt vmcnt(25)
    buffer_load_dwordx4 v8, s[24:27], s57 offen offset:0 nt lds
    s_add_u32 s68, s68, 1
    s_and_b32 s58, s68, 31
    s_add_u32 s60, s63, 3072
    s_add_u32 s88, s60, s86
    buffer_load_dwordx4 v13, s[24:27], s57 offen offset:1024 nt lds
    s_add_u32 m0, s62, 3072
    s_add_u32 s89, s60, s87
    s_cmp_eq_u32 s58, 10
    s_cselect_b32 s63, 33024, 0
    s_cmp_eq_u32 s58, 21
    s_cselect_b32 s86, 33024, 0
    s_cselect_b32 s87, 32256, 0
    buffer_load_dwordx4 v8, s[24:27], s69 offen offset:0 nt lds
    s_add_u32 m0, s62, 0
    v_mad_u32_u24 v22, v12, s63, v8
    v_mad_u32_u24 v13, v11, s86, v8
L_lx1_25_25:
    s_waitcnt vmcnt(25)
    buffer_load_dwordx4 v14, s[24:27], s57 offen offset:2048 nt lds
    s_add_u32 m0, s62, 3072
    v_add_u32 v14, s86, v22
    s_add_u32 s57, s57, s88
    buffer_load_dwordx4 v15, s[24:27], s69 offen offset:1024 nt lds
    v_mad_u32_u24 v15, v11, s87, v8
    buffer_load_dwordx4 v16, s[24:27], s69 offen offset:2048 nt lds
    v_add_u32 v16, s87, v22
    s_add_u32 s69, s69, s89
    s_add_u32 s62, s62, 6144
    s_add_u32 m0, s62, 0
    s_and_b32 s59, s68, 3
    s_cbranch_scc1 L_lw25
    s_branch L_lunit
L_ctl:
    s_sub_u32 s58, s72, 8
    s_cmp_lt_u32 s58, 8
    s_cbranch_scc0 L_ctl_init
    s_getpc_b64 s[44:45]
L_pc:
    s_and_b32 s45, s45, 0xffff
    s_mov_b32 s46, L_end - L_pc
    s_mov_b32 s47, 0x20000
    v_lshlrev_b32 v9, 7, v1
    s_movk_i32 s58, 0
    buffer_load_dword v12, v9, s[44:47], s58 offen
    s_movk_i32 s58, 8192
    buffer_load_dword v13, v9, s[44:47], s58 offen
    s_movk_i32 s58, 16384
    buffer_load_dword v14, v9, s[44:47], s58 offen
    s_movk_i32 s58, 24576
    buffer_load_dword v15, v9, s[44:47], s58 offen
L_ctl_init:
    s_waitcnt lgkmcnt(0)
    s_mov_b32 s52, s22
    s_and_b32 s53, s23, 0xffff
    s_mov_b32 s54, 16793888
    s_mov_b32 s55, 0x20000
    s_mov_b32 s71, 0
    s_add_u32 s98, s22, 16777216
    s_addc_u32 s99, s23, 0
    s_cmp_lt_u32 s72, 8
    s_cselect_b32 s61, 1, 0
    s_and_b32 s59, s72, 7
    s_mul_i32 s59, s59, 4
    s_add_u32 s59, s59, 16777216
    v_mov_b32 v8, s59
    v_mov_b32 v10, 154880
    s_memtime s[28:29]
    s_memrealtime s[96:97]
    s_mov_b32 s32, 0
    s_mov_b64 exec, 1
    s_waitcnt lgkmcnt(0)
    s_mov_b32 s33, s96
    s_waitcnt vmcnt(0)
    s_barrier
    s_mov_b32 s63, 0
L_ctl_loop:
    s_barrier
    s_mov_b32 s62, s96
    s_mov_b32 s30, s28
    s_memtime s[28:29]
    s_memrealtime s[96:97]
    s_waitcnt lgkmcnt(0)
    s_sub_u32 s58, s96, s33
    s_mul_i32 s58, s58, 373
    s_mov_b32 s33, s96
    s_sub_u32 s59, s28, s30
    s_lshl_b32 s59, s59, 4
    s_sub_i32 s58, s58, s59
    s_mul_i32 s58, s58, 80
    s_ashr_i32 s31, s58, 12
    s_cmp_eq_u32 s63, 0
    s_cbranch_scc1 L_ctl_set
    s_mov_b32 s58, 0
    s_sub_i32 s59, s84, s62
    s_add_i32 s60, s59, 5000
    s_cmp_lt_u32 s60, 10000
    s_cselect_b32 s59, s59, 200
    s_add_i32 s58, s58, s59
    s_sub_i32 s59, s85, s62
    s_add_i32 s60, s59, 5000
    s_cmp_lt_u32 s60, 10000
    s_cselect_b32 s59, s59, 200
    s_add_i32 s58, s58, s59
    s_sub_i32 s59, s86, s62
    s_add_i32 s60, s59, 5000
    s_cmp_lt_u32 s60, 10000
    s_cselect_b32 s59, s59, 200
    s_add_i32 s58, s58, s59
    s_sub_i32 s59, s87, s62
    s_add_i32 s60, s59, 5000
    s_cmp_lt_u32 s60, 10000
    s_cselect_b32 s59, s59, 200
    s_add_i32 s58, s58, s59
    s_sub_i32 s59, s88, s62
    s_add_i32 s60, s59, 5000
    s_cmp_lt_u32 s60, 10000
    s_cselect_b32 s59, s59, 200
    s_add_i32 s58, s58, s59
    s_sub_i32 s59, s89, s62
    s_add_i32 s60, s59, 5000
    s_cmp_lt_u32 s60, 10000
    s_cselect_b32 s59, s59, 200
    s_add_i32 s58, s58, s59
    s_sub_i32 s59, s90, s62
    s_add_i32 s60, s59, 5000
    s_cmp_lt_u32 s60, 10000
    s_cselect_b32 s59, s59, 200
    s_add_i32 s58, s58, s59
    s_sub_i32 s59, s91, s62
    s_add_i32 s60, s59, 5000
    s_cmp_lt_u32 s60, 10000
    s_cselect_b32 s59, s59, 200
    s_add_i32 s58, s58, s59
    s_min_u32 s59, s63, 12
    s_cmp_gt_i32 s58, 0
    s_cselect_b32 s63, s59, s63
    s_mul_i32 s58, s58, s63
    s_ashr_i32 s58, s58, 5
    s_mov_b32 s32, s58
L_ctl_set:
    s_sub_i32 s58, s31, s32
    s_add_i32 s58, s58, 4736
    s_max_i32 s58, s58, 4096
    s_min_i32 s70, s58, 6400
    v_mov_b32 v9, s70
    ds_write_b32 v10, v9
    s_and_b32 s58, s71, 768
    s_cselect_b32 s63, 0, 5
    s_cmp_ge_u32 s71, 14848
    s_cselect_b32 s63, 24, s63
    s_cmp_eq_u32 s71, 16128
    s_cselect_b32 s63, 0, s63
    s_mul_i32 s58, s63, s61
    s_cmp_eq_u32 s58, 0
    s_cbranch_scc1 L_ctl_norep
    v_mov_b32 v11, s96
    buffer_store_dword v11, v8, s[52:55], s71 offen sc1
L_ctl_norep:
    s_barrier
    s_barrier
    s_barrier
    s_cmp_eq_u32 s63, 0
    s_cbranch_scc1 L_ctl_nold
    s_load_dwordx8 s[84:91], s[98:99], s71
L_ctl_nold:
    s_add_u32 s71, s71, 256
    s_cmp_lt_u32 s71, 16384
    s_cbranch_scc1 L_ctl_loop
    s_waitcnt lgkmcnt(0)
    s_mov_b64 exec, -1
    s_endpgm
L_consumer:
    v_lshrrev_b32 v3, 2, v1
    v_lshlrev_b32 v3, 3, v3
    v_and_b32 v4, 3, v1
    v_mul_u32_u24 v5, 384, v4
    v_add_u32 v153, v3, v5
    v_add_u32 v153, 155136, v153
    s_mov_b32 s64, 0x3fb8aa3b
    s_mov_b32 s65, 0x3d93cd3a
    s_mov_b32 s66, 0xffff0000
    v_bfe_u32 v36, v1, 2, 1
    v_lshl_add_u32 v36, v2, 2, v36
    v_bfe_u32 v37, v1, 3, 1
    v_lshrrev_b32 v38, 4, v1
    v_lshl_add_u32 v38, v38, 2, v4
    v_lshlrev_b32 v38, 3, v38
    v_add_u32 v38, 73728, v38
    s_movk_i32 s58, 384
    v_add_u32 v3, 0, v36
    v_cmp_le_u32 vcc, 43, v3
    v_add_u32 v5, 43, v3
    v_mov_b32 v6, 42
    v_cndmask_b32 v17, v3, v5, vcc
    v_cmp_le_u32 vcc, 86, v3
    v_add_u32 v5, 43, v17
    s_nop 0
    v_cndmask_b32 v17, v17, v5, vcc
    v_cndmask_b32 v6, 43, v6, vcc
    v_mad_u32_u24 v17, v6, v37, v17
    v_lshrrev_b32 v17, 6, v17
    v_mad_u32_u24 v17, v17, s58, v38
    v_add_u32 v3, 2, v36
    v_cmp_le_u32 vcc, 43, v3
    v_add_u32 v5, 43, v3
    v_mov_b32 v6, 42
    v_cndmask_b32 v18, v3, v5, vcc
    v_cmp_le_u32 vcc, 86, v3
    v_add_u32 v5, 43, v18
    s_nop 0
    v_cndmask_b32 v18, v18, v5, vcc
    v_cndmask_b32 v6, 43, v6, vcc
    v_mad_u32_u24 v18, v6, v37, v18
    v_lshrrev_b32 v18, 6, v18
    v_mad_u32_u24 v18, v18, s58, v38
    v_add_u32 v3, 16, v36
    v_cmp_le_u32 vcc, 43, v3
    v_add_u32 v5, 43, v3
    v_mov_b32 v6, 42
    v_cndmask_b32 v19, v3, v5, vcc
    v_cmp_le_u32 vcc, 86, v3
    v_add_u32 v5, 43, v19
    s_nop 0
    v_cndmask_b32 v19, v19, v5, vcc
    v_cndmask_b32 v6, 43, v6, vcc
    v_mad_u32_u24 v19, v6, v37, v19
    v_lshrrev_b32 v19, 6, v19
    v_mad_u32_u24 v19, v19, s58, v38
    v_add_u32 v3, 18, v36
    v_cmp_le_u32 vcc, 43, v3
    v_add_u32 v5, 43, v3
    v_mov_b32 v6, 42
    v_cndmask_b32 v20, v3, v5, vcc
    v_cmp_le_u32 vcc, 86, v3
    v_add_u32 v5, 43, v20
    s_nop 0
    v_cndmask_b32 v20, v20, v5, vcc
    v_cndmask_b32 v6, 43, v6, vcc
    v_mad_u32_u24 v20, v6, v37, v20
    v_lshrrev_b32 v20, 6, v20
    v_mad_u32_u24 v20, v20, s58, v38
    v_add_u32 v3, 32, v36
    v_cmp_le_u32 vcc, 43, v3
    v_add_u32 v5, 43, v3
    v_mov_b32 v6, 42
    v_cndmask_b32 v21, v3, v5, vcc
    v_cmp_le_u32 vcc, 86, v3
    v_add_u32 v5, 43, v21
    s_nop 0
    v_cndmask_b32 v21, v21, v5, vcc
    v_cndmask_b32 v6, 43, v6, vcc
    v_mad_u32_u24 v21, v6, v37, v21
    v_lshrrev_b32 v21, 6, v21
    v_mad_u32_u24 v21, v21, s58, v38
    v_add_u32 v3, 34, v36
    v_cmp_le_u32 vcc, 43, v3
    v_add_u32 v5, 43, v3
    v_mov_b32 v6, 42
    v_cndmask_b32 v22, v3, v5, vcc
    v_cmp_le_u32 vcc, 86, v3
    v_add_u32 v5, 43, v22
    s_nop 0
    v_cndmask_b32 v22, v22, v5, vcc
    v_cndmask_b32 v6, 43, v6, vcc
    v_mad_u32_u24 v22, v6, v37, v22
    v_lshrrev_b32 v22, 6, v22
    v_mad_u32_u24 v22, v22, s58, v38
    v_add_u32 v3, 48, v36
    v_cmp_le_u32 vcc, 43, v3
    v_add_u32 v5, 43, v3
    v_mov_b32 v6, 42
    v_cndmask_b32 v23, v3, v5, vcc
    v_cmp_le_u32 vcc, 86, v3
    v_add_u32 v5, 43, v23
    s_nop 0
    v_cndmask_b32 v23, v23, v5, vcc
    v_cndmask_b32 v6, 43, v6, vcc
    v_mad_u32_u24 v23, v6, v37, v23
    v_lshrrev_b32 v23, 6, v23
    v_mad_u32_u24 v23, v23, s58, v38
    v_add_u32 v3, 50, v36
    v_cmp_le_u32 vcc, 43, v3
    v_add_u32 v5, 43, v3
    v_mov_b32 v6, 42
    v_cndmask_b32 v24, v3, v5, vcc
    v_cmp_le_u32 vcc, 86, v3
    v_add_u32 v5, 43, v24
    s_nop 0
    v_cndmask_b32 v24, v24, v5, vcc
    v_cndmask_b32 v6, 43, v6, vcc
    v_mad_u32_u24 v24, v6, v37, v24
    v_lshrrev_b32 v24, 6, v24
    v_mad_u32_u24 v24, v24, s58, v38
    v_add_u32 v3, 64, v36
    v_cmp_le_u32 vcc, 43, v3
    v_add_u32 v5, 43, v3
    v_mov_b32 v6, 42
    v_cndmask_b32 v25, v3, v5, vcc
    v_cmp_le_u32 vcc, 86, v3
    v_add_u32 v5, 43, v25
    s_nop 0
    v_cndmask_b32 v25, v25, v5, vcc
    v_cndmask_b32 v6, 43, v6, vcc
    v_mad_u32_u24 v25, v6, v37, v25
    v_lshrrev_b32 v25, 6, v25
    v_mad_u32_u24 v25, v25, s58, v38
    v_add_u32 v3, 66, v36
    v_cmp_le_u32 vcc, 43, v3
    v_add_u32 v5, 43, v3
    v_mov_b32 v6, 42
    v_cndmask_b32 v26, v3, v5, vcc
    v_cmp_le_u32 vcc, 86, v3
    v_add_u32 v5, 43, v26
    s_nop 0
    v_cndmask_b32 v26, v26, v5, vcc
    v_cndmask_b32 v6, 43, v6, vcc
    v_mad_u32_u24 v26, v6, v37, v26
    v_lshrrev_b32 v26, 6, v26
    v_mad_u32_u24 v26, v26, s58, v38
    v_add_u32 v3, 80, v36
    v_cmp_le_u32 vcc, 43, v3
    v_add_u32 v5, 43, v3
    v_mov_b32 v6, 42
    v_cndmask_b32 v27, v3, v5, vcc
    v_cmp_le_u32 vcc, 86, v3
    v_add_u32 v5, 43, v27
    s_nop 0
    v_cndmask_b32 v27, v27, v5, vcc
    v_cndmask_b32 v6, 43, v6, vcc
    v_mad_u32_u24 v27, v6, v37, v27
    v_lshrrev_b32 v27, 6, v27
    v_mad_u32_u24 v27, v27, s58, v38
    v_add_u32 v3, 82, v36
    v_cmp_le_u32 vcc, 43, v3
    v_add_u32 v5, 43, v3
    v_mov_b32 v6, 42
    v_cndmask_b32 v28, v3, v5, vcc
    v_cmp_le_u32 vcc, 86, v3
    v_add_u32 v5, 43, v28
    s_nop 0
    v_cndmask_b32 v28, v28, v5, vcc
    v_cndmask_b32 v6, 43, v6, vcc
    v_mad_u32_u24 v28, v6, v37, v28
    v_lshrrev_b32 v28, 6, v28
    v_mad_u32_u24 v28, v28, s58, v38
    v_add_u32 v3, 96, v36
    v_cmp_le_u32 vcc, 43, v3
    v_add_u32 v5, 43, v3
    v_mov_b32 v6, 42
    v_cndmask_b32 v29, v3, v5, vcc
    v_cmp_le_u32 vcc, 86, v3
    v_add_u32 v5, 43, v29
    s_nop 0
    v_cndmask_b32 v29, v29, v5, vcc
    v_cndmask_b32 v6, 43, v6, vcc
    v_mad_u32_u24 v29, v6, v37, v29
    v_lshrrev_b32 v29, 6, v29
    v_mad_u32_u24 v29, v29, s58, v38
    v_add_u32 v3, 98, v36
    v_cmp_le_u32 vcc, 43, v3
    v_add_u32 v5, 43, v3
    v_mov_b32 v6, 42
    v_cndmask_b32 v30, v3, v5, vcc
    v_cmp_le_u32 vcc, 86, v3
    v_add_u32 v5, 43, v30
    s_nop 0
    v_cndmask_b32 v30, v30, v5, vcc
    v_cndmask_b32 v6, 43, v6, vcc
    v_mad_u32_u24 v30, v6, v37, v30
    v_lshrrev_b32 v30, 6, v30
    v_mad_u32_u24 v30, v30, s58, v38
    v_add_u32 v3, 112, v36
    v_cmp_le_u32 vcc, 43, v3
    v_add_u32 v5, 43, v3
    v_mov_b32 v6, 42
    v_cndmask_b32 v31, v3, v5, vcc
    v_cmp_le_u32 vcc, 86, v3
    v_add_u32 v5, 43, v31
    s_nop 0
    v_cndmask_b32 v31, v31, v5, vcc
    v_cndmask_b32 v6, 43, v6, vcc
    v_mad_u32_u24 v31, v6, v37, v31
    v_lshrrev_b32 v31, 6, v31
    v_mad_u32_u24 v31, v31, s58, v38
    v_add_u32 v3, 114, v36
    v_cmp_le_u32 vcc, 43, v3
    v_add_u32 v5, 43, v3
    v_mov_b32 v6, 42
    v_cndmask_b32 v32, v3, v5, vcc
    v_cmp_le_u32 vcc, 86, v3
    v_add_u32 v5, 43, v32
    s_nop 0
    v_cndmask_b32 v32, v32, v5, vcc
    v_cndmask_b32 v6, 43, v6, vcc
    v_mad_u32_u24 v32, v6, v37, v32
    v_lshrrev_b32 v32, 6, v32
    v_mad_u32_u24 v32, v32, s58, v38
    v_bfe_u32 v36, v1, 4, 1
    v_lshl_add_u32 v36, v2, 2, v36
    v_bfe_u32 v3, v1, 2, 2
    v_lshl_add_u32 v36, v3, 4, v36
    v_lshrrev_b32 v37, 5, v1
    s_mov_b32 s58, 125952
    v_add_u32 v3, 0, v36
    v_cmp_le_u32 vcc, 43, v3
    v_add_u32 v5, 43, v3
    v_mov_b32 v6, 42
    v_cndmask_b32 v7, v3, v5, vcc
    v_cmp_le_u32 vcc, 86, v3
    v_add_u32 v5, 43, v7
    s_nop 0
    v_cndmask_b32 v7, v7, v5, vcc
    v_cndmask_b32 v6, 43, v6, vcc
    v_mad_u32_u24 v7, v6, v37, v7
    v_lshl_add_u32 v7, v7, 1, s58
    v_add_u32 v3, 2, v36
    v_cmp_le_u32 vcc, 43, v3
    v_add_u32 v5, 43, v3
    v_mov_b32 v6, 42
    v_cndmask_b32 v8, v3, v5, vcc
    v_cmp_le_u32 vcc, 86, v3
    v_add_u32 v5, 43, v8
    s_nop 0
    v_cndmask_b32 v8, v8, v5, vcc
    v_cndmask_b32 v6, 43, v6, vcc
    v_mad_u32_u24 v8, v6, v37, v8
    v_lshl_add_u32 v8, v8, 1, s58
    v_add_u32 v3, 64, v36
    v_cmp_le_u32 vcc, 43, v3
    v_add_u32 v5, 43, v3
    v_mov_b32 v6, 42
    v_cndmask_b32 v9, v3, v5, vcc
    v_cmp_le_u32 vcc, 86, v3
    v_add_u32 v5, 43, v9
    s_nop 0
    v_cndmask_b32 v9, v9, v5, vcc
    v_cndmask_b32 v6, 43, v6, vcc
    v_mad_u32_u24 v9, v6, v37, v9
    v_lshl_add_u32 v9, v9, 1, s58
    v_add_u32 v3, 66, v36
    v_cmp_le_u32 vcc, 43, v3
    v_add_u32 v5, 43, v3
    v_mov_b32 v6, 42
    v_cndmask_b32 v10, v3, v5, vcc
    v_cmp_le_u32 vcc, 86, v3
    v_add_u32 v5, 43, v10
    s_nop 0
    v_cndmask_b32 v10, v10, v5, vcc
    v_cndmask_b32 v6, 43, v6, vcc
    v_mad_u32_u24 v10, v6, v37, v10
    v_lshl_add_u32 v10, v10, 1, s58
    v_lshlrev_b32 v11, 2, v1
    v_lshl_add_u32 v11, v2, 9, v11
    v_add_u32 v11, 73728, v11
    v_bfe_u32 v3, v1, 2, 2
    v_lshrrev_b32 v4, 4, v1
    v_and_b32 v5, 3, v1
    v_lshl_add_u32 v4, v4, 2, v5
    v_and_b32 v5, 2, v3
    v_add_u32 v3, v3, v5
    v_lshl_add_u32 v3, v2, 3, v3
    v_mul_u32_u24 v3, 768, v3
    v_lshl_add_u32 v12, v4, 4, v3
    v_and_b32 v3, 3, v1
    v_lshl_add_u32 v154, v3, 2, v2
    v_lshlrev_b32 v154, 2, v154
    v_add_u32 v154, 154944, v154
    v_mov_b32 v14, 0xff800000
    s_mov_b32 s61, 0
    s_mov_b32 s62, 0
    s_movk_i32 s63, 3072
    s_waitcnt vmcnt(0) lgkmcnt(0)
    s_barrier
    ds_read_b64 v[164:165], v153 offset:0
    ds_read_b64 v[166:167], v153 offset:128
    ds_read_b64 v[168:169], v153 offset:256
    v_add_u32 v153, 1536, v153
    v_add_u32 v33, s63, v17
    v_add_u32 v34, s63, v18
    ds_read_b64 v[108:109], v33 offset:0
    ds_read_b64 v[110:111], v33 offset:1536
    ds_read_b64 v[112:113], v33 offset:128
    ds_read_b64 v[114:115], v33 offset:1664
    ds_read_b64 v[116:117], v33 offset:256
    ds_read_b64 v[118:119], v33 offset:1792
    ds_read_b64 v[120:121], v34 offset:0
    ds_read_b64 v[122:123], v34 offset:1536
    ds_read_b64 v[124:125], v34 offset:128
    ds_read_b64 v[126:127], v34 offset:1664
    ds_read_b64 v[128:129], v34 offset:256
    ds_read_b64 v[130:131], v34 offset:1792
    s_waitcnt lgkmcnt(0)
    v_lshlrev_b32 v60, 16, v108
    v_and_b32 v61, s66, v108
    v_lshlrev_b32 v62, 16, v109
    v_and_b32 v63, s66, v109
    v_lshlrev_b32 v84, 16, v110
    v_and_b32 v85, s66, v110
    v_lshlrev_b32 v86, 16, v111
    v_and_b32 v87, s66, v111
    v_lshlrev_b32 v64, 16, v112
    v_and_b32 v65, s66, v112
    v_lshlrev_b32 v66, 16, v113
    v_and_b32 v67, s66, v113
    v_lshlrev_b32 v88, 16, v114
    v_and_b32 v89, s66, v114
    v_lshlrev_b32 v90, 16, v115
    v_and_b32 v91, s66, v115
    v_lshlrev_b32 v68, 16, v116
    v_and_b32 v69, s66, v116
    v_lshlrev_b32 v70, 16, v117
    v_and_b32 v71, s66, v117
    v_lshlrev_b32 v92, 16, v118
    v_and_b32 v93, s66, v118
    v_lshlrev_b32 v94, 16, v119
    v_and_b32 v95, s66, v119
    v_lshlrev_b32 v72, 16, v120
    v_and_b32 v73, s66, v120
    v_lshlrev_b32 v74, 16, v121
    v_and_b32 v75, s66, v121
    v_lshlrev_b32 v96, 16, v122
    v_and_b32 v97, s66, v122
    v_lshlrev_b32 v98, 16, v123
    v_and_b32 v99, s66, v123
    v_lshlrev_b32 v76, 16, v124
    v_and_b32 v77, s66, v124
    v_lshlrev_b32 v78, 16, v125
    v_and_b32 v79, s66, v125
    v_lshlrev_b32 v100, 16, v126
    v_and_b32 v101, s66, v126
    v_lshlrev_b32 v102, 16, v127
    v_and_b32 v103, s66, v127
    v_lshlrev_b32 v80, 16, v128
    v_and_b32 v81, s66, v128
    v_lshlrev_b32 v82, 16, v129
    v_and_b32 v83, s66, v129
    v_lshlrev_b32 v104, 16, v130
    v_and_b32 v105, s66, v130
    v_lshlrev_b32 v106, 16, v131
    v_and_b32 v107, s66, v131
L_kblk:
    v_add_u32 v13, s62, v12
    s_add_u32 s62, s62, 24576
    s_cmp_eq_u32 s62, 73728
    s_cselect_b32 s62, 0, s62
    s_barrier
    ds_read_b128 v[36:39], v13 offset:0
    ds_read_b128 v[40:43], v13 offset:256
    ds_read_b128 v[44:47], v13 offset:512
    ds_read_b128 v[48:51], v13 offset:1536
    ds_read_b128 v[52:55], v13 offset:1792
    ds_read_b128 v[56:59], v13 offset:2048
    s_waitcnt lgkmcnt(3)
    v_cvt_f32_i32 v36, v36
    v_cvt_f32_i32 v37, v37
    v_cvt_f32_i32 v38, v38
    v_cvt_f32_i32 v39, v39
    v_cvt_f32_i32 v40, v40
    v_cvt_f32_i32 v41, v41
    v_cvt_f32_i32 v42, v42
    v_cvt_f32_i32 v43, v43
    v_cvt_f32_i32 v44, v44
    v_cvt_f32_i32 v45, v45
    v_cvt_f32_i32 v46, v46
    v_cvt_f32_i32 v47, v47
    v_sub_f32 v36, v36, v60
    v_sub_f32 v37, v37, v61
    v_sub_f32 v38, v38, v62
    v_sub_f32 v39, v39, v63
    v_sub_f32 v40, v40, v64
    v_sub_f32 v41, v41, v65
    v_sub_f32 v42, v42, v66
    v_sub_f32 v43, v43, v67
    v_sub_f32 v44, v44, v68
    v_sub_f32 v45, v45, v69
    v_sub_f32 v46, v46, v70
    v_sub_f32 v47, v47, v71
    v_cvt_pk_bf16_f32 v36, 0, v36
    v_cvt_pk_bf16_f32 v37, 0, v37
    v_cvt_pk_bf16_f32 v38, 0, v38
    v_cvt_pk_bf16_f32 v39, 0, v39
    v_cvt_pk_bf16_f32 v40, 0, v40
    v_cvt_pk_bf16_f32 v41, 0, v41
    v_cvt_pk_bf16_f32 v42, 0, v42
    v_cvt_pk_bf16_f32 v43, 0, v43
    v_cvt_pk_bf16_f32 v44, 0, v44
    v_cvt_pk_bf16_f32 v45, 0, v45
    v_cvt_pk_bf16_f32 v46, 0, v46
    v_cvt_pk_bf16_f32 v47, 0, v47
    v_mul_f32 v36, v36, v84
    v_mul_f32 v37, v37, v85
    v_mul_f32 v38, v38, v86
    v_mul_f32 v39, v39, v87
    v_mul_f32 v40, v40, v88
    v_mul_f32 v41, v41, v89
    v_mul_f32 v42, v42, v90
    v_mul_f32 v43, v43, v91
    v_mul_f32 v44, v44, v92
    v_mul_f32 v45, v45, v93
    v_mul_f32 v46, v46, v94
    v_mul_f32 v47, v47, v95
    v_cvt_pk_bf16_f32 v132, v36, v37
    v_cvt_pk_bf16_f32 v133, v38, v39
    v_cvt_pk_bf16_f32 v134, v40, v41
    v_cvt_pk_bf16_f32 v135, v42, v43
    v_cvt_pk_bf16_f32 v136, v44, v45
    v_cvt_pk_bf16_f32 v137, v46, v47
    v_mfma_f32_16x16x16_bf16 v[144:147], v[132:133], v[164:165], 0
    v_mfma_f32_16x16x16_bf16 v[144:147], v[134:135], v[166:167], v[144:147]
    v_mfma_f32_16x16x16_bf16 v[144:147], v[136:137], v[168:169], v[144:147]
    s_waitcnt lgkmcnt(0)
    v_cvt_f32_i32 v48, v48
    v_cvt_f32_i32 v49, v49
    v_cvt_f32_i32 v50, v50
    v_cvt_f32_i32 v51, v51
    v_cvt_f32_i32 v52, v52
    v_cvt_f32_i32 v53, v53
    v_cvt_f32_i32 v54, v54
    v_cvt_f32_i32 v55, v55
    v_cvt_f32_i32 v56, v56
    v_cvt_f32_i32 v57, v57
    v_cvt_f32_i32 v58, v58
    v_cvt_f32_i32 v59, v59
    v_sub_f32 v48, v48, v72
    v_sub_f32 v49, v49, v73
    v_sub_f32 v50, v50, v74
    v_sub_f32 v51, v51, v75
    v_sub_f32 v52, v52, v76
    v_sub_f32 v53, v53, v77
    v_sub_f32 v54, v54, v78
    v_sub_f32 v55, v55, v79
    v_sub_f32 v56, v56, v80
    v_sub_f32 v57, v57, v81
    v_sub_f32 v58, v58, v82
    v_sub_f32 v59, v59, v83
    v_cvt_pk_bf16_f32 v48, 0, v48
    v_cvt_pk_bf16_f32 v49, 0, v49
    v_cvt_pk_bf16_f32 v50, 0, v50
    v_cvt_pk_bf16_f32 v51, 0, v51
    v_cvt_pk_bf16_f32 v52, 0, v52
    v_cvt_pk_bf16_f32 v53, 0, v53
    v_cvt_pk_bf16_f32 v54, 0, v54
    v_cvt_pk_bf16_f32 v55, 0, v55
    v_cvt_pk_bf16_f32 v56, 0, v56
    v_cvt_pk_bf16_f32 v57, 0, v57
    v_cvt_pk_bf16_f32 v58, 0, v58
    v_cvt_pk_bf16_f32 v59, 0, v59
    v_mul_f32 v48, v48, v96
    v_mul_f32 v49, v49, v97
    v_mul_f32 v50, v50, v98
    v_mul_f32 v51, v51, v99
    v_mul_f32 v52, v52, v100
    v_mul_f32 v53, v53, v101
    v_mul_f32 v54, v54, v102
    v_mul_f32 v55, v55, v103
    v_mul_f32 v56, v56, v104
    v_mul_f32 v57, v57, v105
    v_mul_f32 v58, v58, v106
    v_mul_f32 v59, v59, v107
    v_cvt_pk_bf16_f32 v138, v48, v49
    v_cvt_pk_bf16_f32 v139, v50, v51
    v_add_f32_dpp v3, v145, v144 row_ror:12 row_mask:0xf bank_mask:0xf
    v_cvt_pk_bf16_f32 v140, v52, v53
    v_cvt_pk_bf16_f32 v141, v54, v55
    v_add_f32_dpp v3, v146, v3 row_ror:8 row_mask:0xf bank_mask:0xf
    v_cvt_pk_bf16_f32 v142, v56, v57
    v_cvt_pk_bf16_f32 v143, v58, v59
    v_add_f32_dpp v15, v147, v3 row_ror:4 row_mask:0xf bank_mask:0x1
    v_mfma_f32_16x16x16_bf16 v[148:151], v[138:139], v[164:165], 0
    v_mfma_f32_16x16x16_bf16 v[148:151], v[140:141], v[166:167], v[148:151]
    v_mfma_f32_16x16x16_bf16 v[148:151], v[142:143], v[168:169], v[148:151]
    v_add_u32 v33, s63, v19
    v_add_u32 v34, s63, v20
    ds_read_b64 v[108:109], v33 offset:0
    ds_read_b64 v[110:111], v33 offset:1536
    ds_read_b64 v[112:113], v33 offset:128
    ds_read_b64 v[114:115], v33 offset:1664
    ds_read_b64 v[116:117], v33 offset:256
    ds_read_b64 v[118:119], v33 offset:1792
    ds_read_b64 v[120:121], v34 offset:0
    v_add_f32_dpp v4, v149, v148 row_ror:12 row_mask:0xf bank_mask:0xf
    ds_read_b64 v[122:123], v34 offset:1536
    ds_read_b64 v[124:125], v34 offset:128
    v_add_f32_dpp v4, v150, v4 row_ror:8 row_mask:0xf bank_mask:0xf
    ds_read_b64 v[126:127], v34 offset:1664
    ds_read_b64 v[128:129], v34 offset:256
    ds_read_b64 v[130:131], v34 offset:1792
    v_add_f32_dpp v16, v151, v4 row_ror:4 row_mask:0xf bank_mask:0x1
    s_waitcnt lgkmcnt(0)
    v_lshlrev_b32 v60, 16, v108
    v_and_b32 v61, s66, v108
    v_lshlrev_b32 v62, 16, v109
    v_and_b32 v63, s66, v109
    v_lshlrev_b32 v84, 16, v110
    v_and_b32 v85, s66, v110
    v_lshlrev_b32 v86, 16, v111
    v_and_b32 v87, s66, v111
    v_lshlrev_b32 v64, 16, v112
    v_and_b32 v65, s66, v112
    v_lshlrev_b32 v66, 16, v113
    v_and_b32 v67, s66, v113
    v_lshlrev_b32 v88, 16, v114
    v_and_b32 v89, s66, v114
    v_lshlrev_b32 v90, 16, v115
    v_and_b32 v91, s66, v115
    v_lshlrev_b32 v68, 16, v116
    v_and_b32 v69, s66, v116
    v_lshlrev_b32 v70, 16, v117
    v_and_b32 v71, s66, v117
    v_lshlrev_b32 v92, 16, v118
    v_and_b32 v93, s66, v118
    v_lshlrev_b32 v94, 16, v119
    v_and_b32 v95, s66, v119
    v_lshlrev_b32 v72, 16, v120
    v_and_b32 v73, s66, v120
    v_lshlrev_b32 v74, 16, v121
    v_and_b32 v75, s66, v121
    v_lshlrev_b32 v96, 16, v122
    v_and_b32 v97, s66, v122
    v_lshlrev_b32 v98, 16, v123
    v_and_b32 v99, s66, v123
    v_lshlrev_b32 v76, 16, v124
    v_and_b32 v77, s66, v124
    v_lshlrev_b32 v78, 16, v125
    v_and_b32 v79, s66, v125
    v_lshlrev_b32 v100, 16, v126
    v_and_b32 v101, s66, v126
    v_lshlrev_b32 v102, 16, v127
    v_and_b32 v103, s66, v127
    v_lshlrev_b32 v80, 16, v128
    v_and_b32 v81, s66, v128
    v_lshlrev_b32 v82, 16, v129
    v_and_b32 v83, s66, v129
    v_lshlrev_b32 v104, 16, v130
    v_and_b32 v105, s66, v130
    v_lshlrev_b32 v106, 16, v131
    v_and_b32 v107, s66, v131
    v_add_u32 v13, s62, v12
    s_add_u32 s62, s62, 24576
    s_cmp_eq_u32 s62, 73728
    s_cselect_b32 s62, 0, s62
    s_barrier
    ds_read_b128 v[36:39], v13 offset:0
    ds_read_b128 v[40:43], v13 offset:256
    ds_read_b128 v[44:47], v13 offset:512
    ds_read_b128 v[48:51], v13 offset:1536
    ds_read_b128 v[52:55], v13 offset:1792
    ds_read_b128 v[56:59], v13 offset:2048
    s_waitcnt lgkmcnt(3)
    v_cvt_f32_i32 v36, v36
    v_cvt_f32_i32 v37, v37
    v_cvt_f32_i32 v38, v38
    v_cvt_f32_i32 v39, v39
    v_cvt_f32_i32 v40, v40
    v_cvt_f32_i32 v41, v41
    v_cvt_f32_i32 v42, v42
    v_cvt_f32_i32 v43, v43
    v_cvt_f32_i32 v44, v44
    v_cvt_f32_i32 v45, v45
    v_cvt_f32_i32 v46, v46
    v_cvt_f32_i32 v47, v47
    v_sub_f32 v36, v36, v60
    v_sub_f32 v37, v37, v61
    v_sub_f32 v38, v38, v62
    v_sub_f32 v39, v39, v63
    v_sub_f32 v40, v40, v64
    v_sub_f32 v41, v41, v65
    v_sub_f32 v42, v42, v66
    v_sub_f32 v43, v43, v67
    v_sub_f32 v44, v44, v68
    v_sub_f32 v45, v45, v69
    v_sub_f32 v46, v46, v70
    v_sub_f32 v47, v47, v71
    v_cvt_pk_bf16_f32 v36, 0, v36
    v_cvt_pk_bf16_f32 v37, 0, v37
    v_cvt_pk_bf16_f32 v38, 0, v38
    v_cvt_pk_bf16_f32 v39, 0, v39
    v_cvt_pk_bf16_f32 v40, 0, v40
    v_cvt_pk_bf16_f32 v41, 0, v41
    v_cvt_pk_bf16_f32 v42, 0, v42
    v_cvt_pk_bf16_f32 v43, 0, v43
    v_cvt_pk_bf16_f32 v44, 0, v44
    v_cvt_pk_bf16_f32 v45, 0, v45
    v_cvt_pk_bf16_f32 v46, 0, v46
    v_cvt_pk_bf16_f32 v47, 0, v47
    v_mul_f32 v36, v36, v84
    v_mul_f32 v37, v37, v85
    v_mul_f32 v38, v38, v86
    v_mul_f32 v39, v39, v87
    v_mul_f32 v40, v40, v88
    v_mul_f32 v41, v41, v89
    v_mul_f32 v42, v42, v90
    v_mul_f32 v43, v43, v91
    v_mul_f32 v44, v44, v92
    v_mul_f32 v45, v45, v93
    v_mul_f32 v46, v46, v94
    v_mul_f32 v47, v47, v95
    v_cvt_pk_bf16_f32 v132, v36, v37
    v_cvt_pk_bf16_f32 v133, v38, v39
    v_cvt_pk_bf16_f32 v134, v40, v41
    v_cvt_pk_bf16_f32 v135, v42, v43
    v_cvt_pk_bf16_f32 v136, v44, v45
    v_cvt_pk_bf16_f32 v137, v46, v47
    v_mfma_f32_16x16x16_bf16 v[144:147], v[132:133], v[164:165], 0
    v_mfma_f32_16x16x16_bf16 v[144:147], v[134:135], v[166:167], v[144:147]
    v_mfma_f32_16x16x16_bf16 v[144:147], v[136:137], v[168:169], v[144:147]
    s_waitcnt lgkmcnt(0)
    v_cvt_f32_i32 v48, v48
    v_cvt_f32_i32 v49, v49
    v_cvt_f32_i32 v50, v50
    v_cvt_f32_i32 v51, v51
    v_cvt_f32_i32 v52, v52
    v_cvt_f32_i32 v53, v53
    v_cvt_f32_i32 v54, v54
    v_cvt_f32_i32 v55, v55
    v_cvt_f32_i32 v56, v56
    v_cvt_f32_i32 v57, v57
    v_cvt_f32_i32 v58, v58
    v_cvt_f32_i32 v59, v59
    v_sub_f32 v48, v48, v72
    v_sub_f32 v49, v49, v73
    v_sub_f32 v50, v50, v74
    v_sub_f32 v51, v51, v75
    v_sub_f32 v52, v52, v76
    v_sub_f32 v53, v53, v77
    v_sub_f32 v54, v54, v78
    v_sub_f32 v55, v55, v79
    v_sub_f32 v56, v56, v80
    v_sub_f32 v57, v57, v81
    v_sub_f32 v58, v58, v82
    v_sub_f32 v59, v59, v83
    v_cvt_pk_bf16_f32 v48, 0, v48
    v_cvt_pk_bf16_f32 v49, 0, v49
    v_cvt_pk_bf16_f32 v50, 0, v50
    v_cvt_pk_bf16_f32 v51, 0, v51
    v_cvt_pk_bf16_f32 v52, 0, v52
    v_cvt_pk_bf16_f32 v53, 0, v53
    v_cvt_pk_bf16_f32 v54, 0, v54
    v_cvt_pk_bf16_f32 v55, 0, v55
    v_cvt_pk_bf16_f32 v56, 0, v56
    v_cvt_pk_bf16_f32 v57, 0, v57
    v_cvt_pk_bf16_f32 v58, 0, v58
    v_cvt_pk_bf16_f32 v59, 0, v59
    v_mul_f32 v48, v48, v96
    v_mul_f32 v49, v49, v97
    v_mul_f32 v50, v50, v98
    v_mul_f32 v51, v51, v99
    v_mul_f32 v52, v52, v100
    v_mul_f32 v53, v53, v101
    v_mul_f32 v54, v54, v102
    v_mul_f32 v55, v55, v103
    v_mul_f32 v56, v56, v104
    v_mul_f32 v57, v57, v105
    v_mul_f32 v58, v58, v106
    v_mul_f32 v59, v59, v107
    v_cvt_pk_bf16_f32 v138, v48, v49
    v_cvt_pk_bf16_f32 v139, v50, v51
    v_add_f32_dpp v3, v146, v145 row_ror:12 row_mask:0xf bank_mask:0xf
    v_cvt_pk_bf16_f32 v140, v52, v53
    v_cvt_pk_bf16_f32 v141, v54, v55
    v_add_f32_dpp v3, v147, v3 row_ror:8 row_mask:0xf bank_mask:0xf
    v_cvt_pk_bf16_f32 v142, v56, v57
    v_cvt_pk_bf16_f32 v143, v58, v59
    v_add_f32_dpp v15, v144, v3 row_ror:4 row_mask:0xf bank_mask:0x2
    v_mfma_f32_16x16x16_bf16 v[148:151], v[138:139], v[164:165], 0
    v_mfma_f32_16x16x16_bf16 v[148:151], v[140:141], v[166:167], v[148:151]
    v_mfma_f32_16x16x16_bf16 v[148:151], v[142:143], v[168:169], v[148:151]
    v_add_u32 v33, s63, v21
    v_add_u32 v34, s63, v22
    ds_read_b64 v[108:109], v33 offset:0
    ds_read_b64 v[110:111], v33 offset:1536
    ds_read_b64 v[112:113], v33 offset:128
    ds_read_b64 v[114:115], v33 offset:1664
    ds_read_b64 v[116:117], v33 offset:256
    ds_read_b64 v[118:119], v33 offset:1792
    ds_read_b64 v[120:121], v34 offset:0
    v_add_f32_dpp v4, v150, v149 row_ror:12 row_mask:0xf bank_mask:0xf
    ds_read_b64 v[122:123], v34 offset:1536
    ds_read_b64 v[124:125], v34 offset:128
    v_add_f32_dpp v4, v151, v4 row_ror:8 row_mask:0xf bank_mask:0xf
    ds_read_b64 v[126:127], v34 offset:1664
    ds_read_b64 v[128:129], v34 offset:256
    ds_read_b64 v[130:131], v34 offset:1792
    v_add_f32_dpp v16, v148, v4 row_ror:4 row_mask:0xf bank_mask:0x2
    s_waitcnt lgkmcnt(0)
    v_lshlrev_b32 v60, 16, v108
    v_and_b32 v61, s66, v108
    v_lshlrev_b32 v62, 16, v109
    v_and_b32 v63, s66, v109
    v_lshlrev_b32 v84, 16, v110
    v_and_b32 v85, s66, v110
    v_lshlrev_b32 v86, 16, v111
    v_and_b32 v87, s66, v111
    v_lshlrev_b32 v64, 16, v112
    v_and_b32 v65, s66, v112
    v_lshlrev_b32 v66, 16, v113
    v_and_b32 v67, s66, v113
    v_lshlrev_b32 v88, 16, v114
    v_and_b32 v89, s66, v114
    v_lshlrev_b32 v90, 16, v115
    v_and_b32 v91, s66, v115
    v_lshlrev_b32 v68, 16, v116
    v_and_b32 v69, s66, v116
    v_lshlrev_b32 v70, 16, v117
    v_and_b32 v71, s66, v117
    v_lshlrev_b32 v92, 16, v118
    v_and_b32 v93, s66, v118
    v_lshlrev_b32 v94, 16, v119
    v_and_b32 v95, s66, v119
    v_lshlrev_b32 v72, 16, v120
    v_and_b32 v73, s66, v120
    v_lshlrev_b32 v74, 16, v121
    v_and_b32 v75, s66, v121
    v_lshlrev_b32 v96, 16, v122
    v_and_b32 v97, s66, v122
    v_lshlrev_b32 v98, 16, v123
    v_and_b32 v99, s66, v123
    v_lshlrev_b32 v76, 16, v124
    v_and_b32 v77, s66, v124
    v_lshlrev_b32 v78, 16, v125
    v_and_b32 v79, s66, v125
    v_lshlrev_b32 v100, 16, v126
    v_and_b32 v101, s66, v126
    v_lshlrev_b32 v102, 16, v127
    v_and_b32 v103, s66, v127
    v_lshlrev_b32 v80, 16, v128
    v_and_b32 v81, s66, v128
    v_lshlrev_b32 v82, 16, v129
    v_and_b32 v83, s66, v129
    v_lshlrev_b32 v104, 16, v130
    v_and_b32 v105, s66, v130
    v_lshlrev_b32 v106, 16, v131
    v_and_b32 v107, s66, v131
    v_add_u32 v13, s62, v12
    s_add_u32 s62, s62, 24576
    s_cmp_eq_u32 s62, 73728
    s_cselect_b32 s62, 0, s62
    s_barrier
    ds_read_b128 v[36:39], v13 offset:0
    ds_read_b128 v[40:43], v13 offset:256
    ds_read_b128 v[44:47], v13 offset:512
    ds_read_b128 v[48:51], v13 offset:1536
    ds_read_b128 v[52:55], v13 offset:1792
    ds_read_b128 v[56:59], v13 offset:2048
    s_waitcnt lgkmcnt(3)
    v_cvt_f32_i32 v36, v36
    v_cvt_f32_i32 v37, v37
    v_cvt_f32_i32 v38, v38
    v_cvt_f32_i32 v39, v39
    v_cvt_f32_i32 v40, v40
    v_cvt_f32_i32 v41, v41
    v_cvt_f32_i32 v42, v42
    v_cvt_f32_i32 v43, v43
    v_cvt_f32_i32 v44, v44
    v_cvt_f32_i32 v45, v45
    v_cvt_f32_i32 v46, v46
    v_cvt_f32_i32 v47, v47
    v_sub_f32 v36, v36, v60
    v_sub_f32 v37, v37, v61
    v_sub_f32 v38, v38, v62
    v_sub_f32 v39, v39, v63
    v_sub_f32 v40, v40, v64
    v_sub_f32 v41, v41, v65
    v_sub_f32 v42, v42, v66
    v_sub_f32 v43, v43, v67
    v_sub_f32 v44, v44, v68
    v_sub_f32 v45, v45, v69
    v_sub_f32 v46, v46, v70
    v_sub_f32 v47, v47, v71
    v_cvt_pk_bf16_f32 v36, 0, v36
    v_cvt_pk_bf16_f32 v37, 0, v37
    v_cvt_pk_bf16_f32 v38, 0, v38
    v_cvt_pk_bf16_f32 v39, 0, v39
    v_cvt_pk_bf16_f32 v40, 0, v40
    v_cvt_pk_bf16_f32 v41, 0, v41
    v_cvt_pk_bf16_f32 v42, 0, v42
    v_cvt_pk_bf16_f32 v43, 0, v43
    v_cvt_pk_bf16_f32 v44, 0, v44
    v_cvt_pk_bf16_f32 v45, 0, v45
    v_cvt_pk_bf16_f32 v46, 0, v46
    v_cvt_pk_bf16_f32 v47, 0, v47
    v_mul_f32 v36, v36, v84
    v_mul_f32 v37, v37, v85
    v_mul_f32 v38, v38, v86
    v_mul_f32 v39, v39, v87
    v_mul_f32 v40, v40, v88
    v_mul_f32 v41, v41, v89
    v_mul_f32 v42, v42, v90
    v_mul_f32 v43, v43, v91
    v_mul_f32 v44, v44, v92
    v_mul_f32 v45, v45, v93
    v_mul_f32 v46, v46, v94
    v_mul_f32 v47, v47, v95
    v_cvt_pk_bf16_f32 v132, v36, v37
    v_cvt_pk_bf16_f32 v133, v38, v39
    v_cvt_pk_bf16_f32 v134, v40, v41
    v_cvt_pk_bf16_f32 v135, v42, v43
    v_cvt_pk_bf16_f32 v136, v44, v45
    v_cvt_pk_bf16_f32 v137, v46, v47
    v_mfma_f32_16x16x16_bf16 v[144:147], v[132:133], v[164:165], 0
    v_mfma_f32_16x16x16_bf16 v[144:147], v[134:135], v[166:167], v[144:147]
    v_mfma_f32_16x16x16_bf16 v[144:147], v[136:137], v[168:169], v[144:147]
    s_waitcnt lgkmcnt(0)
    v_cvt_f32_i32 v48, v48
    v_cvt_f32_i32 v49, v49
    v_cvt_f32_i32 v50, v50
    v_cvt_f32_i32 v51, v51
    v_cvt_f32_i32 v52, v52
    v_cvt_f32_i32 v53, v53
    v_cvt_f32_i32 v54, v54
    v_cvt_f32_i32 v55, v55
    v_cvt_f32_i32 v56, v56
    v_cvt_f32_i32 v57, v57
    v_cvt_f32_i32 v58, v58
    v_cvt_f32_i32 v59, v59
    v_sub_f32 v48, v48, v72
    v_sub_f32 v49, v49, v73
    v_sub_f32 v50, v50, v74
    v_sub_f32 v51, v51, v75
    v_sub_f32 v52, v52, v76
    v_sub_f32 v53, v53, v77
    v_sub_f32 v54, v54, v78
    v_sub_f32 v55, v55, v79
    v_sub_f32 v56, v56, v80
    v_sub_f32 v57, v57, v81
    v_sub_f32 v58, v58, v82
    v_sub_f32 v59, v59, v83
    v_cvt_pk_bf16_f32 v48, 0, v48
    v_cvt_pk_bf16_f32 v49, 0, v49
    v_cvt_pk_bf16_f32 v50, 0, v50
    v_cvt_pk_bf16_f32 v51, 0, v51
    v_cvt_pk_bf16_f32 v52, 0, v52
    v_cvt_pk_bf16_f32 v53, 0, v53
    v_cvt_pk_bf16_f32 v54, 0, v54
    v_cvt_pk_bf16_f32 v55, 0, v55
    v_cvt_pk_bf16_f32 v56, 0, v56
    v_cvt_pk_bf16_f32 v57, 0, v57
    v_cvt_pk_bf16_f32 v58, 0, v58
    v_cvt_pk_bf16_f32 v59, 0, v59
    v_mul_f32 v48, v48, v96
    v_mul_f32 v49, v49, v97
    v_mul_f32 v50, v50, v98
    v_mul_f32 v51, v51, v99
    v_mul_f32 v52, v52, v100
    v_mul_f32 v53, v53, v101
    v_mul_f32 v54, v54, v102
    v_mul_f32 v55, v55, v103
    v_mul_f32 v56, v56, v104
    v_mul_f32 v57, v57, v105
    v_mul_f32 v58, v58, v106
    v_mul_f32 v59, v59, v107
    v_cvt_pk_bf16_f32 v138, v48, v49
    v_cvt_pk_bf16_f32 v139, v50, v51
    v_add_f32_dpp v3, v147, v146 row_ror:12 row_mask:0xf bank_mask:0xf
    v_cvt_pk_bf16_f32 v140, v52, v53
    v_cvt_pk_bf16_f32 v141, v54, v55
    v_add_f32_dpp v3, v144, v3 row_ror:8 row_mask:0xf bank_mask:0xf
    v_cvt_pk_bf16_f32 v142, v56, v57
    v_cvt_pk_bf16_f32 v143, v58, v59
    v_add_f32_dpp v15, v145, v3 row_ror:4 row_mask:0xf bank_mask:0x4
    v_mfma_f32_16x16x16_bf16 v[148:151], v[138:139], v[164:165], 0
    v_mfma_f32_16x16x16_bf16 v[148:151], v[140:141], v[166:167], v[148:151]
    v_mfma_f32_16x16x16_bf16 v[148:151], v[142:143], v[168:169], v[148:151]
    v_add_u32 v33, s63, v23
    v_add_u32 v34, s63, v24
    ds_read_b64 v[108:109], v33 offset:0
    ds_read_b64 v[110:111], v33 offset:1536
    ds_read_b64 v[112:113], v33 offset:128
    ds_read_b64 v[114:115], v33 offset:1664
    ds_read_b64 v[116:117], v33 offset:256
    ds_read_b64 v[118:119], v33 offset:1792
    ds_read_b64 v[120:121], v34 offset:0
    v_add_f32_dpp v4, v151, v150 row_ror:12 row_mask:0xf bank_mask:0xf
    ds_read_b64 v[122:123], v34 offset:1536
    ds_read_b64 v[124:125], v34 offset:128
    v_add_f32_dpp v4, v148, v4 row_ror:8 row_mask:0xf bank_mask:0xf
    ds_read_b64 v[126:127], v34 offset:1664
    ds_read_b64 v[128:129], v34 offset:256
    ds_read_b64 v[130:131], v34 offset:1792
    v_add_f32_dpp v16, v149, v4 row_ror:4 row_mask:0xf bank_mask:0x4
    s_waitcnt lgkmcnt(0)
    v_lshlrev_b32 v60, 16, v108
    v_and_b32 v61, s66, v108
    v_lshlrev_b32 v62, 16, v109
    v_and_b32 v63, s66, v109
    v_lshlrev_b32 v84, 16, v110
    v_and_b32 v85, s66, v110
    v_lshlrev_b32 v86, 16, v111
    v_and_b32 v87, s66, v111
    v_lshlrev_b32 v64, 16, v112
    v_and_b32 v65, s66, v112
    v_lshlrev_b32 v66, 16, v113
    v_and_b32 v67, s66, v113
    v_lshlrev_b32 v88, 16, v114
    v_and_b32 v89, s66, v114
    v_lshlrev_b32 v90, 16, v115
    v_and_b32 v91, s66, v115
    v_lshlrev_b32 v68, 16, v116
    v_and_b32 v69, s66, v116
    v_lshlrev_b32 v70, 16, v117
    v_and_b32 v71, s66, v117
    v_lshlrev_b32 v92, 16, v118
    v_and_b32 v93, s66, v118
    v_lshlrev_b32 v94, 16, v119
    v_and_b32 v95, s66, v119
    v_lshlrev_b32 v72, 16, v120
    v_and_b32 v73, s66, v120
    v_lshlrev_b32 v74, 16, v121
    v_and_b32 v75, s66, v121
    v_lshlrev_b32 v96, 16, v122
    v_and_b32 v97, s66, v122
    v_lshlrev_b32 v98, 16, v123
    v_and_b32 v99, s66, v123
    v_lshlrev_b32 v76, 16, v124
    v_and_b32 v77, s66, v124
    v_lshlrev_b32 v78, 16, v125
    v_and_b32 v79, s66, v125
    v_lshlrev_b32 v100, 16, v126
    v_and_b32 v101, s66, v126
    v_lshlrev_b32 v102, 16, v127
    v_and_b32 v103, s66, v127
    v_lshlrev_b32 v80, 16, v128
    v_and_b32 v81, s66, v128
    v_lshlrev_b32 v82, 16, v129
    v_and_b32 v83, s66, v129
    v_lshlrev_b32 v104, 16, v130
    v_and_b32 v105, s66, v130
    v_lshlrev_b32 v106, 16, v131
    v_and_b32 v107, s66, v131
    v_add_u32 v13, s62, v12
    s_add_u32 s62, s62, 24576
    s_cmp_eq_u32 s62, 73728
    s_cselect_b32 s62, 0, s62
    s_barrier
    ds_read_b128 v[36:39], v13 offset:0
    ds_read_b128 v[40:43], v13 offset:256
    ds_read_b128 v[44:47], v13 offset:512
    ds_read_b128 v[48:51], v13 offset:1536
    ds_read_b128 v[52:55], v13 offset:1792
    ds_read_b128 v[56:59], v13 offset:2048
    s_waitcnt lgkmcnt(3)
    v_cvt_f32_i32 v36, v36
    v_cvt_f32_i32 v37, v37
    v_cvt_f32_i32 v38, v38
    v_cvt_f32_i32 v39, v39
    v_cvt_f32_i32 v40, v40
    v_cvt_f32_i32 v41, v41
    v_cvt_f32_i32 v42, v42
    v_cvt_f32_i32 v43, v43
    v_cvt_f32_i32 v44, v44
    v_cvt_f32_i32 v45, v45
    v_cvt_f32_i32 v46, v46
    v_cvt_f32_i32 v47, v47
    v_sub_f32 v36, v36, v60
    v_sub_f32 v37, v37, v61
    v_sub_f32 v38, v38, v62
    v_sub_f32 v39, v39, v63
    v_sub_f32 v40, v40, v64
    v_sub_f32 v41, v41, v65
    v_sub_f32 v42, v42, v66
    v_sub_f32 v43, v43, v67
    v_sub_f32 v44, v44, v68
    v_sub_f32 v45, v45, v69
    v_sub_f32 v46, v46, v70
    v_sub_f32 v47, v47, v71
    v_cvt_pk_bf16_f32 v36, 0, v36
    v_cvt_pk_bf16_f32 v37, 0, v37
    v_cvt_pk_bf16_f32 v38, 0, v38
    v_cvt_pk_bf16_f32 v39, 0, v39
    v_cvt_pk_bf16_f32 v40, 0, v40
    v_cvt_pk_bf16_f32 v41, 0, v41
    v_cvt_pk_bf16_f32 v42, 0, v42
    v_cvt_pk_bf16_f32 v43, 0, v43
    v_cvt_pk_bf16_f32 v44, 0, v44
    v_cvt_pk_bf16_f32 v45, 0, v45
    v_cvt_pk_bf16_f32 v46, 0, v46
    v_cvt_pk_bf16_f32 v47, 0, v47
    v_mul_f32 v36, v36, v84
    v_mul_f32 v37, v37, v85
    v_mul_f32 v38, v38, v86
    v_mul_f32 v39, v39, v87
    v_mul_f32 v40, v40, v88
    v_mul_f32 v41, v41, v89
    v_mul_f32 v42, v42, v90
    v_mul_f32 v43, v43, v91
    v_mul_f32 v44, v44, v92
    v_mul_f32 v45, v45, v93
    v_mul_f32 v46, v46, v94
    v_mul_f32 v47, v47, v95
    v_cvt_pk_bf16_f32 v132, v36, v37
    v_cvt_pk_bf16_f32 v133, v38, v39
    v_cvt_pk_bf16_f32 v134, v40, v41
    v_cvt_pk_bf16_f32 v135, v42, v43
    v_cvt_pk_bf16_f32 v136, v44, v45
    v_cvt_pk_bf16_f32 v137, v46, v47
    v_mfma_f32_16x16x16_bf16 v[144:147], v[132:133], v[164:165], 0
    v_mfma_f32_16x16x16_bf16 v[144:147], v[134:135], v[166:167], v[144:147]
    v_mfma_f32_16x16x16_bf16 v[144:147], v[136:137], v[168:169], v[144:147]
    s_waitcnt lgkmcnt(0)
    v_cvt_f32_i32 v48, v48
    v_cvt_f32_i32 v49, v49
    v_cvt_f32_i32 v50, v50
    v_cvt_f32_i32 v51, v51
    v_cvt_f32_i32 v52, v52
    v_cvt_f32_i32 v53, v53
    v_cvt_f32_i32 v54, v54
    v_cvt_f32_i32 v55, v55
    v_cvt_f32_i32 v56, v56
    v_cvt_f32_i32 v57, v57
    v_cvt_f32_i32 v58, v58
    v_cvt_f32_i32 v59, v59
    v_sub_f32 v48, v48, v72
    v_sub_f32 v49, v49, v73
    v_sub_f32 v50, v50, v74
    v_sub_f32 v51, v51, v75
    v_sub_f32 v52, v52, v76
    v_sub_f32 v53, v53, v77
    v_sub_f32 v54, v54, v78
    v_sub_f32 v55, v55, v79
    v_sub_f32 v56, v56, v80
    v_sub_f32 v57, v57, v81
    v_sub_f32 v58, v58, v82
    v_sub_f32 v59, v59, v83
    v_cvt_pk_bf16_f32 v48, 0, v48
    v_cvt_pk_bf16_f32 v49, 0, v49
    v_cvt_pk_bf16_f32 v50, 0, v50
    v_cvt_pk_bf16_f32 v51, 0, v51
    v_cvt_pk_bf16_f32 v52, 0, v52
    v_cvt_pk_bf16_f32 v53, 0, v53
    v_cvt_pk_bf16_f32 v54, 0, v54
    v_cvt_pk_bf16_f32 v55, 0, v55
    v_cvt_pk_bf16_f32 v56, 0, v56
    v_cvt_pk_bf16_f32 v57, 0, v57
    v_cvt_pk_bf16_f32 v58, 0, v58
    v_cvt_pk_bf16_f32 v59, 0, v59
    v_mul_f32 v48, v48, v96
    v_mul_f32 v49, v49, v97
    v_mul_f32 v50, v50, v98
    v_mul_f32 v51, v51, v99
    v_mul_f32 v52, v52, v100
    v_mul_f32 v53, v53, v101
    v_mul_f32 v54, v54, v102
    v_mul_f32 v55, v55, v103
    v_mul_f32 v56, v56, v104
    v_mul_f32 v57, v57, v105
    v_mul_f32 v58, v58, v106
    v_mul_f32 v59, v59, v107
    v_cvt_pk_bf16_f32 v138, v48, v49
    v_cvt_pk_bf16_f32 v139, v50, v51
    v_add_f32_dpp v3, v144, v147 row_ror:12 row_mask:0xf bank_mask:0xf
    v_cvt_pk_bf16_f32 v140, v52, v53
    v_cvt_pk_bf16_f32 v141, v54, v55
    v_add_f32_dpp v3, v145, v3 row_ror:8 row_mask:0xf bank_mask:0xf
    v_cvt_pk_bf16_f32 v142, v56, v57
    v_cvt_pk_bf16_f32 v143, v58, v59
    v_add_f32_dpp v15, v146, v3 row_ror:4 row_mask:0xf bank_mask:0x8
    v_mfma_f32_16x16x16_bf16 v[148:151], v[138:139], v[164:165], 0
    v_mfma_f32_16x16x16_bf16 v[148:151], v[140:141], v[166:167], v[148:151]
    v_mfma_f32_16x16x16_bf16 v[148:151], v[142:143], v[168:169], v[148:151]
    v_add_u32 v33, s63, v25
    v_add_u32 v34, s63, v26
    ds_read_b64 v[108:109], v33 offset:0
    ds_read_b64 v[110:111], v33 offset:1536
    ds_read_b64 v[112:113], v33 offset:128
    ds_read_b64 v[114:115], v33 offset:1664
    ds_read_b64 v[116:117], v33 offset:256
    ds_read_b64 v[118:119], v33 offset:1792
    ds_read_b64 v[120:121], v34 offset:0
    v_add_f32_dpp v4, v148, v151 row_ror:12 row_mask:0xf bank_mask:0xf
    ds_read_b64 v[122:123], v34 offset:1536
    ds_read_b64 v[124:125], v34 offset:128
    v_add_f32_dpp v4, v149, v4 row_ror:8 row_mask:0xf bank_mask:0xf
    ds_read_b64 v[126:127], v34 offset:1664
    ds_read_b64 v[128:129], v34 offset:256
    ds_read_b64 v[130:131], v34 offset:1792
    v_add_f32_dpp v16, v150, v4 row_ror:4 row_mask:0xf bank_mask:0x8
    v_cvt_pk_bf16_f32 v3, 0, v15
    v_cvt_pk_bf16_f32 v4, 0, v16
    v_mul_f32 v3, s65, v3
    v_mul_f32 v4, s65, v4
    v_cvt_pk_bf16_f32 v5, v3, v4
    v_max3_f32 v14, v14, v3, v4
    ds_write_b32 v11, v5 offset:0
    s_waitcnt lgkmcnt(0)
    v_lshlrev_b32 v60, 16, v108
    v_and_b32 v61, s66, v108
    v_lshlrev_b32 v62, 16, v109
    v_and_b32 v63, s66, v109
    v_lshlrev_b32 v84, 16, v110
    v_and_b32 v85, s66, v110
    v_lshlrev_b32 v86, 16, v111
    v_and_b32 v87, s66, v111
    v_lshlrev_b32 v64, 16, v112
    v_and_b32 v65, s66, v112
    v_lshlrev_b32 v66, 16, v113
    v_and_b32 v67, s66, v113
    v_lshlrev_b32 v88, 16, v114
    v_and_b32 v89, s66, v114
    v_lshlrev_b32 v90, 16, v115
    v_and_b32 v91, s66, v115
    v_lshlrev_b32 v68, 16, v116
    v_and_b32 v69, s66, v116
    v_lshlrev_b32 v70, 16, v117
    v_and_b32 v71, s66, v117
    v_lshlrev_b32 v92, 16, v118
    v_and_b32 v93, s66, v118
    v_lshlrev_b32 v94, 16, v119
    v_and_b32 v95, s66, v119
    v_lshlrev_b32 v72, 16, v120
    v_and_b32 v73, s66, v120
    v_lshlrev_b32 v74, 16, v121
    v_and_b32 v75, s66, v121
    v_lshlrev_b32 v96, 16, v122
    v_and_b32 v97, s66, v122
    v_lshlrev_b32 v98, 16, v123
    v_and_b32 v99, s66, v123
    v_lshlrev_b32 v76, 16, v124
    v_and_b32 v77, s66, v124
    v_lshlrev_b32 v78, 16, v125
    v_and_b32 v79, s66, v125
    v_lshlrev_b32 v100, 16, v126
    v_and_b32 v101, s66, v126
    v_lshlrev_b32 v102, 16, v127
    v_and_b32 v103, s66, v127
    v_lshlrev_b32 v80, 16, v128
    v_and_b32 v81, s66, v128
    v_lshlrev_b32 v82, 16, v129
    v_and_b32 v83, s66, v129
    v_lshlrev_b32 v104, 16, v130
    v_and_b32 v105, s66, v130
    v_lshlrev_b32 v106, 16, v131
    v_and_b32 v107, s66, v131
    v_add_u32 v13, s62, v12
    s_add_u32 s62, s62, 24576
    s_cmp_eq_u32 s62, 73728
    s_cselect_b32 s62, 0, s62
    s_barrier
    ds_read_b128 v[36:39], v13 offset:0
    ds_read_b128 v[40:43], v13 offset:256
    ds_read_b128 v[44:47], v13 offset:512
    ds_read_b128 v[48:51], v13 offset:1536
    ds_read_b128 v[52:55], v13 offset:1792
    ds_read_b128 v[56:59], v13 offset:2048
    s_waitcnt lgkmcnt(3)
    v_cvt_f32_i32 v36, v36
    v_cvt_f32_i32 v37, v37
    v_cvt_f32_i32 v38, v38
    v_cvt_f32_i32 v39, v39
    v_cvt_f32_i32 v40, v40
    v_cvt_f32_i32 v41, v41
    v_cvt_f32_i32 v42, v42
    v_cvt_f32_i32 v43, v43
    v_cvt_f32_i32 v44, v44
    v_cvt_f32_i32 v45, v45
    v_cvt_f32_i32 v46, v46
    v_cvt_f32_i32 v47, v47
    v_sub_f32 v36, v36, v60
    v_sub_f32 v37, v37, v61
    v_sub_f32 v38, v38, v62
    v_sub_f32 v39, v39, v63
    v_sub_f32 v40, v40, v64
    v_sub_f32 v41, v41, v65
    v_sub_f32 v42, v42, v66
    v_sub_f32 v43, v43, v67
    v_sub_f32 v44, v44, v68
    v_sub_f32 v45, v45, v69
    v_sub_f32 v46, v46, v70
    v_sub_f32 v47, v47, v71
    v_cvt_pk_bf16_f32 v36, 0, v36
    v_cvt_pk_bf16_f32 v37, 0, v37
    v_cvt_pk_bf16_f32 v38, 0, v38
    v_cvt_pk_bf16_f32 v39, 0, v39
    v_cvt_pk_bf16_f32 v40, 0, v40
    v_cvt_pk_bf16_f32 v41, 0, v41
    v_cvt_pk_bf16_f32 v42, 0, v42
    v_cvt_pk_bf16_f32 v43, 0, v43
    v_cvt_pk_bf16_f32 v44, 0, v44
    v_cvt_pk_bf16_f32 v45, 0, v45
    v_cvt_pk_bf16_f32 v46, 0, v46
    v_cvt_pk_bf16_f32 v47, 0, v47
    v_mul_f32 v36, v36, v84
    v_mul_f32 v37, v37, v85
    v_mul_f32 v38, v38, v86
    v_mul_f32 v39, v39, v87
    v_mul_f32 v40, v40, v88
    v_mul_f32 v41, v41, v89
    v_mul_f32 v42, v42, v90
    v_mul_f32 v43, v43, v91
    v_mul_f32 v44, v44, v92
    v_mul_f32 v45, v45, v93
    v_mul_f32 v46, v46, v94
    v_mul_f32 v47, v47, v95
    v_cvt_pk_bf16_f32 v132, v36, v37
    v_cvt_pk_bf16_f32 v133, v38, v39
    v_cvt_pk_bf16_f32 v134, v40, v41
    v_cvt_pk_bf16_f32 v135, v42, v43
    v_cvt_pk_bf16_f32 v136, v44, v45
    v_cvt_pk_bf16_f32 v137, v46, v47
    v_mfma_f32_16x16x16_bf16 v[144:147], v[132:133], v[164:165], 0
    v_mfma_f32_16x16x16_bf16 v[144:147], v[134:135], v[166:167], v[144:147]
    v_mfma_f32_16x16x16_bf16 v[144:147], v[136:137], v[168:169], v[144:147]
    s_waitcnt lgkmcnt(0)
    v_cvt_f32_i32 v48, v48
    v_cvt_f32_i32 v49, v49
    v_cvt_f32_i32 v50, v50
    v_cvt_f32_i32 v51, v51
    v_cvt_f32_i32 v52, v52
    v_cvt_f32_i32 v53, v53
    v_cvt_f32_i32 v54, v54
    v_cvt_f32_i32 v55, v55
    v_cvt_f32_i32 v56, v56
    v_cvt_f32_i32 v57, v57
    v_cvt_f32_i32 v58, v58
    v_cvt_f32_i32 v59, v59
    v_sub_f32 v48, v48, v72
    v_sub_f32 v49, v49, v73
    v_sub_f32 v50, v50, v74
    v_sub_f32 v51, v51, v75
    v_sub_f32 v52, v52, v76
    v_sub_f32 v53, v53, v77
    v_sub_f32 v54, v54, v78
    v_sub_f32 v55, v55, v79
    v_sub_f32 v56, v56, v80
    v_sub_f32 v57, v57, v81
    v_sub_f32 v58, v58, v82
    v_sub_f32 v59, v59, v83
    v_cvt_pk_bf16_f32 v48, 0, v48
    v_cvt_pk_bf16_f32 v49, 0, v49
    v_cvt_pk_bf16_f32 v50, 0, v50
    v_cvt_pk_bf16_f32 v51, 0, v51
    v_cvt_pk_bf16_f32 v52, 0, v52
    v_cvt_pk_bf16_f32 v53, 0, v53
    v_cvt_pk_bf16_f32 v54, 0, v54
    v_cvt_pk_bf16_f32 v55, 0, v55
    v_cvt_pk_bf16_f32 v56, 0, v56
    v_cvt_pk_bf16_f32 v57, 0, v57
    v_cvt_pk_bf16_f32 v58, 0, v58
    v_cvt_pk_bf16_f32 v59, 0, v59
    v_mul_f32 v48, v48, v96
    v_mul_f32 v49, v49, v97
    v_mul_f32 v50, v50, v98
    v_mul_f32 v51, v51, v99
    v_mul_f32 v52, v52, v100
    v_mul_f32 v53, v53, v101
    v_mul_f32 v54, v54, v102
    v_mul_f32 v55, v55, v103
    v_mul_f32 v56, v56, v104
    v_mul_f32 v57, v57, v105
    v_mul_f32 v58, v58, v106
    v_mul_f32 v59, v59, v107
    v_cvt_pk_bf16_f32 v138, v48, v49
    v_cvt_pk_bf16_f32 v139, v50, v51
    v_add_f32_dpp v3, v145, v144 row_ror:12 row_mask:0xf bank_mask:0xf
    v_cvt_pk_bf16_f32 v140, v52, v53
    v_cvt_pk_bf16_f32 v141, v54, v55
    v_add_f32_dpp v3, v146, v3 row_ror:8 row_mask:0xf bank_mask:0xf
    v_cvt_pk_bf16_f32 v142, v56, v57
    v_cvt_pk_bf16_f32 v143, v58, v59
    v_add_f32_dpp v15, v147, v3 row_ror:4 row_mask:0xf bank_mask:0x1
    v_mfma_f32_16x16x16_bf16 v[148:151], v[138:139], v[164:165], 0
    v_mfma_f32_16x16x16_bf16 v[148:151], v[140:141], v[166:167], v[148:151]
    v_mfma_f32_16x16x16_bf16 v[148:151], v[142:143], v[168:169], v[148:151]
    v_add_u32 v33, s63, v27
    v_add_u32 v34, s63, v28
    ds_read_b64 v[108:109], v33 offset:0
    ds_read_b64 v[110:111], v33 offset:1536
    ds_read_b64 v[112:113], v33 offset:128
    ds_read_b64 v[114:115], v33 offset:1664
    ds_read_b64 v[116:117], v33 offset:256
    ds_read_b64 v[118:119], v33 offset:1792
    ds_read_b64 v[120:121], v34 offset:0
    v_add_f32_dpp v4, v149, v148 row_ror:12 row_mask:0xf bank_mask:0xf
    ds_read_b64 v[122:123], v34 offset:1536
    ds_read_b64 v[124:125], v34 offset:128
    v_add_f32_dpp v4, v150, v4 row_ror:8 row_mask:0xf bank_mask:0xf
    ds_read_b64 v[126:127], v34 offset:1664
    ds_read_b64 v[128:129], v34 offset:256
    ds_read_b64 v[130:131], v34 offset:1792
    v_add_f32_dpp v16, v151, v4 row_ror:4 row_mask:0xf bank_mask:0x1
    s_waitcnt lgkmcnt(0)
    v_lshlrev_b32 v60, 16, v108
    v_and_b32 v61, s66, v108
    v_lshlrev_b32 v62, 16, v109
    v_and_b32 v63, s66, v109
    v_lshlrev_b32 v84, 16, v110
    v_and_b32 v85, s66, v110
    v_lshlrev_b32 v86, 16, v111
    v_and_b32 v87, s66, v111
    v_lshlrev_b32 v64, 16, v112
    v_and_b32 v65, s66, v112
    v_lshlrev_b32 v66, 16, v113
    v_and_b32 v67, s66, v113
    v_lshlrev_b32 v88, 16, v114
    v_and_b32 v89, s66, v114
    v_lshlrev_b32 v90, 16, v115
    v_and_b32 v91, s66, v115
    v_lshlrev_b32 v68, 16, v116
    v_and_b32 v69, s66, v116
    v_lshlrev_b32 v70, 16, v117
    v_and_b32 v71, s66, v117
    v_lshlrev_b32 v92, 16, v118
    v_and_b32 v93, s66, v118
    v_lshlrev_b32 v94, 16, v119
    v_and_b32 v95, s66, v119
    v_lshlrev_b32 v72, 16, v120
    v_and_b32 v73, s66, v120
    v_lshlrev_b32 v74, 16, v121
    v_and_b32 v75, s66, v121
    v_lshlrev_b32 v96, 16, v122
    v_and_b32 v97, s66, v122
    v_lshlrev_b32 v98, 16, v123
    v_and_b32 v99, s66, v123
    v_lshlrev_b32 v76, 16, v124
    v_and_b32 v77, s66, v124
    v_lshlrev_b32 v78, 16, v125
    v_and_b32 v79, s66, v125
    v_lshlrev_b32 v100, 16, v126
    v_and_b32 v101, s66, v126
    v_lshlrev_b32 v102, 16, v127
    v_and_b32 v103, s66, v127
    v_lshlrev_b32 v80, 16, v128
    v_and_b32 v81, s66, v128
    v_lshlrev_b32 v82, 16, v129
    v_and_b32 v83, s66, v129
    v_lshlrev_b32 v104, 16, v130
    v_and_b32 v105, s66, v130
    v_lshlrev_b32 v106, 16, v131
    v_and_b32 v107, s66, v131
    v_add_u32 v13, s62, v12
    s_add_u32 s62, s62, 24576
    s_cmp_eq_u32 s62, 73728
    s_cselect_b32 s62, 0, s62
    s_barrier
    ds_read_b128 v[36:39], v13 offset:0
    ds_read_b128 v[40:43], v13 offset:256
    ds_read_b128 v[44:47], v13 offset:512
    ds_read_b128 v[48:51], v13 offset:1536
    ds_read_b128 v[52:55], v13 offset:1792
    ds_read_b128 v[56:59], v13 offset:2048
    s_waitcnt lgkmcnt(3)
    v_cvt_f32_i32 v36, v36
    v_cvt_f32_i32 v37, v37
    v_cvt_f32_i32 v38, v38
    v_cvt_f32_i32 v39, v39
    v_cvt_f32_i32 v40, v40
    v_cvt_f32_i32 v41, v41
    v_cvt_f32_i32 v42, v42
    v_cvt_f32_i32 v43, v43
    v_cvt_f32_i32 v44, v44
    v_cvt_f32_i32 v45, v45
    v_cvt_f32_i32 v46, v46
    v_cvt_f32_i32 v47, v47
    v_sub_f32 v36, v36, v60
    v_sub_f32 v37, v37, v61
    v_sub_f32 v38, v38, v62
    v_sub_f32 v39, v39, v63
    v_sub_f32 v40, v40, v64
    v_sub_f32 v41, v41, v65
    v_sub_f32 v42, v42, v66
    v_sub_f32 v43, v43, v67
    v_sub_f32 v44, v44, v68
    v_sub_f32 v45, v45, v69
    v_sub_f32 v46, v46, v70
    v_sub_f32 v47, v47, v71
    v_cvt_pk_bf16_f32 v36, 0, v36
    v_cvt_pk_bf16_f32 v37, 0, v37
    v_cvt_pk_bf16_f32 v38, 0, v38
    v_cvt_pk_bf16_f32 v39, 0, v39
    v_cvt_pk_bf16_f32 v40, 0, v40
    v_cvt_pk_bf16_f32 v41, 0, v41
    v_cvt_pk_bf16_f32 v42, 0, v42
    v_cvt_pk_bf16_f32 v43, 0, v43
    v_cvt_pk_bf16_f32 v44, 0, v44
    v_cvt_pk_bf16_f32 v45, 0, v45
    v_cvt_pk_bf16_f32 v46, 0, v46
    v_cvt_pk_bf16_f32 v47, 0, v47
    v_mul_f32 v36, v36, v84
    v_mul_f32 v37, v37, v85
    v_mul_f32 v38, v38, v86
    v_mul_f32 v39, v39, v87
    v_mul_f32 v40, v40, v88
    v_mul_f32 v41, v41, v89
    v_mul_f32 v42, v42, v90
    v_mul_f32 v43, v43, v91
    v_mul_f32 v44, v44, v92
    v_mul_f32 v45, v45, v93
    v_mul_f32 v46, v46, v94
    v_mul_f32 v47, v47, v95
    v_cvt_pk_bf16_f32 v132, v36, v37
    v_cvt_pk_bf16_f32 v133, v38, v39
    v_cvt_pk_bf16_f32 v134, v40, v41
    v_cvt_pk_bf16_f32 v135, v42, v43
    v_cvt_pk_bf16_f32 v136, v44, v45
    v_cvt_pk_bf16_f32 v137, v46, v47
    v_mfma_f32_16x16x16_bf16 v[144:147], v[132:133], v[164:165], 0
    v_mfma_f32_16x16x16_bf16 v[144:147], v[134:135], v[166:167], v[144:147]
    v_mfma_f32_16x16x16_bf16 v[144:147], v[136:137], v[168:169], v[144:147]
    s_waitcnt lgkmcnt(0)
    v_cvt_f32_i32 v48, v48
    v_cvt_f32_i32 v49, v49
    v_cvt_f32_i32 v50, v50
    v_cvt_f32_i32 v51, v51
    v_cvt_f32_i32 v52, v52
    v_cvt_f32_i32 v53, v53
    v_cvt_f32_i32 v54, v54
    v_cvt_f32_i32 v55, v55
    v_cvt_f32_i32 v56, v56
    v_cvt_f32_i32 v57, v57
    v_cvt_f32_i32 v58, v58
    v_cvt_f32_i32 v59, v59
    v_sub_f32 v48, v48, v72
    v_sub_f32 v49, v49, v73
    v_sub_f32 v50, v50, v74
    v_sub_f32 v51, v51, v75
    v_sub_f32 v52, v52, v76
    v_sub_f32 v53, v53, v77
    v_sub_f32 v54, v54, v78
    v_sub_f32 v55, v55, v79
    v_sub_f32 v56, v56, v80
    v_sub_f32 v57, v57, v81
    v_sub_f32 v58, v58, v82
    v_sub_f32 v59, v59, v83
    v_cvt_pk_bf16_f32 v48, 0, v48
    v_cvt_pk_bf16_f32 v49, 0, v49
    v_cvt_pk_bf16_f32 v50, 0, v50
    v_cvt_pk_bf16_f32 v51, 0, v51
    v_cvt_pk_bf16_f32 v52, 0, v52
    v_cvt_pk_bf16_f32 v53, 0, v53
    v_cvt_pk_bf16_f32 v54, 0, v54
    v_cvt_pk_bf16_f32 v55, 0, v55
    v_cvt_pk_bf16_f32 v56, 0, v56
    v_cvt_pk_bf16_f32 v57, 0, v57
    v_cvt_pk_bf16_f32 v58, 0, v58
    v_cvt_pk_bf16_f32 v59, 0, v59
    v_mul_f32 v48, v48, v96
    v_mul_f32 v49, v49, v97
    v_mul_f32 v50, v50, v98
    v_mul_f32 v51, v51, v99
    v_mul_f32 v52, v52, v100
    v_mul_f32 v53, v53, v101
    v_mul_f32 v54, v54, v102
    v_mul_f32 v55, v55, v103
    v_mul_f32 v56, v56, v104
    v_mul_f32 v57, v57, v105
    v_mul_f32 v58, v58, v106
    v_mul_f32 v59, v59, v107
    v_cvt_pk_bf16_f32 v138, v48, v49
    v_cvt_pk_bf16_f32 v139, v50, v51
    v_add_f32_dpp v3, v146, v145 row_ror:12 row_mask:0xf bank_mask:0xf
    v_cvt_pk_bf16_f32 v140, v52, v53
    v_cvt_pk_bf16_f32 v141, v54, v55
    v_add_f32_dpp v3, v147, v3 row_ror:8 row_mask:0xf bank_mask:0xf
    v_cvt_pk_bf16_f32 v142, v56, v57
    v_cvt_pk_bf16_f32 v143, v58, v59
    v_add_f32_dpp v15, v144, v3 row_ror:4 row_mask:0xf bank_mask:0x2
    v_mfma_f32_16x16x16_bf16 v[148:151], v[138:139], v[164:165], 0
    v_mfma_f32_16x16x16_bf16 v[148:151], v[140:141], v[166:167], v[148:151]
    v_mfma_f32_16x16x16_bf16 v[148:151], v[142:143], v[168:169], v[148:151]
    v_add_u32 v33, s63, v29
    v_add_u32 v34, s63, v30
    ds_read_b64 v[108:109], v33 offset:0
    ds_read_b64 v[110:111], v33 offset:1536
    ds_read_b64 v[112:113], v33 offset:128
    ds_read_b64 v[114:115], v33 offset:1664
    ds_read_b64 v[116:117], v33 offset:256
    ds_read_b64 v[118:119], v33 offset:1792
    ds_read_b64 v[120:121], v34 offset:0
    v_add_f32_dpp v4, v150, v149 row_ror:12 row_mask:0xf bank_mask:0xf
    ds_read_b64 v[122:123], v34 offset:1536
    ds_read_b64 v[124:125], v34 offset:128
    v_add_f32_dpp v4, v151, v4 row_ror:8 row_mask:0xf bank_mask:0xf
    ds_read_b64 v[126:127], v34 offset:1664
    ds_read_b64 v[128:129], v34 offset:256
    ds_read_b64 v[130:131], v34 offset:1792
    v_add_f32_dpp v16, v148, v4 row_ror:4 row_mask:0xf bank_mask:0x2
    s_waitcnt lgkmcnt(0)
    v_lshlrev_b32 v60, 16, v108
    v_and_b32 v61, s66, v108
    v_lshlrev_b32 v62, 16, v109
    v_and_b32 v63, s66, v109
    v_lshlrev_b32 v84, 16, v110
    v_and_b32 v85, s66, v110
    v_lshlrev_b32 v86, 16, v111
    v_and_b32 v87, s66, v111
    v_lshlrev_b32 v64, 16, v112
    v_and_b32 v65, s66, v112
    v_lshlrev_b32 v66, 16, v113
    v_and_b32 v67, s66, v113
    v_lshlrev_b32 v88, 16, v114
    v_and_b32 v89, s66, v114
    v_lshlrev_b32 v90, 16, v115
    v_and_b32 v91, s66, v115
    v_lshlrev_b32 v68, 16, v116
    v_and_b32 v69, s66, v116
    v_lshlrev_b32 v70, 16, v117
    v_and_b32 v71, s66, v117
    v_lshlrev_b32 v92, 16, v118
    v_and_b32 v93, s66, v118
    v_lshlrev_b32 v94, 16, v119
    v_and_b32 v95, s66, v119
    v_lshlrev_b32 v72, 16, v120
    v_and_b32 v73, s66, v120
    v_lshlrev_b32 v74, 16, v121
    v_and_b32 v75, s66, v121
    v_lshlrev_b32 v96, 16, v122
    v_and_b32 v97, s66, v122
    v_lshlrev_b32 v98, 16, v123
    v_and_b32 v99, s66, v123
    v_lshlrev_b32 v76, 16, v124
    v_and_b32 v77, s66, v124
    v_lshlrev_b32 v78, 16, v125
    v_and_b32 v79, s66, v125
    v_lshlrev_b32 v100, 16, v126
    v_and_b32 v101, s66, v126
    v_lshlrev_b32 v102, 16, v127
    v_and_b32 v103, s66, v127
    v_lshlrev_b32 v80, 16, v128
    v_and_b32 v81, s66, v128
    v_lshlrev_b32 v82, 16, v129
    v_and_b32 v83, s66, v129
    v_lshlrev_b32 v104, 16, v130
    v_and_b32 v105, s66, v130
    v_lshlrev_b32 v106, 16, v131
    v_and_b32 v107, s66, v131
    v_add_u32 v13, s62, v12
    s_add_u32 s62, s62, 24576
    s_cmp_eq_u32 s62, 73728
    s_cselect_b32 s62, 0, s62
    s_barrier
    ds_read_b128 v[36:39], v13 offset:0
    ds_read_b128 v[40:43], v13 offset:256
    ds_read_b128 v[44:47], v13 offset:512
    ds_read_b128 v[48:51], v13 offset:1536
    ds_read_b128 v[52:55], v13 offset:1792
    ds_read_b128 v[56:59], v13 offset:2048
    s_waitcnt lgkmcnt(3)
    v_cvt_f32_i32 v36, v36
    v_cvt_f32_i32 v37, v37
    v_cvt_f32_i32 v38, v38
    v_cvt_f32_i32 v39, v39
    v_cvt_f32_i32 v40, v40
    v_cvt_f32_i32 v41, v41
    v_cvt_f32_i32 v42, v42
    v_cvt_f32_i32 v43, v43
    v_cvt_f32_i32 v44, v44
    v_cvt_f32_i32 v45, v45
    v_cvt_f32_i32 v46, v46
    v_cvt_f32_i32 v47, v47
    v_sub_f32 v36, v36, v60
    v_sub_f32 v37, v37, v61
    v_sub_f32 v38, v38, v62
    v_sub_f32 v39, v39, v63
    v_sub_f32 v40, v40, v64
    v_sub_f32 v41, v41, v65
    v_sub_f32 v42, v42, v66
    v_sub_f32 v43, v43, v67
    v_sub_f32 v44, v44, v68
    v_sub_f32 v45, v45, v69
    v_sub_f32 v46, v46, v70
    v_sub_f32 v47, v47, v71
    v_cvt_pk_bf16_f32 v36, 0, v36
    v_cvt_pk_bf16_f32 v37, 0, v37
    v_cvt_pk_bf16_f32 v38, 0, v38
    v_cvt_pk_bf16_f32 v39, 0, v39
    v_cvt_pk_bf16_f32 v40, 0, v40
    v_cvt_pk_bf16_f32 v41, 0, v41
    v_cvt_pk_bf16_f32 v42, 0, v42
    v_cvt_pk_bf16_f32 v43, 0, v43
    v_cvt_pk_bf16_f32 v44, 0, v44
    v_cvt_pk_bf16_f32 v45, 0, v45
    v_cvt_pk_bf16_f32 v46, 0, v46
    v_cvt_pk_bf16_f32 v47, 0, v47
    v_mul_f32 v36, v36, v84
    v_mul_f32 v37, v37, v85
    v_mul_f32 v38, v38, v86
    v_mul_f32 v39, v39, v87
    v_mul_f32 v40, v40, v88
    v_mul_f32 v41, v41, v89
    v_mul_f32 v42, v42, v90
    v_mul_f32 v43, v43, v91
    v_mul_f32 v44, v44, v92
    v_mul_f32 v45, v45, v93
    v_mul_f32 v46, v46, v94
    v_mul_f32 v47, v47, v95
    v_cvt_pk_bf16_f32 v132, v36, v37
    v_cvt_pk_bf16_f32 v133, v38, v39
    v_cvt_pk_bf16_f32 v134, v40, v41
    v_cvt_pk_bf16_f32 v135, v42, v43
    v_cvt_pk_bf16_f32 v136, v44, v45
    v_cvt_pk_bf16_f32 v137, v46, v47
    v_mfma_f32_16x16x16_bf16 v[144:147], v[132:133], v[164:165], 0
    v_mfma_f32_16x16x16_bf16 v[144:147], v[134:135], v[166:167], v[144:147]
    v_mfma_f32_16x16x16_bf16 v[144:147], v[136:137], v[168:169], v[144:147]
    s_waitcnt lgkmcnt(0)
    v_cvt_f32_i32 v48, v48
    v_cvt_f32_i32 v49, v49
    v_cvt_f32_i32 v50, v50
    v_cvt_f32_i32 v51, v51
    v_cvt_f32_i32 v52, v52
    v_cvt_f32_i32 v53, v53
    v_cvt_f32_i32 v54, v54
    v_cvt_f32_i32 v55, v55
    v_cvt_f32_i32 v56, v56
    v_cvt_f32_i32 v57, v57
    v_cvt_f32_i32 v58, v58
    v_cvt_f32_i32 v59, v59
    v_sub_f32 v48, v48, v72
    v_sub_f32 v49, v49, v73
    v_sub_f32 v50, v50, v74
    v_sub_f32 v51, v51, v75
    v_sub_f32 v52, v52, v76
    v_sub_f32 v53, v53, v77
    v_sub_f32 v54, v54, v78
    v_sub_f32 v55, v55, v79
    v_sub_f32 v56, v56, v80
    v_sub_f32 v57, v57, v81
    v_sub_f32 v58, v58, v82
    v_sub_f32 v59, v59, v83
    v_cvt_pk_bf16_f32 v48, 0, v48
    v_cvt_pk_bf16_f32 v49, 0, v49
    v_cvt_pk_bf16_f32 v50, 0, v50
    v_cvt_pk_bf16_f32 v51, 0, v51
    v_cvt_pk_bf16_f32 v52, 0, v52
    v_cvt_pk_bf16_f32 v53, 0, v53
    v_cvt_pk_bf16_f32 v54, 0, v54
    v_cvt_pk_bf16_f32 v55, 0, v55
    v_cvt_pk_bf16_f32 v56, 0, v56
    v_cvt_pk_bf16_f32 v57, 0, v57
    v_cvt_pk_bf16_f32 v58, 0, v58
    v_cvt_pk_bf16_f32 v59, 0, v59
    v_mul_f32 v48, v48, v96
    v_mul_f32 v49, v49, v97
    v_mul_f32 v50, v50, v98
    v_mul_f32 v51, v51, v99
    v_mul_f32 v52, v52, v100
    v_mul_f32 v53, v53, v101
    v_mul_f32 v54, v54, v102
    v_mul_f32 v55, v55, v103
    v_mul_f32 v56, v56, v104
    v_mul_f32 v57, v57, v105
    v_mul_f32 v58, v58, v106
    v_mul_f32 v59, v59, v107
    v_cvt_pk_bf16_f32 v138, v48, v49
    v_cvt_pk_bf16_f32 v139, v50, v51
    v_add_f32_dpp v3, v147, v146 row_ror:12 row_mask:0xf bank_mask:0xf
    v_cvt_pk_bf16_f32 v140, v52, v53
    v_cvt_pk_bf16_f32 v141, v54, v55
    v_add_f32_dpp v3, v144, v3 row_ror:8 row_mask:0xf bank_mask:0xf
    v_cvt_pk_bf16_f32 v142, v56, v57
    v_cvt_pk_bf16_f32 v143, v58, v59
    v_add_f32_dpp v15, v145, v3 row_ror:4 row_mask:0xf bank_mask:0x4
    v_mfma_f32_16x16x16_bf16 v[148:151], v[138:139], v[164:165], 0
    v_mfma_f32_16x16x16_bf16 v[148:151], v[140:141], v[166:167], v[148:151]
    v_mfma_f32_16x16x16_bf16 v[148:151], v[142:143], v[168:169], v[148:151]
    v_add_u32 v33, s63, v31
    v_add_u32 v34, s63, v32
    ds_read_b64 v[108:109], v33 offset:0
    ds_read_b64 v[110:111], v33 offset:1536
    ds_read_b64 v[112:113], v33 offset:128
    ds_read_b64 v[114:115], v33 offset:1664
    ds_read_b64 v[116:117], v33 offset:256
    ds_read_b64 v[118:119], v33 offset:1792
    ds_read_b64 v[120:121], v34 offset:0
    v_add_f32_dpp v4, v151, v150 row_ror:12 row_mask:0xf bank_mask:0xf
    ds_read_b64 v[122:123], v34 offset:1536
    ds_read_b64 v[124:125], v34 offset:128
    v_add_f32_dpp v4, v148, v4 row_ror:8 row_mask:0xf bank_mask:0xf
    ds_read_b64 v[126:127], v34 offset:1664
    ds_read_b64 v[128:129], v34 offset:256
    ds_read_b64 v[130:131], v34 offset:1792
    v_add_f32_dpp v16, v149, v4 row_ror:4 row_mask:0xf bank_mask:0x4
    s_waitcnt lgkmcnt(0)
    v_lshlrev_b32 v60, 16, v108
    v_and_b32 v61, s66, v108
    v_lshlrev_b32 v62, 16, v109
    v_and_b32 v63, s66, v109
    v_lshlrev_b32 v84, 16, v110
    v_and_b32 v85, s66, v110
    v_lshlrev_b32 v86, 16, v111
    v_and_b32 v87, s66, v111
    v_lshlrev_b32 v64, 16, v112
    v_and_b32 v65, s66, v112
    v_lshlrev_b32 v66, 16, v113
    v_and_b32 v67, s66, v113
    v_lshlrev_b32 v88, 16, v114
    v_and_b32 v89, s66, v114
    v_lshlrev_b32 v90, 16, v115
    v_and_b32 v91, s66, v115
    v_lshlrev_b32 v68, 16, v116
    v_and_b32 v69, s66, v116
    v_lshlrev_b32 v70, 16, v117
    v_and_b32 v71, s66, v117
    v_lshlrev_b32 v92, 16, v118
    v_and_b32 v93, s66, v118
    v_lshlrev_b32 v94, 16, v119
    v_and_b32 v95, s66, v119
    v_lshlrev_b32 v72, 16, v120
    v_and_b32 v73, s66, v120
    v_lshlrev_b32 v74, 16, v121
    v_and_b32 v75, s66, v121
    v_lshlrev_b32 v96, 16, v122
    v_and_b32 v97, s66, v122
    v_lshlrev_b32 v98, 16, v123
    v_and_b32 v99, s66, v123
    v_lshlrev_b32 v76, 16, v124
    v_and_b32 v77, s66, v124
    v_lshlrev_b32 v78, 16, v125
    v_and_b32 v79, s66, v125
    v_lshlrev_b32 v100, 16, v126
    v_and_b32 v101, s66, v126
    v_lshlrev_b32 v102, 16, v127
    v_and_b32 v103, s66, v127
    v_lshlrev_b32 v80, 16, v128
    v_and_b32 v81, s66, v128
    v_lshlrev_b32 v82, 16, v129
    v_and_b32 v83, s66, v129
    v_lshlrev_b32 v104, 16, v130
    v_and_b32 v105, s66, v130
    v_lshlrev_b32 v106, 16, v131
    v_and_b32 v107, s66, v131
    v_add_u32 v13, s62, v12
    s_add_u32 s62, s62, 24576
    s_cmp_eq_u32 s62, 73728
    s_cselect_b32 s62, 0, s62
    s_barrier
    ds_read_b128 v[36:39], v13 offset:0
    ds_read_b128 v[40:43], v13 offset:256
    ds_read_b128 v[44:47], v13 offset:512
    ds_read_b128 v[48:51], v13 offset:1536
    ds_read_b128 v[52:55], v13 offset:1792
    ds_read_b128 v[56:59], v13 offset:2048
    s_waitcnt lgkmcnt(3)
    v_cvt_f32_i32 v36, v36
    v_cvt_f32_i32 v37, v37
    v_cvt_f32_i32 v38, v38
    v_cvt_f32_i32 v39, v39
    v_cvt_f32_i32 v40, v40
    v_cvt_f32_i32 v41, v41
    v_cvt_f32_i32 v42, v42
    v_cvt_f32_i32 v43, v43
    v_cvt_f32_i32 v44, v44
    v_cvt_f32_i32 v45, v45
    v_cvt_f32_i32 v46, v46
    v_cvt_f32_i32 v47, v47
    v_sub_f32 v36, v36, v60
    v_sub_f32 v37, v37, v61
    v_sub_f32 v38, v38, v62
    v_sub_f32 v39, v39, v63
    v_sub_f32 v40, v40, v64
    v_sub_f32 v41, v41, v65
    v_sub_f32 v42, v42, v66
    v_sub_f32 v43, v43, v67
    v_sub_f32 v44, v44, v68
    v_sub_f32 v45, v45, v69
    v_sub_f32 v46, v46, v70
    v_sub_f32 v47, v47, v71
    v_cvt_pk_bf16_f32 v36, 0, v36
    v_cvt_pk_bf16_f32 v37, 0, v37
    v_cvt_pk_bf16_f32 v38, 0, v38
    v_cvt_pk_bf16_f32 v39, 0, v39
    v_cvt_pk_bf16_f32 v40, 0, v40
    v_cvt_pk_bf16_f32 v41, 0, v41
    v_cvt_pk_bf16_f32 v42, 0, v42
    v_cvt_pk_bf16_f32 v43, 0, v43
    v_cvt_pk_bf16_f32 v44, 0, v44
    v_cvt_pk_bf16_f32 v45, 0, v45
    v_cvt_pk_bf16_f32 v46, 0, v46
    v_cvt_pk_bf16_f32 v47, 0, v47
    v_mul_f32 v36, v36, v84
    v_mul_f32 v37, v37, v85
    v_mul_f32 v38, v38, v86
    v_mul_f32 v39, v39, v87
    v_mul_f32 v40, v40, v88
    v_mul_f32 v41, v41, v89
    v_mul_f32 v42, v42, v90
    v_mul_f32 v43, v43, v91
    v_mul_f32 v44, v44, v92
    v_mul_f32 v45, v45, v93
    v_mul_f32 v46, v46, v94
    v_mul_f32 v47, v47, v95
    v_cvt_pk_bf16_f32 v132, v36, v37
    v_cvt_pk_bf16_f32 v133, v38, v39
    v_cvt_pk_bf16_f32 v134, v40, v41
    v_cvt_pk_bf16_f32 v135, v42, v43
    v_cvt_pk_bf16_f32 v136, v44, v45
    v_cvt_pk_bf16_f32 v137, v46, v47
    v_mfma_f32_16x16x16_bf16 v[144:147], v[132:133], v[164:165], 0
    v_mfma_f32_16x16x16_bf16 v[144:147], v[134:135], v[166:167], v[144:147]
    v_mfma_f32_16x16x16_bf16 v[144:147], v[136:137], v[168:169], v[144:147]
    s_waitcnt lgkmcnt(0)
    v_cvt_f32_i32 v48, v48
    v_cvt_f32_i32 v49, v49
    v_cvt_f32_i32 v50, v50
    v_cvt_f32_i32 v51, v51
    v_cvt_f32_i32 v52, v52
    v_cvt_f32_i32 v53, v53
    v_cvt_f32_i32 v54, v54
    v_cvt_f32_i32 v55, v55
    v_cvt_f32_i32 v56, v56
    v_cvt_f32_i32 v57, v57
    v_cvt_f32_i32 v58, v58
    v_cvt_f32_i32 v59, v59
    v_sub_f32 v48, v48, v72
    v_sub_f32 v49, v49, v73
    v_sub_f32 v50, v50, v74
    v_sub_f32 v51, v51, v75
    v_sub_f32 v52, v52, v76
    v_sub_f32 v53, v53, v77
    v_sub_f32 v54, v54, v78
    v_sub_f32 v55, v55, v79
    v_sub_f32 v56, v56, v80
    v_sub_f32 v57, v57, v81
    v_sub_f32 v58, v58, v82
    v_sub_f32 v59, v59, v83
    v_cvt_pk_bf16_f32 v48, 0, v48
    v_cvt_pk_bf16_f32 v49, 0, v49
    v_cvt_pk_bf16_f32 v50, 0, v50
    v_cvt_pk_bf16_f32 v51, 0, v51
    v_cvt_pk_bf16_f32 v52, 0, v52
    v_cvt_pk_bf16_f32 v53, 0, v53
    v_cvt_pk_bf16_f32 v54, 0, v54
    v_cvt_pk_bf16_f32 v55, 0, v55
    v_cvt_pk_bf16_f32 v56, 0, v56
    v_cvt_pk_bf16_f32 v57, 0, v57
    v_cvt_pk_bf16_f32 v58, 0, v58
    v_cvt_pk_bf16_f32 v59, 0, v59
    v_mul_f32 v48, v48, v96
    v_mul_f32 v49, v49, v97
    v_mul_f32 v50, v50, v98
    v_mul_f32 v51, v51, v99
    v_mul_f32 v52, v52, v100
    v_mul_f32 v53, v53, v101
    v_mul_f32 v54, v54, v102
    v_mul_f32 v55, v55, v103
    v_mul_f32 v56, v56, v104
    v_mul_f32 v57, v57, v105
    v_mul_f32 v58, v58, v106
    v_mul_f32 v59, v59, v107
    v_cvt_pk_bf16_f32 v138, v48, v49
    v_cvt_pk_bf16_f32 v139, v50, v51
    v_add_f32_dpp v3, v144, v147 row_ror:12 row_mask:0xf bank_mask:0xf
    v_cvt_pk_bf16_f32 v140, v52, v53
    v_cvt_pk_bf16_f32 v141, v54, v55
    v_add_f32_dpp v3, v145, v3 row_ror:8 row_mask:0xf bank_mask:0xf
    v_cvt_pk_bf16_f32 v142, v56, v57
    v_cvt_pk_bf16_f32 v143, v58, v59
    v_add_f32_dpp v15, v146, v3 row_ror:4 row_mask:0xf bank_mask:0x8
    v_mfma_f32_16x16x16_bf16 v[148:151], v[138:139], v[164:165], 0
    v_mfma_f32_16x16x16_bf16 v[148:151], v[140:141], v[166:167], v[148:151]
    v_mfma_f32_16x16x16_bf16 v[148:151], v[142:143], v[168:169], v[148:151]
    s_add_u32 s63, s63, 3072
    v_add_u32 v33, s63, v17
    v_add_u32 v34, s63, v18
    ds_read_b64 v[108:109], v33 offset:0
    ds_read_b64 v[110:111], v33 offset:1536
    ds_read_b64 v[112:113], v33 offset:128
    ds_read_b64 v[114:115], v33 offset:1664
    ds_read_b64 v[116:117], v33 offset:256
    ds_read_b64 v[118:119], v33 offset:1792
    ds_read_b64 v[120:121], v34 offset:0
    v_add_f32_dpp v4, v148, v151 row_ror:12 row_mask:0xf bank_mask:0xf
    ds_read_b64 v[122:123], v34 offset:1536
    ds_read_b64 v[124:125], v34 offset:128
    v_add_f32_dpp v4, v149, v4 row_ror:8 row_mask:0xf bank_mask:0xf
    ds_read_b64 v[126:127], v34 offset:1664
    ds_read_b64 v[128:129], v34 offset:256
    ds_read_b64 v[130:131], v34 offset:1792
    v_add_f32_dpp v16, v150, v4 row_ror:4 row_mask:0xf bank_mask:0x8
    v_cvt_pk_bf16_f32 v3, 0, v15
    v_cvt_pk_bf16_f32 v4, 0, v16
    v_mul_f32 v3, s65, v3
    v_mul_f32 v4, s65, v4
    v_cvt_pk_bf16_f32 v5, v3, v4
    v_max3_f32 v14, v14, v3, v4
    ds_write_b32 v11, v5 offset:256
    s_waitcnt lgkmcnt(0)
    v_lshlrev_b32 v60, 16, v108
    v_and_b32 v61, s66, v108
    v_lshlrev_b32 v62, 16, v109
    v_and_b32 v63, s66, v109
    v_lshlrev_b32 v84, 16, v110
    v_and_b32 v85, s66, v110
    v_lshlrev_b32 v86, 16, v111
    v_and_b32 v87, s66, v111
    v_lshlrev_b32 v64, 16, v112
    v_and_b32 v65, s66, v112
    v_lshlrev_b32 v66, 16, v113
    v_and_b32 v67, s66, v113
    v_lshlrev_b32 v88, 16, v114
    v_and_b32 v89, s66, v114
    v_lshlrev_b32 v90, 16, v115
    v_and_b32 v91, s66, v115
    v_lshlrev_b32 v68, 16, v116
    v_and_b32 v69, s66, v116
    v_lshlrev_b32 v70, 16, v117
    v_and_b32 v71, s66, v117
    v_lshlrev_b32 v92, 16, v118
    v_and_b32 v93, s66, v118
    v_lshlrev_b32 v94, 16, v119
    v_and_b32 v95, s66, v119
    v_lshlrev_b32 v72, 16, v120
    v_and_b32 v73, s66, v120
    v_lshlrev_b32 v74, 16, v121
    v_and_b32 v75, s66, v121
    v_lshlrev_b32 v96, 16, v122
    v_and_b32 v97, s66, v122
    v_lshlrev_b32 v98, 16, v123
    v_and_b32 v99, s66, v123
    v_lshlrev_b32 v76, 16, v124
    v_and_b32 v77, s66, v124
    v_lshlrev_b32 v78, 16, v125
    v_and_b32 v79, s66, v125
    v_lshlrev_b32 v100, 16, v126
    v_and_b32 v101, s66, v126
    v_lshlrev_b32 v102, 16, v127
    v_and_b32 v103, s66, v127
    v_lshlrev_b32 v80, 16, v128
    v_and_b32 v81, s66, v128
    v_lshlrev_b32 v82, 16, v129
    v_and_b32 v83, s66, v129
    v_lshlrev_b32 v104, 16, v130
    v_and_b32 v105, s66, v130
    v_lshlrev_b32 v106, 16, v131
    v_and_b32 v107, s66, v131
    v_add_u32 v11, 3072, v11
    s_add_u32 s61, s61, 1
    s_cmp_eq_u32 s61, s3
    s_cbranch_scc1 L_kblk_end
    s_cmp_eq_u32 s61, s73
    s_cbranch_scc1 L_kblk_end
    s_cmp_lt_u32 s61, 16
    s_cbranch_scc1 L_kblk
L_kblk_end:
    s_nop 1
    v_max_f32_dpp v14, v14, v14 row_ror:4 row_mask:0xf bank_mask:0xf
    s_nop 1
    v_max_f32_dpp v14, v14, v14 row_ror:8 row_mask:0xf bank_mask:0xf
    v_mov_b32 v3, v14
    s_nop 1
    v_permlane16_swap_b32 v14, v3
    v_max_f32 v14, v14, v3
    v_mov_b32 v3, v14
    s_nop 1
    v_permlane32_swap_b32 v14, v3
    v_max_f32 v14, v14, v3
    v_cvt_pk_bf16_f32 v14, 0, v14
    v_mul_f32 v14, s64, v14
    ds_write_b32 v154, v14
    v_add_u32 v154, 64, v154
    ds_read_b64 v[164:165], v153 offset:0
    ds_read_b64 v[166:167], v153 offset:128
    ds_read_b64 v[168:169], v153 offset:256
    v_add_u32 v153, 1536, v153
    v_mov_b32 v14, 0xff800000
    s_waitcnt lgkmcnt(0)
    s_cmp_lt_u32 s61, 16
    s_cbranch_scc1 L_kblk
    v_lshrrev_b32 v3, 4, v1
    v_and_b32 v4, 15, v1
    v_and_b32 v5, 2, v3
    v_add_u32 v3, v3, v5
    v_lshl_add_u32 v3, v2, 3, v3
    v_mul_u32_u24 v3, 768, v3
    v_lshl_add_u32 v12, v4, 4, v3
    v_subrev_u32 v11, 49152, v11
    s_mov_b32 s63, 0
    v_add_u32 v215, s63, v7
    v_add_u32 v216, s63, v8
    ds_read_b32 v214, v11 offset:0
    ds_read_u16 v217, v215 offset:512
    ds_read_u16 v218, v216 offset:512
    ds_read_u16 v215, v215
    ds_read_u16 v216, v216
    v_mov_b32 v188, 0
    v_mov_b32 v189, 0
    v_mov_b32 v190, 0
    v_mov_b32 v191, 0
    v_mov_b32 v192, 0
    v_mov_b32 v193, 0
    v_mov_b32 v194, 0
    v_mov_b32 v195, 0
    v_mov_b32 v196, 0
    v_mov_b32 v197, 0
    v_mov_b32 v198, 0
    v_mov_b32 v199, 0
    v_mov_b32 v200, 0
    v_mov_b32 v201, 0
    v_mov_b32 v202, 0
    v_mov_b32 v203, 0
    s_mov_b32 s61, 0
    v_and_b32 v3, 3, v1
    v_lshlrev_b32 v20, 4, v3
    v_add_u32 v154, 154944, v20
    v_add_u32 v18, 142336, v20
    v_lshl_add_u32 v156, v2, 6, v18
    v_lshl_add_u32 v20, v2, 6, v20
    v_add_u32 v20, 3072, v20
    v_mul_u32_u24 v155, 3072, v2
    v_lshl_add_u32 v155, v1, 4, v155
    v_add_u32 v155, 142592, v155
    v_lshlrev_b32 v4, 10, v2
    v_lshl_add_u32 v19, v1, 4, v4
    v_lshl_add_u32 v17, v1, 2, v4
    v_add_u32 v17, 142592, v17
    v_mul_u32_u24 v21, 384, v3
    v_lshrrev_b32 v4, 2, v1
    v_lshl_add_u32 v21, v4, 3, v21
    v_lshl_add_u32 v21, v2, 7, v21
    s_mov_b32 s48, s18
    s_and_b32 s49, s19, 0xffff
    s_mov_b32 s50, 393216
    s_mov_b32 s51, 0x20000
    s_mov_b32 s24, s22
    s_and_b32 s25, s23, 0xffff
    s_mov_b32 s26, 848640
    s_mov_b32 s27, 0x20000
    s_mul_i32 s68, s100, 9984
    s_mul_i32 s71, s2, 3328
    s_add_u32 s69, s68, 3328
    s_add_u32 s70, s68, 6656
    s_sub_u32 s57, 255, s100
    s_mul_i32 s57, s57, 1536
    s_mov_b32 s84, 0x7060500
    s_mov_b32 s85, 0x7060501
    s_mov_b32 s86, 0x7060502
    s_mov_b32 s87, 0x7060503
    s_mov_b32 s88, 0x0c0c0400
    s_mov_b32 s89, 0x04000c0c
    s_mov_b32 s90, 0xffffff00
L_vround:
    v_mov_b32 v164, 0
    v_mov_b32 v165, 0
    v_mov_b32 v166, 0
    v_mov_b32 v167, 0
    v_mov_b32 v168, 0
    v_mov_b32 v169, 0
    v_mov_b32 v170, 0
    v_mov_b32 v171, 0
    v_mov_b32 v172, 0
    v_mov_b32 v173, 0
    v_mov_b32 v174, 0
    v_mov_b32 v175, 0
    v_mov_b32 v212, 0
    v_mov_b32 v213, 0
L_vblk:
    s_add_u32 s61, s61, 1
    s_cmp_eq_u32 s61, s3
    s_cselect_b32 s74, 1, 0
    s_cmp_eq_u32 s61, s73
    s_cselect_b32 s74, 1, s74
    s_cmp_eq_u32 s61, 16
    s_cselect_b32 s74, 1, s74
    v_add_u32 v13, s62, v12
    s_add_u32 s62, s62, 24576
    s_cmp_eq_u32 s62, 73728
    s_cselect_b32 s62, 0, s62
    s_barrier
    ds_read_b128 v[160:163], v154
    ds_read_b128 v[36:39], v13 offset:0
    ds_read_b128 v[48:51], v13 offset:1536
    ds_read_b128 v[40:43], v13 offset:256
    ds_read_b128 v[52:55], v13 offset:1792
    ds_read_b128 v[44:47], v13 offset:512
    ds_read_b128 v[56:59], v13 offset:2048
    s_waitcnt lgkmcnt(6)
    v_max_f32 v14, v160, v161
    v_max3_f32 v14, v14, v162, v163
    s_waitcnt lgkmcnt(6)
    v_lshlrev_b32 v219, 16, v214
    v_and_b32 v220, s66, v214
    v_fma_f32 v219, v219, s64, -v14
    v_fma_f32 v220, v220, s64, -v14
    v_exp_f32 v219, v219
    v_exp_f32 v220, v220
    v_lshlrev_b32 v221, 16, v215
    v_lshlrev_b32 v222, 16, v216
    v_mul_f32 v221, v219, v221
    v_mul_f32 v222, v220, v222
    v_add_f32 v212, v212, v219
    v_cvt_pk_bf16_f32 v221, v221, v222
    v_add_f32 v212, v212, v220
    v_lshlrev_b32 v223, 16, v217
    v_lshlrev_b32 v224, 16, v218
    v_lshlrev_b32 v219, 16, v221
    v_and_b32 v220, s66, v221
    v_fmac_f32 v213, v219, v223
    v_fmac_f32 v213, v220, v224
    v_mov_b32_dpp v188, v221 quad_perm:[0,1,2,3] row_mask:0xf bank_mask:0x1
    v_mov_b32_dpp v189, v221 row_ror:12 row_mask:0xf bank_mask:0x1
    v_mov_b32_dpp v190, v221 row_ror:8 row_mask:0xf bank_mask:0x1
    v_mov_b32_dpp v191, v221 row_ror:4 row_mask:0xf bank_mask:0x1
    v_mov_b32_dpp v192, v221 row_ror:4 row_mask:0xf bank_mask:0x2
    v_mov_b32_dpp v193, v221 quad_perm:[0,1,2,3] row_mask:0xf bank_mask:0x2
    v_mov_b32_dpp v194, v221 row_ror:12 row_mask:0xf bank_mask:0x2
    v_mov_b32_dpp v195, v221 row_ror:8 row_mask:0xf bank_mask:0x2
    v_mov_b32_dpp v196, v221 row_ror:8 row_mask:0xf bank_mask:0x4
    v_mov_b32_dpp v197, v221 row_ror:4 row_mask:0xf bank_mask:0x4
    v_mov_b32_dpp v198, v221 quad_perm:[0,1,2,3] row_mask:0xf bank_mask:0x4
    v_mov_b32_dpp v199, v221 row_ror:12 row_mask:0xf bank_mask:0x4
    v_mov_b32_dpp v200, v221 row_ror:12 row_mask:0xf bank_mask:0x8
    v_mov_b32_dpp v201, v221 row_ror:8 row_mask:0xf bank_mask:0x8
    v_mov_b32_dpp v202, v221 row_ror:4 row_mask:0xf bank_mask:0x8
    v_mov_b32_dpp v203, v221 quad_perm:[0,1,2,3] row_mask:0xf bank_mask:0x8
    s_waitcnt lgkmcnt(4)
    v_cvt_f32_i32 v36, v36
    v_cvt_f32_i32 v37, v37
    v_cvt_f32_i32 v38, v38
    v_cvt_f32_i32 v39, v39
    v_cvt_f32_i32 v48, v48
    v_cvt_f32_i32 v49, v49
    v_cvt_f32_i32 v50, v50
    v_cvt_f32_i32 v51, v51
    v_cvt_pk_bf16_f32 v60, v36, v48
    v_cvt_pk_bf16_f32 v64, v37, v49
    v_cvt_pk_bf16_f32 v68, v38, v50
    v_cvt_pk_bf16_f32 v72, v39, v51
    s_waitcnt lgkmcnt(2)
    v_cvt_f32_i32 v40, v40
    v_cvt_f32_i32 v41, v41
    v_cvt_f32_i32 v42, v42
    v_cvt_f32_i32 v43, v43
    v_cvt_f32_i32 v52, v52
    v_cvt_f32_i32 v53, v53
    v_cvt_f32_i32 v54, v54
    v_cvt_f32_i32 v55, v55
    v_cvt_pk_bf16_f32 v76, v40, v52
    v_cvt_pk_bf16_f32 v80, v41, v53
    v_cvt_pk_bf16_f32 v84, v42, v54
    v_cvt_pk_bf16_f32 v88, v43, v55
    s_waitcnt lgkmcnt(0)
    v_cvt_f32_i32 v44, v44
    v_cvt_f32_i32 v45, v45
    v_cvt_f32_i32 v46, v46
    v_cvt_f32_i32 v47, v47
    v_cvt_f32_i32 v56, v56
    v_cvt_f32_i32 v57, v57
    v_cvt_f32_i32 v58, v58
    v_cvt_f32_i32 v59, v59
    v_cvt_pk_bf16_f32 v92, v44, v56
    v_cvt_pk_bf16_f32 v96, v45, v57
    v_cvt_pk_bf16_f32 v100, v46, v58
    v_cvt_pk_bf16_f32 v104, v47, v59
    v_add_u32 v215, s63, v9
    v_add_u32 v216, s63, v10
    ds_read_b32 v214, v11 offset:256
    ds_read_u16 v217, v215 offset:512
    ds_read_u16 v218, v216 offset:512
    ds_read_u16 v215, v215
    ds_read_u16 v216, v216
    v_add_u32 v13, s62, v12
    s_add_u32 s62, s62, 24576
    s_cmp_eq_u32 s62, 73728
    s_cselect_b32 s62, 0, s62
    s_barrier
    ds_read_b128 v[36:39], v13 offset:0
    ds_read_b128 v[48:51], v13 offset:1536
    ds_read_b128 v[40:43], v13 offset:256
    ds_read_b128 v[52:55], v13 offset:1792
    ds_read_b128 v[44:47], v13 offset:512
    ds_read_b128 v[56:59], v13 offset:2048
    s_waitcnt lgkmcnt(4)
    v_cvt_f32_i32 v36, v36
    v_cvt_f32_i32 v37, v37
    v_cvt_f32_i32 v38, v38
    v_cvt_f32_i32 v39, v39
    v_cvt_f32_i32 v48, v48
    v_cvt_f32_i32 v49, v49
    v_cvt_f32_i32 v50, v50
    v_cvt_f32_i32 v51, v51
    v_cvt_pk_bf16_f32 v61, v36, v48
    v_cvt_pk_bf16_f32 v65, v37, v49
    v_cvt_pk_bf16_f32 v69, v38, v50
    v_cvt_pk_bf16_f32 v73, v39, v51
    s_waitcnt lgkmcnt(2)
    v_cvt_f32_i32 v40, v40
    v_cvt_f32_i32 v41, v41
    v_cvt_f32_i32 v42, v42
    v_cvt_f32_i32 v43, v43
    v_cvt_f32_i32 v52, v52
    v_cvt_f32_i32 v53, v53
    v_cvt_f32_i32 v54, v54
    v_cvt_f32_i32 v55, v55
    v_cvt_pk_bf16_f32 v77, v40, v52
    v_cvt_pk_bf16_f32 v81, v41, v53
    v_cvt_pk_bf16_f32 v85, v42, v54
    v_cvt_pk_bf16_f32 v89, v43, v55
    s_waitcnt lgkmcnt(0)
    v_cvt_f32_i32 v44, v44
    v_cvt_f32_i32 v45, v45
    v_cvt_f32_i32 v46, v46
    v_cvt_f32_i32 v47, v47
    v_cvt_f32_i32 v56, v56
    v_cvt_f32_i32 v57, v57
    v_cvt_f32_i32 v58, v58
    v_cvt_f32_i32 v59, v59
    v_cvt_pk_bf16_f32 v93, v44, v56
    v_cvt_pk_bf16_f32 v97, v45, v57
    v_cvt_pk_bf16_f32 v101, v46, v58
    v_cvt_pk_bf16_f32 v105, v47, v59
    v_add_u32 v13, s62, v12
    s_add_u32 s62, s62, 24576
    s_cmp_eq_u32 s62, 73728
    s_cselect_b32 s62, 0, s62
    s_barrier
    ds_read_b128 v[36:39], v13 offset:0
    ds_read_b128 v[48:51], v13 offset:1536
    ds_read_b128 v[40:43], v13 offset:256
    ds_read_b128 v[52:55], v13 offset:1792
    ds_read_b128 v[44:47], v13 offset:512
    ds_read_b128 v[56:59], v13 offset:2048
    s_waitcnt lgkmcnt(4)
    v_cvt_f32_i32 v36, v36
    v_cvt_f32_i32 v37, v37
    v_cvt_f32_i32 v38, v38
    v_cvt_f32_i32 v39, v39
    v_cvt_f32_i32 v48, v48
    v_cvt_f32_i32 v49, v49
    v_cvt_f32_i32 v50, v50
    v_cvt_f32_i32 v51, v51
    v_cvt_pk_bf16_f32 v62, v36, v48
    v_cvt_pk_bf16_f32 v66, v37, v49
    v_cvt_pk_bf16_f32 v70, v38, v50
    v_cvt_pk_bf16_f32 v74, v39, v51
    s_waitcnt lgkmcnt(2)
    v_cvt_f32_i32 v40, v40
    v_cvt_f32_i32 v41, v41
    v_cvt_f32_i32 v42, v42
    v_cvt_f32_i32 v43, v43
    v_cvt_f32_i32 v52, v52
    v_cvt_f32_i32 v53, v53
    v_cvt_f32_i32 v54, v54
    v_cvt_f32_i32 v55, v55
    v_cvt_pk_bf16_f32 v78, v40, v52
    v_cvt_pk_bf16_f32 v82, v41, v53
    v_cvt_pk_bf16_f32 v86, v42, v54
    v_cvt_pk_bf16_f32 v90, v43, v55
    s_waitcnt lgkmcnt(0)
    v_cvt_f32_i32 v44, v44
    v_cvt_f32_i32 v45, v45
    v_cvt_f32_i32 v46, v46
    v_cvt_f32_i32 v47, v47
    v_cvt_f32_i32 v56, v56
    v_cvt_f32_i32 v57, v57
    v_cvt_f32_i32 v58, v58
    v_cvt_f32_i32 v59, v59
    v_cvt_pk_bf16_f32 v94, v44, v56
    v_cvt_pk_bf16_f32 v98, v45, v57
    v_cvt_pk_bf16_f32 v102, v46, v58
    v_cvt_pk_bf16_f32 v106, v47, v59
    v_add_u32 v13, s62, v12
    s_add_u32 s62, s62, 24576
    s_cmp_eq_u32 s62, 73728
    s_cselect_b32 s62, 0, s62
    s_barrier
    ds_read_b128 v[36:39], v13 offset:0
    ds_read_b128 v[48:51], v13 offset:1536
    ds_read_b128 v[40:43], v13 offset:256
    ds_read_b128 v[52:55], v13 offset:1792
    ds_read_b128 v[44:47], v13 offset:512
    ds_read_b128 v[56:59], v13 offset:2048
    s_waitcnt lgkmcnt(4)
    v_cvt_f32_i32 v36, v36
    v_cvt_f32_i32 v37, v37
    v_cvt_f32_i32 v38, v38
    v_cvt_f32_i32 v39, v39
    v_cvt_f32_i32 v48, v48
    v_cvt_f32_i32 v49, v49
    v_cvt_f32_i32 v50, v50
    v_cvt_f32_i32 v51, v51
    v_cvt_pk_bf16_f32 v63, v36, v48
    v_cvt_pk_bf16_f32 v67, v37, v49
    v_cvt_pk_bf16_f32 v71, v38, v50
    v_cvt_pk_bf16_f32 v75, v39, v51
    s_waitcnt lgkmcnt(2)
    v_cvt_f32_i32 v40, v40
    v_cvt_f32_i32 v41, v41
    v_cvt_f32_i32 v42, v42
    v_mfma_f32_16x16x32_bf16 v[164:167], v[188:191], v[60:63], v[164:167]
    v_cvt_f32_i32 v43, v43
    v_cvt_f32_i32 v52, v52
    v_cvt_f32_i32 v53, v53
    v_mfma_f32_16x16x32_bf16 v[164:167], v[192:195], v[64:67], v[164:167]
    v_cvt_f32_i32 v54, v54
    v_cvt_f32_i32 v55, v55
    v_cvt_pk_bf16_f32 v79, v40, v52
    v_mfma_f32_16x16x32_bf16 v[164:167], v[196:199], v[68:71], v[164:167]
    v_cvt_pk_bf16_f32 v83, v41, v53
    v_cvt_pk_bf16_f32 v87, v42, v54
    v_cvt_pk_bf16_f32 v91, v43, v55
    v_mfma_f32_16x16x32_bf16 v[164:167], v[200:203], v[72:75], v[164:167]
    s_waitcnt lgkmcnt(0)
    v_cvt_f32_i32 v44, v44
    v_cvt_f32_i32 v45, v45
    v_cvt_f32_i32 v46, v46
    v_mfma_f32_16x16x32_bf16 v[168:171], v[188:191], v[76:79], v[168:171]
    v_cvt_f32_i32 v47, v47
    v_cvt_f32_i32 v56, v56
    v_cvt_f32_i32 v57, v57
    v_mfma_f32_16x16x32_bf16 v[168:171], v[192:195], v[80:83], v[168:171]
    v_cvt_f32_i32 v58, v58
    v_cvt_f32_i32 v59, v59
    v_cvt_pk_bf16_f32 v95, v44, v56
    v_mfma_f32_16x16x32_bf16 v[168:171], v[196:199], v[84:87], v[168:171]
    v_cvt_pk_bf16_f32 v99, v45, v57
    v_cvt_pk_bf16_f32 v103, v46, v58
    v_cvt_pk_bf16_f32 v107, v47, v59
    v_mfma_f32_16x16x32_bf16 v[168:171], v[200:203], v[88:91], v[168:171]
    v_mfma_f32_16x16x32_bf16 v[172:175], v[188:191], v[92:95], v[172:175]
    v_mfma_f32_16x16x32_bf16 v[172:175], v[192:195], v[96:99], v[172:175]
    v_mfma_f32_16x16x32_bf16 v[172:175], v[196:199], v[100:103], v[172:175]
    v_mfma_f32_16x16x32_bf16 v[172:175], v[200:203], v[104:107], v[172:175]
    v_add_u32 v13, s62, v12
    s_add_u32 s62, s62, 24576
    s_cmp_eq_u32 s62, 73728
    s_cselect_b32 s62, 0, s62
    s_barrier
    ds_read_b128 v[36:39], v13 offset:0
    ds_read_b128 v[48:51], v13 offset:1536
    ds_read_b128 v[40:43], v13 offset:256
    ds_read_b128 v[52:55], v13 offset:1792
    ds_read_b128 v[44:47], v13 offset:512
    ds_read_b128 v[56:59], v13 offset:2048
    s_waitcnt lgkmcnt(6)
    v_lshlrev_b32 v219, 16, v214
    v_and_b32 v220, s66, v214
    v_fma_f32 v219, v219, s64, -v14
    v_fma_f32 v220, v220, s64, -v14
    v_exp_f32 v219, v219
    v_exp_f32 v220, v220
    v_lshlrev_b32 v221, 16, v215
    v_lshlrev_b32 v222, 16, v216
    v_mul_f32 v221, v219, v221
    v_mul_f32 v222, v220, v222
    v_add_f32 v212, v212, v219
    v_cvt_pk_bf16_f32 v221, v221, v222
    v_add_f32 v212, v212, v220
    v_lshlrev_b32 v223, 16, v217
    v_lshlrev_b32 v224, 16, v218
    v_lshlrev_b32 v219, 16, v221
    v_and_b32 v220, s66, v221
    v_fmac_f32 v213, v219, v223
    v_fmac_f32 v213, v220, v224
    v_mov_b32_dpp v188, v221 quad_perm:[0,1,2,3] row_mask:0xf bank_mask:0x1
    v_mov_b32_dpp v189, v221 row_ror:12 row_mask:0xf bank_mask:0x1
    v_mov_b32_dpp v190, v221 row_ror:8 row_mask:0xf bank_mask:0x1
    v_mov_b32_dpp v191, v221 row_ror:4 row_mask:0xf bank_mask:0x1
    v_mov_b32_dpp v192, v221 row_ror:4 row_mask:0xf bank_mask:0x2
    v_mov_b32_dpp v193, v221 quad_perm:[0,1,2,3] row_mask:0xf bank_mask:0x2
    v_mov_b32_dpp v194, v221 row_ror:12 row_mask:0xf bank_mask:0x2
    v_mov_b32_dpp v195, v221 row_ror:8 row_mask:0xf bank_mask:0x2
    v_mov_b32_dpp v196, v221 row_ror:8 row_mask:0xf bank_mask:0x4
    v_mov_b32_dpp v197, v221 row_ror:4 row_mask:0xf bank_mask:0x4
    v_mov_b32_dpp v198, v221 quad_perm:[0,1,2,3] row_mask:0xf bank_mask:0x4
    v_mov_b32_dpp v199, v221 row_ror:12 row_mask:0xf bank_mask:0x4
    v_mov_b32_dpp v200, v221 row_ror:12 row_mask:0xf bank_mask:0x8
    v_mov_b32_dpp v201, v221 row_ror:8 row_mask:0xf bank_mask:0x8
    v_mov_b32_dpp v202, v221 row_ror:4 row_mask:0xf bank_mask:0x8
    v_mov_b32_dpp v203, v221 quad_perm:[0,1,2,3] row_mask:0xf bank_mask:0x8
    s_waitcnt lgkmcnt(4)
    v_cvt_f32_i32 v36, v36
    v_cvt_f32_i32 v37, v37
    v_cvt_f32_i32 v38, v38
    v_cvt_f32_i32 v39, v39
    v_cvt_f32_i32 v48, v48
    v_cvt_f32_i32 v49, v49
    v_cvt_f32_i32 v50, v50
    v_cvt_f32_i32 v51, v51
    v_cvt_pk_bf16_f32 v60, v36, v48
    v_cvt_pk_bf16_f32 v64, v37, v49
    v_cvt_pk_bf16_f32 v68, v38, v50
    v_cvt_pk_bf16_f32 v72, v39, v51
    s_waitcnt lgkmcnt(2)
    v_cvt_f32_i32 v40, v40
    v_cvt_f32_i32 v41, v41
    v_cvt_f32_i32 v42, v42
    v_cvt_f32_i32 v43, v43
    v_cvt_f32_i32 v52, v52
    v_cvt_f32_i32 v53, v53
    v_cvt_f32_i32 v54, v54
    v_cvt_f32_i32 v55, v55
    v_cvt_pk_bf16_f32 v76, v40, v52
    v_cvt_pk_bf16_f32 v80, v41, v53
    v_cvt_pk_bf16_f32 v84, v42, v54
    v_cvt_pk_bf16_f32 v88, v43, v55
    s_waitcnt lgkmcnt(0)
    v_cvt_f32_i32 v44, v44
    v_cvt_f32_i32 v45, v45
    v_cvt_f32_i32 v46, v46
    v_cvt_f32_i32 v47, v47
    v_cvt_f32_i32 v56, v56
    v_cvt_f32_i32 v57, v57
    v_cvt_f32_i32 v58, v58
    v_cvt_f32_i32 v59, v59
    v_cvt_pk_bf16_f32 v92, v44, v56
    v_cvt_pk_bf16_f32 v96, v45, v57
    v_cvt_pk_bf16_f32 v100, v46, v58
    v_cvt_pk_bf16_f32 v104, v47, v59
    v_add_u32 v11, 3072, v11
    s_add_u32 s63, s63, 1024
    v_add_u32 v215, s63, v7
    v_add_u32 v216, s63, v8
    ds_read_b32 v214, v11 offset:0
    ds_read_u16 v217, v215 offset:512
    ds_read_u16 v218, v216 offset:512
    ds_read_u16 v215, v215
    ds_read_u16 v216, v216
    v_add_u32 v13, s62, v12
    s_add_u32 s62, s62, 24576
    s_cmp_eq_u32 s62, 73728
    s_cselect_b32 s62, 0, s62
    s_barrier
    ds_read_b128 v[36:39], v13 offset:0
    ds_read_b128 v[48:51], v13 offset:1536
    ds_read_b128 v[40:43], v13 offset:256
    ds_read_b128 v[52:55], v13 offset:1792
    ds_read_b128 v[44:47], v13 offset:512
    ds_read_b128 v[56:59], v13 offset:2048
    s_waitcnt lgkmcnt(4)
    v_cvt_f32_i32 v36, v36
    v_cvt_f32_i32 v37, v37
    v_cvt_f32_i32 v38, v38
    v_cvt_f32_i32 v39, v39
    v_cvt_f32_i32 v48, v48
    v_cvt_f32_i32 v49, v49
    v_cvt_f32_i32 v50, v50
    v_cvt_f32_i32 v51, v51
    v_cvt_pk_bf16_f32 v61, v36, v48
    v_cvt_pk_bf16_f32 v65, v37, v49
    v_cvt_pk_bf16_f32 v69, v38, v50
    v_cvt_pk_bf16_f32 v73, v39, v51
    s_waitcnt lgkmcnt(2)
    v_cvt_f32_i32 v40, v40
    v_cvt_f32_i32 v41, v41
    v_cvt_f32_i32 v42, v42
    v_cvt_f32_i32 v43, v43
    v_cvt_f32_i32 v52, v52
    v_cvt_f32_i32 v53, v53
    v_cvt_f32_i32 v54, v54
    v_cvt_f32_i32 v55, v55
    v_cvt_pk_bf16_f32 v77, v40, v52
    v_cvt_pk_bf16_f32 v81, v41, v53
    v_cvt_pk_bf16_f32 v85, v42, v54
    v_cvt_pk_bf16_f32 v89, v43, v55
    s_waitcnt lgkmcnt(0)
    v_cvt_f32_i32 v44, v44
    v_cvt_f32_i32 v45, v45
    v_cvt_f32_i32 v46, v46
    v_cvt_f32_i32 v47, v47
    v_cvt_f32_i32 v56, v56
    v_cvt_f32_i32 v57, v57
    v_cvt_f32_i32 v58, v58
    v_cvt_f32_i32 v59, v59
    v_cvt_pk_bf16_f32 v93, v44, v56
    v_cvt_pk_bf16_f32 v97, v45, v57
    v_cvt_pk_bf16_f32 v101, v46, v58
    v_cvt_pk_bf16_f32 v105, v47, v59
    s_cmp_eq_u32 s74, 0
    s_cbranch_scc1 L_vnostat
    v_mov_b32 v22, 154884
    ds_read_b32 v22, v22
    s_nop 1
    v_add_f32_dpp v212, v212, v212 row_ror:4 row_mask:0xf bank_mask:0xf
    s_nop 1
    v_add_f32_dpp v212, v212, v212 row_ror:8 row_mask:0xf bank_mask:0xf
    v_mov_b32 v3, v212
    s_nop 1
    v_permlane16_swap_b32 v212, v3
    v_add_f32 v212, v212, v3
    v_mov_b32 v3, v212
    s_nop 1
    v_permlane32_swap_b32 v212, v3
    v_add_f32 v212, v212, v3
    s_nop 1
    v_add_f32_dpp v213, v213, v213 row_ror:4 row_mask:0xf bank_mask:0xf
    s_nop 1
    v_add_f32_dpp v213, v213, v213 row_ror:8 row_mask:0xf bank_mask:0xf
    v_mov_b32 v3, v213
    s_nop 1
    v_permlane16_swap_b32 v213, v3
    v_add_f32 v213, v213, v3
    v_mov_b32 v3, v213
    s_nop 1
    v_permlane32_swap_b32 v213, v3
    v_add_f32 v213, v213, v3
    v_mov_b32 v160, v14
    v_mov_b32 v161, v212
    v_mov_b32 v162, v213
    ds_write_b128 v156, v[160:163]
    v_add_u32 v154, 64, v154
L_vnostat:
    v_add_u32 v13, s62, v12
    s_add_u32 s62, s62, 24576
    s_cmp_eq_u32 s62, 73728
    s_cselect_b32 s62, 0, s62
    s_barrier
    ds_read_b128 v[36:39], v13 offset:0
    ds_read_b128 v[48:51], v13 offset:1536
    ds_read_b128 v[40:43], v13 offset:256
    ds_read_b128 v[52:55], v13 offset:1792
    ds_read_b128 v[44:47], v13 offset:512
    ds_read_b128 v[56:59], v13 offset:2048
    s_waitcnt lgkmcnt(4)
    v_cvt_f32_i32 v36, v36
    v_cvt_f32_i32 v37, v37
    v_cvt_f32_i32 v38, v38
    v_cvt_f32_i32 v39, v39
    v_cvt_f32_i32 v48, v48
    v_cvt_f32_i32 v49, v49
    v_cvt_f32_i32 v50, v50
    v_cvt_f32_i32 v51, v51
    v_cvt_pk_bf16_f32 v62, v36, v48
    v_cvt_pk_bf16_f32 v66, v37, v49
    v_cvt_pk_bf16_f32 v70, v38, v50
    v_cvt_pk_bf16_f32 v74, v39, v51
    s_waitcnt lgkmcnt(2)
    v_cvt_f32_i32 v40, v40
    v_cvt_f32_i32 v41, v41
    v_cvt_f32_i32 v42, v42
    v_cvt_f32_i32 v43, v43
    v_cvt_f32_i32 v52, v52
    v_cvt_f32_i32 v53, v53
    v_cvt_f32_i32 v54, v54
    v_cvt_f32_i32 v55, v55
    v_cvt_pk_bf16_f32 v78, v40, v52
    v_cvt_pk_bf16_f32 v82, v41, v53
    v_cvt_pk_bf16_f32 v86, v42, v54
    v_cvt_pk_bf16_f32 v90, v43, v55
    s_waitcnt lgkmcnt(0)
    v_cvt_f32_i32 v44, v44
    v_cvt_f32_i32 v45, v45
    v_cvt_f32_i32 v46, v46
    v_cvt_f32_i32 v47, v47
    v_cvt_f32_i32 v56, v56
    v_cvt_f32_i32 v57, v57
    v_cvt_f32_i32 v58, v58
    v_cvt_f32_i32 v59, v59
    v_cvt_pk_bf16_f32 v94, v44, v56
    v_cvt_pk_bf16_f32 v98, v45, v57
    v_cvt_pk_bf16_f32 v102, v46, v58
    v_cvt_pk_bf16_f32 v106, v47, v59
    v_add_u32 v13, s62, v12
    s_add_u32 s62, s62, 24576
    s_cmp_eq_u32 s62, 73728
    s_cselect_b32 s62, 0, s62
    s_barrier
    ds_read_b128 v[36:39], v13 offset:0
    ds_read_b128 v[48:51], v13 offset:1536
    ds_read_b128 v[40:43], v13 offset:256
    ds_read_b128 v[52:55], v13 offset:1792
    ds_read_b128 v[44:47], v13 offset:512
    ds_read_b128 v[56:59], v13 offset:2048
    s_waitcnt lgkmcnt(4)
    v_cvt_f32_i32 v36, v36
    v_cvt_f32_i32 v37, v37
    v_cvt_f32_i32 v38, v38
    v_cvt_f32_i32 v39, v39
    v_cvt_f32_i32 v48, v48
    v_cvt_f32_i32 v49, v49
    v_cvt_f32_i32 v50, v50
    v_cvt_f32_i32 v51, v51
    v_cvt_pk_bf16_f32 v63, v36, v48
    v_cvt_pk_bf16_f32 v67, v37, v49
    v_cvt_pk_bf16_f32 v71, v38, v50
    v_cvt_pk_bf16_f32 v75, v39, v51
    s_waitcnt lgkmcnt(2)
    v_cvt_f32_i32 v40, v40
    v_cvt_f32_i32 v41, v41
    v_cvt_f32_i32 v42, v42
    v_mfma_f32_16x16x32_bf16 v[164:167], v[188:191], v[60:63], v[164:167]
    v_cvt_f32_i32 v43, v43
    v_cvt_f32_i32 v52, v52
    v_cvt_f32_i32 v53, v53
    v_mfma_f32_16x16x32_bf16 v[164:167], v[192:195], v[64:67], v[164:167]
    v_cvt_f32_i32 v54, v54
    v_cvt_f32_i32 v55, v55
    v_cvt_pk_bf16_f32 v79, v40, v52
    v_mfma_f32_16x16x32_bf16 v[164:167], v[196:199], v[68:71], v[164:167]
    v_cvt_pk_bf16_f32 v83, v41, v53
    v_cvt_pk_bf16_f32 v87, v42, v54
    v_cvt_pk_bf16_f32 v91, v43, v55
    v_mfma_f32_16x16x32_bf16 v[164:167], v[200:203], v[72:75], v[164:167]
    s_waitcnt lgkmcnt(0)
    v_cvt_f32_i32 v44, v44
    v_cvt_f32_i32 v45, v45
    v_cvt_f32_i32 v46, v46
    v_mfma_f32_16x16x32_bf16 v[168:171], v[188:191], v[76:79], v[168:171]
    v_cvt_f32_i32 v47, v47
    v_cvt_f32_i32 v56, v56
    v_cvt_f32_i32 v57, v57
    v_mfma_f32_16x16x32_bf16 v[168:171], v[192:195], v[80:83], v[168:171]
    v_cvt_f32_i32 v58, v58
    v_cvt_f32_i32 v59, v59
    v_cvt_pk_bf16_f32 v95, v44, v56
    v_mfma_f32_16x16x32_bf16 v[168:171], v[196:199], v[84:87], v[168:171]
    v_cvt_pk_bf16_f32 v99, v45, v57
    v_cvt_pk_bf16_f32 v103, v46, v58
    v_cvt_pk_bf16_f32 v107, v47, v59
    v_mfma_f32_16x16x32_bf16 v[168:171], v[200:203], v[88:91], v[168:171]
    v_mfma_f32_16x16x32_bf16 v[172:175], v[188:191], v[92:95], v[172:175]
    v_mfma_f32_16x16x32_bf16 v[172:175], v[192:195], v[96:99], v[172:175]
    v_mfma_f32_16x16x32_bf16 v[172:175], v[196:199], v[100:103], v[172:175]
    v_mfma_f32_16x16x32_bf16 v[172:175], v[200:203], v[104:107], v[172:175]
    s_cmp_eq_u32 s74, 0
    s_cbranch_scc1 L_vblk
    ds_write_b128 v155, v[164:167]
    s_nop 0
    ds_write_b128 v155, v[168:171] offset:1024
    s_cmp_lt_u32 s61, 16
    s_nop 1
    ds_write_b128 v155, v[172:175] offset:2048
    s_waitcnt lgkmcnt(0)
    s_cbranch_scc1 L_vround
    s_barrier
    s_cmp_eq_u32 s56, 3
    s_cbranch_scc1 L_fin
    ds_read_b128 v[36:39], v18 offset:0
    ds_read_b128 v[40:43], v18 offset:64
    ds_read_b128 v[44:47], v18 offset:128
    ds_read_b128 v[48:51], v18 offset:192
    ds_read2st64_b32 v[60:61], v17 offset0:0 offset1:1
    ds_read2st64_b32 v[62:63], v17 offset0:2 offset1:3
    ds_read2st64_b32 v[64:65], v17 offset0:12 offset1:13
    ds_read2st64_b32 v[66:67], v17 offset0:14 offset1:15
    ds_read2st64_b32 v[68:69], v17 offset0:24 offset1:25
    ds_read2st64_b32 v[70:71], v17 offset0:26 offset1:27
    ds_read2st64_b32 v[72:73], v17 offset0:36 offset1:37
    ds_read2st64_b32 v[74:75], v17 offset0:38 offset1:39
    s_cmp_eq_u32 s101, 0
    s_cbranch_scc0 L_rp10
    buffer_load_dwordx4 v[176:179], v20, s[24:27], s69 offen sc1
    buffer_load_dwordx4 v[184:187], v20, s[24:27], s70 offen sc1
    buffer_load_dwordx4 v[172:175], v19, s[24:27], s69 offen sc1
    buffer_load_dwordx4 v[180:183], v19, s[24:27], s70 offen sc1
    s_branch L_rp12
L_rp10:
    s_cmp_eq_u32 s101, 1
    s_cbranch_scc0 L_rp11
    buffer_load_dwordx4 v[168:171], v20, s[24:27], s68 offen sc1
    buffer_load_dwordx4 v[184:187], v20, s[24:27], s70 offen sc1
    buffer_load_dwordx4 v[164:167], v19, s[24:27], s68 offen sc1
    buffer_load_dwordx4 v[180:183], v19, s[24:27], s70 offen sc1
    s_branch L_rp12
L_rp11:
    buffer_load_dwordx4 v[168:171], v20, s[24:27], s68 offen sc1
    buffer_load_dwordx4 v[176:179], v20, s[24:27], s69 offen sc1
    buffer_load_dwordx4 v[164:167], v19, s[24:27], s68 offen sc1
    buffer_load_dwordx4 v[172:175], v19, s[24:27], s69 offen sc1
L_rp12:
    s_waitcnt lgkmcnt(8)
    v_add_f32 v37, v37, v41
    v_add_f32 v45, v45, v49
    v_add_f32 v38, v38, v42
    v_add_f32 v46, v46, v50
    v_add_f32 v37, v37, v45
    v_add_f32 v38, v38, v46
    v_mov_b32 v39, v22
    s_waitcnt lgkmcnt(4)
    v_add_f32 v60, v60, v64
    v_add_f32 v61, v61, v65
    v_add_f32 v62, v62, v66
    v_add_f32 v63, v63, v67
    s_waitcnt lgkmcnt(0)
    v_add_f32 v68, v68, v72
    v_add_f32 v69, v69, v73
    v_add_f32 v70, v70, v74
    v_add_f32 v71, v71, v75
    v_add_f32 v60, v60, v68
    v_add_f32 v61, v61, v69
    v_add_f32 v62, v62, v70
    v_add_f32 v63, v63, v71
    v_sub_f32 v60, v60, v38
    v_sub_f32 v61, v61, v38
    v_sub_f32 v62, v62, v38
    v_sub_f32 v63, v63, v38
    s_cmp_eq_u32 s2, 255
    s_cbranch_scc1 L_rsolo
    v_perm_b32 v60, v60, v22, s84
    v_perm_b32 v61, v61, v22, s85
    v_perm_b32 v62, v62, v22, s86
    v_perm_b32 v63, v63, v22, s87
    buffer_store_dwordx4 v[60:63], v19, s[24:27], s71 offen sc1
    s_mov_b64 exec, 15
    buffer_store_dwordx4 v[36:39], v20, s[24:27], s71 offen sc1
    s_mov_b64 exec, -1
    s_cmp_eq_u32 s101, 0
    s_cbranch_scc0 L_rp20
    v_mov_b32 v164, v60
    v_mov_b32 v168, v36
    v_mov_b32 v165, v61
    v_mov_b32 v169, v37
    v_mov_b32 v166, v62
    v_mov_b32 v170, v38
    v_mov_b32 v167, v63
    v_mov_b32 v171, v39
    s_branch L_rp22
L_rp20:
    s_cmp_eq_u32 s101, 1
    s_cbranch_scc0 L_rp21
    v_mov_b32 v172, v60
    v_mov_b32 v176, v36
    v_mov_b32 v173, v61
    v_mov_b32 v177, v37
    v_mov_b32 v174, v62
    v_mov_b32 v178, v38
    v_mov_b32 v175, v63
    v_mov_b32 v179, v39
    s_branch L_rp22
L_rp21:
    v_mov_b32 v180, v60
    v_mov_b32 v184, v36
    v_mov_b32 v181, v61
    v_mov_b32 v185, v37
    v_mov_b32 v182, v62
    v_mov_b32 v186, v38
    v_mov_b32 v183, v63
    v_mov_b32 v187, v39
L_rp22:
    s_waitcnt vmcnt(4)
    v_xor_b32 v40, v171, v22
    v_xor_b32 v41, v179, v22
    v_xor_b32 v42, v187, v22
    v_or3_b32 v4, v40, v41, v42
    s_waitcnt vmcnt(2)
    v_perm_b32 v5, v165, v164, s88
    v_perm_b32 v6, v167, v166, s89
    v_bitop3_b32 v5, v5, v6, v22 bitop3:0x56
    v_or_b32 v4, v4, v5
    v_perm_b32 v5, v173, v172, s88
    v_perm_b32 v6, v175, v174, s89
    v_bitop3_b32 v5, v5, v6, v22 bitop3:0x56
    v_or_b32 v4, v4, v5
    v_perm_b32 v5, v181, v180, s88
    v_perm_b32 v6, v183, v182, s89
    v_bitop3_b32 v5, v5, v6, v22 bitop3:0x56
    v_or_b32 v4, v4, v5
    v_cmp_eq_u32 vcc, 0, v4
    s_nop 4
    s_cmp_eq_u64 vcc, -1
    s_cbranch_scc1 L_rmerge
    s_waitcnt vmcnt(0)
    s_cmp_eq_u32 s101, 0
    s_cbranch_scc0 L_rp30
    buffer_load_dwordx4 v[176:179], v20, s[24:27], s69 offen sc1
    buffer_load_dwordx4 v[184:187], v20, s[24:27], s70 offen sc1
    buffer_load_dwordx4 v[172:175], v19, s[24:27], s69 offen sc1
    buffer_load_dwordx4 v[180:183], v19, s[24:27], s70 offen sc1
    s_branch L_rp32
L_rp30:
    s_cmp_eq_u32 s101, 1
    s_cbranch_scc0 L_rp31
    buffer_load_dwordx4 v[168:171], v20, s[24:27], s68 offen sc1
    buffer_load_dwordx4 v[184:187], v20, s[24:27], s70 offen sc1
    buffer_load_dwordx4 v[164:167], v19, s[24:27], s68 offen sc1
    buffer_load_dwordx4 v[180:183], v19, s[24:27], s70 offen sc1
    s_branch L_rp32
L_rp31:
    buffer_load_dwordx4 v[168:171], v20, s[24:27], s68 offen sc1
    buffer_load_dwordx4 v[176:179], v20, s[24:27], s69 offen sc1
    buffer_load_dwordx4 v[164:167], v19, s[24:27], s68 offen sc1
    buffer_load_dwordx4 v[172:175], v19, s[24:27], s69 offen sc1
L_rp32:
    s_waitcnt vmcnt(2)
    v_xor_b32 v40, v171, v22
    v_xor_b32 v41, v179, v22
    v_xor_b32 v42, v187, v22
    v_or3_b32 v4, v40, v41, v42
    s_waitcnt vmcnt(0)
    v_perm_b32 v5, v165, v164, s88
    v_perm_b32 v6, v167, v166, s89
    v_bitop3_b32 v5, v5, v6, v22 bitop3:0x56
    v_or_b32 v4, v4, v5
    v_perm_b32 v5, v173, v172, s88
    v_perm_b32 v6, v175, v174, s89
    v_bitop3_b32 v5, v5, v6, v22 bitop3:0x56
    v_or_b32 v4, v4, v5
    v_perm_b32 v5, v181, v180, s88
    v_perm_b32 v6, v183, v182, s89
    v_bitop3_b32 v5, v5, v6, v22 bitop3:0x56
    v_or_b32 v4, v4, v5
    v_cmp_eq_u32 vcc, 0, v4
L_rmerge:
    v_max3_f32 v3, v168, v176, v184
    v_sub_f32 v168, v168, v3
    v_sub_f32 v176, v176, v3
    v_sub_f32 v184, v184, v3
    v_exp_f32 v168, v168
    v_exp_f32 v176, v176
    v_exp_f32 v184, v184
    s_and_b64 exec, exec, vcc
    s_cbranch_execz L_fin
    v_and_b32 v164, s90, v164
    v_and_b32 v165, s90, v165
    v_and_b32 v166, s90, v166
    v_and_b32 v167, s90, v167
    v_and_b32 v172, s90, v172
    v_and_b32 v173, s90, v173
    v_and_b32 v174, s90, v174
    v_and_b32 v175, s90, v175
    v_and_b32 v180, s90, v180
    v_and_b32 v181, s90, v181
    v_and_b32 v182, s90, v182
    v_and_b32 v183, s90, v183
    v_mul_f32 v37, v168, v169
    v_fmac_f32 v37, v176, v177
    v_fmac_f32 v37, v184, v185
    v_mul_f32 v60, v164, v168
    v_fmac_f32 v60, v172, v176
    v_fmac_f32 v60, v180, v184
    v_mul_f32 v61, v165, v168
    v_fmac_f32 v61, v173, v176
    v_fmac_f32 v61, v181, v184
    v_mul_f32 v62, v166, v168
    v_fmac_f32 v62, v174, v176
    v_fmac_f32 v62, v182, v184
    v_mul_f32 v63, v167, v168
    v_fmac_f32 v63, v175, v176
    v_fmac_f32 v63, v183, v184
L_rsolo:
    v_rcp_f32 v37, v37
    s_nop 0
    v_mul_f32 v60, v60, v37
    v_mul_f32 v61, v61, v37
    v_mul_f32 v62, v62, v37
    v_mul_f32 v63, v63, v37
    v_cvt_pk_bf16_f32 v64, v60, v61
    v_cvt_pk_bf16_f32 v65, v62, v63
    buffer_store_dwordx2 v[64:65], v21, s[48:51], s57 offen
    s_branch L_fin
L_finisher:
    v_and_b32 v14, 3, v1
    v_mul_u32_u24 v8, 384, v14
    v_lshrrev_b32 v13, 2, v1
    v_lshl_add_u32 v8, v13, 3, v8
    v_lshlrev_b32 v9, 4, v1
    v_lshlrev_b32 v14, 4, v14
    s_memrealtime s[96:97]
    s_waitcnt lgkmcnt(0)
    s_mov_b32 s48, s18
    s_and_b32 s49, s19, 0xffff
    s_mov_b32 s50, 393216
    s_mov_b32 s51, 0x20000
    s_mov_b32 s52, s20
    s_and_b32 s53, s21, 0xffff
    s_mov_b32 s54, 256
    s_mov_b32 s55, 0x20000
    s_mov_b32 s24, s22
    s_and_b32 s25, s23, 0xffff
    s_mov_b32 s26, 2528256
    s_mov_b32 s27, 0x20000
L_fk:
    s_waitcnt vmcnt(63)
    s_movk_i32 s69, 4
L_fb1:
    s_barrier
    s_sub_u32 s69, s69, 1
    s_cmp_lg_u32 s69, 0
    s_cbranch_scc1 L_fb1
    s_waitcnt vmcnt(0)
    s_cmp_eq_u32 s2, 0
    s_cbranch_scc0 L_fk2
    s_or_b32 s71, s96, 1
    v_mov_b32 v16, s71
    v_mov_b32 v17, 0
    s_mov_b64 exec, 1
    buffer_atomic_cmpswap v[16:17], v9, s[52:55], 0 offen sc1
    s_mov_b64 exec, -1
L_fk2:
    s_movk_i32 s69, 124
L_fb2:
    s_barrier
    s_sub_u32 s69, s69, 1
    s_cmp_lg_u32 s69, 0
    s_cbranch_scc1 L_fb2
    s_load_dword s71, s[20:21], 0
    s_barrier
    s_waitcnt lgkmcnt(0)
    s_cmp_eq_u32 s71, 0
    s_cbranch_scc0 L_ftag
    s_or_b32 s71, s96, 1
    v_mov_b32 v16, s71
    v_mov_b32 v17, 0
    s_mov_b64 exec, 1
    buffer_atomic_cmpswap v[16:17], v9, s[52:55], 0 offen sc0 sc1
    s_mov_b64 exec, -1
    s_waitcnt vmcnt(0)
    v_readfirstlane_b32 s58, v16
    s_nop 3
    s_cmp_eq_u32 s58, 0
    s_cselect_b32 s71, s71, s58
L_ftag:
    v_mov_b32 v10, s71
    v_mov_b32 v13, 154884
    ds_write_b32 v13, v10
    s_lshr_b32 s63, s101, 1
    s_lshl_b32 s58, s100, 1
    s_add_u32 s63, s63, s58
    s_mul_i32 s62, s63, 8704
    s_add_u32 s62, s62, 1048576
    s_waitcnt lgkmcnt(0)
    s_cmp_eq_u32 s2, 255
    s_cbranch_scc1 L_fin
    s_cmp_eq_u32 s101, 1
    s_cbranch_scc1 L_fmid
    s_movk_i32 s69, 89
L_fb3:
    s_barrier
    s_sub_u32 s69, s69, 1
    s_cmp_lg_u32 s69, 0
    s_cbranch_scc1 L_fb3
    v_add_u32 v13, 142336, v14
    v_lshlrev_b32 v11, 2, v1
    v_add_u32 v11, 142592, v11
    ds_read_b128 v[16:19], v13 offset:0
    ds_read_b128 v[20:23], v13 offset:64
    ds_read_b128 v[24:27], v13 offset:128
    ds_read_b128 v[28:31], v13 offset:192
    ds_read2st64_b32 v[32:33], v11 offset0:0 offset1:1
    ds_read2st64_b32 v[34:35], v11 offset0:2 offset1:3
    ds_read2st64_b32 v[36:37], v11 offset0:4 offset1:5
    ds_read2st64_b32 v[38:39], v11 offset0:6 offset1:7
    ds_read2st64_b32 v[40:41], v11 offset0:8 offset1:9
    ds_read2st64_b32 v[42:43], v11 offset0:10 offset1:11
    ds_read2st64_b32 v[44:45], v11 offset0:12 offset1:13
    ds_read2st64_b32 v[46:47], v11 offset0:14 offset1:15
    s_waitcnt lgkmcnt(4)
    ds_read2st64_b32 v[48:49], v11 offset0:16 offset1:17
    ds_read2st64_b32 v[50:51], v11 offset0:18 offset1:19
    ds_read2st64_b32 v[52:53], v11 offset0:20 offset1:21
    ds_read2st64_b32 v[54:55], v11 offset0:22 offset1:23
    ds_read2st64_b32 v[56:57], v11 offset0:24 offset1:25
    ds_read2st64_b32 v[58:59], v11 offset0:26 offset1:27
    ds_read2st64_b32 v[60:61], v11 offset0:28 offset1:29
    ds_read2st64_b32 v[62:63], v11 offset0:30 offset1:31
    s_waitcnt lgkmcnt(4)
    ds_read2st64_b32 v[64:65], v11 offset0:32 offset1:33
    ds_read2st64_b32 v[66:67], v11 offset0:34 offset1:35
    ds_read2st64_b32 v[68:69], v11 offset0:36 offset1:37
    ds_read2st64_b32 v[70:71], v11 offset0:38 offset1:39
    ds_read2st64_b32 v[72:73], v11 offset0:40 offset1:41
    ds_read2st64_b32 v[74:75], v11 offset0:42 offset1:43
    ds_read2st64_b32 v[76:77], v11 offset0:44 offset1:45
    ds_read2st64_b32 v[78:79], v11 offset0:46 offset1:47
    v_mov_b32 v83, v10
    v_mov_b32 v87, v10
    v_mov_b32 v91, v10
    v_mov_b32 v95, v10
    v_mov_b32 v99, v10
    v_mov_b32 v96, v16
    v_add_f32 v17, v17, v21
    v_add_f32 v25, v25, v29
    v_add_f32 v97, v17, v25
    v_add_f32 v18, v18, v22
    v_add_f32 v26, v26, v30
    v_add_f32 v98, v18, v26
    s_waitcnt lgkmcnt(0)
    v_add_f32 v32, v32, v44
    v_add_f32 v56, v56, v68
    v_add_f32 v32, v32, v56
    v_sub_f32 v80, v32, v98
    v_add_f32 v33, v33, v45
    v_add_f32 v57, v57, v69
    v_add_f32 v33, v33, v57
    v_sub_f32 v81, v33, v98
    v_add_f32 v34, v34, v46
    v_add_f32 v58, v58, v70
    v_add_f32 v34, v34, v58
    v_sub_f32 v82, v34, v98
    v_add_f32 v35, v35, v47
    v_add_f32 v59, v59, v71
    v_add_f32 v35, v35, v59
    v_sub_f32 v84, v35, v98
    v_add_f32 v36, v36, v48
    v_add_f32 v60, v60, v72
    v_add_f32 v36, v36, v60
    v_sub_f32 v85, v36, v98
    v_add_f32 v37, v37, v49
    v_add_f32 v61, v61, v73
    v_add_f32 v37, v37, v61
    v_sub_f32 v86, v37, v98
    v_add_f32 v38, v38, v50
    v_add_f32 v62, v62, v74
    v_add_f32 v38, v38, v62
    v_sub_f32 v88, v38, v98
    v_add_f32 v39, v39, v51
    v_add_f32 v63, v63, v75
    v_add_f32 v39, v39, v63
    v_sub_f32 v89, v39, v98
    v_add_f32 v40, v40, v52
    v_add_f32 v64, v64, v76
    v_add_f32 v40, v40, v64
    v_sub_f32 v90, v40, v98
    v_add_f32 v41, v41, v53
    v_add_f32 v65, v65, v77
    v_add_f32 v41, v41, v65
    v_sub_f32 v92, v41, v98
    v_add_f32 v42, v42, v54
    v_add_f32 v66, v66, v78
    v_add_f32 v42, v42, v66
    v_sub_f32 v93, v42, v98
    v_add_f32 v43, v43, v55
    v_add_f32 v67, v67, v79
    v_add_f32 v43, v43, v67
    v_sub_f32 v94, v43, v98
    s_movk_i32 s69, 39
L_fb4:
    s_barrier
    s_sub_u32 s69, s69, 1
    s_cmp_lg_u32 s69, 0
    s_cbranch_scc1 L_fb4
    s_barrier
    s_mov_b32 s69, 2
L_fo5:
    s_add_u32 s58, s62, 4352
    s_add_u32 s59, s62, 8448
    buffer_load_dwordx4 v[116:119], v14, s[24:27], s59 offen sc1
    buffer_load_dwordx4 v[100:103], v9, s[24:27], s58 offen offset:0 sc1
    buffer_load_dwordx4 v[104:107], v9, s[24:27], s58 offen offset:1024 sc1
    buffer_load_dwordx4 v[108:111], v9, s[24:27], s58 offen offset:2048 sc1
    buffer_load_dwordx4 v[112:115], v9, s[24:27], s58 offen offset:3072 sc1
    s_waitcnt vmcnt(0)
    v_xor_b32 v13, v10, v103
    v_xor_b32 v11, v10, v107
    v_or_b32 v13, v13, v11
    v_xor_b32 v11, v10, v111
    v_or_b32 v13, v13, v11
    v_xor_b32 v11, v10, v115
    v_or_b32 v13, v13, v11
    v_xor_b32 v11, v10, v119
    v_or_b32 v13, v13, v11
    v_cmp_ne_u32 vcc, 0, v13
    s_nop 4
    s_cmp_eq_u64 vcc, 0
    s_cbranch_scc1 L_fo7
    s_sub_u32 s69, s69, 1
    s_cmp_lg_u32 s69, 0
    s_cbranch_scc1 L_fo5
    s_add_u32 s58, s62, 0
    s_add_u32 s59, s62, 4096
    buffer_store_dwordx4 v[80:83], v9, s[24:27], s58 offen offset:0 sc1
    buffer_store_dwordx4 v[84:87], v9, s[24:27], s58 offen offset:1024 sc1
    buffer_store_dwordx4 v[88:91], v9, s[24:27], s58 offen offset:2048 sc1
    buffer_store_dwordx4 v[92:95], v9, s[24:27], s58 offen offset:3072 sc1
    s_mov_b64 exec, 15
    buffer_store_dwordx4 v[96:99], v14, s[24:27], s59 offen sc1
    s_mov_b64 exec, -1
    s_waitcnt vmcnt(0)
    s_add_u32 s58, s62, 4352
    s_add_u32 s59, s62, 8448
    buffer_load_dwordx4 v[116:119], v14, s[24:27], s59 offen sc1
    buffer_load_dwordx4 v[100:103], v9, s[24:27], s58 offen offset:0 sc1
    buffer_load_dwordx4 v[104:107], v9, s[24:27], s58 offen offset:1024 sc1
    buffer_load_dwordx4 v[108:111], v9, s[24:27], s58 offen offset:2048 sc1
    buffer_load_dwordx4 v[112:115], v9, s[24:27], s58 offen offset:3072 sc1
    s_waitcnt vmcnt(0)
    v_xor_b32 v13, v10, v103
    v_xor_b32 v11, v10, v107
    v_or_b32 v13, v13, v11
    v_xor_b32 v11, v10, v111
    v_or_b32 v13, v13, v11
    v_xor_b32 v11, v10, v115
    v_or_b32 v13, v13, v11
    v_xor_b32 v11, v10, v119
    v_or_b32 v13, v13, v11
    v_cmp_ne_u32 vcc, 0, v13
    s_nop 4
    s_cmp_eq_u64 vcc, 0
    s_cbranch_scc0 L_fin
L_fo7:
    v_max_f32 v11, v96, v116
    v_sub_f32 v16, v96, v11
    v_sub_f32 v17, v116, v11
    v_exp_f32 v16, v16
    v_exp_f32 v17, v17
    s_nop 0
    v_mul_f32 v12, v16, v97
    v_fmac_f32 v12, v17, v117
    v_rcp_f32 v12, v12
    s_add_u32 s58, s63, 0
    s_mul_i32 s58, s58, 1536
    v_mul_f32 v16, v16, v12
    v_mul_f32 v17, v17, v12
    v_mul_f32 v32, v80, v16
    v_fmac_f32 v32, v100, v17
    v_mul_f32 v33, v81, v16
    v_fmac_f32 v33, v101, v17
    v_mul_f32 v34, v82, v16
    v_fmac_f32 v34, v102, v17
    v_mul_f32 v35, v84, v16
    v_fmac_f32 v35, v104, v17
    v_mul_f32 v36, v85, v16
    v_fmac_f32 v36, v105, v17
    v_mul_f32 v37, v86, v16
    v_fmac_f32 v37, v106, v17
    v_mul_f32 v38, v88, v16
    v_fmac_f32 v38, v108, v17
    v_mul_f32 v39, v89, v16
    v_fmac_f32 v39, v109, v17
    v_mul_f32 v40, v90, v16
    v_fmac_f32 v40, v110, v17
    v_mul_f32 v41, v92, v16
    v_fmac_f32 v41, v112, v17
    v_mul_f32 v42, v93, v16
    v_fmac_f32 v42, v113, v17
    v_mul_f32 v43, v94, v16
    v_fmac_f32 v43, v114, v17
    v_cvt_pk_bf16_f32 v44, v32, v33
    v_cvt_pk_bf16_f32 v45, v34, v35
    v_cvt_pk_bf16_f32 v46, v36, v37
    v_cvt_pk_bf16_f32 v47, v38, v39
    v_cvt_pk_bf16_f32 v48, v40, v41
    v_cvt_pk_bf16_f32 v49, v42, v43
    buffer_store_dwordx2 v[44:45], v8, s[48:51], s58 offen offset:0
    buffer_store_dwordx2 v[46:47], v8, s[48:51], s58 offen offset:128
    buffer_store_dwordx2 v[48:49], v8, s[48:51], s58 offen offset:256
    s_branch L_fin
L_fmid:
    v_and_b32 v7, 1, v1
    v_mul_u32_u24 v7, 8704, v7
    v_add_u32 v7, 4108, v7
    s_movk_i32 s69, 41
L_fb5:
    s_barrier
    s_sub_u32 s69, s69, 1
    s_cmp_lg_u32 s69, 0
    s_cbranch_scc1 L_fb5
    v_add_u32 v13, 142336, v14
    v_lshlrev_b32 v11, 2, v1
    v_add_u32 v11, 142592, v11
    ds_read_b128 v[16:19], v13 offset:0
    ds_read_b128 v[20:23], v13 offset:64
    ds_read_b128 v[24:27], v13 offset:128
    ds_read_b128 v[28:31], v13 offset:192
    ds_read2st64_b32 v[32:33], v11 offset0:0 offset1:1
    ds_read2st64_b32 v[34:35], v11 offset0:2 offset1:3
    ds_read2st64_b32 v[36:37], v11 offset0:4 offset1:5
    ds_read2st64_b32 v[38:39], v11 offset0:6 offset1:7
    ds_read2st64_b32 v[40:41], v11 offset0:8 offset1:9
    ds_read2st64_b32 v[42:43], v11 offset0:10 offset1:11
    ds_read2st64_b32 v[44:45], v11 offset0:12 offset1:13
    ds_read2st64_b32 v[46:47], v11 offset0:14 offset1:15
    s_waitcnt lgkmcnt(4)
    ds_read2st64_b32 v[48:49], v11 offset0:16 offset1:17
    ds_read2st64_b32 v[50:51], v11 offset0:18 offset1:19
    ds_read2st64_b32 v[52:53], v11 offset0:20 offset1:21
    ds_read2st64_b32 v[54:55], v11 offset0:22 offset1:23
    ds_read2st64_b32 v[56:57], v11 offset0:24 offset1:25
    ds_read2st64_b32 v[58:59], v11 offset0:26 offset1:27
    ds_read2st64_b32 v[60:61], v11 offset0:28 offset1:29
    ds_read2st64_b32 v[62:63], v11 offset0:30 offset1:31
    s_waitcnt lgkmcnt(4)
    ds_read2st64_b32 v[64:65], v11 offset0:32 offset1:33
    ds_read2st64_b32 v[66:67], v11 offset0:34 offset1:35
    ds_read2st64_b32 v[68:69], v11 offset0:36 offset1:37
    ds_read2st64_b32 v[70:71], v11 offset0:38 offset1:39
    ds_read2st64_b32 v[72:73], v11 offset0:40 offset1:41
    ds_read2st64_b32 v[74:75], v11 offset0:42 offset1:43
    ds_read2st64_b32 v[76:77], v11 offset0:44 offset1:45
    ds_read2st64_b32 v[78:79], v11 offset0:46 offset1:47
    v_mov_b32 v83, v10
    v_mov_b32 v87, v10
    v_mov_b32 v91, v10
    v_mov_b32 v95, v10
    v_mov_b32 v99, v10
    v_mov_b32 v96, v16
    v_add_f32 v17, v17, v21
    v_add_f32 v25, v25, v29
    v_add_f32 v97, v17, v25
    v_add_f32 v18, v18, v22
    v_add_f32 v26, v26, v30
    v_add_f32 v98, v18, v26
    s_waitcnt lgkmcnt(0)
    v_add_f32 v32, v32, v44
    v_add_f32 v56, v56, v68
    v_add_f32 v32, v32, v56
    v_sub_f32 v80, v32, v98
    v_add_f32 v33, v33, v45
    v_add_f32 v57, v57, v69
    v_add_f32 v33, v33, v57
    v_sub_f32 v81, v33, v98
    v_add_f32 v34, v34, v46
    v_add_f32 v58, v58, v70
    v_add_f32 v34, v34, v58
    v_sub_f32 v82, v34, v98
    v_add_f32 v35, v35, v47
    v_add_f32 v59, v59, v71
    v_add_f32 v35, v35, v59
    v_sub_f32 v84, v35, v98
    v_add_f32 v36, v36, v48
    v_add_f32 v60, v60, v72
    v_add_f32 v36, v36, v60
    v_sub_f32 v85, v36, v98
    v_add_f32 v37, v37, v49
    v_add_f32 v61, v61, v73
    v_add_f32 v37, v37, v61
    v_sub_f32 v86, v37, v98
    v_add_f32 v38, v38, v50
    v_add_f32 v62, v62, v74
    v_add_f32 v38, v38, v62
    v_sub_f32 v88, v38, v98
    v_add_f32 v39, v39, v51
    v_add_f32 v63, v63, v75
    v_add_f32 v39, v39, v63
    v_sub_f32 v89, v39, v98
    v_add_f32 v40, v40, v52
    v_add_f32 v64, v64, v76
    v_add_f32 v40, v40, v64
    v_sub_f32 v90, v40, v98
    v_add_f32 v41, v41, v53
    v_add_f32 v65, v65, v77
    v_add_f32 v41, v41, v65
    v_sub_f32 v92, v41, v98
    v_add_f32 v42, v42, v54
    v_add_f32 v66, v66, v78
    v_add_f32 v42, v42, v66
    v_sub_f32 v93, v42, v98
    v_add_f32 v43, v43, v55
    v_add_f32 v67, v67, v79
    v_add_f32 v43, v43, v67
    v_sub_f32 v94, v43, v98
    s_movk_i32 s69, 40
L_fb6:
    s_barrier
    s_sub_u32 s69, s69, 1
    s_cmp_lg_u32 s69, 0
    s_cbranch_scc1 L_fb6
    v_add_u32 v13, 142336, v14
    v_lshlrev_b32 v11, 2, v1
    v_add_u32 v11, 142592, v11
    ds_read_b128 v[16:19], v13 offset:0
    ds_read_b128 v[20:23], v13 offset:64
    ds_read_b128 v[24:27], v13 offset:128
    ds_read_b128 v[28:31], v13 offset:192
    ds_read2st64_b32 v[32:33], v11 offset0:0 offset1:1
    ds_read2st64_b32 v[34:35], v11 offset0:2 offset1:3
    ds_read2st64_b32 v[36:37], v11 offset0:4 offset1:5
    ds_read2st64_b32 v[38:39], v11 offset0:6 offset1:7
    ds_read2st64_b32 v[40:41], v11 offset0:8 offset1:9
    ds_read2st64_b32 v[42:43], v11 offset0:10 offset1:11
    ds_read2st64_b32 v[44:45], v11 offset0:12 offset1:13
    ds_read2st64_b32 v[46:47], v11 offset0:14 offset1:15
    s_waitcnt lgkmcnt(4)
    ds_read2st64_b32 v[48:49], v11 offset0:16 offset1:17
    ds_read2st64_b32 v[50:51], v11 offset0:18 offset1:19
    ds_read2st64_b32 v[52:53], v11 offset0:20 offset1:21
    ds_read2st64_b32 v[54:55], v11 offset0:22 offset1:23
    ds_read2st64_b32 v[56:57], v11 offset0:24 offset1:25
    ds_read2st64_b32 v[58:59], v11 offset0:26 offset1:27
    ds_read2st64_b32 v[60:61], v11 offset0:28 offset1:29
    ds_read2st64_b32 v[62:63], v11 offset0:30 offset1:31
    s_waitcnt lgkmcnt(4)
    ds_read2st64_b32 v[64:65], v11 offset0:32 offset1:33
    ds_read2st64_b32 v[66:67], v11 offset0:34 offset1:35
    ds_read2st64_b32 v[68:69], v11 offset0:36 offset1:37
    ds_read2st64_b32 v[70:71], v11 offset0:38 offset1:39
    ds_read2st64_b32 v[72:73], v11 offset0:40 offset1:41
    ds_read2st64_b32 v[74:75], v11 offset0:42 offset1:43
    ds_read2st64_b32 v[76:77], v11 offset0:44 offset1:45
    ds_read2st64_b32 v[78:79], v11 offset0:46 offset1:47
    v_mov_b32 v103, v10
    v_mov_b32 v107, v10
    v_mov_b32 v111, v10
    v_mov_b32 v115, v10
    v_mov_b32 v119, v10
    v_mov_b32 v116, v16
    v_add_f32 v17, v17, v21
    v_add_f32 v25, v25, v29
    v_add_f32 v117, v17, v25
    v_add_f32 v18, v18, v22
    v_add_f32 v26, v26, v30
    v_add_f32 v118, v18, v26
    s_waitcnt lgkmcnt(0)
    v_add_f32 v32, v32, v44
    v_add_f32 v56, v56, v68
    v_add_f32 v32, v32, v56
    v_sub_f32 v100, v32, v118
    v_add_f32 v33, v33, v45
    v_add_f32 v57, v57, v69
    v_add_f32 v33, v33, v57
    v_sub_f32 v101, v33, v118
    v_add_f32 v34, v34, v46
    v_add_f32 v58, v58, v70
    v_add_f32 v34, v34, v58
    v_sub_f32 v102, v34, v118
    v_add_f32 v35, v35, v47
    v_add_f32 v59, v59, v71
    v_add_f32 v35, v35, v59
    v_sub_f32 v104, v35, v118
    v_add_f32 v36, v36, v48
    v_add_f32 v60, v60, v72
    v_add_f32 v36, v36, v60
    v_sub_f32 v105, v36, v118
    v_add_f32 v37, v37, v49
    v_add_f32 v61, v61, v73
    v_add_f32 v37, v37, v61
    v_sub_f32 v106, v37, v118
    v_add_f32 v38, v38, v50
    v_add_f32 v62, v62, v74
    v_add_f32 v38, v38, v62
    v_sub_f32 v108, v38, v118
    v_add_f32 v39, v39, v51
    v_add_f32 v63, v63, v75
    v_add_f32 v39, v39, v63
    v_sub_f32 v109, v39, v118
    v_add_f32 v40, v40, v52
    v_add_f32 v64, v64, v76
    v_add_f32 v40, v40, v64
    v_sub_f32 v110, v40, v118
    v_add_f32 v41, v41, v53
    v_add_f32 v65, v65, v77
    v_add_f32 v41, v41, v65
    v_sub_f32 v112, v41, v118
    v_add_f32 v42, v42, v54
    v_add_f32 v66, v66, v78
    v_add_f32 v42, v42, v66
    v_sub_f32 v113, v42, v118
    v_add_f32 v43, v43, v55
    v_add_f32 v67, v67, v79
    v_add_f32 v43, v43, v67
    v_sub_f32 v114, v43, v118
    s_movk_i32 s69, 46
L_fb7:
    s_barrier
    s_sub_u32 s69, s69, 1
    s_cmp_lg_u32 s69, 0
    s_cbranch_scc1 L_fb7
    s_add_u32 s58, s62, 4352
    s_add_u32 s59, s62, 8448
    buffer_store_dwordx4 v[80:83], v9, s[24:27], s58 offen offset:0 sc1
    buffer_store_dwordx4 v[84:87], v9, s[24:27], s58 offen offset:1024 sc1
    buffer_store_dwordx4 v[88:91], v9, s[24:27], s58 offen offset:2048 sc1
    buffer_store_dwordx4 v[92:95], v9, s[24:27], s58 offen offset:3072 sc1
    s_mov_b64 exec, 15
    buffer_store_dwordx4 v[96:99], v14, s[24:27], s59 offen sc1
    s_mov_b64 exec, -1
    s_add_u32 s58, s62, 13056
    s_add_u32 s59, s62, 17152
    buffer_store_dwordx4 v[100:103], v9, s[24:27], s58 offen offset:0 sc1
    buffer_store_dwordx4 v[104:107], v9, s[24:27], s58 offen offset:1024 sc1
    buffer_store_dwordx4 v[108:111], v9, s[24:27], s58 offen offset:2048 sc1
    buffer_store_dwordx4 v[112:115], v9, s[24:27], s58 offen offset:3072 sc1
    s_mov_b64 exec, 15
    buffer_store_dwordx4 v[116:119], v14, s[24:27], s59 offen sc1
    s_mov_b64 exec, -1
    s_barrier
    s_barrier
    s_waitcnt vmcnt(0)
    buffer_load_dword v15, v7, s[24:27], s62 offen sc1
    s_waitcnt vmcnt(0)
    v_cmp_eq_u32 vcc, v15, v10
    s_nop 4
    s_and_b32 s70, vcc_lo, 3
    s_cbranch_scc0 L_fin
    s_bitcmp1_b32 s70, 0
    s_cbranch_scc0 L_fm30
    s_waitcnt vmcnt(0)
    s_add_u32 s58, s62, 0
    s_add_u32 s59, s62, 4096
    buffer_load_dwordx4 v[136:139], v14, s[24:27], s59 offen sc1
    buffer_load_dwordx4 v[120:123], v9, s[24:27], s58 offen offset:0 sc1
    buffer_load_dwordx4 v[124:127], v9, s[24:27], s58 offen offset:1024 sc1
    buffer_load_dwordx4 v[128:131], v9, s[24:27], s58 offen offset:2048 sc1
    buffer_load_dwordx4 v[132:135], v9, s[24:27], s58 offen offset:3072 sc1
    s_waitcnt vmcnt(0)
    v_xor_b32 v13, v10, v123
    v_xor_b32 v11, v10, v127
    v_or_b32 v13, v13, v11
    v_xor_b32 v11, v10, v131
    v_or_b32 v13, v13, v11
    v_xor_b32 v11, v10, v135
    v_or_b32 v13, v13, v11
    v_xor_b32 v11, v10, v139
    v_or_b32 v13, v13, v11
    v_cmp_ne_u32 vcc, 0, v13
    s_nop 4
    s_cmp_eq_u64 vcc, 0
    s_cbranch_scc0 L_fm30
    v_max_f32 v11, v136, v96
    v_sub_f32 v16, v136, v11
    v_sub_f32 v17, v96, v11
    v_exp_f32 v16, v16
    v_exp_f32 v17, v17
    s_nop 0
    v_mul_f32 v12, v16, v137
    v_fmac_f32 v12, v17, v97
    v_rcp_f32 v12, v12
    s_add_u32 s58, s63, 0
    s_mul_i32 s58, s58, 1536
    v_mul_f32 v16, v16, v12
    v_mul_f32 v17, v17, v12
    v_mul_f32 v32, v120, v16
    v_fmac_f32 v32, v80, v17
    v_mul_f32 v33, v121, v16
    v_fmac_f32 v33, v81, v17
    v_mul_f32 v34, v122, v16
    v_fmac_f32 v34, v82, v17
    v_mul_f32 v35, v124, v16
    v_fmac_f32 v35, v84, v17
    v_mul_f32 v36, v125, v16
    v_fmac_f32 v36, v85, v17
    v_mul_f32 v37, v126, v16
    v_fmac_f32 v37, v86, v17
    v_mul_f32 v38, v128, v16
    v_fmac_f32 v38, v88, v17
    v_mul_f32 v39, v129, v16
    v_fmac_f32 v39, v89, v17
    v_mul_f32 v40, v130, v16
    v_fmac_f32 v40, v90, v17
    v_mul_f32 v41, v132, v16
    v_fmac_f32 v41, v92, v17
    v_mul_f32 v42, v133, v16
    v_fmac_f32 v42, v93, v17
    v_mul_f32 v43, v134, v16
    v_fmac_f32 v43, v94, v17
    v_cvt_pk_bf16_f32 v44, v32, v33
    v_cvt_pk_bf16_f32 v45, v34, v35
    v_cvt_pk_bf16_f32 v46, v36, v37
    v_cvt_pk_bf16_f32 v47, v38, v39
    v_cvt_pk_bf16_f32 v48, v40, v41
    v_cvt_pk_bf16_f32 v49, v42, v43
    buffer_store_dwordx2 v[44:45], v8, s[48:51], s58 offen offset:0
    buffer_store_dwordx2 v[46:47], v8, s[48:51], s58 offen offset:128
    buffer_store_dwordx2 v[48:49], v8, s[48:51], s58 offen offset:256
L_fm30:
    s_bitcmp1_b32 s70, 1
    s_cbranch_scc0 L_fm31
    s_waitcnt vmcnt(0)
    s_add_u32 s58, s62, 8704
    s_add_u32 s59, s62, 12800
    buffer_load_dwordx4 v[136:139], v14, s[24:27], s59 offen sc1
    buffer_load_dwordx4 v[120:123], v9, s[24:27], s58 offen offset:0 sc1
    buffer_load_dwordx4 v[124:127], v9, s[24:27], s58 offen offset:1024 sc1
    buffer_load_dwordx4 v[128:131], v9, s[24:27], s58 offen offset:2048 sc1
    buffer_load_dwordx4 v[132:135], v9, s[24:27], s58 offen offset:3072 sc1
    s_waitcnt vmcnt(0)
    v_xor_b32 v13, v10, v123
    v_xor_b32 v11, v10, v127
    v_or_b32 v13, v13, v11
    v_xor_b32 v11, v10, v131
    v_or_b32 v13, v13, v11
    v_xor_b32 v11, v10, v135
    v_or_b32 v13, v13, v11
    v_xor_b32 v11, v10, v139
    v_or_b32 v13, v13, v11
    v_cmp_ne_u32 vcc, 0, v13
    s_nop 4
    s_cmp_eq_u64 vcc, 0
    s_cbranch_scc0 L_fm31
    v_max_f32 v11, v136, v116
    v_sub_f32 v16, v136, v11
    v_sub_f32 v17, v116, v11
    v_exp_f32 v16, v16
    v_exp_f32 v17, v17
    s_nop 0
    v_mul_f32 v12, v16, v137
    v_fmac_f32 v12, v17, v117
    v_rcp_f32 v12, v12
    s_add_u32 s58, s63, 1
    s_mul_i32 s58, s58, 1536
    v_mul_f32 v16, v16, v12
    v_mul_f32 v17, v17, v12
    v_mul_f32 v32, v120, v16
    v_fmac_f32 v32, v100, v17
    v_mul_f32 v33, v121, v16
    v_fmac_f32 v33, v101, v17
    v_mul_f32 v34, v122, v16
    v_fmac_f32 v34, v102, v17
    v_mul_f32 v35, v124, v16
    v_fmac_f32 v35, v104, v17
    v_mul_f32 v36, v125, v16
    v_fmac_f32 v36, v105, v17
    v_mul_f32 v37, v126, v16
    v_fmac_f32 v37, v106, v17
    v_mul_f32 v38, v128, v16
    v_fmac_f32 v38, v108, v17
    v_mul_f32 v39, v129, v16
    v_fmac_f32 v39, v109, v17
    v_mul_f32 v40, v130, v16
    v_fmac_f32 v40, v110, v17
    v_mul_f32 v41, v132, v16
    v_fmac_f32 v41, v112, v17
    v_mul_f32 v42, v133, v16
    v_fmac_f32 v42, v113, v17
    v_mul_f32 v43, v134, v16
    v_fmac_f32 v43, v114, v17
    v_cvt_pk_bf16_f32 v44, v32, v33
    v_cvt_pk_bf16_f32 v45, v34, v35
    v_cvt_pk_bf16_f32 v46, v36, v37
    v_cvt_pk_bf16_f32 v47, v38, v39
    v_cvt_pk_bf16_f32 v48, v40, v41
    v_cvt_pk_bf16_f32 v49, v42, v43
    buffer_store_dwordx2 v[44:45], v8, s[48:51], s58 offen offset:0
    buffer_store_dwordx2 v[46:47], v8, s[48:51], s58 offen offset:128
    buffer_store_dwordx2 v[48:49], v8, s[48:51], s58 offen offset:256
L_fm31:
L_fin:
L_end:
    s_endpgm
.section .rodata,"a"
.p2align 6
.amdhsa_kernel standalone__kv_cache_quant_int4_int2_kv_with_per_channel_or_per_token_scales__sampling_kernel
  .amdhsa_next_free_vgpr 232
  .amdhsa_next_free_sgpr 102
  .amdhsa_accum_offset 232
  .amdhsa_group_segment_fixed_size 0
  .amdhsa_kernarg_size 80
  .amdhsa_user_sgpr_count 2
  .amdhsa_user_sgpr_kernarg_segment_ptr 1
  .amdhsa_system_sgpr_workgroup_id_x 1
  .amdhsa_float_denorm_mode_32 3
.end_amdhsa_kernel
```

```asm
; @launch grid=(256,1,1) block=(448,1,1) lds=161280
.amdgcn_target "amdgcn-amd-amdhsa--gfx950"
.text
.globl standalone__kv_cache_quant_int4_int2_kv_with_per_channel_or_per_token_scales__sampling_kernel
.p2align 8
.type standalone__kv_cache_quant_int4_int2_kv_with_per_channel_or_per_token_scales__sampling_kernel,@function
standalone__kv_cache_quant_int4_int2_kv_with_per_channel_or_per_token_scales__sampling_kernel:
    s_load_dwordx16 s[4:19], s[0:1], 0
    s_load_dwordx4 s[20:23], s[0:1], 64
    s_cmp_ge_u32 s2, 256
    s_cbranch_scc1 L_end
    v_lshrrev_b32 v2, 6, v0
    v_and_b32 v1, 63, v0
    v_readfirstlane_b32 s56, v2
    s_mov_b32 s72, s2
    s_bfe_u32 s58, s2, 196612
    s_lshr_b32 s59, s2, 1
    s_and_b32 s59, s59, 2
    s_xor_b32 s2, s2, s58
    s_xor_b32 s2, s2, s59
    s_bfe_u32 s58, s2, 65537
    s_xor_b32 s2, s2, s58
    s_mul_i32 s57, s2, 1398112
    s_add_u32 s57, s57, 43691
    s_lshr_b32 s57, s57, 17
    v_lshlrev_b32 v8, 4, v1
    s_and_b32 s59, s56, 1
    s_mul_i32 s59, s59, 31488
    s_lshl_b32 s58, s57, 7
    s_add_u32 s58, s58, s56
    s_mul_i32 s58, s58, 1536
    s_add_u32 s58, s58, s59
    s_mul_i32 m0, s56, 3072
    s_mov_b32 s26, 805306368
    s_mov_b32 s27, 0x20000
    s_waitcnt lgkmcnt(0)
    s_mov_b32 s24, s6
    s_and_b32 s25, s7, 0xffff
    buffer_load_dwordx4 v8, s[24:27], s58 offen offset:0 nt lds
    buffer_load_dwordx4 v8, s[24:27], s58 offen offset:1024 nt lds
    buffer_load_dwordx4 v8, s[24:27], s58 offen offset:2048 nt lds
    s_mul_i32 s100, s2, 43691
    s_lshr_b32 s100, s100, 17
    s_mul_i32 s101, s100, 3
    s_sub_u32 s101, s2, s101
    s_cmp_eq_u32 s2, 255
    s_cselect_b32 s73, 16, 11
    s_cmp_eq_u32 s101, 1
    s_cselect_b32 s3, 5, s73
    s_cselect_b32 s73, 10, s73
    s_sub_u32 s58, 2, s101
    s_mul_i32 s58, s58, 11
    s_lshr_b32 s58, s58, 1
    s_lshl_b32 s59, s100, 4
    s_sub_u32 s58, s58, s59
    s_add_u32 s58, s58, 4080
    s_sub_u32 s58, s58, s73
    v_cmp_le_u32 vcc, s73, v1
    v_add_u32 v3, s57, v1
    v_add_u32 v4, s58, v1
    v_cndmask_b32 v152, v3, v4, vcc
    s_cmp_eq_u32 s56, 4
    s_cbranch_scc1 L_loader
    s_cmp_lt_u32 s56, 4
    s_cbranch_scc1 L_consumer
    s_cmp_eq_u32 s56, 6
    s_cbranch_scc1 L_ctl
    s_waitcnt lgkmcnt(0)
    s_mov_b32 s44, s4
    s_and_b32 s45, s5, 0xffff
    s_mov_b32 s46, 393216
    s_mov_b32 s47, 0x20000
    s_mov_b32 s32, s12
    s_and_b32 s33, s13, 0xffff
    s_mov_b32 s34, 6291456
    s_mov_b32 s35, 0x20000
    s_mov_b32 s28, s10
    s_and_b32 s29, s11, 0xffff
    s_mov_b32 s30, 6291456
    s_mov_b32 s31, 0x20000
    s_mov_b32 s36, s14
    s_and_b32 s37, s15, 0xffff
    s_mov_b32 s38, 2097152
    s_mov_b32 s39, 0x20000
    s_mov_b32 s40, s16
    s_and_b32 s41, s17, 0xffff
    s_mov_b32 s42, 2097152
    s_mov_b32 s43, 0x20000
    s_sub_u32 s61, s56, 5
    s_mov_b32 s62, s61
    s_mov_b32 exec_hi, 0xffff
L_stq:
    s_mul_i32 s58, s62, s3
    s_cmp_lt_u32 s58, 15
    s_cbranch_scc0 L_stage
    v_readlane_b32 s58, v152, s58
    s_mul_i32 s59, s62, 1536
    s_add_u32 m0, s59, 155136
    s_add_u32 s62, s62, 1
    s_lshr_b32 s58, s58, 4
    s_mul_i32 s58, s58, 1536
    buffer_load_dwordx4 v8, s[44:47], s58 offen nt lds
    buffer_load_dwordx4 v8, s[44:47], s58 offen offset:768 nt lds
    s_branch L_stq
L_stage:
    v_readlane_b32 s60, v152, s61
    s_mul_i32 s59, s61, 3072
    s_add_u32 m0, s59, 76800
    s_mov_b32 exec_hi, 0xffff
    s_mul_i32 s58, s60, 1536
    buffer_load_dwordx4 v8, s[32:35], s58 offen nt lds
    buffer_load_dwordx4 v8, s[32:35], s58 offen offset:768 nt lds
    s_add_u32 m0, m0, 1536
    s_lshl_b32 s59, s61, 10
    buffer_load_dwordx4 v8, s[28:31], s58 offen nt lds
    buffer_load_dwordx4 v8, s[28:31], s58 offen offset:768 nt lds
    s_add_u32 m0, s59, 125952
    s_mov_b32 exec_hi, 0
    s_lshl_b32 s58, s60, 9
    buffer_load_dwordx4 v8, s[36:39], s58 offen nt lds
    s_add_u32 m0, m0, 512
    s_add_u32 s61, s61, 1
    buffer_load_dwordx4 v8, s[40:43], s58 offen nt lds
    s_cmp_lt_u32 s61, 16
    s_cbranch_scc1 L_stage
    s_mov_b32 exec_hi, -1
    s_branch L_finisher
L_loader:
    s_setprio 3
    s_mul_i32 s57, s57, 196608
    s_add_u32 s69, s57, 42240
    s_mov_b32 m0, 21504
    s_add_u32 s57, s57, 12288
    buffer_load_dwordx4 v8, s[24:27], s69 offen offset:0 nt lds
    buffer_load_dwordx4 v8, s[24:27], s69 offen offset:1024 nt lds
    buffer_load_dwordx4 v8, s[24:27], s69 offen offset:2048 nt lds
    s_add_u32 s69, s69, 3072
    v_lshrrev_b32 v11, 5, v1
    v_add_u32 v22, 48, v1
    v_lshrrev_b32 v12, 6, v22
    v_mov_b32 v13, v8
    v_mov_b32 v14, v8
    v_mov_b32 v15, v8
    v_mov_b32 v16, v8
    s_mov_b32 s68, 4
    s_mov_b32 s62, 24576
    s_mov_b32 s63, 0
    s_mov_b32 s86, 0
    s_mov_b32 s87, 0
    s_mov_b32 s70, 18
    s_mov_b32 s74, 0
    v_mov_b32 v20, 4736
    v_mov_b32 v21, 154880
    ds_write_b32 v21, v20
    s_mov_b32 s58, 4
    s_branch L_lnobar
L_lw16:
    s_waitcnt vmcnt(16)
L_lw17:
    s_waitcnt vmcnt(17)
L_lw18:
    s_waitcnt vmcnt(18)
L_lw19:
    s_waitcnt vmcnt(19)
L_lw20:
    s_waitcnt vmcnt(20)
L_lw21:
    s_waitcnt vmcnt(21)
    buffer_load_dwordx4 v8, s[24:27], s57 offen offset:0 nt lds
    s_add_u32 s68, s68, 1
    s_and_b32 s58, s68, 31
    s_add_u32 s60, s63, 3072
    s_add_u32 s88, s60, s86
    buffer_load_dwordx4 v13, s[24:27], s57 offen offset:1024 nt lds
    s_add_u32 m0, s62, 3072
    s_add_u32 s89, s60, s87
    s_cmp_eq_u32 s58, 10
    s_cselect_b32 s63, 33024, 0
    s_cmp_eq_u32 s58, 21
    s_cselect_b32 s86, 33024, 0
    s_cselect_b32 s87, 32256, 0
    buffer_load_dwordx4 v8, s[24:27], s69 offen offset:0 nt lds
    s_add_u32 m0, s62, 0
    v_mad_u32_u24 v22, v12, s63, v8
    v_mad_u32_u24 v13, v11, s86, v8
    s_cmp_eq_u32 s70, 21
    s_cbranch_scc1 L_lx1__21
    s_cmp_eq_u32 s70, 20
    s_cbranch_scc1 L_lx1__20
    s_cmp_eq_u32 s70, 19
    s_cbranch_scc1 L_lx1__19
    s_cmp_eq_u32 s70, 18
    s_cbranch_scc1 L_lx1__18
    s_cmp_eq_u32 s70, 17
    s_cbranch_scc1 L_lx1__17
L_lx1__16:
    s_waitcnt vmcnt(16)
L_lx1__17:
    s_waitcnt vmcnt(17)
L_lx1__18:
    s_waitcnt vmcnt(18)
L_lx1__19:
    s_waitcnt vmcnt(19)
L_lx1__20:
    s_waitcnt vmcnt(20)
L_lx1__21:
    s_waitcnt vmcnt(21)
    buffer_load_dwordx4 v14, s[24:27], s57 offen offset:2048 nt lds
    s_add_u32 m0, s62, 3072
    v_add_u32 v14, s86, v22
    s_add_u32 s57, s57, s88
    buffer_load_dwordx4 v15, s[24:27], s69 offen offset:1024 nt lds
    v_mad_u32_u24 v15, v11, s87, v8
    buffer_load_dwordx4 v16, s[24:27], s69 offen offset:2048 nt lds
    v_add_u32 v16, s87, v22
    s_add_u32 s69, s69, s89
    s_add_u32 s62, s62, 6144
    s_add_u32 m0, s62, 0
    s_and_b32 s59, s68, 3
    s_cbranch_scc0 L_lunit
L_lad:
    s_cmp_eq_u32 s70, 21
    s_cbranch_scc1 L_lw21
    s_cmp_eq_u32 s70, 20
    s_cbranch_scc1 L_lw20
    s_cmp_eq_u32 s70, 19
    s_cbranch_scc1 L_lw19
    s_cmp_eq_u32 s70, 18
    s_cbranch_scc1 L_lw18
    s_cmp_eq_u32 s70, 17
    s_cbranch_scc1 L_lw17
    s_branch L_lw16
L_lunit:
    s_waitcnt vmcnt(24)
    s_cmp_eq_u32 s68, 8
    s_cbranch_scc1 L_lfirst
L_lbar:
    s_barrier
L_lnobar:
    s_waitcnt lgkmcnt(0)
    v_readfirstlane_b32 s59, v20
    ds_read_b32 v20, v21
    s_cmp_eq_u32 s62, 73728
    s_cselect_b32 s62, 0, s62
    s_add_u32 m0, s62, 0
    s_and_b32 s74, s74, 255
    s_add_u32 s74, s74, s59
    s_lshr_b32 s70, s74, 8
    s_cmp_eq_u32 s58, 0
    s_cbranch_scc1 L_lblock
L_lsel:
    s_cmp_le_u32 s70, 21
    s_cbranch_scc1 L_lad
    s_cmp_le_u32 s70, 22
    s_cbranch_scc1 L_lw22
    s_cmp_le_u32 s70, 23
    s_cbranch_scc1 L_lw23
    s_cmp_le_u32 s70, 24
    s_cbranch_scc1 L_lw24
    s_branch L_lw25
L_lblock:
    s_bfe_u32 s58, s68, 262149
    v_readlane_b32 s57, v152, s58
    s_nop 3
    s_mul_i32 s57, s57, 196608
    s_add_u32 s69, s57, 33024
    s_cmp_eq_u32 s58, 0
    s_cbranch_scc0 L_lsel
    s_cmp_eq_u32 s68, 1024
    s_cbranch_scc1 L_ldone
    s_mov_b32 s24, s8
    s_and_b32 s25, s9, 0xffff
    s_branch L_lsel
L_lfirst:
    s_barrier
    s_branch L_lbar
L_ldone:
    s_waitcnt vmcnt(0)
    s_barrier
    s_endpgm
L_lw22:
    s_waitcnt vmcnt(22)
    buffer_load_dwordx4 v8, s[24:27], s57 offen offset:0 nt lds
    s_add_u32 s68, s68, 1
    s_and_b32 s58, s68, 31
    s_add_u32 s60, s63, 3072
    s_add_u32 s88, s60, s86
    buffer_load_dwordx4 v13, s[24:27], s57 offen offset:1024 nt lds
    s_add_u32 m0, s62, 3072
    s_add_u32 s89, s60, s87
    s_cmp_eq_u32 s58, 10
    s_cselect_b32 s63, 33024, 0
    s_cmp_eq_u32 s58, 21
    s_cselect_b32 s86, 33024, 0
    s_cselect_b32 s87, 32256, 0
    buffer_load_dwordx4 v8, s[24:27], s69 offen offset:0 nt lds
    s_add_u32 m0, s62, 0
    v_mad_u32_u24 v22, v12, s63, v8
    v_mad_u32_u24 v13, v11, s86, v8
L_lx1_22_22:
    s_waitcnt vmcnt(22)
    buffer_load_dwordx4 v14, s[24:27], s57 offen offset:2048 nt lds
    s_add_u32 m0, s62, 3072
    v_add_u32 v14, s86, v22
    s_add_u32 s57, s57, s88
    buffer_load_dwordx4 v15, s[24:27], s69 offen offset:1024 nt lds
    v_mad_u32_u24 v15, v11, s87, v8
    buffer_load_dwordx4 v16, s[24:27], s69 offen offset:2048 nt lds
    v_add_u32 v16, s87, v22
    s_add_u32 s69, s69, s89
    s_add_u32 s62, s62, 6144
    s_add_u32 m0, s62, 0
    s_and_b32 s59, s68, 3
    s_cbranch_scc1 L_lw22
    s_branch L_lunit
L_lw23:
    s_waitcnt vmcnt(23)
    buffer_load_dwordx4 v8, s[24:27], s57 offen offset:0 nt lds
    s_add_u32 s68, s68, 1
    s_and_b32 s58, s68, 31
    s_add_u32 s60, s63, 3072
    s_add_u32 s88, s60, s86
    buffer_load_dwordx4 v13, s[24:27], s57 offen offset:1024 nt lds
    s_add_u32 m0, s62, 3072
    s_add_u32 s89, s60, s87
    s_cmp_eq_u32 s58, 10
    s_cselect_b32 s63, 33024, 0
    s_cmp_eq_u32 s58, 21
    s_cselect_b32 s86, 33024, 0
    s_cselect_b32 s87, 32256, 0
    buffer_load_dwordx4 v8, s[24:27], s69 offen offset:0 nt lds
    s_add_u32 m0, s62, 0
    v_mad_u32_u24 v22, v12, s63, v8
    v_mad_u32_u24 v13, v11, s86, v8
L_lx1_23_23:
    s_waitcnt vmcnt(23)
    buffer_load_dwordx4 v14, s[24:27], s57 offen offset:2048 nt lds
    s_add_u32 m0, s62, 3072
    v_add_u32 v14, s86, v22
    s_add_u32 s57, s57, s88
    buffer_load_dwordx4 v15, s[24:27], s69 offen offset:1024 nt lds
    v_mad_u32_u24 v15, v11, s87, v8
    buffer_load_dwordx4 v16, s[24:27], s69 offen offset:2048 nt lds
    v_add_u32 v16, s87, v22
    s_add_u32 s69, s69, s89
    s_add_u32 s62, s62, 6144
    s_add_u32 m0, s62, 0
    s_and_b32 s59, s68, 3
    s_cbranch_scc1 L_lw23
    s_branch L_lunit
L_lw24:
    s_waitcnt vmcnt(24)
    buffer_load_dwordx4 v8, s[24:27], s57 offen offset:0 nt lds
    s_add_u32 s68, s68, 1
    s_and_b32 s58, s68, 31
    s_add_u32 s60, s63, 3072
    s_add_u32 s88, s60, s86
    buffer_load_dwordx4 v13, s[24:27], s57 offen offset:1024 nt lds
    s_add_u32 m0, s62, 3072
    s_add_u32 s89, s60, s87
    s_cmp_eq_u32 s58, 10
    s_cselect_b32 s63, 33024, 0
    s_cmp_eq_u32 s58, 21
    s_cselect_b32 s86, 33024, 0
    s_cselect_b32 s87, 32256, 0
    buffer_load_dwordx4 v8, s[24:27], s69 offen offset:0 nt lds
    s_add_u32 m0, s62, 0
    v_mad_u32_u24 v22, v12, s63, v8
    v_mad_u32_u24 v13, v11, s86, v8
L_lx1_24_24:
    s_waitcnt vmcnt(24)
    buffer_load_dwordx4 v14, s[24:27], s57 offen offset:2048 nt lds
    s_add_u32 m0, s62, 3072
    v_add_u32 v14, s86, v22
    s_add_u32 s57, s57, s88
    buffer_load_dwordx4 v15, s[24:27], s69 offen offset:1024 nt lds
    v_mad_u32_u24 v15, v11, s87, v8
    buffer_load_dwordx4 v16, s[24:27], s69 offen offset:2048 nt lds
    v_add_u32 v16, s87, v22
    s_add_u32 s69, s69, s89
    s_add_u32 s62, s62, 6144
    s_add_u32 m0, s62, 0
    s_and_b32 s59, s68, 3
    s_cbranch_scc1 L_lw24
    s_branch L_lunit
L_lw25:
    s_waitcnt vmcnt(25)
    buffer_load_dwordx4 v8, s[24:27], s57 offen offset:0 nt lds
    s_add_u32 s68, s68, 1
    s_and_b32 s58, s68, 31
    s_add_u32 s60, s63, 3072
    s_add_u32 s88, s60, s86
    buffer_load_dwordx4 v13, s[24:27], s57 offen offset:1024 nt lds
    s_add_u32 m0, s62, 3072
    s_add_u32 s89, s60, s87
    s_cmp_eq_u32 s58, 10
    s_cselect_b32 s63, 33024, 0
    s_cmp_eq_u32 s58, 21
    s_cselect_b32 s86, 33024, 0
    s_cselect_b32 s87, 32256, 0
    buffer_load_dwordx4 v8, s[24:27], s69 offen offset:0 nt lds
    s_add_u32 m0, s62, 0
    v_mad_u32_u24 v22, v12, s63, v8
    v_mad_u32_u24 v13, v11, s86, v8
L_lx1_25_25:
    s_waitcnt vmcnt(25)
    buffer_load_dwordx4 v14, s[24:27], s57 offen offset:2048 nt lds
    s_add_u32 m0, s62, 3072
    v_add_u32 v14, s86, v22
    s_add_u32 s57, s57, s88
    buffer_load_dwordx4 v15, s[24:27], s69 offen offset:1024 nt lds
    v_mad_u32_u24 v15, v11, s87, v8
    buffer_load_dwordx4 v16, s[24:27], s69 offen offset:2048 nt lds
    v_add_u32 v16, s87, v22
    s_add_u32 s69, s69, s89
    s_add_u32 s62, s62, 6144
    s_add_u32 m0, s62, 0
    s_and_b32 s59, s68, 3
    s_cbranch_scc1 L_lw25
    s_branch L_lunit
L_ctl:
    s_sub_u32 s58, s72, 8
    s_cmp_lt_u32 s58, 8
    s_cbranch_scc0 L_ctl_init
    s_getpc_b64 s[44:45]
L_pc:
    s_and_b32 s45, s45, 0xffff
    s_mov_b32 s46, L_end - L_pc
    s_mov_b32 s47, 0x20000
    v_lshlrev_b32 v9, 7, v1
    s_movk_i32 s58, 0
    buffer_load_dword v12, v9, s[44:47], s58 offen
    s_movk_i32 s58, 8192
    buffer_load_dword v13, v9, s[44:47], s58 offen
    s_movk_i32 s58, 16384
    buffer_load_dword v14, v9, s[44:47], s58 offen
    s_movk_i32 s58, 24576
    buffer_load_dword v15, v9, s[44:47], s58 offen
L_ctl_init:
    s_waitcnt lgkmcnt(0)
    s_mov_b32 s52, s22
    s_and_b32 s53, s23, 0xffff
    s_mov_b32 s54, 16793888
    s_mov_b32 s55, 0x20000
    s_mov_b32 s71, 0
    s_add_u32 s98, s22, 16777216
    s_addc_u32 s99, s23, 0
    s_cmp_lt_u32 s72, 8
    s_cselect_b32 s61, 1, 0
    s_and_b32 s59, s72, 7
    s_mul_i32 s59, s59, 4
    s_add_u32 s59, s59, 16777216
    v_mov_b32 v8, s59
    v_mov_b32 v10, 154880
    s_memtime s[28:29]
    s_memrealtime s[96:97]
    s_mov_b32 s32, 0
    s_mov_b64 exec, 1
    s_waitcnt lgkmcnt(0)
    s_mov_b32 s33, s96
    s_waitcnt vmcnt(0)
    s_barrier
    s_mov_b32 s63, 0
L_ctl_loop:
    s_barrier
    s_mov_b32 s62, s96
    s_mov_b32 s30, s28
    s_memtime s[28:29]
    s_memrealtime s[96:97]
    s_waitcnt lgkmcnt(0)
    s_sub_u32 s58, s96, s33
    s_mul_i32 s58, s58, 373
    s_mov_b32 s33, s96
    s_sub_u32 s59, s28, s30
    s_lshl_b32 s59, s59, 4
    s_sub_i32 s58, s58, s59
    s_mul_i32 s58, s58, 80
    s_ashr_i32 s31, s58, 12
    s_cmp_eq_u32 s63, 0
    s_cbranch_scc1 L_ctl_set
    s_mov_b32 s58, 0
    s_sub_i32 s59, s84, s62
    s_add_i32 s60, s59, 5000
    s_cmp_lt_u32 s60, 10000
    s_cselect_b32 s59, s59, 200
    s_add_i32 s58, s58, s59
    s_sub_i32 s59, s85, s62
    s_add_i32 s60, s59, 5000
    s_cmp_lt_u32 s60, 10000
    s_cselect_b32 s59, s59, 200
    s_add_i32 s58, s58, s59
    s_sub_i32 s59, s86, s62
    s_add_i32 s60, s59, 5000
    s_cmp_lt_u32 s60, 10000
    s_cselect_b32 s59, s59, 200
    s_add_i32 s58, s58, s59
    s_sub_i32 s59, s87, s62
    s_add_i32 s60, s59, 5000
    s_cmp_lt_u32 s60, 10000
    s_cselect_b32 s59, s59, 200
    s_add_i32 s58, s58, s59
    s_sub_i32 s59, s88, s62
    s_add_i32 s60, s59, 5000
    s_cmp_lt_u32 s60, 10000
    s_cselect_b32 s59, s59, 200
    s_add_i32 s58, s58, s59
    s_sub_i32 s59, s89, s62
    s_add_i32 s60, s59, 5000
    s_cmp_lt_u32 s60, 10000
    s_cselect_b32 s59, s59, 200
    s_add_i32 s58, s58, s59
    s_sub_i32 s59, s90, s62
    s_add_i32 s60, s59, 5000
    s_cmp_lt_u32 s60, 10000
    s_cselect_b32 s59, s59, 200
    s_add_i32 s58, s58, s59
    s_sub_i32 s59, s91, s62
    s_add_i32 s60, s59, 5000
    s_cmp_lt_u32 s60, 10000
    s_cselect_b32 s59, s59, 200
    s_add_i32 s58, s58, s59
    s_min_u32 s59, s63, 16
    s_cmp_gt_i32 s58, 0
    s_cselect_b32 s63, s59, s63
    s_mul_i32 s58, s58, s63
    s_ashr_i32 s58, s58, 5
    s_mov_b32 s32, s58
L_ctl_set:
    s_sub_i32 s58, s31, s32
    s_add_i32 s58, s58, 4736
    s_max_i32 s58, s58, 4096
    s_min_i32 s70, s58, 6400
    v_mov_b32 v9, s70
    ds_write_b32 v10, v9
    s_and_b32 s58, s71, 768
    s_cselect_b32 s63, 0, 5
    s_cmp_ge_u32 s71, 14848
    s_cselect_b32 s63, 32, s63
    s_cmp_eq_u32 s71, 16128
    s_cselect_b32 s63, 0, s63
    s_mul_i32 s58, s63, s61
    s_cmp_eq_u32 s58, 0
    s_cbranch_scc1 L_ctl_norep
    v_mov_b32 v11, s96
    buffer_store_dword v11, v8, s[52:55], s71 offen sc1
L_ctl_norep:
    s_barrier
    s_barrier
    s_barrier
    s_cmp_eq_u32 s63, 0
    s_cbranch_scc1 L_ctl_nold
    s_load_dwordx8 s[84:91], s[98:99], s71
L_ctl_nold:
    s_add_u32 s71, s71, 256
    s_cmp_lt_u32 s71, 16384
    s_cbranch_scc1 L_ctl_loop
    s_waitcnt lgkmcnt(0)
    s_mov_b64 exec, -1
    s_endpgm
L_consumer:
    v_lshrrev_b32 v3, 2, v1
    v_lshlrev_b32 v3, 3, v3
    v_and_b32 v4, 3, v1
    v_mul_u32_u24 v5, 384, v4
    v_add_u32 v153, v3, v5
    v_add_u32 v153, 155136, v153
    s_mov_b32 s64, 0x3fb8aa3b
    s_mov_b32 s65, 0x3d93cd3a
    s_mov_b32 s66, 0xffff0000
    v_bfe_u32 v36, v1, 2, 1
    v_lshl_add_u32 v36, v2, 2, v36
    v_bfe_u32 v37, v1, 3, 1
    v_lshrrev_b32 v38, 4, v1
    v_lshl_add_u32 v38, v38, 2, v4
    v_lshlrev_b32 v38, 3, v38
    v_add_u32 v38, 73728, v38
    s_movk_i32 s58, 384
    v_add_u32 v3, 0, v36
    v_cmp_le_u32 vcc, 43, v3
    v_add_u32 v5, 43, v3
    v_mov_b32 v6, 42
    v_cndmask_b32 v17, v3, v5, vcc
    v_cmp_le_u32 vcc, 86, v3
    v_add_u32 v5, 43, v17
    s_nop 0
    v_cndmask_b32 v17, v17, v5, vcc
    v_cndmask_b32 v6, 43, v6, vcc
    v_mad_u32_u24 v17, v6, v37, v17
    v_lshrrev_b32 v17, 6, v17
    v_mad_u32_u24 v17, v17, s58, v38
    v_add_u32 v3, 2, v36
    v_cmp_le_u32 vcc, 43, v3
    v_add_u32 v5, 43, v3
    v_mov_b32 v6, 42
    v_cndmask_b32 v18, v3, v5, vcc
    v_cmp_le_u32 vcc, 86, v3
    v_add_u32 v5, 43, v18
    s_nop 0
    v_cndmask_b32 v18, v18, v5, vcc
    v_cndmask_b32 v6, 43, v6, vcc
    v_mad_u32_u24 v18, v6, v37, v18
    v_lshrrev_b32 v18, 6, v18
    v_mad_u32_u24 v18, v18, s58, v38
    v_add_u32 v3, 16, v36
    v_cmp_le_u32 vcc, 43, v3
    v_add_u32 v5, 43, v3
    v_mov_b32 v6, 42
    v_cndmask_b32 v19, v3, v5, vcc
    v_cmp_le_u32 vcc, 86, v3
    v_add_u32 v5, 43, v19
    s_nop 0
    v_cndmask_b32 v19, v19, v5, vcc
    v_cndmask_b32 v6, 43, v6, vcc
    v_mad_u32_u24 v19, v6, v37, v19
    v_lshrrev_b32 v19, 6, v19
    v_mad_u32_u24 v19, v19, s58, v38
    v_add_u32 v3, 18, v36
    v_cmp_le_u32 vcc, 43, v3
    v_add_u32 v5, 43, v3
    v_mov_b32 v6, 42
    v_cndmask_b32 v20, v3, v5, vcc
    v_cmp_le_u32 vcc, 86, v3
    v_add_u32 v5, 43, v20
    s_nop 0
    v_cndmask_b32 v20, v20, v5, vcc
    v_cndmask_b32 v6, 43, v6, vcc
    v_mad_u32_u24 v20, v6, v37, v20
    v_lshrrev_b32 v20, 6, v20
    v_mad_u32_u24 v20, v20, s58, v38
    v_add_u32 v3, 32, v36
    v_cmp_le_u32 vcc, 43, v3
    v_add_u32 v5, 43, v3
    v_mov_b32 v6, 42
    v_cndmask_b32 v21, v3, v5, vcc
    v_cmp_le_u32 vcc, 86, v3
    v_add_u32 v5, 43, v21
    s_nop 0
    v_cndmask_b32 v21, v21, v5, vcc
    v_cndmask_b32 v6, 43, v6, vcc
    v_mad_u32_u24 v21, v6, v37, v21
    v_lshrrev_b32 v21, 6, v21
    v_mad_u32_u24 v21, v21, s58, v38
    v_add_u32 v3, 34, v36
    v_cmp_le_u32 vcc, 43, v3
    v_add_u32 v5, 43, v3
    v_mov_b32 v6, 42
    v_cndmask_b32 v22, v3, v5, vcc
    v_cmp_le_u32 vcc, 86, v3
    v_add_u32 v5, 43, v22
    s_nop 0
    v_cndmask_b32 v22, v22, v5, vcc
    v_cndmask_b32 v6, 43, v6, vcc
    v_mad_u32_u24 v22, v6, v37, v22
    v_lshrrev_b32 v22, 6, v22
    v_mad_u32_u24 v22, v22, s58, v38
    v_add_u32 v3, 48, v36
    v_cmp_le_u32 vcc, 43, v3
    v_add_u32 v5, 43, v3
    v_mov_b32 v6, 42
    v_cndmask_b32 v23, v3, v5, vcc
    v_cmp_le_u32 vcc, 86, v3
    v_add_u32 v5, 43, v23
    s_nop 0
    v_cndmask_b32 v23, v23, v5, vcc
    v_cndmask_b32 v6, 43, v6, vcc
    v_mad_u32_u24 v23, v6, v37, v23
    v_lshrrev_b32 v23, 6, v23
    v_mad_u32_u24 v23, v23, s58, v38
    v_add_u32 v3, 50, v36
    v_cmp_le_u32 vcc, 43, v3
    v_add_u32 v5, 43, v3
    v_mov_b32 v6, 42
    v_cndmask_b32 v24, v3, v5, vcc
    v_cmp_le_u32 vcc, 86, v3
    v_add_u32 v5, 43, v24
    s_nop 0
    v_cndmask_b32 v24, v24, v5, vcc
    v_cndmask_b32 v6, 43, v6, vcc
    v_mad_u32_u24 v24, v6, v37, v24
    v_lshrrev_b32 v24, 6, v24
    v_mad_u32_u24 v24, v24, s58, v38
    v_add_u32 v3, 64, v36
    v_cmp_le_u32 vcc, 43, v3
    v_add_u32 v5, 43, v3
    v_mov_b32 v6, 42
    v_cndmask_b32 v25, v3, v5, vcc
    v_cmp_le_u32 vcc, 86, v3
    v_add_u32 v5, 43, v25
    s_nop 0
    v_cndmask_b32 v25, v25, v5, vcc
    v_cndmask_b32 v6, 43, v6, vcc
    v_mad_u32_u24 v25, v6, v37, v25
    v_lshrrev_b32 v25, 6, v25
    v_mad_u32_u24 v25, v25, s58, v38
    v_add_u32 v3, 66, v36
    v_cmp_le_u32 vcc, 43, v3
    v_add_u32 v5, 43, v3
    v_mov_b32 v6, 42
    v_cndmask_b32 v26, v3, v5, vcc
    v_cmp_le_u32 vcc, 86, v3
    v_add_u32 v5, 43, v26
    s_nop 0
    v_cndmask_b32 v26, v26, v5, vcc
    v_cndmask_b32 v6, 43, v6, vcc
    v_mad_u32_u24 v26, v6, v37, v26
    v_lshrrev_b32 v26, 6, v26
    v_mad_u32_u24 v26, v26, s58, v38
    v_add_u32 v3, 80, v36
    v_cmp_le_u32 vcc, 43, v3
    v_add_u32 v5, 43, v3
    v_mov_b32 v6, 42
    v_cndmask_b32 v27, v3, v5, vcc
    v_cmp_le_u32 vcc, 86, v3
    v_add_u32 v5, 43, v27
    s_nop 0
    v_cndmask_b32 v27, v27, v5, vcc
    v_cndmask_b32 v6, 43, v6, vcc
    v_mad_u32_u24 v27, v6, v37, v27
    v_lshrrev_b32 v27, 6, v27
    v_mad_u32_u24 v27, v27, s58, v38
    v_add_u32 v3, 82, v36
    v_cmp_le_u32 vcc, 43, v3
    v_add_u32 v5, 43, v3
    v_mov_b32 v6, 42
    v_cndmask_b32 v28, v3, v5, vcc
    v_cmp_le_u32 vcc, 86, v3
    v_add_u32 v5, 43, v28
    s_nop 0
    v_cndmask_b32 v28, v28, v5, vcc
    v_cndmask_b32 v6, 43, v6, vcc
    v_mad_u32_u24 v28, v6, v37, v28
    v_lshrrev_b32 v28, 6, v28
    v_mad_u32_u24 v28, v28, s58, v38
    v_add_u32 v3, 96, v36
    v_cmp_le_u32 vcc, 43, v3
    v_add_u32 v5, 43, v3
    v_mov_b32 v6, 42
    v_cndmask_b32 v29, v3, v5, vcc
    v_cmp_le_u32 vcc, 86, v3
    v_add_u32 v5, 43, v29
    s_nop 0
    v_cndmask_b32 v29, v29, v5, vcc
    v_cndmask_b32 v6, 43, v6, vcc
    v_mad_u32_u24 v29, v6, v37, v29
    v_lshrrev_b32 v29, 6, v29
    v_mad_u32_u24 v29, v29, s58, v38
    v_add_u32 v3, 98, v36
    v_cmp_le_u32 vcc, 43, v3
    v_add_u32 v5, 43, v3
    v_mov_b32 v6, 42
    v_cndmask_b32 v30, v3, v5, vcc
    v_cmp_le_u32 vcc, 86, v3
    v_add_u32 v5, 43, v30
    s_nop 0
    v_cndmask_b32 v30, v30, v5, vcc
    v_cndmask_b32 v6, 43, v6, vcc
    v_mad_u32_u24 v30, v6, v37, v30
    v_lshrrev_b32 v30, 6, v30
    v_mad_u32_u24 v30, v30, s58, v38
    v_add_u32 v3, 112, v36
    v_cmp_le_u32 vcc, 43, v3
    v_add_u32 v5, 43, v3
    v_mov_b32 v6, 42
    v_cndmask_b32 v31, v3, v5, vcc
    v_cmp_le_u32 vcc, 86, v3
    v_add_u32 v5, 43, v31
    s_nop 0
    v_cndmask_b32 v31, v31, v5, vcc
    v_cndmask_b32 v6, 43, v6, vcc
    v_mad_u32_u24 v31, v6, v37, v31
    v_lshrrev_b32 v31, 6, v31
    v_mad_u32_u24 v31, v31, s58, v38
    v_add_u32 v3, 114, v36
    v_cmp_le_u32 vcc, 43, v3
    v_add_u32 v5, 43, v3
    v_mov_b32 v6, 42
    v_cndmask_b32 v32, v3, v5, vcc
    v_cmp_le_u32 vcc, 86, v3
    v_add_u32 v5, 43, v32
    s_nop 0
    v_cndmask_b32 v32, v32, v5, vcc
    v_cndmask_b32 v6, 43, v6, vcc
    v_mad_u32_u24 v32, v6, v37, v32
    v_lshrrev_b32 v32, 6, v32
    v_mad_u32_u24 v32, v32, s58, v38
    v_bfe_u32 v36, v1, 4, 1
    v_lshl_add_u32 v36, v2, 2, v36
    v_bfe_u32 v3, v1, 2, 2
    v_lshl_add_u32 v36, v3, 4, v36
    v_lshrrev_b32 v37, 5, v1
    s_mov_b32 s58, 125952
    v_add_u32 v3, 0, v36
    v_cmp_le_u32 vcc, 43, v3
    v_add_u32 v5, 43, v3
    v_mov_b32 v6, 42
    v_cndmask_b32 v7, v3, v5, vcc
    v_cmp_le_u32 vcc, 86, v3
    v_add_u32 v5, 43, v7
    s_nop 0
    v_cndmask_b32 v7, v7, v5, vcc
    v_cndmask_b32 v6, 43, v6, vcc
    v_mad_u32_u24 v7, v6, v37, v7
    v_lshl_add_u32 v7, v7, 1, s58
    v_add_u32 v3, 2, v36
    v_cmp_le_u32 vcc, 43, v3
    v_add_u32 v5, 43, v3
    v_mov_b32 v6, 42
    v_cndmask_b32 v8, v3, v5, vcc
    v_cmp_le_u32 vcc, 86, v3
    v_add_u32 v5, 43, v8
    s_nop 0
    v_cndmask_b32 v8, v8, v5, vcc
    v_cndmask_b32 v6, 43, v6, vcc
    v_mad_u32_u24 v8, v6, v37, v8
    v_lshl_add_u32 v8, v8, 1, s58
    v_add_u32 v3, 64, v36
    v_cmp_le_u32 vcc, 43, v3
    v_add_u32 v5, 43, v3
    v_mov_b32 v6, 42
    v_cndmask_b32 v9, v3, v5, vcc
    v_cmp_le_u32 vcc, 86, v3
    v_add_u32 v5, 43, v9
    s_nop 0
    v_cndmask_b32 v9, v9, v5, vcc
    v_cndmask_b32 v6, 43, v6, vcc
    v_mad_u32_u24 v9, v6, v37, v9
    v_lshl_add_u32 v9, v9, 1, s58
    v_add_u32 v3, 66, v36
    v_cmp_le_u32 vcc, 43, v3
    v_add_u32 v5, 43, v3
    v_mov_b32 v6, 42
    v_cndmask_b32 v10, v3, v5, vcc
    v_cmp_le_u32 vcc, 86, v3
    v_add_u32 v5, 43, v10
    s_nop 0
    v_cndmask_b32 v10, v10, v5, vcc
    v_cndmask_b32 v6, 43, v6, vcc
    v_mad_u32_u24 v10, v6, v37, v10
    v_lshl_add_u32 v10, v10, 1, s58
    v_lshlrev_b32 v11, 2, v1
    v_lshl_add_u32 v11, v2, 9, v11
    v_add_u32 v11, 73728, v11
    v_bfe_u32 v3, v1, 2, 2
    v_lshrrev_b32 v4, 4, v1
    v_and_b32 v5, 3, v1
    v_lshl_add_u32 v4, v4, 2, v5
    v_and_b32 v5, 2, v3
    v_add_u32 v3, v3, v5
    v_lshl_add_u32 v3, v2, 3, v3
    v_mul_u32_u24 v3, 768, v3
    v_lshl_add_u32 v12, v4, 4, v3
    v_and_b32 v3, 3, v1
    v_lshl_add_u32 v154, v3, 2, v2
    v_lshlrev_b32 v154, 2, v154
    v_add_u32 v154, 154944, v154
    v_mov_b32 v14, 0xff800000
    s_mov_b32 s61, 0
    s_mov_b32 s62, 0
    s_movk_i32 s63, 3072
    s_waitcnt vmcnt(0) lgkmcnt(0)
    s_barrier
    ds_read_b64 v[164:165], v153 offset:0
    ds_read_b64 v[166:167], v153 offset:128
    ds_read_b64 v[168:169], v153 offset:256
    v_add_u32 v153, 1536, v153
    v_add_u32 v33, s63, v17
    v_add_u32 v34, s63, v18
    ds_read_b64 v[108:109], v33 offset:0
    ds_read_b64 v[110:111], v33 offset:1536
    ds_read_b64 v[112:113], v33 offset:128
    ds_read_b64 v[114:115], v33 offset:1664
    ds_read_b64 v[116:117], v33 offset:256
    ds_read_b64 v[118:119], v33 offset:1792
    ds_read_b64 v[120:121], v34 offset:0
    ds_read_b64 v[122:123], v34 offset:1536
    ds_read_b64 v[124:125], v34 offset:128
    ds_read_b64 v[126:127], v34 offset:1664
    ds_read_b64 v[128:129], v34 offset:256
    ds_read_b64 v[130:131], v34 offset:1792
    s_waitcnt lgkmcnt(0)
    v_lshlrev_b32 v60, 16, v108
    v_and_b32 v61, s66, v108
    v_lshlrev_b32 v62, 16, v109
    v_and_b32 v63, s66, v109
    v_lshlrev_b32 v84, 16, v110
    v_and_b32 v85, s66, v110
    v_lshlrev_b32 v86, 16, v111
    v_and_b32 v87, s66, v111
    v_lshlrev_b32 v64, 16, v112
    v_and_b32 v65, s66, v112
    v_lshlrev_b32 v66, 16, v113
    v_and_b32 v67, s66, v113
    v_lshlrev_b32 v88, 16, v114
    v_and_b32 v89, s66, v114
    v_lshlrev_b32 v90, 16, v115
    v_and_b32 v91, s66, v115
    v_lshlrev_b32 v68, 16, v116
    v_and_b32 v69, s66, v116
    v_lshlrev_b32 v70, 16, v117
    v_and_b32 v71, s66, v117
    v_lshlrev_b32 v92, 16, v118
    v_and_b32 v93, s66, v118
    v_lshlrev_b32 v94, 16, v119
    v_and_b32 v95, s66, v119
    v_lshlrev_b32 v72, 16, v120
    v_and_b32 v73, s66, v120
    v_lshlrev_b32 v74, 16, v121
    v_and_b32 v75, s66, v121
    v_lshlrev_b32 v96, 16, v122
    v_and_b32 v97, s66, v122
    v_lshlrev_b32 v98, 16, v123
    v_and_b32 v99, s66, v123
    v_lshlrev_b32 v76, 16, v124
    v_and_b32 v77, s66, v124
    v_lshlrev_b32 v78, 16, v125
    v_and_b32 v79, s66, v125
    v_lshlrev_b32 v100, 16, v126
    v_and_b32 v101, s66, v126
    v_lshlrev_b32 v102, 16, v127
    v_and_b32 v103, s66, v127
    v_lshlrev_b32 v80, 16, v128
    v_and_b32 v81, s66, v128
    v_lshlrev_b32 v82, 16, v129
    v_and_b32 v83, s66, v129
    v_lshlrev_b32 v104, 16, v130
    v_and_b32 v105, s66, v130
    v_lshlrev_b32 v106, 16, v131
    v_and_b32 v107, s66, v131
L_kblk:
    v_add_u32 v13, s62, v12
    s_add_u32 s62, s62, 24576
    s_cmp_eq_u32 s62, 73728
    s_cselect_b32 s62, 0, s62
    s_barrier
    ds_read_b128 v[36:39], v13 offset:0
    ds_read_b128 v[40:43], v13 offset:256
    ds_read_b128 v[44:47], v13 offset:512
    ds_read_b128 v[48:51], v13 offset:1536
    ds_read_b128 v[52:55], v13 offset:1792
    ds_read_b128 v[56:59], v13 offset:2048
    s_waitcnt lgkmcnt(3)
    v_cvt_f32_i32 v36, v36
    v_cvt_f32_i32 v37, v37
    v_cvt_f32_i32 v38, v38
    v_cvt_f32_i32 v39, v39
    v_cvt_f32_i32 v40, v40
    v_cvt_f32_i32 v41, v41
    v_cvt_f32_i32 v42, v42
    v_cvt_f32_i32 v43, v43
    v_cvt_f32_i32 v44, v44
    v_cvt_f32_i32 v45, v45
    v_cvt_f32_i32 v46, v46
    v_cvt_f32_i32 v47, v47
    v_sub_f32 v36, v36, v60
    v_sub_f32 v37, v37, v61
    v_sub_f32 v38, v38, v62
    v_sub_f32 v39, v39, v63
    v_sub_f32 v40, v40, v64
    v_sub_f32 v41, v41, v65
    v_sub_f32 v42, v42, v66
    v_sub_f32 v43, v43, v67
    v_sub_f32 v44, v44, v68
    v_sub_f32 v45, v45, v69
    v_sub_f32 v46, v46, v70
    v_sub_f32 v47, v47, v71
    v_cvt_pk_bf16_f32 v36, 0, v36
    v_cvt_pk_bf16_f32 v37, 0, v37
    v_cvt_pk_bf16_f32 v38, 0, v38
    v_cvt_pk_bf16_f32 v39, 0, v39
    v_cvt_pk_bf16_f32 v40, 0, v40
    v_cvt_pk_bf16_f32 v41, 0, v41
    v_cvt_pk_bf16_f32 v42, 0, v42
    v_cvt_pk_bf16_f32 v43, 0, v43
    v_cvt_pk_bf16_f32 v44, 0, v44
    v_cvt_pk_bf16_f32 v45, 0, v45
    v_cvt_pk_bf16_f32 v46, 0, v46
    v_cvt_pk_bf16_f32 v47, 0, v47
    v_mul_f32 v36, v36, v84
    v_mul_f32 v37, v37, v85
    v_mul_f32 v38, v38, v86
    v_mul_f32 v39, v39, v87
    v_mul_f32 v40, v40, v88
    v_mul_f32 v41, v41, v89
    v_mul_f32 v42, v42, v90
    v_mul_f32 v43, v43, v91
    v_mul_f32 v44, v44, v92
    v_mul_f32 v45, v45, v93
    v_mul_f32 v46, v46, v94
    v_mul_f32 v47, v47, v95
    v_cvt_pk_bf16_f32 v132, v36, v37
    v_cvt_pk_bf16_f32 v133, v38, v39
    v_cvt_pk_bf16_f32 v134, v40, v41
    v_cvt_pk_bf16_f32 v135, v42, v43
    v_cvt_pk_bf16_f32 v136, v44, v45
    v_cvt_pk_bf16_f32 v137, v46, v47
    v_mfma_f32_16x16x16_bf16 v[144:147], v[132:133], v[164:165], 0
    v_mfma_f32_16x16x16_bf16 v[144:147], v[134:135], v[166:167], v[144:147]
    v_mfma_f32_16x16x16_bf16 v[144:147], v[136:137], v[168:169], v[144:147]
    s_waitcnt lgkmcnt(0)
    v_cvt_f32_i32 v48, v48
    v_cvt_f32_i32 v49, v49
    v_cvt_f32_i32 v50, v50
    v_cvt_f32_i32 v51, v51
    v_cvt_f32_i32 v52, v52
    v_cvt_f32_i32 v53, v53
    v_cvt_f32_i32 v54, v54
    v_cvt_f32_i32 v55, v55
    v_cvt_f32_i32 v56, v56
    v_cvt_f32_i32 v57, v57
    v_cvt_f32_i32 v58, v58
    v_cvt_f32_i32 v59, v59
    v_sub_f32 v48, v48, v72
    v_sub_f32 v49, v49, v73
    v_sub_f32 v50, v50, v74
    v_sub_f32 v51, v51, v75
    v_sub_f32 v52, v52, v76
    v_sub_f32 v53, v53, v77
    v_sub_f32 v54, v54, v78
    v_sub_f32 v55, v55, v79
    v_sub_f32 v56, v56, v80
    v_sub_f32 v57, v57, v81
    v_sub_f32 v58, v58, v82
    v_sub_f32 v59, v59, v83
    v_cvt_pk_bf16_f32 v48, 0, v48
    v_cvt_pk_bf16_f32 v49, 0, v49
    v_cvt_pk_bf16_f32 v50, 0, v50
    v_cvt_pk_bf16_f32 v51, 0, v51
    v_cvt_pk_bf16_f32 v52, 0, v52
    v_cvt_pk_bf16_f32 v53, 0, v53
    v_cvt_pk_bf16_f32 v54, 0, v54
    v_cvt_pk_bf16_f32 v55, 0, v55
    v_cvt_pk_bf16_f32 v56, 0, v56
    v_cvt_pk_bf16_f32 v57, 0, v57
    v_cvt_pk_bf16_f32 v58, 0, v58
    v_cvt_pk_bf16_f32 v59, 0, v59
    v_mul_f32 v48, v48, v96
    v_mul_f32 v49, v49, v97
    v_mul_f32 v50, v50, v98
    v_mul_f32 v51, v51, v99
    v_mul_f32 v52, v52, v100
    v_mul_f32 v53, v53, v101
    v_mul_f32 v54, v54, v102
    v_mul_f32 v55, v55, v103
    v_mul_f32 v56, v56, v104
    v_mul_f32 v57, v57, v105
    v_mul_f32 v58, v58, v106
    v_mul_f32 v59, v59, v107
    v_cvt_pk_bf16_f32 v138, v48, v49
    v_cvt_pk_bf16_f32 v139, v50, v51
    v_add_f32_dpp v3, v145, v144 row_ror:12 row_mask:0xf bank_mask:0xf
    v_cvt_pk_bf16_f32 v140, v52, v53
    v_cvt_pk_bf16_f32 v141, v54, v55
    v_add_f32_dpp v3, v146, v3 row_ror:8 row_mask:0xf bank_mask:0xf
    v_cvt_pk_bf16_f32 v142, v56, v57
    v_cvt_pk_bf16_f32 v143, v58, v59
    v_add_f32_dpp v15, v147, v3 row_ror:4 row_mask:0xf bank_mask:0x1
    v_mfma_f32_16x16x16_bf16 v[148:151], v[138:139], v[164:165], 0
    v_mfma_f32_16x16x16_bf16 v[148:151], v[140:141], v[166:167], v[148:151]
    v_mfma_f32_16x16x16_bf16 v[148:151], v[142:143], v[168:169], v[148:151]
    v_add_u32 v33, s63, v19
    v_add_u32 v34, s63, v20
    ds_read_b64 v[108:109], v33 offset:0
    ds_read_b64 v[110:111], v33 offset:1536
    ds_read_b64 v[112:113], v33 offset:128
    ds_read_b64 v[114:115], v33 offset:1664
    ds_read_b64 v[116:117], v33 offset:256
    ds_read_b64 v[118:119], v33 offset:1792
    ds_read_b64 v[120:121], v34 offset:0
    v_add_f32_dpp v4, v149, v148 row_ror:12 row_mask:0xf bank_mask:0xf
    ds_read_b64 v[122:123], v34 offset:1536
    ds_read_b64 v[124:125], v34 offset:128
    v_add_f32_dpp v4, v150, v4 row_ror:8 row_mask:0xf bank_mask:0xf
    ds_read_b64 v[126:127], v34 offset:1664
    ds_read_b64 v[128:129], v34 offset:256
    ds_read_b64 v[130:131], v34 offset:1792
    v_add_f32_dpp v16, v151, v4 row_ror:4 row_mask:0xf bank_mask:0x1
    s_waitcnt lgkmcnt(0)
    v_lshlrev_b32 v60, 16, v108
    v_and_b32 v61, s66, v108
    v_lshlrev_b32 v62, 16, v109
    v_and_b32 v63, s66, v109
    v_lshlrev_b32 v84, 16, v110
    v_and_b32 v85, s66, v110
    v_lshlrev_b32 v86, 16, v111
    v_and_b32 v87, s66, v111
    v_lshlrev_b32 v64, 16, v112
    v_and_b32 v65, s66, v112
    v_lshlrev_b32 v66, 16, v113
    v_and_b32 v67, s66, v113
    v_lshlrev_b32 v88, 16, v114
    v_and_b32 v89, s66, v114
    v_lshlrev_b32 v90, 16, v115
    v_and_b32 v91, s66, v115
    v_lshlrev_b32 v68, 16, v116
    v_and_b32 v69, s66, v116
    v_lshlrev_b32 v70, 16, v117
    v_and_b32 v71, s66, v117
    v_lshlrev_b32 v92, 16, v118
    v_and_b32 v93, s66, v118
    v_lshlrev_b32 v94, 16, v119
    v_and_b32 v95, s66, v119
    v_lshlrev_b32 v72, 16, v120
    v_and_b32 v73, s66, v120
    v_lshlrev_b32 v74, 16, v121
    v_and_b32 v75, s66, v121
    v_lshlrev_b32 v96, 16, v122
    v_and_b32 v97, s66, v122
    v_lshlrev_b32 v98, 16, v123
    v_and_b32 v99, s66, v123
    v_lshlrev_b32 v76, 16, v124
    v_and_b32 v77, s66, v124
    v_lshlrev_b32 v78, 16, v125
    v_and_b32 v79, s66, v125
    v_lshlrev_b32 v100, 16, v126
    v_and_b32 v101, s66, v126
    v_lshlrev_b32 v102, 16, v127
    v_and_b32 v103, s66, v127
    v_lshlrev_b32 v80, 16, v128
    v_and_b32 v81, s66, v128
    v_lshlrev_b32 v82, 16, v129
    v_and_b32 v83, s66, v129
    v_lshlrev_b32 v104, 16, v130
    v_and_b32 v105, s66, v130
    v_lshlrev_b32 v106, 16, v131
    v_and_b32 v107, s66, v131
    v_add_u32 v13, s62, v12
    s_add_u32 s62, s62, 24576
    s_cmp_eq_u32 s62, 73728
    s_cselect_b32 s62, 0, s62
    s_barrier
    ds_read_b128 v[36:39], v13 offset:0
    ds_read_b128 v[40:43], v13 offset:256
    ds_read_b128 v[44:47], v13 offset:512
    ds_read_b128 v[48:51], v13 offset:1536
    ds_read_b128 v[52:55], v13 offset:1792
    ds_read_b128 v[56:59], v13 offset:2048
    s_waitcnt lgkmcnt(3)
    v_cvt_f32_i32 v36, v36
    v_cvt_f32_i32 v37, v37
    v_cvt_f32_i32 v38, v38
    v_cvt_f32_i32 v39, v39
    v_cvt_f32_i32 v40, v40
    v_cvt_f32_i32 v41, v41
    v_cvt_f32_i32 v42, v42
    v_cvt_f32_i32 v43, v43
    v_cvt_f32_i32 v44, v44
    v_cvt_f32_i32 v45, v45
    v_cvt_f32_i32 v46, v46
    v_cvt_f32_i32 v47, v47
    v_sub_f32 v36, v36, v60
    v_sub_f32 v37, v37, v61
    v_sub_f32 v38, v38, v62
    v_sub_f32 v39, v39, v63
    v_sub_f32 v40, v40, v64
    v_sub_f32 v41, v41, v65
    v_sub_f32 v42, v42, v66
    v_sub_f32 v43, v43, v67
    v_sub_f32 v44, v44, v68
    v_sub_f32 v45, v45, v69
    v_sub_f32 v46, v46, v70
    v_sub_f32 v47, v47, v71
    v_cvt_pk_bf16_f32 v36, 0, v36
    v_cvt_pk_bf16_f32 v37, 0, v37
    v_cvt_pk_bf16_f32 v38, 0, v38
    v_cvt_pk_bf16_f32 v39, 0, v39
    v_cvt_pk_bf16_f32 v40, 0, v40
    v_cvt_pk_bf16_f32 v41, 0, v41
    v_cvt_pk_bf16_f32 v42, 0, v42
    v_cvt_pk_bf16_f32 v43, 0, v43
    v_cvt_pk_bf16_f32 v44, 0, v44
    v_cvt_pk_bf16_f32 v45, 0, v45
    v_cvt_pk_bf16_f32 v46, 0, v46
    v_cvt_pk_bf16_f32 v47, 0, v47
    v_mul_f32 v36, v36, v84
    v_mul_f32 v37, v37, v85
    v_mul_f32 v38, v38, v86
    v_mul_f32 v39, v39, v87
    v_mul_f32 v40, v40, v88
    v_mul_f32 v41, v41, v89
    v_mul_f32 v42, v42, v90
    v_mul_f32 v43, v43, v91
    v_mul_f32 v44, v44, v92
    v_mul_f32 v45, v45, v93
    v_mul_f32 v46, v46, v94
    v_mul_f32 v47, v47, v95
    v_cvt_pk_bf16_f32 v132, v36, v37
    v_cvt_pk_bf16_f32 v133, v38, v39
    v_cvt_pk_bf16_f32 v134, v40, v41
    v_cvt_pk_bf16_f32 v135, v42, v43
    v_cvt_pk_bf16_f32 v136, v44, v45
    v_cvt_pk_bf16_f32 v137, v46, v47
    v_mfma_f32_16x16x16_bf16 v[144:147], v[132:133], v[164:165], 0
    v_mfma_f32_16x16x16_bf16 v[144:147], v[134:135], v[166:167], v[144:147]
    v_mfma_f32_16x16x16_bf16 v[144:147], v[136:137], v[168:169], v[144:147]
    s_waitcnt lgkmcnt(0)
    v_cvt_f32_i32 v48, v48
    v_cvt_f32_i32 v49, v49
    v_cvt_f32_i32 v50, v50
    v_cvt_f32_i32 v51, v51
    v_cvt_f32_i32 v52, v52
    v_cvt_f32_i32 v53, v53
    v_cvt_f32_i32 v54, v54
    v_cvt_f32_i32 v55, v55
    v_cvt_f32_i32 v56, v56
    v_cvt_f32_i32 v57, v57
    v_cvt_f32_i32 v58, v58
    v_cvt_f32_i32 v59, v59
    v_sub_f32 v48, v48, v72
    v_sub_f32 v49, v49, v73
    v_sub_f32 v50, v50, v74
    v_sub_f32 v51, v51, v75
    v_sub_f32 v52, v52, v76
    v_sub_f32 v53, v53, v77
    v_sub_f32 v54, v54, v78
    v_sub_f32 v55, v55, v79
    v_sub_f32 v56, v56, v80
    v_sub_f32 v57, v57, v81
    v_sub_f32 v58, v58, v82
    v_sub_f32 v59, v59, v83
    v_cvt_pk_bf16_f32 v48, 0, v48
    v_cvt_pk_bf16_f32 v49, 0, v49
    v_cvt_pk_bf16_f32 v50, 0, v50
    v_cvt_pk_bf16_f32 v51, 0, v51
    v_cvt_pk_bf16_f32 v52, 0, v52
    v_cvt_pk_bf16_f32 v53, 0, v53
    v_cvt_pk_bf16_f32 v54, 0, v54
    v_cvt_pk_bf16_f32 v55, 0, v55
    v_cvt_pk_bf16_f32 v56, 0, v56
    v_cvt_pk_bf16_f32 v57, 0, v57
    v_cvt_pk_bf16_f32 v58, 0, v58
    v_cvt_pk_bf16_f32 v59, 0, v59
    v_mul_f32 v48, v48, v96
    v_mul_f32 v49, v49, v97
    v_mul_f32 v50, v50, v98
    v_mul_f32 v51, v51, v99
    v_mul_f32 v52, v52, v100
    v_mul_f32 v53, v53, v101
    v_mul_f32 v54, v54, v102
    v_mul_f32 v55, v55, v103
    v_mul_f32 v56, v56, v104
    v_mul_f32 v57, v57, v105
    v_mul_f32 v58, v58, v106
    v_mul_f32 v59, v59, v107
    v_cvt_pk_bf16_f32 v138, v48, v49
    v_cvt_pk_bf16_f32 v139, v50, v51
    v_add_f32_dpp v3, v146, v145 row_ror:12 row_mask:0xf bank_mask:0xf
    v_cvt_pk_bf16_f32 v140, v52, v53
    v_cvt_pk_bf16_f32 v141, v54, v55
    v_add_f32_dpp v3, v147, v3 row_ror:8 row_mask:0xf bank_mask:0xf
    v_cvt_pk_bf16_f32 v142, v56, v57
    v_cvt_pk_bf16_f32 v143, v58, v59
    v_add_f32_dpp v15, v144, v3 row_ror:4 row_mask:0xf bank_mask:0x2
    v_mfma_f32_16x16x16_bf16 v[148:151], v[138:139], v[164:165], 0
    v_mfma_f32_16x16x16_bf16 v[148:151], v[140:141], v[166:167], v[148:151]
    v_mfma_f32_16x16x16_bf16 v[148:151], v[142:143], v[168:169], v[148:151]
    v_add_u32 v33, s63, v21
    v_add_u32 v34, s63, v22
    ds_read_b64 v[108:109], v33 offset:0
    ds_read_b64 v[110:111], v33 offset:1536
    ds_read_b64 v[112:113], v33 offset:128
    ds_read_b64 v[114:115], v33 offset:1664
    ds_read_b64 v[116:117], v33 offset:256
    ds_read_b64 v[118:119], v33 offset:1792
    ds_read_b64 v[120:121], v34 offset:0
    v_add_f32_dpp v4, v150, v149 row_ror:12 row_mask:0xf bank_mask:0xf
    ds_read_b64 v[122:123], v34 offset:1536
    ds_read_b64 v[124:125], v34 offset:128
    v_add_f32_dpp v4, v151, v4 row_ror:8 row_mask:0xf bank_mask:0xf
    ds_read_b64 v[126:127], v34 offset:1664
    ds_read_b64 v[128:129], v34 offset:256
    ds_read_b64 v[130:131], v34 offset:1792
    v_add_f32_dpp v16, v148, v4 row_ror:4 row_mask:0xf bank_mask:0x2
    s_waitcnt lgkmcnt(0)
    v_lshlrev_b32 v60, 16, v108
    v_and_b32 v61, s66, v108
    v_lshlrev_b32 v62, 16, v109
    v_and_b32 v63, s66, v109
    v_lshlrev_b32 v84, 16, v110
    v_and_b32 v85, s66, v110
    v_lshlrev_b32 v86, 16, v111
    v_and_b32 v87, s66, v111
    v_lshlrev_b32 v64, 16, v112
    v_and_b32 v65, s66, v112
    v_lshlrev_b32 v66, 16, v113
    v_and_b32 v67, s66, v113
    v_lshlrev_b32 v88, 16, v114
    v_and_b32 v89, s66, v114
    v_lshlrev_b32 v90, 16, v115
    v_and_b32 v91, s66, v115
    v_lshlrev_b32 v68, 16, v116
    v_and_b32 v69, s66, v116
    v_lshlrev_b32 v70, 16, v117
    v_and_b32 v71, s66, v117
    v_lshlrev_b32 v92, 16, v118
    v_and_b32 v93, s66, v118
    v_lshlrev_b32 v94, 16, v119
    v_and_b32 v95, s66, v119
    v_lshlrev_b32 v72, 16, v120
    v_and_b32 v73, s66, v120
    v_lshlrev_b32 v74, 16, v121
    v_and_b32 v75, s66, v121
    v_lshlrev_b32 v96, 16, v122
    v_and_b32 v97, s66, v122
    v_lshlrev_b32 v98, 16, v123
    v_and_b32 v99, s66, v123
    v_lshlrev_b32 v76, 16, v124
    v_and_b32 v77, s66, v124
    v_lshlrev_b32 v78, 16, v125
    v_and_b32 v79, s66, v125
    v_lshlrev_b32 v100, 16, v126
    v_and_b32 v101, s66, v126
    v_lshlrev_b32 v102, 16, v127
    v_and_b32 v103, s66, v127
    v_lshlrev_b32 v80, 16, v128
    v_and_b32 v81, s66, v128
    v_lshlrev_b32 v82, 16, v129
    v_and_b32 v83, s66, v129
    v_lshlrev_b32 v104, 16, v130
    v_and_b32 v105, s66, v130
    v_lshlrev_b32 v106, 16, v131
    v_and_b32 v107, s66, v131
    v_add_u32 v13, s62, v12
    s_add_u32 s62, s62, 24576
    s_cmp_eq_u32 s62, 73728
    s_cselect_b32 s62, 0, s62
    s_barrier
    ds_read_b128 v[36:39], v13 offset:0
    ds_read_b128 v[40:43], v13 offset:256
    ds_read_b128 v[44:47], v13 offset:512
    ds_read_b128 v[48:51], v13 offset:1536
    ds_read_b128 v[52:55], v13 offset:1792
    ds_read_b128 v[56:59], v13 offset:2048
    s_waitcnt lgkmcnt(3)
    v_cvt_f32_i32 v36, v36
    v_cvt_f32_i32 v37, v37
    v_cvt_f32_i32 v38, v38
    v_cvt_f32_i32 v39, v39
    v_cvt_f32_i32 v40, v40
    v_cvt_f32_i32 v41, v41
    v_cvt_f32_i32 v42, v42
    v_cvt_f32_i32 v43, v43
    v_cvt_f32_i32 v44, v44
    v_cvt_f32_i32 v45, v45
    v_cvt_f32_i32 v46, v46
    v_cvt_f32_i32 v47, v47
    v_sub_f32 v36, v36, v60
    v_sub_f32 v37, v37, v61
    v_sub_f32 v38, v38, v62
    v_sub_f32 v39, v39, v63
    v_sub_f32 v40, v40, v64
    v_sub_f32 v41, v41, v65
    v_sub_f32 v42, v42, v66
    v_sub_f32 v43, v43, v67
    v_sub_f32 v44, v44, v68
    v_sub_f32 v45, v45, v69
    v_sub_f32 v46, v46, v70
    v_sub_f32 v47, v47, v71
    v_cvt_pk_bf16_f32 v36, 0, v36
    v_cvt_pk_bf16_f32 v37, 0, v37
    v_cvt_pk_bf16_f32 v38, 0, v38
    v_cvt_pk_bf16_f32 v39, 0, v39
    v_cvt_pk_bf16_f32 v40, 0, v40
    v_cvt_pk_bf16_f32 v41, 0, v41
    v_cvt_pk_bf16_f32 v42, 0, v42
    v_cvt_pk_bf16_f32 v43, 0, v43
    v_cvt_pk_bf16_f32 v44, 0, v44
    v_cvt_pk_bf16_f32 v45, 0, v45
    v_cvt_pk_bf16_f32 v46, 0, v46
    v_cvt_pk_bf16_f32 v47, 0, v47
    v_mul_f32 v36, v36, v84
    v_mul_f32 v37, v37, v85
    v_mul_f32 v38, v38, v86
    v_mul_f32 v39, v39, v87
    v_mul_f32 v40, v40, v88
    v_mul_f32 v41, v41, v89
    v_mul_f32 v42, v42, v90
    v_mul_f32 v43, v43, v91
    v_mul_f32 v44, v44, v92
    v_mul_f32 v45, v45, v93
    v_mul_f32 v46, v46, v94
    v_mul_f32 v47, v47, v95
    v_cvt_pk_bf16_f32 v132, v36, v37
    v_cvt_pk_bf16_f32 v133, v38, v39
    v_cvt_pk_bf16_f32 v134, v40, v41
    v_cvt_pk_bf16_f32 v135, v42, v43
    v_cvt_pk_bf16_f32 v136, v44, v45
    v_cvt_pk_bf16_f32 v137, v46, v47
    v_mfma_f32_16x16x16_bf16 v[144:147], v[132:133], v[164:165], 0
    v_mfma_f32_16x16x16_bf16 v[144:147], v[134:135], v[166:167], v[144:147]
    v_mfma_f32_16x16x16_bf16 v[144:147], v[136:137], v[168:169], v[144:147]
    s_waitcnt lgkmcnt(0)
    v_cvt_f32_i32 v48, v48
    v_cvt_f32_i32 v49, v49
    v_cvt_f32_i32 v50, v50
    v_cvt_f32_i32 v51, v51
    v_cvt_f32_i32 v52, v52
    v_cvt_f32_i32 v53, v53
    v_cvt_f32_i32 v54, v54
    v_cvt_f32_i32 v55, v55
    v_cvt_f32_i32 v56, v56
    v_cvt_f32_i32 v57, v57
    v_cvt_f32_i32 v58, v58
    v_cvt_f32_i32 v59, v59
    v_sub_f32 v48, v48, v72
    v_sub_f32 v49, v49, v73
    v_sub_f32 v50, v50, v74
    v_sub_f32 v51, v51, v75
    v_sub_f32 v52, v52, v76
    v_sub_f32 v53, v53, v77
    v_sub_f32 v54, v54, v78
    v_sub_f32 v55, v55, v79
    v_sub_f32 v56, v56, v80
    v_sub_f32 v57, v57, v81
    v_sub_f32 v58, v58, v82
    v_sub_f32 v59, v59, v83
    v_cvt_pk_bf16_f32 v48, 0, v48
    v_cvt_pk_bf16_f32 v49, 0, v49
    v_cvt_pk_bf16_f32 v50, 0, v50
    v_cvt_pk_bf16_f32 v51, 0, v51
    v_cvt_pk_bf16_f32 v52, 0, v52
    v_cvt_pk_bf16_f32 v53, 0, v53
    v_cvt_pk_bf16_f32 v54, 0, v54
    v_cvt_pk_bf16_f32 v55, 0, v55
    v_cvt_pk_bf16_f32 v56, 0, v56
    v_cvt_pk_bf16_f32 v57, 0, v57
    v_cvt_pk_bf16_f32 v58, 0, v58
    v_cvt_pk_bf16_f32 v59, 0, v59
    v_mul_f32 v48, v48, v96
    v_mul_f32 v49, v49, v97
    v_mul_f32 v50, v50, v98
    v_mul_f32 v51, v51, v99
    v_mul_f32 v52, v52, v100
    v_mul_f32 v53, v53, v101
    v_mul_f32 v54, v54, v102
    v_mul_f32 v55, v55, v103
    v_mul_f32 v56, v56, v104
    v_mul_f32 v57, v57, v105
    v_mul_f32 v58, v58, v106
    v_mul_f32 v59, v59, v107
    v_cvt_pk_bf16_f32 v138, v48, v49
    v_cvt_pk_bf16_f32 v139, v50, v51
    v_add_f32_dpp v3, v147, v146 row_ror:12 row_mask:0xf bank_mask:0xf
    v_cvt_pk_bf16_f32 v140, v52, v53
    v_cvt_pk_bf16_f32 v141, v54, v55
    v_add_f32_dpp v3, v144, v3 row_ror:8 row_mask:0xf bank_mask:0xf
    v_cvt_pk_bf16_f32 v142, v56, v57
    v_cvt_pk_bf16_f32 v143, v58, v59
    v_add_f32_dpp v15, v145, v3 row_ror:4 row_mask:0xf bank_mask:0x4
    v_mfma_f32_16x16x16_bf16 v[148:151], v[138:139], v[164:165], 0
    v_mfma_f32_16x16x16_bf16 v[148:151], v[140:141], v[166:167], v[148:151]
    v_mfma_f32_16x16x16_bf16 v[148:151], v[142:143], v[168:169], v[148:151]
    v_add_u32 v33, s63, v23
    v_add_u32 v34, s63, v24
    ds_read_b64 v[108:109], v33 offset:0
    ds_read_b64 v[110:111], v33 offset:1536
    ds_read_b64 v[112:113], v33 offset:128
    ds_read_b64 v[114:115], v33 offset:1664
    ds_read_b64 v[116:117], v33 offset:256
    ds_read_b64 v[118:119], v33 offset:1792
    ds_read_b64 v[120:121], v34 offset:0
    v_add_f32_dpp v4, v151, v150 row_ror:12 row_mask:0xf bank_mask:0xf
    ds_read_b64 v[122:123], v34 offset:1536
    ds_read_b64 v[124:125], v34 offset:128
    v_add_f32_dpp v4, v148, v4 row_ror:8 row_mask:0xf bank_mask:0xf
    ds_read_b64 v[126:127], v34 offset:1664
    ds_read_b64 v[128:129], v34 offset:256
    ds_read_b64 v[130:131], v34 offset:1792
    v_add_f32_dpp v16, v149, v4 row_ror:4 row_mask:0xf bank_mask:0x4
    s_waitcnt lgkmcnt(0)
    v_lshlrev_b32 v60, 16, v108
    v_and_b32 v61, s66, v108
    v_lshlrev_b32 v62, 16, v109
    v_and_b32 v63, s66, v109
    v_lshlrev_b32 v84, 16, v110
    v_and_b32 v85, s66, v110
    v_lshlrev_b32 v86, 16, v111
    v_and_b32 v87, s66, v111
    v_lshlrev_b32 v64, 16, v112
    v_and_b32 v65, s66, v112
    v_lshlrev_b32 v66, 16, v113
    v_and_b32 v67, s66, v113
    v_lshlrev_b32 v88, 16, v114
    v_and_b32 v89, s66, v114
    v_lshlrev_b32 v90, 16, v115
    v_and_b32 v91, s66, v115
    v_lshlrev_b32 v68, 16, v116
    v_and_b32 v69, s66, v116
    v_lshlrev_b32 v70, 16, v117
    v_and_b32 v71, s66, v117
    v_lshlrev_b32 v92, 16, v118
    v_and_b32 v93, s66, v118
    v_lshlrev_b32 v94, 16, v119
    v_and_b32 v95, s66, v119
    v_lshlrev_b32 v72, 16, v120
    v_and_b32 v73, s66, v120
    v_lshlrev_b32 v74, 16, v121
    v_and_b32 v75, s66, v121
    v_lshlrev_b32 v96, 16, v122
    v_and_b32 v97, s66, v122
    v_lshlrev_b32 v98, 16, v123
    v_and_b32 v99, s66, v123
    v_lshlrev_b32 v76, 16, v124
    v_and_b32 v77, s66, v124
    v_lshlrev_b32 v78, 16, v125
    v_and_b32 v79, s66, v125
    v_lshlrev_b32 v100, 16, v126
    v_and_b32 v101, s66, v126
    v_lshlrev_b32 v102, 16, v127
    v_and_b32 v103, s66, v127
    v_lshlrev_b32 v80, 16, v128
    v_and_b32 v81, s66, v128
    v_lshlrev_b32 v82, 16, v129
    v_and_b32 v83, s66, v129
    v_lshlrev_b32 v104, 16, v130
    v_and_b32 v105, s66, v130
    v_lshlrev_b32 v106, 16, v131
    v_and_b32 v107, s66, v131
    v_add_u32 v13, s62, v12
    s_add_u32 s62, s62, 24576
    s_cmp_eq_u32 s62, 73728
    s_cselect_b32 s62, 0, s62
    s_barrier
    ds_read_b128 v[36:39], v13 offset:0
    ds_read_b128 v[40:43], v13 offset:256
    ds_read_b128 v[44:47], v13 offset:512
    ds_read_b128 v[48:51], v13 offset:1536
    ds_read_b128 v[52:55], v13 offset:1792
    ds_read_b128 v[56:59], v13 offset:2048
    s_waitcnt lgkmcnt(3)
    v_cvt_f32_i32 v36, v36
    v_cvt_f32_i32 v37, v37
    v_cvt_f32_i32 v38, v38
    v_cvt_f32_i32 v39, v39
    v_cvt_f32_i32 v40, v40
    v_cvt_f32_i32 v41, v41
    v_cvt_f32_i32 v42, v42
    v_cvt_f32_i32 v43, v43
    v_cvt_f32_i32 v44, v44
    v_cvt_f32_i32 v45, v45
    v_cvt_f32_i32 v46, v46
    v_cvt_f32_i32 v47, v47
    v_sub_f32 v36, v36, v60
    v_sub_f32 v37, v37, v61
    v_sub_f32 v38, v38, v62
    v_sub_f32 v39, v39, v63
    v_sub_f32 v40, v40, v64
    v_sub_f32 v41, v41, v65
    v_sub_f32 v42, v42, v66
    v_sub_f32 v43, v43, v67
    v_sub_f32 v44, v44, v68
    v_sub_f32 v45, v45, v69
    v_sub_f32 v46, v46, v70
    v_sub_f32 v47, v47, v71
    v_cvt_pk_bf16_f32 v36, 0, v36
    v_cvt_pk_bf16_f32 v37, 0, v37
    v_cvt_pk_bf16_f32 v38, 0, v38
    v_cvt_pk_bf16_f32 v39, 0, v39
    v_cvt_pk_bf16_f32 v40, 0, v40
    v_cvt_pk_bf16_f32 v41, 0, v41
    v_cvt_pk_bf16_f32 v42, 0, v42
    v_cvt_pk_bf16_f32 v43, 0, v43
    v_cvt_pk_bf16_f32 v44, 0, v44
    v_cvt_pk_bf16_f32 v45, 0, v45
    v_cvt_pk_bf16_f32 v46, 0, v46
    v_cvt_pk_bf16_f32 v47, 0, v47
    v_mul_f32 v36, v36, v84
    v_mul_f32 v37, v37, v85
    v_mul_f32 v38, v38, v86
    v_mul_f32 v39, v39, v87
    v_mul_f32 v40, v40, v88
    v_mul_f32 v41, v41, v89
    v_mul_f32 v42, v42, v90
    v_mul_f32 v43, v43, v91
    v_mul_f32 v44, v44, v92
    v_mul_f32 v45, v45, v93
    v_mul_f32 v46, v46, v94
    v_mul_f32 v47, v47, v95
    v_cvt_pk_bf16_f32 v132, v36, v37
    v_cvt_pk_bf16_f32 v133, v38, v39
    v_cvt_pk_bf16_f32 v134, v40, v41
    v_cvt_pk_bf16_f32 v135, v42, v43
    v_cvt_pk_bf16_f32 v136, v44, v45
    v_cvt_pk_bf16_f32 v137, v46, v47
    v_mfma_f32_16x16x16_bf16 v[144:147], v[132:133], v[164:165], 0
    v_mfma_f32_16x16x16_bf16 v[144:147], v[134:135], v[166:167], v[144:147]
    v_mfma_f32_16x16x16_bf16 v[144:147], v[136:137], v[168:169], v[144:147]
    s_waitcnt lgkmcnt(0)
    v_cvt_f32_i32 v48, v48
    v_cvt_f32_i32 v49, v49
    v_cvt_f32_i32 v50, v50
    v_cvt_f32_i32 v51, v51
    v_cvt_f32_i32 v52, v52
    v_cvt_f32_i32 v53, v53
    v_cvt_f32_i32 v54, v54
    v_cvt_f32_i32 v55, v55
    v_cvt_f32_i32 v56, v56
    v_cvt_f32_i32 v57, v57
    v_cvt_f32_i32 v58, v58
    v_cvt_f32_i32 v59, v59
    v_sub_f32 v48, v48, v72
    v_sub_f32 v49, v49, v73
    v_sub_f32 v50, v50, v74
    v_sub_f32 v51, v51, v75
    v_sub_f32 v52, v52, v76
    v_sub_f32 v53, v53, v77
    v_sub_f32 v54, v54, v78
    v_sub_f32 v55, v55, v79
    v_sub_f32 v56, v56, v80
    v_sub_f32 v57, v57, v81
    v_sub_f32 v58, v58, v82
    v_sub_f32 v59, v59, v83
    v_cvt_pk_bf16_f32 v48, 0, v48
    v_cvt_pk_bf16_f32 v49, 0, v49
    v_cvt_pk_bf16_f32 v50, 0, v50
    v_cvt_pk_bf16_f32 v51, 0, v51
    v_cvt_pk_bf16_f32 v52, 0, v52
    v_cvt_pk_bf16_f32 v53, 0, v53
    v_cvt_pk_bf16_f32 v54, 0, v54
    v_cvt_pk_bf16_f32 v55, 0, v55
    v_cvt_pk_bf16_f32 v56, 0, v56
    v_cvt_pk_bf16_f32 v57, 0, v57
    v_cvt_pk_bf16_f32 v58, 0, v58
    v_cvt_pk_bf16_f32 v59, 0, v59
    v_mul_f32 v48, v48, v96
    v_mul_f32 v49, v49, v97
    v_mul_f32 v50, v50, v98
    v_mul_f32 v51, v51, v99
    v_mul_f32 v52, v52, v100
    v_mul_f32 v53, v53, v101
    v_mul_f32 v54, v54, v102
    v_mul_f32 v55, v55, v103
    v_mul_f32 v56, v56, v104
    v_mul_f32 v57, v57, v105
    v_mul_f32 v58, v58, v106
    v_mul_f32 v59, v59, v107
    v_cvt_pk_bf16_f32 v138, v48, v49
    v_cvt_pk_bf16_f32 v139, v50, v51
    v_add_f32_dpp v3, v144, v147 row_ror:12 row_mask:0xf bank_mask:0xf
    v_cvt_pk_bf16_f32 v140, v52, v53
    v_cvt_pk_bf16_f32 v141, v54, v55
    v_add_f32_dpp v3, v145, v3 row_ror:8 row_mask:0xf bank_mask:0xf
    v_cvt_pk_bf16_f32 v142, v56, v57
    v_cvt_pk_bf16_f32 v143, v58, v59
    v_add_f32_dpp v15, v146, v3 row_ror:4 row_mask:0xf bank_mask:0x8
    v_mfma_f32_16x16x16_bf16 v[148:151], v[138:139], v[164:165], 0
    v_mfma_f32_16x16x16_bf16 v[148:151], v[140:141], v[166:167], v[148:151]
    v_mfma_f32_16x16x16_bf16 v[148:151], v[142:143], v[168:169], v[148:151]
    v_add_u32 v33, s63, v25
    v_add_u32 v34, s63, v26
    ds_read_b64 v[108:109], v33 offset:0
    ds_read_b64 v[110:111], v33 offset:1536
    ds_read_b64 v[112:113], v33 offset:128
    ds_read_b64 v[114:115], v33 offset:1664
    ds_read_b64 v[116:117], v33 offset:256
    ds_read_b64 v[118:119], v33 offset:1792
    ds_read_b64 v[120:121], v34 offset:0
    v_add_f32_dpp v4, v148, v151 row_ror:12 row_mask:0xf bank_mask:0xf
    ds_read_b64 v[122:123], v34 offset:1536
    ds_read_b64 v[124:125], v34 offset:128
    v_add_f32_dpp v4, v149, v4 row_ror:8 row_mask:0xf bank_mask:0xf
    ds_read_b64 v[126:127], v34 offset:1664
    ds_read_b64 v[128:129], v34 offset:256
    ds_read_b64 v[130:131], v34 offset:1792
    v_add_f32_dpp v16, v150, v4 row_ror:4 row_mask:0xf bank_mask:0x8
    v_cvt_pk_bf16_f32 v3, 0, v15
    v_cvt_pk_bf16_f32 v4, 0, v16
    v_mul_f32 v3, s65, v3
    v_mul_f32 v4, s65, v4
    v_cvt_pk_bf16_f32 v5, v3, v4
    v_max3_f32 v14, v14, v3, v4
    ds_write_b32 v11, v5 offset:0
    s_waitcnt lgkmcnt(0)
    v_lshlrev_b32 v60, 16, v108
    v_and_b32 v61, s66, v108
    v_lshlrev_b32 v62, 16, v109
    v_and_b32 v63, s66, v109
    v_lshlrev_b32 v84, 16, v110
    v_and_b32 v85, s66, v110
    v_lshlrev_b32 v86, 16, v111
    v_and_b32 v87, s66, v111
    v_lshlrev_b32 v64, 16, v112
    v_and_b32 v65, s66, v112
    v_lshlrev_b32 v66, 16, v113
    v_and_b32 v67, s66, v113
    v_lshlrev_b32 v88, 16, v114
    v_and_b32 v89, s66, v114
    v_lshlrev_b32 v90, 16, v115
    v_and_b32 v91, s66, v115
    v_lshlrev_b32 v68, 16, v116
    v_and_b32 v69, s66, v116
    v_lshlrev_b32 v70, 16, v117
    v_and_b32 v71, s66, v117
    v_lshlrev_b32 v92, 16, v118
    v_and_b32 v93, s66, v118
    v_lshlrev_b32 v94, 16, v119
    v_and_b32 v95, s66, v119
    v_lshlrev_b32 v72, 16, v120
    v_and_b32 v73, s66, v120
    v_lshlrev_b32 v74, 16, v121
    v_and_b32 v75, s66, v121
    v_lshlrev_b32 v96, 16, v122
    v_and_b32 v97, s66, v122
    v_lshlrev_b32 v98, 16, v123
    v_and_b32 v99, s66, v123
    v_lshlrev_b32 v76, 16, v124
    v_and_b32 v77, s66, v124
    v_lshlrev_b32 v78, 16, v125
    v_and_b32 v79, s66, v125
    v_lshlrev_b32 v100, 16, v126
    v_and_b32 v101, s66, v126
    v_lshlrev_b32 v102, 16, v127
    v_and_b32 v103, s66, v127
    v_lshlrev_b32 v80, 16, v128
    v_and_b32 v81, s66, v128
    v_lshlrev_b32 v82, 16, v129
    v_and_b32 v83, s66, v129
    v_lshlrev_b32 v104, 16, v130
    v_and_b32 v105, s66, v130
    v_lshlrev_b32 v106, 16, v131
    v_and_b32 v107, s66, v131
    v_add_u32 v13, s62, v12
    s_add_u32 s62, s62, 24576
    s_cmp_eq_u32 s62, 73728
    s_cselect_b32 s62, 0, s62
    s_barrier
    ds_read_b128 v[36:39], v13 offset:0
    ds_read_b128 v[40:43], v13 offset:256
    ds_read_b128 v[44:47], v13 offset:512
    ds_read_b128 v[48:51], v13 offset:1536
    ds_read_b128 v[52:55], v13 offset:1792
    ds_read_b128 v[56:59], v13 offset:2048
    s_waitcnt lgkmcnt(3)
    v_cvt_f32_i32 v36, v36
    v_cvt_f32_i32 v37, v37
    v_cvt_f32_i32 v38, v38
    v_cvt_f32_i32 v39, v39
    v_cvt_f32_i32 v40, v40
    v_cvt_f32_i32 v41, v41
    v_cvt_f32_i32 v42, v42
    v_cvt_f32_i32 v43, v43
    v_cvt_f32_i32 v44, v44
    v_cvt_f32_i32 v45, v45
    v_cvt_f32_i32 v46, v46
    v_cvt_f32_i32 v47, v47
    v_sub_f32 v36, v36, v60
    v_sub_f32 v37, v37, v61
    v_sub_f32 v38, v38, v62
    v_sub_f32 v39, v39, v63
    v_sub_f32 v40, v40, v64
    v_sub_f32 v41, v41, v65
    v_sub_f32 v42, v42, v66
    v_sub_f32 v43, v43, v67
    v_sub_f32 v44, v44, v68
    v_sub_f32 v45, v45, v69
    v_sub_f32 v46, v46, v70
    v_sub_f32 v47, v47, v71
    v_cvt_pk_bf16_f32 v36, 0, v36
    v_cvt_pk_bf16_f32 v37, 0, v37
    v_cvt_pk_bf16_f32 v38, 0, v38
    v_cvt_pk_bf16_f32 v39, 0, v39
    v_cvt_pk_bf16_f32 v40, 0, v40
    v_cvt_pk_bf16_f32 v41, 0, v41
    v_cvt_pk_bf16_f32 v42, 0, v42
    v_cvt_pk_bf16_f32 v43, 0, v43
    v_cvt_pk_bf16_f32 v44, 0, v44
    v_cvt_pk_bf16_f32 v45, 0, v45
    v_cvt_pk_bf16_f32 v46, 0, v46
    v_cvt_pk_bf16_f32 v47, 0, v47
    v_mul_f32 v36, v36, v84
    v_mul_f32 v37, v37, v85
    v_mul_f32 v38, v38, v86
    v_mul_f32 v39, v39, v87
    v_mul_f32 v40, v40, v88
    v_mul_f32 v41, v41, v89
    v_mul_f32 v42, v42, v90
    v_mul_f32 v43, v43, v91
    v_mul_f32 v44, v44, v92
    v_mul_f32 v45, v45, v93
    v_mul_f32 v46, v46, v94
    v_mul_f32 v47, v47, v95
    v_cvt_pk_bf16_f32 v132, v36, v37
    v_cvt_pk_bf16_f32 v133, v38, v39
    v_cvt_pk_bf16_f32 v134, v40, v41
    v_cvt_pk_bf16_f32 v135, v42, v43
    v_cvt_pk_bf16_f32 v136, v44, v45
    v_cvt_pk_bf16_f32 v137, v46, v47
    v_mfma_f32_16x16x16_bf16 v[144:147], v[132:133], v[164:165], 0
    v_mfma_f32_16x16x16_bf16 v[144:147], v[134:135], v[166:167], v[144:147]
    v_mfma_f32_16x16x16_bf16 v[144:147], v[136:137], v[168:169], v[144:147]
    s_waitcnt lgkmcnt(0)
    v_cvt_f32_i32 v48, v48
    v_cvt_f32_i32 v49, v49
    v_cvt_f32_i32 v50, v50
    v_cvt_f32_i32 v51, v51
    v_cvt_f32_i32 v52, v52
    v_cvt_f32_i32 v53, v53
    v_cvt_f32_i32 v54, v54
    v_cvt_f32_i32 v55, v55
    v_cvt_f32_i32 v56, v56
    v_cvt_f32_i32 v57, v57
    v_cvt_f32_i32 v58, v58
    v_cvt_f32_i32 v59, v59
    v_sub_f32 v48, v48, v72
    v_sub_f32 v49, v49, v73
    v_sub_f32 v50, v50, v74
    v_sub_f32 v51, v51, v75
    v_sub_f32 v52, v52, v76
    v_sub_f32 v53, v53, v77
    v_sub_f32 v54, v54, v78
    v_sub_f32 v55, v55, v79
    v_sub_f32 v56, v56, v80
    v_sub_f32 v57, v57, v81
    v_sub_f32 v58, v58, v82
    v_sub_f32 v59, v59, v83
    v_cvt_pk_bf16_f32 v48, 0, v48
    v_cvt_pk_bf16_f32 v49, 0, v49
    v_cvt_pk_bf16_f32 v50, 0, v50
    v_cvt_pk_bf16_f32 v51, 0, v51
    v_cvt_pk_bf16_f32 v52, 0, v52
    v_cvt_pk_bf16_f32 v53, 0, v53
    v_cvt_pk_bf16_f32 v54, 0, v54
    v_cvt_pk_bf16_f32 v55, 0, v55
    v_cvt_pk_bf16_f32 v56, 0, v56
    v_cvt_pk_bf16_f32 v57, 0, v57
    v_cvt_pk_bf16_f32 v58, 0, v58
    v_cvt_pk_bf16_f32 v59, 0, v59
    v_mul_f32 v48, v48, v96
    v_mul_f32 v49, v49, v97
    v_mul_f32 v50, v50, v98
    v_mul_f32 v51, v51, v99
    v_mul_f32 v52, v52, v100
    v_mul_f32 v53, v53, v101
    v_mul_f32 v54, v54, v102
    v_mul_f32 v55, v55, v103
    v_mul_f32 v56, v56, v104
    v_mul_f32 v57, v57, v105
    v_mul_f32 v58, v58, v106
    v_mul_f32 v59, v59, v107
    v_cvt_pk_bf16_f32 v138, v48, v49
    v_cvt_pk_bf16_f32 v139, v50, v51
    v_add_f32_dpp v3, v145, v144 row_ror:12 row_mask:0xf bank_mask:0xf
    v_cvt_pk_bf16_f32 v140, v52, v53
    v_cvt_pk_bf16_f32 v141, v54, v55
    v_add_f32_dpp v3, v146, v3 row_ror:8 row_mask:0xf bank_mask:0xf
    v_cvt_pk_bf16_f32 v142, v56, v57
    v_cvt_pk_bf16_f32 v143, v58, v59
    v_add_f32_dpp v15, v147, v3 row_ror:4 row_mask:0xf bank_mask:0x1
    v_mfma_f32_16x16x16_bf16 v[148:151], v[138:139], v[164:165], 0
    v_mfma_f32_16x16x16_bf16 v[148:151], v[140:141], v[166:167], v[148:151]
    v_mfma_f32_16x16x16_bf16 v[148:151], v[142:143], v[168:169], v[148:151]
    v_add_u32 v33, s63, v27
    v_add_u32 v34, s63, v28
    ds_read_b64 v[108:109], v33 offset:0
    ds_read_b64 v[110:111], v33 offset:1536
    ds_read_b64 v[112:113], v33 offset:128
    ds_read_b64 v[114:115], v33 offset:1664
    ds_read_b64 v[116:117], v33 offset:256
    ds_read_b64 v[118:119], v33 offset:1792
    ds_read_b64 v[120:121], v34 offset:0
    v_add_f32_dpp v4, v149, v148 row_ror:12 row_mask:0xf bank_mask:0xf
    ds_read_b64 v[122:123], v34 offset:1536
    ds_read_b64 v[124:125], v34 offset:128
    v_add_f32_dpp v4, v150, v4 row_ror:8 row_mask:0xf bank_mask:0xf
    ds_read_b64 v[126:127], v34 offset:1664
    ds_read_b64 v[128:129], v34 offset:256
    ds_read_b64 v[130:131], v34 offset:1792
    v_add_f32_dpp v16, v151, v4 row_ror:4 row_mask:0xf bank_mask:0x1
    s_waitcnt lgkmcnt(0)
    v_lshlrev_b32 v60, 16, v108
    v_and_b32 v61, s66, v108
    v_lshlrev_b32 v62, 16, v109
    v_and_b32 v63, s66, v109
    v_lshlrev_b32 v84, 16, v110
    v_and_b32 v85, s66, v110
    v_lshlrev_b32 v86, 16, v111
    v_and_b32 v87, s66, v111
    v_lshlrev_b32 v64, 16, v112
    v_and_b32 v65, s66, v112
    v_lshlrev_b32 v66, 16, v113
    v_and_b32 v67, s66, v113
    v_lshlrev_b32 v88, 16, v114
    v_and_b32 v89, s66, v114
    v_lshlrev_b32 v90, 16, v115
    v_and_b32 v91, s66, v115
    v_lshlrev_b32 v68, 16, v116
    v_and_b32 v69, s66, v116
    v_lshlrev_b32 v70, 16, v117
    v_and_b32 v71, s66, v117
    v_lshlrev_b32 v92, 16, v118
    v_and_b32 v93, s66, v118
    v_lshlrev_b32 v94, 16, v119
    v_and_b32 v95, s66, v119
    v_lshlrev_b32 v72, 16, v120
    v_and_b32 v73, s66, v120
    v_lshlrev_b32 v74, 16, v121
    v_and_b32 v75, s66, v121
    v_lshlrev_b32 v96, 16, v122
    v_and_b32 v97, s66, v122
    v_lshlrev_b32 v98, 16, v123
    v_and_b32 v99, s66, v123
    v_lshlrev_b32 v76, 16, v124
    v_and_b32 v77, s66, v124
    v_lshlrev_b32 v78, 16, v125
    v_and_b32 v79, s66, v125
    v_lshlrev_b32 v100, 16, v126
    v_and_b32 v101, s66, v126
    v_lshlrev_b32 v102, 16, v127
    v_and_b32 v103, s66, v127
    v_lshlrev_b32 v80, 16, v128
    v_and_b32 v81, s66, v128
    v_lshlrev_b32 v82, 16, v129
    v_and_b32 v83, s66, v129
    v_lshlrev_b32 v104, 16, v130
    v_and_b32 v105, s66, v130
    v_lshlrev_b32 v106, 16, v131
    v_and_b32 v107, s66, v131
    v_add_u32 v13, s62, v12
    s_add_u32 s62, s62, 24576
    s_cmp_eq_u32 s62, 73728
    s_cselect_b32 s62, 0, s62
    s_barrier
    ds_read_b128 v[36:39], v13 offset:0
    ds_read_b128 v[40:43], v13 offset:256
    ds_read_b128 v[44:47], v13 offset:512
    ds_read_b128 v[48:51], v13 offset:1536
    ds_read_b128 v[52:55], v13 offset:1792
    ds_read_b128 v[56:59], v13 offset:2048
    s_waitcnt lgkmcnt(3)
    v_cvt_f32_i32 v36, v36
    v_cvt_f32_i32 v37, v37
    v_cvt_f32_i32 v38, v38
    v_cvt_f32_i32 v39, v39
    v_cvt_f32_i32 v40, v40
    v_cvt_f32_i32 v41, v41
    v_cvt_f32_i32 v42, v42
    v_cvt_f32_i32 v43, v43
    v_cvt_f32_i32 v44, v44
    v_cvt_f32_i32 v45, v45
    v_cvt_f32_i32 v46, v46
    v_cvt_f32_i32 v47, v47
    v_sub_f32 v36, v36, v60
    v_sub_f32 v37, v37, v61
    v_sub_f32 v38, v38, v62
    v_sub_f32 v39, v39, v63
    v_sub_f32 v40, v40, v64
    v_sub_f32 v41, v41, v65
    v_sub_f32 v42, v42, v66
    v_sub_f32 v43, v43, v67
    v_sub_f32 v44, v44, v68
    v_sub_f32 v45, v45, v69
    v_sub_f32 v46, v46, v70
    v_sub_f32 v47, v47, v71
    v_cvt_pk_bf16_f32 v36, 0, v36
    v_cvt_pk_bf16_f32 v37, 0, v37
    v_cvt_pk_bf16_f32 v38, 0, v38
    v_cvt_pk_bf16_f32 v39, 0, v39
    v_cvt_pk_bf16_f32 v40, 0, v40
    v_cvt_pk_bf16_f32 v41, 0, v41
    v_cvt_pk_bf16_f32 v42, 0, v42
    v_cvt_pk_bf16_f32 v43, 0, v43
    v_cvt_pk_bf16_f32 v44, 0, v44
    v_cvt_pk_bf16_f32 v45, 0, v45
    v_cvt_pk_bf16_f32 v46, 0, v46
    v_cvt_pk_bf16_f32 v47, 0, v47
    v_mul_f32 v36, v36, v84
    v_mul_f32 v37, v37, v85
    v_mul_f32 v38, v38, v86
    v_mul_f32 v39, v39, v87
    v_mul_f32 v40, v40, v88
    v_mul_f32 v41, v41, v89
    v_mul_f32 v42, v42, v90
    v_mul_f32 v43, v43, v91
    v_mul_f32 v44, v44, v92
    v_mul_f32 v45, v45, v93
    v_mul_f32 v46, v46, v94
    v_mul_f32 v47, v47, v95
    v_cvt_pk_bf16_f32 v132, v36, v37
    v_cvt_pk_bf16_f32 v133, v38, v39
    v_cvt_pk_bf16_f32 v134, v40, v41
    v_cvt_pk_bf16_f32 v135, v42, v43
    v_cvt_pk_bf16_f32 v136, v44, v45
    v_cvt_pk_bf16_f32 v137, v46, v47
    v_mfma_f32_16x16x16_bf16 v[144:147], v[132:133], v[164:165], 0
    v_mfma_f32_16x16x16_bf16 v[144:147], v[134:135], v[166:167], v[144:147]
    v_mfma_f32_16x16x16_bf16 v[144:147], v[136:137], v[168:169], v[144:147]
    s_waitcnt lgkmcnt(0)
    v_cvt_f32_i32 v48, v48
    v_cvt_f32_i32 v49, v49
    v_cvt_f32_i32 v50, v50
    v_cvt_f32_i32 v51, v51
    v_cvt_f32_i32 v52, v52
    v_cvt_f32_i32 v53, v53
    v_cvt_f32_i32 v54, v54
    v_cvt_f32_i32 v55, v55
    v_cvt_f32_i32 v56, v56
    v_cvt_f32_i32 v57, v57
    v_cvt_f32_i32 v58, v58
    v_cvt_f32_i32 v59, v59
    v_sub_f32 v48, v48, v72
    v_sub_f32 v49, v49, v73
    v_sub_f32 v50, v50, v74
    v_sub_f32 v51, v51, v75
    v_sub_f32 v52, v52, v76
    v_sub_f32 v53, v53, v77
    v_sub_f32 v54, v54, v78
    v_sub_f32 v55, v55, v79
    v_sub_f32 v56, v56, v80
    v_sub_f32 v57, v57, v81
    v_sub_f32 v58, v58, v82
    v_sub_f32 v59, v59, v83
    v_cvt_pk_bf16_f32 v48, 0, v48
    v_cvt_pk_bf16_f32 v49, 0, v49
    v_cvt_pk_bf16_f32 v50, 0, v50
    v_cvt_pk_bf16_f32 v51, 0, v51
    v_cvt_pk_bf16_f32 v52, 0, v52
    v_cvt_pk_bf16_f32 v53, 0, v53
    v_cvt_pk_bf16_f32 v54, 0, v54
    v_cvt_pk_bf16_f32 v55, 0, v55
    v_cvt_pk_bf16_f32 v56, 0, v56
    v_cvt_pk_bf16_f32 v57, 0, v57
    v_cvt_pk_bf16_f32 v58, 0, v58
    v_cvt_pk_bf16_f32 v59, 0, v59
    v_mul_f32 v48, v48, v96
    v_mul_f32 v49, v49, v97
    v_mul_f32 v50, v50, v98
    v_mul_f32 v51, v51, v99
    v_mul_f32 v52, v52, v100
    v_mul_f32 v53, v53, v101
    v_mul_f32 v54, v54, v102
    v_mul_f32 v55, v55, v103
    v_mul_f32 v56, v56, v104
    v_mul_f32 v57, v57, v105
    v_mul_f32 v58, v58, v106
    v_mul_f32 v59, v59, v107
    v_cvt_pk_bf16_f32 v138, v48, v49
    v_cvt_pk_bf16_f32 v139, v50, v51
    v_add_f32_dpp v3, v146, v145 row_ror:12 row_mask:0xf bank_mask:0xf
    v_cvt_pk_bf16_f32 v140, v52, v53
    v_cvt_pk_bf16_f32 v141, v54, v55
    v_add_f32_dpp v3, v147, v3 row_ror:8 row_mask:0xf bank_mask:0xf
    v_cvt_pk_bf16_f32 v142, v56, v57
    v_cvt_pk_bf16_f32 v143, v58, v59
    v_add_f32_dpp v15, v144, v3 row_ror:4 row_mask:0xf bank_mask:0x2
    v_mfma_f32_16x16x16_bf16 v[148:151], v[138:139], v[164:165], 0
    v_mfma_f32_16x16x16_bf16 v[148:151], v[140:141], v[166:167], v[148:151]
    v_mfma_f32_16x16x16_bf16 v[148:151], v[142:143], v[168:169], v[148:151]
    v_add_u32 v33, s63, v29
    v_add_u32 v34, s63, v30
    ds_read_b64 v[108:109], v33 offset:0
    ds_read_b64 v[110:111], v33 offset:1536
    ds_read_b64 v[112:113], v33 offset:128
    ds_read_b64 v[114:115], v33 offset:1664
    ds_read_b64 v[116:117], v33 offset:256
    ds_read_b64 v[118:119], v33 offset:1792
    ds_read_b64 v[120:121], v34 offset:0
    v_add_f32_dpp v4, v150, v149 row_ror:12 row_mask:0xf bank_mask:0xf
    ds_read_b64 v[122:123], v34 offset:1536
    ds_read_b64 v[124:125], v34 offset:128
    v_add_f32_dpp v4, v151, v4 row_ror:8 row_mask:0xf bank_mask:0xf
    ds_read_b64 v[126:127], v34 offset:1664
    ds_read_b64 v[128:129], v34 offset:256
    ds_read_b64 v[130:131], v34 offset:1792
    v_add_f32_dpp v16, v148, v4 row_ror:4 row_mask:0xf bank_mask:0x2
    s_waitcnt lgkmcnt(0)
    v_lshlrev_b32 v60, 16, v108
    v_and_b32 v61, s66, v108
    v_lshlrev_b32 v62, 16, v109
    v_and_b32 v63, s66, v109
    v_lshlrev_b32 v84, 16, v110
    v_and_b32 v85, s66, v110
    v_lshlrev_b32 v86, 16, v111
    v_and_b32 v87, s66, v111
    v_lshlrev_b32 v64, 16, v112
    v_and_b32 v65, s66, v112
    v_lshlrev_b32 v66, 16, v113
    v_and_b32 v67, s66, v113
    v_lshlrev_b32 v88, 16, v114
    v_and_b32 v89, s66, v114
    v_lshlrev_b32 v90, 16, v115
    v_and_b32 v91, s66, v115
    v_lshlrev_b32 v68, 16, v116
    v_and_b32 v69, s66, v116
    v_lshlrev_b32 v70, 16, v117
    v_and_b32 v71, s66, v117
    v_lshlrev_b32 v92, 16, v118
    v_and_b32 v93, s66, v118
    v_lshlrev_b32 v94, 16, v119
    v_and_b32 v95, s66, v119
    v_lshlrev_b32 v72, 16, v120
    v_and_b32 v73, s66, v120
    v_lshlrev_b32 v74, 16, v121
    v_and_b32 v75, s66, v121
    v_lshlrev_b32 v96, 16, v122
    v_and_b32 v97, s66, v122
    v_lshlrev_b32 v98, 16, v123
    v_and_b32 v99, s66, v123
    v_lshlrev_b32 v76, 16, v124
    v_and_b32 v77, s66, v124
    v_lshlrev_b32 v78, 16, v125
    v_and_b32 v79, s66, v125
    v_lshlrev_b32 v100, 16, v126
    v_and_b32 v101, s66, v126
    v_lshlrev_b32 v102, 16, v127
    v_and_b32 v103, s66, v127
    v_lshlrev_b32 v80, 16, v128
    v_and_b32 v81, s66, v128
    v_lshlrev_b32 v82, 16, v129
    v_and_b32 v83, s66, v129
    v_lshlrev_b32 v104, 16, v130
    v_and_b32 v105, s66, v130
    v_lshlrev_b32 v106, 16, v131
    v_and_b32 v107, s66, v131
    v_add_u32 v13, s62, v12
    s_add_u32 s62, s62, 24576
    s_cmp_eq_u32 s62, 73728
    s_cselect_b32 s62, 0, s62
    s_barrier
    ds_read_b128 v[36:39], v13 offset:0
    ds_read_b128 v[40:43], v13 offset:256
    ds_read_b128 v[44:47], v13 offset:512
    ds_read_b128 v[48:51], v13 offset:1536
    ds_read_b128 v[52:55], v13 offset:1792
    ds_read_b128 v[56:59], v13 offset:2048
    s_waitcnt lgkmcnt(3)
    v_cvt_f32_i32 v36, v36
    v_cvt_f32_i32 v37, v37
    v_cvt_f32_i32 v38, v38
    v_cvt_f32_i32 v39, v39
    v_cvt_f32_i32 v40, v40
    v_cvt_f32_i32 v41, v41
    v_cvt_f32_i32 v42, v42
    v_cvt_f32_i32 v43, v43
    v_cvt_f32_i32 v44, v44
    v_cvt_f32_i32 v45, v45
    v_cvt_f32_i32 v46, v46
    v_cvt_f32_i32 v47, v47
    v_sub_f32 v36, v36, v60
    v_sub_f32 v37, v37, v61
    v_sub_f32 v38, v38, v62
    v_sub_f32 v39, v39, v63
    v_sub_f32 v40, v40, v64
    v_sub_f32 v41, v41, v65
    v_sub_f32 v42, v42, v66
    v_sub_f32 v43, v43, v67
    v_sub_f32 v44, v44, v68
    v_sub_f32 v45, v45, v69
    v_sub_f32 v46, v46, v70
    v_sub_f32 v47, v47, v71
    v_cvt_pk_bf16_f32 v36, 0, v36
    v_cvt_pk_bf16_f32 v37, 0, v37
    v_cvt_pk_bf16_f32 v38, 0, v38
    v_cvt_pk_bf16_f32 v39, 0, v39
    v_cvt_pk_bf16_f32 v40, 0, v40
    v_cvt_pk_bf16_f32 v41, 0, v41
    v_cvt_pk_bf16_f32 v42, 0, v42
    v_cvt_pk_bf16_f32 v43, 0, v43
    v_cvt_pk_bf16_f32 v44, 0, v44
    v_cvt_pk_bf16_f32 v45, 0, v45
    v_cvt_pk_bf16_f32 v46, 0, v46
    v_cvt_pk_bf16_f32 v47, 0, v47
    v_mul_f32 v36, v36, v84
    v_mul_f32 v37, v37, v85
    v_mul_f32 v38, v38, v86
    v_mul_f32 v39, v39, v87
    v_mul_f32 v40, v40, v88
    v_mul_f32 v41, v41, v89
    v_mul_f32 v42, v42, v90
    v_mul_f32 v43, v43, v91
    v_mul_f32 v44, v44, v92
    v_mul_f32 v45, v45, v93
    v_mul_f32 v46, v46, v94
    v_mul_f32 v47, v47, v95
    v_cvt_pk_bf16_f32 v132, v36, v37
    v_cvt_pk_bf16_f32 v133, v38, v39
    v_cvt_pk_bf16_f32 v134, v40, v41
    v_cvt_pk_bf16_f32 v135, v42, v43
    v_cvt_pk_bf16_f32 v136, v44, v45
    v_cvt_pk_bf16_f32 v137, v46, v47
    v_mfma_f32_16x16x16_bf16 v[144:147], v[132:133], v[164:165], 0
    v_mfma_f32_16x16x16_bf16 v[144:147], v[134:135], v[166:167], v[144:147]
    v_mfma_f32_16x16x16_bf16 v[144:147], v[136:137], v[168:169], v[144:147]
    s_waitcnt lgkmcnt(0)
    v_cvt_f32_i32 v48, v48
    v_cvt_f32_i32 v49, v49
    v_cvt_f32_i32 v50, v50
    v_cvt_f32_i32 v51, v51
    v_cvt_f32_i32 v52, v52
    v_cvt_f32_i32 v53, v53
    v_cvt_f32_i32 v54, v54
    v_cvt_f32_i32 v55, v55
    v_cvt_f32_i32 v56, v56
    v_cvt_f32_i32 v57, v57
    v_cvt_f32_i32 v58, v58
    v_cvt_f32_i32 v59, v59
    v_sub_f32 v48, v48, v72
    v_sub_f32 v49, v49, v73
    v_sub_f32 v50, v50, v74
    v_sub_f32 v51, v51, v75
    v_sub_f32 v52, v52, v76
    v_sub_f32 v53, v53, v77
    v_sub_f32 v54, v54, v78
    v_sub_f32 v55, v55, v79
    v_sub_f32 v56, v56, v80
    v_sub_f32 v57, v57, v81
    v_sub_f32 v58, v58, v82
    v_sub_f32 v59, v59, v83
    v_cvt_pk_bf16_f32 v48, 0, v48
    v_cvt_pk_bf16_f32 v49, 0, v49
    v_cvt_pk_bf16_f32 v50, 0, v50
    v_cvt_pk_bf16_f32 v51, 0, v51
    v_cvt_pk_bf16_f32 v52, 0, v52
    v_cvt_pk_bf16_f32 v53, 0, v53
    v_cvt_pk_bf16_f32 v54, 0, v54
    v_cvt_pk_bf16_f32 v55, 0, v55
    v_cvt_pk_bf16_f32 v56, 0, v56
    v_cvt_pk_bf16_f32 v57, 0, v57
    v_cvt_pk_bf16_f32 v58, 0, v58
    v_cvt_pk_bf16_f32 v59, 0, v59
    v_mul_f32 v48, v48, v96
    v_mul_f32 v49, v49, v97
    v_mul_f32 v50, v50, v98
    v_mul_f32 v51, v51, v99
    v_mul_f32 v52, v52, v100
    v_mul_f32 v53, v53, v101
    v_mul_f32 v54, v54, v102
    v_mul_f32 v55, v55, v103
    v_mul_f32 v56, v56, v104
    v_mul_f32 v57, v57, v105
    v_mul_f32 v58, v58, v106
    v_mul_f32 v59, v59, v107
    v_cvt_pk_bf16_f32 v138, v48, v49
    v_cvt_pk_bf16_f32 v139, v50, v51
    v_add_f32_dpp v3, v147, v146 row_ror:12 row_mask:0xf bank_mask:0xf
    v_cvt_pk_bf16_f32 v140, v52, v53
    v_cvt_pk_bf16_f32 v141, v54, v55
    v_add_f32_dpp v3, v144, v3 row_ror:8 row_mask:0xf bank_mask:0xf
    v_cvt_pk_bf16_f32 v142, v56, v57
    v_cvt_pk_bf16_f32 v143, v58, v59
    v_add_f32_dpp v15, v145, v3 row_ror:4 row_mask:0xf bank_mask:0x4
    v_mfma_f32_16x16x16_bf16 v[148:151], v[138:139], v[164:165], 0
    v_mfma_f32_16x16x16_bf16 v[148:151], v[140:141], v[166:167], v[148:151]
    v_mfma_f32_16x16x16_bf16 v[148:151], v[142:143], v[168:169], v[148:151]
    v_add_u32 v33, s63, v31
    v_add_u32 v34, s63, v32
    ds_read_b64 v[108:109], v33 offset:0
    ds_read_b64 v[110:111], v33 offset:1536
    ds_read_b64 v[112:113], v33 offset:128
    ds_read_b64 v[114:115], v33 offset:1664
    ds_read_b64 v[116:117], v33 offset:256
    ds_read_b64 v[118:119], v33 offset:1792
    ds_read_b64 v[120:121], v34 offset:0
    v_add_f32_dpp v4, v151, v150 row_ror:12 row_mask:0xf bank_mask:0xf
    ds_read_b64 v[122:123], v34 offset:1536
    ds_read_b64 v[124:125], v34 offset:128
    v_add_f32_dpp v4, v148, v4 row_ror:8 row_mask:0xf bank_mask:0xf
    ds_read_b64 v[126:127], v34 offset:1664
    ds_read_b64 v[128:129], v34 offset:256
    ds_read_b64 v[130:131], v34 offset:1792
    v_add_f32_dpp v16, v149, v4 row_ror:4 row_mask:0xf bank_mask:0x4
    s_waitcnt lgkmcnt(0)
    v_lshlrev_b32 v60, 16, v108
    v_and_b32 v61, s66, v108
    v_lshlrev_b32 v62, 16, v109
    v_and_b32 v63, s66, v109
    v_lshlrev_b32 v84, 16, v110
    v_and_b32 v85, s66, v110
    v_lshlrev_b32 v86, 16, v111
    v_and_b32 v87, s66, v111
    v_lshlrev_b32 v64, 16, v112
    v_and_b32 v65, s66, v112
    v_lshlrev_b32 v66, 16, v113
    v_and_b32 v67, s66, v113
    v_lshlrev_b32 v88, 16, v114
    v_and_b32 v89, s66, v114
    v_lshlrev_b32 v90, 16, v115
    v_and_b32 v91, s66, v115
    v_lshlrev_b32 v68, 16, v116
    v_and_b32 v69, s66, v116
    v_lshlrev_b32 v70, 16, v117
    v_and_b32 v71, s66, v117
    v_lshlrev_b32 v92, 16, v118
    v_and_b32 v93, s66, v118
    v_lshlrev_b32 v94, 16, v119
    v_and_b32 v95, s66, v119
    v_lshlrev_b32 v72, 16, v120
    v_and_b32 v73, s66, v120
    v_lshlrev_b32 v74, 16, v121
    v_and_b32 v75, s66, v121
    v_lshlrev_b32 v96, 16, v122
    v_and_b32 v97, s66, v122
    v_lshlrev_b32 v98, 16, v123
    v_and_b32 v99, s66, v123
    v_lshlrev_b32 v76, 16, v124
    v_and_b32 v77, s66, v124
    v_lshlrev_b32 v78, 16, v125
    v_and_b32 v79, s66, v125
    v_lshlrev_b32 v100, 16, v126
    v_and_b32 v101, s66, v126
    v_lshlrev_b32 v102, 16, v127
    v_and_b32 v103, s66, v127
    v_lshlrev_b32 v80, 16, v128
    v_and_b32 v81, s66, v128
    v_lshlrev_b32 v82, 16, v129
    v_and_b32 v83, s66, v129
    v_lshlrev_b32 v104, 16, v130
    v_and_b32 v105, s66, v130
    v_lshlrev_b32 v106, 16, v131
    v_and_b32 v107, s66, v131
    v_add_u32 v13, s62, v12
    s_add_u32 s62, s62, 24576
    s_cmp_eq_u32 s62, 73728
    s_cselect_b32 s62, 0, s62
    s_barrier
    ds_read_b128 v[36:39], v13 offset:0
    ds_read_b128 v[40:43], v13 offset:256
    ds_read_b128 v[44:47], v13 offset:512
    ds_read_b128 v[48:51], v13 offset:1536
    ds_read_b128 v[52:55], v13 offset:1792
    ds_read_b128 v[56:59], v13 offset:2048
    s_waitcnt lgkmcnt(3)
    v_cvt_f32_i32 v36, v36
    v_cvt_f32_i32 v37, v37
    v_cvt_f32_i32 v38, v38
    v_cvt_f32_i32 v39, v39
    v_cvt_f32_i32 v40, v40
    v_cvt_f32_i32 v41, v41
    v_cvt_f32_i32 v42, v42
    v_cvt_f32_i32 v43, v43
    v_cvt_f32_i32 v44, v44
    v_cvt_f32_i32 v45, v45
    v_cvt_f32_i32 v46, v46
    v_cvt_f32_i32 v47, v47
    v_sub_f32 v36, v36, v60
    v_sub_f32 v37, v37, v61
    v_sub_f32 v38, v38, v62
    v_sub_f32 v39, v39, v63
    v_sub_f32 v40, v40, v64
    v_sub_f32 v41, v41, v65
    v_sub_f32 v42, v42, v66
    v_sub_f32 v43, v43, v67
    v_sub_f32 v44, v44, v68
    v_sub_f32 v45, v45, v69
    v_sub_f32 v46, v46, v70
    v_sub_f32 v47, v47, v71
    v_cvt_pk_bf16_f32 v36, 0, v36
    v_cvt_pk_bf16_f32 v37, 0, v37
    v_cvt_pk_bf16_f32 v38, 0, v38
    v_cvt_pk_bf16_f32 v39, 0, v39
    v_cvt_pk_bf16_f32 v40, 0, v40
    v_cvt_pk_bf16_f32 v41, 0, v41
    v_cvt_pk_bf16_f32 v42, 0, v42
    v_cvt_pk_bf16_f32 v43, 0, v43
    v_cvt_pk_bf16_f32 v44, 0, v44
    v_cvt_pk_bf16_f32 v45, 0, v45
    v_cvt_pk_bf16_f32 v46, 0, v46
    v_cvt_pk_bf16_f32 v47, 0, v47
    v_mul_f32 v36, v36, v84
    v_mul_f32 v37, v37, v85
    v_mul_f32 v38, v38, v86
    v_mul_f32 v39, v39, v87
    v_mul_f32 v40, v40, v88
    v_mul_f32 v41, v41, v89
    v_mul_f32 v42, v42, v90
    v_mul_f32 v43, v43, v91
    v_mul_f32 v44, v44, v92
    v_mul_f32 v45, v45, v93
    v_mul_f32 v46, v46, v94
    v_mul_f32 v47, v47, v95
    v_cvt_pk_bf16_f32 v132, v36, v37
    v_cvt_pk_bf16_f32 v133, v38, v39
    v_cvt_pk_bf16_f32 v134, v40, v41
    v_cvt_pk_bf16_f32 v135, v42, v43
    v_cvt_pk_bf16_f32 v136, v44, v45
    v_cvt_pk_bf16_f32 v137, v46, v47
    v_mfma_f32_16x16x16_bf16 v[144:147], v[132:133], v[164:165], 0
    v_mfma_f32_16x16x16_bf16 v[144:147], v[134:135], v[166:167], v[144:147]
    v_mfma_f32_16x16x16_bf16 v[144:147], v[136:137], v[168:169], v[144:147]
    s_waitcnt lgkmcnt(0)
    v_cvt_f32_i32 v48, v48
    v_cvt_f32_i32 v49, v49
    v_cvt_f32_i32 v50, v50
    v_cvt_f32_i32 v51, v51
    v_cvt_f32_i32 v52, v52
    v_cvt_f32_i32 v53, v53
    v_cvt_f32_i32 v54, v54
    v_cvt_f32_i32 v55, v55
    v_cvt_f32_i32 v56, v56
    v_cvt_f32_i32 v57, v57
    v_cvt_f32_i32 v58, v58
    v_cvt_f32_i32 v59, v59
    v_sub_f32 v48, v48, v72
    v_sub_f32 v49, v49, v73
    v_sub_f32 v50, v50, v74
    v_sub_f32 v51, v51, v75
    v_sub_f32 v52, v52, v76
    v_sub_f32 v53, v53, v77
    v_sub_f32 v54, v54, v78
    v_sub_f32 v55, v55, v79
    v_sub_f32 v56, v56, v80
    v_sub_f32 v57, v57, v81
    v_sub_f32 v58, v58, v82
    v_sub_f32 v59, v59, v83
    v_cvt_pk_bf16_f32 v48, 0, v48
    v_cvt_pk_bf16_f32 v49, 0, v49
    v_cvt_pk_bf16_f32 v50, 0, v50
    v_cvt_pk_bf16_f32 v51, 0, v51
    v_cvt_pk_bf16_f32 v52, 0, v52
    v_cvt_pk_bf16_f32 v53, 0, v53
    v_cvt_pk_bf16_f32 v54, 0, v54
    v_cvt_pk_bf16_f32 v55, 0, v55
    v_cvt_pk_bf16_f32 v56, 0, v56
    v_cvt_pk_bf16_f32 v57, 0, v57
    v_cvt_pk_bf16_f32 v58, 0, v58
    v_cvt_pk_bf16_f32 v59, 0, v59
    v_mul_f32 v48, v48, v96
    v_mul_f32 v49, v49, v97
    v_mul_f32 v50, v50, v98
    v_mul_f32 v51, v51, v99
    v_mul_f32 v52, v52, v100
    v_mul_f32 v53, v53, v101
    v_mul_f32 v54, v54, v102
    v_mul_f32 v55, v55, v103
    v_mul_f32 v56, v56, v104
    v_mul_f32 v57, v57, v105
    v_mul_f32 v58, v58, v106
    v_mul_f32 v59, v59, v107
    v_cvt_pk_bf16_f32 v138, v48, v49
    v_cvt_pk_bf16_f32 v139, v50, v51
    v_add_f32_dpp v3, v144, v147 row_ror:12 row_mask:0xf bank_mask:0xf
    v_cvt_pk_bf16_f32 v140, v52, v53
    v_cvt_pk_bf16_f32 v141, v54, v55
    v_add_f32_dpp v3, v145, v3 row_ror:8 row_mask:0xf bank_mask:0xf
    v_cvt_pk_bf16_f32 v142, v56, v57
    v_cvt_pk_bf16_f32 v143, v58, v59
    v_add_f32_dpp v15, v146, v3 row_ror:4 row_mask:0xf bank_mask:0x8
    v_mfma_f32_16x16x16_bf16 v[148:151], v[138:139], v[164:165], 0
    v_mfma_f32_16x16x16_bf16 v[148:151], v[140:141], v[166:167], v[148:151]
    v_mfma_f32_16x16x16_bf16 v[148:151], v[142:143], v[168:169], v[148:151]
    s_add_u32 s63, s63, 3072
    v_add_u32 v33, s63, v17
    v_add_u32 v34, s63, v18
    ds_read_b64 v[108:109], v33 offset:0
    ds_read_b64 v[110:111], v33 offset:1536
    ds_read_b64 v[112:113], v33 offset:128
    ds_read_b64 v[114:115], v33 offset:1664
    ds_read_b64 v[116:117], v33 offset:256
    ds_read_b64 v[118:119], v33 offset:1792
    ds_read_b64 v[120:121], v34 offset:0
    v_add_f32_dpp v4, v148, v151 row_ror:12 row_mask:0xf bank_mask:0xf
    ds_read_b64 v[122:123], v34 offset:1536
    ds_read_b64 v[124:125], v34 offset:128
    v_add_f32_dpp v4, v149, v4 row_ror:8 row_mask:0xf bank_mask:0xf
    ds_read_b64 v[126:127], v34 offset:1664
    ds_read_b64 v[128:129], v34 offset:256
    ds_read_b64 v[130:131], v34 offset:1792
    v_add_f32_dpp v16, v150, v4 row_ror:4 row_mask:0xf bank_mask:0x8
    v_cvt_pk_bf16_f32 v3, 0, v15
    v_cvt_pk_bf16_f32 v4, 0, v16
    v_mul_f32 v3, s65, v3
    v_mul_f32 v4, s65, v4
    v_cvt_pk_bf16_f32 v5, v3, v4
    v_max3_f32 v14, v14, v3, v4
    ds_write_b32 v11, v5 offset:256
    s_waitcnt lgkmcnt(0)
    v_lshlrev_b32 v60, 16, v108
    v_and_b32 v61, s66, v108
    v_lshlrev_b32 v62, 16, v109
    v_and_b32 v63, s66, v109
    v_lshlrev_b32 v84, 16, v110
    v_and_b32 v85, s66, v110
    v_lshlrev_b32 v86, 16, v111
    v_and_b32 v87, s66, v111
    v_lshlrev_b32 v64, 16, v112
    v_and_b32 v65, s66, v112
    v_lshlrev_b32 v66, 16, v113
    v_and_b32 v67, s66, v113
    v_lshlrev_b32 v88, 16, v114
    v_and_b32 v89, s66, v114
    v_lshlrev_b32 v90, 16, v115
    v_and_b32 v91, s66, v115
    v_lshlrev_b32 v68, 16, v116
    v_and_b32 v69, s66, v116
    v_lshlrev_b32 v70, 16, v117
    v_and_b32 v71, s66, v117
    v_lshlrev_b32 v92, 16, v118
    v_and_b32 v93, s66, v118
    v_lshlrev_b32 v94, 16, v119
    v_and_b32 v95, s66, v119
    v_lshlrev_b32 v72, 16, v120
    v_and_b32 v73, s66, v120
    v_lshlrev_b32 v74, 16, v121
    v_and_b32 v75, s66, v121
    v_lshlrev_b32 v96, 16, v122
    v_and_b32 v97, s66, v122
    v_lshlrev_b32 v98, 16, v123
    v_and_b32 v99, s66, v123
    v_lshlrev_b32 v76, 16, v124
    v_and_b32 v77, s66, v124
    v_lshlrev_b32 v78, 16, v125
    v_and_b32 v79, s66, v125
    v_lshlrev_b32 v100, 16, v126
    v_and_b32 v101, s66, v126
    v_lshlrev_b32 v102, 16, v127
    v_and_b32 v103, s66, v127
    v_lshlrev_b32 v80, 16, v128
    v_and_b32 v81, s66, v128
    v_lshlrev_b32 v82, 16, v129
    v_and_b32 v83, s66, v129
    v_lshlrev_b32 v104, 16, v130
    v_and_b32 v105, s66, v130
    v_lshlrev_b32 v106, 16, v131
    v_and_b32 v107, s66, v131
    v_add_u32 v11, 3072, v11
    s_add_u32 s61, s61, 1
    s_cmp_eq_u32 s61, s3
    s_cbranch_scc1 L_kblk_end
    s_cmp_eq_u32 s61, s73
    s_cbranch_scc1 L_kblk_end
    s_cmp_lt_u32 s61, 16
    s_cbranch_scc1 L_kblk
L_kblk_end:
    s_nop 1
    v_max_f32_dpp v14, v14, v14 row_ror:4 row_mask:0xf bank_mask:0xf
    s_nop 1
    v_max_f32_dpp v14, v14, v14 row_ror:8 row_mask:0xf bank_mask:0xf
    v_mov_b32 v3, v14
    s_nop 1
    v_permlane16_swap_b32 v14, v3
    v_max_f32 v14, v14, v3
    v_mov_b32 v3, v14
    s_nop 1
    v_permlane32_swap_b32 v14, v3
    v_max_f32 v14, v14, v3
    v_cvt_pk_bf16_f32 v14, 0, v14
    v_mul_f32 v14, s64, v14
    ds_write_b32 v154, v14
    v_add_u32 v154, 64, v154
    ds_read_b64 v[164:165], v153 offset:0
    ds_read_b64 v[166:167], v153 offset:128
    ds_read_b64 v[168:169], v153 offset:256
    v_add_u32 v153, 1536, v153
    v_mov_b32 v14, 0xff800000
    s_waitcnt lgkmcnt(0)
    s_cmp_lt_u32 s61, 16
    s_cbranch_scc1 L_kblk
    v_lshrrev_b32 v3, 4, v1
    v_and_b32 v4, 15, v1
    v_and_b32 v5, 2, v3
    v_add_u32 v3, v3, v5
    v_lshl_add_u32 v3, v2, 3, v3
    v_mul_u32_u24 v3, 768, v3
    v_lshl_add_u32 v12, v4, 4, v3
    v_subrev_u32 v11, 49152, v11
    s_mov_b32 s63, 0
    v_add_u32 v215, s63, v7
    v_add_u32 v216, s63, v8
    ds_read_b32 v214, v11 offset:0
    ds_read_u16 v217, v215 offset:512
    ds_read_u16 v218, v216 offset:512
    ds_read_u16 v215, v215
    ds_read_u16 v216, v216
    v_mov_b32 v188, 0
    v_mov_b32 v189, 0
    v_mov_b32 v190, 0
    v_mov_b32 v191, 0
    v_mov_b32 v192, 0
    v_mov_b32 v193, 0
    v_mov_b32 v194, 0
    v_mov_b32 v195, 0
    v_mov_b32 v196, 0
    v_mov_b32 v197, 0
    v_mov_b32 v198, 0
    v_mov_b32 v199, 0
    v_mov_b32 v200, 0
    v_mov_b32 v201, 0
    v_mov_b32 v202, 0
    v_mov_b32 v203, 0
    s_mov_b32 s61, 0
    v_and_b32 v3, 3, v1
    v_lshlrev_b32 v20, 4, v3
    v_add_u32 v154, 154944, v20
    v_add_u32 v18, 142336, v20
    v_lshl_add_u32 v156, v2, 6, v18
    v_lshl_add_u32 v20, v2, 6, v20
    v_add_u32 v20, 3072, v20
    v_mul_u32_u24 v155, 3072, v2
    v_lshl_add_u32 v155, v1, 4, v155
    v_add_u32 v155, 142592, v155
    v_lshlrev_b32 v4, 10, v2
    v_lshl_add_u32 v19, v1, 4, v4
    v_lshl_add_u32 v17, v1, 2, v4
    v_add_u32 v17, 142592, v17
    v_mul_u32_u24 v21, 384, v3
    v_lshrrev_b32 v4, 2, v1
    v_lshl_add_u32 v21, v4, 3, v21
    v_lshl_add_u32 v21, v2, 7, v21
    s_mov_b32 s48, s18
    s_and_b32 s49, s19, 0xffff
    s_mov_b32 s50, 393216
    s_mov_b32 s51, 0x20000
    s_mov_b32 s24, s22
    s_and_b32 s25, s23, 0xffff
    s_mov_b32 s26, 848640
    s_mov_b32 s27, 0x20000
    s_mul_i32 s68, s100, 9984
    s_mul_i32 s71, s2, 3328
    s_add_u32 s69, s68, 3328
    s_add_u32 s70, s68, 6656
    s_sub_u32 s57, 255, s100
    s_mul_i32 s57, s57, 1536
    s_mov_b32 s84, 0x7060500
    s_mov_b32 s85, 0x7060501
    s_mov_b32 s86, 0x7060502
    s_mov_b32 s87, 0x7060503
    s_mov_b32 s88, 0x0c0c0400
    s_mov_b32 s89, 0x04000c0c
    s_mov_b32 s90, 0xffffff00
L_vround:
    v_mov_b32 v164, 0
    v_mov_b32 v165, 0
    v_mov_b32 v166, 0
    v_mov_b32 v167, 0
    v_mov_b32 v168, 0
    v_mov_b32 v169, 0
    v_mov_b32 v170, 0
    v_mov_b32 v171, 0
    v_mov_b32 v172, 0
    v_mov_b32 v173, 0
    v_mov_b32 v174, 0
    v_mov_b32 v175, 0
    v_mov_b32 v212, 0
    v_mov_b32 v213, 0
L_vblk:
    s_add_u32 s61, s61, 1
    s_cmp_eq_u32 s61, s3
    s_cselect_b32 s74, 1, 0
    s_cmp_eq_u32 s61, s73
    s_cselect_b32 s74, 1, s74
    s_cmp_eq_u32 s61, 16
    s_cselect_b32 s74, 1, s74
    v_add_u32 v13, s62, v12
    s_add_u32 s62, s62, 24576
    s_cmp_eq_u32 s62, 73728
    s_cselect_b32 s62, 0, s62
    s_barrier
    ds_read_b128 v[160:163], v154
    ds_read_b128 v[36:39], v13 offset:0
    ds_read_b128 v[48:51], v13 offset:1536
    ds_read_b128 v[40:43], v13 offset:256
    ds_read_b128 v[52:55], v13 offset:1792
    ds_read_b128 v[44:47], v13 offset:512
    ds_read_b128 v[56:59], v13 offset:2048
    s_waitcnt lgkmcnt(6)
    v_max_f32 v14, v160, v161
    v_max3_f32 v14, v14, v162, v163
    s_waitcnt lgkmcnt(6)
    v_lshlrev_b32 v219, 16, v214
    v_and_b32 v220, s66, v214
    v_fma_f32 v219, v219, s64, -v14
    v_fma_f32 v220, v220, s64, -v14
    v_exp_f32 v219, v219
    v_exp_f32 v220, v220
    v_lshlrev_b32 v221, 16, v215
    v_lshlrev_b32 v222, 16, v216
    v_mul_f32 v221, v219, v221
    v_mul_f32 v222, v220, v222
    v_add_f32 v212, v212, v219
    v_cvt_pk_bf16_f32 v221, v221, v222
    v_add_f32 v212, v212, v220
    v_lshlrev_b32 v223, 16, v217
    v_lshlrev_b32 v224, 16, v218
    v_lshlrev_b32 v219, 16, v221
    v_and_b32 v220, s66, v221
    v_fmac_f32 v213, v219, v223
    v_fmac_f32 v213, v220, v224
    v_mov_b32_dpp v188, v221 quad_perm:[0,1,2,3] row_mask:0xf bank_mask:0x1
    v_mov_b32_dpp v189, v221 row_ror:12 row_mask:0xf bank_mask:0x1
    v_mov_b32_dpp v190, v221 row_ror:8 row_mask:0xf bank_mask:0x1
    v_mov_b32_dpp v191, v221 row_ror:4 row_mask:0xf bank_mask:0x1
    v_mov_b32_dpp v192, v221 row_ror:4 row_mask:0xf bank_mask:0x2
    v_mov_b32_dpp v193, v221 quad_perm:[0,1,2,3] row_mask:0xf bank_mask:0x2
    v_mov_b32_dpp v194, v221 row_ror:12 row_mask:0xf bank_mask:0x2
    v_mov_b32_dpp v195, v221 row_ror:8 row_mask:0xf bank_mask:0x2
    v_mov_b32_dpp v196, v221 row_ror:8 row_mask:0xf bank_mask:0x4
    v_mov_b32_dpp v197, v221 row_ror:4 row_mask:0xf bank_mask:0x4
    v_mov_b32_dpp v198, v221 quad_perm:[0,1,2,3] row_mask:0xf bank_mask:0x4
    v_mov_b32_dpp v199, v221 row_ror:12 row_mask:0xf bank_mask:0x4
    v_mov_b32_dpp v200, v221 row_ror:12 row_mask:0xf bank_mask:0x8
    v_mov_b32_dpp v201, v221 row_ror:8 row_mask:0xf bank_mask:0x8
    v_mov_b32_dpp v202, v221 row_ror:4 row_mask:0xf bank_mask:0x8
    v_mov_b32_dpp v203, v221 quad_perm:[0,1,2,3] row_mask:0xf bank_mask:0x8
    s_waitcnt lgkmcnt(4)
    v_cvt_f32_i32 v36, v36
    v_cvt_f32_i32 v37, v37
    v_cvt_f32_i32 v38, v38
    v_cvt_f32_i32 v39, v39
    v_cvt_f32_i32 v48, v48
    v_cvt_f32_i32 v49, v49
    v_cvt_f32_i32 v50, v50
    v_cvt_f32_i32 v51, v51
    v_cvt_pk_bf16_f32 v60, v36, v48
    v_cvt_pk_bf16_f32 v64, v37, v49
    v_cvt_pk_bf16_f32 v68, v38, v50
    v_cvt_pk_bf16_f32 v72, v39, v51
    s_waitcnt lgkmcnt(2)
    v_cvt_f32_i32 v40, v40
    v_cvt_f32_i32 v41, v41
    v_cvt_f32_i32 v42, v42
    v_cvt_f32_i32 v43, v43
    v_cvt_f32_i32 v52, v52
    v_cvt_f32_i32 v53, v53
    v_cvt_f32_i32 v54, v54
    v_cvt_f32_i32 v55, v55
    v_cvt_pk_bf16_f32 v76, v40, v52
    v_cvt_pk_bf16_f32 v80, v41, v53
    v_cvt_pk_bf16_f32 v84, v42, v54
    v_cvt_pk_bf16_f32 v88, v43, v55
    s_waitcnt lgkmcnt(0)
    v_cvt_f32_i32 v44, v44
    v_cvt_f32_i32 v45, v45
    v_cvt_f32_i32 v46, v46
    v_cvt_f32_i32 v47, v47
    v_cvt_f32_i32 v56, v56
    v_cvt_f32_i32 v57, v57
    v_cvt_f32_i32 v58, v58
    v_cvt_f32_i32 v59, v59
    v_cvt_pk_bf16_f32 v92, v44, v56
    v_cvt_pk_bf16_f32 v96, v45, v57
    v_cvt_pk_bf16_f32 v100, v46, v58
    v_cvt_pk_bf16_f32 v104, v47, v59
    v_add_u32 v215, s63, v9
    v_add_u32 v216, s63, v10
    ds_read_b32 v214, v11 offset:256
    ds_read_u16 v217, v215 offset:512
    ds_read_u16 v218, v216 offset:512
    ds_read_u16 v215, v215
    ds_read_u16 v216, v216
    v_add_u32 v13, s62, v12
    s_add_u32 s62, s62, 24576
    s_cmp_eq_u32 s62, 73728
    s_cselect_b32 s62, 0, s62
    s_barrier
    ds_read_b128 v[36:39], v13 offset:0
    ds_read_b128 v[48:51], v13 offset:1536
    ds_read_b128 v[40:43], v13 offset:256
    ds_read_b128 v[52:55], v13 offset:1792
    ds_read_b128 v[44:47], v13 offset:512
    ds_read_b128 v[56:59], v13 offset:2048
    s_waitcnt lgkmcnt(4)
    v_cvt_f32_i32 v36, v36
    v_cvt_f32_i32 v37, v37
    v_cvt_f32_i32 v38, v38
    v_cvt_f32_i32 v39, v39
    v_cvt_f32_i32 v48, v48
    v_cvt_f32_i32 v49, v49
    v_cvt_f32_i32 v50, v50
    v_cvt_f32_i32 v51, v51
    v_cvt_pk_bf16_f32 v61, v36, v48
    v_cvt_pk_bf16_f32 v65, v37, v49
    v_cvt_pk_bf16_f32 v69, v38, v50
    v_cvt_pk_bf16_f32 v73, v39, v51
    s_waitcnt lgkmcnt(2)
    v_cvt_f32_i32 v40, v40
    v_cvt_f32_i32 v41, v41
    v_cvt_f32_i32 v42, v42
    v_cvt_f32_i32 v43, v43
    v_cvt_f32_i32 v52, v52
    v_cvt_f32_i32 v53, v53
    v_cvt_f32_i32 v54, v54
    v_cvt_f32_i32 v55, v55
    v_cvt_pk_bf16_f32 v77, v40, v52
    v_cvt_pk_bf16_f32 v81, v41, v53
    v_cvt_pk_bf16_f32 v85, v42, v54
    v_cvt_pk_bf16_f32 v89, v43, v55
    s_waitcnt lgkmcnt(0)
    v_cvt_f32_i32 v44, v44
    v_cvt_f32_i32 v45, v45
    v_cvt_f32_i32 v46, v46
    v_cvt_f32_i32 v47, v47
    v_cvt_f32_i32 v56, v56
    v_cvt_f32_i32 v57, v57
    v_cvt_f32_i32 v58, v58
    v_cvt_f32_i32 v59, v59
    v_cvt_pk_bf16_f32 v93, v44, v56
    v_cvt_pk_bf16_f32 v97, v45, v57
    v_cvt_pk_bf16_f32 v101, v46, v58
    v_cvt_pk_bf16_f32 v105, v47, v59
    v_add_u32 v13, s62, v12
    s_add_u32 s62, s62, 24576
    s_cmp_eq_u32 s62, 73728
    s_cselect_b32 s62, 0, s62
    s_barrier
    ds_read_b128 v[36:39], v13 offset:0
    ds_read_b128 v[48:51], v13 offset:1536
    ds_read_b128 v[40:43], v13 offset:256
    ds_read_b128 v[52:55], v13 offset:1792
    ds_read_b128 v[44:47], v13 offset:512
    ds_read_b128 v[56:59], v13 offset:2048
    s_waitcnt lgkmcnt(4)
    v_cvt_f32_i32 v36, v36
    v_cvt_f32_i32 v37, v37
    v_cvt_f32_i32 v38, v38
    v_cvt_f32_i32 v39, v39
    v_cvt_f32_i32 v48, v48
    v_cvt_f32_i32 v49, v49
    v_cvt_f32_i32 v50, v50
    v_cvt_f32_i32 v51, v51
    v_cvt_pk_bf16_f32 v62, v36, v48
    v_cvt_pk_bf16_f32 v66, v37, v49
    v_cvt_pk_bf16_f32 v70, v38, v50
    v_cvt_pk_bf16_f32 v74, v39, v51
    s_waitcnt lgkmcnt(2)
    v_cvt_f32_i32 v40, v40
    v_cvt_f32_i32 v41, v41
    v_cvt_f32_i32 v42, v42
    v_cvt_f32_i32 v43, v43
    v_cvt_f32_i32 v52, v52
    v_cvt_f32_i32 v53, v53
    v_cvt_f32_i32 v54, v54
    v_cvt_f32_i32 v55, v55
    v_cvt_pk_bf16_f32 v78, v40, v52
    v_cvt_pk_bf16_f32 v82, v41, v53
    v_cvt_pk_bf16_f32 v86, v42, v54
    v_cvt_pk_bf16_f32 v90, v43, v55
    s_waitcnt lgkmcnt(0)
    v_cvt_f32_i32 v44, v44
    v_cvt_f32_i32 v45, v45
    v_cvt_f32_i32 v46, v46
    v_cvt_f32_i32 v47, v47
    v_cvt_f32_i32 v56, v56
    v_cvt_f32_i32 v57, v57
    v_cvt_f32_i32 v58, v58
    v_cvt_f32_i32 v59, v59
    v_cvt_pk_bf16_f32 v94, v44, v56
    v_cvt_pk_bf16_f32 v98, v45, v57
    v_cvt_pk_bf16_f32 v102, v46, v58
    v_cvt_pk_bf16_f32 v106, v47, v59
    v_add_u32 v13, s62, v12
    s_add_u32 s62, s62, 24576
    s_cmp_eq_u32 s62, 73728
    s_cselect_b32 s62, 0, s62
    s_barrier
    ds_read_b128 v[36:39], v13 offset:0
    ds_read_b128 v[48:51], v13 offset:1536
    ds_read_b128 v[40:43], v13 offset:256
    ds_read_b128 v[52:55], v13 offset:1792
    ds_read_b128 v[44:47], v13 offset:512
    ds_read_b128 v[56:59], v13 offset:2048
    s_waitcnt lgkmcnt(4)
    v_cvt_f32_i32 v36, v36
    v_cvt_f32_i32 v37, v37
    v_cvt_f32_i32 v38, v38
    v_cvt_f32_i32 v39, v39
    v_cvt_f32_i32 v48, v48
    v_cvt_f32_i32 v49, v49
    v_cvt_f32_i32 v50, v50
    v_cvt_f32_i32 v51, v51
    v_cvt_pk_bf16_f32 v63, v36, v48
    v_cvt_pk_bf16_f32 v67, v37, v49
    v_cvt_pk_bf16_f32 v71, v38, v50
    v_cvt_pk_bf16_f32 v75, v39, v51
    s_waitcnt lgkmcnt(2)
    v_cvt_f32_i32 v40, v40
    v_cvt_f32_i32 v41, v41
    v_cvt_f32_i32 v42, v42
    v_mfma_f32_16x16x32_bf16 v[164:167], v[188:191], v[60:63], v[164:167]
    v_cvt_f32_i32 v43, v43
    v_cvt_f32_i32 v52, v52
    v_cvt_f32_i32 v53, v53
    v_mfma_f32_16x16x32_bf16 v[164:167], v[192:195], v[64:67], v[164:167]
    v_cvt_f32_i32 v54, v54
    v_cvt_f32_i32 v55, v55
    v_cvt_pk_bf16_f32 v79, v40, v52
    v_mfma_f32_16x16x32_bf16 v[164:167], v[196:199], v[68:71], v[164:167]
    v_cvt_pk_bf16_f32 v83, v41, v53
    v_cvt_pk_bf16_f32 v87, v42, v54
    v_cvt_pk_bf16_f32 v91, v43, v55
    v_mfma_f32_16x16x32_bf16 v[164:167], v[200:203], v[72:75], v[164:167]
    s_waitcnt lgkmcnt(0)
    v_cvt_f32_i32 v44, v44
    v_cvt_f32_i32 v45, v45
    v_cvt_f32_i32 v46, v46
    v_mfma_f32_16x16x32_bf16 v[168:171], v[188:191], v[76:79], v[168:171]
    v_cvt_f32_i32 v47, v47
    v_cvt_f32_i32 v56, v56
    v_cvt_f32_i32 v57, v57
    v_mfma_f32_16x16x32_bf16 v[168:171], v[192:195], v[80:83], v[168:171]
    v_cvt_f32_i32 v58, v58
    v_cvt_f32_i32 v59, v59
    v_cvt_pk_bf16_f32 v95, v44, v56
    v_mfma_f32_16x16x32_bf16 v[168:171], v[196:199], v[84:87], v[168:171]
    v_cvt_pk_bf16_f32 v99, v45, v57
    v_cvt_pk_bf16_f32 v103, v46, v58
    v_cvt_pk_bf16_f32 v107, v47, v59
    v_mfma_f32_16x16x32_bf16 v[168:171], v[200:203], v[88:91], v[168:171]
    v_mfma_f32_16x16x32_bf16 v[172:175], v[188:191], v[92:95], v[172:175]
    v_mfma_f32_16x16x32_bf16 v[172:175], v[192:195], v[96:99], v[172:175]
    v_mfma_f32_16x16x32_bf16 v[172:175], v[196:199], v[100:103], v[172:175]
    v_mfma_f32_16x16x32_bf16 v[172:175], v[200:203], v[104:107], v[172:175]
    v_add_u32 v13, s62, v12
    s_add_u32 s62, s62, 24576
    s_cmp_eq_u32 s62, 73728
    s_cselect_b32 s62, 0, s62
    s_barrier
    ds_read_b128 v[36:39], v13 offset:0
    ds_read_b128 v[48:51], v13 offset:1536
    ds_read_b128 v[40:43], v13 offset:256
    ds_read_b128 v[52:55], v13 offset:1792
    ds_read_b128 v[44:47], v13 offset:512
    ds_read_b128 v[56:59], v13 offset:2048
    s_waitcnt lgkmcnt(6)
    v_lshlrev_b32 v219, 16, v214
    v_and_b32 v220, s66, v214
    v_fma_f32 v219, v219, s64, -v14
    v_fma_f32 v220, v220, s64, -v14
    v_exp_f32 v219, v219
    v_exp_f32 v220, v220
    v_lshlrev_b32 v221, 16, v215
    v_lshlrev_b32 v222, 16, v216
    v_mul_f32 v221, v219, v221
    v_mul_f32 v222, v220, v222
    v_add_f32 v212, v212, v219
    v_cvt_pk_bf16_f32 v221, v221, v222
    v_add_f32 v212, v212, v220
    v_lshlrev_b32 v223, 16, v217
    v_lshlrev_b32 v224, 16, v218
    v_lshlrev_b32 v219, 16, v221
    v_and_b32 v220, s66, v221
    v_fmac_f32 v213, v219, v223
    v_fmac_f32 v213, v220, v224
    v_mov_b32_dpp v188, v221 quad_perm:[0,1,2,3] row_mask:0xf bank_mask:0x1
    v_mov_b32_dpp v189, v221 row_ror:12 row_mask:0xf bank_mask:0x1
    v_mov_b32_dpp v190, v221 row_ror:8 row_mask:0xf bank_mask:0x1
    v_mov_b32_dpp v191, v221 row_ror:4 row_mask:0xf bank_mask:0x1
    v_mov_b32_dpp v192, v221 row_ror:4 row_mask:0xf bank_mask:0x2
    v_mov_b32_dpp v193, v221 quad_perm:[0,1,2,3] row_mask:0xf bank_mask:0x2
    v_mov_b32_dpp v194, v221 row_ror:12 row_mask:0xf bank_mask:0x2
    v_mov_b32_dpp v195, v221 row_ror:8 row_mask:0xf bank_mask:0x2
    v_mov_b32_dpp v196, v221 row_ror:8 row_mask:0xf bank_mask:0x4
    v_mov_b32_dpp v197, v221 row_ror:4 row_mask:0xf bank_mask:0x4
    v_mov_b32_dpp v198, v221 quad_perm:[0,1,2,3] row_mask:0xf bank_mask:0x4
    v_mov_b32_dpp v199, v221 row_ror:12 row_mask:0xf bank_mask:0x4
    v_mov_b32_dpp v200, v221 row_ror:12 row_mask:0xf bank_mask:0x8
    v_mov_b32_dpp v201, v221 row_ror:8 row_mask:0xf bank_mask:0x8
    v_mov_b32_dpp v202, v221 row_ror:4 row_mask:0xf bank_mask:0x8
    v_mov_b32_dpp v203, v221 quad_perm:[0,1,2,3] row_mask:0xf bank_mask:0x8
    s_waitcnt lgkmcnt(4)
    v_cvt_f32_i32 v36, v36
    v_cvt_f32_i32 v37, v37
    v_cvt_f32_i32 v38, v38
    v_cvt_f32_i32 v39, v39
    v_cvt_f32_i32 v48, v48
    v_cvt_f32_i32 v49, v49
    v_cvt_f32_i32 v50, v50
    v_cvt_f32_i32 v51, v51
    v_cvt_pk_bf16_f32 v60, v36, v48
    v_cvt_pk_bf16_f32 v64, v37, v49
    v_cvt_pk_bf16_f32 v68, v38, v50
    v_cvt_pk_bf16_f32 v72, v39, v51
    s_waitcnt lgkmcnt(2)
    v_cvt_f32_i32 v40, v40
    v_cvt_f32_i32 v41, v41
    v_cvt_f32_i32 v42, v42
    v_cvt_f32_i32 v43, v43
    v_cvt_f32_i32 v52, v52
    v_cvt_f32_i32 v53, v53
    v_cvt_f32_i32 v54, v54
    v_cvt_f32_i32 v55, v55
    v_cvt_pk_bf16_f32 v76, v40, v52
    v_cvt_pk_bf16_f32 v80, v41, v53
    v_cvt_pk_bf16_f32 v84, v42, v54
    v_cvt_pk_bf16_f32 v88, v43, v55
    s_waitcnt lgkmcnt(0)
    v_cvt_f32_i32 v44, v44
    v_cvt_f32_i32 v45, v45
    v_cvt_f32_i32 v46, v46
    v_cvt_f32_i32 v47, v47
    v_cvt_f32_i32 v56, v56
    v_cvt_f32_i32 v57, v57
    v_cvt_f32_i32 v58, v58
    v_cvt_f32_i32 v59, v59
    v_cvt_pk_bf16_f32 v92, v44, v56
    v_cvt_pk_bf16_f32 v96, v45, v57
    v_cvt_pk_bf16_f32 v100, v46, v58
    v_cvt_pk_bf16_f32 v104, v47, v59
    v_add_u32 v11, 3072, v11
    s_add_u32 s63, s63, 1024
    v_add_u32 v215, s63, v7
    v_add_u32 v216, s63, v8
    ds_read_b32 v214, v11 offset:0
    ds_read_u16 v217, v215 offset:512
    ds_read_u16 v218, v216 offset:512
    ds_read_u16 v215, v215
    ds_read_u16 v216, v216
    v_add_u32 v13, s62, v12
    s_add_u32 s62, s62, 24576
    s_cmp_eq_u32 s62, 73728
    s_cselect_b32 s62, 0, s62
    s_barrier
    ds_read_b128 v[36:39], v13 offset:0
    ds_read_b128 v[48:51], v13 offset:1536
    ds_read_b128 v[40:43], v13 offset:256
    ds_read_b128 v[52:55], v13 offset:1792
    ds_read_b128 v[44:47], v13 offset:512
    ds_read_b128 v[56:59], v13 offset:2048
    s_waitcnt lgkmcnt(4)
    v_cvt_f32_i32 v36, v36
    v_cvt_f32_i32 v37, v37
    v_cvt_f32_i32 v38, v38
    v_cvt_f32_i32 v39, v39
    v_cvt_f32_i32 v48, v48
    v_cvt_f32_i32 v49, v49
    v_cvt_f32_i32 v50, v50
    v_cvt_f32_i32 v51, v51
    v_cvt_pk_bf16_f32 v61, v36, v48
    v_cvt_pk_bf16_f32 v65, v37, v49
    v_cvt_pk_bf16_f32 v69, v38, v50
    v_cvt_pk_bf16_f32 v73, v39, v51
    s_waitcnt lgkmcnt(2)
    v_cvt_f32_i32 v40, v40
    v_cvt_f32_i32 v41, v41
    v_cvt_f32_i32 v42, v42
    v_cvt_f32_i32 v43, v43
    v_cvt_f32_i32 v52, v52
    v_cvt_f32_i32 v53, v53
    v_cvt_f32_i32 v54, v54
    v_cvt_f32_i32 v55, v55
    v_cvt_pk_bf16_f32 v77, v40, v52
    v_cvt_pk_bf16_f32 v81, v41, v53
    v_cvt_pk_bf16_f32 v85, v42, v54
    v_cvt_pk_bf16_f32 v89, v43, v55
    s_waitcnt lgkmcnt(0)
    v_cvt_f32_i32 v44, v44
    v_cvt_f32_i32 v45, v45
    v_cvt_f32_i32 v46, v46
    v_cvt_f32_i32 v47, v47
    v_cvt_f32_i32 v56, v56
    v_cvt_f32_i32 v57, v57
    v_cvt_f32_i32 v58, v58
    v_cvt_f32_i32 v59, v59
    v_cvt_pk_bf16_f32 v93, v44, v56
    v_cvt_pk_bf16_f32 v97, v45, v57
    v_cvt_pk_bf16_f32 v101, v46, v58
    v_cvt_pk_bf16_f32 v105, v47, v59
    s_cmp_eq_u32 s74, 0
    s_cbranch_scc1 L_vnostat
    v_mov_b32 v22, 154884
    ds_read_b32 v22, v22
    s_nop 1
    v_add_f32_dpp v212, v212, v212 row_ror:4 row_mask:0xf bank_mask:0xf
    s_nop 1
    v_add_f32_dpp v212, v212, v212 row_ror:8 row_mask:0xf bank_mask:0xf
    v_mov_b32 v3, v212
    s_nop 1
    v_permlane16_swap_b32 v212, v3
    v_add_f32 v212, v212, v3
    v_mov_b32 v3, v212
    s_nop 1
    v_permlane32_swap_b32 v212, v3
    v_add_f32 v212, v212, v3
    s_nop 1
    v_add_f32_dpp v213, v213, v213 row_ror:4 row_mask:0xf bank_mask:0xf
    s_nop 1
    v_add_f32_dpp v213, v213, v213 row_ror:8 row_mask:0xf bank_mask:0xf
    v_mov_b32 v3, v213
    s_nop 1
    v_permlane16_swap_b32 v213, v3
    v_add_f32 v213, v213, v3
    v_mov_b32 v3, v213
    s_nop 1
    v_permlane32_swap_b32 v213, v3
    v_add_f32 v213, v213, v3
    v_mov_b32 v160, v14
    v_mov_b32 v161, v212
    v_mov_b32 v162, v213
    ds_write_b128 v156, v[160:163]
    v_add_u32 v154, 64, v154
L_vnostat:
    v_add_u32 v13, s62, v12
    s_add_u32 s62, s62, 24576
    s_cmp_eq_u32 s62, 73728
    s_cselect_b32 s62, 0, s62
    s_barrier
    ds_read_b128 v[36:39], v13 offset:0
    ds_read_b128 v[48:51], v13 offset:1536
    ds_read_b128 v[40:43], v13 offset:256
    ds_read_b128 v[52:55], v13 offset:1792
    ds_read_b128 v[44:47], v13 offset:512
    ds_read_b128 v[56:59], v13 offset:2048
    s_waitcnt lgkmcnt(4)
    v_cvt_f32_i32 v36, v36
    v_cvt_f32_i32 v37, v37
    v_cvt_f32_i32 v38, v38
    v_cvt_f32_i32 v39, v39
    v_cvt_f32_i32 v48, v48
    v_cvt_f32_i32 v49, v49
    v_cvt_f32_i32 v50, v50
    v_cvt_f32_i32 v51, v51
    v_cvt_pk_bf16_f32 v62, v36, v48
    v_cvt_pk_bf16_f32 v66, v37, v49
    v_cvt_pk_bf16_f32 v70, v38, v50
    v_cvt_pk_bf16_f32 v74, v39, v51
    s_waitcnt lgkmcnt(2)
    v_cvt_f32_i32 v40, v40
    v_cvt_f32_i32 v41, v41
    v_cvt_f32_i32 v42, v42
    v_cvt_f32_i32 v43, v43
    v_cvt_f32_i32 v52, v52
    v_cvt_f32_i32 v53, v53
    v_cvt_f32_i32 v54, v54
    v_cvt_f32_i32 v55, v55
    v_cvt_pk_bf16_f32 v78, v40, v52
    v_cvt_pk_bf16_f32 v82, v41, v53
    v_cvt_pk_bf16_f32 v86, v42, v54
    v_cvt_pk_bf16_f32 v90, v43, v55
    s_waitcnt lgkmcnt(0)
    v_cvt_f32_i32 v44, v44
    v_cvt_f32_i32 v45, v45
    v_cvt_f32_i32 v46, v46
    v_cvt_f32_i32 v47, v47
    v_cvt_f32_i32 v56, v56
    v_cvt_f32_i32 v57, v57
    v_cvt_f32_i32 v58, v58
    v_cvt_f32_i32 v59, v59
    v_cvt_pk_bf16_f32 v94, v44, v56
    v_cvt_pk_bf16_f32 v98, v45, v57
    v_cvt_pk_bf16_f32 v102, v46, v58
    v_cvt_pk_bf16_f32 v106, v47, v59
    v_add_u32 v13, s62, v12
    s_add_u32 s62, s62, 24576
    s_cmp_eq_u32 s62, 73728
    s_cselect_b32 s62, 0, s62
    s_barrier
    ds_read_b128 v[36:39], v13 offset:0
    ds_read_b128 v[48:51], v13 offset:1536
    ds_read_b128 v[40:43], v13 offset:256
    ds_read_b128 v[52:55], v13 offset:1792
    ds_read_b128 v[44:47], v13 offset:512
    ds_read_b128 v[56:59], v13 offset:2048
    s_waitcnt lgkmcnt(4)
    v_cvt_f32_i32 v36, v36
    v_cvt_f32_i32 v37, v37
    v_cvt_f32_i32 v38, v38
    v_cvt_f32_i32 v39, v39
    v_cvt_f32_i32 v48, v48
    v_cvt_f32_i32 v49, v49
    v_cvt_f32_i32 v50, v50
    v_cvt_f32_i32 v51, v51
    v_cvt_pk_bf16_f32 v63, v36, v48
    v_cvt_pk_bf16_f32 v67, v37, v49
    v_cvt_pk_bf16_f32 v71, v38, v50
    v_cvt_pk_bf16_f32 v75, v39, v51
    s_waitcnt lgkmcnt(2)
    v_cvt_f32_i32 v40, v40
    v_cvt_f32_i32 v41, v41
    v_cvt_f32_i32 v42, v42
    v_mfma_f32_16x16x32_bf16 v[164:167], v[188:191], v[60:63], v[164:167]
    v_cvt_f32_i32 v43, v43
    v_cvt_f32_i32 v52, v52
    v_cvt_f32_i32 v53, v53
    v_mfma_f32_16x16x32_bf16 v[164:167], v[192:195], v[64:67], v[164:167]
    v_cvt_f32_i32 v54, v54
    v_cvt_f32_i32 v55, v55
    v_cvt_pk_bf16_f32 v79, v40, v52
    v_mfma_f32_16x16x32_bf16 v[164:167], v[196:199], v[68:71], v[164:167]
    v_cvt_pk_bf16_f32 v83, v41, v53
    v_cvt_pk_bf16_f32 v87, v42, v54
    v_cvt_pk_bf16_f32 v91, v43, v55
    v_mfma_f32_16x16x32_bf16 v[164:167], v[200:203], v[72:75], v[164:167]
    s_waitcnt lgkmcnt(0)
    v_cvt_f32_i32 v44, v44
    v_cvt_f32_i32 v45, v45
    v_cvt_f32_i32 v46, v46
    v_mfma_f32_16x16x32_bf16 v[168:171], v[188:191], v[76:79], v[168:171]
    v_cvt_f32_i32 v47, v47
    v_cvt_f32_i32 v56, v56
    v_cvt_f32_i32 v57, v57
    v_mfma_f32_16x16x32_bf16 v[168:171], v[192:195], v[80:83], v[168:171]
    v_cvt_f32_i32 v58, v58
    v_cvt_f32_i32 v59, v59
    v_cvt_pk_bf16_f32 v95, v44, v56
    v_mfma_f32_16x16x32_bf16 v[168:171], v[196:199], v[84:87], v[168:171]
    v_cvt_pk_bf16_f32 v99, v45, v57
    v_cvt_pk_bf16_f32 v103, v46, v58
    v_cvt_pk_bf16_f32 v107, v47, v59
    v_mfma_f32_16x16x32_bf16 v[168:171], v[200:203], v[88:91], v[168:171]
    v_mfma_f32_16x16x32_bf16 v[172:175], v[188:191], v[92:95], v[172:175]
    v_mfma_f32_16x16x32_bf16 v[172:175], v[192:195], v[96:99], v[172:175]
    v_mfma_f32_16x16x32_bf16 v[172:175], v[196:199], v[100:103], v[172:175]
    v_mfma_f32_16x16x32_bf16 v[172:175], v[200:203], v[104:107], v[172:175]
    s_cmp_eq_u32 s74, 0
    s_cbranch_scc1 L_vblk
    ds_write_b128 v155, v[164:167]
    s_nop 0
    ds_write_b128 v155, v[168:171] offset:1024
    s_cmp_lt_u32 s61, 16
    s_nop 1
    ds_write_b128 v155, v[172:175] offset:2048
    s_waitcnt lgkmcnt(0)
    s_cbranch_scc1 L_vround
    s_barrier
    s_cmp_eq_u32 s56, 3
    s_cbranch_scc1 L_fin
    ds_read_b128 v[36:39], v18 offset:0
    ds_read_b128 v[40:43], v18 offset:64
    ds_read_b128 v[44:47], v18 offset:128
    ds_read_b128 v[48:51], v18 offset:192
    ds_read2st64_b32 v[60:61], v17 offset0:0 offset1:1
    ds_read2st64_b32 v[62:63], v17 offset0:2 offset1:3
    ds_read2st64_b32 v[64:65], v17 offset0:12 offset1:13
    ds_read2st64_b32 v[66:67], v17 offset0:14 offset1:15
    ds_read2st64_b32 v[68:69], v17 offset0:24 offset1:25
    ds_read2st64_b32 v[70:71], v17 offset0:26 offset1:27
    ds_read2st64_b32 v[72:73], v17 offset0:36 offset1:37
    ds_read2st64_b32 v[74:75], v17 offset0:38 offset1:39
    s_cmp_eq_u32 s101, 0
    s_cbranch_scc0 L_rp10
    buffer_load_dwordx4 v[176:179], v20, s[24:27], s69 offen sc1
    buffer_load_dwordx4 v[184:187], v20, s[24:27], s70 offen sc1
    buffer_load_dwordx4 v[172:175], v19, s[24:27], s69 offen sc1
    buffer_load_dwordx4 v[180:183], v19, s[24:27], s70 offen sc1
    s_branch L_rp12
L_rp10:
    s_cmp_eq_u32 s101, 1
    s_cbranch_scc0 L_rp11
    buffer_load_dwordx4 v[168:171], v20, s[24:27], s68 offen sc1
    buffer_load_dwordx4 v[184:187], v20, s[24:27], s70 offen sc1
    buffer_load_dwordx4 v[164:167], v19, s[24:27], s68 offen sc1
    buffer_load_dwordx4 v[180:183], v19, s[24:27], s70 offen sc1
    s_branch L_rp12
L_rp11:
    buffer_load_dwordx4 v[168:171], v20, s[24:27], s68 offen sc1
    buffer_load_dwordx4 v[176:179], v20, s[24:27], s69 offen sc1
    buffer_load_dwordx4 v[164:167], v19, s[24:27], s68 offen sc1
    buffer_load_dwordx4 v[172:175], v19, s[24:27], s69 offen sc1
L_rp12:
    s_waitcnt lgkmcnt(8)
    v_add_f32 v37, v37, v41
    v_add_f32 v45, v45, v49
    v_add_f32 v38, v38, v42
    v_add_f32 v46, v46, v50
    v_add_f32 v37, v37, v45
    v_add_f32 v38, v38, v46
    v_mov_b32 v39, v22
    s_waitcnt lgkmcnt(4)
    v_add_f32 v60, v60, v64
    v_add_f32 v61, v61, v65
    v_add_f32 v62, v62, v66
    v_add_f32 v63, v63, v67
    s_waitcnt lgkmcnt(0)
    v_add_f32 v68, v68, v72
    v_add_f32 v69, v69, v73
    v_add_f32 v70, v70, v74
    v_add_f32 v71, v71, v75
    v_add_f32 v60, v60, v68
    v_add_f32 v61, v61, v69
    v_add_f32 v62, v62, v70
    v_add_f32 v63, v63, v71
    v_sub_f32 v60, v60, v38
    v_sub_f32 v61, v61, v38
    v_sub_f32 v62, v62, v38
    v_sub_f32 v63, v63, v38
    s_cmp_eq_u32 s2, 255
    s_cbranch_scc1 L_rsolo
    v_perm_b32 v60, v60, v22, s84
    v_perm_b32 v61, v61, v22, s85
    v_perm_b32 v62, v62, v22, s86
    v_perm_b32 v63, v63, v22, s87
    buffer_store_dwordx4 v[60:63], v19, s[24:27], s71 offen sc1
    s_mov_b64 exec, 15
    buffer_store_dwordx4 v[36:39], v20, s[24:27], s71 offen sc1
    s_mov_b64 exec, -1
    s_cmp_eq_u32 s101, 0
    s_cbranch_scc0 L_rp20
    v_mov_b32 v164, v60
    v_mov_b32 v168, v36
    v_mov_b32 v165, v61
    v_mov_b32 v169, v37
    v_mov_b32 v166, v62
    v_mov_b32 v170, v38
    v_mov_b32 v167, v63
    v_mov_b32 v171, v39
    s_branch L_rp22
L_rp20:
    s_cmp_eq_u32 s101, 1
    s_cbranch_scc0 L_rp21
    v_mov_b32 v172, v60
    v_mov_b32 v176, v36
    v_mov_b32 v173, v61
    v_mov_b32 v177, v37
    v_mov_b32 v174, v62
    v_mov_b32 v178, v38
    v_mov_b32 v175, v63
    v_mov_b32 v179, v39
    s_branch L_rp22
L_rp21:
    v_mov_b32 v180, v60
    v_mov_b32 v184, v36
    v_mov_b32 v181, v61
    v_mov_b32 v185, v37
    v_mov_b32 v182, v62
    v_mov_b32 v186, v38
    v_mov_b32 v183, v63
    v_mov_b32 v187, v39
L_rp22:
    s_waitcnt vmcnt(4)
    v_xor_b32 v40, v171, v22
    v_xor_b32 v41, v179, v22
    v_xor_b32 v42, v187, v22
    v_or3_b32 v4, v40, v41, v42
    s_waitcnt vmcnt(2)
    v_perm_b32 v5, v165, v164, s88
    v_perm_b32 v6, v167, v166, s89
    v_bitop3_b32 v5, v5, v6, v22 bitop3:0x56
    v_or_b32 v4, v4, v5
    v_perm_b32 v5, v173, v172, s88
    v_perm_b32 v6, v175, v174, s89
    v_bitop3_b32 v5, v5, v6, v22 bitop3:0x56
    v_or_b32 v4, v4, v5
    v_perm_b32 v5, v181, v180, s88
    v_perm_b32 v6, v183, v182, s89
    v_bitop3_b32 v5, v5, v6, v22 bitop3:0x56
    v_or_b32 v4, v4, v5
    v_cmp_eq_u32 vcc, 0, v4
    s_nop 4
    s_cmp_eq_u64 vcc, -1
    s_cbranch_scc1 L_rmerge
    s_waitcnt vmcnt(0)
    s_cmp_eq_u32 s101, 0
    s_cbranch_scc0 L_rp30
    buffer_load_dwordx4 v[176:179], v20, s[24:27], s69 offen sc1
    buffer_load_dwordx4 v[184:187], v20, s[24:27], s70 offen sc1
    buffer_load_dwordx4 v[172:175], v19, s[24:27], s69 offen sc1
    buffer_load_dwordx4 v[180:183], v19, s[24:27], s70 offen sc1
    s_branch L_rp32
L_rp30:
    s_cmp_eq_u32 s101, 1
    s_cbranch_scc0 L_rp31
    buffer_load_dwordx4 v[168:171], v20, s[24:27], s68 offen sc1
    buffer_load_dwordx4 v[184:187], v20, s[24:27], s70 offen sc1
    buffer_load_dwordx4 v[164:167], v19, s[24:27], s68 offen sc1
    buffer_load_dwordx4 v[180:183], v19, s[24:27], s70 offen sc1
    s_branch L_rp32
L_rp31:
    buffer_load_dwordx4 v[168:171], v20, s[24:27], s68 offen sc1
    buffer_load_dwordx4 v[176:179], v20, s[24:27], s69 offen sc1
    buffer_load_dwordx4 v[164:167], v19, s[24:27], s68 offen sc1
    buffer_load_dwordx4 v[172:175], v19, s[24:27], s69 offen sc1
L_rp32:
    s_waitcnt vmcnt(2)
    v_xor_b32 v40, v171, v22
    v_xor_b32 v41, v179, v22
    v_xor_b32 v42, v187, v22
    v_or3_b32 v4, v40, v41, v42
    s_waitcnt vmcnt(0)
    v_perm_b32 v5, v165, v164, s88
    v_perm_b32 v6, v167, v166, s89
    v_bitop3_b32 v5, v5, v6, v22 bitop3:0x56
    v_or_b32 v4, v4, v5
    v_perm_b32 v5, v173, v172, s88
    v_perm_b32 v6, v175, v174, s89
    v_bitop3_b32 v5, v5, v6, v22 bitop3:0x56
    v_or_b32 v4, v4, v5
    v_perm_b32 v5, v181, v180, s88
    v_perm_b32 v6, v183, v182, s89
    v_bitop3_b32 v5, v5, v6, v22 bitop3:0x56
    v_or_b32 v4, v4, v5
    v_cmp_eq_u32 vcc, 0, v4
L_rmerge:
    v_max3_f32 v3, v168, v176, v184
    v_sub_f32 v168, v168, v3
    v_sub_f32 v176, v176, v3
    v_sub_f32 v184, v184, v3
    v_exp_f32 v168, v168
    v_exp_f32 v176, v176
    v_exp_f32 v184, v184
    s_and_b64 exec, exec, vcc
    s_cbranch_execz L_fin
    v_and_b32 v164, s90, v164
    v_and_b32 v165, s90, v165
    v_and_b32 v166, s90, v166
    v_and_b32 v167, s90, v167
    v_and_b32 v172, s90, v172
    v_and_b32 v173, s90, v173
    v_and_b32 v174, s90, v174
    v_and_b32 v175, s90, v175
    v_and_b32 v180, s90, v180
    v_and_b32 v181, s90, v181
    v_and_b32 v182, s90, v182
    v_and_b32 v183, s90, v183
    v_mul_f32 v37, v168, v169
    v_fmac_f32 v37, v176, v177
    v_fmac_f32 v37, v184, v185
    v_mul_f32 v60, v164, v168
    v_fmac_f32 v60, v172, v176
    v_fmac_f32 v60, v180, v184
    v_mul_f32 v61, v165, v168
    v_fmac_f32 v61, v173, v176
    v_fmac_f32 v61, v181, v184
    v_mul_f32 v62, v166, v168
    v_fmac_f32 v62, v174, v176
    v_fmac_f32 v62, v182, v184
    v_mul_f32 v63, v167, v168
    v_fmac_f32 v63, v175, v176
    v_fmac_f32 v63, v183, v184
L_rsolo:
    v_rcp_f32 v37, v37
    s_nop 0
    v_mul_f32 v60, v60, v37
    v_mul_f32 v61, v61, v37
    v_mul_f32 v62, v62, v37
    v_mul_f32 v63, v63, v37
    v_cvt_pk_bf16_f32 v64, v60, v61
    v_cvt_pk_bf16_f32 v65, v62, v63
    buffer_store_dwordx2 v[64:65], v21, s[48:51], s57 offen
    s_branch L_fin
L_finisher:
    v_and_b32 v14, 3, v1
    v_mul_u32_u24 v8, 384, v14
    v_lshrrev_b32 v13, 2, v1
    v_lshl_add_u32 v8, v13, 3, v8
    v_lshlrev_b32 v9, 4, v1
    v_lshlrev_b32 v14, 4, v14
    s_memrealtime s[96:97]
    s_waitcnt lgkmcnt(0)
    s_mov_b32 s48, s18
    s_and_b32 s49, s19, 0xffff
    s_mov_b32 s50, 393216
    s_mov_b32 s51, 0x20000
    s_mov_b32 s52, s20
    s_and_b32 s53, s21, 0xffff
    s_mov_b32 s54, 256
    s_mov_b32 s55, 0x20000
    s_mov_b32 s24, s22
    s_and_b32 s25, s23, 0xffff
    s_mov_b32 s26, 2528256
    s_mov_b32 s27, 0x20000
L_fk:
    s_waitcnt vmcnt(63)
    s_movk_i32 s69, 4
L_fb1:
    s_barrier
    s_sub_u32 s69, s69, 1
    s_cmp_lg_u32 s69, 0
    s_cbranch_scc1 L_fb1
    s_waitcnt vmcnt(0)
    s_cmp_eq_u32 s2, 0
    s_cbranch_scc0 L_fk2
    s_or_b32 s71, s96, 1
    v_mov_b32 v16, s71
    v_mov_b32 v17, 0
    s_mov_b64 exec, 1
    buffer_atomic_cmpswap v[16:17], v9, s[52:55], 0 offen sc1
    s_mov_b64 exec, -1
L_fk2:
    s_movk_i32 s69, 124
L_fb2:
    s_barrier
    s_sub_u32 s69, s69, 1
    s_cmp_lg_u32 s69, 0
    s_cbranch_scc1 L_fb2
    s_load_dword s71, s[20:21], 0
    s_barrier
    s_waitcnt lgkmcnt(0)
    s_cmp_eq_u32 s71, 0
    s_cbranch_scc0 L_ftag
    s_or_b32 s71, s96, 1
    v_mov_b32 v16, s71
    v_mov_b32 v17, 0
    s_mov_b64 exec, 1
    buffer_atomic_cmpswap v[16:17], v9, s[52:55], 0 offen sc0 sc1
    s_mov_b64 exec, -1
    s_waitcnt vmcnt(0)
    v_readfirstlane_b32 s58, v16
    s_nop 3
    s_cmp_eq_u32 s58, 0
    s_cselect_b32 s71, s71, s58
L_ftag:
    v_mov_b32 v10, s71
    v_mov_b32 v13, 154884
    ds_write_b32 v13, v10
    s_lshr_b32 s63, s101, 1
    s_lshl_b32 s58, s100, 1
    s_add_u32 s63, s63, s58
    s_mul_i32 s62, s63, 8704
    s_add_u32 s62, s62, 1048576
    s_waitcnt lgkmcnt(0)
    s_cmp_eq_u32 s2, 255
    s_cbranch_scc1 L_fin
    s_cmp_eq_u32 s101, 1
    s_cbranch_scc1 L_fmid
    s_movk_i32 s69, 89
L_fb3:
    s_barrier
    s_sub_u32 s69, s69, 1
    s_cmp_lg_u32 s69, 0
    s_cbranch_scc1 L_fb3
    v_add_u32 v13, 142336, v14
    v_lshlrev_b32 v11, 2, v1
    v_add_u32 v11, 142592, v11
    ds_read_b128 v[16:19], v13 offset:0
    ds_read_b128 v[20:23], v13 offset:64
    ds_read_b128 v[24:27], v13 offset:128
    ds_read_b128 v[28:31], v13 offset:192
    ds_read2st64_b32 v[32:33], v11 offset0:0 offset1:1
    ds_read2st64_b32 v[34:35], v11 offset0:2 offset1:3
    ds_read2st64_b32 v[36:37], v11 offset0:4 offset1:5
    ds_read2st64_b32 v[38:39], v11 offset0:6 offset1:7
    ds_read2st64_b32 v[40:41], v11 offset0:8 offset1:9
    ds_read2st64_b32 v[42:43], v11 offset0:10 offset1:11
    ds_read2st64_b32 v[44:45], v11 offset0:12 offset1:13
    ds_read2st64_b32 v[46:47], v11 offset0:14 offset1:15
    s_waitcnt lgkmcnt(4)
    ds_read2st64_b32 v[48:49], v11 offset0:16 offset1:17
    ds_read2st64_b32 v[50:51], v11 offset0:18 offset1:19
    ds_read2st64_b32 v[52:53], v11 offset0:20 offset1:21
    ds_read2st64_b32 v[54:55], v11 offset0:22 offset1:23
    ds_read2st64_b32 v[56:57], v11 offset0:24 offset1:25
    ds_read2st64_b32 v[58:59], v11 offset0:26 offset1:27
    ds_read2st64_b32 v[60:61], v11 offset0:28 offset1:29
    ds_read2st64_b32 v[62:63], v11 offset0:30 offset1:31
    s_waitcnt lgkmcnt(4)
    ds_read2st64_b32 v[64:65], v11 offset0:32 offset1:33
    ds_read2st64_b32 v[66:67], v11 offset0:34 offset1:35
    ds_read2st64_b32 v[68:69], v11 offset0:36 offset1:37
    ds_read2st64_b32 v[70:71], v11 offset0:38 offset1:39
    ds_read2st64_b32 v[72:73], v11 offset0:40 offset1:41
    ds_read2st64_b32 v[74:75], v11 offset0:42 offset1:43
    ds_read2st64_b32 v[76:77], v11 offset0:44 offset1:45
    ds_read2st64_b32 v[78:79], v11 offset0:46 offset1:47
    v_mov_b32 v83, v10
    v_mov_b32 v87, v10
    v_mov_b32 v91, v10
    v_mov_b32 v95, v10
    v_mov_b32 v99, v10
    v_mov_b32 v96, v16
    v_add_f32 v17, v17, v21
    v_add_f32 v25, v25, v29
    v_add_f32 v97, v17, v25
    v_add_f32 v18, v18, v22
    v_add_f32 v26, v26, v30
    v_add_f32 v98, v18, v26
    s_waitcnt lgkmcnt(0)
    v_add_f32 v32, v32, v44
    v_add_f32 v56, v56, v68
    v_add_f32 v32, v32, v56
    v_sub_f32 v80, v32, v98
    v_add_f32 v33, v33, v45
    v_add_f32 v57, v57, v69
    v_add_f32 v33, v33, v57
    v_sub_f32 v81, v33, v98
    v_add_f32 v34, v34, v46
    v_add_f32 v58, v58, v70
    v_add_f32 v34, v34, v58
    v_sub_f32 v82, v34, v98
    v_add_f32 v35, v35, v47
    v_add_f32 v59, v59, v71
    v_add_f32 v35, v35, v59
    v_sub_f32 v84, v35, v98
    v_add_f32 v36, v36, v48
    v_add_f32 v60, v60, v72
    v_add_f32 v36, v36, v60
    v_sub_f32 v85, v36, v98
    v_add_f32 v37, v37, v49
    v_add_f32 v61, v61, v73
    v_add_f32 v37, v37, v61
    v_sub_f32 v86, v37, v98
    v_add_f32 v38, v38, v50
    v_add_f32 v62, v62, v74
    v_add_f32 v38, v38, v62
    v_sub_f32 v88, v38, v98
    v_add_f32 v39, v39, v51
    v_add_f32 v63, v63, v75
    v_add_f32 v39, v39, v63
    v_sub_f32 v89, v39, v98
    v_add_f32 v40, v40, v52
    v_add_f32 v64, v64, v76
    v_add_f32 v40, v40, v64
    v_sub_f32 v90, v40, v98
    v_add_f32 v41, v41, v53
    v_add_f32 v65, v65, v77
    v_add_f32 v41, v41, v65
    v_sub_f32 v92, v41, v98
    v_add_f32 v42, v42, v54
    v_add_f32 v66, v66, v78
    v_add_f32 v42, v42, v66
    v_sub_f32 v93, v42, v98
    v_add_f32 v43, v43, v55
    v_add_f32 v67, v67, v79
    v_add_f32 v43, v43, v67
    v_sub_f32 v94, v43, v98
    s_movk_i32 s69, 39
L_fb4:
    s_barrier
    s_sub_u32 s69, s69, 1
    s_cmp_lg_u32 s69, 0
    s_cbranch_scc1 L_fb4
    s_add_u32 s58, s62, 4352
    s_add_u32 s59, s62, 8448
    buffer_load_dwordx4 v[116:119], v14, s[24:27], s59 offen sc1 nt
    buffer_load_dwordx4 v[100:103], v9, s[24:27], s58 offen offset:0 sc1 nt
    buffer_load_dwordx4 v[104:107], v9, s[24:27], s58 offen offset:1024 sc1 nt
    buffer_load_dwordx4 v[108:111], v9, s[24:27], s58 offen offset:2048 sc1 nt
    buffer_load_dwordx4 v[112:115], v9, s[24:27], s58 offen offset:3072 sc1 nt
    s_barrier
    s_waitcnt vmcnt(0)
    v_xor_b32 v13, v10, v103
    v_xor_b32 v11, v10, v107
    v_or_b32 v13, v13, v11
    v_xor_b32 v11, v10, v111
    v_or_b32 v13, v13, v11
    v_xor_b32 v11, v10, v115
    v_or_b32 v13, v13, v11
    v_xor_b32 v11, v10, v119
    v_or_b32 v13, v13, v11
    v_cmp_ne_u32 vcc, 0, v13
    s_nop 4
    s_cmp_eq_u64 vcc, 0
    s_cbranch_scc1 L_fo7
    s_add_u32 s58, s62, 0
    s_add_u32 s59, s62, 4096
    buffer_store_dwordx4 v[80:83], v9, s[24:27], s58 offen offset:0 sc1 nt
    buffer_store_dwordx4 v[84:87], v9, s[24:27], s58 offen offset:1024 sc1 nt
    buffer_store_dwordx4 v[88:91], v9, s[24:27], s58 offen offset:2048 sc1 nt
    buffer_store_dwordx4 v[92:95], v9, s[24:27], s58 offen offset:3072 sc1 nt
    s_mov_b64 exec, 15
    buffer_store_dwordx4 v[96:99], v14, s[24:27], s59 offen sc1 nt
    s_mov_b64 exec, -1
    s_waitcnt vmcnt(0)
    s_add_u32 s58, s62, 4352
    s_add_u32 s59, s62, 8448
    buffer_load_dwordx4 v[116:119], v14, s[24:27], s59 offen sc1 nt
    buffer_load_dwordx4 v[100:103], v9, s[24:27], s58 offen offset:0 sc1 nt
    buffer_load_dwordx4 v[104:107], v9, s[24:27], s58 offen offset:1024 sc1 nt
    buffer_load_dwordx4 v[108:111], v9, s[24:27], s58 offen offset:2048 sc1 nt
    buffer_load_dwordx4 v[112:115], v9, s[24:27], s58 offen offset:3072 sc1 nt
    s_waitcnt vmcnt(0)
    v_xor_b32 v13, v10, v103
    v_xor_b32 v11, v10, v107
    v_or_b32 v13, v13, v11
    v_xor_b32 v11, v10, v111
    v_or_b32 v13, v13, v11
    v_xor_b32 v11, v10, v115
    v_or_b32 v13, v13, v11
    v_xor_b32 v11, v10, v119
    v_or_b32 v13, v13, v11
    v_cmp_ne_u32 vcc, 0, v13
    s_nop 4
    s_cmp_eq_u64 vcc, 0
    s_cbranch_scc0 L_fin
L_fo7:
    v_max_f32 v11, v96, v116
    v_sub_f32 v16, v96, v11
    v_sub_f32 v17, v116, v11
    v_exp_f32 v16, v16
    v_exp_f32 v17, v17
    s_nop 0
    v_mul_f32 v12, v16, v97
    v_fmac_f32 v12, v17, v117
    v_rcp_f32 v12, v12
    s_add_u32 s58, s63, 0
    s_mul_i32 s58, s58, 1536
    v_mul_f32 v16, v16, v12
    v_mul_f32 v17, v17, v12
    v_mul_f32 v32, v80, v16
    v_fmac_f32 v32, v100, v17
    v_mul_f32 v33, v81, v16
    v_fmac_f32 v33, v101, v17
    v_mul_f32 v34, v82, v16
    v_fmac_f32 v34, v102, v17
    v_mul_f32 v35, v84, v16
    v_fmac_f32 v35, v104, v17
    v_mul_f32 v36, v85, v16
    v_fmac_f32 v36, v105, v17
    v_mul_f32 v37, v86, v16
    v_fmac_f32 v37, v106, v17
    v_mul_f32 v38, v88, v16
    v_fmac_f32 v38, v108, v17
    v_mul_f32 v39, v89, v16
    v_fmac_f32 v39, v109, v17
    v_mul_f32 v40, v90, v16
    v_fmac_f32 v40, v110, v17
    v_mul_f32 v41, v92, v16
    v_fmac_f32 v41, v112, v17
    v_mul_f32 v42, v93, v16
    v_fmac_f32 v42, v113, v17
    v_mul_f32 v43, v94, v16
    v_fmac_f32 v43, v114, v17
    v_cvt_pk_bf16_f32 v44, v32, v33
    v_cvt_pk_bf16_f32 v45, v34, v35
    v_cvt_pk_bf16_f32 v46, v36, v37
    v_cvt_pk_bf16_f32 v47, v38, v39
    v_cvt_pk_bf16_f32 v48, v40, v41
    v_cvt_pk_bf16_f32 v49, v42, v43
    buffer_store_dwordx2 v[44:45], v8, s[48:51], s58 offen offset:0
    buffer_store_dwordx2 v[46:47], v8, s[48:51], s58 offen offset:128
    buffer_store_dwordx2 v[48:49], v8, s[48:51], s58 offen offset:256
    s_branch L_fin
L_fmid:
    v_and_b32 v7, 1, v1
    v_mul_u32_u24 v7, 8704, v7
    v_add_u32 v7, 4108, v7
    s_movk_i32 s69, 41
L_fb5:
    s_barrier
    s_sub_u32 s69, s69, 1
    s_cmp_lg_u32 s69, 0
    s_cbranch_scc1 L_fb5
    v_add_u32 v13, 142336, v14
    v_lshlrev_b32 v11, 2, v1
    v_add_u32 v11, 142592, v11
    ds_read_b128 v[16:19], v13 offset:0
    ds_read_b128 v[20:23], v13 offset:64
    ds_read_b128 v[24:27], v13 offset:128
    ds_read_b128 v[28:31], v13 offset:192
    ds_read2st64_b32 v[32:33], v11 offset0:0 offset1:1
    ds_read2st64_b32 v[34:35], v11 offset0:2 offset1:3
    ds_read2st64_b32 v[36:37], v11 offset0:4 offset1:5
    ds_read2st64_b32 v[38:39], v11 offset0:6 offset1:7
    ds_read2st64_b32 v[40:41], v11 offset0:8 offset1:9
    ds_read2st64_b32 v[42:43], v11 offset0:10 offset1:11
    ds_read2st64_b32 v[44:45], v11 offset0:12 offset1:13
    ds_read2st64_b32 v[46:47], v11 offset0:14 offset1:15
    s_waitcnt lgkmcnt(4)
    ds_read2st64_b32 v[48:49], v11 offset0:16 offset1:17
    ds_read2st64_b32 v[50:51], v11 offset0:18 offset1:19
    ds_read2st64_b32 v[52:53], v11 offset0:20 offset1:21
    ds_read2st64_b32 v[54:55], v11 offset0:22 offset1:23
    ds_read2st64_b32 v[56:57], v11 offset0:24 offset1:25
    ds_read2st64_b32 v[58:59], v11 offset0:26 offset1:27
    ds_read2st64_b32 v[60:61], v11 offset0:28 offset1:29
    ds_read2st64_b32 v[62:63], v11 offset0:30 offset1:31
    s_waitcnt lgkmcnt(4)
    ds_read2st64_b32 v[64:65], v11 offset0:32 offset1:33
    ds_read2st64_b32 v[66:67], v11 offset0:34 offset1:35
    ds_read2st64_b32 v[68:69], v11 offset0:36 offset1:37
    ds_read2st64_b32 v[70:71], v11 offset0:38 offset1:39
    ds_read2st64_b32 v[72:73], v11 offset0:40 offset1:41
    ds_read2st64_b32 v[74:75], v11 offset0:42 offset1:43
    ds_read2st64_b32 v[76:77], v11 offset0:44 offset1:45
    ds_read2st64_b32 v[78:79], v11 offset0:46 offset1:47
    v_mov_b32 v83, v10
    v_mov_b32 v87, v10
    v_mov_b32 v91, v10
    v_mov_b32 v95, v10
    v_mov_b32 v99, v10
    v_mov_b32 v96, v16
    v_add_f32 v17, v17, v21
    v_add_f32 v25, v25, v29
    v_add_f32 v97, v17, v25
    v_add_f32 v18, v18, v22
    v_add_f32 v26, v26, v30
    v_add_f32 v98, v18, v26
    s_waitcnt lgkmcnt(0)
    v_add_f32 v32, v32, v44
    v_add_f32 v56, v56, v68
    v_add_f32 v32, v32, v56
    v_sub_f32 v80, v32, v98
    v_add_f32 v33, v33, v45
    v_add_f32 v57, v57, v69
    v_add_f32 v33, v33, v57
    v_sub_f32 v81, v33, v98
    v_add_f32 v34, v34, v46
    v_add_f32 v58, v58, v70
    v_add_f32 v34, v34, v58
    v_sub_f32 v82, v34, v98
    v_add_f32 v35, v35, v47
    v_add_f32 v59, v59, v71
    v_add_f32 v35, v35, v59
    v_sub_f32 v84, v35, v98
    v_add_f32 v36, v36, v48
    v_add_f32 v60, v60, v72
    v_add_f32 v36, v36, v60
    v_sub_f32 v85, v36, v98
    v_add_f32 v37, v37, v49
    v_add_f32 v61, v61, v73
    v_add_f32 v37, v37, v61
    v_sub_f32 v86, v37, v98
    v_add_f32 v38, v38, v50
    v_add_f32 v62, v62, v74
    v_add_f32 v38, v38, v62
    v_sub_f32 v88, v38, v98
    v_add_f32 v39, v39, v51
    v_add_f32 v63, v63, v75
    v_add_f32 v39, v39, v63
    v_sub_f32 v89, v39, v98
    v_add_f32 v40, v40, v52
    v_add_f32 v64, v64, v76
    v_add_f32 v40, v40, v64
    v_sub_f32 v90, v40, v98
    v_add_f32 v41, v41, v53
    v_add_f32 v65, v65, v77
    v_add_f32 v41, v41, v65
    v_sub_f32 v92, v41, v98
    v_add_f32 v42, v42, v54
    v_add_f32 v66, v66, v78
    v_add_f32 v42, v42, v66
    v_sub_f32 v93, v42, v98
    v_add_f32 v43, v43, v55
    v_add_f32 v67, v67, v79
    v_add_f32 v43, v43, v67
    v_sub_f32 v94, v43, v98
    s_movk_i32 s69, 40
L_fb6:
    s_barrier
    s_sub_u32 s69, s69, 1
    s_cmp_lg_u32 s69, 0
    s_cbranch_scc1 L_fb6
    v_add_u32 v13, 142336, v14
    v_lshlrev_b32 v11, 2, v1
    v_add_u32 v11, 142592, v11
    ds_read_b128 v[16:19], v13 offset:0
    ds_read_b128 v[20:23], v13 offset:64
    ds_read_b128 v[24:27], v13 offset:128
    ds_read_b128 v[28:31], v13 offset:192
    ds_read2st64_b32 v[32:33], v11 offset0:0 offset1:1
    ds_read2st64_b32 v[34:35], v11 offset0:2 offset1:3
    ds_read2st64_b32 v[36:37], v11 offset0:4 offset1:5
    ds_read2st64_b32 v[38:39], v11 offset0:6 offset1:7
    ds_read2st64_b32 v[40:41], v11 offset0:8 offset1:9
    ds_read2st64_b32 v[42:43], v11 offset0:10 offset1:11
    ds_read2st64_b32 v[44:45], v11 offset0:12 offset1:13
    ds_read2st64_b32 v[46:47], v11 offset0:14 offset1:15
    s_waitcnt lgkmcnt(4)
    ds_read2st64_b32 v[48:49], v11 offset0:16 offset1:17
    ds_read2st64_b32 v[50:51], v11 offset0:18 offset1:19
    ds_read2st64_b32 v[52:53], v11 offset0:20 offset1:21
    ds_read2st64_b32 v[54:55], v11 offset0:22 offset1:23
    ds_read2st64_b32 v[56:57], v11 offset0:24 offset1:25
    ds_read2st64_b32 v[58:59], v11 offset0:26 offset1:27
    ds_read2st64_b32 v[60:61], v11 offset0:28 offset1:29
    ds_read2st64_b32 v[62:63], v11 offset0:30 offset1:31
    s_waitcnt lgkmcnt(4)
    ds_read2st64_b32 v[64:65], v11 offset0:32 offset1:33
    ds_read2st64_b32 v[66:67], v11 offset0:34 offset1:35
    ds_read2st64_b32 v[68:69], v11 offset0:36 offset1:37
    ds_read2st64_b32 v[70:71], v11 offset0:38 offset1:39
    ds_read2st64_b32 v[72:73], v11 offset0:40 offset1:41
    ds_read2st64_b32 v[74:75], v11 offset0:42 offset1:43
    ds_read2st64_b32 v[76:77], v11 offset0:44 offset1:45
    ds_read2st64_b32 v[78:79], v11 offset0:46 offset1:47
    v_mov_b32 v103, v10
    v_mov_b32 v107, v10
    v_mov_b32 v111, v10
    v_mov_b32 v115, v10
    v_mov_b32 v119, v10
    v_mov_b32 v116, v16
    v_add_f32 v17, v17, v21
    v_add_f32 v25, v25, v29
    v_add_f32 v117, v17, v25
    v_add_f32 v18, v18, v22
    v_add_f32 v26, v26, v30
    v_add_f32 v118, v18, v26
    s_waitcnt lgkmcnt(0)
    v_add_f32 v32, v32, v44
    v_add_f32 v56, v56, v68
    v_add_f32 v32, v32, v56
    v_sub_f32 v100, v32, v118
    v_add_f32 v33, v33, v45
    v_add_f32 v57, v57, v69
    v_add_f32 v33, v33, v57
    v_sub_f32 v101, v33, v118
    v_add_f32 v34, v34, v46
    v_add_f32 v58, v58, v70
    v_add_f32 v34, v34, v58
    v_sub_f32 v102, v34, v118
    v_add_f32 v35, v35, v47
    v_add_f32 v59, v59, v71
    v_add_f32 v35, v35, v59
    v_sub_f32 v104, v35, v118
    v_add_f32 v36, v36, v48
    v_add_f32 v60, v60, v72
    v_add_f32 v36, v36, v60
    v_sub_f32 v105, v36, v118
    v_add_f32 v37, v37, v49
    v_add_f32 v61, v61, v73
    v_add_f32 v37, v37, v61
    v_sub_f32 v106, v37, v118
    v_add_f32 v38, v38, v50
    v_add_f32 v62, v62, v74
    v_add_f32 v38, v38, v62
    v_sub_f32 v108, v38, v118
    v_add_f32 v39, v39, v51
    v_add_f32 v63, v63, v75
    v_add_f32 v39, v39, v63
    v_sub_f32 v109, v39, v118
    v_add_f32 v40, v40, v52
    v_add_f32 v64, v64, v76
    v_add_f32 v40, v40, v64
    v_sub_f32 v110, v40, v118
    v_add_f32 v41, v41, v53
    v_add_f32 v65, v65, v77
    v_add_f32 v41, v41, v65
    v_sub_f32 v112, v41, v118
    v_add_f32 v42, v42, v54
    v_add_f32 v66, v66, v78
    v_add_f32 v42, v42, v66
    v_sub_f32 v113, v42, v118
    v_add_f32 v43, v43, v55
    v_add_f32 v67, v67, v79
    v_add_f32 v43, v43, v67
    v_sub_f32 v114, v43, v118
    s_movk_i32 s69, 45
L_fb7:
    s_barrier
    s_sub_u32 s69, s69, 1
    s_cmp_lg_u32 s69, 0
    s_cbranch_scc1 L_fb7
    s_add_u32 s58, s62, 4352
    s_add_u32 s59, s62, 8448
    buffer_store_dwordx4 v[80:83], v9, s[24:27], s58 offen offset:0 sc1 nt
    buffer_store_dwordx4 v[84:87], v9, s[24:27], s58 offen offset:1024 sc1 nt
    buffer_store_dwordx4 v[88:91], v9, s[24:27], s58 offen offset:2048 sc1 nt
    buffer_store_dwordx4 v[92:95], v9, s[24:27], s58 offen offset:3072 sc1 nt
    s_mov_b64 exec, 15
    buffer_store_dwordx4 v[96:99], v14, s[24:27], s59 offen sc1 nt
    s_mov_b64 exec, -1
    s_add_u32 s58, s62, 13056
    s_add_u32 s59, s62, 17152
    buffer_store_dwordx4 v[100:103], v9, s[24:27], s58 offen offset:0 sc1 nt
    buffer_store_dwordx4 v[104:107], v9, s[24:27], s58 offen offset:1024 sc1 nt
    buffer_store_dwordx4 v[108:111], v9, s[24:27], s58 offen offset:2048 sc1 nt
    buffer_store_dwordx4 v[112:115], v9, s[24:27], s58 offen offset:3072 sc1 nt
    s_mov_b64 exec, 15
    buffer_store_dwordx4 v[116:119], v14, s[24:27], s59 offen sc1 nt
    s_mov_b64 exec, -1
    s_barrier
    s_barrier
    s_barrier
    s_waitcnt vmcnt(0)
    buffer_load_dword v15, v7, s[24:27], s62 offen sc1
    s_waitcnt vmcnt(0)
    v_cmp_eq_u32 vcc, v15, v10
    s_nop 4
    s_and_b32 s70, vcc_lo, 3
    s_cbranch_scc0 L_fin
    s_bitcmp1_b32 s70, 0
    s_cbranch_scc0 L_fm30
    s_waitcnt vmcnt(0)
    s_add_u32 s58, s62, 0
    s_add_u32 s59, s62, 4096
    buffer_load_dwordx4 v[136:139], v14, s[24:27], s59 offen sc1 nt
    buffer_load_dwordx4 v[120:123], v9, s[24:27], s58 offen offset:0 sc1 nt
    buffer_load_dwordx4 v[124:127], v9, s[24:27], s58 offen offset:1024 sc1 nt
    buffer_load_dwordx4 v[128:131], v9, s[24:27], s58 offen offset:2048 sc1 nt
    buffer_load_dwordx4 v[132:135], v9, s[24:27], s58 offen offset:3072 sc1 nt
    s_waitcnt vmcnt(0)
    v_xor_b32 v13, v10, v123
    v_xor_b32 v11, v10, v127
    v_or_b32 v13, v13, v11
    v_xor_b32 v11, v10, v131
    v_or_b32 v13, v13, v11
    v_xor_b32 v11, v10, v135
    v_or_b32 v13, v13, v11
    v_xor_b32 v11, v10, v139
    v_or_b32 v13, v13, v11
    v_cmp_ne_u32 vcc, 0, v13
    s_nop 4
    s_cmp_eq_u64 vcc, 0
    s_cbranch_scc0 L_fm30
    v_max_f32 v11, v136, v96
    v_sub_f32 v16, v136, v11
    v_sub_f32 v17, v96, v11
    v_exp_f32 v16, v16
    v_exp_f32 v17, v17
    s_nop 0
    v_mul_f32 v12, v16, v137
    v_fmac_f32 v12, v17, v97
    v_rcp_f32 v12, v12
    s_add_u32 s58, s63, 0
    s_mul_i32 s58, s58, 1536
    v_mul_f32 v16, v16, v12
    v_mul_f32 v17, v17, v12
    v_mul_f32 v32, v120, v16
    v_fmac_f32 v32, v80, v17
    v_mul_f32 v33, v121, v16
    v_fmac_f32 v33, v81, v17
    v_mul_f32 v34, v122, v16
    v_fmac_f32 v34, v82, v17
    v_mul_f32 v35, v124, v16
    v_fmac_f32 v35, v84, v17
    v_mul_f32 v36, v125, v16
    v_fmac_f32 v36, v85, v17
    v_mul_f32 v37, v126, v16
    v_fmac_f32 v37, v86, v17
    v_mul_f32 v38, v128, v16
    v_fmac_f32 v38, v88, v17
    v_mul_f32 v39, v129, v16
    v_fmac_f32 v39, v89, v17
    v_mul_f32 v40, v130, v16
    v_fmac_f32 v40, v90, v17
    v_mul_f32 v41, v132, v16
    v_fmac_f32 v41, v92, v17
    v_mul_f32 v42, v133, v16
    v_fmac_f32 v42, v93, v17
    v_mul_f32 v43, v134, v16
    v_fmac_f32 v43, v94, v17
    v_cvt_pk_bf16_f32 v44, v32, v33
    v_cvt_pk_bf16_f32 v45, v34, v35
    v_cvt_pk_bf16_f32 v46, v36, v37
    v_cvt_pk_bf16_f32 v47, v38, v39
    v_cvt_pk_bf16_f32 v48, v40, v41
    v_cvt_pk_bf16_f32 v49, v42, v43
    buffer_store_dwordx2 v[44:45], v8, s[48:51], s58 offen offset:0
    buffer_store_dwordx2 v[46:47], v8, s[48:51], s58 offen offset:128
    buffer_store_dwordx2 v[48:49], v8, s[48:51], s58 offen offset:256
L_fm30:
    s_bitcmp1_b32 s70, 1
    s_cbranch_scc0 L_fm31
    s_waitcnt vmcnt(0)
    s_add_u32 s58, s62, 8704
    s_add_u32 s59, s62, 12800
    buffer_load_dwordx4 v[136:139], v14, s[24:27], s59 offen sc1 nt
    buffer_load_dwordx4 v[120:123], v9, s[24:27], s58 offen offset:0 sc1 nt
    buffer_load_dwordx4 v[124:127], v9, s[24:27], s58 offen offset:1024 sc1 nt
    buffer_load_dwordx4 v[128:131], v9, s[24:27], s58 offen offset:2048 sc1 nt
    buffer_load_dwordx4 v[132:135], v9, s[24:27], s58 offen offset:3072 sc1 nt
    s_waitcnt vmcnt(0)
    v_xor_b32 v13, v10, v123
    v_xor_b32 v11, v10, v127
    v_or_b32 v13, v13, v11
    v_xor_b32 v11, v10, v131
    v_or_b32 v13, v13, v11
    v_xor_b32 v11, v10, v135
    v_or_b32 v13, v13, v11
    v_xor_b32 v11, v10, v139
    v_or_b32 v13, v13, v11
    v_cmp_ne_u32 vcc, 0, v13
    s_nop 4
    s_cmp_eq_u64 vcc, 0
    s_cbranch_scc0 L_fm31
    v_max_f32 v11, v136, v116
    v_sub_f32 v16, v136, v11
    v_sub_f32 v17, v116, v11
    v_exp_f32 v16, v16
    v_exp_f32 v17, v17
    s_nop 0
    v_mul_f32 v12, v16, v137
    v_fmac_f32 v12, v17, v117
    v_rcp_f32 v12, v12
    s_add_u32 s58, s63, 1
    s_mul_i32 s58, s58, 1536
    v_mul_f32 v16, v16, v12
    v_mul_f32 v17, v17, v12
    v_mul_f32 v32, v120, v16
    v_fmac_f32 v32, v100, v17
    v_mul_f32 v33, v121, v16
    v_fmac_f32 v33, v101, v17
    v_mul_f32 v34, v122, v16
    v_fmac_f32 v34, v102, v17
    v_mul_f32 v35, v124, v16
    v_fmac_f32 v35, v104, v17
    v_mul_f32 v36, v125, v16
    v_fmac_f32 v36, v105, v17
    v_mul_f32 v37, v126, v16
    v_fmac_f32 v37, v106, v17
    v_mul_f32 v38, v128, v16
    v_fmac_f32 v38, v108, v17
    v_mul_f32 v39, v129, v16
    v_fmac_f32 v39, v109, v17
    v_mul_f32 v40, v130, v16
    v_fmac_f32 v40, v110, v17
    v_mul_f32 v41, v132, v16
    v_fmac_f32 v41, v112, v17
    v_mul_f32 v42, v133, v16
    v_fmac_f32 v42, v113, v17
    v_mul_f32 v43, v134, v16
    v_fmac_f32 v43, v114, v17
    v_cvt_pk_bf16_f32 v44, v32, v33
    v_cvt_pk_bf16_f32 v45, v34, v35
    v_cvt_pk_bf16_f32 v46, v36, v37
    v_cvt_pk_bf16_f32 v47, v38, v39
    v_cvt_pk_bf16_f32 v48, v40, v41
    v_cvt_pk_bf16_f32 v49, v42, v43
    buffer_store_dwordx2 v[44:45], v8, s[48:51], s58 offen offset:0
    buffer_store_dwordx2 v[46:47], v8, s[48:51], s58 offen offset:128
    buffer_store_dwordx2 v[48:49], v8, s[48:51], s58 offen offset:256
L_fm31:
L_fin:
L_end:
    s_endpgm
.section .rodata,"a"
.p2align 6
.amdhsa_kernel standalone__kv_cache_quant_int4_int2_kv_with_per_channel_or_per_token_scales__sampling_kernel
  .amdhsa_next_free_vgpr 232
  .amdhsa_next_free_sgpr 102
  .amdhsa_accum_offset 232
  .amdhsa_group_segment_fixed_size 0
  .amdhsa_kernarg_size 80
  .amdhsa_user_sgpr_count 2
  .amdhsa_user_sgpr_kernarg_segment_ptr 1
  .amdhsa_system_sgpr_workgroup_id_x 1
  .amdhsa_float_denorm_mode_32 3
.end_amdhsa_kernel
```

```asm
; @launch grid=(256,1,1) block=(448,1,1) lds=161280
.amdgcn_target "amdgcn-amd-amdhsa--gfx950"
.text
.globl standalone__kv_cache_quant_int4_int2_kv_with_per_channel_or_per_token_scales__sampling_kernel
.p2align 8
.type standalone__kv_cache_quant_int4_int2_kv_with_per_channel_or_per_token_scales__sampling_kernel,@function
standalone__kv_cache_quant_int4_int2_kv_with_per_channel_or_per_token_scales__sampling_kernel:
    s_load_dwordx16 s[4:19], s[0:1], 0
    s_load_dwordx4 s[20:23], s[0:1], 64
    s_cmp_ge_u32 s2, 256
    s_cbranch_scc1 L_end
    v_lshrrev_b32 v2, 6, v0
    v_and_b32 v1, 63, v0
    v_readfirstlane_b32 s56, v2
    s_mov_b32 s72, s2
    s_bfe_u32 s58, s2, 196612
    s_lshr_b32 s59, s2, 1
    s_and_b32 s59, s59, 2
    s_xor_b32 s2, s2, s58
    s_xor_b32 s2, s2, s59
    s_bfe_u32 s58, s2, 65537
    s_xor_b32 s2, s2, s58
    s_mul_i32 s57, s2, 1398112
    s_add_u32 s57, s57, 43691
    s_lshr_b32 s57, s57, 17
    v_lshlrev_b32 v8, 4, v1
    s_and_b32 s59, s56, 1
    s_mul_i32 s59, s59, 31488
    s_lshl_b32 s58, s57, 7
    s_add_u32 s58, s58, s56
    s_mul_i32 s58, s58, 1536
    s_add_u32 s58, s58, s59
    s_mul_i32 m0, s56, 3072
    s_mov_b32 s26, 805306368
    s_mov_b32 s27, 0x20000
    s_waitcnt lgkmcnt(0)
    s_mov_b32 s24, s6
    s_and_b32 s25, s7, 0xffff
    buffer_load_dwordx4 v8, s[24:27], s58 offen offset:0 nt lds
    buffer_load_dwordx4 v8, s[24:27], s58 offen offset:1024 nt lds
    buffer_load_dwordx4 v8, s[24:27], s58 offen offset:2048 nt lds
    s_mul_i32 s100, s2, 43691
    s_lshr_b32 s100, s100, 17
    s_mul_i32 s101, s100, 3
    s_sub_u32 s101, s2, s101
    s_cmp_eq_u32 s2, 255
    s_cselect_b32 s73, 16, 11
    s_cmp_eq_u32 s101, 1
    s_cselect_b32 s3, 5, s73
    s_cselect_b32 s73, 10, s73
    s_sub_u32 s58, 2, s101
    s_mul_i32 s58, s58, 11
    s_lshr_b32 s58, s58, 1
    s_lshl_b32 s59, s100, 4
    s_sub_u32 s58, s58, s59
    s_add_u32 s58, s58, 4080
    s_sub_u32 s58, s58, s73
    v_cmp_le_u32 vcc, s73, v1
    v_add_u32 v3, s57, v1
    v_add_u32 v4, s58, v1
    v_cndmask_b32 v152, v3, v4, vcc
    s_cmp_eq_u32 s56, 4
    s_cbranch_scc1 L_loader
    s_cmp_lt_u32 s56, 4
    s_cbranch_scc1 L_consumer
    s_cmp_eq_u32 s56, 6
    s_cbranch_scc1 L_ctl
    s_waitcnt lgkmcnt(0)
    s_mov_b32 s44, s4
    s_and_b32 s45, s5, 0xffff
    s_mov_b32 s46, 393216
    s_mov_b32 s47, 0x20000
    s_mov_b32 s32, s12
    s_and_b32 s33, s13, 0xffff
    s_mov_b32 s34, 6291456
    s_mov_b32 s35, 0x20000
    s_mov_b32 s28, s10
    s_and_b32 s29, s11, 0xffff
    s_mov_b32 s30, 6291456
    s_mov_b32 s31, 0x20000
    s_mov_b32 s36, s14
    s_and_b32 s37, s15, 0xffff
    s_mov_b32 s38, 2097152
    s_mov_b32 s39, 0x20000
    s_mov_b32 s40, s16
    s_and_b32 s41, s17, 0xffff
    s_mov_b32 s42, 2097152
    s_mov_b32 s43, 0x20000
    s_sub_u32 s61, s56, 5
    s_mov_b32 s62, s61
    s_mov_b32 exec_hi, 0xffff
L_stq:
    s_mul_i32 s58, s62, s3
    s_cmp_lt_u32 s58, 15
    s_cbranch_scc0 L_stage
    v_readlane_b32 s58, v152, s58
    s_mul_i32 s59, s62, 1536
    s_add_u32 m0, s59, 155136
    s_add_u32 s62, s62, 1
    s_lshr_b32 s58, s58, 4
    s_mul_i32 s58, s58, 1536
    buffer_load_dwordx4 v8, s[44:47], s58 offen nt lds
    buffer_load_dwordx4 v8, s[44:47], s58 offen offset:768 nt lds
    s_branch L_stq
L_stage:
    v_readlane_b32 s60, v152, s61
    s_mul_i32 s59, s61, 3072
    s_add_u32 m0, s59, 76800
    s_mov_b32 exec_hi, 0xffff
    s_mul_i32 s58, s60, 1536
    buffer_load_dwordx4 v8, s[32:35], s58 offen nt lds
    buffer_load_dwordx4 v8, s[32:35], s58 offen offset:768 nt lds
    s_add_u32 m0, m0, 1536
    s_lshl_b32 s59, s61, 10
    buffer_load_dwordx4 v8, s[28:31], s58 offen nt lds
    buffer_load_dwordx4 v8, s[28:31], s58 offen offset:768 nt lds
    s_add_u32 m0, s59, 125952
    s_mov_b32 exec_hi, 0
    s_lshl_b32 s58, s60, 9
    buffer_load_dwordx4 v8, s[36:39], s58 offen nt lds
    s_add_u32 m0, m0, 512
    s_add_u32 s61, s61, 1
    buffer_load_dwordx4 v8, s[40:43], s58 offen nt lds
    s_cmp_lt_u32 s61, 16
    s_cbranch_scc1 L_stage
    s_mov_b32 exec_hi, -1
    s_branch L_finisher
L_loader:
    s_setprio 3
    s_mul_i32 s57, s57, 196608
    s_add_u32 s69, s57, 42240
    s_mov_b32 m0, 21504
    s_add_u32 s57, s57, 12288
    buffer_load_dwordx4 v8, s[24:27], s69 offen offset:0 nt lds
    buffer_load_dwordx4 v8, s[24:27], s69 offen offset:1024 nt lds
    buffer_load_dwordx4 v8, s[24:27], s69 offen offset:2048 nt lds
    s_add_u32 s69, s69, 3072
    v_lshrrev_b32 v11, 5, v1
    v_add_u32 v22, 48, v1
    v_lshrrev_b32 v12, 6, v22
    v_mov_b32 v13, v8
    v_mov_b32 v14, v8
    v_mov_b32 v15, v8
    v_mov_b32 v16, v8
    s_mov_b32 s68, 4
    s_mov_b32 s62, 24576
    s_mov_b32 s63, 0
    s_mov_b32 s86, 0
    s_mov_b32 s87, 0
    s_mov_b32 s70, 18
    s_mov_b32 s74, 0
    v_mov_b32 v20, 4812
    v_mov_b32 v21, 154880
    ds_write_b32 v21, v20
    s_mov_b32 s58, 4
    s_branch L_lnobar
L_lw16:
    s_waitcnt vmcnt(16)
L_lw17:
    s_waitcnt vmcnt(17)
L_lw18:
    s_waitcnt vmcnt(18)
L_lw19:
    s_waitcnt vmcnt(19)
L_lw20:
    s_waitcnt vmcnt(20)
L_lw21:
    s_waitcnt vmcnt(21)
L_lw22:
    s_waitcnt vmcnt(22)
    buffer_load_dwordx4 v8, s[24:27], s57 offen offset:0 nt lds
    s_add_u32 s68, s68, 1
    s_and_b32 s58, s68, 31
    s_add_u32 s60, s63, 3072
    s_add_u32 s88, s60, s86
    buffer_load_dwordx4 v13, s[24:27], s57 offen offset:1024 nt lds
    s_add_u32 m0, s62, 3072
    s_add_u32 s89, s60, s87
    s_cmp_eq_u32 s58, 10
    s_cselect_b32 s63, 33024, 0
    s_cmp_eq_u32 s58, 21
    s_cselect_b32 s86, 33024, 0
    s_cselect_b32 s87, 32256, 0
    buffer_load_dwordx4 v8, s[24:27], s69 offen offset:0 nt lds
    s_add_u32 m0, s62, 0
    v_mad_u32_u24 v22, v12, s63, v8
    v_mad_u32_u24 v13, v11, s86, v8
    s_cmp_eq_u32 s70, 22
    s_cbranch_scc1 L_lx1__22
    s_cmp_eq_u32 s70, 21
    s_cbranch_scc1 L_lx1__21
    s_cmp_eq_u32 s70, 20
    s_cbranch_scc1 L_lx1__20
    s_cmp_eq_u32 s70, 19
    s_cbranch_scc1 L_lx1__19
    s_cmp_eq_u32 s70, 18
    s_cbranch_scc1 L_lx1__18
    s_cmp_eq_u32 s70, 17
    s_cbranch_scc1 L_lx1__17
L_lx1__16:
    s_waitcnt vmcnt(16)
L_lx1__17:
    s_waitcnt vmcnt(17)
L_lx1__18:
    s_waitcnt vmcnt(18)
L_lx1__19:
    s_waitcnt vmcnt(19)
L_lx1__20:
    s_waitcnt vmcnt(20)
L_lx1__21:
    s_waitcnt vmcnt(21)
L_lx1__22:
    s_waitcnt vmcnt(22)
    buffer_load_dwordx4 v14, s[24:27], s57 offen offset:2048 nt lds
    s_add_u32 m0, s62, 3072
    v_add_u32 v14, s86, v22
    s_add_u32 s57, s57, s88
    buffer_load_dwordx4 v15, s[24:27], s69 offen offset:1024 nt lds
    v_mad_u32_u24 v15, v11, s87, v8
    buffer_load_dwordx4 v16, s[24:27], s69 offen offset:2048 nt lds
    v_add_u32 v16, s87, v22
    s_add_u32 s69, s69, s89
    s_add_u32 s62, s62, 6144
    s_add_u32 m0, s62, 0
    s_and_b32 s59, s68, 3
    s_cbranch_scc0 L_lunit
L_lad:
    s_cmp_eq_u32 s70, 22
    s_cbranch_scc1 L_lw22
    s_cmp_eq_u32 s70, 21
    s_cbranch_scc1 L_lw21
    s_cmp_eq_u32 s70, 20
    s_cbranch_scc1 L_lw20
    s_cmp_eq_u32 s70, 19
    s_cbranch_scc1 L_lw19
    s_cmp_eq_u32 s70, 18
    s_cbranch_scc1 L_lw18
    s_cmp_eq_u32 s70, 17
    s_cbranch_scc1 L_lw17
    s_branch L_lw16
L_lunit:
    s_waitcnt vmcnt(24)
    s_cmp_eq_u32 s68, 8
    s_cbranch_scc1 L_lfirst
L_lbar:
    s_barrier
L_lnobar:
    s_waitcnt lgkmcnt(0)
    v_readfirstlane_b32 s59, v20
    ds_read_b32 v20, v21
    s_cmp_eq_u32 s62, 73728
    s_cselect_b32 s62, 0, s62
    s_add_u32 m0, s62, 0
    s_and_b32 s74, s74, 255
    s_add_u32 s74, s74, s59
    s_lshr_b32 s70, s74, 8
    s_cmp_eq_u32 s58, 0
    s_cbranch_scc1 L_lblock
L_lsel:
    s_cmp_eq_u32 s70, 19
    s_cbranch_scc1 L_lw19
    s_cmp_eq_u32 s70, 20
    s_cbranch_scc1 L_lw20
    s_cmp_eq_u32 s70, 18
    s_cbranch_scc1 L_lw18
    s_cmp_le_u32 s70, 22
    s_cbranch_scc1 L_lad
    s_cmp_le_u32 s70, 23
    s_cbranch_scc1 L_lw23
    s_cmp_le_u32 s70, 24
    s_cbranch_scc1 L_lw24
    s_branch L_lw25
L_lblock:
    s_bfe_u32 s58, s68, 262149
    v_readlane_b32 s57, v152, s58
    s_nop 3
    s_mul_i32 s57, s57, 196608
    s_add_u32 s69, s57, 33024
    s_cmp_eq_u32 s58, 0
    s_cbranch_scc0 L_lsel
    s_cmp_eq_u32 s68, 1024
    s_cbranch_scc1 L_ldone
    s_mov_b32 s24, s8
    s_and_b32 s25, s9, 0xffff
    s_branch L_lsel
L_lfirst:
    s_barrier
    s_branch L_lbar
L_ldone:
    s_waitcnt vmcnt(0)
    s_barrier
    s_endpgm
L_lw23:
    s_waitcnt vmcnt(23)
    buffer_load_dwordx4 v8, s[24:27], s57 offen offset:0 nt lds
    s_add_u32 s68, s68, 1
    s_and_b32 s58, s68, 31
    s_add_u32 s60, s63, 3072
    s_add_u32 s88, s60, s86
    buffer_load_dwordx4 v13, s[24:27], s57 offen offset:1024 nt lds
    s_add_u32 m0, s62, 3072
    s_add_u32 s89, s60, s87
    s_cmp_eq_u32 s58, 10
    s_cselect_b32 s63, 33024, 0
    s_cmp_eq_u32 s58, 21
    s_cselect_b32 s86, 33024, 0
    s_cselect_b32 s87, 32256, 0
    buffer_load_dwordx4 v8, s[24:27], s69 offen offset:0 nt lds
    s_add_u32 m0, s62, 0
    v_mad_u32_u24 v22, v12, s63, v8
    v_mad_u32_u24 v13, v11, s86, v8
L_lx1_23_23:
    s_waitcnt vmcnt(23)
    buffer_load_dwordx4 v14, s[24:27], s57 offen offset:2048 nt lds
    s_add_u32 m0, s62, 3072
    v_add_u32 v14, s86, v22
    s_add_u32 s57, s57, s88
    buffer_load_dwordx4 v15, s[24:27], s69 offen offset:1024 nt lds
    v_mad_u32_u24 v15, v11, s87, v8
    buffer_load_dwordx4 v16, s[24:27], s69 offen offset:2048 nt lds
    v_add_u32 v16, s87, v22
    s_add_u32 s69, s69, s89
    s_add_u32 s62, s62, 6144
    s_add_u32 m0, s62, 0
    s_and_b32 s59, s68, 3
    s_cbranch_scc1 L_lw23
    s_branch L_lunit
L_lw24:
    s_waitcnt vmcnt(24)
    buffer_load_dwordx4 v8, s[24:27], s57 offen offset:0 nt lds
    s_add_u32 s68, s68, 1
    s_and_b32 s58, s68, 31
    s_add_u32 s60, s63, 3072
    s_add_u32 s88, s60, s86
    buffer_load_dwordx4 v13, s[24:27], s57 offen offset:1024 nt lds
    s_add_u32 m0, s62, 3072
    s_add_u32 s89, s60, s87
    s_cmp_eq_u32 s58, 10
    s_cselect_b32 s63, 33024, 0
    s_cmp_eq_u32 s58, 21
    s_cselect_b32 s86, 33024, 0
    s_cselect_b32 s87, 32256, 0
    buffer_load_dwordx4 v8, s[24:27], s69 offen offset:0 nt lds
    s_add_u32 m0, s62, 0
    v_mad_u32_u24 v22, v12, s63, v8
    v_mad_u32_u24 v13, v11, s86, v8
L_lx1_24_24:
    s_waitcnt vmcnt(24)
    buffer_load_dwordx4 v14, s[24:27], s57 offen offset:2048 nt lds
    s_add_u32 m0, s62, 3072
    v_add_u32 v14, s86, v22
    s_add_u32 s57, s57, s88
    buffer_load_dwordx4 v15, s[24:27], s69 offen offset:1024 nt lds
    v_mad_u32_u24 v15, v11, s87, v8
    buffer_load_dwordx4 v16, s[24:27], s69 offen offset:2048 nt lds
    v_add_u32 v16, s87, v22
    s_add_u32 s69, s69, s89
    s_add_u32 s62, s62, 6144
    s_add_u32 m0, s62, 0
    s_and_b32 s59, s68, 3
    s_cbranch_scc1 L_lw24
    s_branch L_lunit
L_lw25:
    s_waitcnt vmcnt(25)
    buffer_load_dwordx4 v8, s[24:27], s57 offen offset:0 nt lds
    s_add_u32 s68, s68, 1
    s_and_b32 s58, s68, 31
    s_add_u32 s60, s63, 3072
    s_add_u32 s88, s60, s86
    buffer_load_dwordx4 v13, s[24:27], s57 offen offset:1024 nt lds
    s_add_u32 m0, s62, 3072
    s_add_u32 s89, s60, s87
    s_cmp_eq_u32 s58, 10
    s_cselect_b32 s63, 33024, 0
    s_cmp_eq_u32 s58, 21
    s_cselect_b32 s86, 33024, 0
    s_cselect_b32 s87, 32256, 0
    buffer_load_dwordx4 v8, s[24:27], s69 offen offset:0 nt lds
    s_add_u32 m0, s62, 0
    v_mad_u32_u24 v22, v12, s63, v8
    v_mad_u32_u24 v13, v11, s86, v8
L_lx1_25_25:
    s_waitcnt vmcnt(25)
    buffer_load_dwordx4 v14, s[24:27], s57 offen offset:2048 nt lds
    s_add_u32 m0, s62, 3072
    v_add_u32 v14, s86, v22
    s_add_u32 s57, s57, s88
    buffer_load_dwordx4 v15, s[24:27], s69 offen offset:1024 nt lds
    v_mad_u32_u24 v15, v11, s87, v8
    buffer_load_dwordx4 v16, s[24:27], s69 offen offset:2048 nt lds
    v_add_u32 v16, s87, v22
    s_add_u32 s69, s69, s89
    s_add_u32 s62, s62, 6144
    s_add_u32 m0, s62, 0
    s_and_b32 s59, s68, 3
    s_cbranch_scc1 L_lw25
    s_branch L_lunit
L_ctl:
    s_sub_u32 s58, s72, 8
    s_cmp_lt_u32 s58, 8
    s_cbranch_scc0 L_ctl_init
    s_getpc_b64 s[44:45]
L_pc:
    s_and_b32 s45, s45, 0xffff
    s_mov_b32 s46, L_end - L_pc
    s_mov_b32 s47, 0x20000
    v_lshlrev_b32 v9, 7, v1
    s_movk_i32 s58, 0
    buffer_load_dword v12, v9, s[44:47], s58 offen
    s_movk_i32 s58, 8192
    buffer_load_dword v13, v9, s[44:47], s58 offen
    s_movk_i32 s58, 16384
    buffer_load_dword v14, v9, s[44:47], s58 offen
    s_movk_i32 s58, 24576
    buffer_load_dword v15, v9, s[44:47], s58 offen
L_ctl_init:
    s_waitcnt lgkmcnt(0)
    s_mov_b32 s52, s22
    s_and_b32 s53, s23, 0xffff
    s_mov_b32 s54, 16793888
    s_mov_b32 s55, 0x20000
    s_mov_b32 s71, 0
    s_add_u32 s98, s22, 16777216
    s_addc_u32 s99, s23, 0
    s_cmp_lt_u32 s72, 8
    s_cselect_b32 s61, 1, 0
    s_and_b32 s59, s72, 7
    s_mul_i32 s59, s59, 4
    s_add_u32 s59, s59, 16777216
    v_mov_b32 v8, s59
    v_mov_b32 v10, 154880
    s_memtime s[28:29]
    s_memrealtime s[96:97]
    s_mov_b32 s32, 0
    s_mov_b64 exec, 1
    s_waitcnt lgkmcnt(0)
    s_mov_b32 s33, s96
    s_waitcnt vmcnt(0)
    s_barrier
    s_mov_b32 s63, 0
L_ctl_loop:
    s_barrier
    s_mov_b32 s62, s96
    s_mov_b32 s30, s28
    s_memtime s[28:29]
    s_memrealtime s[96:97]
    s_waitcnt lgkmcnt(0)
    s_sub_u32 s58, s96, s33
    s_mul_i32 s58, s58, 373
    s_mov_b32 s33, s96
    s_sub_u32 s59, s28, s30
    s_lshl_b32 s59, s59, 4
    s_sub_i32 s58, s58, s59
    s_mul_i32 s58, s58, 80
    s_ashr_i32 s31, s58, 12
    s_cmp_eq_u32 s63, 0
    s_cbranch_scc1 L_ctl_set
    s_mov_b32 s58, 0
    s_sub_i32 s59, s84, s62
    s_add_i32 s60, s59, 5000
    s_cmp_lt_u32 s60, 10000
    s_cselect_b32 s59, s59, 200
    s_add_i32 s58, s58, s59
    s_sub_i32 s59, s85, s62
    s_add_i32 s60, s59, 5000
    s_cmp_lt_u32 s60, 10000
    s_cselect_b32 s59, s59, 200
    s_add_i32 s58, s58, s59
    s_sub_i32 s59, s86, s62
    s_add_i32 s60, s59, 5000
    s_cmp_lt_u32 s60, 10000
    s_cselect_b32 s59, s59, 200
    s_add_i32 s58, s58, s59
    s_sub_i32 s59, s87, s62
    s_add_i32 s60, s59, 5000
    s_cmp_lt_u32 s60, 10000
    s_cselect_b32 s59, s59, 200
    s_add_i32 s58, s58, s59
    s_sub_i32 s59, s88, s62
    s_add_i32 s60, s59, 5000
    s_cmp_lt_u32 s60, 10000
    s_cselect_b32 s59, s59, 200
    s_add_i32 s58, s58, s59
    s_sub_i32 s59, s89, s62
    s_add_i32 s60, s59, 5000
    s_cmp_lt_u32 s60, 10000
    s_cselect_b32 s59, s59, 200
    s_add_i32 s58, s58, s59
    s_sub_i32 s59, s90, s62
    s_add_i32 s60, s59, 5000
    s_cmp_lt_u32 s60, 10000
    s_cselect_b32 s59, s59, 200
    s_add_i32 s58, s58, s59
    s_sub_i32 s59, s91, s62
    s_add_i32 s60, s59, 5000
    s_cmp_lt_u32 s60, 10000
    s_cselect_b32 s59, s59, 200
    s_add_i32 s58, s58, s59
    s_min_u32 s59, s63, 16
    s_cmp_gt_i32 s58, 0
    s_cselect_b32 s63, s59, s63
    s_mul_i32 s58, s58, s63
    s_ashr_i32 s58, s58, 5
    s_mov_b32 s32, s58
L_ctl_set:
    s_sub_i32 s58, s31, s32
    s_add_i32 s58, s58, 4812
    s_max_i32 s58, s58, 4096
    s_min_i32 s70, s58, 6400
    v_mov_b32 v9, s70
    ds_write_b32 v10, v9
    s_and_b32 s58, s71, 768
    s_cselect_b32 s63, 0, 5
    s_cmp_ge_u32 s71, 14848
    s_cselect_b32 s63, 32, s63
    s_cmp_eq_u32 s71, 16128
    s_cselect_b32 s63, 0, s63
    s_mul_i32 s58, s63, s61
    s_cmp_eq_u32 s58, 0
    s_cbranch_scc1 L_ctl_norep
    v_mov_b32 v11, s96
    buffer_store_dword v11, v8, s[52:55], s71 offen sc1
L_ctl_norep:
    s_barrier
    s_barrier
    s_barrier
    s_cmp_eq_u32 s63, 0
    s_cbranch_scc1 L_ctl_nold
    s_load_dwordx8 s[84:91], s[98:99], s71
L_ctl_nold:
    s_add_u32 s71, s71, 256
    s_cmp_lt_u32 s71, 16384
    s_cbranch_scc1 L_ctl_loop
    s_waitcnt lgkmcnt(0)
    s_mov_b64 exec, -1
    s_endpgm
L_consumer:
    v_lshrrev_b32 v3, 2, v1
    v_lshlrev_b32 v3, 3, v3
    v_and_b32 v4, 3, v1
    v_mul_u32_u24 v5, 384, v4
    v_add_u32 v153, v3, v5
    v_add_u32 v153, 155136, v153
    s_mov_b32 s64, 0x3fb8aa3b
    s_mov_b32 s65, 0x3d93cd3a
    s_mov_b32 s66, 0xffff0000
    v_bfe_u32 v36, v1, 2, 1
    v_lshl_add_u32 v36, v2, 2, v36
    v_bfe_u32 v37, v1, 3, 1
    v_lshrrev_b32 v38, 4, v1
    v_lshl_add_u32 v38, v38, 2, v4
    v_lshlrev_b32 v38, 3, v38
    v_add_u32 v38, 73728, v38
    s_movk_i32 s58, 384
    v_add_u32 v3, 0, v36
    v_cmp_le_u32 vcc, 43, v3
    v_add_u32 v5, 43, v3
    v_mov_b32 v6, 42
    v_cndmask_b32 v17, v3, v5, vcc
    v_cmp_le_u32 vcc, 86, v3
    v_add_u32 v5, 43, v17
    s_nop 0
    v_cndmask_b32 v17, v17, v5, vcc
    v_cndmask_b32 v6, 43, v6, vcc
    v_mad_u32_u24 v17, v6, v37, v17
    v_lshrrev_b32 v17, 6, v17
    v_mad_u32_u24 v17, v17, s58, v38
    v_add_u32 v3, 2, v36
    v_cmp_le_u32 vcc, 43, v3
    v_add_u32 v5, 43, v3
    v_mov_b32 v6, 42
    v_cndmask_b32 v18, v3, v5, vcc
    v_cmp_le_u32 vcc, 86, v3
    v_add_u32 v5, 43, v18
    s_nop 0
    v_cndmask_b32 v18, v18, v5, vcc
    v_cndmask_b32 v6, 43, v6, vcc
    v_mad_u32_u24 v18, v6, v37, v18
    v_lshrrev_b32 v18, 6, v18
    v_mad_u32_u24 v18, v18, s58, v38
    v_add_u32 v3, 16, v36
    v_cmp_le_u32 vcc, 43, v3
    v_add_u32 v5, 43, v3
    v_mov_b32 v6, 42
    v_cndmask_b32 v19, v3, v5, vcc
    v_cmp_le_u32 vcc, 86, v3
    v_add_u32 v5, 43, v19
    s_nop 0
    v_cndmask_b32 v19, v19, v5, vcc
    v_cndmask_b32 v6, 43, v6, vcc
    v_mad_u32_u24 v19, v6, v37, v19
    v_lshrrev_b32 v19, 6, v19
    v_mad_u32_u24 v19, v19, s58, v38
    v_add_u32 v3, 18, v36
    v_cmp_le_u32 vcc, 43, v3
    v_add_u32 v5, 43, v3
    v_mov_b32 v6, 42
    v_cndmask_b32 v20, v3, v5, vcc
    v_cmp_le_u32 vcc, 86, v3
    v_add_u32 v5, 43, v20
    s_nop 0
    v_cndmask_b32 v20, v20, v5, vcc
    v_cndmask_b32 v6, 43, v6, vcc
    v_mad_u32_u24 v20, v6, v37, v20
    v_lshrrev_b32 v20, 6, v20
    v_mad_u32_u24 v20, v20, s58, v38
    v_add_u32 v3, 32, v36
    v_cmp_le_u32 vcc, 43, v3
    v_add_u32 v5, 43, v3
    v_mov_b32 v6, 42
    v_cndmask_b32 v21, v3, v5, vcc
    v_cmp_le_u32 vcc, 86, v3
    v_add_u32 v5, 43, v21
    s_nop 0
    v_cndmask_b32 v21, v21, v5, vcc
    v_cndmask_b32 v6, 43, v6, vcc
    v_mad_u32_u24 v21, v6, v37, v21
    v_lshrrev_b32 v21, 6, v21
    v_mad_u32_u24 v21, v21, s58, v38
    v_add_u32 v3, 34, v36
    v_cmp_le_u32 vcc, 43, v3
    v_add_u32 v5, 43, v3
    v_mov_b32 v6, 42
    v_cndmask_b32 v22, v3, v5, vcc
    v_cmp_le_u32 vcc, 86, v3
    v_add_u32 v5, 43, v22
    s_nop 0
    v_cndmask_b32 v22, v22, v5, vcc
    v_cndmask_b32 v6, 43, v6, vcc
    v_mad_u32_u24 v22, v6, v37, v22
    v_lshrrev_b32 v22, 6, v22
    v_mad_u32_u24 v22, v22, s58, v38
    v_add_u32 v3, 48, v36
    v_cmp_le_u32 vcc, 43, v3
    v_add_u32 v5, 43, v3
    v_mov_b32 v6, 42
    v_cndmask_b32 v23, v3, v5, vcc
    v_cmp_le_u32 vcc, 86, v3
    v_add_u32 v5, 43, v23
    s_nop 0
    v_cndmask_b32 v23, v23, v5, vcc
    v_cndmask_b32 v6, 43, v6, vcc
    v_mad_u32_u24 v23, v6, v37, v23
    v_lshrrev_b32 v23, 6, v23
    v_mad_u32_u24 v23, v23, s58, v38
    v_add_u32 v3, 50, v36
    v_cmp_le_u32 vcc, 43, v3
    v_add_u32 v5, 43, v3
    v_mov_b32 v6, 42
    v_cndmask_b32 v24, v3, v5, vcc
    v_cmp_le_u32 vcc, 86, v3
    v_add_u32 v5, 43, v24
    s_nop 0
    v_cndmask_b32 v24, v24, v5, vcc
    v_cndmask_b32 v6, 43, v6, vcc
    v_mad_u32_u24 v24, v6, v37, v24
    v_lshrrev_b32 v24, 6, v24
    v_mad_u32_u24 v24, v24, s58, v38
    v_add_u32 v3, 64, v36
    v_cmp_le_u32 vcc, 43, v3
    v_add_u32 v5, 43, v3
    v_mov_b32 v6, 42
    v_cndmask_b32 v25, v3, v5, vcc
    v_cmp_le_u32 vcc, 86, v3
    v_add_u32 v5, 43, v25
    s_nop 0
    v_cndmask_b32 v25, v25, v5, vcc
    v_cndmask_b32 v6, 43, v6, vcc
    v_mad_u32_u24 v25, v6, v37, v25
    v_lshrrev_b32 v25, 6, v25
    v_mad_u32_u24 v25, v25, s58, v38
    v_add_u32 v3, 66, v36
    v_cmp_le_u32 vcc, 43, v3
    v_add_u32 v5, 43, v3
    v_mov_b32 v6, 42
    v_cndmask_b32 v26, v3, v5, vcc
    v_cmp_le_u32 vcc, 86, v3
    v_add_u32 v5, 43, v26
    s_nop 0
    v_cndmask_b32 v26, v26, v5, vcc
    v_cndmask_b32 v6, 43, v6, vcc
    v_mad_u32_u24 v26, v6, v37, v26
    v_lshrrev_b32 v26, 6, v26
    v_mad_u32_u24 v26, v26, s58, v38
    v_add_u32 v3, 80, v36
    v_cmp_le_u32 vcc, 43, v3
    v_add_u32 v5, 43, v3
    v_mov_b32 v6, 42
    v_cndmask_b32 v27, v3, v5, vcc
    v_cmp_le_u32 vcc, 86, v3
    v_add_u32 v5, 43, v27
    s_nop 0
    v_cndmask_b32 v27, v27, v5, vcc
    v_cndmask_b32 v6, 43, v6, vcc
    v_mad_u32_u24 v27, v6, v37, v27
    v_lshrrev_b32 v27, 6, v27
    v_mad_u32_u24 v27, v27, s58, v38
    v_add_u32 v3, 82, v36
    v_cmp_le_u32 vcc, 43, v3
    v_add_u32 v5, 43, v3
    v_mov_b32 v6, 42
    v_cndmask_b32 v28, v3, v5, vcc
    v_cmp_le_u32 vcc, 86, v3
    v_add_u32 v5, 43, v28
    s_nop 0
    v_cndmask_b32 v28, v28, v5, vcc
    v_cndmask_b32 v6, 43, v6, vcc
    v_mad_u32_u24 v28, v6, v37, v28
    v_lshrrev_b32 v28, 6, v28
    v_mad_u32_u24 v28, v28, s58, v38
    v_add_u32 v3, 96, v36
    v_cmp_le_u32 vcc, 43, v3
    v_add_u32 v5, 43, v3
    v_mov_b32 v6, 42
    v_cndmask_b32 v29, v3, v5, vcc
    v_cmp_le_u32 vcc, 86, v3
    v_add_u32 v5, 43, v29
    s_nop 0
    v_cndmask_b32 v29, v29, v5, vcc
    v_cndmask_b32 v6, 43, v6, vcc
    v_mad_u32_u24 v29, v6, v37, v29
    v_lshrrev_b32 v29, 6, v29
    v_mad_u32_u24 v29, v29, s58, v38
    v_add_u32 v3, 98, v36
    v_cmp_le_u32 vcc, 43, v3
    v_add_u32 v5, 43, v3
    v_mov_b32 v6, 42
    v_cndmask_b32 v30, v3, v5, vcc
    v_cmp_le_u32 vcc, 86, v3
    v_add_u32 v5, 43, v30
    s_nop 0
    v_cndmask_b32 v30, v30, v5, vcc
    v_cndmask_b32 v6, 43, v6, vcc
    v_mad_u32_u24 v30, v6, v37, v30
    v_lshrrev_b32 v30, 6, v30
    v_mad_u32_u24 v30, v30, s58, v38
    v_add_u32 v3, 112, v36
    v_cmp_le_u32 vcc, 43, v3
    v_add_u32 v5, 43, v3
    v_mov_b32 v6, 42
    v_cndmask_b32 v31, v3, v5, vcc
    v_cmp_le_u32 vcc, 86, v3
    v_add_u32 v5, 43, v31
    s_nop 0
    v_cndmask_b32 v31, v31, v5, vcc
    v_cndmask_b32 v6, 43, v6, vcc
    v_mad_u32_u24 v31, v6, v37, v31
    v_lshrrev_b32 v31, 6, v31
    v_mad_u32_u24 v31, v31, s58, v38
    v_add_u32 v3, 114, v36
    v_cmp_le_u32 vcc, 43, v3
    v_add_u32 v5, 43, v3
    v_mov_b32 v6, 42
    v_cndmask_b32 v32, v3, v5, vcc
    v_cmp_le_u32 vcc, 86, v3
    v_add_u32 v5, 43, v32
    s_nop 0
    v_cndmask_b32 v32, v32, v5, vcc
    v_cndmask_b32 v6, 43, v6, vcc
    v_mad_u32_u24 v32, v6, v37, v32
    v_lshrrev_b32 v32, 6, v32
    v_mad_u32_u24 v32, v32, s58, v38
    v_bfe_u32 v36, v1, 4, 1
    v_lshl_add_u32 v36, v2, 2, v36
    v_bfe_u32 v3, v1, 2, 2
    v_lshl_add_u32 v36, v3, 4, v36
    v_lshrrev_b32 v37, 5, v1
    s_mov_b32 s58, 125952
    v_add_u32 v3, 0, v36
    v_cmp_le_u32 vcc, 43, v3
    v_add_u32 v5, 43, v3
    v_mov_b32 v6, 42
    v_cndmask_b32 v7, v3, v5, vcc
    v_cmp_le_u32 vcc, 86, v3
    v_add_u32 v5, 43, v7
    s_nop 0
    v_cndmask_b32 v7, v7, v5, vcc
    v_cndmask_b32 v6, 43, v6, vcc
    v_mad_u32_u24 v7, v6, v37, v7
    v_lshl_add_u32 v7, v7, 1, s58
    v_add_u32 v3, 2, v36
    v_cmp_le_u32 vcc, 43, v3
    v_add_u32 v5, 43, v3
    v_mov_b32 v6, 42
    v_cndmask_b32 v8, v3, v5, vcc
    v_cmp_le_u32 vcc, 86, v3
    v_add_u32 v5, 43, v8
    s_nop 0
    v_cndmask_b32 v8, v8, v5, vcc
    v_cndmask_b32 v6, 43, v6, vcc
    v_mad_u32_u24 v8, v6, v37, v8
    v_lshl_add_u32 v8, v8, 1, s58
    v_add_u32 v3, 64, v36
    v_cmp_le_u32 vcc, 43, v3
    v_add_u32 v5, 43, v3
    v_mov_b32 v6, 42
    v_cndmask_b32 v9, v3, v5, vcc
    v_cmp_le_u32 vcc, 86, v3
    v_add_u32 v5, 43, v9
    s_nop 0
    v_cndmask_b32 v9, v9, v5, vcc
    v_cndmask_b32 v6, 43, v6, vcc
    v_mad_u32_u24 v9, v6, v37, v9
    v_lshl_add_u32 v9, v9, 1, s58
    v_add_u32 v3, 66, v36
    v_cmp_le_u32 vcc, 43, v3
    v_add_u32 v5, 43, v3
    v_mov_b32 v6, 42
    v_cndmask_b32 v10, v3, v5, vcc
    v_cmp_le_u32 vcc, 86, v3
    v_add_u32 v5, 43, v10
    s_nop 0
    v_cndmask_b32 v10, v10, v5, vcc
    v_cndmask_b32 v6, 43, v6, vcc
    v_mad_u32_u24 v10, v6, v37, v10
    v_lshl_add_u32 v10, v10, 1, s58
    v_lshlrev_b32 v11, 2, v1
    v_lshl_add_u32 v11, v2, 9, v11
    v_add_u32 v11, 73728, v11
    v_bfe_u32 v3, v1, 2, 2
    v_lshrrev_b32 v4, 4, v1
    v_and_b32 v5, 3, v1
    v_lshl_add_u32 v4, v4, 2, v5
    v_and_b32 v5, 2, v3
    v_add_u32 v3, v3, v5
    v_lshl_add_u32 v3, v2, 3, v3
    v_mul_u32_u24 v3, 768, v3
    v_lshl_add_u32 v12, v4, 4, v3
    v_and_b32 v3, 3, v1
    v_lshl_add_u32 v154, v3, 2, v2
    v_lshlrev_b32 v154, 2, v154
    v_add_u32 v154, 154944, v154
    v_mov_b32 v14, 0xff800000
    s_mov_b32 s61, 0
    s_mov_b32 s62, 0
    s_movk_i32 s63, 3072
    s_waitcnt vmcnt(0) lgkmcnt(0)
    s_barrier
    ds_read_b64 v[164:165], v153 offset:0
    ds_read_b64 v[166:167], v153 offset:128
    ds_read_b64 v[168:169], v153 offset:256
    v_add_u32 v153, 1536, v153
    v_add_u32 v33, s63, v17
    v_add_u32 v34, s63, v18
    ds_read_b64 v[108:109], v33 offset:0
    ds_read_b64 v[110:111], v33 offset:1536
    ds_read_b64 v[112:113], v33 offset:128
    ds_read_b64 v[114:115], v33 offset:1664
    ds_read_b64 v[116:117], v33 offset:256
    ds_read_b64 v[118:119], v33 offset:1792
    ds_read_b64 v[120:121], v34 offset:0
    ds_read_b64 v[122:123], v34 offset:1536
    ds_read_b64 v[124:125], v34 offset:128
    ds_read_b64 v[126:127], v34 offset:1664
    ds_read_b64 v[128:129], v34 offset:256
    ds_read_b64 v[130:131], v34 offset:1792
    s_waitcnt lgkmcnt(0)
    v_lshlrev_b32 v60, 16, v108
    v_and_b32 v61, s66, v108
    v_lshlrev_b32 v62, 16, v109
    v_and_b32 v63, s66, v109
    v_lshlrev_b32 v84, 16, v110
    v_and_b32 v85, s66, v110
    v_lshlrev_b32 v86, 16, v111
    v_and_b32 v87, s66, v111
    v_lshlrev_b32 v64, 16, v112
    v_and_b32 v65, s66, v112
    v_lshlrev_b32 v66, 16, v113
    v_and_b32 v67, s66, v113
    v_lshlrev_b32 v88, 16, v114
    v_and_b32 v89, s66, v114
    v_lshlrev_b32 v90, 16, v115
    v_and_b32 v91, s66, v115
    v_lshlrev_b32 v68, 16, v116
    v_and_b32 v69, s66, v116
    v_lshlrev_b32 v70, 16, v117
    v_and_b32 v71, s66, v117
    v_lshlrev_b32 v92, 16, v118
    v_and_b32 v93, s66, v118
    v_lshlrev_b32 v94, 16, v119
    v_and_b32 v95, s66, v119
    v_lshlrev_b32 v72, 16, v120
    v_and_b32 v73, s66, v120
    v_lshlrev_b32 v74, 16, v121
    v_and_b32 v75, s66, v121
    v_lshlrev_b32 v96, 16, v122
    v_and_b32 v97, s66, v122
    v_lshlrev_b32 v98, 16, v123
    v_and_b32 v99, s66, v123
    v_lshlrev_b32 v76, 16, v124
    v_and_b32 v77, s66, v124
    v_lshlrev_b32 v78, 16, v125
    v_and_b32 v79, s66, v125
    v_lshlrev_b32 v100, 16, v126
    v_and_b32 v101, s66, v126
    v_lshlrev_b32 v102, 16, v127
    v_and_b32 v103, s66, v127
    v_lshlrev_b32 v80, 16, v128
    v_and_b32 v81, s66, v128
    v_lshlrev_b32 v82, 16, v129
    v_and_b32 v83, s66, v129
    v_lshlrev_b32 v104, 16, v130
    v_and_b32 v105, s66, v130
    v_lshlrev_b32 v106, 16, v131
    v_and_b32 v107, s66, v131
L_kblk:
    v_add_u32 v13, s62, v12
    s_add_u32 s62, s62, 24576
    s_cmp_eq_u32 s62, 73728
    s_cselect_b32 s62, 0, s62
    s_barrier
    ds_read_b128 v[36:39], v13 offset:0
    ds_read_b128 v[40:43], v13 offset:256
    ds_read_b128 v[44:47], v13 offset:512
    ds_read_b128 v[48:51], v13 offset:1536
    ds_read_b128 v[52:55], v13 offset:1792
    ds_read_b128 v[56:59], v13 offset:2048
    s_waitcnt lgkmcnt(3)
    v_cvt_f32_i32 v36, v36
    v_cvt_f32_i32 v37, v37
    v_cvt_f32_i32 v38, v38
    v_cvt_f32_i32 v39, v39
    v_cvt_f32_i32 v40, v40
    v_cvt_f32_i32 v41, v41
    v_cvt_f32_i32 v42, v42
    v_cvt_f32_i32 v43, v43
    v_cvt_f32_i32 v44, v44
    v_cvt_f32_i32 v45, v45
    v_cvt_f32_i32 v46, v46
    v_cvt_f32_i32 v47, v47
    v_sub_f32 v36, v36, v60
    v_sub_f32 v37, v37, v61
    v_sub_f32 v38, v38, v62
    v_sub_f32 v39, v39, v63
    v_sub_f32 v40, v40, v64
    v_sub_f32 v41, v41, v65
    v_sub_f32 v42, v42, v66
    v_sub_f32 v43, v43, v67
    v_sub_f32 v44, v44, v68
    v_sub_f32 v45, v45, v69
    v_sub_f32 v46, v46, v70
    v_sub_f32 v47, v47, v71
    v_cvt_pk_bf16_f32 v36, 0, v36
    v_cvt_pk_bf16_f32 v37, 0, v37
    v_cvt_pk_bf16_f32 v38, 0, v38
    v_cvt_pk_bf16_f32 v39, 0, v39
    v_cvt_pk_bf16_f32 v40, 0, v40
    v_cvt_pk_bf16_f32 v41, 0, v41
    v_cvt_pk_bf16_f32 v42, 0, v42
    v_cvt_pk_bf16_f32 v43, 0, v43
    v_cvt_pk_bf16_f32 v44, 0, v44
    v_cvt_pk_bf16_f32 v45, 0, v45
    v_cvt_pk_bf16_f32 v46, 0, v46
    v_cvt_pk_bf16_f32 v47, 0, v47
    v_mul_f32 v36, v36, v84
    v_mul_f32 v37, v37, v85
    v_mul_f32 v38, v38, v86
    v_mul_f32 v39, v39, v87
    v_mul_f32 v40, v40, v88
    v_mul_f32 v41, v41, v89
    v_mul_f32 v42, v42, v90
    v_mul_f32 v43, v43, v91
    v_mul_f32 v44, v44, v92
    v_mul_f32 v45, v45, v93
    v_mul_f32 v46, v46, v94
    v_mul_f32 v47, v47, v95
    v_cvt_pk_bf16_f32 v132, v36, v37
    v_cvt_pk_bf16_f32 v133, v38, v39
    v_cvt_pk_bf16_f32 v134, v40, v41
    v_cvt_pk_bf16_f32 v135, v42, v43
    v_cvt_pk_bf16_f32 v136, v44, v45
    v_cvt_pk_bf16_f32 v137, v46, v47
    v_mfma_f32_16x16x16_bf16 v[144:147], v[132:133], v[164:165], 0
    v_mfma_f32_16x16x16_bf16 v[144:147], v[134:135], v[166:167], v[144:147]
    v_mfma_f32_16x16x16_bf16 v[144:147], v[136:137], v[168:169], v[144:147]
    s_waitcnt lgkmcnt(0)
    v_cvt_f32_i32 v48, v48
    v_cvt_f32_i32 v49, v49
    v_cvt_f32_i32 v50, v50
    v_cvt_f32_i32 v51, v51
    v_cvt_f32_i32 v52, v52
    v_cvt_f32_i32 v53, v53
    v_cvt_f32_i32 v54, v54
    v_cvt_f32_i32 v55, v55
    v_cvt_f32_i32 v56, v56
    v_cvt_f32_i32 v57, v57
    v_cvt_f32_i32 v58, v58
    v_cvt_f32_i32 v59, v59
    v_sub_f32 v48, v48, v72
    v_sub_f32 v49, v49, v73
    v_sub_f32 v50, v50, v74
    v_sub_f32 v51, v51, v75
    v_sub_f32 v52, v52, v76
    v_sub_f32 v53, v53, v77
    v_sub_f32 v54, v54, v78
    v_sub_f32 v55, v55, v79
    v_sub_f32 v56, v56, v80
    v_sub_f32 v57, v57, v81
    v_sub_f32 v58, v58, v82
    v_sub_f32 v59, v59, v83
    v_cvt_pk_bf16_f32 v48, 0, v48
    v_cvt_pk_bf16_f32 v49, 0, v49
    v_cvt_pk_bf16_f32 v50, 0, v50
    v_cvt_pk_bf16_f32 v51, 0, v51
    v_cvt_pk_bf16_f32 v52, 0, v52
    v_cvt_pk_bf16_f32 v53, 0, v53
    v_cvt_pk_bf16_f32 v54, 0, v54
    v_cvt_pk_bf16_f32 v55, 0, v55
    v_cvt_pk_bf16_f32 v56, 0, v56
    v_cvt_pk_bf16_f32 v57, 0, v57
    v_cvt_pk_bf16_f32 v58, 0, v58
    v_cvt_pk_bf16_f32 v59, 0, v59
    v_mul_f32 v48, v48, v96
    v_mul_f32 v49, v49, v97
    v_mul_f32 v50, v50, v98
    v_mul_f32 v51, v51, v99
    v_mul_f32 v52, v52, v100
    v_mul_f32 v53, v53, v101
    v_mul_f32 v54, v54, v102
    v_mul_f32 v55, v55, v103
    v_mul_f32 v56, v56, v104
    v_mul_f32 v57, v57, v105
    v_mul_f32 v58, v58, v106
    v_mul_f32 v59, v59, v107
    v_cvt_pk_bf16_f32 v138, v48, v49
    v_cvt_pk_bf16_f32 v139, v50, v51
    v_add_f32_dpp v3, v145, v144 row_ror:12 row_mask:0xf bank_mask:0xf
    v_cvt_pk_bf16_f32 v140, v52, v53
    v_cvt_pk_bf16_f32 v141, v54, v55
    v_add_f32_dpp v3, v146, v3 row_ror:8 row_mask:0xf bank_mask:0xf
    v_cvt_pk_bf16_f32 v142, v56, v57
    v_cvt_pk_bf16_f32 v143, v58, v59
    v_add_f32_dpp v15, v147, v3 row_ror:4 row_mask:0xf bank_mask:0x1
    v_mfma_f32_16x16x16_bf16 v[148:151], v[138:139], v[164:165], 0
    v_mfma_f32_16x16x16_bf16 v[148:151], v[140:141], v[166:167], v[148:151]
    v_mfma_f32_16x16x16_bf16 v[148:151], v[142:143], v[168:169], v[148:151]
    v_add_u32 v33, s63, v19
    v_add_u32 v34, s63, v20
    ds_read_b64 v[108:109], v33 offset:0
    ds_read_b64 v[110:111], v33 offset:1536
    ds_read_b64 v[112:113], v33 offset:128
    ds_read_b64 v[114:115], v33 offset:1664
    ds_read_b64 v[116:117], v33 offset:256
    ds_read_b64 v[118:119], v33 offset:1792
    ds_read_b64 v[120:121], v34 offset:0
    v_add_f32_dpp v4, v149, v148 row_ror:12 row_mask:0xf bank_mask:0xf
    ds_read_b64 v[122:123], v34 offset:1536
    ds_read_b64 v[124:125], v34 offset:128
    v_add_f32_dpp v4, v150, v4 row_ror:8 row_mask:0xf bank_mask:0xf
    ds_read_b64 v[126:127], v34 offset:1664
    ds_read_b64 v[128:129], v34 offset:256
    ds_read_b64 v[130:131], v34 offset:1792
    v_add_f32_dpp v16, v151, v4 row_ror:4 row_mask:0xf bank_mask:0x1
    s_waitcnt lgkmcnt(0)
    v_lshlrev_b32 v60, 16, v108
    v_and_b32 v61, s66, v108
    v_lshlrev_b32 v62, 16, v109
    v_and_b32 v63, s66, v109
    v_lshlrev_b32 v84, 16, v110
    v_and_b32 v85, s66, v110
    v_lshlrev_b32 v86, 16, v111
    v_and_b32 v87, s66, v111
    v_lshlrev_b32 v64, 16, v112
    v_and_b32 v65, s66, v112
    v_lshlrev_b32 v66, 16, v113
    v_and_b32 v67, s66, v113
    v_lshlrev_b32 v88, 16, v114
    v_and_b32 v89, s66, v114
    v_lshlrev_b32 v90, 16, v115
    v_and_b32 v91, s66, v115
    v_lshlrev_b32 v68, 16, v116
    v_and_b32 v69, s66, v116
    v_lshlrev_b32 v70, 16, v117
    v_and_b32 v71, s66, v117
    v_lshlrev_b32 v92, 16, v118
    v_and_b32 v93, s66, v118
    v_lshlrev_b32 v94, 16, v119
    v_and_b32 v95, s66, v119
    v_lshlrev_b32 v72, 16, v120
    v_and_b32 v73, s66, v120
    v_lshlrev_b32 v74, 16, v121
    v_and_b32 v75, s66, v121
    v_lshlrev_b32 v96, 16, v122
    v_and_b32 v97, s66, v122
    v_lshlrev_b32 v98, 16, v123
    v_and_b32 v99, s66, v123
    v_lshlrev_b32 v76, 16, v124
    v_and_b32 v77, s66, v124
    v_lshlrev_b32 v78, 16, v125
    v_and_b32 v79, s66, v125
    v_lshlrev_b32 v100, 16, v126
    v_and_b32 v101, s66, v126
    v_lshlrev_b32 v102, 16, v127
    v_and_b32 v103, s66, v127
    v_lshlrev_b32 v80, 16, v128
    v_and_b32 v81, s66, v128
    v_lshlrev_b32 v82, 16, v129
    v_and_b32 v83, s66, v129
    v_lshlrev_b32 v104, 16, v130
    v_and_b32 v105, s66, v130
    v_lshlrev_b32 v106, 16, v131
    v_and_b32 v107, s66, v131
    v_add_u32 v13, s62, v12
    s_add_u32 s62, s62, 24576
    s_cmp_eq_u32 s62, 73728
    s_cselect_b32 s62, 0, s62
    s_barrier
    ds_read_b128 v[36:39], v13 offset:0
    ds_read_b128 v[40:43], v13 offset:256
    ds_read_b128 v[44:47], v13 offset:512
    ds_read_b128 v[48:51], v13 offset:1536
    ds_read_b128 v[52:55], v13 offset:1792
    ds_read_b128 v[56:59], v13 offset:2048
    s_waitcnt lgkmcnt(3)
    v_cvt_f32_i32 v36, v36
    v_cvt_f32_i32 v37, v37
    v_cvt_f32_i32 v38, v38
    v_cvt_f32_i32 v39, v39
    v_cvt_f32_i32 v40, v40
    v_cvt_f32_i32 v41, v41
    v_cvt_f32_i32 v42, v42
    v_cvt_f32_i32 v43, v43
    v_cvt_f32_i32 v44, v44
    v_cvt_f32_i32 v45, v45
    v_cvt_f32_i32 v46, v46
    v_cvt_f32_i32 v47, v47
    v_sub_f32 v36, v36, v60
    v_sub_f32 v37, v37, v61
    v_sub_f32 v38, v38, v62
    v_sub_f32 v39, v39, v63
    v_sub_f32 v40, v40, v64
    v_sub_f32 v41, v41, v65
    v_sub_f32 v42, v42, v66
    v_sub_f32 v43, v43, v67
    v_sub_f32 v44, v44, v68
    v_sub_f32 v45, v45, v69
    v_sub_f32 v46, v46, v70
    v_sub_f32 v47, v47, v71
    v_cvt_pk_bf16_f32 v36, 0, v36
    v_cvt_pk_bf16_f32 v37, 0, v37
    v_cvt_pk_bf16_f32 v38, 0, v38
    v_cvt_pk_bf16_f32 v39, 0, v39
    v_cvt_pk_bf16_f32 v40, 0, v40
    v_cvt_pk_bf16_f32 v41, 0, v41
    v_cvt_pk_bf16_f32 v42, 0, v42
    v_cvt_pk_bf16_f32 v43, 0, v43
    v_cvt_pk_bf16_f32 v44, 0, v44
    v_cvt_pk_bf16_f32 v45, 0, v45
    v_cvt_pk_bf16_f32 v46, 0, v46
    v_cvt_pk_bf16_f32 v47, 0, v47
    v_mul_f32 v36, v36, v84
    v_mul_f32 v37, v37, v85
    v_mul_f32 v38, v38, v86
    v_mul_f32 v39, v39, v87
    v_mul_f32 v40, v40, v88
    v_mul_f32 v41, v41, v89
    v_mul_f32 v42, v42, v90
    v_mul_f32 v43, v43, v91
    v_mul_f32 v44, v44, v92
    v_mul_f32 v45, v45, v93
    v_mul_f32 v46, v46, v94
    v_mul_f32 v47, v47, v95
    v_cvt_pk_bf16_f32 v132, v36, v37
    v_cvt_pk_bf16_f32 v133, v38, v39
    v_cvt_pk_bf16_f32 v134, v40, v41
    v_cvt_pk_bf16_f32 v135, v42, v43
    v_cvt_pk_bf16_f32 v136, v44, v45
    v_cvt_pk_bf16_f32 v137, v46, v47
    v_mfma_f32_16x16x16_bf16 v[144:147], v[132:133], v[164:165], 0
    v_mfma_f32_16x16x16_bf16 v[144:147], v[134:135], v[166:167], v[144:147]
    v_mfma_f32_16x16x16_bf16 v[144:147], v[136:137], v[168:169], v[144:147]
    s_waitcnt lgkmcnt(0)
    v_cvt_f32_i32 v48, v48
    v_cvt_f32_i32 v49, v49
    v_cvt_f32_i32 v50, v50
    v_cvt_f32_i32 v51, v51
    v_cvt_f32_i32 v52, v52
    v_cvt_f32_i32 v53, v53
    v_cvt_f32_i32 v54, v54
    v_cvt_f32_i32 v55, v55
    v_cvt_f32_i32 v56, v56
    v_cvt_f32_i32 v57, v57
    v_cvt_f32_i32 v58, v58
    v_cvt_f32_i32 v59, v59
    v_sub_f32 v48, v48, v72
    v_sub_f32 v49, v49, v73
    v_sub_f32 v50, v50, v74
    v_sub_f32 v51, v51, v75
    v_sub_f32 v52, v52, v76
    v_sub_f32 v53, v53, v77
    v_sub_f32 v54, v54, v78
    v_sub_f32 v55, v55, v79
    v_sub_f32 v56, v56, v80
    v_sub_f32 v57, v57, v81
    v_sub_f32 v58, v58, v82
    v_sub_f32 v59, v59, v83
    v_cvt_pk_bf16_f32 v48, 0, v48
    v_cvt_pk_bf16_f32 v49, 0, v49
    v_cvt_pk_bf16_f32 v50, 0, v50
    v_cvt_pk_bf16_f32 v51, 0, v51
    v_cvt_pk_bf16_f32 v52, 0, v52
    v_cvt_pk_bf16_f32 v53, 0, v53
    v_cvt_pk_bf16_f32 v54, 0, v54
    v_cvt_pk_bf16_f32 v55, 0, v55
    v_cvt_pk_bf16_f32 v56, 0, v56
    v_cvt_pk_bf16_f32 v57, 0, v57
    v_cvt_pk_bf16_f32 v58, 0, v58
    v_cvt_pk_bf16_f32 v59, 0, v59
    v_mul_f32 v48, v48, v96
    v_mul_f32 v49, v49, v97
    v_mul_f32 v50, v50, v98
    v_mul_f32 v51, v51, v99
    v_mul_f32 v52, v52, v100
    v_mul_f32 v53, v53, v101
    v_mul_f32 v54, v54, v102
    v_mul_f32 v55, v55, v103
    v_mul_f32 v56, v56, v104
    v_mul_f32 v57, v57, v105
    v_mul_f32 v58, v58, v106
    v_mul_f32 v59, v59, v107
    v_cvt_pk_bf16_f32 v138, v48, v49
    v_cvt_pk_bf16_f32 v139, v50, v51
    v_add_f32_dpp v3, v146, v145 row_ror:12 row_mask:0xf bank_mask:0xf
    v_cvt_pk_bf16_f32 v140, v52, v53
    v_cvt_pk_bf16_f32 v141, v54, v55
    v_add_f32_dpp v3, v147, v3 row_ror:8 row_mask:0xf bank_mask:0xf
    v_cvt_pk_bf16_f32 v142, v56, v57
    v_cvt_pk_bf16_f32 v143, v58, v59
    v_add_f32_dpp v15, v144, v3 row_ror:4 row_mask:0xf bank_mask:0x2
    v_mfma_f32_16x16x16_bf16 v[148:151], v[138:139], v[164:165], 0
    v_mfma_f32_16x16x16_bf16 v[148:151], v[140:141], v[166:167], v[148:151]
    v_mfma_f32_16x16x16_bf16 v[148:151], v[142:143], v[168:169], v[148:151]
    v_add_u32 v33, s63, v21
    v_add_u32 v34, s63, v22
    ds_read_b64 v[108:109], v33 offset:0
    ds_read_b64 v[110:111], v33 offset:1536
    ds_read_b64 v[112:113], v33 offset:128
    ds_read_b64 v[114:115], v33 offset:1664
    ds_read_b64 v[116:117], v33 offset:256
    ds_read_b64 v[118:119], v33 offset:1792
    ds_read_b64 v[120:121], v34 offset:0
    v_add_f32_dpp v4, v150, v149 row_ror:12 row_mask:0xf bank_mask:0xf
    ds_read_b64 v[122:123], v34 offset:1536
    ds_read_b64 v[124:125], v34 offset:128
    v_add_f32_dpp v4, v151, v4 row_ror:8 row_mask:0xf bank_mask:0xf
    ds_read_b64 v[126:127], v34 offset:1664
    ds_read_b64 v[128:129], v34 offset:256
    ds_read_b64 v[130:131], v34 offset:1792
    v_add_f32_dpp v16, v148, v4 row_ror:4 row_mask:0xf bank_mask:0x2
    s_waitcnt lgkmcnt(0)
    v_lshlrev_b32 v60, 16, v108
    v_and_b32 v61, s66, v108
    v_lshlrev_b32 v62, 16, v109
    v_and_b32 v63, s66, v109
    v_lshlrev_b32 v84, 16, v110
    v_and_b32 v85, s66, v110
    v_lshlrev_b32 v86, 16, v111
    v_and_b32 v87, s66, v111
    v_lshlrev_b32 v64, 16, v112
    v_and_b32 v65, s66, v112
    v_lshlrev_b32 v66, 16, v113
    v_and_b32 v67, s66, v113
    v_lshlrev_b32 v88, 16, v114
    v_and_b32 v89, s66, v114
    v_lshlrev_b32 v90, 16, v115
    v_and_b32 v91, s66, v115
    v_lshlrev_b32 v68, 16, v116
    v_and_b32 v69, s66, v116
    v_lshlrev_b32 v70, 16, v117
    v_and_b32 v71, s66, v117
    v_lshlrev_b32 v92, 16, v118
    v_and_b32 v93, s66, v118
    v_lshlrev_b32 v94, 16, v119
    v_and_b32 v95, s66, v119
    v_lshlrev_b32 v72, 16, v120
    v_and_b32 v73, s66, v120
    v_lshlrev_b32 v74, 16, v121
    v_and_b32 v75, s66, v121
    v_lshlrev_b32 v96, 16, v122
    v_and_b32 v97, s66, v122
    v_lshlrev_b32 v98, 16, v123
    v_and_b32 v99, s66, v123
    v_lshlrev_b32 v76, 16, v124
    v_and_b32 v77, s66, v124
    v_lshlrev_b32 v78, 16, v125
    v_and_b32 v79, s66, v125
    v_lshlrev_b32 v100, 16, v126
    v_and_b32 v101, s66, v126
    v_lshlrev_b32 v102, 16, v127
    v_and_b32 v103, s66, v127
    v_lshlrev_b32 v80, 16, v128
    v_and_b32 v81, s66, v128
    v_lshlrev_b32 v82, 16, v129
    v_and_b32 v83, s66, v129
    v_lshlrev_b32 v104, 16, v130
    v_and_b32 v105, s66, v130
    v_lshlrev_b32 v106, 16, v131
    v_and_b32 v107, s66, v131
    v_add_u32 v13, s62, v12
    s_add_u32 s62, s62, 24576
    s_cmp_eq_u32 s62, 73728
    s_cselect_b32 s62, 0, s62
    s_barrier
    ds_read_b128 v[36:39], v13 offset:0
    ds_read_b128 v[40:43], v13 offset:256
    ds_read_b128 v[44:47], v13 offset:512
    ds_read_b128 v[48:51], v13 offset:1536
    ds_read_b128 v[52:55], v13 offset:1792
    ds_read_b128 v[56:59], v13 offset:2048
    s_waitcnt lgkmcnt(3)
    v_cvt_f32_i32 v36, v36
    v_cvt_f32_i32 v37, v37
    v_cvt_f32_i32 v38, v38
    v_cvt_f32_i32 v39, v39
    v_cvt_f32_i32 v40, v40
    v_cvt_f32_i32 v41, v41
    v_cvt_f32_i32 v42, v42
    v_cvt_f32_i32 v43, v43
    v_cvt_f32_i32 v44, v44
    v_cvt_f32_i32 v45, v45
    v_cvt_f32_i32 v46, v46
    v_cvt_f32_i32 v47, v47
    v_sub_f32 v36, v36, v60
    v_sub_f32 v37, v37, v61
    v_sub_f32 v38, v38, v62
    v_sub_f32 v39, v39, v63
    v_sub_f32 v40, v40, v64
    v_sub_f32 v41, v41, v65
    v_sub_f32 v42, v42, v66
    v_sub_f32 v43, v43, v67
    v_sub_f32 v44, v44, v68
    v_sub_f32 v45, v45, v69
    v_sub_f32 v46, v46, v70
    v_sub_f32 v47, v47, v71
    v_cvt_pk_bf16_f32 v36, 0, v36
    v_cvt_pk_bf16_f32 v37, 0, v37
    v_cvt_pk_bf16_f32 v38, 0, v38
    v_cvt_pk_bf16_f32 v39, 0, v39
    v_cvt_pk_bf16_f32 v40, 0, v40
    v_cvt_pk_bf16_f32 v41, 0, v41
    v_cvt_pk_bf16_f32 v42, 0, v42
    v_cvt_pk_bf16_f32 v43, 0, v43
    v_cvt_pk_bf16_f32 v44, 0, v44
    v_cvt_pk_bf16_f32 v45, 0, v45
    v_cvt_pk_bf16_f32 v46, 0, v46
    v_cvt_pk_bf16_f32 v47, 0, v47
    v_mul_f32 v36, v36, v84
    v_mul_f32 v37, v37, v85
    v_mul_f32 v38, v38, v86
    v_mul_f32 v39, v39, v87
    v_mul_f32 v40, v40, v88
    v_mul_f32 v41, v41, v89
    v_mul_f32 v42, v42, v90
    v_mul_f32 v43, v43, v91
    v_mul_f32 v44, v44, v92
    v_mul_f32 v45, v45, v93
    v_mul_f32 v46, v46, v94
    v_mul_f32 v47, v47, v95
    v_cvt_pk_bf16_f32 v132, v36, v37
    v_cvt_pk_bf16_f32 v133, v38, v39
    v_cvt_pk_bf16_f32 v134, v40, v41
    v_cvt_pk_bf16_f32 v135, v42, v43
    v_cvt_pk_bf16_f32 v136, v44, v45
    v_cvt_pk_bf16_f32 v137, v46, v47
    v_mfma_f32_16x16x16_bf16 v[144:147], v[132:133], v[164:165], 0
    v_mfma_f32_16x16x16_bf16 v[144:147], v[134:135], v[166:167], v[144:147]
    v_mfma_f32_16x16x16_bf16 v[144:147], v[136:137], v[168:169], v[144:147]
    s_waitcnt lgkmcnt(0)
    v_cvt_f32_i32 v48, v48
    v_cvt_f32_i32 v49, v49
    v_cvt_f32_i32 v50, v50
    v_cvt_f32_i32 v51, v51
    v_cvt_f32_i32 v52, v52
    v_cvt_f32_i32 v53, v53
    v_cvt_f32_i32 v54, v54
    v_cvt_f32_i32 v55, v55
    v_cvt_f32_i32 v56, v56
    v_cvt_f32_i32 v57, v57
    v_cvt_f32_i32 v58, v58
    v_cvt_f32_i32 v59, v59
    v_sub_f32 v48, v48, v72
    v_sub_f32 v49, v49, v73
    v_sub_f32 v50, v50, v74
    v_sub_f32 v51, v51, v75
    v_sub_f32 v52, v52, v76
    v_sub_f32 v53, v53, v77
    v_sub_f32 v54, v54, v78
    v_sub_f32 v55, v55, v79
    v_sub_f32 v56, v56, v80
    v_sub_f32 v57, v57, v81
    v_sub_f32 v58, v58, v82
    v_sub_f32 v59, v59, v83
    v_cvt_pk_bf16_f32 v48, 0, v48
    v_cvt_pk_bf16_f32 v49, 0, v49
    v_cvt_pk_bf16_f32 v50, 0, v50
    v_cvt_pk_bf16_f32 v51, 0, v51
    v_cvt_pk_bf16_f32 v52, 0, v52
    v_cvt_pk_bf16_f32 v53, 0, v53
    v_cvt_pk_bf16_f32 v54, 0, v54
    v_cvt_pk_bf16_f32 v55, 0, v55
    v_cvt_pk_bf16_f32 v56, 0, v56
    v_cvt_pk_bf16_f32 v57, 0, v57
    v_cvt_pk_bf16_f32 v58, 0, v58
    v_cvt_pk_bf16_f32 v59, 0, v59
    v_mul_f32 v48, v48, v96
    v_mul_f32 v49, v49, v97
    v_mul_f32 v50, v50, v98
    v_mul_f32 v51, v51, v99
    v_mul_f32 v52, v52, v100
    v_mul_f32 v53, v53, v101
    v_mul_f32 v54, v54, v102
    v_mul_f32 v55, v55, v103
    v_mul_f32 v56, v56, v104
    v_mul_f32 v57, v57, v105
    v_mul_f32 v58, v58, v106
    v_mul_f32 v59, v59, v107
    v_cvt_pk_bf16_f32 v138, v48, v49
    v_cvt_pk_bf16_f32 v139, v50, v51
    v_add_f32_dpp v3, v147, v146 row_ror:12 row_mask:0xf bank_mask:0xf
    v_cvt_pk_bf16_f32 v140, v52, v53
    v_cvt_pk_bf16_f32 v141, v54, v55
    v_add_f32_dpp v3, v144, v3 row_ror:8 row_mask:0xf bank_mask:0xf
    v_cvt_pk_bf16_f32 v142, v56, v57
    v_cvt_pk_bf16_f32 v143, v58, v59
    v_add_f32_dpp v15, v145, v3 row_ror:4 row_mask:0xf bank_mask:0x4
    v_mfma_f32_16x16x16_bf16 v[148:151], v[138:139], v[164:165], 0
    v_mfma_f32_16x16x16_bf16 v[148:151], v[140:141], v[166:167], v[148:151]
    v_mfma_f32_16x16x16_bf16 v[148:151], v[142:143], v[168:169], v[148:151]
    v_add_u32 v33, s63, v23
    v_add_u32 v34, s63, v24
    ds_read_b64 v[108:109], v33 offset:0
    ds_read_b64 v[110:111], v33 offset:1536
    ds_read_b64 v[112:113], v33 offset:128
    ds_read_b64 v[114:115], v33 offset:1664
    ds_read_b64 v[116:117], v33 offset:256
    ds_read_b64 v[118:119], v33 offset:1792
    ds_read_b64 v[120:121], v34 offset:0
    v_add_f32_dpp v4, v151, v150 row_ror:12 row_mask:0xf bank_mask:0xf
    ds_read_b64 v[122:123], v34 offset:1536
    ds_read_b64 v[124:125], v34 offset:128
    v_add_f32_dpp v4, v148, v4 row_ror:8 row_mask:0xf bank_mask:0xf
    ds_read_b64 v[126:127], v34 offset:1664
    ds_read_b64 v[128:129], v34 offset:256
    ds_read_b64 v[130:131], v34 offset:1792
    v_add_f32_dpp v16, v149, v4 row_ror:4 row_mask:0xf bank_mask:0x4
    s_waitcnt lgkmcnt(0)
    v_lshlrev_b32 v60, 16, v108
    v_and_b32 v61, s66, v108
    v_lshlrev_b32 v62, 16, v109
    v_and_b32 v63, s66, v109
    v_lshlrev_b32 v84, 16, v110
    v_and_b32 v85, s66, v110
    v_lshlrev_b32 v86, 16, v111
    v_and_b32 v87, s66, v111
    v_lshlrev_b32 v64, 16, v112
    v_and_b32 v65, s66, v112
    v_lshlrev_b32 v66, 16, v113
    v_and_b32 v67, s66, v113
    v_lshlrev_b32 v88, 16, v114
    v_and_b32 v89, s66, v114
    v_lshlrev_b32 v90, 16, v115
    v_and_b32 v91, s66, v115
    v_lshlrev_b32 v68, 16, v116
    v_and_b32 v69, s66, v116
    v_lshlrev_b32 v70, 16, v117
    v_and_b32 v71, s66, v117
    v_lshlrev_b32 v92, 16, v118
    v_and_b32 v93, s66, v118
    v_lshlrev_b32 v94, 16, v119
    v_and_b32 v95, s66, v119
    v_lshlrev_b32 v72, 16, v120
    v_and_b32 v73, s66, v120
    v_lshlrev_b32 v74, 16, v121
    v_and_b32 v75, s66, v121
    v_lshlrev_b32 v96, 16, v122
    v_and_b32 v97, s66, v122
    v_lshlrev_b32 v98, 16, v123
    v_and_b32 v99, s66, v123
    v_lshlrev_b32 v76, 16, v124
    v_and_b32 v77, s66, v124
    v_lshlrev_b32 v78, 16, v125
    v_and_b32 v79, s66, v125
    v_lshlrev_b32 v100, 16, v126
    v_and_b32 v101, s66, v126
    v_lshlrev_b32 v102, 16, v127
    v_and_b32 v103, s66, v127
    v_lshlrev_b32 v80, 16, v128
    v_and_b32 v81, s66, v128
    v_lshlrev_b32 v82, 16, v129
    v_and_b32 v83, s66, v129
    v_lshlrev_b32 v104, 16, v130
    v_and_b32 v105, s66, v130
    v_lshlrev_b32 v106, 16, v131
    v_and_b32 v107, s66, v131
    v_add_u32 v13, s62, v12
    s_add_u32 s62, s62, 24576
    s_cmp_eq_u32 s62, 73728
    s_cselect_b32 s62, 0, s62
    s_barrier
    ds_read_b128 v[36:39], v13 offset:0
    ds_read_b128 v[40:43], v13 offset:256
    ds_read_b128 v[44:47], v13 offset:512
    ds_read_b128 v[48:51], v13 offset:1536
    ds_read_b128 v[52:55], v13 offset:1792
    ds_read_b128 v[56:59], v13 offset:2048
    s_waitcnt lgkmcnt(3)
    v_cvt_f32_i32 v36, v36
    v_cvt_f32_i32 v37, v37
    v_cvt_f32_i32 v38, v38
    v_cvt_f32_i32 v39, v39
    v_cvt_f32_i32 v40, v40
    v_cvt_f32_i32 v41, v41
    v_cvt_f32_i32 v42, v42
    v_cvt_f32_i32 v43, v43
    v_cvt_f32_i32 v44, v44
    v_cvt_f32_i32 v45, v45
    v_cvt_f32_i32 v46, v46
    v_cvt_f32_i32 v47, v47
    v_sub_f32 v36, v36, v60
    v_sub_f32 v37, v37, v61
    v_sub_f32 v38, v38, v62
    v_sub_f32 v39, v39, v63
    v_sub_f32 v40, v40, v64
    v_sub_f32 v41, v41, v65
    v_sub_f32 v42, v42, v66
    v_sub_f32 v43, v43, v67
    v_sub_f32 v44, v44, v68
    v_sub_f32 v45, v45, v69
    v_sub_f32 v46, v46, v70
    v_sub_f32 v47, v47, v71
    v_cvt_pk_bf16_f32 v36, 0, v36
    v_cvt_pk_bf16_f32 v37, 0, v37
    v_cvt_pk_bf16_f32 v38, 0, v38
    v_cvt_pk_bf16_f32 v39, 0, v39
    v_cvt_pk_bf16_f32 v40, 0, v40
    v_cvt_pk_bf16_f32 v41, 0, v41
    v_cvt_pk_bf16_f32 v42, 0, v42
    v_cvt_pk_bf16_f32 v43, 0, v43
    v_cvt_pk_bf16_f32 v44, 0, v44
    v_cvt_pk_bf16_f32 v45, 0, v45
    v_cvt_pk_bf16_f32 v46, 0, v46
    v_cvt_pk_bf16_f32 v47, 0, v47
    v_mul_f32 v36, v36, v84
    v_mul_f32 v37, v37, v85
    v_mul_f32 v38, v38, v86
    v_mul_f32 v39, v39, v87
    v_mul_f32 v40, v40, v88
    v_mul_f32 v41, v41, v89
    v_mul_f32 v42, v42, v90
    v_mul_f32 v43, v43, v91
    v_mul_f32 v44, v44, v92
    v_mul_f32 v45, v45, v93
    v_mul_f32 v46, v46, v94
    v_mul_f32 v47, v47, v95
    v_cvt_pk_bf16_f32 v132, v36, v37
    v_cvt_pk_bf16_f32 v133, v38, v39
    v_cvt_pk_bf16_f32 v134, v40, v41
    v_cvt_pk_bf16_f32 v135, v42, v43
    v_cvt_pk_bf16_f32 v136, v44, v45
    v_cvt_pk_bf16_f32 v137, v46, v47
    v_mfma_f32_16x16x16_bf16 v[144:147], v[132:133], v[164:165], 0
    v_mfma_f32_16x16x16_bf16 v[144:147], v[134:135], v[166:167], v[144:147]
    v_mfma_f32_16x16x16_bf16 v[144:147], v[136:137], v[168:169], v[144:147]
    s_waitcnt lgkmcnt(0)
    v_cvt_f32_i32 v48, v48
    v_cvt_f32_i32 v49, v49
    v_cvt_f32_i32 v50, v50
    v_cvt_f32_i32 v51, v51
    v_cvt_f32_i32 v52, v52
    v_cvt_f32_i32 v53, v53
    v_cvt_f32_i32 v54, v54
    v_cvt_f32_i32 v55, v55
    v_cvt_f32_i32 v56, v56
    v_cvt_f32_i32 v57, v57
    v_cvt_f32_i32 v58, v58
    v_cvt_f32_i32 v59, v59
    v_sub_f32 v48, v48, v72
    v_sub_f32 v49, v49, v73
    v_sub_f32 v50, v50, v74
    v_sub_f32 v51, v51, v75
    v_sub_f32 v52, v52, v76
    v_sub_f32 v53, v53, v77
    v_sub_f32 v54, v54, v78
    v_sub_f32 v55, v55, v79
    v_sub_f32 v56, v56, v80
    v_sub_f32 v57, v57, v81
    v_sub_f32 v58, v58, v82
    v_sub_f32 v59, v59, v83
    v_cvt_pk_bf16_f32 v48, 0, v48
    v_cvt_pk_bf16_f32 v49, 0, v49
    v_cvt_pk_bf16_f32 v50, 0, v50
    v_cvt_pk_bf16_f32 v51, 0, v51
    v_cvt_pk_bf16_f32 v52, 0, v52
    v_cvt_pk_bf16_f32 v53, 0, v53
    v_cvt_pk_bf16_f32 v54, 0, v54
    v_cvt_pk_bf16_f32 v55, 0, v55
    v_cvt_pk_bf16_f32 v56, 0, v56
    v_cvt_pk_bf16_f32 v57, 0, v57
    v_cvt_pk_bf16_f32 v58, 0, v58
    v_cvt_pk_bf16_f32 v59, 0, v59
    v_mul_f32 v48, v48, v96
    v_mul_f32 v49, v49, v97
    v_mul_f32 v50, v50, v98
    v_mul_f32 v51, v51, v99
    v_mul_f32 v52, v52, v100
    v_mul_f32 v53, v53, v101
    v_mul_f32 v54, v54, v102
    v_mul_f32 v55, v55, v103
    v_mul_f32 v56, v56, v104
    v_mul_f32 v57, v57, v105
    v_mul_f32 v58, v58, v106
    v_mul_f32 v59, v59, v107
    v_cvt_pk_bf16_f32 v138, v48, v49
    v_cvt_pk_bf16_f32 v139, v50, v51
    v_add_f32_dpp v3, v144, v147 row_ror:12 row_mask:0xf bank_mask:0xf
    v_cvt_pk_bf16_f32 v140, v52, v53
    v_cvt_pk_bf16_f32 v141, v54, v55
    v_add_f32_dpp v3, v145, v3 row_ror:8 row_mask:0xf bank_mask:0xf
    v_cvt_pk_bf16_f32 v142, v56, v57
    v_cvt_pk_bf16_f32 v143, v58, v59
    v_add_f32_dpp v15, v146, v3 row_ror:4 row_mask:0xf bank_mask:0x8
    v_mfma_f32_16x16x16_bf16 v[148:151], v[138:139], v[164:165], 0
    v_mfma_f32_16x16x16_bf16 v[148:151], v[140:141], v[166:167], v[148:151]
    v_mfma_f32_16x16x16_bf16 v[148:151], v[142:143], v[168:169], v[148:151]
    v_add_u32 v33, s63, v25
    v_add_u32 v34, s63, v26
    ds_read_b64 v[108:109], v33 offset:0
    ds_read_b64 v[110:111], v33 offset:1536
    ds_read_b64 v[112:113], v33 offset:128
    ds_read_b64 v[114:115], v33 offset:1664
    ds_read_b64 v[116:117], v33 offset:256
    ds_read_b64 v[118:119], v33 offset:1792
    ds_read_b64 v[120:121], v34 offset:0
    v_add_f32_dpp v4, v148, v151 row_ror:12 row_mask:0xf bank_mask:0xf
    ds_read_b64 v[122:123], v34 offset:1536
    ds_read_b64 v[124:125], v34 offset:128
    v_add_f32_dpp v4, v149, v4 row_ror:8 row_mask:0xf bank_mask:0xf
    ds_read_b64 v[126:127], v34 offset:1664
    ds_read_b64 v[128:129], v34 offset:256
    ds_read_b64 v[130:131], v34 offset:1792
    v_add_f32_dpp v16, v150, v4 row_ror:4 row_mask:0xf bank_mask:0x8
    v_cvt_pk_bf16_f32 v3, 0, v15
    v_cvt_pk_bf16_f32 v4, 0, v16
    v_mul_f32 v3, s65, v3
    v_mul_f32 v4, s65, v4
    v_cvt_pk_bf16_f32 v5, v3, v4
    v_max3_f32 v14, v14, v3, v4
    ds_write_b32 v11, v5 offset:0
    s_waitcnt lgkmcnt(0)
    v_lshlrev_b32 v60, 16, v108
    v_and_b32 v61, s66, v108
    v_lshlrev_b32 v62, 16, v109
    v_and_b32 v63, s66, v109
    v_lshlrev_b32 v84, 16, v110
    v_and_b32 v85, s66, v110
    v_lshlrev_b32 v86, 16, v111
    v_and_b32 v87, s66, v111
    v_lshlrev_b32 v64, 16, v112
    v_and_b32 v65, s66, v112
    v_lshlrev_b32 v66, 16, v113
    v_and_b32 v67, s66, v113
    v_lshlrev_b32 v88, 16, v114
    v_and_b32 v89, s66, v114
    v_lshlrev_b32 v90, 16, v115
    v_and_b32 v91, s66, v115
    v_lshlrev_b32 v68, 16, v116
    v_and_b32 v69, s66, v116
    v_lshlrev_b32 v70, 16, v117
    v_and_b32 v71, s66, v117
    v_lshlrev_b32 v92, 16, v118
    v_and_b32 v93, s66, v118
    v_lshlrev_b32 v94, 16, v119
    v_and_b32 v95, s66, v119
    v_lshlrev_b32 v72, 16, v120
    v_and_b32 v73, s66, v120
    v_lshlrev_b32 v74, 16, v121
    v_and_b32 v75, s66, v121
    v_lshlrev_b32 v96, 16, v122
    v_and_b32 v97, s66, v122
    v_lshlrev_b32 v98, 16, v123
    v_and_b32 v99, s66, v123
    v_lshlrev_b32 v76, 16, v124
    v_and_b32 v77, s66, v124
    v_lshlrev_b32 v78, 16, v125
    v_and_b32 v79, s66, v125
    v_lshlrev_b32 v100, 16, v126
    v_and_b32 v101, s66, v126
    v_lshlrev_b32 v102, 16, v127
    v_and_b32 v103, s66, v127
    v_lshlrev_b32 v80, 16, v128
    v_and_b32 v81, s66, v128
    v_lshlrev_b32 v82, 16, v129
    v_and_b32 v83, s66, v129
    v_lshlrev_b32 v104, 16, v130
    v_and_b32 v105, s66, v130
    v_lshlrev_b32 v106, 16, v131
    v_and_b32 v107, s66, v131
    v_add_u32 v13, s62, v12
    s_add_u32 s62, s62, 24576
    s_cmp_eq_u32 s62, 73728
    s_cselect_b32 s62, 0, s62
    s_barrier
    ds_read_b128 v[36:39], v13 offset:0
    ds_read_b128 v[40:43], v13 offset:256
    ds_read_b128 v[44:47], v13 offset:512
    ds_read_b128 v[48:51], v13 offset:1536
    ds_read_b128 v[52:55], v13 offset:1792
    ds_read_b128 v[56:59], v13 offset:2048
    s_waitcnt lgkmcnt(3)
    v_cvt_f32_i32 v36, v36
    v_cvt_f32_i32 v37, v37
    v_cvt_f32_i32 v38, v38
    v_cvt_f32_i32 v39, v39
    v_cvt_f32_i32 v40, v40
    v_cvt_f32_i32 v41, v41
    v_cvt_f32_i32 v42, v42
    v_cvt_f32_i32 v43, v43
    v_cvt_f32_i32 v44, v44
    v_cvt_f32_i32 v45, v45
    v_cvt_f32_i32 v46, v46
    v_cvt_f32_i32 v47, v47
    v_sub_f32 v36, v36, v60
    v_sub_f32 v37, v37, v61
    v_sub_f32 v38, v38, v62
    v_sub_f32 v39, v39, v63
    v_sub_f32 v40, v40, v64
    v_sub_f32 v41, v41, v65
    v_sub_f32 v42, v42, v66
    v_sub_f32 v43, v43, v67
    v_sub_f32 v44, v44, v68
    v_sub_f32 v45, v45, v69
    v_sub_f32 v46, v46, v70
    v_sub_f32 v47, v47, v71
    v_cvt_pk_bf16_f32 v36, 0, v36
    v_cvt_pk_bf16_f32 v37, 0, v37
    v_cvt_pk_bf16_f32 v38, 0, v38
    v_cvt_pk_bf16_f32 v39, 0, v39
    v_cvt_pk_bf16_f32 v40, 0, v40
    v_cvt_pk_bf16_f32 v41, 0, v41
    v_cvt_pk_bf16_f32 v42, 0, v42
    v_cvt_pk_bf16_f32 v43, 0, v43
    v_cvt_pk_bf16_f32 v44, 0, v44
    v_cvt_pk_bf16_f32 v45, 0, v45
    v_cvt_pk_bf16_f32 v46, 0, v46
    v_cvt_pk_bf16_f32 v47, 0, v47
    v_mul_f32 v36, v36, v84
    v_mul_f32 v37, v37, v85
    v_mul_f32 v38, v38, v86
    v_mul_f32 v39, v39, v87
    v_mul_f32 v40, v40, v88
    v_mul_f32 v41, v41, v89
    v_mul_f32 v42, v42, v90
    v_mul_f32 v43, v43, v91
    v_mul_f32 v44, v44, v92
    v_mul_f32 v45, v45, v93
    v_mul_f32 v46, v46, v94
    v_mul_f32 v47, v47, v95
    v_cvt_pk_bf16_f32 v132, v36, v37
    v_cvt_pk_bf16_f32 v133, v38, v39
    v_cvt_pk_bf16_f32 v134, v40, v41
    v_cvt_pk_bf16_f32 v135, v42, v43
    v_cvt_pk_bf16_f32 v136, v44, v45
    v_cvt_pk_bf16_f32 v137, v46, v47
    v_mfma_f32_16x16x16_bf16 v[144:147], v[132:133], v[164:165], 0
    v_mfma_f32_16x16x16_bf16 v[144:147], v[134:135], v[166:167], v[144:147]
    v_mfma_f32_16x16x16_bf16 v[144:147], v[136:137], v[168:169], v[144:147]
    s_waitcnt lgkmcnt(0)
    v_cvt_f32_i32 v48, v48
    v_cvt_f32_i32 v49, v49
    v_cvt_f32_i32 v50, v50
    v_cvt_f32_i32 v51, v51
    v_cvt_f32_i32 v52, v52
    v_cvt_f32_i32 v53, v53
    v_cvt_f32_i32 v54, v54
    v_cvt_f32_i32 v55, v55
    v_cvt_f32_i32 v56, v56
    v_cvt_f32_i32 v57, v57
    v_cvt_f32_i32 v58, v58
    v_cvt_f32_i32 v59, v59
    v_sub_f32 v48, v48, v72
    v_sub_f32 v49, v49, v73
    v_sub_f32 v50, v50, v74
    v_sub_f32 v51, v51, v75
    v_sub_f32 v52, v52, v76
    v_sub_f32 v53, v53, v77
    v_sub_f32 v54, v54, v78
    v_sub_f32 v55, v55, v79
    v_sub_f32 v56, v56, v80
    v_sub_f32 v57, v57, v81
    v_sub_f32 v58, v58, v82
    v_sub_f32 v59, v59, v83
    v_cvt_pk_bf16_f32 v48, 0, v48
    v_cvt_pk_bf16_f32 v49, 0, v49
    v_cvt_pk_bf16_f32 v50, 0, v50
    v_cvt_pk_bf16_f32 v51, 0, v51
    v_cvt_pk_bf16_f32 v52, 0, v52
    v_cvt_pk_bf16_f32 v53, 0, v53
    v_cvt_pk_bf16_f32 v54, 0, v54
    v_cvt_pk_bf16_f32 v55, 0, v55
    v_cvt_pk_bf16_f32 v56, 0, v56
    v_cvt_pk_bf16_f32 v57, 0, v57
    v_cvt_pk_bf16_f32 v58, 0, v58
    v_cvt_pk_bf16_f32 v59, 0, v59
    v_mul_f32 v48, v48, v96
    v_mul_f32 v49, v49, v97
    v_mul_f32 v50, v50, v98
    v_mul_f32 v51, v51, v99
    v_mul_f32 v52, v52, v100
    v_mul_f32 v53, v53, v101
    v_mul_f32 v54, v54, v102
    v_mul_f32 v55, v55, v103
    v_mul_f32 v56, v56, v104
    v_mul_f32 v57, v57, v105
    v_mul_f32 v58, v58, v106
    v_mul_f32 v59, v59, v107
    v_cvt_pk_bf16_f32 v138, v48, v49
    v_cvt_pk_bf16_f32 v139, v50, v51
    v_add_f32_dpp v3, v145, v144 row_ror:12 row_mask:0xf bank_mask:0xf
    v_cvt_pk_bf16_f32 v140, v52, v53
    v_cvt_pk_bf16_f32 v141, v54, v55
    v_add_f32_dpp v3, v146, v3 row_ror:8 row_mask:0xf bank_mask:0xf
    v_cvt_pk_bf16_f32 v142, v56, v57
    v_cvt_pk_bf16_f32 v143, v58, v59
    v_add_f32_dpp v15, v147, v3 row_ror:4 row_mask:0xf bank_mask:0x1
    v_mfma_f32_16x16x16_bf16 v[148:151], v[138:139], v[164:165], 0
    v_mfma_f32_16x16x16_bf16 v[148:151], v[140:141], v[166:167], v[148:151]
    v_mfma_f32_16x16x16_bf16 v[148:151], v[142:143], v[168:169], v[148:151]
    v_add_u32 v33, s63, v27
    v_add_u32 v34, s63, v28
    ds_read_b64 v[108:109], v33 offset:0
    ds_read_b64 v[110:111], v33 offset:1536
    ds_read_b64 v[112:113], v33 offset:128
    ds_read_b64 v[114:115], v33 offset:1664
    ds_read_b64 v[116:117], v33 offset:256
    ds_read_b64 v[118:119], v33 offset:1792
    ds_read_b64 v[120:121], v34 offset:0
    v_add_f32_dpp v4, v149, v148 row_ror:12 row_mask:0xf bank_mask:0xf
    ds_read_b64 v[122:123], v34 offset:1536
    ds_read_b64 v[124:125], v34 offset:128
    v_add_f32_dpp v4, v150, v4 row_ror:8 row_mask:0xf bank_mask:0xf
    ds_read_b64 v[126:127], v34 offset:1664
    ds_read_b64 v[128:129], v34 offset:256
    ds_read_b64 v[130:131], v34 offset:1792
    v_add_f32_dpp v16, v151, v4 row_ror:4 row_mask:0xf bank_mask:0x1
    s_waitcnt lgkmcnt(0)
    v_lshlrev_b32 v60, 16, v108
    v_and_b32 v61, s66, v108
    v_lshlrev_b32 v62, 16, v109
    v_and_b32 v63, s66, v109
    v_lshlrev_b32 v84, 16, v110
    v_and_b32 v85, s66, v110
    v_lshlrev_b32 v86, 16, v111
    v_and_b32 v87, s66, v111
    v_lshlrev_b32 v64, 16, v112
    v_and_b32 v65, s66, v112
    v_lshlrev_b32 v66, 16, v113
    v_and_b32 v67, s66, v113
    v_lshlrev_b32 v88, 16, v114
    v_and_b32 v89, s66, v114
    v_lshlrev_b32 v90, 16, v115
    v_and_b32 v91, s66, v115
    v_lshlrev_b32 v68, 16, v116
    v_and_b32 v69, s66, v116
    v_lshlrev_b32 v70, 16, v117
    v_and_b32 v71, s66, v117
    v_lshlrev_b32 v92, 16, v118
    v_and_b32 v93, s66, v118
    v_lshlrev_b32 v94, 16, v119
    v_and_b32 v95, s66, v119
    v_lshlrev_b32 v72, 16, v120
    v_and_b32 v73, s66, v120
    v_lshlrev_b32 v74, 16, v121
    v_and_b32 v75, s66, v121
    v_lshlrev_b32 v96, 16, v122
    v_and_b32 v97, s66, v122
    v_lshlrev_b32 v98, 16, v123
    v_and_b32 v99, s66, v123
    v_lshlrev_b32 v76, 16, v124
    v_and_b32 v77, s66, v124
    v_lshlrev_b32 v78, 16, v125
    v_and_b32 v79, s66, v125
    v_lshlrev_b32 v100, 16, v126
    v_and_b32 v101, s66, v126
    v_lshlrev_b32 v102, 16, v127
    v_and_b32 v103, s66, v127
    v_lshlrev_b32 v80, 16, v128
    v_and_b32 v81, s66, v128
    v_lshlrev_b32 v82, 16, v129
    v_and_b32 v83, s66, v129
    v_lshlrev_b32 v104, 16, v130
    v_and_b32 v105, s66, v130
    v_lshlrev_b32 v106, 16, v131
    v_and_b32 v107, s66, v131
    v_add_u32 v13, s62, v12
    s_add_u32 s62, s62, 24576
    s_cmp_eq_u32 s62, 73728
    s_cselect_b32 s62, 0, s62
    s_barrier
    ds_read_b128 v[36:39], v13 offset:0
    ds_read_b128 v[40:43], v13 offset:256
    ds_read_b128 v[44:47], v13 offset:512
    ds_read_b128 v[48:51], v13 offset:1536
    ds_read_b128 v[52:55], v13 offset:1792
    ds_read_b128 v[56:59], v13 offset:2048
    s_waitcnt lgkmcnt(3)
    v_cvt_f32_i32 v36, v36
    v_cvt_f32_i32 v37, v37
    v_cvt_f32_i32 v38, v38
    v_cvt_f32_i32 v39, v39
    v_cvt_f32_i32 v40, v40
    v_cvt_f32_i32 v41, v41
    v_cvt_f32_i32 v42, v42
    v_cvt_f32_i32 v43, v43
    v_cvt_f32_i32 v44, v44
    v_cvt_f32_i32 v45, v45
    v_cvt_f32_i32 v46, v46
    v_cvt_f32_i32 v47, v47
    v_sub_f32 v36, v36, v60
    v_sub_f32 v37, v37, v61
    v_sub_f32 v38, v38, v62
    v_sub_f32 v39, v39, v63
    v_sub_f32 v40, v40, v64
    v_sub_f32 v41, v41, v65
    v_sub_f32 v42, v42, v66
    v_sub_f32 v43, v43, v67
    v_sub_f32 v44, v44, v68
    v_sub_f32 v45, v45, v69
    v_sub_f32 v46, v46, v70
    v_sub_f32 v47, v47, v71
    v_cvt_pk_bf16_f32 v36, 0, v36
    v_cvt_pk_bf16_f32 v37, 0, v37
    v_cvt_pk_bf16_f32 v38, 0, v38
    v_cvt_pk_bf16_f32 v39, 0, v39
    v_cvt_pk_bf16_f32 v40, 0, v40
    v_cvt_pk_bf16_f32 v41, 0, v41
    v_cvt_pk_bf16_f32 v42, 0, v42
    v_cvt_pk_bf16_f32 v43, 0, v43
    v_cvt_pk_bf16_f32 v44, 0, v44
    v_cvt_pk_bf16_f32 v45, 0, v45
    v_cvt_pk_bf16_f32 v46, 0, v46
    v_cvt_pk_bf16_f32 v47, 0, v47
    v_mul_f32 v36, v36, v84
    v_mul_f32 v37, v37, v85
    v_mul_f32 v38, v38, v86
    v_mul_f32 v39, v39, v87
    v_mul_f32 v40, v40, v88
    v_mul_f32 v41, v41, v89
    v_mul_f32 v42, v42, v90
    v_mul_f32 v43, v43, v91
    v_mul_f32 v44, v44, v92
    v_mul_f32 v45, v45, v93
    v_mul_f32 v46, v46, v94
    v_mul_f32 v47, v47, v95
    v_cvt_pk_bf16_f32 v132, v36, v37
    v_cvt_pk_bf16_f32 v133, v38, v39
    v_cvt_pk_bf16_f32 v134, v40, v41
    v_cvt_pk_bf16_f32 v135, v42, v43
    v_cvt_pk_bf16_f32 v136, v44, v45
    v_cvt_pk_bf16_f32 v137, v46, v47
    v_mfma_f32_16x16x16_bf16 v[144:147], v[132:133], v[164:165], 0
    v_mfma_f32_16x16x16_bf16 v[144:147], v[134:135], v[166:167], v[144:147]
    v_mfma_f32_16x16x16_bf16 v[144:147], v[136:137], v[168:169], v[144:147]
    s_waitcnt lgkmcnt(0)
    v_cvt_f32_i32 v48, v48
    v_cvt_f32_i32 v49, v49
    v_cvt_f32_i32 v50, v50
    v_cvt_f32_i32 v51, v51
    v_cvt_f32_i32 v52, v52
    v_cvt_f32_i32 v53, v53
    v_cvt_f32_i32 v54, v54
    v_cvt_f32_i32 v55, v55
    v_cvt_f32_i32 v56, v56
    v_cvt_f32_i32 v57, v57
    v_cvt_f32_i32 v58, v58
    v_cvt_f32_i32 v59, v59
    v_sub_f32 v48, v48, v72
    v_sub_f32 v49, v49, v73
    v_sub_f32 v50, v50, v74
    v_sub_f32 v51, v51, v75
    v_sub_f32 v52, v52, v76
    v_sub_f32 v53, v53, v77
    v_sub_f32 v54, v54, v78
    v_sub_f32 v55, v55, v79
    v_sub_f32 v56, v56, v80
    v_sub_f32 v57, v57, v81
    v_sub_f32 v58, v58, v82
    v_sub_f32 v59, v59, v83
    v_cvt_pk_bf16_f32 v48, 0, v48
    v_cvt_pk_bf16_f32 v49, 0, v49
    v_cvt_pk_bf16_f32 v50, 0, v50
    v_cvt_pk_bf16_f32 v51, 0, v51
    v_cvt_pk_bf16_f32 v52, 0, v52
    v_cvt_pk_bf16_f32 v53, 0, v53
    v_cvt_pk_bf16_f32 v54, 0, v54
    v_cvt_pk_bf16_f32 v55, 0, v55
    v_cvt_pk_bf16_f32 v56, 0, v56
    v_cvt_pk_bf16_f32 v57, 0, v57
    v_cvt_pk_bf16_f32 v58, 0, v58
    v_cvt_pk_bf16_f32 v59, 0, v59
    v_mul_f32 v48, v48, v96
    v_mul_f32 v49, v49, v97
    v_mul_f32 v50, v50, v98
    v_mul_f32 v51, v51, v99
    v_mul_f32 v52, v52, v100
    v_mul_f32 v53, v53, v101
    v_mul_f32 v54, v54, v102
    v_mul_f32 v55, v55, v103
    v_mul_f32 v56, v56, v104
    v_mul_f32 v57, v57, v105
    v_mul_f32 v58, v58, v106
    v_mul_f32 v59, v59, v107
    v_cvt_pk_bf16_f32 v138, v48, v49
    v_cvt_pk_bf16_f32 v139, v50, v51
    v_add_f32_dpp v3, v146, v145 row_ror:12 row_mask:0xf bank_mask:0xf
    v_cvt_pk_bf16_f32 v140, v52, v53
    v_cvt_pk_bf16_f32 v141, v54, v55
    v_add_f32_dpp v3, v147, v3 row_ror:8 row_mask:0xf bank_mask:0xf
    v_cvt_pk_bf16_f32 v142, v56, v57
    v_cvt_pk_bf16_f32 v143, v58, v59
    v_add_f32_dpp v15, v144, v3 row_ror:4 row_mask:0xf bank_mask:0x2
    v_mfma_f32_16x16x16_bf16 v[148:151], v[138:139], v[164:165], 0
    v_mfma_f32_16x16x16_bf16 v[148:151], v[140:141], v[166:167], v[148:151]
    v_mfma_f32_16x16x16_bf16 v[148:151], v[142:143], v[168:169], v[148:151]
    v_add_u32 v33, s63, v29
    v_add_u32 v34, s63, v30
    ds_read_b64 v[108:109], v33 offset:0
    ds_read_b64 v[110:111], v33 offset:1536
    ds_read_b64 v[112:113], v33 offset:128
    ds_read_b64 v[114:115], v33 offset:1664
    ds_read_b64 v[116:117], v33 offset:256
    ds_read_b64 v[118:119], v33 offset:1792
    ds_read_b64 v[120:121], v34 offset:0
    v_add_f32_dpp v4, v150, v149 row_ror:12 row_mask:0xf bank_mask:0xf
    ds_read_b64 v[122:123], v34 offset:1536
    ds_read_b64 v[124:125], v34 offset:128
    v_add_f32_dpp v4, v151, v4 row_ror:8 row_mask:0xf bank_mask:0xf
    ds_read_b64 v[126:127], v34 offset:1664
    ds_read_b64 v[128:129], v34 offset:256
    ds_read_b64 v[130:131], v34 offset:1792
    v_add_f32_dpp v16, v148, v4 row_ror:4 row_mask:0xf bank_mask:0x2
    s_waitcnt lgkmcnt(0)
    v_lshlrev_b32 v60, 16, v108
    v_and_b32 v61, s66, v108
    v_lshlrev_b32 v62, 16, v109
    v_and_b32 v63, s66, v109
    v_lshlrev_b32 v84, 16, v110
    v_and_b32 v85, s66, v110
    v_lshlrev_b32 v86, 16, v111
    v_and_b32 v87, s66, v111
    v_lshlrev_b32 v64, 16, v112
    v_and_b32 v65, s66, v112
    v_lshlrev_b32 v66, 16, v113
    v_and_b32 v67, s66, v113
    v_lshlrev_b32 v88, 16, v114
    v_and_b32 v89, s66, v114
    v_lshlrev_b32 v90, 16, v115
    v_and_b32 v91, s66, v115
    v_lshlrev_b32 v68, 16, v116
    v_and_b32 v69, s66, v116
    v_lshlrev_b32 v70, 16, v117
    v_and_b32 v71, s66, v117
    v_lshlrev_b32 v92, 16, v118
    v_and_b32 v93, s66, v118
    v_lshlrev_b32 v94, 16, v119
    v_and_b32 v95, s66, v119
    v_lshlrev_b32 v72, 16, v120
    v_and_b32 v73, s66, v120
    v_lshlrev_b32 v74, 16, v121
    v_and_b32 v75, s66, v121
    v_lshlrev_b32 v96, 16, v122
    v_and_b32 v97, s66, v122
    v_lshlrev_b32 v98, 16, v123
    v_and_b32 v99, s66, v123
    v_lshlrev_b32 v76, 16, v124
    v_and_b32 v77, s66, v124
    v_lshlrev_b32 v78, 16, v125
    v_and_b32 v79, s66, v125
    v_lshlrev_b32 v100, 16, v126
    v_and_b32 v101, s66, v126
    v_lshlrev_b32 v102, 16, v127
    v_and_b32 v103, s66, v127
    v_lshlrev_b32 v80, 16, v128
    v_and_b32 v81, s66, v128
    v_lshlrev_b32 v82, 16, v129
    v_and_b32 v83, s66, v129
    v_lshlrev_b32 v104, 16, v130
    v_and_b32 v105, s66, v130
    v_lshlrev_b32 v106, 16, v131
    v_and_b32 v107, s66, v131
    v_add_u32 v13, s62, v12
    s_add_u32 s62, s62, 24576
    s_cmp_eq_u32 s62, 73728
    s_cselect_b32 s62, 0, s62
    s_barrier
    ds_read_b128 v[36:39], v13 offset:0
    ds_read_b128 v[40:43], v13 offset:256
    ds_read_b128 v[44:47], v13 offset:512
    ds_read_b128 v[48:51], v13 offset:1536
    ds_read_b128 v[52:55], v13 offset:1792
    ds_read_b128 v[56:59], v13 offset:2048
    s_waitcnt lgkmcnt(3)
    v_cvt_f32_i32 v36, v36
    v_cvt_f32_i32 v37, v37
    v_cvt_f32_i32 v38, v38
    v_cvt_f32_i32 v39, v39
    v_cvt_f32_i32 v40, v40
    v_cvt_f32_i32 v41, v41
    v_cvt_f32_i32 v42, v42
    v_cvt_f32_i32 v43, v43
    v_cvt_f32_i32 v44, v44
    v_cvt_f32_i32 v45, v45
    v_cvt_f32_i32 v46, v46
    v_cvt_f32_i32 v47, v47
    v_sub_f32 v36, v36, v60
    v_sub_f32 v37, v37, v61
    v_sub_f32 v38, v38, v62
    v_sub_f32 v39, v39, v63
    v_sub_f32 v40, v40, v64
    v_sub_f32 v41, v41, v65
    v_sub_f32 v42, v42, v66
    v_sub_f32 v43, v43, v67
    v_sub_f32 v44, v44, v68
    v_sub_f32 v45, v45, v69
    v_sub_f32 v46, v46, v70
    v_sub_f32 v47, v47, v71
    v_cvt_pk_bf16_f32 v36, 0, v36
    v_cvt_pk_bf16_f32 v37, 0, v37
    v_cvt_pk_bf16_f32 v38, 0, v38
    v_cvt_pk_bf16_f32 v39, 0, v39
    v_cvt_pk_bf16_f32 v40, 0, v40
    v_cvt_pk_bf16_f32 v41, 0, v41
    v_cvt_pk_bf16_f32 v42, 0, v42
    v_cvt_pk_bf16_f32 v43, 0, v43
    v_cvt_pk_bf16_f32 v44, 0, v44
    v_cvt_pk_bf16_f32 v45, 0, v45
    v_cvt_pk_bf16_f32 v46, 0, v46
    v_cvt_pk_bf16_f32 v47, 0, v47
    v_mul_f32 v36, v36, v84
    v_mul_f32 v37, v37, v85
    v_mul_f32 v38, v38, v86
    v_mul_f32 v39, v39, v87
    v_mul_f32 v40, v40, v88
    v_mul_f32 v41, v41, v89
    v_mul_f32 v42, v42, v90
    v_mul_f32 v43, v43, v91
    v_mul_f32 v44, v44, v92
    v_mul_f32 v45, v45, v93
    v_mul_f32 v46, v46, v94
    v_mul_f32 v47, v47, v95
    v_cvt_pk_bf16_f32 v132, v36, v37
    v_cvt_pk_bf16_f32 v133, v38, v39
    v_cvt_pk_bf16_f32 v134, v40, v41
    v_cvt_pk_bf16_f32 v135, v42, v43
    v_cvt_pk_bf16_f32 v136, v44, v45
    v_cvt_pk_bf16_f32 v137, v46, v47
    v_mfma_f32_16x16x16_bf16 v[144:147], v[132:133], v[164:165], 0
    v_mfma_f32_16x16x16_bf16 v[144:147], v[134:135], v[166:167], v[144:147]
    v_mfma_f32_16x16x16_bf16 v[144:147], v[136:137], v[168:169], v[144:147]
    s_waitcnt lgkmcnt(0)
    v_cvt_f32_i32 v48, v48
    v_cvt_f32_i32 v49, v49
    v_cvt_f32_i32 v50, v50
    v_cvt_f32_i32 v51, v51
    v_cvt_f32_i32 v52, v52
    v_cvt_f32_i32 v53, v53
    v_cvt_f32_i32 v54, v54
    v_cvt_f32_i32 v55, v55
    v_cvt_f32_i32 v56, v56
    v_cvt_f32_i32 v57, v57
    v_cvt_f32_i32 v58, v58
    v_cvt_f32_i32 v59, v59
    v_sub_f32 v48, v48, v72
    v_sub_f32 v49, v49, v73
    v_sub_f32 v50, v50, v74
    v_sub_f32 v51, v51, v75
    v_sub_f32 v52, v52, v76
    v_sub_f32 v53, v53, v77
    v_sub_f32 v54, v54, v78
    v_sub_f32 v55, v55, v79
    v_sub_f32 v56, v56, v80
    v_sub_f32 v57, v57, v81
    v_sub_f32 v58, v58, v82
    v_sub_f32 v59, v59, v83
    v_cvt_pk_bf16_f32 v48, 0, v48
    v_cvt_pk_bf16_f32 v49, 0, v49
    v_cvt_pk_bf16_f32 v50, 0, v50
    v_cvt_pk_bf16_f32 v51, 0, v51
    v_cvt_pk_bf16_f32 v52, 0, v52
    v_cvt_pk_bf16_f32 v53, 0, v53
    v_cvt_pk_bf16_f32 v54, 0, v54
    v_cvt_pk_bf16_f32 v55, 0, v55
    v_cvt_pk_bf16_f32 v56, 0, v56
    v_cvt_pk_bf16_f32 v57, 0, v57
    v_cvt_pk_bf16_f32 v58, 0, v58
    v_cvt_pk_bf16_f32 v59, 0, v59
    v_mul_f32 v48, v48, v96
    v_mul_f32 v49, v49, v97
    v_mul_f32 v50, v50, v98
    v_mul_f32 v51, v51, v99
    v_mul_f32 v52, v52, v100
    v_mul_f32 v53, v53, v101
    v_mul_f32 v54, v54, v102
    v_mul_f32 v55, v55, v103
    v_mul_f32 v56, v56, v104
    v_mul_f32 v57, v57, v105
    v_mul_f32 v58, v58, v106
    v_mul_f32 v59, v59, v107
    v_cvt_pk_bf16_f32 v138, v48, v49
    v_cvt_pk_bf16_f32 v139, v50, v51
    v_add_f32_dpp v3, v147, v146 row_ror:12 row_mask:0xf bank_mask:0xf
    v_cvt_pk_bf16_f32 v140, v52, v53
    v_cvt_pk_bf16_f32 v141, v54, v55
    v_add_f32_dpp v3, v144, v3 row_ror:8 row_mask:0xf bank_mask:0xf
    v_cvt_pk_bf16_f32 v142, v56, v57
    v_cvt_pk_bf16_f32 v143, v58, v59
    v_add_f32_dpp v15, v145, v3 row_ror:4 row_mask:0xf bank_mask:0x4
    v_mfma_f32_16x16x16_bf16 v[148:151], v[138:139], v[164:165], 0
    v_mfma_f32_16x16x16_bf16 v[148:151], v[140:141], v[166:167], v[148:151]
    v_mfma_f32_16x16x16_bf16 v[148:151], v[142:143], v[168:169], v[148:151]
    v_add_u32 v33, s63, v31
    v_add_u32 v34, s63, v32
    ds_read_b64 v[108:109], v33 offset:0
    ds_read_b64 v[110:111], v33 offset:1536
    ds_read_b64 v[112:113], v33 offset:128
    ds_read_b64 v[114:115], v33 offset:1664
    ds_read_b64 v[116:117], v33 offset:256
    ds_read_b64 v[118:119], v33 offset:1792
    ds_read_b64 v[120:121], v34 offset:0
    v_add_f32_dpp v4, v151, v150 row_ror:12 row_mask:0xf bank_mask:0xf
    ds_read_b64 v[122:123], v34 offset:1536
    ds_read_b64 v[124:125], v34 offset:128
    v_add_f32_dpp v4, v148, v4 row_ror:8 row_mask:0xf bank_mask:0xf
    ds_read_b64 v[126:127], v34 offset:1664
    ds_read_b64 v[128:129], v34 offset:256
    ds_read_b64 v[130:131], v34 offset:1792
    v_add_f32_dpp v16, v149, v4 row_ror:4 row_mask:0xf bank_mask:0x4
    s_waitcnt lgkmcnt(0)
    v_lshlrev_b32 v60, 16, v108
    v_and_b32 v61, s66, v108
    v_lshlrev_b32 v62, 16, v109
    v_and_b32 v63, s66, v109
    v_lshlrev_b32 v84, 16, v110
    v_and_b32 v85, s66, v110
    v_lshlrev_b32 v86, 16, v111
    v_and_b32 v87, s66, v111
    v_lshlrev_b32 v64, 16, v112
    v_and_b32 v65, s66, v112
    v_lshlrev_b32 v66, 16, v113
    v_and_b32 v67, s66, v113
    v_lshlrev_b32 v88, 16, v114
    v_and_b32 v89, s66, v114
    v_lshlrev_b32 v90, 16, v115
    v_and_b32 v91, s66, v115
    v_lshlrev_b32 v68, 16, v116
    v_and_b32 v69, s66, v116
    v_lshlrev_b32 v70, 16, v117
    v_and_b32 v71, s66, v117
    v_lshlrev_b32 v92, 16, v118
    v_and_b32 v93, s66, v118
    v_lshlrev_b32 v94, 16, v119
    v_and_b32 v95, s66, v119
    v_lshlrev_b32 v72, 16, v120
    v_and_b32 v73, s66, v120
    v_lshlrev_b32 v74, 16, v121
    v_and_b32 v75, s66, v121
    v_lshlrev_b32 v96, 16, v122
    v_and_b32 v97, s66, v122
    v_lshlrev_b32 v98, 16, v123
    v_and_b32 v99, s66, v123
    v_lshlrev_b32 v76, 16, v124
    v_and_b32 v77, s66, v124
    v_lshlrev_b32 v78, 16, v125
    v_and_b32 v79, s66, v125
    v_lshlrev_b32 v100, 16, v126
    v_and_b32 v101, s66, v126
    v_lshlrev_b32 v102, 16, v127
    v_and_b32 v103, s66, v127
    v_lshlrev_b32 v80, 16, v128
    v_and_b32 v81, s66, v128
    v_lshlrev_b32 v82, 16, v129
    v_and_b32 v83, s66, v129
    v_lshlrev_b32 v104, 16, v130
    v_and_b32 v105, s66, v130
    v_lshlrev_b32 v106, 16, v131
    v_and_b32 v107, s66, v131
    v_add_u32 v13, s62, v12
    s_add_u32 s62, s62, 24576
    s_cmp_eq_u32 s62, 73728
    s_cselect_b32 s62, 0, s62
    s_barrier
    ds_read_b128 v[36:39], v13 offset:0
    ds_read_b128 v[40:43], v13 offset:256
    ds_read_b128 v[44:47], v13 offset:512
    ds_read_b128 v[48:51], v13 offset:1536
    ds_read_b128 v[52:55], v13 offset:1792
    ds_read_b128 v[56:59], v13 offset:2048
    s_waitcnt lgkmcnt(3)
    v_cvt_f32_i32 v36, v36
    v_cvt_f32_i32 v37, v37
    v_cvt_f32_i32 v38, v38
    v_cvt_f32_i32 v39, v39
    v_cvt_f32_i32 v40, v40
    v_cvt_f32_i32 v41, v41
    v_cvt_f32_i32 v42, v42
    v_cvt_f32_i32 v43, v43
    v_cvt_f32_i32 v44, v44
    v_cvt_f32_i32 v45, v45
    v_cvt_f32_i32 v46, v46
    v_cvt_f32_i32 v47, v47
    v_sub_f32 v36, v36, v60
    v_sub_f32 v37, v37, v61
    v_sub_f32 v38, v38, v62
    v_sub_f32 v39, v39, v63
    v_sub_f32 v40, v40, v64
    v_sub_f32 v41, v41, v65
    v_sub_f32 v42, v42, v66
    v_sub_f32 v43, v43, v67
    v_sub_f32 v44, v44, v68
    v_sub_f32 v45, v45, v69
    v_sub_f32 v46, v46, v70
    v_sub_f32 v47, v47, v71
    v_cvt_pk_bf16_f32 v36, 0, v36
    v_cvt_pk_bf16_f32 v37, 0, v37
    v_cvt_pk_bf16_f32 v38, 0, v38
    v_cvt_pk_bf16_f32 v39, 0, v39
    v_cvt_pk_bf16_f32 v40, 0, v40
    v_cvt_pk_bf16_f32 v41, 0, v41
    v_cvt_pk_bf16_f32 v42, 0, v42
    v_cvt_pk_bf16_f32 v43, 0, v43
    v_cvt_pk_bf16_f32 v44, 0, v44
    v_cvt_pk_bf16_f32 v45, 0, v45
    v_cvt_pk_bf16_f32 v46, 0, v46
    v_cvt_pk_bf16_f32 v47, 0, v47
    v_mul_f32 v36, v36, v84
    v_mul_f32 v37, v37, v85
    v_mul_f32 v38, v38, v86
    v_mul_f32 v39, v39, v87
    v_mul_f32 v40, v40, v88
    v_mul_f32 v41, v41, v89
    v_mul_f32 v42, v42, v90
    v_mul_f32 v43, v43, v91
    v_mul_f32 v44, v44, v92
    v_mul_f32 v45, v45, v93
    v_mul_f32 v46, v46, v94
    v_mul_f32 v47, v47, v95
    v_cvt_pk_bf16_f32 v132, v36, v37
    v_cvt_pk_bf16_f32 v133, v38, v39
    v_cvt_pk_bf16_f32 v134, v40, v41
    v_cvt_pk_bf16_f32 v135, v42, v43
    v_cvt_pk_bf16_f32 v136, v44, v45
    v_cvt_pk_bf16_f32 v137, v46, v47
    v_mfma_f32_16x16x16_bf16 v[144:147], v[132:133], v[164:165], 0
    v_mfma_f32_16x16x16_bf16 v[144:147], v[134:135], v[166:167], v[144:147]
    v_mfma_f32_16x16x16_bf16 v[144:147], v[136:137], v[168:169], v[144:147]
    s_waitcnt lgkmcnt(0)
    v_cvt_f32_i32 v48, v48
    v_cvt_f32_i32 v49, v49
    v_cvt_f32_i32 v50, v50
    v_cvt_f32_i32 v51, v51
    v_cvt_f32_i32 v52, v52
    v_cvt_f32_i32 v53, v53
    v_cvt_f32_i32 v54, v54
    v_cvt_f32_i32 v55, v55
    v_cvt_f32_i32 v56, v56
    v_cvt_f32_i32 v57, v57
    v_cvt_f32_i32 v58, v58
    v_cvt_f32_i32 v59, v59
    v_sub_f32 v48, v48, v72
    v_sub_f32 v49, v49, v73
    v_sub_f32 v50, v50, v74
    v_sub_f32 v51, v51, v75
    v_sub_f32 v52, v52, v76
    v_sub_f32 v53, v53, v77
    v_sub_f32 v54, v54, v78
    v_sub_f32 v55, v55, v79
    v_sub_f32 v56, v56, v80
    v_sub_f32 v57, v57, v81
    v_sub_f32 v58, v58, v82
    v_sub_f32 v59, v59, v83
    v_cvt_pk_bf16_f32 v48, 0, v48
    v_cvt_pk_bf16_f32 v49, 0, v49
    v_cvt_pk_bf16_f32 v50, 0, v50
    v_cvt_pk_bf16_f32 v51, 0, v51
    v_cvt_pk_bf16_f32 v52, 0, v52
    v_cvt_pk_bf16_f32 v53, 0, v53
    v_cvt_pk_bf16_f32 v54, 0, v54
    v_cvt_pk_bf16_f32 v55, 0, v55
    v_cvt_pk_bf16_f32 v56, 0, v56
    v_cvt_pk_bf16_f32 v57, 0, v57
    v_cvt_pk_bf16_f32 v58, 0, v58
    v_cvt_pk_bf16_f32 v59, 0, v59
    v_mul_f32 v48, v48, v96
    v_mul_f32 v49, v49, v97
    v_mul_f32 v50, v50, v98
    v_mul_f32 v51, v51, v99
    v_mul_f32 v52, v52, v100
    v_mul_f32 v53, v53, v101
    v_mul_f32 v54, v54, v102
    v_mul_f32 v55, v55, v103
    v_mul_f32 v56, v56, v104
    v_mul_f32 v57, v57, v105
    v_mul_f32 v58, v58, v106
    v_mul_f32 v59, v59, v107
    v_cvt_pk_bf16_f32 v138, v48, v49
    v_cvt_pk_bf16_f32 v139, v50, v51
    v_add_f32_dpp v3, v144, v147 row_ror:12 row_mask:0xf bank_mask:0xf
    v_cvt_pk_bf16_f32 v140, v52, v53
    v_cvt_pk_bf16_f32 v141, v54, v55
    v_add_f32_dpp v3, v145, v3 row_ror:8 row_mask:0xf bank_mask:0xf
    v_cvt_pk_bf16_f32 v142, v56, v57
    v_cvt_pk_bf16_f32 v143, v58, v59
    v_add_f32_dpp v15, v146, v3 row_ror:4 row_mask:0xf bank_mask:0x8
    v_mfma_f32_16x16x16_bf16 v[148:151], v[138:139], v[164:165], 0
    v_mfma_f32_16x16x16_bf16 v[148:151], v[140:141], v[166:167], v[148:151]
    v_mfma_f32_16x16x16_bf16 v[148:151], v[142:143], v[168:169], v[148:151]
    s_add_u32 s63, s63, 3072
    v_add_u32 v33, s63, v17
    v_add_u32 v34, s63, v18
    ds_read_b64 v[108:109], v33 offset:0
    ds_read_b64 v[110:111], v33 offset:1536
    ds_read_b64 v[112:113], v33 offset:128
    ds_read_b64 v[114:115], v33 offset:1664
    ds_read_b64 v[116:117], v33 offset:256
    ds_read_b64 v[118:119], v33 offset:1792
    ds_read_b64 v[120:121], v34 offset:0
    v_add_f32_dpp v4, v148, v151 row_ror:12 row_mask:0xf bank_mask:0xf
    ds_read_b64 v[122:123], v34 offset:1536
    ds_read_b64 v[124:125], v34 offset:128
    v_add_f32_dpp v4, v149, v4 row_ror:8 row_mask:0xf bank_mask:0xf
    ds_read_b64 v[126:127], v34 offset:1664
    ds_read_b64 v[128:129], v34 offset:256
    ds_read_b64 v[130:131], v34 offset:1792
    v_add_f32_dpp v16, v150, v4 row_ror:4 row_mask:0xf bank_mask:0x8
    v_cvt_pk_bf16_f32 v3, 0, v15
    v_cvt_pk_bf16_f32 v4, 0, v16
    v_mul_f32 v3, s65, v3
    v_mul_f32 v4, s65, v4
    v_cvt_pk_bf16_f32 v5, v3, v4
    v_max3_f32 v14, v14, v3, v4
    ds_write_b32 v11, v5 offset:256
    s_waitcnt lgkmcnt(0)
    v_lshlrev_b32 v60, 16, v108
    v_and_b32 v61, s66, v108
    v_lshlrev_b32 v62, 16, v109
    v_and_b32 v63, s66, v109
    v_lshlrev_b32 v84, 16, v110
    v_and_b32 v85, s66, v110
    v_lshlrev_b32 v86, 16, v111
    v_and_b32 v87, s66, v111
    v_lshlrev_b32 v64, 16, v112
    v_and_b32 v65, s66, v112
    v_lshlrev_b32 v66, 16, v113
    v_and_b32 v67, s66, v113
    v_lshlrev_b32 v88, 16, v114
    v_and_b32 v89, s66, v114
    v_lshlrev_b32 v90, 16, v115
    v_and_b32 v91, s66, v115
    v_lshlrev_b32 v68, 16, v116
    v_and_b32 v69, s66, v116
    v_lshlrev_b32 v70, 16, v117
    v_and_b32 v71, s66, v117
    v_lshlrev_b32 v92, 16, v118
    v_and_b32 v93, s66, v118
    v_lshlrev_b32 v94, 16, v119
    v_and_b32 v95, s66, v119
    v_lshlrev_b32 v72, 16, v120
    v_and_b32 v73, s66, v120
    v_lshlrev_b32 v74, 16, v121
    v_and_b32 v75, s66, v121
    v_lshlrev_b32 v96, 16, v122
    v_and_b32 v97, s66, v122
    v_lshlrev_b32 v98, 16, v123
    v_and_b32 v99, s66, v123
    v_lshlrev_b32 v76, 16, v124
    v_and_b32 v77, s66, v124
    v_lshlrev_b32 v78, 16, v125
    v_and_b32 v79, s66, v125
    v_lshlrev_b32 v100, 16, v126
    v_and_b32 v101, s66, v126
    v_lshlrev_b32 v102, 16, v127
    v_and_b32 v103, s66, v127
    v_lshlrev_b32 v80, 16, v128
    v_and_b32 v81, s66, v128
    v_lshlrev_b32 v82, 16, v129
    v_and_b32 v83, s66, v129
    v_lshlrev_b32 v104, 16, v130
    v_and_b32 v105, s66, v130
    v_lshlrev_b32 v106, 16, v131
    v_and_b32 v107, s66, v131
    v_add_u32 v11, 3072, v11
    s_add_u32 s61, s61, 1
    s_cmp_eq_u32 s61, s3
    s_cbranch_scc1 L_kblk_end
    s_cmp_eq_u32 s61, s73
    s_cbranch_scc1 L_kblk_end
    s_cmp_lt_u32 s61, 16
    s_cbranch_scc1 L_kblk
L_kblk_end:
    s_nop 1
    v_max_f32_dpp v14, v14, v14 row_ror:4 row_mask:0xf bank_mask:0xf
    s_nop 1
    v_max_f32_dpp v14, v14, v14 row_ror:8 row_mask:0xf bank_mask:0xf
    v_mov_b32 v3, v14
    s_nop 1
    v_permlane16_swap_b32 v14, v3
    v_max_f32 v14, v14, v3
    v_mov_b32 v3, v14
    s_nop 1
    v_permlane32_swap_b32 v14, v3
    v_max_f32 v14, v14, v3
    v_cvt_pk_bf16_f32 v14, 0, v14
    v_mul_f32 v14, s64, v14
    ds_write_b32 v154, v14
    v_add_u32 v154, 64, v154
    ds_read_b64 v[164:165], v153 offset:0
    ds_read_b64 v[166:167], v153 offset:128
    ds_read_b64 v[168:169], v153 offset:256
    v_add_u32 v153, 1536, v153
    v_mov_b32 v14, 0xff800000
    s_waitcnt lgkmcnt(0)
    s_cmp_lt_u32 s61, 16
    s_cbranch_scc1 L_kblk
    v_lshrrev_b32 v3, 4, v1
    v_and_b32 v4, 15, v1
    v_and_b32 v5, 2, v3
    v_add_u32 v3, v3, v5
    v_lshl_add_u32 v3, v2, 3, v3
    v_mul_u32_u24 v3, 768, v3
    v_lshl_add_u32 v12, v4, 4, v3
    v_subrev_u32 v11, 49152, v11
    s_mov_b32 s63, 0
    v_add_u32 v215, s63, v7
    v_add_u32 v216, s63, v8
    ds_read_b32 v214, v11 offset:0
    ds_read_u16 v217, v215 offset:512
    ds_read_u16 v218, v216 offset:512
    ds_read_u16 v215, v215
    ds_read_u16 v216, v216
    v_mov_b32 v188, 0
    v_mov_b32 v189, 0
    v_mov_b32 v190, 0
    v_mov_b32 v191, 0
    v_mov_b32 v192, 0
    v_mov_b32 v193, 0
    v_mov_b32 v194, 0
    v_mov_b32 v195, 0
    v_mov_b32 v196, 0
    v_mov_b32 v197, 0
    v_mov_b32 v198, 0
    v_mov_b32 v199, 0
    v_mov_b32 v200, 0
    v_mov_b32 v201, 0
    v_mov_b32 v202, 0
    v_mov_b32 v203, 0
    s_mov_b32 s61, 0
    v_and_b32 v3, 3, v1
    v_lshlrev_b32 v20, 4, v3
    v_add_u32 v154, 154944, v20
    v_add_u32 v18, 142336, v20
    v_lshl_add_u32 v156, v2, 6, v18
    v_lshl_add_u32 v20, v2, 6, v20
    v_add_u32 v20, 3072, v20
    v_mul_u32_u24 v155, 3072, v2
    v_lshl_add_u32 v155, v1, 4, v155
    v_add_u32 v155, 142592, v155
    v_lshlrev_b32 v4, 10, v2
    v_lshl_add_u32 v19, v1, 4, v4
    v_lshl_add_u32 v17, v1, 2, v4
    v_add_u32 v17, 142592, v17
    v_mul_u32_u24 v21, 384, v3
    v_lshrrev_b32 v4, 2, v1
    v_lshl_add_u32 v21, v4, 3, v21
    v_lshl_add_u32 v21, v2, 7, v21
    s_mov_b32 s48, s18
    s_and_b32 s49, s19, 0xffff
    s_mov_b32 s50, 393216
    s_mov_b32 s51, 0x20000
    s_mov_b32 s24, s22
    s_and_b32 s25, s23, 0xffff
    s_mov_b32 s26, 848640
    s_mov_b32 s27, 0x20000
    s_mul_i32 s68, s100, 9984
    s_mul_i32 s71, s2, 3328
    s_add_u32 s69, s68, 3328
    s_add_u32 s70, s68, 6656
    s_sub_u32 s57, 255, s100
    s_mul_i32 s57, s57, 1536
    s_mov_b32 s84, 0x7060500
    s_mov_b32 s85, 0x7060501
    s_mov_b32 s86, 0x7060502
    s_mov_b32 s87, 0x7060503
    s_mov_b32 s88, 0x0c0c0400
    s_mov_b32 s89, 0x04000c0c
    s_mov_b32 s90, 0xffffff00
L_vround:
    v_mov_b32 v164, 0
    v_mov_b32 v165, 0
    v_mov_b32 v166, 0
    v_mov_b32 v167, 0
    v_mov_b32 v168, 0
    v_mov_b32 v169, 0
    v_mov_b32 v170, 0
    v_mov_b32 v171, 0
    v_mov_b32 v172, 0
    v_mov_b32 v173, 0
    v_mov_b32 v174, 0
    v_mov_b32 v175, 0
    v_mov_b32 v212, 0
    v_mov_b32 v213, 0
L_vblk:
    s_add_u32 s61, s61, 1
    s_cmp_eq_u32 s61, s3
    s_cselect_b32 s74, 1, 0
    s_cmp_eq_u32 s61, s73
    s_cselect_b32 s74, 1, s74
    s_cmp_eq_u32 s61, 16
    s_cselect_b32 s74, 1, s74
    v_add_u32 v13, s62, v12
    s_add_u32 s62, s62, 24576
    s_cmp_eq_u32 s62, 73728
    s_cselect_b32 s62, 0, s62
    s_barrier
    ds_read_b128 v[160:163], v154
    ds_read_b128 v[36:39], v13 offset:0
    ds_read_b128 v[48:51], v13 offset:1536
    ds_read_b128 v[40:43], v13 offset:256
    ds_read_b128 v[52:55], v13 offset:1792
    ds_read_b128 v[44:47], v13 offset:512
    ds_read_b128 v[56:59], v13 offset:2048
    s_waitcnt lgkmcnt(6)
    v_max_f32 v14, v160, v161
    v_max3_f32 v14, v14, v162, v163
    s_waitcnt lgkmcnt(6)
    v_lshlrev_b32 v219, 16, v214
    v_and_b32 v220, s66, v214
    v_fma_f32 v219, v219, s64, -v14
    v_fma_f32 v220, v220, s64, -v14
    v_exp_f32 v219, v219
    v_exp_f32 v220, v220
    v_lshlrev_b32 v221, 16, v215
    v_lshlrev_b32 v222, 16, v216
    v_mul_f32 v221, v219, v221
    v_mul_f32 v222, v220, v222
    v_add_f32 v212, v212, v219
    v_cvt_pk_bf16_f32 v221, v221, v222
    v_add_f32 v212, v212, v220
    v_lshlrev_b32 v223, 16, v217
    v_lshlrev_b32 v224, 16, v218
    v_lshlrev_b32 v219, 16, v221
    v_and_b32 v220, s66, v221
    v_fmac_f32 v213, v219, v223
    v_fmac_f32 v213, v220, v224
    v_mov_b32_dpp v188, v221 quad_perm:[0,1,2,3] row_mask:0xf bank_mask:0x1
    v_mov_b32_dpp v189, v221 row_ror:12 row_mask:0xf bank_mask:0x1
    v_mov_b32_dpp v190, v221 row_ror:8 row_mask:0xf bank_mask:0x1
    v_mov_b32_dpp v191, v221 row_ror:4 row_mask:0xf bank_mask:0x1
    v_mov_b32_dpp v192, v221 row_ror:4 row_mask:0xf bank_mask:0x2
    v_mov_b32_dpp v193, v221 quad_perm:[0,1,2,3] row_mask:0xf bank_mask:0x2
    v_mov_b32_dpp v194, v221 row_ror:12 row_mask:0xf bank_mask:0x2
    v_mov_b32_dpp v195, v221 row_ror:8 row_mask:0xf bank_mask:0x2
    v_mov_b32_dpp v196, v221 row_ror:8 row_mask:0xf bank_mask:0x4
    v_mov_b32_dpp v197, v221 row_ror:4 row_mask:0xf bank_mask:0x4
    v_mov_b32_dpp v198, v221 quad_perm:[0,1,2,3] row_mask:0xf bank_mask:0x4
    v_mov_b32_dpp v199, v221 row_ror:12 row_mask:0xf bank_mask:0x4
    v_mov_b32_dpp v200, v221 row_ror:12 row_mask:0xf bank_mask:0x8
    v_mov_b32_dpp v201, v221 row_ror:8 row_mask:0xf bank_mask:0x8
    v_mov_b32_dpp v202, v221 row_ror:4 row_mask:0xf bank_mask:0x8
    v_mov_b32_dpp v203, v221 quad_perm:[0,1,2,3] row_mask:0xf bank_mask:0x8
    s_waitcnt lgkmcnt(4)
    v_cvt_f32_i32 v36, v36
    v_cvt_f32_i32 v37, v37
    v_cvt_f32_i32 v38, v38
    v_cvt_f32_i32 v39, v39
    v_cvt_f32_i32 v48, v48
    v_cvt_f32_i32 v49, v49
    v_cvt_f32_i32 v50, v50
    v_cvt_f32_i32 v51, v51
    v_cvt_pk_bf16_f32 v60, v36, v48
    v_cvt_pk_bf16_f32 v64, v37, v49
    v_cvt_pk_bf16_f32 v68, v38, v50
    v_cvt_pk_bf16_f32 v72, v39, v51
    s_waitcnt lgkmcnt(2)
    v_cvt_f32_i32 v40, v40
    v_cvt_f32_i32 v41, v41
    v_cvt_f32_i32 v42, v42
    v_cvt_f32_i32 v43, v43
    v_cvt_f32_i32 v52, v52
    v_cvt_f32_i32 v53, v53
    v_cvt_f32_i32 v54, v54
    v_cvt_f32_i32 v55, v55
    v_cvt_pk_bf16_f32 v76, v40, v52
    v_cvt_pk_bf16_f32 v80, v41, v53
    v_cvt_pk_bf16_f32 v84, v42, v54
    v_cvt_pk_bf16_f32 v88, v43, v55
    s_waitcnt lgkmcnt(0)
    v_cvt_f32_i32 v44, v44
    v_cvt_f32_i32 v45, v45
    v_cvt_f32_i32 v46, v46
    v_cvt_f32_i32 v47, v47
    v_cvt_f32_i32 v56, v56
    v_cvt_f32_i32 v57, v57
    v_cvt_f32_i32 v58, v58
    v_cvt_f32_i32 v59, v59
    v_cvt_pk_bf16_f32 v92, v44, v56
    v_cvt_pk_bf16_f32 v96, v45, v57
    v_cvt_pk_bf16_f32 v100, v46, v58
    v_cvt_pk_bf16_f32 v104, v47, v59
    v_add_u32 v215, s63, v9
    v_add_u32 v216, s63, v10
    ds_read_b32 v214, v11 offset:256
    ds_read_u16 v217, v215 offset:512
    ds_read_u16 v218, v216 offset:512
    ds_read_u16 v215, v215
    ds_read_u16 v216, v216
    v_add_u32 v13, s62, v12
    s_add_u32 s62, s62, 24576
    s_cmp_eq_u32 s62, 73728
    s_cselect_b32 s62, 0, s62
    s_barrier
    ds_read_b128 v[36:39], v13 offset:0
    ds_read_b128 v[48:51], v13 offset:1536
    ds_read_b128 v[40:43], v13 offset:256
    ds_read_b128 v[52:55], v13 offset:1792
    ds_read_b128 v[44:47], v13 offset:512
    ds_read_b128 v[56:59], v13 offset:2048
    s_waitcnt lgkmcnt(4)
    v_cvt_f32_i32 v36, v36
    v_cvt_f32_i32 v37, v37
    v_cvt_f32_i32 v38, v38
    v_cvt_f32_i32 v39, v39
    v_cvt_f32_i32 v48, v48
    v_cvt_f32_i32 v49, v49
    v_cvt_f32_i32 v50, v50
    v_cvt_f32_i32 v51, v51
    v_cvt_pk_bf16_f32 v61, v36, v48
    v_cvt_pk_bf16_f32 v65, v37, v49
    v_cvt_pk_bf16_f32 v69, v38, v50
    v_cvt_pk_bf16_f32 v73, v39, v51
    s_waitcnt lgkmcnt(2)
    v_cvt_f32_i32 v40, v40
    v_cvt_f32_i32 v41, v41
    v_cvt_f32_i32 v42, v42
    v_cvt_f32_i32 v43, v43
    v_cvt_f32_i32 v52, v52
    v_cvt_f32_i32 v53, v53
    v_cvt_f32_i32 v54, v54
    v_cvt_f32_i32 v55, v55
    v_cvt_pk_bf16_f32 v77, v40, v52
    v_cvt_pk_bf16_f32 v81, v41, v53
    v_cvt_pk_bf16_f32 v85, v42, v54
    v_cvt_pk_bf16_f32 v89, v43, v55
    s_waitcnt lgkmcnt(0)
    v_cvt_f32_i32 v44, v44
    v_cvt_f32_i32 v45, v45
    v_cvt_f32_i32 v46, v46
    v_cvt_f32_i32 v47, v47
    v_cvt_f32_i32 v56, v56
    v_cvt_f32_i32 v57, v57
    v_cvt_f32_i32 v58, v58
    v_cvt_f32_i32 v59, v59
    v_cvt_pk_bf16_f32 v93, v44, v56
    v_cvt_pk_bf16_f32 v97, v45, v57
    v_cvt_pk_bf16_f32 v101, v46, v58
    v_cvt_pk_bf16_f32 v105, v47, v59
    v_add_u32 v13, s62, v12
    s_add_u32 s62, s62, 24576
    s_cmp_eq_u32 s62, 73728
    s_cselect_b32 s62, 0, s62
    s_barrier
    ds_read_b128 v[36:39], v13 offset:0
    ds_read_b128 v[48:51], v13 offset:1536
    ds_read_b128 v[40:43], v13 offset:256
    ds_read_b128 v[52:55], v13 offset:1792
    ds_read_b128 v[44:47], v13 offset:512
    ds_read_b128 v[56:59], v13 offset:2048
    s_waitcnt lgkmcnt(4)
    v_cvt_f32_i32 v36, v36
    v_cvt_f32_i32 v37, v37
    v_cvt_f32_i32 v38, v38
    v_cvt_f32_i32 v39, v39
    v_cvt_f32_i32 v48, v48
    v_cvt_f32_i32 v49, v49
    v_cvt_f32_i32 v50, v50
    v_cvt_f32_i32 v51, v51
    v_cvt_pk_bf16_f32 v62, v36, v48
    v_cvt_pk_bf16_f32 v66, v37, v49
    v_cvt_pk_bf16_f32 v70, v38, v50
    v_cvt_pk_bf16_f32 v74, v39, v51
    s_waitcnt lgkmcnt(2)
    v_cvt_f32_i32 v40, v40
    v_cvt_f32_i32 v41, v41
    v_cvt_f32_i32 v42, v42
    v_cvt_f32_i32 v43, v43
    v_cvt_f32_i32 v52, v52
    v_cvt_f32_i32 v53, v53
    v_cvt_f32_i32 v54, v54
    v_cvt_f32_i32 v55, v55
    v_cvt_pk_bf16_f32 v78, v40, v52
    v_cvt_pk_bf16_f32 v82, v41, v53
    v_cvt_pk_bf16_f32 v86, v42, v54
    v_cvt_pk_bf16_f32 v90, v43, v55
    s_waitcnt lgkmcnt(0)
    v_cvt_f32_i32 v44, v44
    v_cvt_f32_i32 v45, v45
    v_cvt_f32_i32 v46, v46
    v_cvt_f32_i32 v47, v47
    v_cvt_f32_i32 v56, v56
    v_cvt_f32_i32 v57, v57
    v_cvt_f32_i32 v58, v58
    v_cvt_f32_i32 v59, v59
    v_cvt_pk_bf16_f32 v94, v44, v56
    v_cvt_pk_bf16_f32 v98, v45, v57
    v_cvt_pk_bf16_f32 v102, v46, v58
    v_cvt_pk_bf16_f32 v106, v47, v59
    v_add_u32 v13, s62, v12
    s_add_u32 s62, s62, 24576
    s_cmp_eq_u32 s62, 73728
    s_cselect_b32 s62, 0, s62
    s_barrier
    ds_read_b128 v[36:39], v13 offset:0
    ds_read_b128 v[48:51], v13 offset:1536
    ds_read_b128 v[40:43], v13 offset:256
    ds_read_b128 v[52:55], v13 offset:1792
    ds_read_b128 v[44:47], v13 offset:512
    ds_read_b128 v[56:59], v13 offset:2048
    s_waitcnt lgkmcnt(4)
    v_cvt_f32_i32 v36, v36
    v_cvt_f32_i32 v37, v37
    v_cvt_f32_i32 v38, v38
    v_cvt_f32_i32 v39, v39
    v_cvt_f32_i32 v48, v48
    v_cvt_f32_i32 v49, v49
    v_cvt_f32_i32 v50, v50
    v_cvt_f32_i32 v51, v51
    v_cvt_pk_bf16_f32 v63, v36, v48
    v_cvt_pk_bf16_f32 v67, v37, v49
    v_cvt_pk_bf16_f32 v71, v38, v50
    v_cvt_pk_bf16_f32 v75, v39, v51
    s_waitcnt lgkmcnt(2)
    v_cvt_f32_i32 v40, v40
    v_cvt_f32_i32 v41, v41
    v_cvt_f32_i32 v42, v42
    v_mfma_f32_16x16x32_bf16 v[164:167], v[188:191], v[60:63], v[164:167]
    v_cvt_f32_i32 v43, v43
    v_cvt_f32_i32 v52, v52
    v_cvt_f32_i32 v53, v53
    v_mfma_f32_16x16x32_bf16 v[164:167], v[192:195], v[64:67], v[164:167]
    v_cvt_f32_i32 v54, v54
    v_cvt_f32_i32 v55, v55
    v_cvt_pk_bf16_f32 v79, v40, v52
    v_mfma_f32_16x16x32_bf16 v[164:167], v[196:199], v[68:71], v[164:167]
    v_cvt_pk_bf16_f32 v83, v41, v53
    v_cvt_pk_bf16_f32 v87, v42, v54
    v_cvt_pk_bf16_f32 v91, v43, v55
    v_mfma_f32_16x16x32_bf16 v[164:167], v[200:203], v[72:75], v[164:167]
    s_waitcnt lgkmcnt(0)
    v_cvt_f32_i32 v44, v44
    v_cvt_f32_i32 v45, v45
    v_cvt_f32_i32 v46, v46
    v_mfma_f32_16x16x32_bf16 v[168:171], v[188:191], v[76:79], v[168:171]
    v_cvt_f32_i32 v47, v47
    v_cvt_f32_i32 v56, v56
    v_cvt_f32_i32 v57, v57
    v_mfma_f32_16x16x32_bf16 v[168:171], v[192:195], v[80:83], v[168:171]
    v_cvt_f32_i32 v58, v58
    v_cvt_f32_i32 v59, v59
    v_cvt_pk_bf16_f32 v95, v44, v56
    v_mfma_f32_16x16x32_bf16 v[168:171], v[196:199], v[84:87], v[168:171]
    v_cvt_pk_bf16_f32 v99, v45, v57
    v_cvt_pk_bf16_f32 v103, v46, v58
    v_cvt_pk_bf16_f32 v107, v47, v59
    v_mfma_f32_16x16x32_bf16 v[168:171], v[200:203], v[88:91], v[168:171]
    v_mfma_f32_16x16x32_bf16 v[172:175], v[188:191], v[92:95], v[172:175]
    v_mfma_f32_16x16x32_bf16 v[172:175], v[192:195], v[96:99], v[172:175]
    v_mfma_f32_16x16x32_bf16 v[172:175], v[196:199], v[100:103], v[172:175]
    v_mfma_f32_16x16x32_bf16 v[172:175], v[200:203], v[104:107], v[172:175]
    v_add_u32 v13, s62, v12
    s_add_u32 s62, s62, 24576
    s_cmp_eq_u32 s62, 73728
    s_cselect_b32 s62, 0, s62
    s_barrier
    ds_read_b128 v[36:39], v13 offset:0
    ds_read_b128 v[48:51], v13 offset:1536
    ds_read_b128 v[40:43], v13 offset:256
    ds_read_b128 v[52:55], v13 offset:1792
    ds_read_b128 v[44:47], v13 offset:512
    ds_read_b128 v[56:59], v13 offset:2048
    s_waitcnt lgkmcnt(6)
    v_lshlrev_b32 v219, 16, v214
    v_and_b32 v220, s66, v214
    v_fma_f32 v219, v219, s64, -v14
    v_fma_f32 v220, v220, s64, -v14
    v_exp_f32 v219, v219
    v_exp_f32 v220, v220
    v_lshlrev_b32 v221, 16, v215
    v_lshlrev_b32 v222, 16, v216
    v_mul_f32 v221, v219, v221
    v_mul_f32 v222, v220, v222
    v_add_f32 v212, v212, v219
    v_cvt_pk_bf16_f32 v221, v221, v222
    v_add_f32 v212, v212, v220
    v_lshlrev_b32 v223, 16, v217
    v_lshlrev_b32 v224, 16, v218
    v_lshlrev_b32 v219, 16, v221
    v_and_b32 v220, s66, v221
    v_fmac_f32 v213, v219, v223
    v_fmac_f32 v213, v220, v224
    v_mov_b32_dpp v188, v221 quad_perm:[0,1,2,3] row_mask:0xf bank_mask:0x1
    v_mov_b32_dpp v189, v221 row_ror:12 row_mask:0xf bank_mask:0x1
    v_mov_b32_dpp v190, v221 row_ror:8 row_mask:0xf bank_mask:0x1
    v_mov_b32_dpp v191, v221 row_ror:4 row_mask:0xf bank_mask:0x1
    v_mov_b32_dpp v192, v221 row_ror:4 row_mask:0xf bank_mask:0x2
    v_mov_b32_dpp v193, v221 quad_perm:[0,1,2,3] row_mask:0xf bank_mask:0x2
    v_mov_b32_dpp v194, v221 row_ror:12 row_mask:0xf bank_mask:0x2
    v_mov_b32_dpp v195, v221 row_ror:8 row_mask:0xf bank_mask:0x2
    v_mov_b32_dpp v196, v221 row_ror:8 row_mask:0xf bank_mask:0x4
    v_mov_b32_dpp v197, v221 row_ror:4 row_mask:0xf bank_mask:0x4
    v_mov_b32_dpp v198, v221 quad_perm:[0,1,2,3] row_mask:0xf bank_mask:0x4
    v_mov_b32_dpp v199, v221 row_ror:12 row_mask:0xf bank_mask:0x4
    v_mov_b32_dpp v200, v221 row_ror:12 row_mask:0xf bank_mask:0x8
    v_mov_b32_dpp v201, v221 row_ror:8 row_mask:0xf bank_mask:0x8
    v_mov_b32_dpp v202, v221 row_ror:4 row_mask:0xf bank_mask:0x8
    v_mov_b32_dpp v203, v221 quad_perm:[0,1,2,3] row_mask:0xf bank_mask:0x8
    s_waitcnt lgkmcnt(4)
    v_cvt_f32_i32 v36, v36
    v_cvt_f32_i32 v37, v37
    v_cvt_f32_i32 v38, v38
    v_cvt_f32_i32 v39, v39
    v_cvt_f32_i32 v48, v48
    v_cvt_f32_i32 v49, v49
    v_cvt_f32_i32 v50, v50
    v_cvt_f32_i32 v51, v51
    v_cvt_pk_bf16_f32 v60, v36, v48
    v_cvt_pk_bf16_f32 v64, v37, v49
    v_cvt_pk_bf16_f32 v68, v38, v50
    v_cvt_pk_bf16_f32 v72, v39, v51
    s_waitcnt lgkmcnt(2)
    v_cvt_f32_i32 v40, v40
    v_cvt_f32_i32 v41, v41
    v_cvt_f32_i32 v42, v42
    v_cvt_f32_i32 v43, v43
    v_cvt_f32_i32 v52, v52
    v_cvt_f32_i32 v53, v53
    v_cvt_f32_i32 v54, v54
    v_cvt_f32_i32 v55, v55
    v_cvt_pk_bf16_f32 v76, v40, v52
    v_cvt_pk_bf16_f32 v80, v41, v53
    v_cvt_pk_bf16_f32 v84, v42, v54
    v_cvt_pk_bf16_f32 v88, v43, v55
    s_waitcnt lgkmcnt(0)
    v_cvt_f32_i32 v44, v44
    v_cvt_f32_i32 v45, v45
    v_cvt_f32_i32 v46, v46
    v_cvt_f32_i32 v47, v47
    v_cvt_f32_i32 v56, v56
    v_cvt_f32_i32 v57, v57
    v_cvt_f32_i32 v58, v58
    v_cvt_f32_i32 v59, v59
    v_cvt_pk_bf16_f32 v92, v44, v56
    v_cvt_pk_bf16_f32 v96, v45, v57
    v_cvt_pk_bf16_f32 v100, v46, v58
    v_cvt_pk_bf16_f32 v104, v47, v59
    v_add_u32 v11, 3072, v11
    s_add_u32 s63, s63, 1024
    v_add_u32 v215, s63, v7
    v_add_u32 v216, s63, v8
    ds_read_b32 v214, v11 offset:0
    ds_read_u16 v217, v215 offset:512
    ds_read_u16 v218, v216 offset:512
    ds_read_u16 v215, v215
    ds_read_u16 v216, v216
    v_add_u32 v13, s62, v12
    s_add_u32 s62, s62, 24576
    s_cmp_eq_u32 s62, 73728
    s_cselect_b32 s62, 0, s62
    s_barrier
    ds_read_b128 v[36:39], v13 offset:0
    ds_read_b128 v[48:51], v13 offset:1536
    ds_read_b128 v[40:43], v13 offset:256
    ds_read_b128 v[52:55], v13 offset:1792
    ds_read_b128 v[44:47], v13 offset:512
    ds_read_b128 v[56:59], v13 offset:2048
    s_waitcnt lgkmcnt(4)
    v_cvt_f32_i32 v36, v36
    v_cvt_f32_i32 v37, v37
    v_cvt_f32_i32 v38, v38
    v_cvt_f32_i32 v39, v39
    v_cvt_f32_i32 v48, v48
    v_cvt_f32_i32 v49, v49
    v_cvt_f32_i32 v50, v50
    v_cvt_f32_i32 v51, v51
    v_cvt_pk_bf16_f32 v61, v36, v48
    v_cvt_pk_bf16_f32 v65, v37, v49
    v_cvt_pk_bf16_f32 v69, v38, v50
    v_cvt_pk_bf16_f32 v73, v39, v51
    s_waitcnt lgkmcnt(2)
    v_cvt_f32_i32 v40, v40
    v_cvt_f32_i32 v41, v41
    v_cvt_f32_i32 v42, v42
    v_cvt_f32_i32 v43, v43
    v_cvt_f32_i32 v52, v52
    v_cvt_f32_i32 v53, v53
    v_cvt_f32_i32 v54, v54
    v_cvt_f32_i32 v55, v55
    v_cvt_pk_bf16_f32 v77, v40, v52
    v_cvt_pk_bf16_f32 v81, v41, v53
    v_cvt_pk_bf16_f32 v85, v42, v54
    v_cvt_pk_bf16_f32 v89, v43, v55
    s_waitcnt lgkmcnt(0)
    v_cvt_f32_i32 v44, v44
    v_cvt_f32_i32 v45, v45
    v_cvt_f32_i32 v46, v46
    v_cvt_f32_i32 v47, v47
    v_cvt_f32_i32 v56, v56
    v_cvt_f32_i32 v57, v57
    v_cvt_f32_i32 v58, v58
    v_cvt_f32_i32 v59, v59
    v_cvt_pk_bf16_f32 v93, v44, v56
    v_cvt_pk_bf16_f32 v97, v45, v57
    v_cvt_pk_bf16_f32 v101, v46, v58
    v_cvt_pk_bf16_f32 v105, v47, v59
    s_cmp_eq_u32 s74, 0
    s_cbranch_scc1 L_vnostat
    v_mov_b32 v22, 154884
    ds_read_b32 v22, v22
    s_nop 1
    v_add_f32_dpp v212, v212, v212 row_ror:4 row_mask:0xf bank_mask:0xf
    s_nop 1
    v_add_f32_dpp v212, v212, v212 row_ror:8 row_mask:0xf bank_mask:0xf
    v_mov_b32 v3, v212
    s_nop 1
    v_permlane16_swap_b32 v212, v3
    v_add_f32 v212, v212, v3
    v_mov_b32 v3, v212
    s_nop 1
    v_permlane32_swap_b32 v212, v3
    v_add_f32 v212, v212, v3
    s_nop 1
    v_add_f32_dpp v213, v213, v213 row_ror:4 row_mask:0xf bank_mask:0xf
    s_nop 1
    v_add_f32_dpp v213, v213, v213 row_ror:8 row_mask:0xf bank_mask:0xf
    v_mov_b32 v3, v213
    s_nop 1
    v_permlane16_swap_b32 v213, v3
    v_add_f32 v213, v213, v3
    v_mov_b32 v3, v213
    s_nop 1
    v_permlane32_swap_b32 v213, v3
    v_add_f32 v213, v213, v3
    v_mov_b32 v160, v14
    v_mov_b32 v161, v212
    v_mov_b32 v162, v213
    ds_write_b128 v156, v[160:163]
    v_add_u32 v154, 64, v154
L_vnostat:
    v_add_u32 v13, s62, v12
    s_add_u32 s62, s62, 24576
    s_cmp_eq_u32 s62, 73728
    s_cselect_b32 s62, 0, s62
    s_barrier
    ds_read_b128 v[36:39], v13 offset:0
    ds_read_b128 v[48:51], v13 offset:1536
    ds_read_b128 v[40:43], v13 offset:256
    ds_read_b128 v[52:55], v13 offset:1792
    ds_read_b128 v[44:47], v13 offset:512
    ds_read_b128 v[56:59], v13 offset:2048
    s_waitcnt lgkmcnt(4)
    v_cvt_f32_i32 v36, v36
    v_cvt_f32_i32 v37, v37
    v_cvt_f32_i32 v38, v38
    v_cvt_f32_i32 v39, v39
    v_cvt_f32_i32 v48, v48
    v_cvt_f32_i32 v49, v49
    v_cvt_f32_i32 v50, v50
    v_cvt_f32_i32 v51, v51
    v_cvt_pk_bf16_f32 v62, v36, v48
    v_cvt_pk_bf16_f32 v66, v37, v49
    v_cvt_pk_bf16_f32 v70, v38, v50
    v_cvt_pk_bf16_f32 v74, v39, v51
    s_waitcnt lgkmcnt(2)
    v_cvt_f32_i32 v40, v40
    v_cvt_f32_i32 v41, v41
    v_cvt_f32_i32 v42, v42
    v_cvt_f32_i32 v43, v43
    v_cvt_f32_i32 v52, v52
    v_cvt_f32_i32 v53, v53
    v_cvt_f32_i32 v54, v54
    v_cvt_f32_i32 v55, v55
    v_cvt_pk_bf16_f32 v78, v40, v52
    v_cvt_pk_bf16_f32 v82, v41, v53
    v_cvt_pk_bf16_f32 v86, v42, v54
    v_cvt_pk_bf16_f32 v90, v43, v55
    s_waitcnt lgkmcnt(0)
    v_cvt_f32_i32 v44, v44
    v_cvt_f32_i32 v45, v45
    v_cvt_f32_i32 v46, v46
    v_cvt_f32_i32 v47, v47
    v_cvt_f32_i32 v56, v56
    v_cvt_f32_i32 v57, v57
    v_cvt_f32_i32 v58, v58
    v_cvt_f32_i32 v59, v59
    v_cvt_pk_bf16_f32 v94, v44, v56
    v_cvt_pk_bf16_f32 v98, v45, v57
    v_cvt_pk_bf16_f32 v102, v46, v58
    v_cvt_pk_bf16_f32 v106, v47, v59
    v_add_u32 v13, s62, v12
    s_add_u32 s62, s62, 24576
    s_cmp_eq_u32 s62, 73728
    s_cselect_b32 s62, 0, s62
    s_barrier
    ds_read_b128 v[36:39], v13 offset:0
    ds_read_b128 v[48:51], v13 offset:1536
    ds_read_b128 v[40:43], v13 offset:256
    ds_read_b128 v[52:55], v13 offset:1792
    ds_read_b128 v[44:47], v13 offset:512
    ds_read_b128 v[56:59], v13 offset:2048
    s_waitcnt lgkmcnt(4)
    v_cvt_f32_i32 v36, v36
    v_cvt_f32_i32 v37, v37
    v_cvt_f32_i32 v38, v38
    v_cvt_f32_i32 v39, v39
    v_cvt_f32_i32 v48, v48
    v_cvt_f32_i32 v49, v49
    v_cvt_f32_i32 v50, v50
    v_cvt_f32_i32 v51, v51
    v_cvt_pk_bf16_f32 v63, v36, v48
    v_cvt_pk_bf16_f32 v67, v37, v49
    v_cvt_pk_bf16_f32 v71, v38, v50
    v_cvt_pk_bf16_f32 v75, v39, v51
    s_waitcnt lgkmcnt(2)
    v_cvt_f32_i32 v40, v40
    v_cvt_f32_i32 v41, v41
    v_cvt_f32_i32 v42, v42
    v_mfma_f32_16x16x32_bf16 v[164:167], v[188:191], v[60:63], v[164:167]
    v_cvt_f32_i32 v43, v43
    v_cvt_f32_i32 v52, v52
    v_cvt_f32_i32 v53, v53
    v_mfma_f32_16x16x32_bf16 v[164:167], v[192:195], v[64:67], v[164:167]
    v_cvt_f32_i32 v54, v54
    v_cvt_f32_i32 v55, v55
    v_cvt_pk_bf16_f32 v79, v40, v52
    v_mfma_f32_16x16x32_bf16 v[164:167], v[196:199], v[68:71], v[164:167]
    v_cvt_pk_bf16_f32 v83, v41, v53
    v_cvt_pk_bf16_f32 v87, v42, v54
    v_cvt_pk_bf16_f32 v91, v43, v55
    v_mfma_f32_16x16x32_bf16 v[164:167], v[200:203], v[72:75], v[164:167]
    s_waitcnt lgkmcnt(0)
    v_cvt_f32_i32 v44, v44
    v_cvt_f32_i32 v45, v45
    v_cvt_f32_i32 v46, v46
    v_mfma_f32_16x16x32_bf16 v[168:171], v[188:191], v[76:79], v[168:171]
    v_cvt_f32_i32 v47, v47
    v_cvt_f32_i32 v56, v56
    v_cvt_f32_i32 v57, v57
    v_mfma_f32_16x16x32_bf16 v[168:171], v[192:195], v[80:83], v[168:171]
    v_cvt_f32_i32 v58, v58
    v_cvt_f32_i32 v59, v59
    v_cvt_pk_bf16_f32 v95, v44, v56
    v_mfma_f32_16x16x32_bf16 v[168:171], v[196:199], v[84:87], v[168:171]
    v_cvt_pk_bf16_f32 v99, v45, v57
    v_cvt_pk_bf16_f32 v103, v46, v58
    v_cvt_pk_bf16_f32 v107, v47, v59
    v_mfma_f32_16x16x32_bf16 v[168:171], v[200:203], v[88:91], v[168:171]
    v_mfma_f32_16x16x32_bf16 v[172:175], v[188:191], v[92:95], v[172:175]
    v_mfma_f32_16x16x32_bf16 v[172:175], v[192:195], v[96:99], v[172:175]
    v_mfma_f32_16x16x32_bf16 v[172:175], v[196:199], v[100:103], v[172:175]
    v_mfma_f32_16x16x32_bf16 v[172:175], v[200:203], v[104:107], v[172:175]
    s_cmp_eq_u32 s74, 0
    s_cbranch_scc1 L_vblk
    ds_write_b128 v155, v[164:167]
    s_nop 0
    ds_write_b128 v155, v[168:171] offset:1024
    s_cmp_lt_u32 s61, 16
    s_nop 1
    ds_write_b128 v155, v[172:175] offset:2048
    s_waitcnt lgkmcnt(0)
    s_cbranch_scc1 L_vround
    s_barrier
    s_cmp_eq_u32 s56, 3
    s_cbranch_scc1 L_fin
    ds_read_b128 v[36:39], v18 offset:0
    ds_read_b128 v[40:43], v18 offset:64
    ds_read_b128 v[44:47], v18 offset:128
    ds_read_b128 v[48:51], v18 offset:192
    ds_read2st64_b32 v[60:61], v17 offset0:0 offset1:1
    ds_read2st64_b32 v[62:63], v17 offset0:2 offset1:3
    ds_read2st64_b32 v[64:65], v17 offset0:12 offset1:13
    ds_read2st64_b32 v[66:67], v17 offset0:14 offset1:15
    ds_read2st64_b32 v[68:69], v17 offset0:24 offset1:25
    ds_read2st64_b32 v[70:71], v17 offset0:26 offset1:27
    ds_read2st64_b32 v[72:73], v17 offset0:36 offset1:37
    ds_read2st64_b32 v[74:75], v17 offset0:38 offset1:39
    s_cmp_eq_u32 s101, 0
    s_cbranch_scc0 L_rp10
    buffer_load_dwordx4 v[176:179], v20, s[24:27], s69 offen sc1
    buffer_load_dwordx4 v[184:187], v20, s[24:27], s70 offen sc1
    buffer_load_dwordx4 v[172:175], v19, s[24:27], s69 offen sc1
    buffer_load_dwordx4 v[180:183], v19, s[24:27], s70 offen sc1
    s_branch L_rp12
L_rp10:
    s_cmp_eq_u32 s101, 1
    s_cbranch_scc0 L_rp11
    buffer_load_dwordx4 v[168:171], v20, s[24:27], s68 offen sc1
    buffer_load_dwordx4 v[184:187], v20, s[24:27], s70 offen sc1
    buffer_load_dwordx4 v[164:167], v19, s[24:27], s68 offen sc1
    buffer_load_dwordx4 v[180:183], v19, s[24:27], s70 offen sc1
    s_branch L_rp12
L_rp11:
    buffer_load_dwordx4 v[168:171], v20, s[24:27], s68 offen sc1
    buffer_load_dwordx4 v[176:179], v20, s[24:27], s69 offen sc1
    buffer_load_dwordx4 v[164:167], v19, s[24:27], s68 offen sc1
    buffer_load_dwordx4 v[172:175], v19, s[24:27], s69 offen sc1
L_rp12:
    s_waitcnt lgkmcnt(8)
    v_add_f32 v37, v37, v41
    v_add_f32 v45, v45, v49
    v_add_f32 v38, v38, v42
    v_add_f32 v46, v46, v50
    v_add_f32 v37, v37, v45
    v_add_f32 v38, v38, v46
    v_mov_b32 v39, v22
    s_waitcnt lgkmcnt(4)
    v_add_f32 v60, v60, v64
    v_add_f32 v61, v61, v65
    v_add_f32 v62, v62, v66
    v_add_f32 v63, v63, v67
    s_waitcnt lgkmcnt(0)
    v_add_f32 v68, v68, v72
    v_add_f32 v69, v69, v73
    v_add_f32 v70, v70, v74
    v_add_f32 v71, v71, v75
    v_add_f32 v60, v60, v68
    v_add_f32 v61, v61, v69
    v_add_f32 v62, v62, v70
    v_add_f32 v63, v63, v71
    v_sub_f32 v60, v60, v38
    v_sub_f32 v61, v61, v38
    v_sub_f32 v62, v62, v38
    v_sub_f32 v63, v63, v38
    s_cmp_eq_u32 s2, 255
    s_cbranch_scc1 L_rsolo
    v_perm_b32 v60, v60, v22, s84
    v_perm_b32 v61, v61, v22, s85
    v_perm_b32 v62, v62, v22, s86
    v_perm_b32 v63, v63, v22, s87
    buffer_store_dwordx4 v[60:63], v19, s[24:27], s71 offen sc1
    s_mov_b64 exec, 15
    buffer_store_dwordx4 v[36:39], v20, s[24:27], s71 offen sc1
    s_mov_b64 exec, -1
    s_cmp_eq_u32 s101, 0
    s_cbranch_scc0 L_rp20
    v_mov_b32 v164, v60
    v_mov_b32 v168, v36
    v_mov_b32 v165, v61
    v_mov_b32 v169, v37
    v_mov_b32 v166, v62
    v_mov_b32 v170, v38
    v_mov_b32 v167, v63
    v_mov_b32 v171, v39
    s_branch L_rp22
L_rp20:
    s_cmp_eq_u32 s101, 1
    s_cbranch_scc0 L_rp21
    v_mov_b32 v172, v60
    v_mov_b32 v176, v36
    v_mov_b32 v173, v61
    v_mov_b32 v177, v37
    v_mov_b32 v174, v62
    v_mov_b32 v178, v38
    v_mov_b32 v175, v63
    v_mov_b32 v179, v39
    s_branch L_rp22
L_rp21:
    v_mov_b32 v180, v60
    v_mov_b32 v184, v36
    v_mov_b32 v181, v61
    v_mov_b32 v185, v37
    v_mov_b32 v182, v62
    v_mov_b32 v186, v38
    v_mov_b32 v183, v63
    v_mov_b32 v187, v39
L_rp22:
    s_waitcnt vmcnt(4)
    v_xor_b32 v40, v171, v22
    v_xor_b32 v41, v179, v22
    v_xor_b32 v42, v187, v22
    v_or3_b32 v4, v40, v41, v42
    s_waitcnt vmcnt(2)
    v_perm_b32 v5, v165, v164, s88
    v_perm_b32 v6, v167, v166, s89
    v_bitop3_b32 v5, v5, v6, v22 bitop3:0x56
    v_or_b32 v4, v4, v5
    v_perm_b32 v5, v173, v172, s88
    v_perm_b32 v6, v175, v174, s89
    v_bitop3_b32 v5, v5, v6, v22 bitop3:0x56
    v_or_b32 v4, v4, v5
    v_perm_b32 v5, v181, v180, s88
    v_perm_b32 v6, v183, v182, s89
    v_bitop3_b32 v5, v5, v6, v22 bitop3:0x56
    v_or_b32 v4, v4, v5
    v_cmp_eq_u32 vcc, 0, v4
    s_nop 4
    s_cmp_eq_u64 vcc, -1
    s_cbranch_scc1 L_rmerge
    s_waitcnt vmcnt(0)
    s_cmp_eq_u32 s101, 0
    s_cbranch_scc0 L_rp30
    buffer_load_dwordx4 v[176:179], v20, s[24:27], s69 offen sc1
    buffer_load_dwordx4 v[184:187], v20, s[24:27], s70 offen sc1
    buffer_load_dwordx4 v[172:175], v19, s[24:27], s69 offen sc1
    buffer_load_dwordx4 v[180:183], v19, s[24:27], s70 offen sc1
    s_branch L_rp32
L_rp30:
    s_cmp_eq_u32 s101, 1
    s_cbranch_scc0 L_rp31
    buffer_load_dwordx4 v[168:171], v20, s[24:27], s68 offen sc1
    buffer_load_dwordx4 v[184:187], v20, s[24:27], s70 offen sc1
    buffer_load_dwordx4 v[164:167], v19, s[24:27], s68 offen sc1
    buffer_load_dwordx4 v[180:183], v19, s[24:27], s70 offen sc1
    s_branch L_rp32
L_rp31:
    buffer_load_dwordx4 v[168:171], v20, s[24:27], s68 offen sc1
    buffer_load_dwordx4 v[176:179], v20, s[24:27], s69 offen sc1
    buffer_load_dwordx4 v[164:167], v19, s[24:27], s68 offen sc1
    buffer_load_dwordx4 v[172:175], v19, s[24:27], s69 offen sc1
L_rp32:
    s_waitcnt vmcnt(2)
    v_xor_b32 v40, v171, v22
    v_xor_b32 v41, v179, v22
    v_xor_b32 v42, v187, v22
    v_or3_b32 v4, v40, v41, v42
    s_waitcnt vmcnt(0)
    v_perm_b32 v5, v165, v164, s88
    v_perm_b32 v6, v167, v166, s89
    v_bitop3_b32 v5, v5, v6, v22 bitop3:0x56
    v_or_b32 v4, v4, v5
    v_perm_b32 v5, v173, v172, s88
    v_perm_b32 v6, v175, v174, s89
    v_bitop3_b32 v5, v5, v6, v22 bitop3:0x56
    v_or_b32 v4, v4, v5
    v_perm_b32 v5, v181, v180, s88
    v_perm_b32 v6, v183, v182, s89
    v_bitop3_b32 v5, v5, v6, v22 bitop3:0x56
    v_or_b32 v4, v4, v5
    v_cmp_eq_u32 vcc, 0, v4
L_rmerge:
    v_max3_f32 v3, v168, v176, v184
    v_sub_f32 v168, v168, v3
    v_sub_f32 v176, v176, v3
    v_sub_f32 v184, v184, v3
    v_exp_f32 v168, v168
    v_exp_f32 v176, v176
    v_exp_f32 v184, v184
    s_and_b64 exec, exec, vcc
    s_cbranch_execz L_fin
    v_and_b32 v164, s90, v164
    v_and_b32 v165, s90, v165
    v_and_b32 v166, s90, v166
    v_and_b32 v167, s90, v167
    v_and_b32 v172, s90, v172
    v_and_b32 v173, s90, v173
    v_and_b32 v174, s90, v174
    v_and_b32 v175, s90, v175
    v_and_b32 v180, s90, v180
    v_and_b32 v181, s90, v181
    v_and_b32 v182, s90, v182
    v_and_b32 v183, s90, v183
    v_mul_f32 v37, v168, v169
    v_fmac_f32 v37, v176, v177
    v_fmac_f32 v37, v184, v185
    v_mul_f32 v60, v164, v168
    v_fmac_f32 v60, v172, v176
    v_fmac_f32 v60, v180, v184
    v_mul_f32 v61, v165, v168
    v_fmac_f32 v61, v173, v176
    v_fmac_f32 v61, v181, v184
    v_mul_f32 v62, v166, v168
    v_fmac_f32 v62, v174, v176
    v_fmac_f32 v62, v182, v184
    v_mul_f32 v63, v167, v168
    v_fmac_f32 v63, v175, v176
    v_fmac_f32 v63, v183, v184
L_rsolo:
    v_rcp_f32 v37, v37
    s_nop 0
    v_mul_f32 v60, v60, v37
    v_mul_f32 v61, v61, v37
    v_mul_f32 v62, v62, v37
    v_mul_f32 v63, v63, v37
    v_cvt_pk_bf16_f32 v64, v60, v61
    v_cvt_pk_bf16_f32 v65, v62, v63
    buffer_store_dwordx2 v[64:65], v21, s[48:51], s57 offen
    s_branch L_fin
L_finisher:
    v_and_b32 v14, 3, v1
    v_mul_u32_u24 v8, 384, v14
    v_lshrrev_b32 v13, 2, v1
    v_lshl_add_u32 v8, v13, 3, v8
    v_lshlrev_b32 v9, 4, v1
    v_lshlrev_b32 v14, 4, v14
    s_memrealtime s[96:97]
    s_waitcnt lgkmcnt(0)
    s_mov_b32 s48, s18
    s_and_b32 s49, s19, 0xffff
    s_mov_b32 s50, 393216
    s_mov_b32 s51, 0x20000
    s_mov_b32 s52, s20
    s_and_b32 s53, s21, 0xffff
    s_mov_b32 s54, 256
    s_mov_b32 s55, 0x20000
    s_mov_b32 s24, s22
    s_and_b32 s25, s23, 0xffff
    s_mov_b32 s26, 2528256
    s_mov_b32 s27, 0x20000
L_fk:
    s_waitcnt vmcnt(63)
    s_movk_i32 s69, 4
L_fb1:
    s_barrier
    s_sub_u32 s69, s69, 1
    s_cmp_lg_u32 s69, 0
    s_cbranch_scc1 L_fb1
    s_waitcnt vmcnt(0)
    s_cmp_eq_u32 s2, 0
    s_cbranch_scc0 L_fk2
    s_or_b32 s71, s96, 1
    v_mov_b32 v16, s71
    v_mov_b32 v17, 0
    s_mov_b64 exec, 1
    buffer_atomic_cmpswap v[16:17], v9, s[52:55], 0 offen sc1
    s_mov_b64 exec, -1
L_fk2:
    s_movk_i32 s69, 124
L_fb2:
    s_barrier
    s_sub_u32 s69, s69, 1
    s_cmp_lg_u32 s69, 0
    s_cbranch_scc1 L_fb2
    s_load_dword s71, s[20:21], 0
    s_barrier
    s_waitcnt lgkmcnt(0)
    s_cmp_eq_u32 s71, 0
    s_cbranch_scc0 L_ftag
    s_or_b32 s71, s96, 1
    v_mov_b32 v16, s71
    v_mov_b32 v17, 0
    s_mov_b64 exec, 1
    buffer_atomic_cmpswap v[16:17], v9, s[52:55], 0 offen sc0 sc1
    s_mov_b64 exec, -1
    s_waitcnt vmcnt(0)
    v_readfirstlane_b32 s58, v16
    s_nop 3
    s_cmp_eq_u32 s58, 0
    s_cselect_b32 s71, s71, s58
L_ftag:
    v_mov_b32 v10, s71
    v_mov_b32 v13, 154884
    ds_write_b32 v13, v10
    s_lshr_b32 s63, s101, 1
    s_lshl_b32 s58, s100, 1
    s_add_u32 s63, s63, s58
    s_mul_i32 s62, s63, 8704
    s_add_u32 s62, s62, 1048576
    s_waitcnt lgkmcnt(0)
    s_cmp_eq_u32 s2, 255
    s_cbranch_scc1 L_fin
    s_cmp_eq_u32 s101, 1
    s_cbranch_scc1 L_fmid
    s_movk_i32 s69, 89
L_fb3:
    s_barrier
    s_sub_u32 s69, s69, 1
    s_cmp_lg_u32 s69, 0
    s_cbranch_scc1 L_fb3
    v_add_u32 v13, 142336, v14
    v_lshlrev_b32 v11, 2, v1
    v_add_u32 v11, 142592, v11
    ds_read_b128 v[16:19], v13 offset:0
    ds_read_b128 v[20:23], v13 offset:64
    ds_read_b128 v[24:27], v13 offset:128
    ds_read_b128 v[28:31], v13 offset:192
    ds_read2st64_b32 v[32:33], v11 offset0:0 offset1:1
    ds_read2st64_b32 v[34:35], v11 offset0:2 offset1:3
    ds_read2st64_b32 v[36:37], v11 offset0:4 offset1:5
    ds_read2st64_b32 v[38:39], v11 offset0:6 offset1:7
    ds_read2st64_b32 v[40:41], v11 offset0:8 offset1:9
    ds_read2st64_b32 v[42:43], v11 offset0:10 offset1:11
    ds_read2st64_b32 v[44:45], v11 offset0:12 offset1:13
    ds_read2st64_b32 v[46:47], v11 offset0:14 offset1:15
    s_waitcnt lgkmcnt(4)
    ds_read2st64_b32 v[48:49], v11 offset0:16 offset1:17
    ds_read2st64_b32 v[50:51], v11 offset0:18 offset1:19
    ds_read2st64_b32 v[52:53], v11 offset0:20 offset1:21
    ds_read2st64_b32 v[54:55], v11 offset0:22 offset1:23
    ds_read2st64_b32 v[56:57], v11 offset0:24 offset1:25
    ds_read2st64_b32 v[58:59], v11 offset0:26 offset1:27
    ds_read2st64_b32 v[60:61], v11 offset0:28 offset1:29
    ds_read2st64_b32 v[62:63], v11 offset0:30 offset1:31
    s_waitcnt lgkmcnt(4)
    ds_read2st64_b32 v[64:65], v11 offset0:32 offset1:33
    ds_read2st64_b32 v[66:67], v11 offset0:34 offset1:35
    ds_read2st64_b32 v[68:69], v11 offset0:36 offset1:37
    ds_read2st64_b32 v[70:71], v11 offset0:38 offset1:39
    ds_read2st64_b32 v[72:73], v11 offset0:40 offset1:41
    ds_read2st64_b32 v[74:75], v11 offset0:42 offset1:43
    ds_read2st64_b32 v[76:77], v11 offset0:44 offset1:45
    ds_read2st64_b32 v[78:79], v11 offset0:46 offset1:47
    v_mov_b32 v83, v10
    v_mov_b32 v87, v10
    v_mov_b32 v91, v10
    v_mov_b32 v95, v10
    v_mov_b32 v99, v10
    v_mov_b32 v96, v16
    v_add_f32 v17, v17, v21
    v_add_f32 v25, v25, v29
    v_add_f32 v97, v17, v25
    v_add_f32 v18, v18, v22
    v_add_f32 v26, v26, v30
    v_add_f32 v98, v18, v26
    s_waitcnt lgkmcnt(0)
    v_add_f32 v32, v32, v44
    v_add_f32 v56, v56, v68
    v_add_f32 v32, v32, v56
    v_sub_f32 v80, v32, v98
    v_add_f32 v33, v33, v45
    v_add_f32 v57, v57, v69
    v_add_f32 v33, v33, v57
    v_sub_f32 v81, v33, v98
    v_add_f32 v34, v34, v46
    v_add_f32 v58, v58, v70
    v_add_f32 v34, v34, v58
    v_sub_f32 v82, v34, v98
    v_add_f32 v35, v35, v47
    v_add_f32 v59, v59, v71
    v_add_f32 v35, v35, v59
    v_sub_f32 v84, v35, v98
    v_add_f32 v36, v36, v48
    v_add_f32 v60, v60, v72
    v_add_f32 v36, v36, v60
    v_sub_f32 v85, v36, v98
    v_add_f32 v37, v37, v49
    v_add_f32 v61, v61, v73
    v_add_f32 v37, v37, v61
    v_sub_f32 v86, v37, v98
    v_add_f32 v38, v38, v50
    v_add_f32 v62, v62, v74
    v_add_f32 v38, v38, v62
    v_sub_f32 v88, v38, v98
    v_add_f32 v39, v39, v51
    v_add_f32 v63, v63, v75
    v_add_f32 v39, v39, v63
    v_sub_f32 v89, v39, v98
    v_add_f32 v40, v40, v52
    v_add_f32 v64, v64, v76
    v_add_f32 v40, v40, v64
    v_sub_f32 v90, v40, v98
    v_add_f32 v41, v41, v53
    v_add_f32 v65, v65, v77
    v_add_f32 v41, v41, v65
    v_sub_f32 v92, v41, v98
    v_add_f32 v42, v42, v54
    v_add_f32 v66, v66, v78
    v_add_f32 v42, v42, v66
    v_sub_f32 v93, v42, v98
    v_add_f32 v43, v43, v55
    v_add_f32 v67, v67, v79
    v_add_f32 v43, v43, v67
    v_sub_f32 v94, v43, v98
    s_movk_i32 s69, 39
L_fb4:
    s_barrier
    s_sub_u32 s69, s69, 1
    s_cmp_lg_u32 s69, 0
    s_cbranch_scc1 L_fb4
    s_add_u32 s58, s62, 4352
    s_add_u32 s59, s62, 8448
    buffer_load_dwordx4 v[116:119], v14, s[24:27], s59 offen sc1 nt
    buffer_load_dwordx4 v[100:103], v9, s[24:27], s58 offen offset:0 sc1 nt
    buffer_load_dwordx4 v[104:107], v9, s[24:27], s58 offen offset:1024 sc1 nt
    buffer_load_dwordx4 v[108:111], v9, s[24:27], s58 offen offset:2048 sc1 nt
    buffer_load_dwordx4 v[112:115], v9, s[24:27], s58 offen offset:3072 sc1 nt
    s_barrier
    s_waitcnt vmcnt(0)
    v_xor_b32 v13, v10, v103
    v_xor_b32 v11, v10, v107
    v_or_b32 v13, v13, v11
    v_xor_b32 v11, v10, v111
    v_or_b32 v13, v13, v11
    v_xor_b32 v11, v10, v115
    v_or_b32 v13, v13, v11
    v_xor_b32 v11, v10, v119
    v_or_b32 v13, v13, v11
    v_cmp_ne_u32 vcc, 0, v13
    s_nop 4
    s_cmp_eq_u64 vcc, 0
    s_cbranch_scc1 L_fo7
    s_add_u32 s58, s62, 0
    s_add_u32 s59, s62, 4096
    buffer_store_dwordx4 v[80:83], v9, s[24:27], s58 offen offset:0 sc1 nt
    buffer_store_dwordx4 v[84:87], v9, s[24:27], s58 offen offset:1024 sc1 nt
    buffer_store_dwordx4 v[88:91], v9, s[24:27], s58 offen offset:2048 sc1 nt
    buffer_store_dwordx4 v[92:95], v9, s[24:27], s58 offen offset:3072 sc1 nt
    s_mov_b64 exec, 15
    buffer_store_dwordx4 v[96:99], v14, s[24:27], s59 offen sc1 nt
    s_mov_b64 exec, -1
    s_waitcnt vmcnt(0)
    s_add_u32 s58, s62, 4352
    s_add_u32 s59, s62, 8448
    buffer_load_dwordx4 v[116:119], v14, s[24:27], s59 offen sc1 nt
    buffer_load_dwordx4 v[100:103], v9, s[24:27], s58 offen offset:0 sc1 nt
    buffer_load_dwordx4 v[104:107], v9, s[24:27], s58 offen offset:1024 sc1 nt
    buffer_load_dwordx4 v[108:111], v9, s[24:27], s58 offen offset:2048 sc1 nt
    buffer_load_dwordx4 v[112:115], v9, s[24:27], s58 offen offset:3072 sc1 nt
    s_waitcnt vmcnt(0)
    v_xor_b32 v13, v10, v103
    v_xor_b32 v11, v10, v107
    v_or_b32 v13, v13, v11
    v_xor_b32 v11, v10, v111
    v_or_b32 v13, v13, v11
    v_xor_b32 v11, v10, v115
    v_or_b32 v13, v13, v11
    v_xor_b32 v11, v10, v119
    v_or_b32 v13, v13, v11
    v_cmp_ne_u32 vcc, 0, v13
    s_nop 4
    s_cmp_eq_u64 vcc, 0
    s_cbranch_scc0 L_fin
L_fo7:
    v_max_f32 v11, v96, v116
    v_sub_f32 v16, v96, v11
    v_sub_f32 v17, v116, v11
    v_exp_f32 v16, v16
    v_exp_f32 v17, v17
    s_nop 0
    v_mul_f32 v12, v16, v97
    v_fmac_f32 v12, v17, v117
    v_rcp_f32 v12, v12
    s_add_u32 s58, s63, 0
    s_mul_i32 s58, s58, 1536
    v_mul_f32 v16, v16, v12
    v_mul_f32 v17, v17, v12
    v_mul_f32 v32, v80, v16
    v_fmac_f32 v32, v100, v17
    v_mul_f32 v33, v81, v16
    v_fmac_f32 v33, v101, v17
    v_mul_f32 v34, v82, v16
    v_fmac_f32 v34, v102, v17
    v_mul_f32 v35, v84, v16
    v_fmac_f32 v35, v104, v17
    v_mul_f32 v36, v85, v16
    v_fmac_f32 v36, v105, v17
    v_mul_f32 v37, v86, v16
    v_fmac_f32 v37, v106, v17
    v_mul_f32 v38, v88, v16
    v_fmac_f32 v38, v108, v17
    v_mul_f32 v39, v89, v16
    v_fmac_f32 v39, v109, v17
    v_mul_f32 v40, v90, v16
    v_fmac_f32 v40, v110, v17
    v_mul_f32 v41, v92, v16
    v_fmac_f32 v41, v112, v17
    v_mul_f32 v42, v93, v16
    v_fmac_f32 v42, v113, v17
    v_mul_f32 v43, v94, v16
    v_fmac_f32 v43, v114, v17
    v_cvt_pk_bf16_f32 v44, v32, v33
    v_cvt_pk_bf16_f32 v45, v34, v35
    v_cvt_pk_bf16_f32 v46, v36, v37
    v_cvt_pk_bf16_f32 v47, v38, v39
    v_cvt_pk_bf16_f32 v48, v40, v41
    v_cvt_pk_bf16_f32 v49, v42, v43
    buffer_store_dwordx2 v[44:45], v8, s[48:51], s58 offen offset:0
    buffer_store_dwordx2 v[46:47], v8, s[48:51], s58 offen offset:128
    buffer_store_dwordx2 v[48:49], v8, s[48:51], s58 offen offset:256
    s_branch L_fin
L_fmid:
    v_and_b32 v7, 1, v1
    v_mul_u32_u24 v7, 8704, v7
    v_add_u32 v7, 4108, v7
    s_movk_i32 s69, 41
L_fb5:
    s_barrier
    s_sub_u32 s69, s69, 1
    s_cmp_lg_u32 s69, 0
    s_cbranch_scc1 L_fb5
    v_add_u32 v13, 142336, v14
    v_lshlrev_b32 v11, 2, v1
    v_add_u32 v11, 142592, v11
    ds_read_b128 v[16:19], v13 offset:0
    ds_read_b128 v[20:23], v13 offset:64
    ds_read_b128 v[24:27], v13 offset:128
    ds_read_b128 v[28:31], v13 offset:192
    ds_read2st64_b32 v[32:33], v11 offset0:0 offset1:1
    ds_read2st64_b32 v[34:35], v11 offset0:2 offset1:3
    ds_read2st64_b32 v[36:37], v11 offset0:4 offset1:5
    ds_read2st64_b32 v[38:39], v11 offset0:6 offset1:7
    ds_read2st64_b32 v[40:41], v11 offset0:8 offset1:9
    ds_read2st64_b32 v[42:43], v11 offset0:10 offset1:11
    ds_read2st64_b32 v[44:45], v11 offset0:12 offset1:13
    ds_read2st64_b32 v[46:47], v11 offset0:14 offset1:15
    s_waitcnt lgkmcnt(4)
    ds_read2st64_b32 v[48:49], v11 offset0:16 offset1:17
    ds_read2st64_b32 v[50:51], v11 offset0:18 offset1:19
    ds_read2st64_b32 v[52:53], v11 offset0:20 offset1:21
    ds_read2st64_b32 v[54:55], v11 offset0:22 offset1:23
    ds_read2st64_b32 v[56:57], v11 offset0:24 offset1:25
    ds_read2st64_b32 v[58:59], v11 offset0:26 offset1:27
    ds_read2st64_b32 v[60:61], v11 offset0:28 offset1:29
    ds_read2st64_b32 v[62:63], v11 offset0:30 offset1:31
    s_waitcnt lgkmcnt(4)
    ds_read2st64_b32 v[64:65], v11 offset0:32 offset1:33
    ds_read2st64_b32 v[66:67], v11 offset0:34 offset1:35
    ds_read2st64_b32 v[68:69], v11 offset0:36 offset1:37
    ds_read2st64_b32 v[70:71], v11 offset0:38 offset1:39
    ds_read2st64_b32 v[72:73], v11 offset0:40 offset1:41
    ds_read2st64_b32 v[74:75], v11 offset0:42 offset1:43
    ds_read2st64_b32 v[76:77], v11 offset0:44 offset1:45
    ds_read2st64_b32 v[78:79], v11 offset0:46 offset1:47
    v_mov_b32 v83, v10
    v_mov_b32 v87, v10
    v_mov_b32 v91, v10
    v_mov_b32 v95, v10
    v_mov_b32 v99, v10
    v_mov_b32 v96, v16
    v_add_f32 v17, v17, v21
    v_add_f32 v25, v25, v29
    v_add_f32 v97, v17, v25
    v_add_f32 v18, v18, v22
    v_add_f32 v26, v26, v30
    v_add_f32 v98, v18, v26
    s_waitcnt lgkmcnt(0)
    v_add_f32 v32, v32, v44
    v_add_f32 v56, v56, v68
    v_add_f32 v32, v32, v56
    v_sub_f32 v80, v32, v98
    v_add_f32 v33, v33, v45
    v_add_f32 v57, v57, v69
    v_add_f32 v33, v33, v57
    v_sub_f32 v81, v33, v98
    v_add_f32 v34, v34, v46
    v_add_f32 v58, v58, v70
    v_add_f32 v34, v34, v58
    v_sub_f32 v82, v34, v98
    v_add_f32 v35, v35, v47
    v_add_f32 v59, v59, v71
    v_add_f32 v35, v35, v59
    v_sub_f32 v84, v35, v98
    v_add_f32 v36, v36, v48
    v_add_f32 v60, v60, v72
    v_add_f32 v36, v36, v60
    v_sub_f32 v85, v36, v98
    v_add_f32 v37, v37, v49
    v_add_f32 v61, v61, v73
    v_add_f32 v37, v37, v61
    v_sub_f32 v86, v37, v98
    v_add_f32 v38, v38, v50
    v_add_f32 v62, v62, v74
    v_add_f32 v38, v38, v62
    v_sub_f32 v88, v38, v98
    v_add_f32 v39, v39, v51
    v_add_f32 v63, v63, v75
    v_add_f32 v39, v39, v63
    v_sub_f32 v89, v39, v98
    v_add_f32 v40, v40, v52
    v_add_f32 v64, v64, v76
    v_add_f32 v40, v40, v64
    v_sub_f32 v90, v40, v98
    v_add_f32 v41, v41, v53
    v_add_f32 v65, v65, v77
    v_add_f32 v41, v41, v65
    v_sub_f32 v92, v41, v98
    v_add_f32 v42, v42, v54
    v_add_f32 v66, v66, v78
    v_add_f32 v42, v42, v66
    v_sub_f32 v93, v42, v98
    v_add_f32 v43, v43, v55
    v_add_f32 v67, v67, v79
    v_add_f32 v43, v43, v67
    v_sub_f32 v94, v43, v98
    s_movk_i32 s69, 40
L_fb6:
    s_barrier
    s_sub_u32 s69, s69, 1
    s_cmp_lg_u32 s69, 0
    s_cbranch_scc1 L_fb6
    v_add_u32 v13, 142336, v14
    v_lshlrev_b32 v11, 2, v1
    v_add_u32 v11, 142592, v11
    ds_read_b128 v[16:19], v13 offset:0
    ds_read_b128 v[20:23], v13 offset:64
    ds_read_b128 v[24:27], v13 offset:128
    ds_read_b128 v[28:31], v13 offset:192
    ds_read2st64_b32 v[32:33], v11 offset0:0 offset1:1
    ds_read2st64_b32 v[34:35], v11 offset0:2 offset1:3
    ds_read2st64_b32 v[36:37], v11 offset0:4 offset1:5
    ds_read2st64_b32 v[38:39], v11 offset0:6 offset1:7
    ds_read2st64_b32 v[40:41], v11 offset0:8 offset1:9
    ds_read2st64_b32 v[42:43], v11 offset0:10 offset1:11
    ds_read2st64_b32 v[44:45], v11 offset0:12 offset1:13
    ds_read2st64_b32 v[46:47], v11 offset0:14 offset1:15
    s_waitcnt lgkmcnt(4)
    ds_read2st64_b32 v[48:49], v11 offset0:16 offset1:17
    ds_read2st64_b32 v[50:51], v11 offset0:18 offset1:19
    ds_read2st64_b32 v[52:53], v11 offset0:20 offset1:21
    ds_read2st64_b32 v[54:55], v11 offset0:22 offset1:23
    ds_read2st64_b32 v[56:57], v11 offset0:24 offset1:25
    ds_read2st64_b32 v[58:59], v11 offset0:26 offset1:27
    ds_read2st64_b32 v[60:61], v11 offset0:28 offset1:29
    ds_read2st64_b32 v[62:63], v11 offset0:30 offset1:31
    s_waitcnt lgkmcnt(4)
    ds_read2st64_b32 v[64:65], v11 offset0:32 offset1:33
    ds_read2st64_b32 v[66:67], v11 offset0:34 offset1:35
    ds_read2st64_b32 v[68:69], v11 offset0:36 offset1:37
    ds_read2st64_b32 v[70:71], v11 offset0:38 offset1:39
    ds_read2st64_b32 v[72:73], v11 offset0:40 offset1:41
    ds_read2st64_b32 v[74:75], v11 offset0:42 offset1:43
    ds_read2st64_b32 v[76:77], v11 offset0:44 offset1:45
    ds_read2st64_b32 v[78:79], v11 offset0:46 offset1:47
    v_mov_b32 v103, v10
    v_mov_b32 v107, v10
    v_mov_b32 v111, v10
    v_mov_b32 v115, v10
    v_mov_b32 v119, v10
    v_mov_b32 v116, v16
    v_add_f32 v17, v17, v21
    v_add_f32 v25, v25, v29
    v_add_f32 v117, v17, v25
    v_add_f32 v18, v18, v22
    v_add_f32 v26, v26, v30
    v_add_f32 v118, v18, v26
    s_waitcnt lgkmcnt(0)
    v_add_f32 v32, v32, v44
    v_add_f32 v56, v56, v68
    v_add_f32 v32, v32, v56
    v_sub_f32 v100, v32, v118
    v_add_f32 v33, v33, v45
    v_add_f32 v57, v57, v69
    v_add_f32 v33, v33, v57
    v_sub_f32 v101, v33, v118
    v_add_f32 v34, v34, v46
    v_add_f32 v58, v58, v70
    v_add_f32 v34, v34, v58
    v_sub_f32 v102, v34, v118
    v_add_f32 v35, v35, v47
    v_add_f32 v59, v59, v71
    v_add_f32 v35, v35, v59
    v_sub_f32 v104, v35, v118
    v_add_f32 v36, v36, v48
    v_add_f32 v60, v60, v72
    v_add_f32 v36, v36, v60
    v_sub_f32 v105, v36, v118
    v_add_f32 v37, v37, v49
    v_add_f32 v61, v61, v73
    v_add_f32 v37, v37, v61
    v_sub_f32 v106, v37, v118
    v_add_f32 v38, v38, v50
    v_add_f32 v62, v62, v74
    v_add_f32 v38, v38, v62
    v_sub_f32 v108, v38, v118
    v_add_f32 v39, v39, v51
    v_add_f32 v63, v63, v75
    v_add_f32 v39, v39, v63
    v_sub_f32 v109, v39, v118
    v_add_f32 v40, v40, v52
    v_add_f32 v64, v64, v76
    v_add_f32 v40, v40, v64
    v_sub_f32 v110, v40, v118
    v_add_f32 v41, v41, v53
    v_add_f32 v65, v65, v77
    v_add_f32 v41, v41, v65
    v_sub_f32 v112, v41, v118
    v_add_f32 v42, v42, v54
    v_add_f32 v66, v66, v78
    v_add_f32 v42, v42, v66
    v_sub_f32 v113, v42, v118
    v_add_f32 v43, v43, v55
    v_add_f32 v67, v67, v79
    v_add_f32 v43, v43, v67
    v_sub_f32 v114, v43, v118
    s_movk_i32 s69, 45
L_fb7:
    s_barrier
    s_sub_u32 s69, s69, 1
    s_cmp_lg_u32 s69, 0
    s_cbranch_scc1 L_fb7
    s_add_u32 s58, s62, 4352
    s_add_u32 s59, s62, 8448
    buffer_store_dwordx4 v[80:83], v9, s[24:27], s58 offen offset:0 sc1 nt
    buffer_store_dwordx4 v[84:87], v9, s[24:27], s58 offen offset:1024 sc1 nt
    buffer_store_dwordx4 v[88:91], v9, s[24:27], s58 offen offset:2048 sc1 nt
    buffer_store_dwordx4 v[92:95], v9, s[24:27], s58 offen offset:3072 sc1 nt
    s_mov_b64 exec, 15
    buffer_store_dwordx4 v[96:99], v14, s[24:27], s59 offen sc1 nt
    s_mov_b64 exec, -1
    s_add_u32 s58, s62, 13056
    s_add_u32 s59, s62, 17152
    buffer_store_dwordx4 v[100:103], v9, s[24:27], s58 offen offset:0 sc1 nt
    buffer_store_dwordx4 v[104:107], v9, s[24:27], s58 offen offset:1024 sc1 nt
    buffer_store_dwordx4 v[108:111], v9, s[24:27], s58 offen offset:2048 sc1 nt
    buffer_store_dwordx4 v[112:115], v9, s[24:27], s58 offen offset:3072 sc1 nt
    s_mov_b64 exec, 15
    buffer_store_dwordx4 v[116:119], v14, s[24:27], s59 offen sc1 nt
    s_mov_b64 exec, -1
    s_barrier
    s_barrier
    s_barrier
    s_waitcnt vmcnt(0)
    buffer_load_dword v15, v7, s[24:27], s62 offen sc1
    s_waitcnt vmcnt(0)
    v_cmp_eq_u32 vcc, v15, v10
    s_nop 4
    s_and_b32 s70, vcc_lo, 3
    s_cbranch_scc0 L_fin
    s_bitcmp1_b32 s70, 0
    s_cbranch_scc0 L_fm30
    s_waitcnt vmcnt(0)
    s_add_u32 s58, s62, 0
    s_add_u32 s59, s62, 4096
    buffer_load_dwordx4 v[136:139], v14, s[24:27], s59 offen sc1 nt
    buffer_load_dwordx4 v[120:123], v9, s[24:27], s58 offen offset:0 sc1 nt
    buffer_load_dwordx4 v[124:127], v9, s[24:27], s58 offen offset:1024 sc1 nt
    buffer_load_dwordx4 v[128:131], v9, s[24:27], s58 offen offset:2048 sc1 nt
    buffer_load_dwordx4 v[132:135], v9, s[24:27], s58 offen offset:3072 sc1 nt
    s_waitcnt vmcnt(0)
    v_xor_b32 v13, v10, v123
    v_xor_b32 v11, v10, v127
    v_or_b32 v13, v13, v11
    v_xor_b32 v11, v10, v131
    v_or_b32 v13, v13, v11
    v_xor_b32 v11, v10, v135
    v_or_b32 v13, v13, v11
    v_xor_b32 v11, v10, v139
    v_or_b32 v13, v13, v11
    v_cmp_ne_u32 vcc, 0, v13
    s_nop 4
    s_cmp_eq_u64 vcc, 0
    s_cbranch_scc0 L_fm30
    v_max_f32 v11, v136, v96
    v_sub_f32 v16, v136, v11
    v_sub_f32 v17, v96, v11
    v_exp_f32 v16, v16
    v_exp_f32 v17, v17
    s_nop 0
    v_mul_f32 v12, v16, v137
    v_fmac_f32 v12, v17, v97
    v_rcp_f32 v12, v12
    s_add_u32 s58, s63, 0
    s_mul_i32 s58, s58, 1536
    v_mul_f32 v16, v16, v12
    v_mul_f32 v17, v17, v12
    v_mul_f32 v32, v120, v16
    v_fmac_f32 v32, v80, v17
    v_mul_f32 v33, v121, v16
    v_fmac_f32 v33, v81, v17
    v_mul_f32 v34, v122, v16
    v_fmac_f32 v34, v82, v17
    v_mul_f32 v35, v124, v16
    v_fmac_f32 v35, v84, v17
    v_mul_f32 v36, v125, v16
    v_fmac_f32 v36, v85, v17
    v_mul_f32 v37, v126, v16
    v_fmac_f32 v37, v86, v17
    v_mul_f32 v38, v128, v16
    v_fmac_f32 v38, v88, v17
    v_mul_f32 v39, v129, v16
    v_fmac_f32 v39, v89, v17
    v_mul_f32 v40, v130, v16
    v_fmac_f32 v40, v90, v17
    v_mul_f32 v41, v132, v16
    v_fmac_f32 v41, v92, v17
    v_mul_f32 v42, v133, v16
    v_fmac_f32 v42, v93, v17
    v_mul_f32 v43, v134, v16
    v_fmac_f32 v43, v94, v17
    v_cvt_pk_bf16_f32 v44, v32, v33
    v_cvt_pk_bf16_f32 v45, v34, v35
    v_cvt_pk_bf16_f32 v46, v36, v37
    v_cvt_pk_bf16_f32 v47, v38, v39
    v_cvt_pk_bf16_f32 v48, v40, v41
    v_cvt_pk_bf16_f32 v49, v42, v43
    buffer_store_dwordx2 v[44:45], v8, s[48:51], s58 offen offset:0
    buffer_store_dwordx2 v[46:47], v8, s[48:51], s58 offen offset:128
    buffer_store_dwordx2 v[48:49], v8, s[48:51], s58 offen offset:256
L_fm30:
    s_bitcmp1_b32 s70, 1
    s_cbranch_scc0 L_fm31
    s_waitcnt vmcnt(0)
    s_add_u32 s58, s62, 8704
    s_add_u32 s59, s62, 12800
    buffer_load_dwordx4 v[136:139], v14, s[24:27], s59 offen sc1 nt
    buffer_load_dwordx4 v[120:123], v9, s[24:27], s58 offen offset:0 sc1 nt
    buffer_load_dwordx4 v[124:127], v9, s[24:27], s58 offen offset:1024 sc1 nt
    buffer_load_dwordx4 v[128:131], v9, s[24:27], s58 offen offset:2048 sc1 nt
    buffer_load_dwordx4 v[132:135], v9, s[24:27], s58 offen offset:3072 sc1 nt
    s_waitcnt vmcnt(0)
    v_xor_b32 v13, v10, v123
    v_xor_b32 v11, v10, v127
    v_or_b32 v13, v13, v11
    v_xor_b32 v11, v10, v131
    v_or_b32 v13, v13, v11
    v_xor_b32 v11, v10, v135
    v_or_b32 v13, v13, v11
    v_xor_b32 v11, v10, v139
    v_or_b32 v13, v13, v11
    v_cmp_ne_u32 vcc, 0, v13
    s_nop 4
    s_cmp_eq_u64 vcc, 0
    s_cbranch_scc0 L_fm31
    v_max_f32 v11, v136, v116
    v_sub_f32 v16, v136, v11
    v_sub_f32 v17, v116, v11
    v_exp_f32 v16, v16
    v_exp_f32 v17, v17
    s_nop 0
    v_mul_f32 v12, v16, v137
    v_fmac_f32 v12, v17, v117
    v_rcp_f32 v12, v12
    s_add_u32 s58, s63, 1
    s_mul_i32 s58, s58, 1536
    v_mul_f32 v16, v16, v12
    v_mul_f32 v17, v17, v12
    v_mul_f32 v32, v120, v16
    v_fmac_f32 v32, v100, v17
    v_mul_f32 v33, v121, v16
    v_fmac_f32 v33, v101, v17
    v_mul_f32 v34, v122, v16
    v_fmac_f32 v34, v102, v17
    v_mul_f32 v35, v124, v16
    v_fmac_f32 v35, v104, v17
    v_mul_f32 v36, v125, v16
    v_fmac_f32 v36, v105, v17
    v_mul_f32 v37, v126, v16
    v_fmac_f32 v37, v106, v17
    v_mul_f32 v38, v128, v16
    v_fmac_f32 v38, v108, v17
    v_mul_f32 v39, v129, v16
    v_fmac_f32 v39, v109, v17
    v_mul_f32 v40, v130, v16
    v_fmac_f32 v40, v110, v17
    v_mul_f32 v41, v132, v16
    v_fmac_f32 v41, v112, v17
    v_mul_f32 v42, v133, v16
    v_fmac_f32 v42, v113, v17
    v_mul_f32 v43, v134, v16
    v_fmac_f32 v43, v114, v17
    v_cvt_pk_bf16_f32 v44, v32, v33
    v_cvt_pk_bf16_f32 v45, v34, v35
    v_cvt_pk_bf16_f32 v46, v36, v37
    v_cvt_pk_bf16_f32 v47, v38, v39
    v_cvt_pk_bf16_f32 v48, v40, v41
    v_cvt_pk_bf16_f32 v49, v42, v43
    buffer_store_dwordx2 v[44:45], v8, s[48:51], s58 offen offset:0
    buffer_store_dwordx2 v[46:47], v8, s[48:51], s58 offen offset:128
    buffer_store_dwordx2 v[48:49], v8, s[48:51], s58 offen offset:256
L_fm31:
L_fin:
L_end:
    s_endpgm
.section .rodata,"a"
.p2align 6
.amdhsa_kernel standalone__kv_cache_quant_int4_int2_kv_with_per_channel_or_per_token_scales__sampling_kernel
  .amdhsa_next_free_vgpr 232
  .amdhsa_next_free_sgpr 102
  .amdhsa_accum_offset 232
  .amdhsa_group_segment_fixed_size 0
  .amdhsa_kernarg_size 80
  .amdhsa_user_sgpr_count 2
  .amdhsa_user_sgpr_kernarg_segment_ptr 1
  .amdhsa_system_sgpr_workgroup_id_x 1
  .amdhsa_float_denorm_mode_32 3
.end_amdhsa_kernel
```

```asm
; @launch grid=(256,1,1) block=(448,1,1) lds=157248
.amdgcn_target "amdgcn-amd-amdhsa--gfx950"
.text
.globl standalone__kv_cache_quant_int4_int2_kv_with_per_channel_or_per_token_scales__sampling_kernel
.p2align 8
.type standalone__kv_cache_quant_int4_int2_kv_with_per_channel_or_per_token_scales__sampling_kernel,@function
standalone__kv_cache_quant_int4_int2_kv_with_per_channel_or_per_token_scales__sampling_kernel:
    s_load_dwordx16 s[4:19], s[0:1], 0
    s_load_dwordx4 s[20:23], s[0:1], 64
    s_cmp_ge_u32 s2, 256
    s_cbranch_scc1 L_end
    v_lshrrev_b32 v2, 6, v0
    v_and_b32 v1, 63, v0
    v_readfirstlane_b32 s56, v2
    s_mov_b32 s72, s2
    s_mov_b32 s50, 0xc2100867
    s_mov_b32 s51, 0x80402046
    v_lshlrev_b32 v3, 3, v1
    v_lshrrev_b64 v[8:9], v3, s[50:51]
    v_and_b32 v8, s2, v8
    v_bcnt_u32_b32 v8, v8, 0
    v_and_b32 v8, 1, v8
    v_cmp_ne_u32 vcc, 0, v8
    v_lshlrev_b32 v8, 4, v1
    v_lshrrev_b32 v11, 5, v1
    s_mov_b32 s26, 805306368
    s_mov_b32 s27, 0x20000
    s_and_b32 s2, vcc_lo, 255
    s_mul_i32 s3, s2, 11184896
    s_add_u32 s3, s3, 43691
    s_lshr_b32 s3, s3, 17
    s_lshl_b32 s58, s3, 3
    s_add_u32 s58, s58, s56
    s_bfe_u32 s59, s58, 327681
    s_and_b32 s60, s58, 1
    s_lshr_b32 s57, s58, 6
    s_lshl_b32 s57, s57, 6
    s_add_u32 s57, s57, s59
    s_lshl_b32 s57, s57, 2
    s_cmp_gt_u32 s59, 10
    s_addc_u32 s58, s60, 0
    s_mul_i32 s58, s58, 43
    s_add_u32 s57, s57, s58
    s_sub_u32 s60, 43, s60
    s_cmp_gt_u32 s59, 21
    s_cselect_b32 s58, s60, 0
    s_add_u32 s57, s57, s58
    s_cmp_eq_u32 s59, 21
    s_cselect_b32 s60, s60, 0
    s_mul_i32 s60, s60, 768
    v_mad_u32_u24 v13, v11, s60, v8
    v_add_u32 v14, s60, v8
    s_mul_i32 m0, s56, 3072
    s_mul_i32 s58, s57, 768
    s_waitcnt lgkmcnt(0)
    s_mov_b32 s24, s6
    s_and_b32 s25, s7, 0xffff
    buffer_load_dwordx4 v8, s[24:27], s58 offen offset:0 nt lds
    buffer_load_dwordx4 v13, s[24:27], s58 offen offset:1024 nt lds
    buffer_load_dwordx4 v14, s[24:27], s58 offen offset:2048 nt lds
    s_getpc_b64 s[50:51]
L_pc0:
    s_and_b32 s52, s72, 0xfc
    s_add_u32 s52, s52, second_item - L_pc0
    s_load_dword s53, s[50:51], s52
    s_mul_i32 s100, s2, 43691
    s_lshr_b32 s100, s100, 17
    s_mul_i32 s101, s100, 3
    s_sub_u32 s101, s2, s101
    s_and_b32 s67, s101, 1
    s_add_u32 s67, s67, 85
    s_cmp_eq_u32 s56, 4
    s_cbranch_scc1 L_loader
    s_cmp_lt_u32 s56, 4
    s_cbranch_scc1 L_consumer
    s_cmp_eq_u32 s56, 6
    s_cbranch_scc1 L_ctl
    s_mov_b32 s44, s4
    s_and_b32 s45, s5, 0xffff
    s_mov_b32 s46, 393216
    s_mov_b32 s47, 0x20000
    s_lshr_b32 s68, s3, 7
    s_mov_b32 s70, 144640
    s_mov_b32 m0, s70
    s_mul_i32 s58, s68, 1536
    s_mov_b32 exec_hi, 0xffff
    buffer_load_dwordx4 v8, s[44:47], s58 offen nt lds
    buffer_load_dwordx4 v8, s[44:47], s58 offen offset:768 nt lds
    s_mov_b32 exec_hi, -1
    s_add_u32 s70, s70, 1536
    s_cmp_eq_u32 s101, 1
    s_cbranch_scc0 L_stq
    s_add_u32 s68, s68, 1
    s_mov_b32 m0, s70
    s_mul_i32 s58, s68, 1536
    s_mov_b32 exec_hi, 0xffff
    buffer_load_dwordx4 v8, s[44:47], s58 offen nt lds
    buffer_load_dwordx4 v8, s[44:47], s58 offen offset:768 nt lds
    s_mov_b32 exec_hi, -1
    s_add_u32 s70, s70, 1536
L_stq:
    s_lshr_b32 s68, s3, 3
    s_lshl_b32 s68, s68, 2
    s_and_b32 s58, s3, 7
    s_addc_u32 s68, s68, 0
    s_mov_b32 s32, s12
    s_and_b32 s33, s13, 0xffff
    s_mov_b32 s34, 6291456
    s_mov_b32 s35, 0x20000
    s_mov_b32 s28, s10
    s_and_b32 s29, s11, 0xffff
    s_mov_b32 s30, 6291456
    s_mov_b32 s31, 0x20000
    s_mul_i32 s59, s68, 384
    s_mov_b32 m0, 74240
    s_nop 0
    buffer_load_dwordx4 v8, s[32:35], s59 offen offset:0 nt lds
    buffer_load_dwordx4 v8, s[32:35], s59 offen offset:1024 nt lds
    buffer_load_dwordx4 v8, s[32:35], s59 offen offset:2048 nt lds
    buffer_load_dwordx4 v8, s[32:35], s59 offen offset:3072 nt lds
    s_mov_b32 m0, 100864
    s_nop 0
    buffer_load_dwordx4 v8, s[28:31], s59 offen offset:0 nt lds
    buffer_load_dwordx4 v8, s[28:31], s59 offen offset:1024 nt lds
    buffer_load_dwordx4 v8, s[28:31], s59 offen offset:2048 nt lds
    buffer_load_dwordx4 v8, s[28:31], s59 offen offset:3072 nt lds
    s_lshl_b32 s58, s72, 3
    s_waitcnt lgkmcnt(0)
    s_lshr_b32 s53, s53, s58
    s_and_b32 s53, s53, 255
    s_mul_i32 s54, s53, 43691
    s_lshr_b32 s54, s54, 17
    s_mul_i32 s55, s54, 3
    s_sub_u32 s55, s53, s55
    s_sub_u32 s73, 2, s55
    s_mul_i32 s73, s73, 85
    s_add_u32 s73, s73, 1
    s_lshr_b32 s73, s73, 1
    s_sub_u32 s58, 255, s54
    s_lshl_b32 s58, s58, 7
    s_add_u32 s73, s73, s58
    s_lshr_b32 s69, s73, 7
    s_mov_b32 m0, s70
    s_mul_i32 s58, s69, 1536
    s_mov_b32 exec_hi, 0xffff
    buffer_load_dwordx4 v8, s[44:47], s58 offen nt lds
    buffer_load_dwordx4 v8, s[44:47], s58 offen offset:768 nt lds
    s_mov_b32 exec_hi, -1
    s_add_u32 s70, s70, 1536
    s_lshr_b32 s69, s73, 3
    s_lshl_b32 s69, s69, 2
    s_and_b32 s58, s73, 7
    s_addc_u32 s69, s69, 0
    s_cmp_eq_u32 s101, 1
    s_cselect_b32 s70, 46, 43
    s_cselect_b32 s71, 2, 0
    s_add_u32 s71, s71, 66
    s_sub_u32 s69, s69, s70
    s_mul_i32 s57, s68, 384
    s_mul_i32 s61, s69, 384
    s_mul_i32 s62, s70, 384
    s_mul_i32 s63, s71, 384
    v_add_u32 v9, 4096, v8
    s_movk_i32 s59, 4096
L_stage0:
    v_cmp_gt_u32 vcc, s62, v9
    v_add_u32 v10, s57, v9
    v_add_u32 v17, s61, v9
    v_cndmask_b32 v10, v17, v10, vcc
    v_cmp_gt_u32 vcc, s63, v9
    s_add_u32 m0, s59, 74240
    v_add_u32 v9, 1024, v9
    s_add_u32 s59, s59, 1024
    s_nop 1
    s_mov_b64 exec, vcc
    buffer_load_dwordx4 v10, s[32:35], 0 offen nt lds
    s_add_u32 m0, m0, 26624
    s_cmp_lt_u32 s59, s63
    buffer_load_dwordx4 v10, s[28:31], 0 offen nt lds
    s_cbranch_scc1 L_stage0
    s_mov_b64 exec, -1
    s_mov_b32 s32, s14
    s_and_b32 s33, s15, 0xffff
    s_mov_b32 s34, 2097152
    s_mov_b32 s35, 0x20000
    s_mov_b32 s28, s16
    s_and_b32 s29, s17, 0xffff
    s_mov_b32 s30, 2097152
    s_mov_b32 s31, 0x20000
    s_mul_i32 s57, s68, 128
    s_mul_i32 s61, s69, 128
    s_mul_i32 s62, s70, 128
    s_mul_i32 s63, s71, 128
    v_add_u32 v9, 0, v8
    s_movk_i32 s59, 0
L_stage1:
    v_cmp_gt_u32 vcc, s62, v9
    v_add_u32 v10, s57, v9
    v_add_u32 v17, s61, v9
    v_cndmask_b32 v10, v17, v10, vcc
    v_cmp_gt_u32 vcc, s63, v9
    s_add_u32 m0, s59, 126976
    v_add_u32 v9, 1024, v9
    s_add_u32 s59, s59, 1024
    s_nop 1
    s_mov_b64 exec, vcc
    buffer_load_dwordx4 v10, s[32:35], 0 offen nt lds
    s_add_u32 m0, m0, 8704
    s_cmp_lt_u32 s59, s63
    buffer_load_dwordx4 v10, s[28:31], 0 offen nt lds
    s_cbranch_scc1 L_stage1
    s_mov_b64 exec, -1
    s_branch L_finisher
L_loader:
    s_setprio 3
    s_lshl_b32 s58, s3, 3
    s_add_u32 s58, s58, 7
    s_bfe_u32 s59, s58, 327681
    s_and_b32 s60, s58, 1
    s_lshr_b32 s57, s58, 6
    s_lshl_b32 s57, s57, 6
    s_add_u32 s57, s57, s59
    s_lshl_b32 s57, s57, 2
    s_cmp_gt_u32 s59, 10
    s_addc_u32 s58, s60, 0
    s_mul_i32 s58, s58, 43
    s_add_u32 s57, s57, s58
    s_sub_u32 s60, 43, s60
    s_cmp_gt_u32 s59, 21
    s_cselect_b32 s58, s60, 0
    s_add_u32 s57, s57, s58
    s_cmp_eq_u32 s59, 21
    s_cselect_b32 s60, s60, 0
    s_mul_i32 s60, s60, 768
    v_mad_u32_u24 v13, v11, s60, v8
    v_add_u32 v14, s60, v8
    s_mul_i32 m0, 7, 3072
    s_mul_i32 s58, s57, 768
    buffer_load_dwordx4 v8, s[24:27], s58 offen offset:0 nt lds
    buffer_load_dwordx4 v13, s[24:27], s58 offen offset:1024 nt lds
    buffer_load_dwordx4 v14, s[24:27], s58 offen offset:2048 nt lds
    s_add_u32 s69, s58, 3072
    s_cmp_gt_u32 s59, 21
    s_cselect_b32 s58, 42, 43
    s_mul_i32 s58, s58, 768
    s_sub_u32 s57, s69, s58
    v_add_u32 v22, 48, v1
    v_lshrrev_b32 v12, 6, v22
    v_mov_b32 v15, v8
    v_mov_b32 v16, v8
    s_add_u32 s68, s59, 1
    s_mov_b32 s62, 24576
    s_mov_b32 s63, 0
    s_mov_b32 s86, 0
    s_mov_b32 s87, 0
    s_mov_b32 s61, 1
    s_mov_b32 s91, s67
    s_mov_b32 s74, 0
    v_mov_b32 v20, 4748
    v_mov_b32 v21, 156928
    ds_write_b32 v21, v20
    s_lshl_b32 s58, s72, 3
    s_waitcnt lgkmcnt(0)
    s_lshr_b32 s53, s53, s58
    s_and_b32 s53, s53, 255
    s_mul_i32 s54, s53, 43691
    s_lshr_b32 s54, s54, 17
    s_mul_i32 s55, s54, 3
    s_sub_u32 s55, s53, s55
    s_sub_u32 s73, 2, s55
    s_mul_i32 s73, s73, 85
    s_add_u32 s73, s73, 1
    s_lshr_b32 s73, s73, 1
    s_sub_u32 s58, 255, s54
    s_lshl_b32 s58, s58, 7
    s_add_u32 s73, s73, s58
    s_mov_b32 s58, 4
    s_branch L_lnobar
L_lw16:
    s_waitcnt vmcnt(16)
L_lw17:
    s_waitcnt vmcnt(17)
L_lw18:
    s_waitcnt vmcnt(18)
L_lw19:
    s_waitcnt vmcnt(19)
L_lw20:
    s_waitcnt vmcnt(20)
L_lw21:
    s_waitcnt vmcnt(21)
L_lw22:
    s_waitcnt vmcnt(22)
    buffer_load_dwordx4 v8, s[24:27], s57 offen offset:0 nt lds
    s_add_u32 s68, s68, 1
    s_and_b32 s58, s68, 31
    s_add_u32 s60, s63, 3072
    s_add_u32 s88, s60, s86
    buffer_load_dwordx4 v13, s[24:27], s57 offen offset:1024 nt lds
    s_add_u32 m0, s62, 3072
    s_add_u32 s89, s60, s87
    s_cmp_eq_u32 s58, 10
    s_cselect_b32 s63, 33024, 0
    s_cmp_eq_u32 s58, 21
    s_cselect_b32 s86, 33024, 0
    s_cselect_b32 s87, 32256, 0
    buffer_load_dwordx4 v8, s[24:27], s69 offen offset:0 nt lds
    s_add_u32 m0, s62, 0
    v_mad_u32_u24 v22, v12, s63, v8
    v_mad_u32_u24 v13, v11, s86, v8
    s_cmp_eq_u32 s70, 22
    s_cbranch_scc1 L_lx1__22
    s_cmp_eq_u32 s70, 21
    s_cbranch_scc1 L_lx1__21
    s_cmp_eq_u32 s70, 20
    s_cbranch_scc1 L_lx1__20
    s_cmp_eq_u32 s70, 19
    s_cbranch_scc1 L_lx1__19
    s_cmp_eq_u32 s70, 18
    s_cbranch_scc1 L_lx1__18
    s_cmp_eq_u32 s70, 17
    s_cbranch_scc1 L_lx1__17
L_lx1__16:
    s_waitcnt vmcnt(16)
L_lx1__17:
    s_waitcnt vmcnt(17)
L_lx1__18:
    s_waitcnt vmcnt(18)
L_lx1__19:
    s_waitcnt vmcnt(19)
L_lx1__20:
    s_waitcnt vmcnt(20)
L_lx1__21:
    s_waitcnt vmcnt(21)
L_lx1__22:
    s_waitcnt vmcnt(22)
    buffer_load_dwordx4 v14, s[24:27], s57 offen offset:2048 nt lds
    s_add_u32 m0, s62, 3072
    v_add_u32 v14, s86, v22
    s_add_u32 s57, s57, s88
    buffer_load_dwordx4 v15, s[24:27], s69 offen offset:1024 nt lds
    v_mad_u32_u24 v15, v11, s87, v8
    buffer_load_dwordx4 v16, s[24:27], s69 offen offset:2048 nt lds
    v_add_u32 v16, s87, v22
    s_add_u32 s69, s69, s89
    s_add_u32 s62, s62, 6144
    s_add_u32 m0, s62, 0
    s_and_b32 s59, s68, 3
    s_cbranch_scc0 L_lunit
L_lad:
    s_cmp_eq_u32 s70, 22
    s_cbranch_scc1 L_lw22
    s_cmp_eq_u32 s70, 21
    s_cbranch_scc1 L_lw21
    s_cmp_eq_u32 s70, 20
    s_cbranch_scc1 L_lw20
    s_cmp_eq_u32 s70, 19
    s_cbranch_scc1 L_lw19
    s_cmp_eq_u32 s70, 18
    s_cbranch_scc1 L_lw18
    s_cmp_eq_u32 s70, 17
    s_cbranch_scc1 L_lw17
    s_branch L_lw16
L_lunit:
    s_waitcnt vmcnt(24)
    s_add_u32 s61, s61, 1
    s_cmp_eq_u32 s61, 2
    s_cbranch_scc1 L_lfirst
L_lbar:
    s_barrier
L_lnobar:
    s_waitcnt lgkmcnt(0)
    v_readfirstlane_b32 s59, v20
    ds_read_b32 v20, v21
    s_cmp_eq_u32 s62, 73728
    s_cselect_b32 s62, 0, s62
    s_add_u32 m0, s62, 0
    s_and_b32 s74, s74, 255
    s_add_u32 s74, s74, s59
    s_lshr_b32 s70, s74, 8
    s_cmp_eq_u32 s61, s91
    s_cselect_b32 s58, 0, s58
    s_cmp_eq_u32 s58, 0
    s_cbranch_scc1 L_lblock
L_lsel:
    s_cmp_eq_u32 s70, 19
    s_cbranch_scc1 L_lw19
    s_cmp_eq_u32 s70, 20
    s_cbranch_scc1 L_lw20
    s_cmp_eq_u32 s70, 18
    s_cbranch_scc1 L_lw18
    s_cmp_le_u32 s70, 22
    s_cbranch_scc1 L_lad
    s_cmp_eq_u32 s70, 23
    s_cbranch_scc1 L_lw23
    s_cmp_eq_u32 s70, 24
    s_cbranch_scc1 L_lw24
    s_branch L_lw25
L_lblock:
    s_add_u32 s57, s57, 32256
    s_add_u32 s69, s57, 33024
    s_cmp_eq_u32 s61, s91
    s_cbranch_scc0 L_lsel
    s_cmp_eq_u32 s61, 256
    s_cbranch_scc1 L_ldone
    s_or_b32 s58, s61, 127
    s_add_u32 s58, s58, 1
    s_add_u32 s91, s67, 128
    s_cmp_eq_u32 s61, 128
    s_cselect_b32 s91, s91, s58
    s_cselect_b32 s68, s3, s73
    s_cbranch_scc0 L_lsame
    s_mov_b32 s24, s8
    s_and_b32 s25, s9, 0xffff
L_lsame:
    s_and_b32 s58, s68, 7
    s_cselect_b32 s57, 43, 0
    s_lshl_b32 s58, s58, 4
    s_sub_u32 s57, s57, s58
    s_lshl_b32 s58, s68, 5
    s_add_u32 s57, s57, s58
    s_mul_i32 s57, s57, 768
    s_add_u32 s69, s57, 33024
    s_lshl_b32 s68, s68, 2
    s_branch L_lsel
L_lfirst:
    s_barrier
    s_branch L_lbar
L_ldone:
    s_waitcnt vmcnt(0)
    s_barrier
    s_endpgm
L_lw23:
    s_waitcnt vmcnt(23)
    buffer_load_dwordx4 v8, s[24:27], s57 offen offset:0 nt lds
    s_add_u32 s68, s68, 1
    s_and_b32 s58, s68, 31
    s_add_u32 s60, s63, 3072
    s_add_u32 s88, s60, s86
    buffer_load_dwordx4 v13, s[24:27], s57 offen offset:1024 nt lds
    s_add_u32 m0, s62, 3072
    s_add_u32 s89, s60, s87
    s_cmp_eq_u32 s58, 10
    s_cselect_b32 s63, 33024, 0
    s_cmp_eq_u32 s58, 21
    s_cselect_b32 s86, 33024, 0
    s_cselect_b32 s87, 32256, 0
    buffer_load_dwordx4 v8, s[24:27], s69 offen offset:0 nt lds
    s_add_u32 m0, s62, 0
    v_mad_u32_u24 v22, v12, s63, v8
    v_mad_u32_u24 v13, v11, s86, v8
L_lx1_23_23:
    s_waitcnt vmcnt(23)
    buffer_load_dwordx4 v14, s[24:27], s57 offen offset:2048 nt lds
    s_add_u32 m0, s62, 3072
    v_add_u32 v14, s86, v22
    s_add_u32 s57, s57, s88
    buffer_load_dwordx4 v15, s[24:27], s69 offen offset:1024 nt lds
    v_mad_u32_u24 v15, v11, s87, v8
    buffer_load_dwordx4 v16, s[24:27], s69 offen offset:2048 nt lds
    v_add_u32 v16, s87, v22
    s_add_u32 s69, s69, s89
    s_add_u32 s62, s62, 6144
    s_add_u32 m0, s62, 0
    s_and_b32 s59, s68, 3
    s_cbranch_scc1 L_lw23
    s_branch L_lunit
L_lw24:
    s_waitcnt vmcnt(24)
    buffer_load_dwordx4 v8, s[24:27], s57 offen offset:0 nt lds
    s_add_u32 s68, s68, 1
    s_and_b32 s58, s68, 31
    s_add_u32 s60, s63, 3072
    s_add_u32 s88, s60, s86
    buffer_load_dwordx4 v13, s[24:27], s57 offen offset:1024 nt lds
    s_add_u32 m0, s62, 3072
    s_add_u32 s89, s60, s87
    s_cmp_eq_u32 s58, 10
    s_cselect_b32 s63, 33024, 0
    s_cmp_eq_u32 s58, 21
    s_cselect_b32 s86, 33024, 0
    s_cselect_b32 s87, 32256, 0
    buffer_load_dwordx4 v8, s[24:27], s69 offen offset:0 nt lds
    s_add_u32 m0, s62, 0
    v_mad_u32_u24 v22, v12, s63, v8
    v_mad_u32_u24 v13, v11, s86, v8
L_lx1_24_24:
    s_waitcnt vmcnt(24)
    buffer_load_dwordx4 v14, s[24:27], s57 offen offset:2048 nt lds
    s_add_u32 m0, s62, 3072
    v_add_u32 v14, s86, v22
    s_add_u32 s57, s57, s88
    buffer_load_dwordx4 v15, s[24:27], s69 offen offset:1024 nt lds
    v_mad_u32_u24 v15, v11, s87, v8
    buffer_load_dwordx4 v16, s[24:27], s69 offen offset:2048 nt lds
    v_add_u32 v16, s87, v22
    s_add_u32 s69, s69, s89
    s_add_u32 s62, s62, 6144
    s_add_u32 m0, s62, 0
    s_and_b32 s59, s68, 3
    s_cbranch_scc1 L_lw24
    s_branch L_lunit
L_lw25:
    s_waitcnt vmcnt(25)
    buffer_load_dwordx4 v8, s[24:27], s57 offen offset:0 nt lds
    s_add_u32 s68, s68, 1
    s_and_b32 s58, s68, 31
    s_add_u32 s60, s63, 3072
    s_add_u32 s88, s60, s86
    buffer_load_dwordx4 v13, s[24:27], s57 offen offset:1024 nt lds
    s_add_u32 m0, s62, 3072
    s_add_u32 s89, s60, s87
    s_cmp_eq_u32 s58, 10
    s_cselect_b32 s63, 33024, 0
    s_cmp_eq_u32 s58, 21
    s_cselect_b32 s86, 33024, 0
    s_cselect_b32 s87, 32256, 0
    buffer_load_dwordx4 v8, s[24:27], s69 offen offset:0 nt lds
    s_add_u32 m0, s62, 0
    v_mad_u32_u24 v22, v12, s63, v8
    v_mad_u32_u24 v13, v11, s86, v8
L_lx1_25_25:
    s_waitcnt vmcnt(25)
    buffer_load_dwordx4 v14, s[24:27], s57 offen offset:2048 nt lds
    s_add_u32 m0, s62, 3072
    v_add_u32 v14, s86, v22
    s_add_u32 s57, s57, s88
    buffer_load_dwordx4 v15, s[24:27], s69 offen offset:1024 nt lds
    v_mad_u32_u24 v15, v11, s87, v8
    buffer_load_dwordx4 v16, s[24:27], s69 offen offset:2048 nt lds
    v_add_u32 v16, s87, v22
    s_add_u32 s69, s69, s89
    s_add_u32 s62, s62, 6144
    s_add_u32 m0, s62, 0
    s_and_b32 s59, s68, 3
    s_cbranch_scc1 L_lw25
    s_branch L_lunit
L_ctl:
    s_sub_u32 s58, s72, 8
    s_cmp_lt_u32 s58, 8
    s_cbranch_scc0 L_ctl_init
    s_getpc_b64 s[44:45]
L_pc:
    s_and_b32 s45, s45, 0xffff
    s_mov_b32 s46, L_end - L_pc
    s_mov_b32 s47, 0x20000
    v_lshlrev_b32 v9, 7, v1
    s_movk_i32 s58, 0
    buffer_load_dword v12, v9, s[44:47], s58 offen
    s_movk_i32 s58, 8192
    buffer_load_dword v13, v9, s[44:47], s58 offen
L_ctl_init:
    s_waitcnt lgkmcnt(0)
    s_mov_b32 s52, s22
    s_and_b32 s53, s23, 0xffff
    s_mov_b32 s54, 16793856
    s_mov_b32 s55, 0x20000
    s_mov_b32 s71, 0
    s_mov_b32 s32, 0
    s_mov_b32 s63, 0
    s_add_u32 s98, s22, 16777216
    s_addc_u32 s99, s23, 0
    s_cmp_lt_u32 s72, 8
    s_cselect_b32 s61, 1, 0
    s_and_b32 s59, s72, 7
    s_lshl_b32 s59, s59, 2
    s_add_u32 s59, s59, 16777216
    v_mov_b32 v8, s59
    v_mov_b32 v10, 156928
    s_memtime s[28:29]
    s_memrealtime s[96:97]
    s_mov_b64 exec, 1
    s_waitcnt vmcnt(0) lgkmcnt(0)
    s_barrier
L_ctl_loop:
    s_barrier
    s_mov_b32 s62, s96
    s_mov_b32 s30, s28
    s_memtime s[28:29]
    s_memrealtime s[96:97]
    s_waitcnt lgkmcnt(0)
    s_sub_u32 s58, s96, s62
    s_mul_i32 s58, s58, 373
    s_sub_u32 s59, s28, s30
    s_lshl_b32 s59, s59, 4
    s_sub_i32 s58, s58, s59
    s_mul_i32 s58, s58, 80
    s_ashr_i32 s31, s58, 12
    s_cmp_eq_u32 s63, 0
    s_cbranch_scc1 L_ctl_set
    s_mov_b32 s58, 0
    s_mov_b32 s33, -5000
    s_sub_i32 s59, s84, s62
    s_add_i32 s60, s59, 5000
    s_cmp_lt_u32 s60, 10000
    s_cselect_b32 s59, s59, 200
    s_add_i32 s58, s58, s59
    s_max_i32 s33, s33, s59
    s_sub_i32 s59, s85, s62
    s_add_i32 s60, s59, 5000
    s_cmp_lt_u32 s60, 10000
    s_cselect_b32 s59, s59, 200
    s_add_i32 s58, s58, s59
    s_max_i32 s33, s33, s59
    s_sub_i32 s59, s86, s62
    s_add_i32 s60, s59, 5000
    s_cmp_lt_u32 s60, 10000
    s_cselect_b32 s59, s59, 200
    s_add_i32 s58, s58, s59
    s_max_i32 s33, s33, s59
    s_sub_i32 s59, s87, s62
    s_add_i32 s60, s59, 5000
    s_cmp_lt_u32 s60, 10000
    s_cselect_b32 s59, s59, 200
    s_add_i32 s58, s58, s59
    s_max_i32 s33, s33, s59
    s_sub_i32 s59, s88, s62
    s_add_i32 s60, s59, 5000
    s_cmp_lt_u32 s60, 10000
    s_cselect_b32 s59, s59, 200
    s_add_i32 s58, s58, s59
    s_max_i32 s33, s33, s59
    s_sub_i32 s59, s89, s62
    s_add_i32 s60, s59, 5000
    s_cmp_lt_u32 s60, 10000
    s_cselect_b32 s59, s59, 200
    s_add_i32 s58, s58, s59
    s_max_i32 s33, s33, s59
    s_sub_i32 s59, s90, s62
    s_add_i32 s60, s59, 5000
    s_cmp_lt_u32 s60, 10000
    s_cselect_b32 s59, s59, 200
    s_add_i32 s58, s58, s59
    s_max_i32 s33, s33, s59
    s_sub_i32 s59, s91, s62
    s_add_i32 s60, s59, 5000
    s_cmp_lt_u32 s60, 10000
    s_cselect_b32 s59, s59, 200
    s_add_i32 s58, s58, s59
    s_max_i32 s33, s33, s59
    s_lshl_b32 s33, s33, 3
    s_sub_i32 s33, s33, s58
    s_sub_i32 s33, s33, 480
    s_max_i32 s33, s33, 0
    s_mul_i32 s33, s33, 7
    s_lshr_b32 s33, s33, 5
    s_min_u32 s33, s33, 256
    s_min_u32 s59, s63, 16
    s_cmp_gt_i32 s58, 0
    s_cselect_b32 s63, s59, s63
    s_mul_i32 s58, s58, s63
    s_ashr_i32 s32, s58, 5
    s_add_i32 s32, s32, s33
L_ctl_set:
    s_sub_i32 s58, s31, s32
    s_add_i32 s58, s58, 4748
    s_max_i32 s58, s58, 4096
    s_min_i32 s70, s58, 6400
    v_mov_b32 v9, s70
    ds_write_b32 v10, v9
    s_and_b32 s58, s71, 768
    s_cselect_b32 s63, 0, 7
    s_cmp_ge_u32 s71, 14848
    s_cselect_b32 s63, 32, s63
    s_cmp_eq_u32 s71, 16128
    s_cselect_b32 s63, 0, s63
    s_mul_i32 s58, s63, s61
    s_cmp_eq_u32 s58, 0
    s_cbranch_scc1 L_ctl_norep
    v_mov_b32 v11, s96
    buffer_store_dword v11, v8, s[52:55], s71 offen sc1
L_ctl_norep:
    s_barrier
    s_barrier
    s_barrier
    s_cmp_eq_u32 s63, 0
    s_cbranch_scc1 L_ctl_nold
    s_load_dwordx8 s[84:91], s[98:99], s71
L_ctl_nold:
    s_add_u32 s71, s71, 256
    s_cmp_lt_u32 s71, 16384
    s_cbranch_scc1 L_ctl_loop
    s_endpgm
L_consumer:
    v_lshrrev_b32 v3, 2, v1
    v_and_b32 v4, 3, v1
    v_mul_u32_u24 v5, 384, v4
    v_lshl_add_u32 v34, v3, 3, v5
    v_add_u32 v34, 144640, v34
    v_lshrrev_b32 v5, 4, v1
    v_lshl_add_u32 v5, v5, 2, v4
    v_lshlrev_b32 v25, 3, v5
    v_add_u32 v25, 74240, v25
    v_lshl_add_u32 v26, v2, 4, v5
    v_lshlrev_b32 v26, 2, v26
    v_add_u32 v26, 73728, v26
    v_lshl_add_u32 v35, v4, 2, v2
    v_lshlrev_b32 v35, 2, v35
    v_add_u32 v35, 156992, v35
    v_and_b32 v3, 3, v3
    v_lshl_add_u32 v24, v2, 2, v3
    v_lshl_add_u32 v27, v2, 2, v24
    v_mul_u32_u24 v27, 768, v27
    v_lshl_add_u32 v27, v5, 4, v27
    s_mov_b32 s64, 0x3fb8aa3b
    s_mov_b32 s65, 0x3d93cd3a
    s_mov_b32 s66, 0xffff0000
    v_mov_b32 v29, 0xff800000
    v_mov_b32 v30, 0xff800000
    v_mov_b32 v31, 0xff800000
    s_mov_b32 s62, 0
    s_lshl_b32 s58, s72, 3
    s_waitcnt lgkmcnt(0)
    s_lshr_b32 s53, s53, s58
    s_and_b32 s53, s53, 255
    s_mul_i32 s54, s53, 43691
    s_lshr_b32 s54, s54, 17
    s_mul_i32 s55, s54, 3
    s_sub_u32 s55, s53, s55
    s_sub_u32 s73, 2, s55
    s_mul_i32 s73, s73, 85
    s_add_u32 s73, s73, 1
    s_lshr_b32 s73, s73, 1
    s_sub_u32 s58, 255, s54
    s_lshl_b32 s58, s58, 7
    s_add_u32 s73, s73, s58
    s_and_b32 s58, s73, 7
    s_cselect_b32 s58, 1, 0
    s_cmp_eq_u32 s101, 1
    s_cselect_b32 s79, 46, 43
    s_cselect_b32 s91, 43, s67
    s_sub_u32 s79, s79, s58
    s_lshl_b32 s79, s79, 6
    s_cmp_eq_u32 s2, 255
    s_cselect_b32 s91, 128, s91
    s_mov_b32 s61, 0
    s_mov_b32 s78, 0
    s_mov_b32 s77, s91
    s_and_b32 s63, s3, 7
    s_cselect_b32 s76, -64, 0
    s_lshl_b32 s63, s63, 4
    s_waitcnt vmcnt(0) lgkmcnt(0)
    s_barrier
    ds_read_b64 v[180:181], v34 offset:0
    ds_read_b64 v[182:183], v34 offset:128
    ds_read_b64 v[184:185], v34 offset:256
    v_add_u32 v34, 1536, v34
    v_add_u32 v5, s63, v24
    v_cmp_le_u32 vcc, 43, v5
    v_add_u32 v32, s76, v5
    v_add_u32 v6, 43, v32
    v_cndmask_b32 v32, v32, v6, vcc
    v_cmp_le_u32 vcc, 86, v5
    v_add_u32 v6, 43, v32
    v_add_u32 v33, 85, v32
    v_cndmask_b32 v32, v32, v6, vcc
    v_cndmask_b32 v33, v6, v33, vcc
    v_lshrrev_b32 v32, 6, v32
    v_mul_u32_u24 v32, 384, v32
    v_add_u32 v32, v32, v25
    v_lshrrev_b32 v33, 6, v33
    v_mul_u32_u24 v33, 384, v33
    v_add_u32 v33, v33, v25
    ds_read_b64 v[132:133], v32 offset:0
    ds_read_b64 v[134:135], v32 offset:26624
    ds_read_b64 v[136:137], v32 offset:128
    ds_read_b64 v[138:139], v32 offset:26752
    ds_read_b64 v[140:141], v32 offset:256
    ds_read_b64 v[142:143], v32 offset:26880
    ds_read_b64 v[144:145], v33 offset:0
    ds_read_b64 v[146:147], v33 offset:26624
    ds_read_b64 v[148:149], v33 offset:128
    ds_read_b64 v[150:151], v33 offset:26752
    ds_read_b64 v[152:153], v33 offset:256
    ds_read_b64 v[154:155], v33 offset:26880
L_kstep:
    s_waitcnt lgkmcnt(0)
    v_lshlrev_b32 v84, 16, v132
    v_and_b32 v85, s66, v132
    v_lshlrev_b32 v86, 16, v133
    v_and_b32 v87, s66, v133
    v_lshlrev_b32 v108, 16, v134
    v_and_b32 v109, s66, v134
    v_lshlrev_b32 v110, 16, v135
    v_and_b32 v111, s66, v135
    v_lshlrev_b32 v88, 16, v136
    v_and_b32 v89, s66, v136
    v_lshlrev_b32 v90, 16, v137
    v_and_b32 v91, s66, v137
    v_lshlrev_b32 v112, 16, v138
    v_and_b32 v113, s66, v138
    v_lshlrev_b32 v114, 16, v139
    v_and_b32 v115, s66, v139
    v_lshlrev_b32 v92, 16, v140
    v_and_b32 v93, s66, v140
    v_lshlrev_b32 v94, 16, v141
    v_and_b32 v95, s66, v141
    v_lshlrev_b32 v116, 16, v142
    v_and_b32 v117, s66, v142
    v_lshlrev_b32 v118, 16, v143
    v_and_b32 v119, s66, v143
    v_lshlrev_b32 v96, 16, v144
    v_and_b32 v97, s66, v144
    v_lshlrev_b32 v98, 16, v145
    v_and_b32 v99, s66, v145
    v_lshlrev_b32 v120, 16, v146
    v_and_b32 v121, s66, v146
    v_lshlrev_b32 v122, 16, v147
    v_and_b32 v123, s66, v147
    v_lshlrev_b32 v100, 16, v148
    v_and_b32 v101, s66, v148
    v_lshlrev_b32 v102, 16, v149
    v_and_b32 v103, s66, v149
    v_lshlrev_b32 v124, 16, v150
    v_and_b32 v125, s66, v150
    v_lshlrev_b32 v126, 16, v151
    v_and_b32 v127, s66, v151
    v_lshlrev_b32 v104, 16, v152
    v_and_b32 v105, s66, v152
    v_lshlrev_b32 v106, 16, v153
    v_and_b32 v107, s66, v153
    v_lshlrev_b32 v128, 16, v154
    v_and_b32 v129, s66, v154
    v_lshlrev_b32 v130, 16, v155
    v_and_b32 v131, s66, v155
    s_barrier
    v_add_u32 v28, s62, v27
    s_add_u32 s62, s62, 24576
    s_cmp_eq_u32 s62, 73728
    s_cselect_b32 s62, 0, s62
    ds_read_b128 v[60:63], v28 offset:0
    ds_read_b128 v[64:67], v28 offset:256
    ds_read_b128 v[68:71], v28 offset:512
    ds_read_b128 v[72:75], v28 offset:3072
    ds_read_b128 v[76:79], v28 offset:3328
    ds_read_b128 v[80:83], v28 offset:3584
    v_add_u32 v46, s78, v26
    s_add_u32 s61, s61, 1
    s_add_u32 s63, s63, 16
    s_and_b32 s63, s63, 127
    s_cselect_b32 s58, 0, 256
    s_add_u32 s76, s76, s58
    s_and_b32 s58, s73, 7
    s_lshl_b32 s58, s58, 4
    s_cmp_eq_u32 s61, s67
    s_cselect_b32 s63, s58, s63
    s_cselect_b32 s76, s79, s76
    s_lshr_b32 s78, s61, 1
    s_lshl_b32 s78, s78, 8
    s_bitcmp1_b32 s61, 0
    s_cselect_b32 s58, 26624, 0
    s_add_u32 s78, s78, s58
    s_waitcnt lgkmcnt(3)
    v_cvt_f32_i32 v60, v60
    v_cvt_f32_i32 v61, v61
    v_cvt_f32_i32 v62, v62
    v_cvt_f32_i32 v63, v63
    v_cvt_f32_i32 v64, v64
    v_cvt_f32_i32 v65, v65
    v_cvt_f32_i32 v66, v66
    v_cvt_f32_i32 v67, v67
    v_cvt_f32_i32 v68, v68
    v_cvt_f32_i32 v69, v69
    v_cvt_f32_i32 v70, v70
    v_cvt_f32_i32 v71, v71
    v_pk_add_f32 v[60:61], v[60:61], v[84:85] neg_lo:[0,1] neg_hi:[0,1]
    v_pk_add_f32 v[62:63], v[62:63], v[86:87] neg_lo:[0,1] neg_hi:[0,1]
    v_pk_add_f32 v[64:65], v[64:65], v[88:89] neg_lo:[0,1] neg_hi:[0,1]
    v_pk_add_f32 v[66:67], v[66:67], v[90:91] neg_lo:[0,1] neg_hi:[0,1]
    v_pk_add_f32 v[68:69], v[68:69], v[92:93] neg_lo:[0,1] neg_hi:[0,1]
    v_pk_add_f32 v[70:71], v[70:71], v[94:95] neg_lo:[0,1] neg_hi:[0,1]
    v_cvt_pk_bf16_f32 v60, 0, v60
    v_cvt_pk_bf16_f32 v61, 0, v61
    v_cvt_pk_bf16_f32 v62, 0, v62
    v_cvt_pk_bf16_f32 v63, 0, v63
    v_cvt_pk_bf16_f32 v64, 0, v64
    v_cvt_pk_bf16_f32 v65, 0, v65
    v_cvt_pk_bf16_f32 v66, 0, v66
    v_cvt_pk_bf16_f32 v67, 0, v67
    v_cvt_pk_bf16_f32 v68, 0, v68
    v_cvt_pk_bf16_f32 v69, 0, v69
    v_cvt_pk_bf16_f32 v70, 0, v70
    v_cvt_pk_bf16_f32 v71, 0, v71
    v_pk_mul_f32 v[60:61], v[60:61], v[108:109]
    v_pk_mul_f32 v[62:63], v[62:63], v[110:111]
    v_pk_mul_f32 v[64:65], v[64:65], v[112:113]
    v_pk_mul_f32 v[66:67], v[66:67], v[114:115]
    v_pk_mul_f32 v[68:69], v[68:69], v[116:117]
    v_pk_mul_f32 v[70:71], v[70:71], v[118:119]
    v_cvt_pk_bf16_f32 v156, v60, v61
    v_cvt_pk_bf16_f32 v157, v62, v63
    v_cvt_pk_bf16_f32 v158, v64, v65
    v_cvt_pk_bf16_f32 v159, v66, v67
    v_cvt_pk_bf16_f32 v160, v68, v69
    v_cvt_pk_bf16_f32 v161, v70, v71
    v_mfma_f32_16x16x16_bf16 v[168:171], v[156:157], v[180:181], 0
    v_mfma_f32_16x16x16_bf16 v[168:171], v[158:159], v[182:183], v[168:171]
    v_mfma_f32_16x16x16_bf16 v[168:171], v[160:161], v[184:185], v[168:171]
    s_waitcnt lgkmcnt(0)
    v_cvt_f32_i32 v72, v72
    v_cvt_f32_i32 v73, v73
    v_cvt_f32_i32 v74, v74
    v_cvt_f32_i32 v75, v75
    v_cvt_f32_i32 v76, v76
    v_cvt_f32_i32 v77, v77
    v_cvt_f32_i32 v78, v78
    v_cvt_f32_i32 v79, v79
    v_cvt_f32_i32 v80, v80
    v_cvt_f32_i32 v81, v81
    v_cvt_f32_i32 v82, v82
    v_cvt_f32_i32 v83, v83
    v_pk_add_f32 v[72:73], v[72:73], v[96:97] neg_lo:[0,1] neg_hi:[0,1]
    v_pk_add_f32 v[74:75], v[74:75], v[98:99] neg_lo:[0,1] neg_hi:[0,1]
    v_pk_add_f32 v[76:77], v[76:77], v[100:101] neg_lo:[0,1] neg_hi:[0,1]
    v_pk_add_f32 v[78:79], v[78:79], v[102:103] neg_lo:[0,1] neg_hi:[0,1]
    v_pk_add_f32 v[80:81], v[80:81], v[104:105] neg_lo:[0,1] neg_hi:[0,1]
    v_pk_add_f32 v[82:83], v[82:83], v[106:107] neg_lo:[0,1] neg_hi:[0,1]
    v_cvt_pk_bf16_f32 v72, 0, v72
    v_cvt_pk_bf16_f32 v73, 0, v73
    v_cvt_pk_bf16_f32 v74, 0, v74
    v_cvt_pk_bf16_f32 v75, 0, v75
    v_cvt_pk_bf16_f32 v76, 0, v76
    v_cvt_pk_bf16_f32 v77, 0, v77
    v_cvt_pk_bf16_f32 v78, 0, v78
    v_cvt_pk_bf16_f32 v79, 0, v79
    v_cvt_pk_bf16_f32 v80, 0, v80
    v_cvt_pk_bf16_f32 v81, 0, v81
    v_cvt_pk_bf16_f32 v82, 0, v82
    v_cvt_pk_bf16_f32 v83, 0, v83
    v_pk_mul_f32 v[72:73], v[72:73], v[120:121]
    v_pk_mul_f32 v[74:75], v[74:75], v[122:123]
    v_pk_mul_f32 v[76:77], v[76:77], v[124:125]
    v_pk_mul_f32 v[78:79], v[78:79], v[126:127]
    v_pk_mul_f32 v[80:81], v[80:81], v[128:129]
    v_pk_mul_f32 v[82:83], v[82:83], v[130:131]
    v_cvt_pk_bf16_f32 v162, v72, v73
    v_cvt_pk_bf16_f32 v163, v74, v75
    v_add_f32_dpp v3, v169, v168 row_ror:12 row_mask:0xf bank_mask:0xf
    v_cvt_pk_bf16_f32 v164, v76, v77
    v_cvt_pk_bf16_f32 v165, v78, v79
    v_add_f32_dpp v3, v170, v3 row_ror:8 row_mask:0xf bank_mask:0xf
    v_cvt_pk_bf16_f32 v166, v80, v81
    v_cvt_pk_bf16_f32 v167, v82, v83
    v_add_f32_dpp v30, v171, v3 row_ror:4 row_mask:0xf bank_mask:0x1
    v_mfma_f32_16x16x16_bf16 v[172:175], v[162:163], v[180:181], 0
    v_mfma_f32_16x16x16_bf16 v[172:175], v[164:165], v[182:183], v[172:175]
    v_mfma_f32_16x16x16_bf16 v[172:175], v[166:167], v[184:185], v[172:175]
    v_add_u32 v5, s63, v24
    v_cmp_le_u32 vcc, 43, v5
    v_add_u32 v32, s76, v5
    v_add_u32 v6, 43, v32
    v_cndmask_b32 v32, v32, v6, vcc
    v_cmp_le_u32 vcc, 86, v5
    v_add_u32 v6, 43, v32
    v_add_u32 v33, 85, v32
    v_cndmask_b32 v32, v32, v6, vcc
    v_cndmask_b32 v33, v6, v33, vcc
    v_lshrrev_b32 v32, 6, v32
    v_mul_u32_u24 v32, 384, v32
    v_add_u32 v32, v32, v25
    v_lshrrev_b32 v33, 6, v33
    v_mul_u32_u24 v33, 384, v33
    v_add_u32 v33, v33, v25
    ds_read_b64 v[132:133], v32 offset:0
    ds_read_b64 v[134:135], v32 offset:26624
    ds_read_b64 v[136:137], v32 offset:128
    ds_read_b64 v[138:139], v32 offset:26752
    v_add_f32_dpp v4, v173, v172 row_ror:12 row_mask:0xf bank_mask:0xf
    ds_read_b64 v[140:141], v32 offset:256
    ds_read_b64 v[142:143], v32 offset:26880
    v_add_f32_dpp v4, v174, v4 row_ror:8 row_mask:0xf bank_mask:0xf
    ds_read_b64 v[144:145], v33 offset:0
    ds_read_b64 v[146:147], v33 offset:26624
    ds_read_b64 v[148:149], v33 offset:128
    ds_read_b64 v[150:151], v33 offset:26752
    ds_read_b64 v[152:153], v33 offset:256
    ds_read_b64 v[154:155], v33 offset:26880
    v_add_f32_dpp v31, v175, v4 row_ror:4 row_mask:0xf bank_mask:0x1
    v_cvt_pk_bf16_f32 v3, 0, v30
    v_cvt_pk_bf16_f32 v4, 0, v31
    v_mul_f32 v3, s65, v3
    v_mul_f32 v4, s65, v4
    v_cvt_pk_bf16_f32 v5, v3, v4
    v_max3_f32 v29, v29, v3, v4
    s_mov_b32 exec_lo, 0x000f000f
    s_mov_b32 exec_hi, 0x000f000f
    ds_write_b32 v46, v5
    s_mov_b64 exec, -1
    s_cmp_eq_u32 s61, s77
    s_cbranch_scc0 L_kstep
    v_mov_b32 v3, v29
    s_nop 1
    v_permlane16_swap_b32 v29, v3
    v_max_f32 v29, v29, v3
    v_mov_b32 v3, v29
    s_nop 1
    v_permlane32_swap_b32 v29, v3
    v_max_f32 v29, v29, v3
    v_cvt_pk_bf16_f32 v29, 0, v29
    v_mul_f32 v29, s64, v29
    s_waitcnt lgkmcnt(0)
    s_mov_b64 exec, 15
    ds_write_b32 v35, v29
    s_mov_b64 exec, -1
    ds_read_b64 v[180:181], v34 offset:0
    ds_read_b64 v[182:183], v34 offset:128
    ds_read_b64 v[184:185], v34 offset:256
    v_add_u32 v34, 1536, v34
    v_add_u32 v35, 64, v35
    v_mov_b32 v29, 0xff800000
    s_add_u32 s77, s77, s91
    s_min_u32 s77, s77, 128
    s_cmp_lt_u32 s61, 128
    s_cbranch_scc1 L_kstep
    v_lshrrev_b32 v3, 4, v1
    v_and_b32 v4, 15, v1
    v_lshl_add_u32 v24, v2, 2, v3
    v_lshl_add_u32 v27, v2, 2, v24
    v_mul_u32_u24 v27, 768, v27
    v_lshl_add_u32 v27, v4, 4, v27
    v_and_b32 v3, 3, v1
    v_lshlrev_b32 v41, 4, v3
    v_add_u32 v35, 156992, v41
    v_add_u32 v39, 144384, v41
    v_lshl_add_u32 v37, v2, 6, v39
    v_lshl_add_u32 v41, v2, 6, v41
    v_add_u32 v41, 3072, v41
    v_mul_u32_u24 v36, 3072, v2
    v_lshl_add_u32 v36, v1, 4, v36
    v_add_u32 v36, 144640, v36
    v_lshlrev_b32 v4, 10, v2
    v_lshl_add_u32 v40, v1, 4, v4
    v_lshl_add_u32 v38, v1, 2, v4
    v_add_u32 v38, 144640, v38
    v_mul_u32_u24 v42, 384, v3
    v_lshrrev_b32 v4, 2, v1
    v_lshl_add_u32 v42, v4, 3, v42
    v_lshl_add_u32 v42, v2, 7, v42
    s_mov_b32 s48, s18
    s_and_b32 s49, s19, 0xffff
    s_mov_b32 s50, 393216
    s_mov_b32 s51, 0x20000
    s_mov_b32 s24, s22
    s_and_b32 s25, s23, 0xffff
    s_mov_b32 s26, 848640
    s_mov_b32 s27, 0x20000
    s_mul_i32 s68, s54, 9984
    s_mul_i32 s71, s53, 3328
    s_add_u32 s69, s68, 3328
    s_add_u32 s70, s68, 6656
    s_sub_u32 s57, 255, s54
    s_mul_i32 s57, s57, 1536
    s_mov_b32 s84, 0x7060500
    s_mov_b32 s85, 0x7060501
    s_mov_b32 s86, 0x7060502
    s_mov_b32 s87, 0x7060503
    s_mov_b32 s88, 0x0c0c0400
    s_mov_b32 s89, 0x04000c0c
    s_mov_b32 s90, 0xffffff00
    s_mov_b32 s61, 0
    s_mov_b32 s78, 0
    s_mov_b32 s77, s91
    s_and_b32 s63, s3, 7
    s_cselect_b32 s76, -64, 0
    s_lshl_b32 s63, s63, 4
    s_waitcnt lgkmcnt(0)
    v_mov_b32 v168, 0
    v_mov_b32 v169, 0
    v_mov_b32 v170, 0
    v_mov_b32 v171, 0
    s_barrier
L_vround:
    v_mov_b32 v180, 0
    v_mov_b32 v181, 0
    v_mov_b32 v182, 0
    v_mov_b32 v183, 0
    v_mov_b32 v184, 0
    v_mov_b32 v185, 0
    v_mov_b32 v186, 0
    v_mov_b32 v187, 0
    v_mov_b32 v188, 0
    v_mov_b32 v189, 0
    v_mov_b32 v190, 0
    v_mov_b32 v191, 0
    v_mov_b32 v44, 0
    v_mov_b32 v45, 0
L_vstep:
    v_add_u32 v5, s63, v24
    v_cmp_le_u32 vcc, 43, v5
    v_add_u32 v47, s76, v5
    v_add_u32 v6, 43, v47
    v_cndmask_b32 v47, v47, v6, vcc
    v_cmp_le_u32 vcc, 86, v5
    v_add_u32 v6, 43, v47
    v_add_u32 v48, 85, v47
    v_cndmask_b32 v47, v47, v6, vcc
    v_cndmask_b32 v48, v6, v48, vcc
    v_add_u32 v46, s78, v26
    s_mov_b32 s58, 126976
    v_lshl_add_u32 v47, v47, 1, s58
    v_lshl_add_u32 v48, v48, 1, s58
    ds_read_b128 v[176:179], v35
    ds_read_b32 v46, v46
    ds_read_u16 v49, v47 offset:8704
    ds_read_u16 v50, v48 offset:8704
    ds_read_u16 v47, v47
    ds_read_u16 v48, v48
    s_add_u32 s61, s61, 1
    s_add_u32 s63, s63, 16
    s_and_b32 s63, s63, 127
    s_cselect_b32 s58, 0, 256
    s_add_u32 s76, s76, s58
    s_and_b32 s58, s73, 7
    s_lshl_b32 s58, s58, 4
    s_cmp_eq_u32 s61, s67
    s_cselect_b32 s63, s58, s63
    s_cselect_b32 s76, s79, s76
    s_lshr_b32 s78, s61, 1
    s_lshl_b32 s78, s78, 8
    s_bitcmp1_b32 s61, 0
    s_cselect_b32 s58, 26624, 0
    s_add_u32 s78, s78, s58
    s_waitcnt lgkmcnt(4)
    v_max_f32 v29, v176, v177
    v_max3_f32 v29, v29, v178, v179
    v_lshlrev_b32 v51, 16, v46
    v_and_b32 v52, s66, v46
    v_fma_f32 v51, v51, s64, -v29
    v_fma_f32 v52, v52, s64, -v29
    v_exp_f32 v51, v51
    v_exp_f32 v52, v52
    s_waitcnt lgkmcnt(0)
    v_lshlrev_b32 v53, 16, v47
    v_lshlrev_b32 v54, 16, v48
    v_mul_f32 v53, v51, v53
    v_mul_f32 v54, v52, v54
    v_add_f32 v44, v44, v51
    v_cvt_pk_bf16_f32 v53, v53, v54
    v_add_f32 v44, v44, v52
    v_lshlrev_b32 v55, 16, v49
    v_lshlrev_b32 v56, 16, v50
    v_lshlrev_b32 v51, 16, v53
    v_and_b32 v52, s66, v53
    v_fmac_f32 v45, v51, v55
    v_fmac_f32 v45, v52, v56
    v_mov_b32_dpp v168, v53 quad_perm:[0,1,2,3] row_mask:0xf bank_mask:0x1
    v_mov_b32_dpp v169, v53 quad_perm:[0,1,2,3] row_mask:0xf bank_mask:0x2
    v_mov_b32_dpp v170, v53 quad_perm:[0,1,2,3] row_mask:0xf bank_mask:0x4
    v_mov_b32_dpp v171, v53 quad_perm:[0,1,2,3] row_mask:0xf bank_mask:0x8
    s_cmp_eq_u32 s61, s77
    s_cbranch_scc0 L_vnostat
    v_mov_b32 v43, 156932
    ds_read_b32 v43, v43
    v_mov_b32 v3, v44
    s_nop 1
    v_permlane16_swap_b32 v44, v3
    v_add_f32 v44, v44, v3
    v_mov_b32 v3, v44
    s_nop 1
    v_permlane32_swap_b32 v44, v3
    v_add_f32 v44, v44, v3
    v_mov_b32 v3, v45
    s_nop 1
    v_permlane16_swap_b32 v45, v3
    v_add_f32 v45, v45, v3
    v_mov_b32 v3, v45
    s_nop 1
    v_permlane32_swap_b32 v45, v3
    v_add_f32 v45, v45, v3
    v_mov_b32 v176, v29
    v_mov_b32 v177, v44
    v_mov_b32 v178, v45
    ds_write_b128 v37, v[176:179]
    v_add_u32 v35, 64, v35
L_vnostat:
    s_cmp_eq_u32 s61, 1
    s_cbranch_scc1 L_vnobar
    s_barrier
L_vnobar:
    v_add_u32 v28, s62, v27
    s_add_u32 s62, s62, 24576
    s_cmp_eq_u32 s62, 73728
    s_cselect_b32 s62, 0, s62
    ds_read_b128 v[60:63], v28 offset:0
    ds_read_b128 v[72:75], v28 offset:3072
    ds_read_b128 v[64:67], v28 offset:256
    ds_read_b128 v[76:79], v28 offset:3328
    ds_read_b128 v[68:71], v28 offset:512
    ds_read_b128 v[80:83], v28 offset:3584
    s_waitcnt lgkmcnt(4)
    v_cvt_f32_i32 v60, v60
    v_cvt_f32_i32 v61, v61
    v_cvt_f32_i32 v62, v62
    v_cvt_f32_i32 v63, v63
    v_cvt_f32_i32 v72, v72
    v_cvt_f32_i32 v73, v73
    v_cvt_f32_i32 v74, v74
    v_cvt_f32_i32 v75, v75
    v_cvt_pk_bf16_f32 v156, v60, v72
    v_cvt_pk_bf16_f32 v157, v61, v73
    v_cvt_pk_bf16_f32 v158, v62, v74
    v_cvt_pk_bf16_f32 v159, v63, v75
    s_waitcnt lgkmcnt(2)
    v_cvt_f32_i32 v64, v64
    v_cvt_f32_i32 v65, v65
    v_mfma_f32_16x16x32_bf16 v[180:183], v[168:171], v[156:159], v[180:183]
    v_cvt_f32_i32 v66, v66
    v_cvt_f32_i32 v67, v67
    v_cvt_f32_i32 v76, v76
    v_cvt_f32_i32 v77, v77
    v_cvt_f32_i32 v78, v78
    v_cvt_f32_i32 v79, v79
    v_cvt_pk_bf16_f32 v160, v64, v76
    v_cvt_pk_bf16_f32 v161, v65, v77
    v_cvt_pk_bf16_f32 v162, v66, v78
    v_cvt_pk_bf16_f32 v163, v67, v79
    s_waitcnt lgkmcnt(0)
    v_cvt_f32_i32 v68, v68
    v_cvt_f32_i32 v69, v69
    v_mfma_f32_16x16x32_bf16 v[184:187], v[168:171], v[160:163], v[184:187]
    v_cvt_f32_i32 v70, v70
    v_cvt_f32_i32 v71, v71
    v_cvt_f32_i32 v80, v80
    v_cvt_f32_i32 v81, v81
    v_cvt_f32_i32 v82, v82
    v_cvt_f32_i32 v83, v83
    v_cvt_pk_bf16_f32 v164, v68, v80
    v_cvt_pk_bf16_f32 v165, v69, v81
    v_cvt_pk_bf16_f32 v166, v70, v82
    v_cvt_pk_bf16_f32 v167, v71, v83
    s_cmp_eq_u32 s61, s77
    s_nop 0
    v_mfma_f32_16x16x32_bf16 v[188:191], v[168:171], v[164:167], v[188:191]
    s_cbranch_scc0 L_vstep
    ds_write_b128 v36, v[180:183]
    ds_write_b128 v36, v[184:187] offset:1024
    s_add_u32 s77, s77, s91
    s_min_u32 s77, s77, 128
    s_cmp_lt_u32 s61, 128
    s_nop 1
    ds_write_b128 v36, v[188:191] offset:2048
    s_waitcnt lgkmcnt(0)
    s_cbranch_scc1 L_vround
    s_barrier
    s_cmp_eq_u32 s56, 3
    s_cbranch_scc1 L_fin
    ds_read_b128 v[60:63], v39 offset:0
    ds_read_b128 v[64:67], v39 offset:64
    ds_read_b128 v[68:71], v39 offset:128
    ds_read_b128 v[72:75], v39 offset:192
    ds_read2st64_b32 v[84:85], v38 offset0:0 offset1:1
    ds_read2st64_b32 v[86:87], v38 offset0:2 offset1:3
    ds_read2st64_b32 v[88:89], v38 offset0:12 offset1:13
    ds_read2st64_b32 v[90:91], v38 offset0:14 offset1:15
    ds_read2st64_b32 v[92:93], v38 offset0:24 offset1:25
    ds_read2st64_b32 v[94:95], v38 offset0:26 offset1:27
    ds_read2st64_b32 v[96:97], v38 offset0:36 offset1:37
    ds_read2st64_b32 v[98:99], v38 offset0:38 offset1:39
    s_cmp_eq_u32 s55, 0
    s_cbranch_scc0 L_rp10
    buffer_load_dwordx4 v[192:195], v41, s[24:27], s69 offen sc1
    buffer_load_dwordx4 v[200:203], v41, s[24:27], s70 offen sc1
    buffer_load_dwordx4 v[188:191], v40, s[24:27], s69 offen sc1
    buffer_load_dwordx4 v[196:199], v40, s[24:27], s70 offen sc1
    s_branch L_rp12
L_rp10:
    s_cmp_eq_u32 s55, 1
    s_cbranch_scc0 L_rp11
    buffer_load_dwordx4 v[184:187], v41, s[24:27], s68 offen sc1
    buffer_load_dwordx4 v[200:203], v41, s[24:27], s70 offen sc1
    buffer_load_dwordx4 v[180:183], v40, s[24:27], s68 offen sc1
    buffer_load_dwordx4 v[196:199], v40, s[24:27], s70 offen sc1
    s_branch L_rp12
L_rp11:
    buffer_load_dwordx4 v[184:187], v41, s[24:27], s68 offen sc1
    buffer_load_dwordx4 v[192:195], v41, s[24:27], s69 offen sc1
    buffer_load_dwordx4 v[180:183], v40, s[24:27], s68 offen sc1
    buffer_load_dwordx4 v[188:191], v40, s[24:27], s69 offen sc1
L_rp12:
    s_waitcnt lgkmcnt(8)
    v_add_f32 v61, v61, v65
    v_add_f32 v69, v69, v73
    v_add_f32 v62, v62, v66
    v_add_f32 v70, v70, v74
    v_add_f32 v61, v61, v69
    v_add_f32 v62, v62, v70
    v_mov_b32 v63, v43
    s_waitcnt lgkmcnt(4)
    v_add_f32 v84, v84, v88
    v_add_f32 v85, v85, v89
    v_add_f32 v86, v86, v90
    v_add_f32 v87, v87, v91
    s_waitcnt lgkmcnt(0)
    v_add_f32 v92, v92, v96
    v_add_f32 v93, v93, v97
    v_add_f32 v94, v94, v98
    v_add_f32 v95, v95, v99
    v_add_f32 v84, v84, v92
    v_add_f32 v85, v85, v93
    v_add_f32 v86, v86, v94
    v_add_f32 v87, v87, v95
    v_sub_f32 v84, v84, v62
    v_sub_f32 v85, v85, v62
    v_sub_f32 v86, v86, v62
    v_sub_f32 v87, v87, v62
    s_cmp_eq_u32 s2, 255
    s_cbranch_scc1 L_rsolo
    v_perm_b32 v84, v84, v43, s84
    v_perm_b32 v85, v85, v43, s85
    v_perm_b32 v86, v86, v43, s86
    v_perm_b32 v87, v87, v43, s87
    buffer_store_dwordx4 v[84:87], v40, s[24:27], s71 offen sc1
    s_mov_b64 exec, 15
    buffer_store_dwordx4 v[60:63], v41, s[24:27], s71 offen sc1
    s_mov_b64 exec, -1
    s_cmp_eq_u32 s55, 0
    s_cbranch_scc0 L_rp20
    v_mov_b32 v180, v84
    v_mov_b32 v184, v60
    v_mov_b32 v181, v85
    v_mov_b32 v185, v61
    v_mov_b32 v182, v86
    v_mov_b32 v186, v62
    v_mov_b32 v183, v87
    v_mov_b32 v187, v63
    s_branch L_rp22
L_rp20:
    s_cmp_eq_u32 s55, 1
    s_cbranch_scc0 L_rp21
    v_mov_b32 v188, v84
    v_mov_b32 v192, v60
    v_mov_b32 v189, v85
    v_mov_b32 v193, v61
    v_mov_b32 v190, v86
    v_mov_b32 v194, v62
    v_mov_b32 v191, v87
    v_mov_b32 v195, v63
    s_branch L_rp22
L_rp21:
    v_mov_b32 v196, v84
    v_mov_b32 v200, v60
    v_mov_b32 v197, v85
    v_mov_b32 v201, v61
    v_mov_b32 v198, v86
    v_mov_b32 v202, v62
    v_mov_b32 v199, v87
    v_mov_b32 v203, v63
L_rp22:
    s_waitcnt vmcnt(4)
    v_xor_b32 v64, v187, v43
    v_xor_b32 v65, v195, v43
    v_xor_b32 v66, v203, v43
    v_or3_b32 v4, v64, v65, v66
    s_waitcnt vmcnt(2)
    v_perm_b32 v5, v181, v180, s88
    v_perm_b32 v6, v183, v182, s89
    v_bitop3_b32 v5, v5, v6, v43 bitop3:0x56
    v_or_b32 v4, v4, v5
    v_perm_b32 v5, v189, v188, s88
    v_perm_b32 v6, v191, v190, s89
    v_bitop3_b32 v5, v5, v6, v43 bitop3:0x56
    v_or_b32 v4, v4, v5
    v_perm_b32 v5, v197, v196, s88
    v_perm_b32 v6, v199, v198, s89
    v_bitop3_b32 v5, v5, v6, v43 bitop3:0x56
    v_or_b32 v4, v4, v5
    v_cmp_eq_u32 vcc, 0, v4
    s_nop 4
    s_cmp_eq_u64 vcc, -1
    s_cbranch_scc1 L_rmerge
    s_waitcnt vmcnt(0)
    s_cmp_eq_u32 s55, 0
    s_cbranch_scc0 L_rp30
    buffer_load_dwordx4 v[192:195], v41, s[24:27], s69 offen sc1
    buffer_load_dwordx4 v[200:203], v41, s[24:27], s70 offen sc1
    buffer_load_dwordx4 v[188:191], v40, s[24:27], s69 offen sc1
    buffer_load_dwordx4 v[196:199], v40, s[24:27], s70 offen sc1
    s_branch L_rp32
L_rp30:
    s_cmp_eq_u32 s55, 1
    s_cbranch_scc0 L_rp31
    buffer_load_dwordx4 v[184:187], v41, s[24:27], s68 offen sc1
    buffer_load_dwordx4 v[200:203], v41, s[24:27], s70 offen sc1
    buffer_load_dwordx4 v[180:183], v40, s[24:27], s68 offen sc1
    buffer_load_dwordx4 v[196:199], v40, s[24:27], s70 offen sc1
    s_branch L_rp32
L_rp31:
    buffer_load_dwordx4 v[184:187], v41, s[24:27], s68 offen sc1
    buffer_load_dwordx4 v[192:195], v41, s[24:27], s69 offen sc1
    buffer_load_dwordx4 v[180:183], v40, s[24:27], s68 offen sc1
    buffer_load_dwordx4 v[188:191], v40, s[24:27], s69 offen sc1
L_rp32:
    s_waitcnt vmcnt(2)
    v_xor_b32 v64, v187, v43
    v_xor_b32 v65, v195, v43
    v_xor_b32 v66, v203, v43
    v_or3_b32 v4, v64, v65, v66
    s_waitcnt vmcnt(0)
    v_perm_b32 v5, v181, v180, s88
    v_perm_b32 v6, v183, v182, s89
    v_bitop3_b32 v5, v5, v6, v43 bitop3:0x56
    v_or_b32 v4, v4, v5
    v_perm_b32 v5, v189, v188, s88
    v_perm_b32 v6, v191, v190, s89
    v_bitop3_b32 v5, v5, v6, v43 bitop3:0x56
    v_or_b32 v4, v4, v5
    v_perm_b32 v5, v197, v196, s88
    v_perm_b32 v6, v199, v198, s89
    v_bitop3_b32 v5, v5, v6, v43 bitop3:0x56
    v_or_b32 v4, v4, v5
    v_cmp_eq_u32 vcc, 0, v4
L_rmerge:
    v_max3_f32 v3, v184, v192, v200
    v_sub_f32 v184, v184, v3
    v_sub_f32 v192, v192, v3
    v_sub_f32 v200, v200, v3
    v_exp_f32 v184, v184
    v_exp_f32 v192, v192
    v_exp_f32 v200, v200
    s_and_b64 exec, exec, vcc
    s_cbranch_execz L_fin
    v_and_b32 v180, s90, v180
    v_and_b32 v181, s90, v181
    v_and_b32 v182, s90, v182
    v_and_b32 v183, s90, v183
    v_and_b32 v188, s90, v188
    v_and_b32 v189, s90, v189
    v_and_b32 v190, s90, v190
    v_and_b32 v191, s90, v191
    v_and_b32 v196, s90, v196
    v_and_b32 v197, s90, v197
    v_and_b32 v198, s90, v198
    v_and_b32 v199, s90, v199
    v_mul_f32 v61, v184, v185
    v_fmac_f32 v61, v192, v193
    v_fmac_f32 v61, v200, v201
    v_mul_f32 v84, v180, v184
    v_fmac_f32 v84, v188, v192
    v_fmac_f32 v84, v196, v200
    v_mul_f32 v85, v181, v184
    v_fmac_f32 v85, v189, v192
    v_fmac_f32 v85, v197, v200
    v_mul_f32 v86, v182, v184
    v_fmac_f32 v86, v190, v192
    v_fmac_f32 v86, v198, v200
    v_mul_f32 v87, v183, v184
    v_fmac_f32 v87, v191, v192
    v_fmac_f32 v87, v199, v200
L_rsolo:
    v_rcp_f32 v61, v61
    s_nop 0
    v_mul_f32 v84, v84, v61
    v_mul_f32 v85, v85, v61
    v_mul_f32 v86, v86, v61
    v_mul_f32 v87, v87, v61
    v_cvt_pk_bf16_f32 v88, v84, v85
    v_cvt_pk_bf16_f32 v89, v86, v87
    buffer_store_dwordx2 v[88:89], v42, s[48:51], s57 offen
    s_branch L_fin
L_finisher:
    v_and_b32 v14, 3, v1
    v_mul_u32_u24 v8, 384, v14
    v_lshrrev_b32 v13, 2, v1
    v_lshl_add_u32 v8, v13, 3, v8
    v_lshlrev_b32 v9, 4, v1
    v_lshlrev_b32 v14, 4, v14
    s_memrealtime s[96:97]
    s_waitcnt lgkmcnt(0)
    s_mov_b32 s48, s18
    s_and_b32 s49, s19, 0xffff
    s_mov_b32 s50, 393216
    s_mov_b32 s51, 0x20000
    s_mov_b32 s52, s20
    s_and_b32 s53, s21, 0xffff
    s_mov_b32 s54, 256
    s_mov_b32 s55, 0x20000
    s_mov_b32 s24, s22
    s_and_b32 s25, s23, 0xffff
    s_mov_b32 s26, 2528256
    s_mov_b32 s27, 0x20000
L_fk:
    s_waitcnt vmcnt(56)
    s_movk_i32 s69, 6
L_fb1:
    s_barrier
    s_sub_u32 s69, s69, 1
    s_cmp_lg_u32 s69, 0
    s_cbranch_scc1 L_fb1
    s_waitcnt vmcnt(0)
    s_cmp_eq_u32 s2, 0
    s_cbranch_scc0 L_fk2
    s_or_b32 s71, s96, 1
    v_mov_b32 v16, s71
    v_mov_b32 v17, 0
    s_mov_b64 exec, 1
    buffer_atomic_cmpswap v[16:17], v9, s[52:55], 0 offen sc1
    s_mov_b64 exec, -1
L_fk2:
    s_movk_i32 s69, 122
L_fb2:
    s_barrier
    s_sub_u32 s69, s69, 1
    s_cmp_lg_u32 s69, 0
    s_cbranch_scc1 L_fb2
    s_load_dword s71, s[20:21], 0
    s_barrier
    s_waitcnt lgkmcnt(0)
    s_cmp_eq_u32 s71, 0
    s_cbranch_scc0 L_ftag
    s_or_b32 s71, s96, 1
    v_mov_b32 v16, s71
    v_mov_b32 v17, 0
    s_mov_b64 exec, 1
    buffer_atomic_cmpswap v[16:17], v9, s[52:55], 0 offen sc0 sc1
    s_mov_b64 exec, -1
    s_waitcnt vmcnt(0)
    v_readfirstlane_b32 s58, v16
    s_nop 3
    s_cmp_eq_u32 s58, 0
    s_cselect_b32 s71, s71, s58
L_ftag:
    v_mov_b32 v10, s71
    v_mov_b32 v13, 156932
    ds_write_b32 v13, v10
    s_lshr_b32 s63, s101, 1
    s_lshl_b32 s58, s100, 1
    s_add_u32 s63, s63, s58
    s_mul_i32 s62, s63, 8704
    s_add_u32 s62, s62, 1048576
    s_waitcnt lgkmcnt(0)
    s_cmp_eq_u32 s2, 255
    s_cbranch_scc1 L_fin
    s_cmp_eq_u32 s101, 1
    s_cbranch_scc1 L_fmid
    s_movk_i32 s69, 86
L_fb3:
    s_barrier
    s_sub_u32 s69, s69, 1
    s_cmp_lg_u32 s69, 0
    s_cbranch_scc1 L_fb3
    v_add_u32 v13, 144384, v14
    v_lshlrev_b32 v11, 2, v1
    v_add_u32 v11, 144640, v11
    ds_read_b128 v[16:19], v13 offset:0
    ds_read_b128 v[20:23], v13 offset:64
    ds_read_b128 v[24:27], v13 offset:128
    ds_read_b128 v[28:31], v13 offset:192
    ds_read2st64_b32 v[32:33], v11 offset0:0 offset1:1
    ds_read2st64_b32 v[34:35], v11 offset0:2 offset1:3
    ds_read2st64_b32 v[36:37], v11 offset0:4 offset1:5
    ds_read2st64_b32 v[38:39], v11 offset0:6 offset1:7
    ds_read2st64_b32 v[40:41], v11 offset0:8 offset1:9
    ds_read2st64_b32 v[42:43], v11 offset0:10 offset1:11
    ds_read2st64_b32 v[44:45], v11 offset0:12 offset1:13
    ds_read2st64_b32 v[46:47], v11 offset0:14 offset1:15
    s_waitcnt lgkmcnt(4)
    ds_read2st64_b32 v[48:49], v11 offset0:16 offset1:17
    ds_read2st64_b32 v[50:51], v11 offset0:18 offset1:19
    ds_read2st64_b32 v[52:53], v11 offset0:20 offset1:21
    ds_read2st64_b32 v[54:55], v11 offset0:22 offset1:23
    ds_read2st64_b32 v[56:57], v11 offset0:24 offset1:25
    ds_read2st64_b32 v[58:59], v11 offset0:26 offset1:27
    ds_read2st64_b32 v[60:61], v11 offset0:28 offset1:29
    ds_read2st64_b32 v[62:63], v11 offset0:30 offset1:31
    s_waitcnt lgkmcnt(4)
    ds_read2st64_b32 v[64:65], v11 offset0:32 offset1:33
    ds_read2st64_b32 v[66:67], v11 offset0:34 offset1:35
    ds_read2st64_b32 v[68:69], v11 offset0:36 offset1:37
    ds_read2st64_b32 v[70:71], v11 offset0:38 offset1:39
    ds_read2st64_b32 v[72:73], v11 offset0:40 offset1:41
    ds_read2st64_b32 v[74:75], v11 offset0:42 offset1:43
    ds_read2st64_b32 v[76:77], v11 offset0:44 offset1:45
    ds_read2st64_b32 v[78:79], v11 offset0:46 offset1:47
    v_mov_b32 v83, v10
    v_mov_b32 v87, v10
    v_mov_b32 v91, v10
    v_mov_b32 v95, v10
    v_mov_b32 v99, v10
    v_mov_b32 v96, v16
    v_add_f32 v17, v17, v21
    v_add_f32 v25, v25, v29
    v_add_f32 v97, v17, v25
    v_add_f32 v18, v18, v22
    v_add_f32 v26, v26, v30
    v_add_f32 v98, v18, v26
    s_waitcnt lgkmcnt(0)
    v_add_f32 v32, v32, v44
    v_add_f32 v56, v56, v68
    v_add_f32 v32, v32, v56
    v_sub_f32 v80, v32, v98
    v_add_f32 v33, v33, v45
    v_add_f32 v57, v57, v69
    v_add_f32 v33, v33, v57
    v_sub_f32 v81, v33, v98
    v_add_f32 v34, v34, v46
    v_add_f32 v58, v58, v70
    v_add_f32 v34, v34, v58
    v_sub_f32 v82, v34, v98
    v_add_f32 v35, v35, v47
    v_add_f32 v59, v59, v71
    v_add_f32 v35, v35, v59
    v_sub_f32 v84, v35, v98
    v_add_f32 v36, v36, v48
    v_add_f32 v60, v60, v72
    v_add_f32 v36, v36, v60
    v_sub_f32 v85, v36, v98
    v_add_f32 v37, v37, v49
    v_add_f32 v61, v61, v73
    v_add_f32 v37, v37, v61
    v_sub_f32 v86, v37, v98
    v_add_f32 v38, v38, v50
    v_add_f32 v62, v62, v74
    v_add_f32 v38, v38, v62
    v_sub_f32 v88, v38, v98
    v_add_f32 v39, v39, v51
    v_add_f32 v63, v63, v75
    v_add_f32 v39, v39, v63
    v_sub_f32 v89, v39, v98
    v_add_f32 v40, v40, v52
    v_add_f32 v64, v64, v76
    v_add_f32 v40, v40, v64
    v_sub_f32 v90, v40, v98
    v_add_f32 v41, v41, v53
    v_add_f32 v65, v65, v77
    v_add_f32 v41, v41, v65
    v_sub_f32 v92, v41, v98
    v_add_f32 v42, v42, v54
    v_add_f32 v66, v66, v78
    v_add_f32 v42, v42, v66
    v_sub_f32 v93, v42, v98
    v_add_f32 v43, v43, v55
    v_add_f32 v67, v67, v79
    v_add_f32 v43, v43, v67
    v_sub_f32 v94, v43, v98
    s_movk_i32 s69, 42
L_fb4:
    s_barrier
    s_sub_u32 s69, s69, 1
    s_cmp_lg_u32 s69, 0
    s_cbranch_scc1 L_fb4
    s_add_u32 s58, s62, 4352
    s_add_u32 s59, s62, 8448
    buffer_load_dwordx4 v[116:119], v14, s[24:27], s59 offen sc1 nt
    buffer_load_dwordx4 v[100:103], v9, s[24:27], s58 offen offset:0 sc1 nt
    buffer_load_dwordx4 v[104:107], v9, s[24:27], s58 offen offset:1024 sc1 nt
    buffer_load_dwordx4 v[108:111], v9, s[24:27], s58 offen offset:2048 sc1 nt
    buffer_load_dwordx4 v[112:115], v9, s[24:27], s58 offen offset:3072 sc1 nt
    s_barrier
    s_waitcnt vmcnt(0)
    v_xor_b32 v13, v10, v103
    v_xor_b32 v11, v10, v107
    v_or_b32 v13, v13, v11
    v_xor_b32 v11, v10, v111
    v_or_b32 v13, v13, v11
    v_xor_b32 v11, v10, v115
    v_or_b32 v13, v13, v11
    v_xor_b32 v11, v10, v119
    v_or_b32 v13, v13, v11
    v_cmp_ne_u32 vcc, 0, v13
    s_nop 4
    s_cmp_eq_u64 vcc, 0
    s_cbranch_scc1 L_fo7
    s_add_u32 s58, s62, 0
    s_add_u32 s59, s62, 4096
    buffer_store_dwordx4 v[80:83], v9, s[24:27], s58 offen offset:0 sc1 nt
    buffer_store_dwordx4 v[84:87], v9, s[24:27], s58 offen offset:1024 sc1 nt
    buffer_store_dwordx4 v[88:91], v9, s[24:27], s58 offen offset:2048 sc1 nt
    buffer_store_dwordx4 v[92:95], v9, s[24:27], s58 offen offset:3072 sc1 nt
    s_mov_b64 exec, 15
    buffer_store_dwordx4 v[96:99], v14, s[24:27], s59 offen sc1 nt
    s_mov_b64 exec, -1
    s_waitcnt vmcnt(0)
    s_add_u32 s58, s62, 4352
    s_add_u32 s59, s62, 8448
    buffer_load_dwordx4 v[116:119], v14, s[24:27], s59 offen sc1 nt
    buffer_load_dwordx4 v[100:103], v9, s[24:27], s58 offen offset:0 sc1 nt
    buffer_load_dwordx4 v[104:107], v9, s[24:27], s58 offen offset:1024 sc1 nt
    buffer_load_dwordx4 v[108:111], v9, s[24:27], s58 offen offset:2048 sc1 nt
    buffer_load_dwordx4 v[112:115], v9, s[24:27], s58 offen offset:3072 sc1 nt
    s_waitcnt vmcnt(0)
    v_xor_b32 v13, v10, v103
    v_xor_b32 v11, v10, v107
    v_or_b32 v13, v13, v11
    v_xor_b32 v11, v10, v111
    v_or_b32 v13, v13, v11
    v_xor_b32 v11, v10, v115
    v_or_b32 v13, v13, v11
    v_xor_b32 v11, v10, v119
    v_or_b32 v13, v13, v11
    v_cmp_ne_u32 vcc, 0, v13
    s_nop 4
    s_cmp_eq_u64 vcc, 0
    s_cbranch_scc0 L_fin
L_fo7:
    v_max_f32 v11, v96, v116
    v_sub_f32 v16, v96, v11
    v_sub_f32 v17, v116, v11
    v_exp_f32 v16, v16
    v_exp_f32 v17, v17
    s_nop 0
    v_mul_f32 v12, v16, v97
    v_fmac_f32 v12, v17, v117
    v_rcp_f32 v12, v12
    s_add_u32 s58, s63, 0
    s_mul_i32 s58, s58, 1536
    v_mul_f32 v16, v16, v12
    v_mul_f32 v17, v17, v12
    v_mul_f32 v32, v80, v16
    v_fmac_f32 v32, v100, v17
    v_mul_f32 v33, v81, v16
    v_fmac_f32 v33, v101, v17
    v_mul_f32 v34, v82, v16
    v_fmac_f32 v34, v102, v17
    v_mul_f32 v35, v84, v16
    v_fmac_f32 v35, v104, v17
    v_mul_f32 v36, v85, v16
    v_fmac_f32 v36, v105, v17
    v_mul_f32 v37, v86, v16
    v_fmac_f32 v37, v106, v17
    v_mul_f32 v38, v88, v16
    v_fmac_f32 v38, v108, v17
    v_mul_f32 v39, v89, v16
    v_fmac_f32 v39, v109, v17
    v_mul_f32 v40, v90, v16
    v_fmac_f32 v40, v110, v17
    v_mul_f32 v41, v92, v16
    v_fmac_f32 v41, v112, v17
    v_mul_f32 v42, v93, v16
    v_fmac_f32 v42, v113, v17
    v_mul_f32 v43, v94, v16
    v_fmac_f32 v43, v114, v17
    v_cvt_pk_bf16_f32 v44, v32, v33
    v_cvt_pk_bf16_f32 v45, v34, v35
    v_cvt_pk_bf16_f32 v46, v36, v37
    v_cvt_pk_bf16_f32 v47, v38, v39
    v_cvt_pk_bf16_f32 v48, v40, v41
    v_cvt_pk_bf16_f32 v49, v42, v43
    buffer_store_dwordx2 v[44:45], v8, s[48:51], s58 offen offset:0
    buffer_store_dwordx2 v[46:47], v8, s[48:51], s58 offen offset:128
    buffer_store_dwordx2 v[48:49], v8, s[48:51], s58 offen offset:256
    s_branch L_fin
L_fmid:
    v_and_b32 v7, 1, v1
    v_mul_u32_u24 v7, 8704, v7
    v_add_u32 v7, 4108, v7
    s_movk_i32 s69, 44
L_fb5:
    s_barrier
    s_sub_u32 s69, s69, 1
    s_cmp_lg_u32 s69, 0
    s_cbranch_scc1 L_fb5
    v_add_u32 v13, 144384, v14
    v_lshlrev_b32 v11, 2, v1
    v_add_u32 v11, 144640, v11
    ds_read_b128 v[16:19], v13 offset:0
    ds_read_b128 v[20:23], v13 offset:64
    ds_read_b128 v[24:27], v13 offset:128
    ds_read_b128 v[28:31], v13 offset:192
    ds_read2st64_b32 v[32:33], v11 offset0:0 offset1:1
    ds_read2st64_b32 v[34:35], v11 offset0:2 offset1:3
    ds_read2st64_b32 v[36:37], v11 offset0:4 offset1:5
    ds_read2st64_b32 v[38:39], v11 offset0:6 offset1:7
    ds_read2st64_b32 v[40:41], v11 offset0:8 offset1:9
    ds_read2st64_b32 v[42:43], v11 offset0:10 offset1:11
    ds_read2st64_b32 v[44:45], v11 offset0:12 offset1:13
    ds_read2st64_b32 v[46:47], v11 offset0:14 offset1:15
    s_waitcnt lgkmcnt(4)
    ds_read2st64_b32 v[48:49], v11 offset0:16 offset1:17
    ds_read2st64_b32 v[50:51], v11 offset0:18 offset1:19
    ds_read2st64_b32 v[52:53], v11 offset0:20 offset1:21
    ds_read2st64_b32 v[54:55], v11 offset0:22 offset1:23
    ds_read2st64_b32 v[56:57], v11 offset0:24 offset1:25
    ds_read2st64_b32 v[58:59], v11 offset0:26 offset1:27
    ds_read2st64_b32 v[60:61], v11 offset0:28 offset1:29
    ds_read2st64_b32 v[62:63], v11 offset0:30 offset1:31
    s_waitcnt lgkmcnt(4)
    ds_read2st64_b32 v[64:65], v11 offset0:32 offset1:33
    ds_read2st64_b32 v[66:67], v11 offset0:34 offset1:35
    ds_read2st64_b32 v[68:69], v11 offset0:36 offset1:37
    ds_read2st64_b32 v[70:71], v11 offset0:38 offset1:39
    ds_read2st64_b32 v[72:73], v11 offset0:40 offset1:41
    ds_read2st64_b32 v[74:75], v11 offset0:42 offset1:43
    ds_read2st64_b32 v[76:77], v11 offset0:44 offset1:45
    ds_read2st64_b32 v[78:79], v11 offset0:46 offset1:47
    v_mov_b32 v83, v10
    v_mov_b32 v87, v10
    v_mov_b32 v91, v10
    v_mov_b32 v95, v10
    v_mov_b32 v99, v10
    v_mov_b32 v96, v16
    v_add_f32 v17, v17, v21
    v_add_f32 v25, v25, v29
    v_add_f32 v97, v17, v25
    v_add_f32 v18, v18, v22
    v_add_f32 v26, v26, v30
    v_add_f32 v98, v18, v26
    s_waitcnt lgkmcnt(0)
    v_add_f32 v32, v32, v44
    v_add_f32 v56, v56, v68
    v_add_f32 v32, v32, v56
    v_sub_f32 v80, v32, v98
    v_add_f32 v33, v33, v45
    v_add_f32 v57, v57, v69
    v_add_f32 v33, v33, v57
    v_sub_f32 v81, v33, v98
    v_add_f32 v34, v34, v46
    v_add_f32 v58, v58, v70
    v_add_f32 v34, v34, v58
    v_sub_f32 v82, v34, v98
    v_add_f32 v35, v35, v47
    v_add_f32 v59, v59, v71
    v_add_f32 v35, v35, v59
    v_sub_f32 v84, v35, v98
    v_add_f32 v36, v36, v48
    v_add_f32 v60, v60, v72
    v_add_f32 v36, v36, v60
    v_sub_f32 v85, v36, v98
    v_add_f32 v37, v37, v49
    v_add_f32 v61, v61, v73
    v_add_f32 v37, v37, v61
    v_sub_f32 v86, v37, v98
    v_add_f32 v38, v38, v50
    v_add_f32 v62, v62, v74
    v_add_f32 v38, v38, v62
    v_sub_f32 v88, v38, v98
    v_add_f32 v39, v39, v51
    v_add_f32 v63, v63, v75
    v_add_f32 v39, v39, v63
    v_sub_f32 v89, v39, v98
    v_add_f32 v40, v40, v52
    v_add_f32 v64, v64, v76
    v_add_f32 v40, v40, v64
    v_sub_f32 v90, v40, v98
    v_add_f32 v41, v41, v53
    v_add_f32 v65, v65, v77
    v_add_f32 v41, v41, v65
    v_sub_f32 v92, v41, v98
    v_add_f32 v42, v42, v54
    v_add_f32 v66, v66, v78
    v_add_f32 v42, v42, v66
    v_sub_f32 v93, v42, v98
    v_add_f32 v43, v43, v55
    v_add_f32 v67, v67, v79
    v_add_f32 v43, v43, v67
    v_sub_f32 v94, v43, v98
    s_movk_i32 s69, 43
L_fb6:
    s_barrier
    s_sub_u32 s69, s69, 1
    s_cmp_lg_u32 s69, 0
    s_cbranch_scc1 L_fb6
    v_add_u32 v13, 144384, v14
    v_lshlrev_b32 v11, 2, v1
    v_add_u32 v11, 144640, v11
    ds_read_b128 v[16:19], v13 offset:0
    ds_read_b128 v[20:23], v13 offset:64
    ds_read_b128 v[24:27], v13 offset:128
    ds_read_b128 v[28:31], v13 offset:192
    ds_read2st64_b32 v[32:33], v11 offset0:0 offset1:1
    ds_read2st64_b32 v[34:35], v11 offset0:2 offset1:3
    ds_read2st64_b32 v[36:37], v11 offset0:4 offset1:5
    ds_read2st64_b32 v[38:39], v11 offset0:6 offset1:7
    ds_read2st64_b32 v[40:41], v11 offset0:8 offset1:9
    ds_read2st64_b32 v[42:43], v11 offset0:10 offset1:11
    ds_read2st64_b32 v[44:45], v11 offset0:12 offset1:13
    ds_read2st64_b32 v[46:47], v11 offset0:14 offset1:15
    s_waitcnt lgkmcnt(4)
    ds_read2st64_b32 v[48:49], v11 offset0:16 offset1:17
    ds_read2st64_b32 v[50:51], v11 offset0:18 offset1:19
    ds_read2st64_b32 v[52:53], v11 offset0:20 offset1:21
    ds_read2st64_b32 v[54:55], v11 offset0:22 offset1:23
    ds_read2st64_b32 v[56:57], v11 offset0:24 offset1:25
    ds_read2st64_b32 v[58:59], v11 offset0:26 offset1:27
    ds_read2st64_b32 v[60:61], v11 offset0:28 offset1:29
    ds_read2st64_b32 v[62:63], v11 offset0:30 offset1:31
    s_waitcnt lgkmcnt(4)
    ds_read2st64_b32 v[64:65], v11 offset0:32 offset1:33
    ds_read2st64_b32 v[66:67], v11 offset0:34 offset1:35
    ds_read2st64_b32 v[68:69], v11 offset0:36 offset1:37
    ds_read2st64_b32 v[70:71], v11 offset0:38 offset1:39
    ds_read2st64_b32 v[72:73], v11 offset0:40 offset1:41
    ds_read2st64_b32 v[74:75], v11 offset0:42 offset1:43
    ds_read2st64_b32 v[76:77], v11 offset0:44 offset1:45
    ds_read2st64_b32 v[78:79], v11 offset0:46 offset1:47
    v_mov_b32 v103, v10
    v_mov_b32 v107, v10
    v_mov_b32 v111, v10
    v_mov_b32 v115, v10
    v_mov_b32 v119, v10
    v_mov_b32 v116, v16
    v_add_f32 v17, v17, v21
    v_add_f32 v25, v25, v29
    v_add_f32 v117, v17, v25
    v_add_f32 v18, v18, v22
    v_add_f32 v26, v26, v30
    v_add_f32 v118, v18, v26
    s_waitcnt lgkmcnt(0)
    v_add_f32 v32, v32, v44
    v_add_f32 v56, v56, v68
    v_add_f32 v32, v32, v56
    v_sub_f32 v100, v32, v118
    v_add_f32 v33, v33, v45
    v_add_f32 v57, v57, v69
    v_add_f32 v33, v33, v57
    v_sub_f32 v101, v33, v118
    v_add_f32 v34, v34, v46
    v_add_f32 v58, v58, v70
    v_add_f32 v34, v34, v58
    v_sub_f32 v102, v34, v118
    v_add_f32 v35, v35, v47
    v_add_f32 v59, v59, v71
    v_add_f32 v35, v35, v59
    v_sub_f32 v104, v35, v118
    v_add_f32 v36, v36, v48
    v_add_f32 v60, v60, v72
    v_add_f32 v36, v36, v60
    v_sub_f32 v105, v36, v118
    v_add_f32 v37, v37, v49
    v_add_f32 v61, v61, v73
    v_add_f32 v37, v37, v61
    v_sub_f32 v106, v37, v118
    v_add_f32 v38, v38, v50
    v_add_f32 v62, v62, v74
    v_add_f32 v38, v38, v62
    v_sub_f32 v108, v38, v118
    v_add_f32 v39, v39, v51
    v_add_f32 v63, v63, v75
    v_add_f32 v39, v39, v63
    v_sub_f32 v109, v39, v118
    v_add_f32 v40, v40, v52
    v_add_f32 v64, v64, v76
    v_add_f32 v40, v40, v64
    v_sub_f32 v110, v40, v118
    v_add_f32 v41, v41, v53
    v_add_f32 v65, v65, v77
    v_add_f32 v41, v41, v65
    v_sub_f32 v112, v41, v118
    v_add_f32 v42, v42, v54
    v_add_f32 v66, v66, v78
    v_add_f32 v42, v42, v66
    v_sub_f32 v113, v42, v118
    v_add_f32 v43, v43, v55
    v_add_f32 v67, v67, v79
    v_add_f32 v43, v43, v67
    v_sub_f32 v114, v43, v118
    s_movk_i32 s69, 39
L_fb7:
    s_barrier
    s_sub_u32 s69, s69, 1
    s_cmp_lg_u32 s69, 0
    s_cbranch_scc1 L_fb7
    s_add_u32 s58, s62, 4352
    s_add_u32 s59, s62, 8448
    buffer_store_dwordx4 v[80:83], v9, s[24:27], s58 offen offset:0 sc1 nt
    buffer_store_dwordx4 v[84:87], v9, s[24:27], s58 offen offset:1024 sc1 nt
    buffer_store_dwordx4 v[88:91], v9, s[24:27], s58 offen offset:2048 sc1 nt
    buffer_store_dwordx4 v[92:95], v9, s[24:27], s58 offen offset:3072 sc1 nt
    s_mov_b64 exec, 15
    buffer_store_dwordx4 v[96:99], v14, s[24:27], s59 offen sc1 nt
    s_mov_b64 exec, -1
    s_add_u32 s58, s62, 13056
    s_add_u32 s59, s62, 17152
    buffer_store_dwordx4 v[100:103], v9, s[24:27], s58 offen offset:0 sc1 nt
    buffer_store_dwordx4 v[104:107], v9, s[24:27], s58 offen offset:1024 sc1 nt
    buffer_store_dwordx4 v[108:111], v9, s[24:27], s58 offen offset:2048 sc1 nt
    buffer_store_dwordx4 v[112:115], v9, s[24:27], s58 offen offset:3072 sc1 nt
    s_mov_b64 exec, 15
    buffer_store_dwordx4 v[116:119], v14, s[24:27], s59 offen sc1 nt
    s_mov_b64 exec, -1
    s_barrier
    s_barrier
    s_barrier
    s_waitcnt vmcnt(0)
    buffer_load_dword v15, v7, s[24:27], s62 offen sc1
    s_waitcnt vmcnt(0)
    v_cmp_eq_u32 vcc, v15, v10
    s_nop 4
    s_and_b32 s70, vcc_lo, 3
    s_cbranch_scc0 L_fin
    s_bitcmp1_b32 s70, 0
    s_cbranch_scc0 L_fm30
    s_waitcnt vmcnt(0)
    s_add_u32 s58, s62, 0
    s_add_u32 s59, s62, 4096
    buffer_load_dwordx4 v[136:139], v14, s[24:27], s59 offen sc1 nt
    buffer_load_dwordx4 v[120:123], v9, s[24:27], s58 offen offset:0 sc1 nt
    buffer_load_dwordx4 v[124:127], v9, s[24:27], s58 offen offset:1024 sc1 nt
    buffer_load_dwordx4 v[128:131], v9, s[24:27], s58 offen offset:2048 sc1 nt
    buffer_load_dwordx4 v[132:135], v9, s[24:27], s58 offen offset:3072 sc1 nt
    s_waitcnt vmcnt(0)
    v_xor_b32 v13, v10, v123
    v_xor_b32 v11, v10, v127
    v_or_b32 v13, v13, v11
    v_xor_b32 v11, v10, v131
    v_or_b32 v13, v13, v11
    v_xor_b32 v11, v10, v135
    v_or_b32 v13, v13, v11
    v_xor_b32 v11, v10, v139
    v_or_b32 v13, v13, v11
    v_cmp_ne_u32 vcc, 0, v13
    s_nop 4
    s_cmp_eq_u64 vcc, 0
    s_cbranch_scc0 L_fm30
    v_max_f32 v11, v136, v96
    v_sub_f32 v16, v136, v11
    v_sub_f32 v17, v96, v11
    v_exp_f32 v16, v16
    v_exp_f32 v17, v17
    s_nop 0
    v_mul_f32 v12, v16, v137
    v_fmac_f32 v12, v17, v97
    v_rcp_f32 v12, v12
    s_add_u32 s58, s63, 0
    s_mul_i32 s58, s58, 1536
    v_mul_f32 v16, v16, v12
    v_mul_f32 v17, v17, v12
    v_mul_f32 v32, v120, v16
    v_fmac_f32 v32, v80, v17
    v_mul_f32 v33, v121, v16
    v_fmac_f32 v33, v81, v17
    v_mul_f32 v34, v122, v16
    v_fmac_f32 v34, v82, v17
    v_mul_f32 v35, v124, v16
    v_fmac_f32 v35, v84, v17
    v_mul_f32 v36, v125, v16
    v_fmac_f32 v36, v85, v17
    v_mul_f32 v37, v126, v16
    v_fmac_f32 v37, v86, v17
    v_mul_f32 v38, v128, v16
    v_fmac_f32 v38, v88, v17
    v_mul_f32 v39, v129, v16
    v_fmac_f32 v39, v89, v17
    v_mul_f32 v40, v130, v16
    v_fmac_f32 v40, v90, v17
    v_mul_f32 v41, v132, v16
    v_fmac_f32 v41, v92, v17
    v_mul_f32 v42, v133, v16
    v_fmac_f32 v42, v93, v17
    v_mul_f32 v43, v134, v16
    v_fmac_f32 v43, v94, v17
    v_cvt_pk_bf16_f32 v44, v32, v33
    v_cvt_pk_bf16_f32 v45, v34, v35
    v_cvt_pk_bf16_f32 v46, v36, v37
    v_cvt_pk_bf16_f32 v47, v38, v39
    v_cvt_pk_bf16_f32 v48, v40, v41
    v_cvt_pk_bf16_f32 v49, v42, v43
    buffer_store_dwordx2 v[44:45], v8, s[48:51], s58 offen offset:0
    buffer_store_dwordx2 v[46:47], v8, s[48:51], s58 offen offset:128
    buffer_store_dwordx2 v[48:49], v8, s[48:51], s58 offen offset:256
L_fm30:
    s_bitcmp1_b32 s70, 1
    s_cbranch_scc0 L_fm31
    s_waitcnt vmcnt(0)
    s_add_u32 s58, s62, 8704
    s_add_u32 s59, s62, 12800
    buffer_load_dwordx4 v[136:139], v14, s[24:27], s59 offen sc1 nt
    buffer_load_dwordx4 v[120:123], v9, s[24:27], s58 offen offset:0 sc1 nt
    buffer_load_dwordx4 v[124:127], v9, s[24:27], s58 offen offset:1024 sc1 nt
    buffer_load_dwordx4 v[128:131], v9, s[24:27], s58 offen offset:2048 sc1 nt
    buffer_load_dwordx4 v[132:135], v9, s[24:27], s58 offen offset:3072 sc1 nt
    s_waitcnt vmcnt(0)
    v_xor_b32 v13, v10, v123
    v_xor_b32 v11, v10, v127
    v_or_b32 v13, v13, v11
    v_xor_b32 v11, v10, v131
    v_or_b32 v13, v13, v11
    v_xor_b32 v11, v10, v135
    v_or_b32 v13, v13, v11
    v_xor_b32 v11, v10, v139
    v_or_b32 v13, v13, v11
    v_cmp_ne_u32 vcc, 0, v13
    s_nop 4
    s_cmp_eq_u64 vcc, 0
    s_cbranch_scc0 L_fm31
    v_max_f32 v11, v136, v116
    v_sub_f32 v16, v136, v11
    v_sub_f32 v17, v116, v11
    v_exp_f32 v16, v16
    v_exp_f32 v17, v17
    s_nop 0
    v_mul_f32 v12, v16, v137
    v_fmac_f32 v12, v17, v117
    v_rcp_f32 v12, v12
    s_add_u32 s58, s63, 1
    s_mul_i32 s58, s58, 1536
    v_mul_f32 v16, v16, v12
    v_mul_f32 v17, v17, v12
    v_mul_f32 v32, v120, v16
    v_fmac_f32 v32, v100, v17
    v_mul_f32 v33, v121, v16
    v_fmac_f32 v33, v101, v17
    v_mul_f32 v34, v122, v16
    v_fmac_f32 v34, v102, v17
    v_mul_f32 v35, v124, v16
    v_fmac_f32 v35, v104, v17
    v_mul_f32 v36, v125, v16
    v_fmac_f32 v36, v105, v17
    v_mul_f32 v37, v126, v16
    v_fmac_f32 v37, v106, v17
    v_mul_f32 v38, v128, v16
    v_fmac_f32 v38, v108, v17
    v_mul_f32 v39, v129, v16
    v_fmac_f32 v39, v109, v17
    v_mul_f32 v40, v130, v16
    v_fmac_f32 v40, v110, v17
    v_mul_f32 v41, v132, v16
    v_fmac_f32 v41, v112, v17
    v_mul_f32 v42, v133, v16
    v_fmac_f32 v42, v113, v17
    v_mul_f32 v43, v134, v16
    v_fmac_f32 v43, v114, v17
    v_cvt_pk_bf16_f32 v44, v32, v33
    v_cvt_pk_bf16_f32 v45, v34, v35
    v_cvt_pk_bf16_f32 v46, v36, v37
    v_cvt_pk_bf16_f32 v47, v38, v39
    v_cvt_pk_bf16_f32 v48, v40, v41
    v_cvt_pk_bf16_f32 v49, v42, v43
    buffer_store_dwordx2 v[44:45], v8, s[48:51], s58 offen offset:0
    buffer_store_dwordx2 v[46:47], v8, s[48:51], s58 offen offset:128
    buffer_store_dwordx2 v[48:49], v8, s[48:51], s58 offen offset:256
L_fm31:
L_fin:
L_end:
    s_endpgm
    .p2align 8
    .type second_item,@object
second_item:
    .byte 32, 31, 10, 8, 42, 40, 0, 2, 48, 50, 26, 24, 58, 159, 16, 18
    .byte 133, 135, 191, 223, 143, 141, 165, 145, 149, 151, 175, 173, 56, 157, 147, 167
    .byte 102, 116, 92, 78, 108, 247, 86, 241, 195, 100, 76, 251, 201, 110, 70, 68
    .byte 118, 209, 233, 94, 124, 126, 227, 84, 137, 125, 249, 215, 239, 88, 243, 232
    .byte 15, 13, 37, 39, 5, 7, 47, 45, 34, 29, 53, 55, 21, 23, 63, 61
    .byte 170, 168, 128, 146, 160, 162, 154, 152, 186, 184, 19, 183, 176, 178, 138, 77
    .byte 89, 91, 115, 113, 83, 65, 121, 107, 236, 75, 99, 212, 230, 244, 105, 79
    .byte 73, 254, 198, 97, 67, 81, 204, 123, 252, 238, 214, 71, 246, 228, 220, 206
    .byte 22, 20, 139, 155, 12, 14, 38, 129, 6, 4, 44, 62, 185, 187, 181, 36
    .byte 179, 161, 60, 46, 28, 30, 54, 52, 163, 177, 130, 189, 35, 171, 131, 225
    .byte 64, 66, 122, 120, 217, 72, 96, 199, 80, 231, 106, 221, 74, 253, 112, 98
    .byte 245, 82, 207, 205, 90, 237, 197, 114, 229, 219, 153, 104, 211, 203, 213, 235
    .byte 41, 43, 3, 164, 51, 49, 25, 27, 127, 59, 166, 180, 134, 33, 188, 174
    .byte 57, 158, 182, 1, 169, 132, 9, 190, 140, 142, 144, 17, 150, 148, 172, 11
    .byte 218, 109, 224, 226, 117, 119, 95, 93, 156, 216, 85, 87, 192, 103, 250, 248
    .byte 202, 200, 69, 242, 208, 194, 234, 136, 111, 193, 240, 196, 101, 210, 222, 255
    .size second_item, 256
.section .rodata,"a"
.p2align 6
.amdhsa_kernel standalone__kv_cache_quant_int4_int2_kv_with_per_channel_or_per_token_scales__sampling_kernel
  .amdhsa_next_free_vgpr 208
  .amdhsa_next_free_sgpr 102
  .amdhsa_accum_offset 208
  .amdhsa_group_segment_fixed_size 0
  .amdhsa_kernarg_size 80
  .amdhsa_user_sgpr_count 2
  .amdhsa_user_sgpr_kernarg_segment_ptr 1
  .amdhsa_system_sgpr_workgroup_id_x 1
  .amdhsa_float_denorm_mode_32 3
.end_amdhsa_kernel
```
